```python
import torch

def _softmax(x, axis=-1):
    return torch.softmax(x, dim=axis)
def _gelu(x):
    return torch.nn.functional.gelu(x, approximate="tanh")
def _silu(x):
    return torch.nn.functional.silu(x)
def _sigmoid(x):
    return torch.sigmoid(x)
def _layernorm(x, axis=-1, eps=1e-5):
    m = x.mean(dim=axis, keepdim=True)
    v = x.var(dim=axis, keepdim=True, unbiased=False)
    return (x - m) / torch.sqrt(v + eps)
def _scatter_add(tgt, idx, src, axis=0):
    return tgt.clone().index_add_(axis, idx, src)
def _segment_sum(src, seg, n):
    out = torch.zeros((n,) + src.shape[1:], dtype=src.dtype)
    return out.index_add_(0, seg, src)
def _pad(x, pw):
    flat = tuple(v for pair in reversed(pw) for v in pair)
    return torch.nn.functional.pad(x, flat)

kernel_name = 'standalone__modern_conv_block_convnext__vision'

def setup_inputs():

    _w = (lambda a: (lambda t: t.to(torch.bfloat16) if t.is_floating_point() else t)(torch.as_tensor(a)))
    H = W = 512
    C = 96
    K = 3
    return {
        "x": _w((lambda *s: torch.randn(*s, dtype=torch.bfloat16) * 0.05)(1, H, W, C)),
        "dw": _w((lambda *s: torch.randn(*s, dtype=torch.bfloat16) * 0.05)(K, K, C)),
        "w1": _w((lambda *s: torch.randn(*s, dtype=torch.bfloat16) * 0.05)(C, 4 * C)),
        "b1": _w((lambda *s: torch.randn(*s, dtype=torch.bfloat16) * 0.2)(4 * C)),
        "w2": _w((lambda *s: torch.randn(*s, dtype=torch.bfloat16) * 0.05)(4 * C, C)),
        "b2": _w((lambda *s: torch.randn(*s, dtype=torch.bfloat16) * 0.2)(C)),
        "gamma": _w((lambda *s: torch.randn(*s, dtype=torch.bfloat16) * 0.05)(C)),
    }

def reference(x, dw, w1, b1, w2, b2, gamma):
    B, H, W, C = x.shape
    K = dw.shape[0]
    pad = K // 2
    xp = _pad(x, ((0,0),(pad,pad),(pad,pad),(0,0)))
    out = torch.zeros_like(x)
    for i in range(K):
        for j in range(K):
            out = out + xp[:, i:i+H, j:j+W, :] * dw[i, j][None, None, None, :]
    h = _layernorm(out, axis=-1)
    h = torch.einsum('bhwc,ce->bhwe', h, w1) + b1
    h = _gelu(h)
    h = torch.einsum('bhwe,ec->bhwc', h, w2) + b2
    return x + gamma[None, None, None, :] * h
```

```asm
; @launch grid=(256,1,1) block=(256,1,1) lds=163840
.amdgcn_target "amdgcn-amd-amdhsa--gfx950"
.text
.globl standalone__modern_conv_block_convnext__vision_kernel
.p2align 8
.type standalone__modern_conv_block_convnext__vision_kernel,@function
standalone__modern_conv_block_convnext__vision_kernel:
    s_cmp_ge_u32 s2, 256
    s_cbranch_scc1 L_end
    s_load_dwordx16 s[4:19], s[0:1], 0
    v_lshrrev_b32 v128, 6, v0
    v_and_b32 v129, 63, v0
    v_readfirstlane_b32 s3, v128
    s_getpc_b64 s[60:61]
L_pc:
    v_lshlrev_b32 v18, 7, v0
    v_add_u32 v18, L_prep0-L_pc, v18
    v_min_u32 v18, L_end-L_pc, v18
    v_mov_b32 v19, s61
    v_add_co_u32 v18, vcc, s60, v18
    s_nop 1
    v_addc_co_u32 v19, vcc, 0, v19, vcc
    global_load_dword v18, v[18:19], off
    s_and_b32 s60, s2, 7
    s_lshl_b32 s60, s60, 5
    s_lshr_b32 s61, s2, 3
    s_add_u32 s60, s60, s61
    s_lshr_b32 s61, s60, 4
    s_and_b32 s60, s60, 15
    s_lshl_b32 s54, s61, 5
    s_lshl_b32 s60, s60, 5
    s_lshl_b32 s62, s3, 3
    s_add_u32 s55, s60, s62
    s_mul_i32 s61, s54, 98304
    s_mul_i32 s62, s55, 192
    s_add_u32 s63, s61, s62
    s_sub_u32 s64, s63, 98496
    s_sub_u32 s65, s55, 1
    s_mul_i32 s56, s3, 12800
    s_add_u32 s56, s56, 90112
    s_mov_b32 s68, 98304
    s_movk_i32 s69, 192
    v_lshrrev_b32 v128, 2, v129
    v_and_b32 v130, 3, v129
    v_mov_b32 v135, s64
    v_bfrev_b32 v136, 1
    v_mul_u32_u24 v131, 205, v128
    v_lshrrev_b32 v131, 11, v131
    v_mad_i32_i24 v132, v131, -10, v128
    v_bfe_u32 v133, v131, 1, 1
    v_bfe_u32 v134, v132, 2, 1
    v_lshl_or_b32 v133, v133, 1, v134
    v_xor_b32 v133, v133, v130
    v_mad_u32_u24 v131, v131, s68, v135
    v_lshl_add_u32 v131, v133, 4, v131
    v_mad_u32_u24 v131, v132, s69, v131
    v_add_u32 v132, s65, v132
    v_cmp_gt_u32 vcc, 0x200, v132
    s_nop 1
    v_cndmask_b32 v1, v136, v131, vcc
    v_add_u32 v128, 16, v128
    v_mul_u32_u24 v131, 205, v128
    v_lshrrev_b32 v131, 11, v131
    v_mad_i32_i24 v132, v131, -10, v128
    v_bfe_u32 v133, v131, 1, 1
    v_bfe_u32 v134, v132, 2, 1
    v_lshl_or_b32 v133, v133, 1, v134
    v_xor_b32 v133, v133, v130
    v_mad_u32_u24 v131, v131, s68, v135
    v_lshl_add_u32 v131, v133, 4, v131
    v_mad_u32_u24 v131, v132, s69, v131
    v_add_u32 v132, s65, v132
    v_cmp_gt_u32 vcc, 0x200, v132
    s_nop 1
    v_cndmask_b32 v2, v136, v131, vcc
    v_add_u32 v128, 16, v128
    v_mul_u32_u24 v131, 205, v128
    v_lshrrev_b32 v131, 11, v131
    v_mad_i32_i24 v132, v131, -10, v128
    v_bfe_u32 v133, v131, 1, 1
    v_bfe_u32 v134, v132, 2, 1
    v_lshl_or_b32 v133, v133, 1, v134
    v_xor_b32 v133, v133, v130
    v_mad_u32_u24 v131, v131, s68, v135
    v_lshl_add_u32 v131, v133, 4, v131
    v_mad_u32_u24 v131, v132, s69, v131
    v_add_u32 v132, s65, v132
    v_cmp_gt_u32 vcc, 0x200, v132
    s_nop 1
    v_cndmask_b32 v3, v136, v131, vcc
    v_add_u32 v128, 16, v128
    v_mul_u32_u24 v131, 205, v128
    v_lshrrev_b32 v131, 11, v131
    v_mad_i32_i24 v132, v131, -10, v128
    v_bfe_u32 v133, v131, 1, 1
    v_bfe_u32 v134, v132, 2, 1
    v_lshl_or_b32 v133, v133, 1, v134
    v_xor_b32 v133, v133, v130
    v_mad_u32_u24 v131, v131, s68, v135
    v_lshl_add_u32 v131, v133, 4, v131
    v_mad_u32_u24 v131, v132, s69, v131
    v_add_u32 v132, s65, v132
    v_cmp_gt_u32 vcc, 0x200, v132
    s_nop 1
    v_cndmask_b32 v4, v136, v131, vcc
    v_add_u32 v128, 16, v128
    v_mul_u32_u24 v131, 205, v128
    v_lshrrev_b32 v131, 11, v131
    v_mad_i32_i24 v132, v131, -10, v128
    v_bfe_u32 v133, v131, 1, 1
    v_bfe_u32 v134, v132, 2, 1
    v_lshl_or_b32 v133, v133, 1, v134
    v_xor_b32 v133, v133, v130
    v_mad_u32_u24 v131, v131, s68, v135
    v_lshl_add_u32 v131, v133, 4, v131
    v_mad_u32_u24 v131, v132, s69, v131
    v_add_u32 v132, s65, v132
    v_cmp_gt_u32 vcc, 0x200, v132
    s_nop 1
    v_cndmask_b32 v5, v136, v131, vcc
    v_add_u32 v128, 16, v128
    v_mul_u32_u24 v131, 205, v128
    v_lshrrev_b32 v131, 11, v131
    v_mad_i32_i24 v132, v131, -10, v128
    v_bfe_u32 v133, v131, 1, 1
    v_bfe_u32 v134, v132, 2, 1
    v_lshl_or_b32 v133, v133, 1, v134
    v_xor_b32 v133, v133, v130
    v_mad_u32_u24 v131, v131, s68, v135
    v_lshl_add_u32 v131, v133, 4, v131
    v_mad_u32_u24 v131, v132, s69, v131
    v_add_u32 v132, s65, v132
    v_cmp_gt_u32 vcc, 0x200, v132
    s_nop 1
    v_cndmask_b32 v6, v136, v131, vcc
    v_lshrrev_b32 v128, 4, v129
    v_add_u32 v128, 96, v128
    v_bfe_u32 v130, v129, 2, 2
    v_mul_u32_u24 v131, 205, v128
    v_lshrrev_b32 v131, 11, v131
    v_mad_i32_i24 v132, v131, -10, v128
    v_bfe_u32 v133, v131, 1, 1
    v_bfe_u32 v134, v132, 2, 1
    v_lshl_or_b32 v133, v133, 1, v134
    v_xor_b32 v133, v133, v130
    v_mad_u32_u24 v131, v131, s68, v135
    v_lshl_add_u32 v131, v133, 4, v131
    v_mad_u32_u24 v131, v132, s69, v131
    v_add_u32 v132, s65, v132
    v_cmp_gt_u32 vcc, 0x200, v132
    v_and_b32 v133, 3, v129
    v_lshl_add_u32 v131, v133, 2, v131
    v_cndmask_b32 v7, v136, v131, vcc
    s_cmp_lt_u32 s55, 504
    s_cselect_b32 s66, 10, 0
    v_add_u32 v135, 1856, v135
    v_mad_u32_u24 v131, v129, s68, v135
    v_cmp_gt_u32 vcc, s66, v129
    s_nop 1
    v_cndmask_b32 v31, v136, v131, vcc
    v_lshrrev_b32 v138, 5, v129
    v_mul_u32_u24 v139, 1366, v0
    v_lshrrev_b32 v139, 16, v139
    v_mul_u32_u24 v139, 384, v139
    v_lshl_add_u32 v139, v0, 2, v139
    v_lshlrev_b32 v140, 3, v0
    s_lshr_b32 s71, s2, 3
    s_lshl_b32 s71, s71, 2
    s_add_u32 s71, s71, s3
    s_mul_i32 s71, s71, 640
    v_lshlrev_b32 v141, 7, v129
    v_cmp_gt_u32 vcc, 5, v129
    s_nop 1
    v_cndmask_b32 v141, v136, v141, vcc
    s_waitcnt lgkmcnt(0)
    s_mov_b32 s20, s4
    s_mov_b32 s21, s5
    s_mov_b32 s22, 50331648
    s_mov_b32 s23, 0x20000
    s_mov_b32 s28, s6
    s_mov_b32 s29, s7
    s_mov_b32 s30, 1728
    s_mov_b32 s31, 0x20000
    s_mov_b32 s36, s14
    s_mov_b32 s37, s15
    s_mov_b32 s38, 192
    s_mov_b32 s39, 0x20000
    s_mov_b32 s40, s16
    s_mov_b32 s41, s17
    s_mov_b32 s42, 192
    s_mov_b32 s43, 0x20000
    s_mov_b32 s44, s8
    s_mov_b32 s45, s9
    s_mov_b32 s46, 73728
    s_mov_b32 s47, 0x20000
    s_mov_b32 s48, s12
    s_mov_b32 s49, s13
    s_mov_b32 s50, 73728
    s_mov_b32 s51, 0x20000
    s_mov_b32 s32, s10
    s_mov_b32 s33, s11
    s_mov_b32 s34, 768
    s_mov_b32 s35, 0x20000
    buffer_load_dword v142, v141, s[44:47], s71 offen
    buffer_load_dword v143, v141, s[48:51], s71 offen
    v_lshlrev_b32 v147, 7, v129
    buffer_load_dword v147, v147, s[32:35], 0 offen
    buffer_load_dword v144, v139, s[28:31], 0 offen
    buffer_load_dword v145, v139, s[28:31], 0 offen offset:192
    buffer_load_dword v146, v139, s[28:31], 0 offen offset:384
    buffer_load_dwordx2 v[148:149], v140, s[36:39], 0 offen
    buffer_load_dwordx2 v[150:151], v140, s[40:43], 0 offen
    s_add_u32 m0, s56, 0
    s_nop 0
    buffer_load_dwordx4 v1, s[20:23], 0 offen offset:0 lds
    s_add_u32 m0, s56, 1024
    s_nop 0
    buffer_load_dwordx4 v2, s[20:23], 0 offen offset:0 lds
    s_add_u32 m0, s56, 2048
    s_nop 0
    buffer_load_dwordx4 v3, s[20:23], 0 offen offset:0 lds
    s_add_u32 m0, s56, 3072
    s_nop 0
    buffer_load_dwordx4 v4, s[20:23], 0 offen offset:0 lds
    s_add_u32 m0, s56, 4096
    s_nop 0
    buffer_load_dwordx4 v5, s[20:23], 0 offen offset:0 lds
    s_add_u32 m0, s56, 5120
    s_nop 0
    buffer_load_dwordx4 v6, s[20:23], 0 offen offset:0 lds
    s_add_u32 m0, s56, 6144
    s_nop 0
    buffer_load_dword v7, s[20:23], 0 offen offset:0 lds
    v_mov_b32 v157, 268435456
    v_and_b32 v152, 15, v129
    v_lshrrev_b32 v153, 4, v129
    v_add_u32 v154, 4, v152
    v_lshrrev_b32 v154, 3, v154
    v_mad_i32_i24 v155, v154, -4, v152
    v_and_b32 v154, 1, v154
    v_and_b32 v156, 1, v153
    v_lshlrev_b32 v158, 1, v154
    v_mul_u32_u24 v159, 98304, v158
    v_mad_u32_u24 v159, v155, s69, v159
    v_lshl_add_u32 v159, v138, 4, v159
    v_lshl_add_u32 v159, v156, 5, v159
    v_add_u32 v26, s63, v159
    v_xor_b32 v161, v154, v138
    v_add_u32 v159, v158, v153
    v_add_u32 v160, 0, v155
    v_mad_u32_u24 v159, v159, 10, v160
    v_bfe_u32 v160, v160, 2, 1
    v_lshl_or_b32 v160, v161, 1, v160
    v_lshl_add_u32 v160, v159, 2, v160
    v_lshl_add_u32 v8, v160, 4, s56
    v_add_u32 v162, 1, v156
    v_add_u32 v159, v158, v138
    v_add_u32 v160, v162, v155
    v_mad_u32_u24 v159, v159, 10, v160
    v_bfe_u32 v160, v160, 2, 1
    v_lshl_or_b32 v160, v154, 1, v160
    v_lshl_add_u32 v160, v159, 2, v160
    v_lshl_add_u32 v12, v160, 4, s56
    v_xor_b32 v9, 16, v8
    v_xor_b32 v10, 32, v8
    v_xor_b32 v11, 48, v8
    v_xor_b32 v13, 16, v12
    v_xor_b32 v14, 32, v12
    v_xor_b32 v15, 48, v12
    v_xor_b32 v161, v154, v156
    v_add_u32 v159, v158, v162
    v_add_u32 v160, 1, v155
    v_mad_u32_u24 v159, v159, 10, v160
    v_bfe_u32 v160, v160, 2, 1
    v_lshl_or_b32 v160, v161, 1, v160
    v_xor_b32 v160, v138, v160
    v_lshl_add_u32 v160, v159, 2, v160
    v_lshl_add_u32 v20, v160, 4, s56
    v_xor_b32 v21, 32, v20
    v_bfe_u32 v158, v152, 2, 1
    v_sub_u32 v158, v153, v158
    v_and_b32 v159, 3, v152
    v_mul_u32_u24 v16, 0x1111, v159
    v_lshrrev_b32 v160, 3, v152
    v_lshl_add_u32 v159, v160, 2, v159
    v_lshlrev_b32 v159, 5, v159
    v_add_u32 v159, 141312, v159
    s_movk_i32 s70, 3072
    v_cmp_gt_u32 vcc, 3, v158
    v_mad_u32_u24 v159, v158, s70, v159
    s_nop 0
    v_cndmask_b32 v22, v157, v159, vcc
    v_lshlrev_b32 v23, 4, v129
    v_add_u32 v24, 40960, v23
    v_lshlrev_b32 v25, 4, v138
    v_add_u32 v25, 150528, v25
    v_bfe_u32 v158, v129, 1, 1
    v_bfe_u32 v159, v129, 3, 2
    v_lshl_add_u32 v158, v159, 1, v158
    v_bfe_u32 v159, v129, 2, 1
    v_cmp_eq_u32 vcc, v159, v138
    v_and_b32 v160, 1, v129
    v_lshlrev_b32 v160, 4, v160
    v_mov_b32 v161, 0x3f80
    v_lshlrev_b32 v160, v160, v161
    v_cndmask_b32 v158, 15, v158, vcc
    v_cmp_eq_u32 vcc, 0, v158
    s_nop 1
    v_cndmask_b32 v162, 0, v160, vcc
    v_cmp_eq_u32 vcc, 1, v158
    s_nop 1
    v_cndmask_b32 v163, 0, v160, vcc
    v_cmp_eq_u32 vcc, 2, v158
    s_nop 1
    v_cndmask_b32 v164, 0, v160, vcc
    v_cmp_eq_u32 vcc, 3, v158
    s_nop 1
    v_cndmask_b32 v165, 0, v160, vcc
    v_cmp_eq_u32 vcc, 4, v158
    s_nop 1
    v_cndmask_b32 v166, 0, v160, vcc
    v_cmp_eq_u32 vcc, 5, v158
    s_nop 1
    v_cndmask_b32 v167, 0, v160, vcc
    v_cmp_eq_u32 vcc, 6, v158
    s_nop 1
    v_cndmask_b32 v168, 0, v160, vcc
    v_cmp_eq_u32 vcc, 7, v158
    s_nop 1
    v_cndmask_b32 v169, 0, v160, vcc
    v_accvgpr_write_b32 a224, v162
    v_accvgpr_write_b32 a225, v163
    v_accvgpr_write_b32 a226, v164
    v_accvgpr_write_b32 a227, v165
    v_accvgpr_write_b32 a228, v166
    v_accvgpr_write_b32 a229, v167
    v_accvgpr_write_b32 a230, v168
    v_accvgpr_write_b32 a231, v169
    s_mov_b32 s24, s18
    s_mov_b32 s25, s19
    s_mov_b32 s26, 50331648
    s_mov_b32 s27, 0x20000
    s_mov_b32 s52, 0
    s_mov_b32 s80, 0
    s_mov_b32 s81, 98304
    s_mov_b32 s82, 393216
    s_mov_b32 s83, 491520
    s_mov_b32 s53, 1156203754
    s_mov_b32 s58, 0x3c003c00
    s_mov_b32 s85, 150912
    s_mov_b32 s59, 0x3eeff558
    s_mov_b32 s84, 0x37800000
    v_lshlrev_b32 v17, 4, v138
    v_lshrrev_b32 v17, v17, -1
    s_cmp_ge_u32 s3, 2
    s_cbranch_scc1 L_prep1
L_prep0:
    v_bfe_u32 v158, v129, 2, 1
    v_bfe_u32 v159, v129, 3, 2
    v_lshl_add_u32 v158, v158, 2, v159
    v_mul_u32_u24 v158, 768, v158
    v_and_b32 v159, 3, v129
    v_lshl_add_u32 v236, v138, 2, v159
    v_lshlrev_b32 v236, 4, v236
    v_add_u32 v232, v158, v236
    v_and_b32 v159, 0x5c, v0
    v_cmp_eq_u32 vcc, 0x5c, v159
    s_mul_i32 s72, s3, 36864
    s_mul_i32 s60, s3, 3072
    v_cndmask_b32 v237, v157, v236, vcc
    v_add_u32 v234, s60, v24
    s_mov_b32 s74, 72960
    buffer_load_dwordx4 v[176:179], v236, s[44:47], s74 offen offset:0
    buffer_load_dwordx4 v[180:183], v236, s[44:47], s74 offen offset:128
    s_add_u32 s74, s72, 0
    s_add_u32 s75, s72, 6144
    buffer_load_dwordx4 a[0:3], v232, s[44:47], s74 offen offset:0
    buffer_load_dwordx4 a[4:7], v232, s[44:47], s74 offen offset:128
    buffer_load_dwordx4 a[8:11], v232, s[44:47], s75 offen offset:0
    buffer_load_dwordx4 a[12:15], v232, s[44:47], s75 offen offset:128
    s_add_u32 s74, s72, 12288
    s_add_u32 s75, s72, 18432
    buffer_load_dwordx4 a[16:19], v232, s[44:47], s74 offen offset:0
    buffer_load_dwordx4 a[20:23], v232, s[44:47], s74 offen offset:128
    buffer_load_dwordx4 a[24:27], v232, s[44:47], s75 offen offset:0
    buffer_load_dwordx4 a[28:31], v232, s[44:47], s75 offen offset:128
    v_lshlrev_b32 v158, 6, v0
    v_add_u32 v158, 141312, v158
    v_cmp_gt_u32 vcc, 144, v0
    s_nop 1
    v_cndmask_b32 v158, v157, v158, vcc
    v_and_b32 v159, 3, v0
    v_lshl_add_u32 v160, v159, 2, v158
    v_lshrrev_b32 v159, 1, v159
    v_lshl_add_u32 v159, v159, 2, v158
    v_and_b32 v161, 0x1c, v0
    v_bfe_u32 v162, v0, 1, 1
    v_and_b32 v163, 1, v0
    v_lshl_or_b32 v162, v163, 1, v162
    v_or_b32 v161, v161, v162
    v_lshlrev_b32 v161, 4, v161
    v_add_u32 v161, 150528, v161
    v_cmp_gt_u32 vcc, 24, v0
    s_nop 1
    v_cndmask_b32 v161, v157, v161, vcc
    v_mov_b32 v164, 0
    v_mov_b32 v165, 0
    v_mov_b32 v166, 0
    v_mov_b32 v167, 0
    ds_write_b128 v158, v[164:167]
    ds_write_b128 v158, v[164:167] offset:16
    ds_write_b128 v158, v[164:167] offset:32
    ds_write_b128 v158, v[164:167] offset:48
    s_waitcnt vmcnt(21)
    ds_write_b16 v160, v144
    ds_write_b16_d16_hi v160, v144 offset:34
    s_waitcnt vmcnt(20)
    ds_write_b16 v159, v145 offset:16
    ds_write_b16_d16_hi v159, v145 offset:48
    s_waitcnt vmcnt(19)
    ds_write_b16 v159, v146 offset:24
    ds_write_b16_d16_hi v159, v146 offset:56
    s_waitcnt vmcnt(18)
    v_lshlrev_b32 v168, 16, v148
    v_and_b32 v169, 0xffff0000, v148
    v_lshlrev_b32 v170, 16, v149
    v_and_b32 v171, 0xffff0000, v149
    s_waitcnt vmcnt(17)
    v_lshlrev_b32 v172, 16, v150
    v_and_b32 v173, 0xffff0000, v150
    v_lshlrev_b32 v174, 16, v151
    v_and_b32 v175, 0xffff0000, v151
    v_mul_f32 v168, v168, v172
    v_mul_f32 v169, v169, v173
    v_mul_f32 v170, v170, v174
    v_mul_f32 v171, v171, v175
    ds_write_b128 v161, v[168:171]
    buffer_load_dwordx4 v[200:203], v237, s[32:35], 0 offen offset:0
    buffer_load_dwordx4 v[204:207], v237, s[32:35], 0 offen offset:128
    s_add_u32 s74, s72, 24576
    s_add_u32 s75, s72, 30720
    buffer_load_dwordx4 a[32:35], v232, s[44:47], s74 offen offset:0
    buffer_load_dwordx4 a[36:39], v232, s[44:47], s74 offen offset:128
    buffer_load_dwordx4 a[40:43], v232, s[44:47], s75 offen offset:0
    buffer_load_dwordx4 a[44:47], v232, s[44:47], s75 offen offset:128
    s_mov_b32 s74, 73216
    buffer_load_dwordx4 v[184:187], v236, s[44:47], s74 offen offset:0
    buffer_load_dwordx4 v[188:191], v236, s[44:47], s74 offen offset:128
    s_add_u32 s74, s72, 0
    s_add_u32 s75, s72, 6144
    buffer_load_dwordx4 a[48:51], v232, s[44:47], s74 offen offset:256
    buffer_load_dwordx4 a[52:55], v232, s[44:47], s74 offen offset:384
    buffer_load_dwordx4 a[56:59], v232, s[44:47], s75 offen offset:256
    buffer_load_dwordx4 a[60:63], v232, s[44:47], s75 offen offset:384
    s_add_u32 s74, s72, 12288
    s_add_u32 s75, s72, 18432
    buffer_load_dwordx4 a[64:67], v232, s[44:47], s74 offen offset:256
    buffer_load_dwordx4 a[68:71], v232, s[44:47], s74 offen offset:384
    buffer_load_dwordx4 a[72:75], v232, s[44:47], s75 offen offset:256
    buffer_load_dwordx4 a[76:79], v232, s[44:47], s75 offen offset:384
    s_mov_b32 s70, 0x409d30fc
    v_mul_u32_u24 v252, 0x100010, v0
    v_add_u32 v252, 0xc0004, v252
    v_lshl_add_u32 v253, v0, 2, s85
    v_add_u32 v80, 0x0, v252
    v_add_u32 v88, 0x10001000, v252
    v_add_u32 v96, 0x20002000, v252
    v_add_u32 v104, 0x30003000, v252
    v_cvt_f32_f16 v81, v80
    v_cvt_f32_f16 v89, v88
    v_cvt_f32_f16 v97, v96
    v_cvt_f32_f16 v105, v104
    v_cvt_f32_f16_sdwa v82, v80 dst_sel:DWORD dst_unused:UNUSED_PAD src0_sel:WORD_1
    v_cvt_f32_f16_sdwa v90, v88 dst_sel:DWORD dst_unused:UNUSED_PAD src0_sel:WORD_1
    v_cvt_f32_f16_sdwa v98, v96 dst_sel:DWORD dst_unused:UNUSED_PAD src0_sel:WORD_1
    v_cvt_f32_f16_sdwa v106, v104 dst_sel:DWORD dst_unused:UNUSED_PAD src0_sel:WORD_1
    v_fma_f32 v83, v81, v81, s70
    v_fma_f32 v91, v89, v89, s70
    v_fma_f32 v99, v97, v97, s70
    v_fma_f32 v107, v105, v105, s70
    v_fma_f32 v84, v82, v82, s70
    v_fma_f32 v92, v90, v90, s70
    v_fma_f32 v100, v98, v98, s70
    v_fma_f32 v108, v106, v106, s70
    v_mul_f32 v83, -v81, v83
    v_mul_f32 v91, -v89, v91
    v_mul_f32 v99, -v97, v99
    v_mul_f32 v107, -v105, v107
    v_mul_f32 v84, -v82, v84
    v_mul_f32 v92, -v90, v92
    v_mul_f32 v100, -v98, v100
    v_mul_f32 v108, -v106, v108
    v_exp_f32 v83, v83
    v_exp_f32 v91, v91
    v_exp_f32 v99, v99
    v_exp_f32 v107, v107
    v_exp_f32 v84, v84
    v_exp_f32 v92, v92
    v_exp_f32 v100, v100
    v_exp_f32 v108, v108
    v_add_f32 v83, 1.0, v83
    v_add_f32 v91, 1.0, v91
    v_add_f32 v99, 1.0, v99
    v_add_f32 v107, 1.0, v107
    v_add_f32 v84, 1.0, v84
    v_add_f32 v92, 1.0, v92
    v_add_f32 v100, 1.0, v100
    v_add_f32 v108, 1.0, v108
    v_rcp_f32 v83, v83
    v_rcp_f32 v91, v91
    v_rcp_f32 v99, v99
    v_rcp_f32 v107, v107
    v_rcp_f32 v84, v84
    v_rcp_f32 v92, v92
    v_rcp_f32 v100, v100
    v_rcp_f32 v108, v108
    v_mul_f32 v83, v81, v83
    v_mul_f32 v91, v89, v91
    v_mul_f32 v99, v97, v99
    v_mul_f32 v107, v105, v107
    v_mul_f32 v84, v82, v84
    v_mul_f32 v92, v90, v92
    v_mul_f32 v100, v98, v100
    v_mul_f32 v108, v106, v108
    v_cvt_pk_f16_f32 v80, v83, v84
    v_cvt_pk_f16_f32 v88, v91, v92
    v_cvt_pk_f16_f32 v96, v99, v100
    v_cvt_pk_f16_f32 v104, v107, v108
    ds_write_b32 v253, v80 offset:0
    ds_write_b32 v253, v88 offset:1024
    ds_write_b32 v253, v96 offset:2048
    ds_write_b32 v253, v104 offset:3072
    v_add_u32 v80, 0x40004000, v252
    v_add_u32 v88, 0x50005000, v252
    v_add_u32 v96, 0x60006000, v252
    v_add_u32 v104, 0x70007000, v252
    v_cvt_f32_f16 v81, v80
    v_cvt_f32_f16 v89, v88
    v_cvt_f32_f16 v97, v96
    v_cvt_f32_f16 v105, v104
    v_cvt_f32_f16_sdwa v82, v80 dst_sel:DWORD dst_unused:UNUSED_PAD src0_sel:WORD_1
    v_cvt_f32_f16_sdwa v90, v88 dst_sel:DWORD dst_unused:UNUSED_PAD src0_sel:WORD_1
    v_cvt_f32_f16_sdwa v98, v96 dst_sel:DWORD dst_unused:UNUSED_PAD src0_sel:WORD_1
    v_cvt_f32_f16_sdwa v106, v104 dst_sel:DWORD dst_unused:UNUSED_PAD src0_sel:WORD_1
    v_fma_f32 v83, v81, v81, s70
    v_fma_f32 v91, v89, v89, s70
    v_fma_f32 v99, v97, v97, s70
    v_fma_f32 v107, v105, v105, s70
    v_fma_f32 v84, v82, v82, s70
    v_fma_f32 v92, v90, v90, s70
    v_fma_f32 v100, v98, v98, s70
    v_fma_f32 v108, v106, v106, s70
    v_mul_f32 v83, -v81, v83
    v_mul_f32 v91, -v89, v91
    v_mul_f32 v99, -v97, v99
    v_mul_f32 v107, -v105, v107
    v_mul_f32 v84, -v82, v84
    v_mul_f32 v92, -v90, v92
    v_mul_f32 v100, -v98, v100
    v_mul_f32 v108, -v106, v108
    v_exp_f32 v83, v83
    v_exp_f32 v91, v91
    v_exp_f32 v99, v99
    v_exp_f32 v107, v107
    v_exp_f32 v84, v84
    v_exp_f32 v92, v92
    v_exp_f32 v100, v100
    v_exp_f32 v108, v108
    v_add_f32 v83, 1.0, v83
    v_add_f32 v91, 1.0, v91
    v_add_f32 v99, 1.0, v99
    v_add_f32 v107, 1.0, v107
    v_add_f32 v84, 1.0, v84
    v_add_f32 v92, 1.0, v92
    v_add_f32 v100, 1.0, v100
    v_add_f32 v108, 1.0, v108
    v_rcp_f32 v83, v83
    v_rcp_f32 v91, v91
    v_rcp_f32 v99, v99
    v_rcp_f32 v107, v107
    v_rcp_f32 v84, v84
    v_rcp_f32 v92, v92
    v_rcp_f32 v100, v100
    v_rcp_f32 v108, v108
    v_mul_f32 v83, v81, v83
    v_mul_f32 v91, v89, v91
    v_mul_f32 v99, v97, v99
    v_mul_f32 v107, v105, v107
    v_mul_f32 v84, v82, v84
    v_mul_f32 v92, v90, v92
    v_mul_f32 v100, v98, v100
    v_mul_f32 v108, v106, v108
    v_cvt_pk_f16_f32 v80, v83, v84
    v_cvt_pk_f16_f32 v88, v91, v92
    v_cvt_pk_f16_f32 v96, v99, v100
    v_cvt_pk_f16_f32 v104, v107, v108
    s_waitcnt lgkmcnt(11)
    ds_write_b32 v253, v80 offset:4096
    ds_write_b32 v253, v88 offset:5120
    ds_write_b32 v253, v96 offset:6144
    ds_write_b32 v253, v104 offset:7168
    v_add_u32 v80, 0x80008000, v252
    v_add_u32 v88, 0x90009000, v252
    v_add_u32 v96, 0xa000a000, v252
    v_cvt_f32_f16 v81, v80
    v_cvt_f32_f16 v89, v88
    v_cvt_f32_f16 v97, v96
    v_cvt_f32_f16_sdwa v82, v80 dst_sel:DWORD dst_unused:UNUSED_PAD src0_sel:WORD_1
    v_cvt_f32_f16_sdwa v90, v88 dst_sel:DWORD dst_unused:UNUSED_PAD src0_sel:WORD_1
    v_cvt_f32_f16_sdwa v98, v96 dst_sel:DWORD dst_unused:UNUSED_PAD src0_sel:WORD_1
    v_fma_f32 v83, v81, v81, s70
    v_fma_f32 v91, v89, v89, s70
    v_fma_f32 v99, v97, v97, s70
    v_fma_f32 v84, v82, v82, s70
    v_fma_f32 v92, v90, v90, s70
    v_fma_f32 v100, v98, v98, s70
    v_mul_f32 v83, -v81, v83
    v_mul_f32 v91, -v89, v91
    v_mul_f32 v99, -v97, v99
    v_mul_f32 v84, -v82, v84
    v_mul_f32 v92, -v90, v92
    v_mul_f32 v100, -v98, v100
    v_exp_f32 v83, v83
    v_exp_f32 v91, v91
    v_exp_f32 v99, v99
    v_exp_f32 v84, v84
    v_exp_f32 v92, v92
    v_exp_f32 v100, v100
    v_add_f32 v83, 1.0, v83
    v_add_f32 v91, 1.0, v91
    v_add_f32 v99, 1.0, v99
    v_add_f32 v84, 1.0, v84
    v_add_f32 v92, 1.0, v92
    v_add_f32 v100, 1.0, v100
    v_rcp_f32 v83, v83
    v_rcp_f32 v91, v91
    v_rcp_f32 v99, v99
    v_rcp_f32 v84, v84
    v_rcp_f32 v92, v92
    v_rcp_f32 v100, v100
    v_mul_f32 v83, v81, v83
    v_mul_f32 v91, v89, v91
    v_mul_f32 v99, v97, v99
    v_mul_f32 v84, v82, v84
    v_mul_f32 v92, v90, v92
    v_mul_f32 v100, v98, v100
    v_cvt_pk_f16_f32 v80, v83, v84
    v_cvt_pk_f16_f32 v88, v91, v92
    v_cvt_pk_f16_f32 v96, v99, v100
    s_waitcnt lgkmcnt(12)
    ds_write_b32 v253, v80 offset:8192
    ds_write_b32 v253, v88 offset:9216
    ds_write_b32 v253, v96 offset:10240
    v_add_u32 v80, 0xb000b000, v252
    v_add_u32 v88, 0xc000c000, v252
    v_cvt_f32_f16 v81, v80
    v_cvt_f32_f16 v89, v88
    v_cvt_f32_f16_sdwa v82, v80 dst_sel:DWORD dst_unused:UNUSED_PAD src0_sel:WORD_1
    v_cvt_f32_f16_sdwa v90, v88 dst_sel:DWORD dst_unused:UNUSED_PAD src0_sel:WORD_1
    v_fma_f32 v83, v81, v81, s70
    v_fma_f32 v91, v89, v89, s70
    v_fma_f32 v84, v82, v82, s70
    v_fma_f32 v92, v90, v90, s70
    v_mul_f32 v83, -v81, v83
    v_mul_f32 v91, -v89, v91
    v_mul_f32 v84, -v82, v84
    v_mul_f32 v92, -v90, v92
    v_exp_f32 v83, v83
    v_exp_f32 v91, v91
    v_exp_f32 v84, v84
    v_exp_f32 v92, v92
    v_add_f32 v83, 1.0, v83
    v_add_f32 v91, 1.0, v91
    v_add_f32 v84, 1.0, v84
    v_add_f32 v92, 1.0, v92
    v_rcp_f32 v83, v83
    v_rcp_f32 v91, v91
    v_rcp_f32 v84, v84
    v_rcp_f32 v92, v92
    v_mul_f32 v83, v81, v83
    v_mul_f32 v91, v89, v91
    v_mul_f32 v84, v82, v84
    v_mul_f32 v92, v90, v92
    v_cvt_pk_f16_f32 v80, v83, v84
    v_cvt_pk_f16_f32 v88, v91, v92
    s_waitcnt lgkmcnt(13)
    ds_write_b32 v253, v80 offset:11264
    ds_write_b32 v253, v88 offset:12288
    s_waitcnt vmcnt(25)
    v_xor_b32 v176, 0x80008000, v176
    v_xor_b32 v177, 0x80008000, v177
    v_xor_b32 v178, 0x80008000, v178
    v_xor_b32 v179, 0x80008000, v179
    s_waitcnt vmcnt(24)
    v_xor_b32 v180, 0x80008000, v180
    v_xor_b32 v181, 0x80008000, v181
    v_xor_b32 v182, 0x80008000, v182
    v_xor_b32 v183, 0x80008000, v183
    v_mfma_f32_32x32x16_bf16 v[144:159], v[176:179], a[224:227], 0
    s_nop 0
    v_mfma_f32_32x32x16_bf16 v[144:159], v[180:183], a[228:231], v[144:159]
    s_waitcnt vmcnt(23)
    s_nop 8
    v_mfma_f32_32x32x16_bf16 v[80:95], a[0:3], a[224:227], v[144:159]
    s_waitcnt vmcnt(21)
    v_mfma_f32_32x32x16_bf16 v[96:111], a[8:11], a[224:227], v[144:159]
    v_mfma_f32_32x32x16_bf16 v[80:95], a[4:7], a[228:231], v[80:95]
    s_waitcnt vmcnt(20)
    v_mfma_f32_32x32x16_bf16 v[96:111], a[12:15], a[228:231], v[96:111]
    s_waitcnt vmcnt(19)
    v_mfma_f32_32x32x16_bf16 v[112:127], a[16:19], a[224:227], v[144:159]
    s_nop 7
    v_cvt_pk_f16_f32 v224, v80, v84
    v_cvt_pk_f16_f32 v225, v88, v92
    v_cvt_pk_f16_f32 v226, v96, v100
    v_cvt_pk_f16_f32 v227, v104, v108
    s_waitcnt lgkmcnt(14)
    ds_write_b128 v234, v[224:227] offset:0
    buffer_load_dwordx4 v[208:211], v237, s[32:35], 0 offen offset:256
    buffer_load_dwordx4 v[212:215], v237, s[32:35], 0 offen offset:384
    s_waitcnt vmcnt(19)
    v_mfma_f32_32x32x16_bf16 v[128:143], a[24:27], a[224:227], v[144:159]
    v_cvt_pk_f16_f32 v228, v81, v85
    v_cvt_pk_f16_f32 v229, v89, v93
    v_cvt_pk_f16_f32 v230, v97, v101
    v_cvt_pk_f16_f32 v231, v105, v109
    s_waitcnt lgkmcnt(14)
    ds_write_b128 v234, v[228:231] offset:12288
    s_add_u32 s74, s72, 24576
    s_add_u32 s75, s72, 30720
    v_mfma_f32_32x32x16_bf16 v[112:127], a[20:23], a[228:231], v[112:127]
    v_cvt_pk_f16_f32 v224, v82, v86
    v_cvt_pk_f16_f32 v225, v90, v94
    v_cvt_pk_f16_f32 v226, v98, v102
    v_cvt_pk_f16_f32 v227, v106, v110
    s_waitcnt lgkmcnt(14)
    ds_write_b128 v234, v[224:227] offset:24576
    buffer_load_dwordx4 a[80:83], v232, s[44:47], s74 offen offset:256
    buffer_load_dwordx4 a[84:87], v232, s[44:47], s74 offen offset:384
    s_waitcnt vmcnt(20)
    v_mfma_f32_32x32x16_bf16 v[128:143], a[28:31], a[228:231], v[128:143]
    v_cvt_pk_f16_f32 v228, v83, v87
    v_cvt_pk_f16_f32 v229, v91, v95
    v_cvt_pk_f16_f32 v230, v99, v103
    v_cvt_pk_f16_f32 v231, v107, v111
    s_waitcnt lgkmcnt(14)
    ds_write_b128 v234, v[228:231] offset:36864
    buffer_load_dwordx4 a[88:91], v232, s[44:47], s75 offen offset:256
    buffer_load_dwordx4 a[92:95], v232, s[44:47], s75 offen offset:384
    s_waitcnt vmcnt(19)
    v_mfma_f32_32x32x16_bf16 v[80:95], a[32:35], a[224:227], v[144:159]
    v_cvt_pk_f16_f32 v224, v112, v116
    v_cvt_pk_f16_f32 v225, v120, v124
    s_waitcnt vmcnt(17)
    v_mfma_f32_32x32x16_bf16 v[96:111], a[40:43], a[224:227], v[144:159]
    v_cvt_pk_f16_f32 v226, v128, v132
    v_cvt_pk_f16_f32 v227, v136, v140
    s_waitcnt lgkmcnt(14)
    ds_write_b128 v234, v[224:227] offset:1024
    s_mov_b32 s74, 73472
    buffer_load_dwordx4 v[192:195], v236, s[44:47], s74 offen offset:0
    buffer_load_dwordx4 v[196:199], v236, s[44:47], s74 offen offset:128
    s_add_u32 s74, s72, 0
    v_mfma_f32_32x32x16_bf16 v[80:95], a[36:39], a[228:231], v[80:95]
    v_cvt_pk_f16_f32 v228, v113, v117
    v_cvt_pk_f16_f32 v229, v121, v125
    s_waitcnt vmcnt(18)
    v_mfma_f32_32x32x16_bf16 v[96:111], a[44:47], a[228:231], v[96:111]
    v_cvt_pk_f16_f32 v230, v129, v133
    v_cvt_pk_f16_f32 v231, v137, v141
    s_waitcnt lgkmcnt(14)
    ds_write_b128 v234, v[228:231] offset:13312
    s_add_u32 s75, s72, 6144
    buffer_load_dwordx4 v[32:35], v232, s[44:47], s74 offen offset:512
    buffer_load_dwordx4 v[36:39], v232, s[44:47], s74 offen offset:640
    buffer_load_dwordx4 v[40:43], v232, s[44:47], s75 offen offset:512
    buffer_load_dwordx4 v[44:47], v232, s[44:47], s75 offen offset:640
    v_mfma_f32_32x32x16_bf16 v[96:111], v[200:203], a[224:227], v[96:111]
    v_cvt_pk_f16_f32 v224, v114, v118
    v_cvt_pk_f16_f32 v225, v122, v126
    v_cvt_pk_f16_f32 v226, v130, v134
    v_cvt_pk_f16_f32 v227, v138, v142
    s_waitcnt lgkmcnt(14)
    ds_write_b128 v234, v[224:227] offset:25600
    s_waitcnt vmcnt(21)
    v_xor_b32 v184, 0x80008000, v184
    v_xor_b32 v185, 0x80008000, v185
    v_xor_b32 v186, 0x80008000, v186
    v_xor_b32 v187, 0x80008000, v187
    s_waitcnt vmcnt(20)
    v_xor_b32 v188, 0x80008000, v188
    v_mfma_f32_32x32x16_bf16 v[96:111], v[204:207], a[228:231], v[96:111]
    v_cvt_pk_f16_f32 v228, v115, v119
    v_cvt_pk_f16_f32 v229, v123, v127
    v_cvt_pk_f16_f32 v230, v131, v135
    v_cvt_pk_f16_f32 v231, v139, v143
    s_waitcnt lgkmcnt(14)
    ds_write_b128 v234, v[228:231] offset:37888
    v_xor_b32 v189, 0x80008000, v189
    v_xor_b32 v190, 0x80008000, v190
    v_xor_b32 v191, 0x80008000, v191
    v_mfma_f32_32x32x16_bf16 v[144:159], v[184:187], a[224:227], 0
    s_nop 0
    v_mfma_f32_32x32x16_bf16 v[144:159], v[188:191], a[228:231], v[144:159]
    s_waitcnt vmcnt(19)
    s_nop 8
    v_mfma_f32_32x32x16_bf16 v[112:127], a[48:51], a[224:227], v[144:159]
    v_cvt_pk_f16_f32 v224, v80, v84
    v_cvt_pk_f16_f32 v225, v88, v92
    v_cvt_pk_f16_f32 v226, v96, v100
    v_cvt_pk_f16_f32 v227, v104, v108
    s_waitcnt lgkmcnt(14)
    ds_write_b128 v234, v[224:227] offset:2048
    s_add_u32 s74, s72, 12288
    s_waitcnt vmcnt(17)
    v_mfma_f32_32x32x16_bf16 v[128:143], a[56:59], a[224:227], v[144:159]
    v_cvt_pk_f16_f32 v228, v81, v85
    v_cvt_pk_f16_f32 v229, v89, v93
    v_cvt_pk_f16_f32 v230, v97, v101
    v_cvt_pk_f16_f32 v231, v105, v109
    s_waitcnt lgkmcnt(14)
    ds_write_b128 v234, v[228:231] offset:14336
    s_add_u32 s75, s72, 18432
    buffer_load_dwordx4 v[48:51], v232, s[44:47], s74 offen offset:512
    v_mfma_f32_32x32x16_bf16 v[112:127], a[52:55], a[228:231], v[112:127]
    v_cvt_pk_f16_f32 v224, v82, v86
    v_cvt_pk_f16_f32 v225, v90, v94
    v_cvt_pk_f16_f32 v226, v98, v102
    v_cvt_pk_f16_f32 v227, v106, v110
    s_waitcnt lgkmcnt(14)
    ds_write_b128 v234, v[224:227] offset:26624
    buffer_load_dwordx4 v[52:55], v232, s[44:47], s74 offen offset:640
    s_waitcnt vmcnt(18)
    v_mfma_f32_32x32x16_bf16 v[128:143], a[60:63], a[228:231], v[128:143]
    v_cvt_pk_f16_f32 v228, v83, v87
    v_cvt_pk_f16_f32 v229, v91, v95
    v_cvt_pk_f16_f32 v230, v99, v103
    v_cvt_pk_f16_f32 v231, v107, v111
    s_waitcnt lgkmcnt(14)
    ds_write_b128 v234, v[228:231] offset:38912
    v_subrev_u32 v234, 40960, v234
    buffer_load_dwordx4 v[56:59], v232, s[44:47], s75 offen offset:512
    buffer_load_dwordx4 v[60:63], v232, s[44:47], s75 offen offset:640
    s_waitcnt vmcnt(19)
    v_mfma_f32_32x32x16_bf16 v[80:95], a[64:67], a[224:227], v[144:159]
    v_cvt_pk_f16_f32 v224, v112, v116
    v_cvt_pk_f16_f32 v225, v120, v124
    v_cvt_pk_f16_f32 v226, v128, v132
    v_cvt_pk_f16_f32 v227, v136, v140
    s_waitcnt lgkmcnt(14)
    ds_write_b128 v234, v[224:227] offset:0
    buffer_load_dwordx4 v[216:219], v237, s[32:35], 0 offen offset:512
    buffer_load_dwordx4 v[220:223], v237, s[32:35], 0 offen offset:640
    s_waitcnt vmcnt(19)
    v_mfma_f32_32x32x16_bf16 v[96:111], a[72:75], a[224:227], v[144:159]
    v_cvt_pk_f16_f32 v228, v113, v117
    v_cvt_pk_f16_f32 v229, v121, v125
    v_cvt_pk_f16_f32 v230, v129, v133
    v_cvt_pk_f16_f32 v231, v137, v141
    s_waitcnt lgkmcnt(14)
    ds_write_b128 v234, v[228:231] offset:10240
    s_add_u32 s74, s72, 24576
    s_add_u32 s75, s72, 30720
    v_mfma_f32_32x32x16_bf16 v[80:95], a[68:71], a[228:231], v[80:95]
    v_cvt_pk_f16_f32 v224, v114, v118
    v_cvt_pk_f16_f32 v225, v122, v126
    v_cvt_pk_f16_f32 v226, v130, v134
    v_cvt_pk_f16_f32 v227, v138, v142
    s_waitcnt lgkmcnt(14)
    ds_write_b128 v234, v[224:227] offset:20480
    buffer_load_dwordx4 v[64:67], v232, s[44:47], s74 offen offset:512
    buffer_load_dwordx4 v[68:71], v232, s[44:47], s74 offen offset:640
    s_waitcnt vmcnt(20)
    v_mfma_f32_32x32x16_bf16 v[96:111], a[76:79], a[228:231], v[96:111]
    v_cvt_pk_f16_f32 v228, v115, v119
    v_cvt_pk_f16_f32 v229, v123, v127
    v_cvt_pk_f16_f32 v230, v131, v135
    v_cvt_pk_f16_f32 v231, v139, v143
    s_waitcnt lgkmcnt(14)
    ds_write_b128 v234, v[228:231] offset:30720
    buffer_load_dwordx4 v[72:75], v232, s[44:47], s75 offen offset:512
    buffer_load_dwordx4 v[76:79], v232, s[44:47], s75 offen offset:640
    s_waitcnt lgkmcnt(0)
    s_barrier
    s_waitcnt vmcnt(19)
    v_mfma_f32_32x32x16_bf16 v[112:127], a[80:83], a[224:227], v[144:159]
    v_cvt_pk_f16_f32 v224, v80, v84
    v_cvt_pk_f16_f32 v225, v88, v92
    s_waitcnt vmcnt(17)
    v_mfma_f32_32x32x16_bf16 v[128:143], a[88:91], a[224:227], v[144:159]
    v_cvt_pk_f16_f32 v226, v96, v100
    v_cvt_pk_f16_f32 v227, v104, v108
    ds_write_b128 v234, v[224:227] offset:1024
    ds_read_b128 a[0:3], v24 offset:0
    ds_read_b128 a[4:7], v24 offset:1024
    ds_read_b128 a[8:11], v24 offset:2048
    ds_read_b128 a[12:15], v24 offset:3072
    ds_read_b128 a[16:19], v24 offset:4096
    ds_read_b128 a[20:23], v24 offset:5120
    s_add_u32 m0, s56, 6336
    s_nop 0
    buffer_load_dwordx4 v1, s[20:23], 0 offen offset:64 lds
    s_add_u32 m0, s56, 7360
    s_nop 0
    buffer_load_dwordx4 v2, s[20:23], 0 offen offset:64 lds
    s_add_u32 m0, s56, 8384
    s_nop 0
    buffer_load_dwordx4 v3, s[20:23], 0 offen offset:64 lds
    v_mfma_f32_32x32x16_bf16 v[112:127], a[84:87], a[228:231], v[112:127]
    v_cvt_pk_f16_f32 v228, v81, v85
    v_cvt_pk_f16_f32 v229, v89, v93
    s_waitcnt vmcnt(19)
    v_mfma_f32_32x32x16_bf16 v[128:143], a[92:95], a[228:231], v[128:143]
    v_cvt_pk_f16_f32 v230, v97, v101
    v_cvt_pk_f16_f32 v231, v105, v109
    ds_write_b128 v234, v[228:231] offset:11264
    ds_read_b128 a[24:27], v24 offset:6144
    ds_read_b128 a[28:31], v24 offset:7168
    ds_read_b128 a[32:35], v24 offset:8192
    ds_read_b128 a[36:39], v24 offset:9216
    ds_read_b128 a[40:43], v24 offset:10240
    ds_read_b128 a[44:47], v24 offset:11264
    s_add_u32 m0, s56, 9408
    s_nop 0
    buffer_load_dwordx4 v4, s[20:23], 0 offen offset:64 lds
    s_add_u32 m0, s56, 10432
    s_nop 0
    buffer_load_dwordx4 v5, s[20:23], 0 offen offset:64 lds
    s_add_u32 m0, s56, 11456
    s_nop 0
    buffer_load_dwordx4 v6, s[20:23], 0 offen offset:64 lds
    v_mfma_f32_32x32x16_bf16 v[128:143], v[208:211], a[224:227], v[128:143]
    v_cvt_pk_f16_f32 v224, v82, v86
    v_cvt_pk_f16_f32 v225, v90, v94
    v_cvt_pk_f16_f32 v226, v98, v102
    v_cvt_pk_f16_f32 v227, v106, v110
    ds_write_b128 v234, v[224:227] offset:21504
    s_waitcnt lgkmcnt(9)
    ds_read_b128 a[96:99], v24 offset:24576
    ds_read_b128 a[100:103], v24 offset:25600
    ds_read_b128 a[104:107], v24 offset:26624
    ds_read_b128 a[108:111], v24 offset:27648
    ds_read_b128 a[112:115], v24 offset:28672
    ds_read_b128 a[116:119], v24 offset:29696
    s_add_u32 m0, s56, 12480
    s_nop 0
    buffer_load_dword v7, s[20:23], 0 offen offset:64 lds
    buffer_load_dword v254, v31, s[20:23], 0 offen
    s_waitcnt vmcnt(23)
    v_xor_b32 v192, 0x80008000, v192
    v_xor_b32 v193, 0x80008000, v193
    v_xor_b32 v194, 0x80008000, v194
    v_mfma_f32_32x32x16_bf16 v[128:143], v[212:215], a[228:231], v[128:143]
    v_cvt_pk_f16_f32 v228, v83, v87
    v_cvt_pk_f16_f32 v229, v91, v95
    v_cvt_pk_f16_f32 v230, v99, v103
    v_cvt_pk_f16_f32 v231, v107, v111
    s_waitcnt lgkmcnt(9)
    ds_write_b128 v234, v[228:231] offset:31744
    ds_read_b128 a[120:123], v24 offset:30720
    ds_read_b128 a[124:127], v24 offset:31744
    ds_read_b128 a[128:131], v24 offset:32768
    ds_read_b128 a[132:135], v24 offset:33792
    ds_read_b128 a[136:139], v24 offset:34816
    s_waitcnt lgkmcnt(14)
    ds_read_b128 a[140:143], v24 offset:35840
    v_xor_b32 v195, 0x80008000, v195
    s_waitcnt vmcnt(22)
    v_xor_b32 v196, 0x80008000, v196
    v_xor_b32 v197, 0x80008000, v197
    v_xor_b32 v198, 0x80008000, v198
    v_xor_b32 v199, 0x80008000, v199
    v_mfma_f32_32x32x16_bf16 v[144:159], v[192:195], a[224:227], 0
    s_nop 0
    v_mfma_f32_32x32x16_bf16 v[144:159], v[196:199], a[228:231], v[144:159]
    s_waitcnt vmcnt(21)
    s_nop 8
    v_mfma_f32_32x32x16_bf16 v[80:95], v[32:35], a[224:227], v[144:159]
    v_cvt_pk_f16_f32 v224, v112, v116
    v_cvt_pk_f16_f32 v225, v120, v124
    v_cvt_pk_f16_f32 v226, v128, v132
    v_cvt_pk_f16_f32 v227, v136, v140
    s_waitcnt lgkmcnt(9)
    ds_write_b128 v234, v[224:227] offset:2048
    ds_read_b128 a[144:147], v24 offset:36864
    ds_read_b128 a[148:151], v24 offset:37888
    ds_read_b128 a[152:155], v24 offset:38912
    ds_read_b128 a[156:159], v24 offset:39936
    ds_read_b128 a[160:163], v24 offset:40960
    s_waitcnt lgkmcnt(14)
    ds_read_b128 a[164:167], v24 offset:41984
    s_waitcnt vmcnt(19)
    v_mfma_f32_32x32x16_bf16 v[96:111], v[40:43], a[224:227], v[144:159]
    v_cvt_pk_f16_f32 v228, v113, v117
    v_cvt_pk_f16_f32 v229, v121, v125
    v_cvt_pk_f16_f32 v230, v129, v133
    v_cvt_pk_f16_f32 v231, v137, v141
    s_waitcnt lgkmcnt(9)
    ds_write_b128 v234, v[228:231] offset:12288
    ds_read_b128 a[168:171], v24 offset:43008
    ds_read_b128 a[172:175], v24 offset:44032
    ds_read_b128 a[176:179], v24 offset:45056
    ds_read_b128 a[180:183], v24 offset:46080
    ds_read_b128 a[184:187], v24 offset:47104
    s_waitcnt lgkmcnt(14)
    ds_read_b128 a[188:191], v24 offset:48128
    v_mfma_f32_32x32x16_bf16 v[80:95], v[36:39], a[228:231], v[80:95]
    v_cvt_pk_f16_f32 v224, v114, v118
    v_cvt_pk_f16_f32 v225, v122, v126
    v_cvt_pk_f16_f32 v226, v130, v134
    v_cvt_pk_f16_f32 v227, v138, v142
    s_waitcnt lgkmcnt(9)
    ds_write_b128 v234, v[224:227] offset:22528
    ds_read_b128 a[192:195], v23 offset:0
    ds_read_b128 a[196:199], v23 offset:3072
    ds_read_b128 a[200:203], v23 offset:10240
    ds_read_b128 a[204:207], v23 offset:13312
    ds_read_b128 a[208:211], v23 offset:20480
    s_waitcnt lgkmcnt(14)
    ds_read_b128 a[212:215], v23 offset:23552
    s_waitcnt vmcnt(18)
    v_mfma_f32_32x32x16_bf16 v[96:111], v[44:47], a[228:231], v[96:111]
    v_cvt_pk_f16_f32 v228, v115, v119
    v_cvt_pk_f16_f32 v229, v123, v127
    v_cvt_pk_f16_f32 v230, v131, v135
    v_cvt_pk_f16_f32 v231, v139, v143
    s_waitcnt lgkmcnt(14)
    ds_write_b128 v234, v[228:231] offset:32768
    v_add_u32 v234, 40960, v234
    s_waitcnt lgkmcnt(13)
    ds_read_b128 a[216:219], v23 offset:30720
    ds_read_b128 a[220:223], v23 offset:33792
    s_waitcnt lgkmcnt(9)
    ds_read_b128 a[48:51], v24 offset:12288
    ds_read_b128 a[52:55], v24 offset:13312
    ds_read_b128 a[56:59], v24 offset:14336
    ds_read_b128 a[60:63], v24 offset:15360
    ds_read_b128 a[64:67], v24 offset:16384
    ds_read_b128 a[68:71], v24 offset:17408
    s_waitcnt lgkmcnt(9)
    ds_read_b128 a[72:75], v24 offset:18432
    ds_read_b128 a[76:79], v24 offset:19456
    ds_read_b128 a[80:83], v24 offset:20480
    ds_read_b128 a[84:87], v24 offset:21504
    ds_read_b128 a[88:91], v24 offset:22528
    ds_read_b128 a[92:95], v24 offset:23552
    s_waitcnt lgkmcnt(0)
    s_barrier
    s_waitcnt vmcnt(17)
    v_mfma_f32_32x32x16_bf16 v[112:127], v[48:51], a[224:227], v[144:159]
    v_cvt_pk_f16_f32 v224, v80, v84
    v_cvt_pk_f16_f32 v225, v88, v92
    v_cvt_pk_f16_f32 v226, v96, v100
    v_cvt_pk_f16_f32 v227, v104, v108
    ds_write_b128 v234, v[224:227] offset:0
    s_waitcnt vmcnt(15)
    v_mfma_f32_32x32x16_bf16 v[128:143], v[56:59], a[224:227], v[144:159]
    v_cvt_pk_f16_f32 v228, v81, v85
    v_cvt_pk_f16_f32 v229, v89, v93
    v_cvt_pk_f16_f32 v230, v97, v101
    v_cvt_pk_f16_f32 v231, v105, v109
    ds_write_b128 v234, v[228:231] offset:12288
    v_mfma_f32_32x32x16_bf16 v[112:127], v[52:55], a[228:231], v[112:127]
    v_cvt_pk_f16_f32 v224, v82, v86
    v_cvt_pk_f16_f32 v225, v90, v94
    v_cvt_pk_f16_f32 v226, v98, v102
    v_cvt_pk_f16_f32 v227, v106, v110
    ds_write_b128 v234, v[224:227] offset:24576
    s_waitcnt vmcnt(14)
    v_mfma_f32_32x32x16_bf16 v[128:143], v[60:63], a[228:231], v[128:143]
    v_cvt_pk_f16_f32 v228, v83, v87
    v_cvt_pk_f16_f32 v229, v91, v95
    v_cvt_pk_f16_f32 v230, v99, v103
    v_cvt_pk_f16_f32 v231, v107, v111
    ds_write_b128 v234, v[228:231] offset:36864
    s_waitcnt vmcnt(11)
    v_mfma_f32_32x32x16_bf16 v[80:95], v[64:67], a[224:227], v[144:159]
    v_cvt_pk_f16_f32 v224, v112, v116
    v_cvt_pk_f16_f32 v225, v120, v124
    s_waitcnt vmcnt(9)
    v_mfma_f32_32x32x16_bf16 v[96:111], v[72:75], a[224:227], v[144:159]
    s_nop 0
    v_cvt_pk_f16_f32 v226, v128, v132
    v_cvt_pk_f16_f32 v227, v136, v140
    ds_write_b128 v234, v[224:227] offset:1024
    v_mfma_f32_32x32x16_bf16 v[80:95], v[68:71], a[228:231], v[80:95]
    v_cvt_pk_f16_f32 v228, v113, v117
    v_cvt_pk_f16_f32 v229, v121, v125
    s_waitcnt vmcnt(8)
    v_mfma_f32_32x32x16_bf16 v[96:111], v[76:79], a[228:231], v[96:111]
    v_cvt_pk_f16_f32 v230, v129, v133
    v_cvt_pk_f16_f32 v231, v137, v141
    ds_write_b128 v234, v[228:231] offset:13312
    v_mfma_f32_32x32x16_bf16 v[96:111], v[216:219], a[224:227], v[96:111]
    v_cvt_pk_f16_f32 v224, v114, v118
    v_cvt_pk_f16_f32 v225, v122, v126
    v_cvt_pk_f16_f32 v226, v130, v134
    v_cvt_pk_f16_f32 v227, v138, v142
    ds_write_b128 v234, v[224:227] offset:25600
    v_mfma_f32_32x32x16_bf16 v[96:111], v[220:223], a[228:231], v[96:111]
    v_cvt_pk_f16_f32 v228, v115, v119
    v_cvt_pk_f16_f32 v229, v123, v127
    v_cvt_pk_f16_f32 v230, v131, v135
    v_cvt_pk_f16_f32 v231, v139, v143
    ds_write_b128 v234, v[228:231] offset:37888
    v_cvt_pk_f16_f32 v224, v80, v84
    v_cvt_pk_f16_f32 v225, v88, v92
    s_nop 4
    v_cvt_pk_f16_f32 v226, v96, v100
    v_cvt_pk_f16_f32 v227, v104, v108
    ds_write_b128 v234, v[224:227] offset:2048
    v_cvt_pk_f16_f32 v228, v81, v85
    v_cvt_pk_f16_f32 v229, v89, v93
    v_cvt_pk_f16_f32 v230, v97, v101
    v_cvt_pk_f16_f32 v231, v105, v109
    ds_write_b128 v234, v[228:231] offset:14336
    v_cvt_pk_f16_f32 v224, v82, v86
    v_cvt_pk_f16_f32 v225, v90, v94
    v_cvt_pk_f16_f32 v226, v98, v102
    v_cvt_pk_f16_f32 v227, v106, v110
    ds_write_b128 v234, v[224:227] offset:26624
    v_cvt_pk_f16_f32 v228, v83, v87
    v_cvt_pk_f16_f32 v229, v91, v95
    v_cvt_pk_f16_f32 v230, v99, v103
    v_cvt_pk_f16_f32 v231, v107, v111
    ds_write_b128 v234, v[228:231] offset:38912
    s_branch L_conv0
L_prep1:
    v_bfe_u32 v158, v129, 2, 1
    v_bfe_u32 v159, v129, 3, 2
    v_lshl_add_u32 v159, v158, 5, v159
    v_lshl_add_u32 v159, v138, 3, v159
    v_and_b32 v160, 3, v129
    v_xor_b32 v161, v138, v160
    v_lshlrev_b32 v161, 4, v161
    v_mad_u32_u24 v232, v159, s69, v161
    s_sub_u32 s60, s3, 2
    s_mul_i32 s72, s60, 3072
    s_mul_i32 s60, s60, 24576
    s_add_u32 s60, s60, 40960
    v_bfe_u32 v159, v129, 3, 1
    v_lshl_add_u32 v161, v159, 2, v160
    v_lshl_add_u32 v161, v158, 3, v161
    v_lshlrev_b32 v236, 1, v161
    v_xor_b32 v237, 16, v236
    v_and_b32 v159, 15, v129
    v_bfe_u32 v160, v129, 4, 1
    v_lshl_add_u32 v160, v160, 1, v138
    v_lshl_add_u32 v159, v160, 5, v159
    v_lshlrev_b32 v238, 11, v158
    v_mul_u32_u24 v158, 768, v158
    v_add_u32 v159, v158, v159
    v_lshl_add_u32 v234, v159, 4, s60
    v_xor_b32 v235, 64, v234
    s_lshl_b32 s60, s3, 12
    s_add_u32 s60, s60, 32768
    v_add_u32 v238, s60, v238
    v_sub_u32 v238, 0, v238
    v_and_b32 v239, 16, v129
    v_lshlrev_b32 v239, 7, v239
    buffer_load_ushort v176, v236, s[40:43], 0 offen offset:0
    buffer_load_ushort v177, v237, s[40:43], 0 offen offset:0
    buffer_load_ushort v178, v236, s[40:43], 0 offen offset:32
    buffer_load_ushort v179, v237, s[40:43], 0 offen offset:32
    buffer_load_ushort v180, v236, s[40:43], 0 offen offset:64
    buffer_load_ushort v181, v237, s[40:43], 0 offen offset:64
    buffer_load_ushort v182, v236, s[40:43], 0 offen offset:96
    buffer_load_ushort v183, v237, s[40:43], 0 offen offset:96
    buffer_load_ushort v184, v236, s[40:43], 0 offen offset:128
    buffer_load_ushort v185, v237, s[40:43], 0 offen offset:128
    buffer_load_ushort v186, v236, s[40:43], 0 offen offset:160
    buffer_load_ushort v187, v237, s[40:43], 0 offen offset:160
    s_add_u32 s74, s72, 0
    s_add_u32 s75, s72, 12288
    buffer_load_dwordx4 a[0:3], v232, s[48:51], s74 offen offset:0
    buffer_load_dwordx4 a[4:7], v232, s[48:51], s75 offen offset:0
    buffer_load_dwordx4 a[8:11], v232, s[48:51], s74 offen offset:768
    buffer_load_dwordx4 a[12:15], v232, s[48:51], s75 offen offset:768
    buffer_load_dwordx4 a[16:19], v232, s[48:51], s74 offen offset:64
    buffer_load_dwordx4 a[20:23], v232, s[48:51], s75 offen offset:64
    buffer_load_dwordx4 a[24:27], v232, s[48:51], s74 offen offset:832
    buffer_load_dwordx4 a[28:31], v232, s[48:51], s75 offen offset:832
    v_lshlrev_b32 v158, 6, v0
    v_add_u32 v158, 141312, v158
    v_cmp_gt_u32 vcc, 144, v0
    s_nop 1
    v_cndmask_b32 v158, v157, v158, vcc
    v_and_b32 v159, 3, v0
    v_lshl_add_u32 v160, v159, 2, v158
    v_lshrrev_b32 v159, 1, v159
    v_lshl_add_u32 v159, v159, 2, v158
    v_and_b32 v161, 0x1c, v0
    v_bfe_u32 v162, v0, 1, 1
    v_and_b32 v163, 1, v0
    v_lshl_or_b32 v162, v163, 1, v162
    v_or_b32 v161, v161, v162
    v_lshlrev_b32 v161, 4, v161
    v_add_u32 v161, 150528, v161
    v_cmp_gt_u32 vcc, 24, v0
    s_nop 1
    v_cndmask_b32 v161, v157, v161, vcc
    v_mov_b32 v164, 0
    v_mov_b32 v165, 0
    v_mov_b32 v166, 0
    v_mov_b32 v167, 0
    ds_write_b128 v158, v[164:167]
    ds_write_b128 v158, v[164:167] offset:16
    ds_write_b128 v158, v[164:167] offset:32
    ds_write_b128 v158, v[164:167] offset:48
    s_waitcnt vmcnt(31)
    ds_write_b16 v160, v144
    ds_write_b16_d16_hi v160, v144 offset:34
    s_waitcnt vmcnt(30)
    ds_write_b16 v159, v145 offset:16
    ds_write_b16_d16_hi v159, v145 offset:48
    s_waitcnt vmcnt(29)
    ds_write_b16 v159, v146 offset:24
    ds_write_b16_d16_hi v159, v146 offset:56
    s_waitcnt vmcnt(28)
    v_lshlrev_b32 v168, 16, v148
    v_and_b32 v169, 0xffff0000, v148
    v_lshlrev_b32 v170, 16, v149
    v_and_b32 v171, 0xffff0000, v149
    s_waitcnt vmcnt(27)
    v_lshlrev_b32 v172, 16, v150
    v_and_b32 v173, 0xffff0000, v150
    v_lshlrev_b32 v174, 16, v151
    v_and_b32 v175, 0xffff0000, v151
    v_mul_f32 v168, v168, v172
    v_mul_f32 v169, v169, v173
    v_mul_f32 v170, v170, v174
    v_mul_f32 v171, v171, v175
    ds_write_b128 v161, v[168:171]
    buffer_load_dwordx4 a[32:35], v232, s[48:51], s74 offen offset:128
    buffer_load_dwordx4 a[36:39], v232, s[48:51], s75 offen offset:128
    buffer_load_dwordx4 a[40:43], v232, s[48:51], s74 offen offset:896
    buffer_load_dwordx4 a[44:47], v232, s[48:51], s75 offen offset:896
    s_add_u32 s74, s72, 24576
    s_add_u32 s75, s72, 36864
    buffer_load_dwordx4 a[48:51], v232, s[48:51], s74 offen offset:0
    buffer_load_dwordx4 a[52:55], v232, s[48:51], s75 offen offset:0
    buffer_load_dwordx4 a[56:59], v232, s[48:51], s74 offen offset:768
    buffer_load_dwordx4 a[60:63], v232, s[48:51], s75 offen offset:768
    buffer_load_dwordx4 a[64:67], v232, s[48:51], s74 offen offset:64
    buffer_load_dwordx4 a[68:71], v232, s[48:51], s75 offen offset:64
    buffer_load_dwordx4 a[72:75], v232, s[48:51], s74 offen offset:832
    buffer_load_dwordx4 a[76:79], v232, s[48:51], s75 offen offset:832
    s_mov_b32 s70, 0x409d30fc
    v_mul_u32_u24 v252, 0x100010, v0
    v_add_u32 v252, 0xc0004, v252
    v_lshl_add_u32 v253, v0, 2, s85
    v_add_u32 v80, 0x0, v252
    v_add_u32 v88, 0x10001000, v252
    v_add_u32 v96, 0x20002000, v252
    v_add_u32 v104, 0x30003000, v252
    v_cvt_f32_f16 v81, v80
    v_cvt_f32_f16 v89, v88
    v_cvt_f32_f16 v97, v96
    v_cvt_f32_f16 v105, v104
    v_cvt_f32_f16_sdwa v82, v80 dst_sel:DWORD dst_unused:UNUSED_PAD src0_sel:WORD_1
    v_cvt_f32_f16_sdwa v90, v88 dst_sel:DWORD dst_unused:UNUSED_PAD src0_sel:WORD_1
    v_cvt_f32_f16_sdwa v98, v96 dst_sel:DWORD dst_unused:UNUSED_PAD src0_sel:WORD_1
    v_cvt_f32_f16_sdwa v106, v104 dst_sel:DWORD dst_unused:UNUSED_PAD src0_sel:WORD_1
    v_fma_f32 v83, v81, v81, s70
    v_fma_f32 v91, v89, v89, s70
    v_fma_f32 v99, v97, v97, s70
    v_fma_f32 v107, v105, v105, s70
    v_fma_f32 v84, v82, v82, s70
    v_fma_f32 v92, v90, v90, s70
    v_fma_f32 v100, v98, v98, s70
    v_fma_f32 v108, v106, v106, s70
    v_mul_f32 v83, -v81, v83
    v_mul_f32 v91, -v89, v91
    v_mul_f32 v99, -v97, v99
    v_mul_f32 v107, -v105, v107
    v_mul_f32 v84, -v82, v84
    v_mul_f32 v92, -v90, v92
    v_mul_f32 v100, -v98, v100
    v_mul_f32 v108, -v106, v108
    v_exp_f32 v83, v83
    v_exp_f32 v91, v91
    v_exp_f32 v99, v99
    v_exp_f32 v107, v107
    v_exp_f32 v84, v84
    v_exp_f32 v92, v92
    v_exp_f32 v100, v100
    v_exp_f32 v108, v108
    v_add_f32 v83, 1.0, v83
    v_add_f32 v91, 1.0, v91
    v_add_f32 v99, 1.0, v99
    v_add_f32 v107, 1.0, v107
    v_add_f32 v84, 1.0, v84
    v_add_f32 v92, 1.0, v92
    v_add_f32 v100, 1.0, v100
    v_add_f32 v108, 1.0, v108
    v_rcp_f32 v83, v83
    v_rcp_f32 v91, v91
    v_rcp_f32 v99, v99
    v_rcp_f32 v107, v107
    v_rcp_f32 v84, v84
    v_rcp_f32 v92, v92
    v_rcp_f32 v100, v100
    v_rcp_f32 v108, v108
    v_mul_f32 v83, v81, v83
    v_mul_f32 v91, v89, v91
    v_mul_f32 v99, v97, v99
    v_mul_f32 v107, v105, v107
    v_mul_f32 v84, v82, v84
    v_mul_f32 v92, v90, v92
    v_mul_f32 v100, v98, v100
    v_mul_f32 v108, v106, v108
    v_cvt_pk_f16_f32 v80, v83, v84
    v_cvt_pk_f16_f32 v88, v91, v92
    v_cvt_pk_f16_f32 v96, v99, v100
    v_cvt_pk_f16_f32 v104, v107, v108
    ds_write_b32 v253, v80 offset:0
    ds_write_b32 v253, v88 offset:1024
    ds_write_b32 v253, v96 offset:2048
    ds_write_b32 v253, v104 offset:3072
    v_add_u32 v80, 0x40004000, v252
    v_add_u32 v88, 0x50005000, v252
    v_add_u32 v96, 0x60006000, v252
    v_add_u32 v104, 0x70007000, v252
    v_cvt_f32_f16 v81, v80
    v_cvt_f32_f16 v89, v88
    v_cvt_f32_f16 v97, v96
    v_cvt_f32_f16 v105, v104
    v_cvt_f32_f16_sdwa v82, v80 dst_sel:DWORD dst_unused:UNUSED_PAD src0_sel:WORD_1
    v_cvt_f32_f16_sdwa v90, v88 dst_sel:DWORD dst_unused:UNUSED_PAD src0_sel:WORD_1
    v_cvt_f32_f16_sdwa v98, v96 dst_sel:DWORD dst_unused:UNUSED_PAD src0_sel:WORD_1
    v_cvt_f32_f16_sdwa v106, v104 dst_sel:DWORD dst_unused:UNUSED_PAD src0_sel:WORD_1
    v_fma_f32 v83, v81, v81, s70
    v_fma_f32 v91, v89, v89, s70
    v_fma_f32 v99, v97, v97, s70
    v_fma_f32 v107, v105, v105, s70
    v_fma_f32 v84, v82, v82, s70
    v_fma_f32 v92, v90, v90, s70
    v_fma_f32 v100, v98, v98, s70
    v_fma_f32 v108, v106, v106, s70
    v_mul_f32 v83, -v81, v83
    v_mul_f32 v91, -v89, v91
    v_mul_f32 v99, -v97, v99
    v_mul_f32 v107, -v105, v107
    v_mul_f32 v84, -v82, v84
    v_mul_f32 v92, -v90, v92
    v_mul_f32 v100, -v98, v100
    v_mul_f32 v108, -v106, v108
    v_exp_f32 v83, v83
    v_exp_f32 v91, v91
    v_exp_f32 v99, v99
    v_exp_f32 v107, v107
    v_exp_f32 v84, v84
    v_exp_f32 v92, v92
    v_exp_f32 v100, v100
    v_exp_f32 v108, v108
    v_add_f32 v83, 1.0, v83
    v_add_f32 v91, 1.0, v91
    v_add_f32 v99, 1.0, v99
    v_add_f32 v107, 1.0, v107
    v_add_f32 v84, 1.0, v84
    v_add_f32 v92, 1.0, v92
    v_add_f32 v100, 1.0, v100
    v_add_f32 v108, 1.0, v108
    v_rcp_f32 v83, v83
    v_rcp_f32 v91, v91
    v_rcp_f32 v99, v99
    v_rcp_f32 v107, v107
    v_rcp_f32 v84, v84
    v_rcp_f32 v92, v92
    v_rcp_f32 v100, v100
    v_rcp_f32 v108, v108
    v_mul_f32 v83, v81, v83
    v_mul_f32 v91, v89, v91
    v_mul_f32 v99, v97, v99
    v_mul_f32 v107, v105, v107
    v_mul_f32 v84, v82, v84
    v_mul_f32 v92, v90, v92
    v_mul_f32 v100, v98, v100
    v_mul_f32 v108, v106, v108
    v_cvt_pk_f16_f32 v80, v83, v84
    v_cvt_pk_f16_f32 v88, v91, v92
    v_cvt_pk_f16_f32 v96, v99, v100
    v_cvt_pk_f16_f32 v104, v107, v108
    s_waitcnt lgkmcnt(11)
    ds_write_b32 v253, v80 offset:4096
    ds_write_b32 v253, v88 offset:5120
    ds_write_b32 v253, v96 offset:6144
    ds_write_b32 v253, v104 offset:7168
    v_add_u32 v80, 0x80008000, v252
    v_add_u32 v88, 0x90009000, v252
    v_add_u32 v96, 0xa000a000, v252
    v_cvt_f32_f16 v81, v80
    v_cvt_f32_f16 v89, v88
    v_cvt_f32_f16 v97, v96
    v_cvt_f32_f16_sdwa v82, v80 dst_sel:DWORD dst_unused:UNUSED_PAD src0_sel:WORD_1
    v_cvt_f32_f16_sdwa v90, v88 dst_sel:DWORD dst_unused:UNUSED_PAD src0_sel:WORD_1
    v_cvt_f32_f16_sdwa v98, v96 dst_sel:DWORD dst_unused:UNUSED_PAD src0_sel:WORD_1
    v_fma_f32 v83, v81, v81, s70
    v_fma_f32 v91, v89, v89, s70
    v_fma_f32 v99, v97, v97, s70
    v_fma_f32 v84, v82, v82, s70
    v_fma_f32 v92, v90, v90, s70
    v_fma_f32 v100, v98, v98, s70
    v_mul_f32 v83, -v81, v83
    v_mul_f32 v91, -v89, v91
    v_mul_f32 v99, -v97, v99
    v_mul_f32 v84, -v82, v84
    v_mul_f32 v92, -v90, v92
    v_mul_f32 v100, -v98, v100
    v_exp_f32 v83, v83
    v_exp_f32 v91, v91
    v_exp_f32 v99, v99
    v_exp_f32 v84, v84
    v_exp_f32 v92, v92
    v_exp_f32 v100, v100
    v_add_f32 v83, 1.0, v83
    v_add_f32 v91, 1.0, v91
    v_add_f32 v99, 1.0, v99
    v_add_f32 v84, 1.0, v84
    v_add_f32 v92, 1.0, v92
    v_add_f32 v100, 1.0, v100
    v_rcp_f32 v83, v83
    v_rcp_f32 v91, v91
    v_rcp_f32 v99, v99
    v_rcp_f32 v84, v84
    v_rcp_f32 v92, v92
    v_rcp_f32 v100, v100
    v_mul_f32 v83, v81, v83
    v_mul_f32 v91, v89, v91
    v_mul_f32 v99, v97, v99
    v_mul_f32 v84, v82, v84
    v_mul_f32 v92, v90, v92
    v_mul_f32 v100, v98, v100
    v_cvt_pk_f16_f32 v80, v83, v84
    v_cvt_pk_f16_f32 v88, v91, v92
    v_cvt_pk_f16_f32 v96, v99, v100
    s_waitcnt lgkmcnt(12)
    ds_write_b32 v253, v80 offset:8192
    ds_write_b32 v253, v88 offset:9216
    ds_write_b32 v253, v96 offset:10240
    v_add_u32 v80, 0xb000b000, v252
    v_add_u32 v88, 0xc000c000, v252
    v_cvt_f32_f16 v81, v80
    v_cvt_f32_f16 v89, v88
    v_cvt_f32_f16_sdwa v82, v80 dst_sel:DWORD dst_unused:UNUSED_PAD src0_sel:WORD_1
    v_cvt_f32_f16_sdwa v90, v88 dst_sel:DWORD dst_unused:UNUSED_PAD src0_sel:WORD_1
    v_fma_f32 v83, v81, v81, s70
    v_fma_f32 v91, v89, v89, s70
    v_fma_f32 v84, v82, v82, s70
    v_fma_f32 v92, v90, v90, s70
    v_mul_f32 v83, -v81, v83
    v_mul_f32 v91, -v89, v91
    v_mul_f32 v84, -v82, v84
    v_mul_f32 v92, -v90, v92
    v_exp_f32 v83, v83
    v_exp_f32 v91, v91
    v_exp_f32 v84, v84
    v_exp_f32 v92, v92
    v_add_f32 v83, 1.0, v83
    v_add_f32 v91, 1.0, v91
    v_add_f32 v84, 1.0, v84
    v_add_f32 v92, 1.0, v92
    v_rcp_f32 v83, v83
    v_rcp_f32 v91, v91
    v_rcp_f32 v84, v84
    v_rcp_f32 v92, v92
    v_mul_f32 v83, v81, v83
    v_mul_f32 v91, v89, v91
    v_mul_f32 v84, v82, v84
    v_mul_f32 v92, v90, v92
    v_cvt_pk_f16_f32 v80, v83, v84
    v_cvt_pk_f16_f32 v88, v91, v92
    s_waitcnt lgkmcnt(13)
    ds_write_b32 v253, v80 offset:11264
    ds_write_b32 v253, v88 offset:12288
    s_waitcnt vmcnt(31)
    v_lshlrev_b32 v176, 16, v176
    s_waitcnt vmcnt(30)
    v_lshlrev_b32 v177, 16, v177
    s_waitcnt vmcnt(29)
    v_lshlrev_b32 v178, 16, v178
    s_waitcnt vmcnt(28)
    v_lshlrev_b32 v179, 16, v179
    s_waitcnt vmcnt(27)
    v_lshlrev_b32 v180, 16, v180
    s_waitcnt vmcnt(26)
    v_lshlrev_b32 v181, 16, v181
    s_waitcnt vmcnt(25)
    v_lshlrev_b32 v182, 16, v182
    s_waitcnt vmcnt(24)
    v_lshlrev_b32 v183, 16, v183
    s_waitcnt vmcnt(23)
    v_lshlrev_b32 v184, 16, v184
    s_waitcnt vmcnt(22)
    v_lshlrev_b32 v185, 16, v185
    s_waitcnt vmcnt(21)
    v_lshlrev_b32 v186, 16, v186
    s_waitcnt vmcnt(20)
    v_lshlrev_b32 v187, 16, v187
    v_mul_f32 v176, 0x40088e99, v176
    v_mul_f32 v177, 0x40088e99, v177
    v_mul_f32 v178, 0x40088e99, v178
    v_mul_f32 v179, 0x40088e99, v179
    v_mul_f32 v180, 0x40088e99, v180
    v_mul_f32 v181, 0x40088e99, v181
    v_mul_f32 v182, 0x40088e99, v182
    v_mul_f32 v183, 0x40088e99, v183
    v_mul_f32 v184, 0x40088e99, v184
    v_mul_f32 v185, 0x40088e99, v185
    v_mul_f32 v186, 0x40088e99, v186
    v_mul_f32 v187, 0x40088e99, v187
    s_waitcnt vmcnt(19)
    v_mfma_f32_32x32x16_bf16 v[80:95], a[0:3], a[224:227], 0
    s_waitcnt vmcnt(17)
    v_mfma_f32_32x32x16_bf16 v[96:111], a[8:11], a[224:227], 0
    v_mfma_f32_32x32x16_bf16 v[80:95], a[4:7], a[228:231], v[80:95]
    s_waitcnt vmcnt(16)
    v_mfma_f32_32x32x16_bf16 v[96:111], a[12:15], a[228:231], v[96:111]
    s_waitcnt vmcnt(15)
    v_mfma_f32_32x32x16_bf16 v[112:127], a[16:19], a[224:227], 0
    s_nop 7
    v_pk_mul_f32 v[80:81], v[80:81], v[176:177]
    v_pk_mul_f32 v[84:85], v[84:85], v[176:177]
    v_pk_mul_f32 v[88:89], v[88:89], v[176:177]
    v_pk_mul_f32 v[92:93], v[92:93], v[176:177]
    v_pk_mul_f32 v[96:97], v[96:97], v[176:177]
    v_pk_mul_f32 v[100:101], v[100:101], v[176:177]
    v_pk_mul_f32 v[104:105], v[104:105], v[176:177]
    v_pk_mul_f32 v[108:109], v[108:109], v[176:177]
    v_cvt_pk_f16_f32 v224, v80, v84
    v_cvt_pk_f16_f32 v225, v88, v92
    v_cvt_pk_f16_f32 v226, v96, v100
    v_cvt_pk_f16_f32 v227, v104, v108
    s_waitcnt lgkmcnt(14)
    ds_write_b128 v234, v[224:227] offset:6144
    buffer_load_dwordx4 a[80:83], v232, s[48:51], s74 offen offset:128
    s_waitcnt vmcnt(14)
    v_mfma_f32_32x32x16_bf16 v[128:143], a[24:27], a[224:227], 0
    v_cvt_pk_f16_f32 v228, v81, v85
    v_cvt_pk_f16_f32 v229, v89, v93
    v_cvt_pk_f16_f32 v230, v97, v101
    v_cvt_pk_f16_f32 v231, v105, v109
    s_waitcnt lgkmcnt(14)
    ds_write_b128 v235, v[228:231] offset:6144
    buffer_load_dwordx4 a[84:87], v232, s[48:51], s75 offen offset:128
    v_mfma_f32_32x32x16_bf16 v[112:127], a[20:23], a[228:231], v[112:127]
    v_pk_mul_f32 v[82:83], v[82:83], v[178:179]
    v_pk_mul_f32 v[86:87], v[86:87], v[178:179]
    v_pk_mul_f32 v[90:91], v[90:91], v[178:179]
    v_pk_mul_f32 v[94:95], v[94:95], v[178:179]
    v_pk_mul_f32 v[98:99], v[98:99], v[178:179]
    v_pk_mul_f32 v[102:103], v[102:103], v[178:179]
    v_pk_mul_f32 v[106:107], v[106:107], v[178:179]
    v_pk_mul_f32 v[110:111], v[110:111], v[178:179]
    v_cvt_pk_f16_f32 v224, v82, v86
    v_cvt_pk_f16_f32 v225, v90, v94
    v_cvt_pk_f16_f32 v226, v98, v102
    v_cvt_pk_f16_f32 v227, v106, v110
    s_waitcnt lgkmcnt(14)
    ds_write_b128 v234, v[224:227] offset:6400
    buffer_load_dwordx4 a[88:91], v232, s[48:51], s74 offen offset:896
    s_waitcnt vmcnt(15)
    v_mfma_f32_32x32x16_bf16 v[128:143], a[28:31], a[228:231], v[128:143]
    v_cvt_pk_f16_f32 v228, v83, v87
    v_cvt_pk_f16_f32 v229, v91, v95
    v_cvt_pk_f16_f32 v230, v99, v103
    v_cvt_pk_f16_f32 v231, v107, v111
    s_waitcnt lgkmcnt(14)
    ds_write_b128 v235, v[228:231] offset:6400
    buffer_load_dwordx4 a[92:95], v232, s[48:51], s75 offen offset:896
    s_waitcnt vmcnt(15)
    v_mfma_f32_32x32x16_bf16 v[80:95], a[32:35], a[224:227], 0
    v_pk_mul_f32 v[112:113], v[112:113], v[180:181]
    v_pk_mul_f32 v[116:117], v[116:117], v[180:181]
    v_pk_mul_f32 v[120:121], v[120:121], v[180:181]
    v_pk_mul_f32 v[124:125], v[124:125], v[180:181]
    v_pk_mul_f32 v[128:129], v[128:129], v[180:181]
    v_pk_mul_f32 v[132:133], v[132:133], v[180:181]
    v_pk_mul_f32 v[136:137], v[136:137], v[180:181]
    v_pk_mul_f32 v[140:141], v[140:141], v[180:181]
    v_cvt_pk_f16_f32 v224, v112, v116
    v_cvt_pk_f16_f32 v225, v120, v124
    v_cvt_pk_f16_f32 v226, v128, v132
    v_cvt_pk_f16_f32 v227, v136, v140
    s_waitcnt lgkmcnt(14)
    ds_write_b128 v234, v[224:227] offset:8192
    s_add_u32 s74, s72, 49152
    s_waitcnt vmcnt(13)
    v_mfma_f32_32x32x16_bf16 v[96:111], a[40:43], a[224:227], 0
    v_cvt_pk_f16_f32 v228, v113, v117
    v_cvt_pk_f16_f32 v229, v121, v125
    v_cvt_pk_f16_f32 v230, v129, v133
    v_cvt_pk_f16_f32 v231, v137, v141
    s_waitcnt lgkmcnt(14)
    ds_write_b128 v235, v[228:231] offset:8192
    s_add_u32 s75, s72, 61440
    buffer_load_dwordx4 v[32:35], v232, s[48:51], s74 offen offset:0
    v_mfma_f32_32x32x16_bf16 v[80:95], a[36:39], a[228:231], v[80:95]
    v_pk_mul_f32 v[114:115], v[114:115], v[182:183]
    v_pk_mul_f32 v[118:119], v[118:119], v[182:183]
    v_pk_mul_f32 v[122:123], v[122:123], v[182:183]
    v_pk_mul_f32 v[126:127], v[126:127], v[182:183]
    v_pk_mul_f32 v[130:131], v[130:131], v[182:183]
    v_pk_mul_f32 v[134:135], v[134:135], v[182:183]
    v_pk_mul_f32 v[138:139], v[138:139], v[182:183]
    v_pk_mul_f32 v[142:143], v[142:143], v[182:183]
    v_cvt_pk_f16_f32 v224, v114, v118
    v_cvt_pk_f16_f32 v225, v122, v126
    v_cvt_pk_f16_f32 v226, v130, v134
    v_cvt_pk_f16_f32 v227, v138, v142
    s_waitcnt lgkmcnt(14)
    ds_write_b128 v234, v[224:227] offset:8448
    buffer_load_dwordx4 v[36:39], v232, s[48:51], s75 offen offset:0
    s_waitcnt vmcnt(14)
    v_mfma_f32_32x32x16_bf16 v[96:111], a[44:47], a[228:231], v[96:111]
    v_cvt_pk_f16_f32 v228, v115, v119
    v_cvt_pk_f16_f32 v229, v123, v127
    v_cvt_pk_f16_f32 v230, v131, v135
    v_cvt_pk_f16_f32 v231, v139, v143
    s_waitcnt lgkmcnt(14)
    ds_write_b128 v235, v[228:231] offset:8448
    buffer_load_dwordx4 v[40:43], v232, s[48:51], s74 offen offset:768
    buffer_load_dwordx4 v[44:47], v232, s[48:51], s75 offen offset:768
    s_waitcnt vmcnt(15)
    v_mfma_f32_32x32x16_bf16 v[112:127], a[48:51], a[224:227], 0
    v_pk_mul_f32 v[80:81], v[80:81], v[184:185]
    v_pk_mul_f32 v[84:85], v[84:85], v[184:185]
    v_pk_mul_f32 v[88:89], v[88:89], v[184:185]
    v_pk_mul_f32 v[92:93], v[92:93], v[184:185]
    v_pk_mul_f32 v[96:97], v[96:97], v[184:185]
    v_pk_mul_f32 v[100:101], v[100:101], v[184:185]
    v_pk_mul_f32 v[104:105], v[104:105], v[184:185]
    v_pk_mul_f32 v[108:109], v[108:109], v[184:185]
    v_cvt_pk_f16_f32 v224, v80, v84
    v_cvt_pk_f16_f32 v225, v88, v92
    v_cvt_pk_f16_f32 v226, v96, v100
    v_cvt_pk_f16_f32 v227, v104, v108
    s_waitcnt lgkmcnt(14)
    ds_write_b128 v234, v[224:227] offset:10240
    buffer_load_dwordx4 v[48:51], v232, s[48:51], s74 offen offset:64
    s_waitcnt vmcnt(14)
    v_mfma_f32_32x32x16_bf16 v[128:143], a[56:59], a[224:227], 0
    v_cvt_pk_f16_f32 v228, v81, v85
    v_cvt_pk_f16_f32 v229, v89, v93
    v_cvt_pk_f16_f32 v230, v97, v101
    v_cvt_pk_f16_f32 v231, v105, v109
    s_waitcnt lgkmcnt(14)
    ds_write_b128 v235, v[228:231] offset:10240
    buffer_load_dwordx4 v[52:55], v232, s[48:51], s75 offen offset:64
    v_mfma_f32_32x32x16_bf16 v[112:127], a[52:55], a[228:231], v[112:127]
    v_pk_mul_f32 v[82:83], v[82:83], v[186:187]
    v_pk_mul_f32 v[86:87], v[86:87], v[186:187]
    v_pk_mul_f32 v[90:91], v[90:91], v[186:187]
    v_pk_mul_f32 v[94:95], v[94:95], v[186:187]
    v_pk_mul_f32 v[98:99], v[98:99], v[186:187]
    v_pk_mul_f32 v[102:103], v[102:103], v[186:187]
    v_pk_mul_f32 v[106:107], v[106:107], v[186:187]
    v_pk_mul_f32 v[110:111], v[110:111], v[186:187]
    v_cvt_pk_f16_f32 v224, v82, v86
    v_cvt_pk_f16_f32 v225, v90, v94
    v_cvt_pk_f16_f32 v226, v98, v102
    v_cvt_pk_f16_f32 v227, v106, v110
    s_waitcnt lgkmcnt(14)
    ds_write_b128 v234, v[224:227] offset:10496
    buffer_load_dwordx4 v[56:59], v232, s[48:51], s74 offen offset:832
    s_waitcnt vmcnt(15)
    v_mfma_f32_32x32x16_bf16 v[128:143], a[60:63], a[228:231], v[128:143]
    v_cvt_pk_f16_f32 v228, v83, v87
    v_cvt_pk_f16_f32 v229, v91, v95
    v_cvt_pk_f16_f32 v230, v99, v103
    v_cvt_pk_f16_f32 v231, v107, v111
    s_waitcnt lgkmcnt(14)
    ds_write_b128 v235, v[228:231] offset:10496
    v_add_u32 v234, v238, v234
    v_add_u32 v235, v238, v235
    buffer_load_dwordx4 v[60:63], v232, s[48:51], s75 offen offset:832
    s_waitcnt lgkmcnt(0)
    s_barrier
    s_waitcnt vmcnt(15)
    v_mfma_f32_32x32x16_bf16 v[80:95], a[64:67], a[224:227], 0
    v_pk_mul_f32 v[112:113], v[112:113], v[176:177]
    v_pk_mul_f32 v[116:117], v[116:117], v[176:177]
    v_pk_mul_f32 v[120:121], v[120:121], v[176:177]
    v_pk_mul_f32 v[124:125], v[124:125], v[176:177]
    v_pk_mul_f32 v[128:129], v[128:129], v[176:177]
    v_pk_mul_f32 v[132:133], v[132:133], v[176:177]
    v_pk_mul_f32 v[136:137], v[136:137], v[176:177]
    v_pk_mul_f32 v[140:141], v[140:141], v[176:177]
    v_cvt_pk_f16_f32 v224, v112, v116
    v_cvt_pk_f16_f32 v225, v120, v124
    v_cvt_pk_f16_f32 v226, v128, v132
    v_cvt_pk_f16_f32 v227, v136, v140
    ds_write_b128 v234, v[224:227] offset:6144
    ds_read_b128 a[0:3], v24 offset:0
    ds_read_b128 a[4:7], v24 offset:1024
    ds_read_b128 a[8:11], v24 offset:2048
    ds_read_b128 a[12:15], v24 offset:3072
    ds_read_b128 a[16:19], v24 offset:4096
    ds_read_b128 a[20:23], v24 offset:5120
    buffer_load_dwordx4 v[64:67], v232, s[48:51], s74 offen offset:128
    s_waitcnt vmcnt(14)
    v_mfma_f32_32x32x16_bf16 v[96:111], a[72:75], a[224:227], 0
    v_cvt_pk_f16_f32 v228, v113, v117
    v_cvt_pk_f16_f32 v229, v121, v125
    v_cvt_pk_f16_f32 v230, v129, v133
    v_cvt_pk_f16_f32 v231, v137, v141
    ds_write_b128 v235, v[228:231] offset:6144
    ds_read_b128 a[24:27], v24 offset:6144
    ds_read_b128 a[28:31], v24 offset:7168
    ds_read_b128 a[32:35], v24 offset:8192
    ds_read_b128 a[36:39], v24 offset:9216
    ds_read_b128 a[40:43], v24 offset:10240
    ds_read_b128 a[44:47], v24 offset:11264
    buffer_load_dwordx4 v[68:71], v232, s[48:51], s75 offen offset:128
    v_mfma_f32_32x32x16_bf16 v[80:95], a[68:71], a[228:231], v[80:95]
    v_pk_mul_f32 v[114:115], v[114:115], v[178:179]
    v_pk_mul_f32 v[118:119], v[118:119], v[178:179]
    v_pk_mul_f32 v[122:123], v[122:123], v[178:179]
    v_pk_mul_f32 v[126:127], v[126:127], v[178:179]
    v_pk_mul_f32 v[130:131], v[130:131], v[178:179]
    v_pk_mul_f32 v[134:135], v[134:135], v[178:179]
    v_pk_mul_f32 v[138:139], v[138:139], v[178:179]
    v_pk_mul_f32 v[142:143], v[142:143], v[178:179]
    v_cvt_pk_f16_f32 v224, v114, v118
    v_cvt_pk_f16_f32 v225, v122, v126
    v_cvt_pk_f16_f32 v226, v130, v134
    v_cvt_pk_f16_f32 v227, v138, v142
    ds_write_b128 v234, v[224:227] offset:6400
    s_waitcnt lgkmcnt(9)
    ds_read_b128 a[96:99], v24 offset:24576
    ds_read_b128 a[100:103], v24 offset:25600
    ds_read_b128 a[104:107], v24 offset:26624
    ds_read_b128 a[108:111], v24 offset:27648
    ds_read_b128 a[112:115], v24 offset:28672
    ds_read_b128 a[116:119], v24 offset:29696
    buffer_load_dwordx4 v[72:75], v232, s[48:51], s74 offen offset:896
    s_waitcnt vmcnt(15)
    v_mfma_f32_32x32x16_bf16 v[96:111], a[76:79], a[228:231], v[96:111]
    v_cvt_pk_f16_f32 v228, v115, v119
    v_cvt_pk_f16_f32 v229, v123, v127
    v_cvt_pk_f16_f32 v230, v131, v135
    v_cvt_pk_f16_f32 v231, v139, v143
    s_waitcnt lgkmcnt(9)
    ds_write_b128 v235, v[228:231] offset:6400
    ds_read_b128 a[120:123], v24 offset:30720
    ds_read_b128 a[124:127], v24 offset:31744
    ds_read_b128 a[128:131], v24 offset:32768
    ds_read_b128 a[132:135], v24 offset:33792
    ds_read_b128 a[136:139], v24 offset:34816
    s_waitcnt lgkmcnt(14)
    ds_read_b128 a[140:143], v24 offset:35840
    buffer_load_dwordx4 v[76:79], v232, s[48:51], s75 offen offset:896
    s_waitcnt vmcnt(15)
    v_mfma_f32_32x32x16_bf16 v[112:127], a[80:83], a[224:227], 0
    v_pk_mul_f32 v[80:81], v[80:81], v[180:181]
    v_pk_mul_f32 v[84:85], v[84:85], v[180:181]
    v_pk_mul_f32 v[88:89], v[88:89], v[180:181]
    v_pk_mul_f32 v[92:93], v[92:93], v[180:181]
    v_pk_mul_f32 v[96:97], v[96:97], v[180:181]
    v_pk_mul_f32 v[100:101], v[100:101], v[180:181]
    v_pk_mul_f32 v[104:105], v[104:105], v[180:181]
    v_pk_mul_f32 v[108:109], v[108:109], v[180:181]
    v_cvt_pk_f16_f32 v224, v80, v84
    v_cvt_pk_f16_f32 v225, v88, v92
    v_cvt_pk_f16_f32 v226, v96, v100
    v_cvt_pk_f16_f32 v227, v104, v108
    s_waitcnt lgkmcnt(9)
    ds_write_b128 v234, v[224:227] offset:8192
    ds_read_b128 a[144:147], v24 offset:36864
    ds_read_b128 a[148:151], v24 offset:37888
    ds_read_b128 a[152:155], v24 offset:38912
    ds_read_b128 a[156:159], v24 offset:39936
    ds_read_b128 a[160:163], v24 offset:40960
    s_waitcnt lgkmcnt(14)
    ds_read_b128 a[164:167], v24 offset:41984
    s_add_u32 m0, s56, 6336
    s_nop 0
    buffer_load_dwordx4 v1, s[20:23], 0 offen offset:64 lds
    s_add_u32 m0, s56, 7360
    s_waitcnt vmcnt(14)
    v_mfma_f32_32x32x16_bf16 v[128:143], a[88:91], a[224:227], 0
    v_cvt_pk_f16_f32 v228, v81, v85
    v_cvt_pk_f16_f32 v229, v89, v93
    v_cvt_pk_f16_f32 v230, v97, v101
    v_cvt_pk_f16_f32 v231, v105, v109
    s_waitcnt lgkmcnt(9)
    ds_write_b128 v235, v[228:231] offset:8192
    ds_read_b128 a[168:171], v24 offset:43008
    ds_read_b128 a[172:175], v24 offset:44032
    ds_read_b128 a[176:179], v24 offset:45056
    ds_read_b128 a[180:183], v24 offset:46080
    ds_read_b128 a[184:187], v24 offset:47104
    s_waitcnt lgkmcnt(14)
    ds_read_b128 a[188:191], v24 offset:48128
    buffer_load_dwordx4 v2, s[20:23], 0 offen offset:64 lds
    s_add_u32 m0, s56, 8384
    s_nop 0
    buffer_load_dwordx4 v3, s[20:23], 0 offen offset:64 lds
    s_add_u32 m0, s56, 9408
    v_mfma_f32_32x32x16_bf16 v[112:127], a[84:87], a[228:231], v[112:127]
    v_pk_mul_f32 v[82:83], v[82:83], v[182:183]
    v_pk_mul_f32 v[86:87], v[86:87], v[182:183]
    v_pk_mul_f32 v[90:91], v[90:91], v[182:183]
    v_pk_mul_f32 v[94:95], v[94:95], v[182:183]
    v_pk_mul_f32 v[98:99], v[98:99], v[182:183]
    v_pk_mul_f32 v[102:103], v[102:103], v[182:183]
    v_pk_mul_f32 v[106:107], v[106:107], v[182:183]
    v_pk_mul_f32 v[110:111], v[110:111], v[182:183]
    v_cvt_pk_f16_f32 v224, v82, v86
    v_cvt_pk_f16_f32 v225, v90, v94
    v_cvt_pk_f16_f32 v226, v98, v102
    v_cvt_pk_f16_f32 v227, v106, v110
    s_waitcnt lgkmcnt(9)
    ds_write_b128 v234, v[224:227] offset:8448
    ds_read_b128 a[192:195], v23 offset:0
    ds_read_b128 a[196:199], v23 offset:3072
    ds_read_b128 a[200:203], v23 offset:10240
    ds_read_b128 a[204:207], v23 offset:13312
    ds_read_b128 a[208:211], v23 offset:20480
    s_waitcnt lgkmcnt(14)
    ds_read_b128 a[212:215], v23 offset:23552
    buffer_load_dwordx4 v4, s[20:23], 0 offen offset:64 lds
    s_add_u32 m0, s56, 10432
    s_nop 0
    buffer_load_dwordx4 v5, s[20:23], 0 offen offset:64 lds
    s_add_u32 m0, s56, 11456
    s_waitcnt vmcnt(17)
    v_mfma_f32_32x32x16_bf16 v[128:143], a[92:95], a[228:231], v[128:143]
    v_cvt_pk_f16_f32 v228, v83, v87
    v_cvt_pk_f16_f32 v229, v91, v95
    v_cvt_pk_f16_f32 v230, v99, v103
    v_cvt_pk_f16_f32 v231, v107, v111
    s_waitcnt lgkmcnt(14)
    ds_write_b128 v235, v[228:231] offset:8448
    v_add_u32 v234, v239, v234
    v_add_u32 v235, v239, v235
    v_add_u32 v238, v238, v239
    s_waitcnt lgkmcnt(13)
    ds_read_b128 a[216:219], v23 offset:30720
    ds_read_b128 a[220:223], v23 offset:33792
    buffer_load_dwordx4 v6, s[20:23], 0 offen offset:64 lds
    s_add_u32 m0, s56, 12480
    s_nop 0
    buffer_load_dword v7, s[20:23], 0 offen offset:64 lds
    buffer_load_dword v254, v31, s[20:23], 0 offen
    s_waitcnt lgkmcnt(9)
    ds_read_b128 a[48:51], v24 offset:12288
    ds_read_b128 a[52:55], v24 offset:13312
    ds_read_b128 a[56:59], v24 offset:14336
    ds_read_b128 a[60:63], v24 offset:15360
    ds_read_b128 a[64:67], v24 offset:16384
    ds_read_b128 a[68:71], v24 offset:17408
    s_waitcnt lgkmcnt(9)
    ds_read_b128 a[72:75], v24 offset:18432
    ds_read_b128 a[76:79], v24 offset:19456
    ds_read_b128 a[80:83], v24 offset:20480
    ds_read_b128 a[84:87], v24 offset:21504
    ds_read_b128 a[88:91], v24 offset:22528
    ds_read_b128 a[92:95], v24 offset:23552
    s_waitcnt lgkmcnt(0)
    s_barrier
    s_waitcnt vmcnt(19)
    v_mfma_f32_32x32x16_bf16 v[80:95], v[32:35], a[224:227], 0
    v_pk_mul_f32 v[112:113], v[112:113], v[184:185]
    v_pk_mul_f32 v[116:117], v[116:117], v[184:185]
    v_pk_mul_f32 v[120:121], v[120:121], v[184:185]
    v_pk_mul_f32 v[124:125], v[124:125], v[184:185]
    v_pk_mul_f32 v[128:129], v[128:129], v[184:185]
    v_pk_mul_f32 v[132:133], v[132:133], v[184:185]
    v_pk_mul_f32 v[136:137], v[136:137], v[184:185]
    v_pk_mul_f32 v[140:141], v[140:141], v[184:185]
    v_cvt_pk_f16_f32 v224, v112, v116
    v_cvt_pk_f16_f32 v225, v120, v124
    v_cvt_pk_f16_f32 v226, v128, v132
    v_cvt_pk_f16_f32 v227, v136, v140
    ds_write_b128 v234, v[224:227] offset:0
    s_waitcnt vmcnt(17)
    v_mfma_f32_32x32x16_bf16 v[96:111], v[40:43], a[224:227], 0
    v_cvt_pk_f16_f32 v228, v113, v117
    v_cvt_pk_f16_f32 v229, v121, v125
    v_cvt_pk_f16_f32 v230, v129, v133
    v_cvt_pk_f16_f32 v231, v137, v141
    ds_write_b128 v235, v[228:231] offset:0
    v_mfma_f32_32x32x16_bf16 v[80:95], v[36:39], a[228:231], v[80:95]
    v_pk_mul_f32 v[114:115], v[114:115], v[186:187]
    v_pk_mul_f32 v[118:119], v[118:119], v[186:187]
    v_pk_mul_f32 v[122:123], v[122:123], v[186:187]
    v_pk_mul_f32 v[126:127], v[126:127], v[186:187]
    v_pk_mul_f32 v[130:131], v[130:131], v[186:187]
    v_pk_mul_f32 v[134:135], v[134:135], v[186:187]
    v_pk_mul_f32 v[138:139], v[138:139], v[186:187]
    v_pk_mul_f32 v[142:143], v[142:143], v[186:187]
    v_cvt_pk_f16_f32 v224, v114, v118
    v_cvt_pk_f16_f32 v225, v122, v126
    v_cvt_pk_f16_f32 v226, v130, v134
    v_cvt_pk_f16_f32 v227, v138, v142
    ds_write_b128 v234, v[224:227] offset:256
    s_waitcnt vmcnt(16)
    v_mfma_f32_32x32x16_bf16 v[96:111], v[44:47], a[228:231], v[96:111]
    v_cvt_pk_f16_f32 v228, v115, v119
    v_cvt_pk_f16_f32 v229, v123, v127
    v_cvt_pk_f16_f32 v230, v131, v135
    v_cvt_pk_f16_f32 v231, v139, v143
    ds_write_b128 v235, v[228:231] offset:256
    v_sub_u32 v234, v234, v238
    v_sub_u32 v235, v235, v238
    s_waitcnt vmcnt(15)
    v_mfma_f32_32x32x16_bf16 v[112:127], v[48:51], a[224:227], 0
    v_pk_mul_f32 v[80:81], v[80:81], v[176:177]
    v_pk_mul_f32 v[84:85], v[84:85], v[176:177]
    v_pk_mul_f32 v[88:89], v[88:89], v[176:177]
    v_pk_mul_f32 v[92:93], v[92:93], v[176:177]
    v_pk_mul_f32 v[96:97], v[96:97], v[176:177]
    v_pk_mul_f32 v[100:101], v[100:101], v[176:177]
    v_pk_mul_f32 v[104:105], v[104:105], v[176:177]
    v_pk_mul_f32 v[108:109], v[108:109], v[176:177]
    v_cvt_pk_f16_f32 v224, v80, v84
    v_cvt_pk_f16_f32 v225, v88, v92
    v_cvt_pk_f16_f32 v226, v96, v100
    v_cvt_pk_f16_f32 v227, v104, v108
    ds_write_b128 v234, v[224:227] offset:6144
    s_waitcnt vmcnt(13)
    v_mfma_f32_32x32x16_bf16 v[128:143], v[56:59], a[224:227], 0
    v_cvt_pk_f16_f32 v228, v81, v85
    v_cvt_pk_f16_f32 v229, v89, v93
    v_cvt_pk_f16_f32 v230, v97, v101
    v_cvt_pk_f16_f32 v231, v105, v109
    ds_write_b128 v235, v[228:231] offset:6144
    v_mfma_f32_32x32x16_bf16 v[112:127], v[52:55], a[228:231], v[112:127]
    v_pk_mul_f32 v[82:83], v[82:83], v[178:179]
    v_pk_mul_f32 v[86:87], v[86:87], v[178:179]
    v_pk_mul_f32 v[90:91], v[90:91], v[178:179]
    v_pk_mul_f32 v[94:95], v[94:95], v[178:179]
    v_pk_mul_f32 v[98:99], v[98:99], v[178:179]
    v_pk_mul_f32 v[102:103], v[102:103], v[178:179]
    v_pk_mul_f32 v[106:107], v[106:107], v[178:179]
    v_pk_mul_f32 v[110:111], v[110:111], v[178:179]
    v_cvt_pk_f16_f32 v224, v82, v86
    v_cvt_pk_f16_f32 v225, v90, v94
    v_cvt_pk_f16_f32 v226, v98, v102
    v_cvt_pk_f16_f32 v227, v106, v110
    ds_write_b128 v234, v[224:227] offset:6400
    s_waitcnt vmcnt(12)
    v_mfma_f32_32x32x16_bf16 v[128:143], v[60:63], a[228:231], v[128:143]
    v_cvt_pk_f16_f32 v228, v83, v87
    v_cvt_pk_f16_f32 v229, v91, v95
    v_cvt_pk_f16_f32 v230, v99, v103
    v_cvt_pk_f16_f32 v231, v107, v111
    ds_write_b128 v235, v[228:231] offset:6400
    s_waitcnt vmcnt(11)
    v_mfma_f32_32x32x16_bf16 v[80:95], v[64:67], a[224:227], 0
    v_pk_mul_f32 v[112:113], v[112:113], v[180:181]
    v_pk_mul_f32 v[116:117], v[116:117], v[180:181]
    v_pk_mul_f32 v[120:121], v[120:121], v[180:181]
    v_pk_mul_f32 v[124:125], v[124:125], v[180:181]
    s_nop 0
    v_pk_mul_f32 v[128:129], v[128:129], v[180:181]
    v_pk_mul_f32 v[132:133], v[132:133], v[180:181]
    v_pk_mul_f32 v[136:137], v[136:137], v[180:181]
    v_pk_mul_f32 v[140:141], v[140:141], v[180:181]
    v_cvt_pk_f16_f32 v224, v112, v116
    v_cvt_pk_f16_f32 v225, v120, v124
    v_cvt_pk_f16_f32 v226, v128, v132
    v_cvt_pk_f16_f32 v227, v136, v140
    ds_write_b128 v234, v[224:227] offset:8192
    s_waitcnt vmcnt(9)
    v_mfma_f32_32x32x16_bf16 v[96:111], v[72:75], a[224:227], 0
    v_cvt_pk_f16_f32 v228, v113, v117
    v_cvt_pk_f16_f32 v229, v121, v125
    v_cvt_pk_f16_f32 v230, v129, v133
    v_cvt_pk_f16_f32 v231, v137, v141
    ds_write_b128 v235, v[228:231] offset:8192
    v_mfma_f32_32x32x16_bf16 v[80:95], v[68:71], a[228:231], v[80:95]
    v_pk_mul_f32 v[114:115], v[114:115], v[182:183]
    v_pk_mul_f32 v[118:119], v[118:119], v[182:183]
    v_pk_mul_f32 v[122:123], v[122:123], v[182:183]
    v_pk_mul_f32 v[126:127], v[126:127], v[182:183]
    v_pk_mul_f32 v[130:131], v[130:131], v[182:183]
    v_pk_mul_f32 v[134:135], v[134:135], v[182:183]
    v_pk_mul_f32 v[138:139], v[138:139], v[182:183]
    v_pk_mul_f32 v[142:143], v[142:143], v[182:183]
    v_cvt_pk_f16_f32 v224, v114, v118
    v_cvt_pk_f16_f32 v225, v122, v126
    v_cvt_pk_f16_f32 v226, v130, v134
    v_cvt_pk_f16_f32 v227, v138, v142
    ds_write_b128 v234, v[224:227] offset:8448
    s_waitcnt vmcnt(8)
    v_mfma_f32_32x32x16_bf16 v[96:111], v[76:79], a[228:231], v[96:111]
    v_cvt_pk_f16_f32 v228, v115, v119
    v_cvt_pk_f16_f32 v229, v123, v127
    v_cvt_pk_f16_f32 v230, v131, v135
    v_cvt_pk_f16_f32 v231, v139, v143
    ds_write_b128 v235, v[228:231] offset:8448
    v_pk_mul_f32 v[80:81], v[80:81], v[184:185]
    v_pk_mul_f32 v[84:85], v[84:85], v[184:185]
    v_pk_mul_f32 v[88:89], v[88:89], v[184:185]
    v_pk_mul_f32 v[92:93], v[92:93], v[184:185]
    s_nop 2
    v_pk_mul_f32 v[96:97], v[96:97], v[184:185]
    v_pk_mul_f32 v[100:101], v[100:101], v[184:185]
    v_pk_mul_f32 v[104:105], v[104:105], v[184:185]
    v_pk_mul_f32 v[108:109], v[108:109], v[184:185]
    v_cvt_pk_f16_f32 v224, v80, v84
    v_cvt_pk_f16_f32 v225, v88, v92
    v_cvt_pk_f16_f32 v226, v96, v100
    v_cvt_pk_f16_f32 v227, v104, v108
    ds_write_b128 v234, v[224:227] offset:10240
    v_cvt_pk_f16_f32 v228, v81, v85
    v_cvt_pk_f16_f32 v229, v89, v93
    v_cvt_pk_f16_f32 v230, v97, v101
    v_cvt_pk_f16_f32 v231, v105, v109
    ds_write_b128 v235, v[228:231] offset:10240
    v_pk_mul_f32 v[82:83], v[82:83], v[186:187]
    v_pk_mul_f32 v[86:87], v[86:87], v[186:187]
    v_pk_mul_f32 v[90:91], v[90:91], v[186:187]
    v_pk_mul_f32 v[94:95], v[94:95], v[186:187]
    v_pk_mul_f32 v[98:99], v[98:99], v[186:187]
    v_pk_mul_f32 v[102:103], v[102:103], v[186:187]
    v_pk_mul_f32 v[106:107], v[106:107], v[186:187]
    v_pk_mul_f32 v[110:111], v[110:111], v[186:187]
    v_cvt_pk_f16_f32 v224, v82, v86
    v_cvt_pk_f16_f32 v225, v90, v94
    v_cvt_pk_f16_f32 v226, v98, v102
    v_cvt_pk_f16_f32 v227, v106, v110
    ds_write_b128 v234, v[224:227] offset:10496
    v_cvt_pk_f16_f32 v228, v83, v87
    v_cvt_pk_f16_f32 v229, v91, v95
    v_cvt_pk_f16_f32 v230, v99, v103
    v_cvt_pk_f16_f32 v231, v107, v111
    s_waitcnt lgkmcnt(14)
    ds_write_b128 v235, v[228:231] offset:10496
L_conv0:
    s_waitcnt lgkmcnt(9)
    ds_read_b128 v[192:195], v22 offset:0
    ds_read_b128 v[200:203], v22 offset:16
    ds_read_b128 a[232:235], v8 offset:0
    s_waitcnt lgkmcnt(9)
    ds_read_b128 a[244:247], v8 offset:2560
    ds_read_b128 a[236:239], v12 offset:0
    ds_read_b128 a[248:251], v12 offset:2560
    ds_read_b128 a[240:243], v14 offset:1280
    ds_read_b128 a[252:255], v14 offset:3840
    ds_read_b128 v[196:199], v22 offset:256
    s_waitcnt lgkmcnt(9)
    ds_read_b128 v[204:207], v22 offset:272
    ds_read_b128 v[176:179], v9 offset:0
    ds_read_b128 v[188:191], v9 offset:2560
    ds_read_b128 v[180:183], v13 offset:0
    ds_read_b128 v[232:235], v13 offset:2560
    ds_read_b128 v[184:187], v15 offset:1280
    s_waitcnt lgkmcnt(11)
    ds_read_b128 v[236:239], v15 offset:3840
    ds_read_b128 v[52:55], v20 offset:2560
    ds_read_b128 v[48:51], v20 offset:0
    ds_read_b128 v[60:63], v21 offset:2560
    v_mfma_f32_16x16x32_bf16 v[128:131], v[192:195], a[232:235], 0
    s_waitcnt lgkmcnt(0)
    ds_read_b128 v[56:59], v21 offset:0
    ds_read_b128 v[32:35], v25 offset:0
    ds_read_b128 v[36:39], v25 offset:32
    ds_read_b128 v[40:43], v25 offset:64
    ds_read_b128 v[44:47], v25 offset:96
    ds_read_b128 a[232:235], v10 offset:0
    v_mfma_f32_16x16x32_bf16 v[152:155], v[192:195], a[244:247], 0
    ds_read_b128 a[244:247], v10 offset:2560
    ds_read_b128 v[192:195], v22 offset:512
    v_smfmac_f32_16x16x64_bf16 v[128:131], v[200:203], a[236:243], v16
    ds_read_b128 a[236:239], v14 offset:0
    ds_read_b128 a[240:243], v12 offset:1280
    s_nop 0
    v_smfmac_f32_16x16x64_bf16 v[152:155], v[200:203], a[248:255], v16
    ds_read_b128 a[248:251], v14 offset:2560
    ds_read_b128 a[252:255], v12 offset:3840
    ds_read_b128 v[200:203], v22 offset:528
    s_nop 0
    v_cvt_pkrtz_f16_f32 v128, v128, v129
    v_cvt_pkrtz_f16_f32 v129, v130, v131
    v_dot2_f32_f16 v28, v128, v128, 0
    v_dot2_f32_f16 v27, v128, s58, 0
    v_cvt_pkrtz_f16_f32 v152, v152, v153
    v_mfma_f32_16x16x32_bf16 v[224:227], v[196:199], v[176:179], 0
    ds_read_b128 v[176:179], v11 offset:0
    v_cvt_pkrtz_f16_f32 v153, v154, v155
    v_mfma_f32_16x16x32_bf16 v[228:231], v[196:199], v[188:191], 0
    s_waitcnt lgkmcnt(12)
    ds_read_b128 v[188:191], v11 offset:2560
    ds_read_b128 v[196:199], v22 offset:768
    v_dot2_f32_f16 v30, v152, v152, 0
    v_dot2_f32_f16 v29, v152, s58, 0
    v_dot2_f32_f16 v28, v129, v129, v28
    v_dot2_f32_f16 v30, v153, v153, v30
    v_dot2_f32_f16 v27, v129, s58, v27
    v_smfmac_f32_16x16x64_bf16 v[224:227], v[204:207], v[180:187], v16
    s_waitcnt lgkmcnt(1)
    ds_read_b128 v[180:183], v15 offset:0
    ds_read_b128 v[184:187], v13 offset:1280
    v_smfmac_f32_16x16x64_bf16 v[228:231], v[204:207], v[232:239], v16
    s_add_u32 m0, s56, -128
    ds_read_b128 v[232:235], v15 offset:2560
    ds_read_b128 v[236:239], v13 offset:3840
    ds_read_b128 v[204:207], v22 offset:784
    v_cvt_pkrtz_f16_f32 v130, v224, v225
    v_cvt_pkrtz_f16_f32 v131, v226, v227
    v_dot2_f32_f16 v29, v153, s58, v29
    s_nop 0
    v_cvt_pkrtz_f16_f32 v154, v228, v229
    v_cvt_pkrtz_f16_f32 v155, v230, v231
    v_dot2_f32_f16 v28, v130, v130, v28
    v_dot2_f32_f16 v30, v154, v154, v30
    v_dot2_f32_f16 v27, v130, s58, v27
    v_dot2_f32_f16 v29, v154, s58, v29
    v_dot2_f32_f16 v28, v131, v131, v28
    v_dot2_f32_f16 v30, v155, v155, v30
    v_dot2_f32_f16 v27, v131, s58, v27
    v_dot2_f32_f16 v29, v155, s58, v29
    v_mfma_f32_16x16x32_bf16 v[132:135], v[192:195], a[232:235], 0
    s_waitcnt vmcnt(1)
    ds_read_b128 a[232:235], v8 offset:6400
    v_mfma_f32_16x16x32_bf16 v[156:159], v[192:195], a[244:247], 0
    ds_read_b128 a[244:247], v8 offset:8960
    ds_read_b128 v[192:195], v22 offset:1024
    s_nop 0
    v_smfmac_f32_16x16x64_bf16 v[132:135], v[200:203], a[236:243], v16
    ds_read_b128 a[236:239], v12 offset:6400
    ds_read_b128 a[240:243], v14 offset:7680
    v_smfmac_f32_16x16x64_bf16 v[156:159], v[200:203], a[248:255], v16
    ds_read_b128 a[248:251], v12 offset:8960
    ds_read_b128 a[252:255], v14 offset:10240
    ds_read_b128 v[200:203], v22 offset:1040
    s_nop 1
    v_cvt_pkrtz_f16_f32 v132, v132, v133
    s_waitcnt lgkmcnt(13)
    v_mfma_f32_16x16x32_bf16 v[224:227], v[196:199], v[176:179], 0
    ds_read_b128 v[176:179], v9 offset:6400
    v_cvt_pkrtz_f16_f32 v156, v156, v157
    v_mfma_f32_16x16x32_bf16 v[228:231], v[196:199], v[188:191], 0
    s_waitcnt lgkmcnt(10)
    ds_read_b128 v[188:191], v9 offset:8960
    ds_read_b128 v[196:199], v22 offset:1280
    v_cvt_pkrtz_f16_f32 v133, v134, v135
    v_cvt_pkrtz_f16_f32 v157, v158, v159
    v_dot2_f32_f16 v28, v132, v132, v28
    v_dot2_f32_f16 v30, v156, v156, v30
    v_dot2_f32_f16 v27, v132, s58, v27
    v_dot2_f32_f16 v29, v156, s58, v29
    v_dot2_f32_f16 v28, v133, v133, v28
    v_dot2_f32_f16 v30, v157, v157, v30
    v_dot2_f32_f16 v27, v133, s58, v27
    s_waitcnt lgkmcnt(11)
    v_smfmac_f32_16x16x64_bf16 v[224:227], v[204:207], v[180:187], v16
    buffer_load_dwordx4 v1, s[20:23], 0 offen offset:128 lds
    ds_read_b128 v[180:183], v13 offset:6400
    ds_read_b128 v[184:187], v15 offset:7680
    s_add_u32 m0, s56, 896
    v_smfmac_f32_16x16x64_bf16 v[228:231], v[204:207], v[232:239], v16
    s_waitcnt lgkmcnt(0)
    buffer_load_dwordx4 v2, s[20:23], 0 offen offset:128 lds
    ds_read_b128 v[232:235], v13 offset:8960
    ds_read_b128 v[236:239], v15 offset:10240
    ds_read_b128 v[204:207], v22 offset:1296
    v_dot2_f32_f16 v29, v157, s58, v29
    v_cvt_pkrtz_f16_f32 v134, v224, v225
    v_cvt_pkrtz_f16_f32 v135, v226, v227
    v_dot2_f32_f16 v28, v134, v134, v28
    v_mfma_f32_16x16x32_bf16 v[136:139], v[192:195], a[232:235], 0
    s_add_u32 m0, s56, 1920
    ds_read_b128 a[232:235], v10 offset:6400
    buffer_load_dwordx4 v3, s[20:23], 0 offen offset:128 lds
    ds_read_b128 v[212:215], v20 offset:8960
    v_mfma_f32_16x16x32_bf16 v[160:163], v[192:195], a[244:247], 0
    s_add_u32 m0, s56, 2944
    ds_read_b128 a[244:247], v10 offset:8960
    buffer_load_dwordx4 v4, s[20:23], 0 offen offset:128 lds
    ds_read_b128 v[192:195], v22 offset:1536
    v_mfma_f32_32x32x16_bf16 v[80:95], a[224:227], v[52:55], v[32:47]
    s_add_u32 m0, s56, 3968
    v_cvt_pkrtz_f16_f32 v158, v228, v229
    v_cvt_pkrtz_f16_f32 v159, v230, v231
    v_smfmac_f32_16x16x64_bf16 v[136:139], v[200:203], a[236:243], v16
    buffer_load_dwordx4 v5, s[20:23], 0 offen offset:128 lds
    ds_read_b128 a[236:239], v14 offset:6400
    ds_read_b128 a[240:243], v12 offset:7680
    ds_read_b128 v[208:211], v20 offset:6400
    v_smfmac_f32_16x16x64_bf16 v[160:163], v[200:203], a[248:255], v16
    s_add_u32 m0, s56, 4992
    ds_read_b128 a[248:251], v14 offset:8960
    buffer_load_dwordx4 v6, s[20:23], 0 offen offset:128 lds
    ds_read_b128 a[252:255], v12 offset:10240
    ds_read_b128 v[200:203], v22 offset:1552
    v_mfma_f32_32x32x16_bf16 v[32:47], a[224:227], v[48:51], v[32:47]
    s_add_u32 m0, s56, 6016
    v_cvt_pkrtz_f16_f32 v136, v136, v137
    v_cvt_pkrtz_f16_f32 v160, v160, v161
    v_cvt_pkrtz_f16_f32 v137, v138, v139
    v_cvt_pkrtz_f16_f32 v161, v162, v163
    v_mfma_f32_16x16x32_bf16 v[224:227], v[196:199], v[176:179], 0
    s_waitcnt lgkmcnt(1)
    buffer_load_dword v7, s[20:23], 0 offen offset:128 lds
    ds_read_b128 v[176:179], v11 offset:6400
    ds_read_b128 v[220:223], v21 offset:8960
    v_mfma_f32_16x16x32_bf16 v[228:231], v[196:199], v[188:191], 0
    ds_read_b128 v[188:191], v11 offset:8960
    ds_read_b128 v[196:199], v22 offset:1792
    v_mfma_f32_32x32x16_bf16 v[80:95], a[228:231], v[60:63], v[80:95]
    v_smfmac_f32_16x16x64_bf16 v[224:227], v[204:207], v[180:187], v16
    ds_read_b128 v[180:183], v15 offset:6400
    ds_read_b128 v[184:187], v13 offset:7680
    ds_read_b128 v[216:219], v21 offset:6400
    v_smfmac_f32_16x16x64_bf16 v[228:231], v[204:207], v[232:239], v16
    ds_read_b128 v[232:235], v15 offset:8960
    ds_read_b128 v[236:239], v13 offset:10240
    ds_read_b128 v[204:207], v22 offset:1808
    v_mfma_f32_32x32x16_bf16 v[32:47], a[228:231], v[56:59], v[32:47]
    v_cvt_pkrtz_f16_f32 v138, v224, v225
    v_cvt_pkrtz_f16_f32 v139, v226, v227
    s_nop 1
    v_cvt_pkrtz_f16_f32 v162, v228, v229
    v_cvt_pkrtz_f16_f32 v163, v230, v231
    v_mfma_f32_16x16x32_bf16 v[140:143], v[192:195], a[232:235], 0
    v_mfma_f32_16x16x32_bf16 v[164:167], v[192:195], a[244:247], 0
    ds_read_b128 v[192:195], v22 offset:2048
    v_dot2_f32_f16 v30, v158, v158, v30
    v_dot2_f32_f16 v27, v134, s58, v27
    v_dot2_f32_f16 v29, v158, s58, v29
    v_dot2_f32_f16 v28, v135, v135, v28
    v_dot2_f32_f16 v30, v159, v159, v30
    s_waitcnt lgkmcnt(11)
    v_smfmac_f32_16x16x64_bf16 v[140:143], v[200:203], a[236:243], v16
    v_smfmac_f32_16x16x64_bf16 v[164:167], v[200:203], a[248:255], v16
    s_waitcnt lgkmcnt(10)
    ds_read_b128 v[200:203], v22 offset:2064
    v_dot2_f32_f16 v27, v135, s58, v27
    v_dot2_f32_f16 v29, v159, s58, v29
    v_dot2_f32_f16 v28, v136, v136, v28
    v_dot2_f32_f16 v30, v160, v160, v30
    v_dot2_f32_f16 v27, v136, s58, v27
    v_dot2_f32_f16 v29, v160, s58, v29
    v_dot2_f32_f16 v28, v137, v137, v28
    v_dot2_f32_f16 v30, v161, v161, v30
    v_dot2_f32_f16 v27, v137, s58, v27
    v_dot2_f32_f16 v29, v161, s58, v29
    v_dot2_f32_f16 v28, v138, v138, v28
    v_dot2_f32_f16 v30, v162, v162, v30
    v_dot2_f32_f16 v27, v138, s58, v27
    v_dot2_f32_f16 v29, v162, s58, v29
    v_dot2_f32_f16 v28, v139, v139, v28
    v_dot2_f32_f16 v30, v163, v163, v30
    v_dot2_f32_f16 v27, v139, s58, v27
    v_dot2_f32_f16 v29, v163, s58, v29
    v_cvt_pkrtz_f16_f32 v140, v140, v141
    v_cvt_pkrtz_f16_f32 v164, v164, v165
    v_cvt_pkrtz_f16_f32 v141, v142, v143
    s_waitcnt lgkmcnt(8)
    v_mfma_f32_16x16x32_bf16 v[224:227], v[196:199], v[176:179], 0
    v_cvt_pkrtz_f16_f32 v165, v166, v167
    v_mfma_f32_16x16x32_bf16 v[228:231], v[196:199], v[188:191], 0
    s_waitcnt lgkmcnt(6)
    ds_read_b128 v[196:199], v22 offset:2304
    v_dot2_f32_f16 v28, v140, v140, v28
    v_dot2_f32_f16 v30, v164, v164, v30
    v_dot2_f32_f16 v27, v140, s58, v27
    v_dot2_f32_f16 v29, v164, s58, v29
    v_dot2_f32_f16 v28, v141, v141, v28
    s_waitcnt lgkmcnt(3)
    v_smfmac_f32_16x16x64_bf16 v[224:227], v[204:207], v[180:187], v16
    v_smfmac_f32_16x16x64_bf16 v[228:231], v[204:207], v[232:239], v16
    s_waitcnt lgkmcnt(1)
    ds_read_b128 v[204:207], v22 offset:2320
    v_dot2_f32_f16 v30, v165, v165, v30
    v_dot2_f32_f16 v27, v141, s58, v27
    v_dot2_f32_f16 v29, v165, s58, v29
    s_nop 1
    v_cvt_pkrtz_f16_f32 v142, v224, v225
    v_cvt_pkrtz_f16_f32 v166, v228, v229
    v_cvt_pkrtz_f16_f32 v143, v226, v227
    v_cvt_pkrtz_f16_f32 v167, v230, v231
    v_dot2_f32_f16 v28, v142, v142, v28
    v_dot2_f32_f16 v30, v166, v166, v30
    v_dot2_f32_f16 v27, v142, s58, v27
    v_dot2_f32_f16 v29, v166, s58, v29
    v_dot2_f32_f16 v28, v143, v143, v28
    v_dot2_f32_f16 v30, v167, v167, v30
    v_dot2_f32_f16 v27, v143, s58, v27
    v_dot2_f32_f16 v29, v167, s58, v29
    s_waitcnt vmcnt(0)
    ds_read_b128 a[232:235], v8 offset:0
    ds_read_b128 a[244:247], v8 offset:2560
    ds_read_b128 a[236:239], v12 offset:0
    ds_read_b128 a[240:243], v14 offset:1280
    ds_read_b128 a[248:251], v12 offset:2560
    ds_read_b128 a[252:255], v14 offset:3840
    ds_read_b128 v[176:179], v9 offset:0
    ds_read_b128 v[188:191], v9 offset:2560
    ds_read_b128 v[180:183], v13 offset:0
    ds_read_b128 v[184:187], v15 offset:1280
    ds_read_b128 v[232:235], v13 offset:2560
    ds_read_b128 v[236:239], v15 offset:3840
    s_waitcnt lgkmcnt(11)
    v_mfma_f32_16x16x32_bf16 v[144:147], v[192:195], a[232:235], 0
    s_waitcnt lgkmcnt(10)
    ds_read_b128 a[232:235], v10 offset:0
    v_mfma_f32_16x16x32_bf16 v[168:171], v[192:195], a[244:247], 0
    s_waitcnt lgkmcnt(10)
    ds_read_b128 a[244:247], v10 offset:2560
    ds_read_b128 v[192:195], v22 offset:2560
    s_waitcnt lgkmcnt(11)
    v_smfmac_f32_16x16x64_bf16 v[144:147], v[200:203], a[236:243], v16
    s_waitcnt lgkmcnt(10)
    ds_read_b128 a[236:239], v14 offset:0
    ds_read_b128 a[240:243], v12 offset:1280
    s_waitcnt lgkmcnt(11)
    v_smfmac_f32_16x16x64_bf16 v[168:171], v[200:203], a[248:255], v16
    ds_read_b128 a[248:251], v14 offset:2560
    ds_read_b128 a[252:255], v12 offset:3840
    ds_read_b128 v[200:203], v22 offset:2576
    s_waitcnt lgkmcnt(13)
    v_mfma_f32_16x16x32_bf16 v[224:227], v[196:199], v[176:179], 0
    s_waitcnt lgkmcnt(12)
    ds_read_b128 v[176:179], v11 offset:0
    ds_read_b128 v[48:51], v25 offset:128
    v_mfma_f32_16x16x32_bf16 v[228:231], v[196:199], v[188:191], 0
    s_waitcnt lgkmcnt(1)
    ds_read_b128 v[188:191], v11 offset:2560
    ds_read_b128 v[196:199], v22 offset:2816
    ds_read_b128 v[52:55], v25 offset:160
    v_cvt_pkrtz_f16_f32 v144, v144, v145
    v_cvt_pkrtz_f16_f32 v168, v168, v169
    v_smfmac_f32_16x16x64_bf16 v[224:227], v[204:207], v[180:187], v16
    ds_read_b128 v[180:183], v15 offset:0
    ds_read_b128 v[184:187], v13 offset:1280
    ds_read_b128 v[56:59], v25 offset:192
    v_cvt_pkrtz_f16_f32 v145, v146, v147
    v_cvt_pkrtz_f16_f32 v169, v170, v171
    v_dot2_f32_f16 v28, v144, v144, v28
    v_smfmac_f32_16x16x64_bf16 v[228:231], v[204:207], v[232:239], v16
    ds_read_b128 v[232:235], v15 offset:2560
    ds_read_b128 v[236:239], v13 offset:3840
    ds_read_b128 v[204:207], v22 offset:2832
    ds_read_b128 v[60:63], v25 offset:224
    v_cvt_pkrtz_f16_f32 v146, v224, v225
    v_dot2_f32_f16 v30, v168, v168, v30
    v_dot2_f32_f16 v27, v144, s58, v27
    v_dot2_f32_f16 v29, v168, s58, v29
    v_dot2_f32_f16 v28, v145, v145, v28
    v_dot2_f32_f16 v30, v169, v169, v30
    v_dot2_f32_f16 v27, v145, s58, v27
    v_dot2_f32_f16 v29, v169, s58, v29
    v_cvt_pkrtz_f16_f32 v170, v228, v229
    v_cvt_pkrtz_f16_f32 v147, v226, v227
    v_cvt_pkrtz_f16_f32 v171, v230, v231
    v_mfma_f32_16x16x32_bf16 v[148:151], v[192:195], a[232:235], 0
    ds_read_b128 v[64:67], v25 offset:256
    v_mfma_f32_16x16x32_bf16 v[172:175], v[192:195], a[244:247], 0
    ds_read_b128 v[68:71], v25 offset:288
    s_nop 2
    v_smfmac_f32_16x16x64_bf16 v[148:151], v[200:203], a[236:243], v16
    ds_read_b128 v[72:75], v25 offset:320
    v_smfmac_f32_16x16x64_bf16 v[172:175], v[200:203], a[248:255], v16
    s_waitcnt lgkmcnt(13)
    ds_read_b128 v[76:79], v25 offset:352
    s_nop 3
    v_cvt_pkrtz_f16_f32 v148, v148, v149
    v_cvt_pkrtz_f16_f32 v149, v150, v151
    v_cvt_pkrtz_f16_f32 v172, v172, v173
    v_cvt_pkrtz_f16_f32 v173, v174, v175
    s_waitcnt lgkmcnt(12)
    v_mfma_f32_16x16x32_bf16 v[224:227], v[196:199], v[176:179], 0
    ds_read_b128 a[232:235], v23 offset:1024
    ds_read_b128 a[236:239], v23 offset:2048
    v_mfma_f32_16x16x32_bf16 v[228:231], v[196:199], v[188:191], 0
    s_waitcnt lgkmcnt(8)
    ds_read_b128 a[240:243], v23 offset:4096
    ds_read_b128 a[244:247], v23 offset:5120
    s_waitcnt lgkmcnt(9)
    v_smfmac_f32_16x16x64_bf16 v[224:227], v[204:207], v[180:187], v16
    ds_read_b128 a[248:251], v23 offset:11264
    v_smfmac_f32_16x16x64_bf16 v[228:231], v[204:207], v[232:239], v16
    ds_read_b128 a[252:255], v23 offset:12288
    s_waitcnt lgkmcnt(0)
    s_barrier
    s_branch L_mid
L_conv:
    v_mfma_f32_16x16x32_bf16 v[128:131], v[192:195], a[232:235], 0
    ds_read_b128 a[232:235], v10 offset:0
    v_mfma_f32_16x16x32_bf16 v[152:155], v[192:195], a[244:247], 0
    ds_read_b128 a[244:247], v10 offset:2560
    ds_read_b128 v[192:195], v22 offset:512
    s_nop 1
    v_smfmac_f32_16x16x64_bf16 v[128:131], v[200:203], a[236:243], v16
    ds_read_b128 a[236:239], v14 offset:0
    ds_read_b128 a[240:243], v12 offset:1280
    v_smfmac_f32_16x16x64_bf16 v[152:155], v[200:203], a[248:255], v16
    ds_read_b128 a[248:251], v14 offset:2560
    ds_read_b128 a[252:255], v12 offset:3840
    ds_read_b128 v[200:203], v22 offset:528
    v_mfma_f32_16x16x32_bf16 v[224:227], v[196:199], v[176:179], 0
    ds_read_b128 v[176:179], v11 offset:0
    v_cvt_pkrtz_f16_f32 v128, v128, v129
    v_mfma_f32_16x16x32_bf16 v[228:231], v[196:199], v[188:191], 0
    ds_read_b128 v[188:191], v11 offset:2560
    ds_read_b128 v[196:199], v22 offset:768
    v_cvt_pkrtz_f16_f32 v152, v152, v153
    v_smfmac_f32_16x16x64_bf16 v[224:227], v[204:207], v[180:187], v16
    ds_read_b128 v[180:183], v15 offset:0
    s_waitcnt lgkmcnt(14)
    ds_read_b128 v[184:187], v13 offset:1280
    v_smfmac_f32_16x16x64_bf16 v[228:231], v[204:207], v[232:239], v16
    s_waitcnt lgkmcnt(10)
    ds_read_b128 v[232:235], v15 offset:2560
    ds_read_b128 v[236:239], v13 offset:3840
    ds_read_b128 v[204:207], v22 offset:784
    v_mfma_f32_32x32x16_f16 v[80:95], a[172:175], v[244:247], v[80:95]
    s_add_u32 m0, s56, -128
    v_cvt_pkrtz_f16_f32 v129, v130, v131
    v_cvt_pkrtz_f16_f32 v153, v154, v155
    v_cvt_pkrtz_f16_f32 v130, v224, v225
    v_cvt_pkrtz_f16_f32 v154, v228, v229
    v_cvt_pkrtz_f16_f32 v131, v226, v227
    v_cvt_pkrtz_f16_f32 v155, v230, v231
    v_mfma_f32_16x16x32_bf16 v[132:135], v[192:195], a[232:235], 0
    ds_read_b128 a[232:235], v8 offset:6400
    v_mfma_f32_16x16x32_bf16 v[156:159], v[192:195], a[244:247], 0
    s_waitcnt lgkmcnt(2)
    ds_read_b128 a[244:247], v8 offset:8960
    ds_read_b128 v[192:195], v22 offset:1024
    v_mfma_f32_32x32x16_f16 v[96:111], a[180:183], v[244:247], v[96:111]
    v_cvt_pk_bf16_f32 v80, v80, v81
    v_cvt_pk_bf16_f32 v81, v82, v83
    v_cvt_pk_bf16_f32 v82, v84, v85
    v_cvt_pk_bf16_f32 v83, v86, v87
    v_cvt_pk_bf16_f32 v84, v88, v89
    v_cvt_pk_bf16_f32 v85, v90, v91
    v_smfmac_f32_16x16x64_bf16 v[132:135], v[200:203], a[236:243], v16
    ds_read_b128 a[236:239], v12 offset:6400
    ds_read_b128 a[240:243], v14 offset:7680
    v_smfmac_f32_16x16x64_bf16 v[156:159], v[200:203], a[248:255], v16
    ds_read_b128 a[248:251], v12 offset:8960
    ds_read_b128 a[252:255], v14 offset:10240
    ds_read_b128 v[200:203], v22 offset:1040
    v_mfma_f32_32x32x16_f16 v[112:127], a[188:191], v[244:247], v[112:127]
    v_cvt_pk_bf16_f32 v86, v92, v93
    v_cvt_pk_bf16_f32 v87, v94, v95
    v_permlane16_swap_b32 v80, v84
    v_permlane16_swap_b32 v81, v85
    v_mfma_f32_16x16x32_bf16 v[224:227], v[196:199], v[176:179], 0
    s_waitcnt lgkmcnt(7)
    buffer_load_dwordx4 v1, s[20:23], 0 offen offset:128 lds
    ds_read_b128 v[176:179], v9 offset:6400
    ds_read_b128 v[32:35], v25 offset:0
    v_mfma_f32_16x16x32_bf16 v[228:231], v[196:199], v[188:191], 0
    s_add_u32 m0, s56, 896
    ds_read_b128 v[188:191], v9 offset:8960
    buffer_load_dwordx4 v2, s[20:23], 0 offen offset:128 lds
    ds_read_b128 v[196:199], v22 offset:1280
    ds_read_b128 v[36:39], v25 offset:32
    v_smfmac_f32_16x16x64_bf16 v[224:227], v[204:207], v[180:187], v16
    s_add_u32 m0, s56, 1920
    ds_read_b128 v[180:183], v13 offset:6400
    buffer_load_dwordx4 v3, s[20:23], 0 offen offset:128 lds
    ds_read_b128 v[184:187], v15 offset:7680
    ds_read_b128 v[40:43], v25 offset:64
    v_smfmac_f32_16x16x64_bf16 v[228:231], v[204:207], v[232:239], v16
    s_add_u32 m0, s56, 2944
    s_waitcnt lgkmcnt(14)
    ds_read_b128 v[232:235], v13 offset:8960
    buffer_load_dwordx4 v4, s[20:23], 0 offen offset:128 lds
    s_waitcnt lgkmcnt(12)
    ds_read_b128 v[236:239], v15 offset:10240
    ds_read_b128 v[204:207], v22 offset:1296
    ds_read_b128 v[44:47], v25 offset:96
    v_permlane16_swap_b32 v82, v86
    v_permlane16_swap_b32 v83, v87
    v_cvt_pkrtz_f16_f32 v132, v132, v133
    v_cvt_pkrtz_f16_f32 v156, v156, v157
    v_cvt_pkrtz_f16_f32 v133, v134, v135
    v_cvt_pkrtz_f16_f32 v157, v158, v159
    v_dot2_f32_f16 v28, v128, v128, 0
    v_dot2_f32_f16 v30, v152, v152, 0
    v_dot2_f32_f16 v27, v128, s58, 0
    v_dot2_f32_f16 v29, v152, s58, 0
    v_dot2_f32_f16 v28, v129, v129, v28
    v_dot2_f32_f16 v30, v153, v153, v30
    v_dot2_f32_f16 v27, v129, s58, v27
    v_dot2_f32_f16 v29, v153, s58, v29
    v_dot2_f32_f16 v28, v130, v130, v28
    v_dot2_f32_f16 v30, v154, v154, v30
    v_dot2_f32_f16 v27, v130, s58, v27
    v_dot2_f32_f16 v29, v154, s58, v29
    v_dot2_f32_f16 v28, v131, v131, v28
    v_dot2_f32_f16 v30, v155, v155, v30
    v_dot2_f32_f16 v27, v131, s58, v27
    v_dot2_f32_f16 v29, v155, s58, v29
    v_dot2_f32_f16 v28, v132, v132, v28
    v_dot2_f32_f16 v30, v156, v156, v30
    v_dot2_f32_f16 v27, v132, s58, v27
    v_dot2_f32_f16 v29, v156, s58, v29
    v_dot2_f32_f16 v28, v133, v133, v28
    v_dot2_f32_f16 v30, v157, v157, v30
    v_dot2_f32_f16 v27, v133, s58, v27
    v_dot2_f32_f16 v29, v157, s58, v29
    v_cvt_pkrtz_f16_f32 v134, v224, v225
    v_cvt_pkrtz_f16_f32 v158, v228, v229
    v_cvt_pkrtz_f16_f32 v135, v226, v227
    v_mfma_f32_16x16x32_bf16 v[136:139], v[192:195], a[232:235], 0
    s_add_u32 m0, s56, 3968
    buffer_store_dwordx4 v[80:83], v26, s[24:27], s82 offen offset:0 sc0 sc1
    buffer_load_dwordx4 v5, s[20:23], 0 offen offset:128 lds
    s_waitcnt lgkmcnt(14)
    ds_read_b128 a[232:235], v10 offset:6400
    buffer_store_dwordx4 v[84:87], v26, s[24:27], s83 offen offset:0 sc0 sc1
    s_waitcnt lgkmcnt(14)
    ds_read_b128 v[212:215], v20 offset:8960
    v_mfma_f32_16x16x32_bf16 v[160:163], v[192:195], a[244:247], 0
    s_add_u32 m0, s56, 4992
    s_waitcnt lgkmcnt(14)
    ds_read_b128 a[244:247], v10 offset:8960
    buffer_load_dwordx4 v6, s[20:23], 0 offen offset:128 lds
    s_waitcnt lgkmcnt(14)
    ds_read_b128 v[192:195], v22 offset:1536
    v_cvt_pkrtz_f16_f32 v159, v230, v231
    v_cvt_pk_bf16_f32 v96, v96, v97
    v_cvt_pk_bf16_f32 v97, v98, v99
    v_cvt_pk_bf16_f32 v98, v100, v101
    v_cvt_pk_bf16_f32 v99, v102, v103
    v_cvt_pk_bf16_f32 v100, v104, v105
    v_cvt_pk_bf16_f32 v101, v106, v107
    v_cvt_pk_bf16_f32 v102, v108, v109
    v_cvt_pk_bf16_f32 v103, v110, v111
    s_waitcnt lgkmcnt(4)
    v_mfma_f32_32x32x16_bf16 v[80:95], a[224:227], v[52:55], v[32:47]
    s_add_u32 m0, s56, 6016
    v_permlane16_swap_b32 v96, v100
    v_permlane16_swap_b32 v97, v101
    v_permlane16_swap_b32 v98, v102
    v_smfmac_f32_16x16x64_bf16 v[136:139], v[200:203], a[236:243], v16
    buffer_load_dword v7, s[20:23], 0 offen offset:128 lds
    ds_read_b128 a[236:239], v14 offset:6400
    ds_read_b128 a[240:243], v12 offset:7680
    ds_read_b128 v[208:211], v20 offset:6400
    v_smfmac_f32_16x16x64_bf16 v[160:163], v[200:203], a[248:255], v16
    ds_read_b128 a[248:251], v14 offset:8960
    ds_read_b128 a[252:255], v12 offset:10240
    ds_read_b128 v[200:203], v22 offset:1552
    v_mfma_f32_32x32x16_bf16 v[32:47], a[224:227], v[48:51], v[32:47]
    v_permlane16_swap_b32 v99, v103
    v_cvt_pkrtz_f16_f32 v136, v136, v137
    v_cvt_pkrtz_f16_f32 v137, v138, v139
    v_cvt_pk_bf16_f32 v112, v112, v113
    v_cvt_pkrtz_f16_f32 v160, v160, v161
    v_mfma_f32_16x16x32_bf16 v[224:227], v[196:199], v[176:179], 0
    ds_read_b128 v[176:179], v11 offset:6400
    ds_read_b128 v[220:223], v21 offset:8960
    v_mfma_f32_16x16x32_bf16 v[228:231], v[196:199], v[188:191], 0
    ds_read_b128 v[188:191], v11 offset:8960
    ds_read_b128 v[196:199], v22 offset:1792
    v_mfma_f32_32x32x16_bf16 v[80:95], a[228:231], v[60:63], v[80:95]
    v_cvt_pkrtz_f16_f32 v161, v162, v163
    v_cvt_pk_bf16_f32 v113, v114, v115
    v_cvt_pk_bf16_f32 v114, v116, v117
    v_cvt_pk_bf16_f32 v115, v118, v119
    v_cvt_pk_bf16_f32 v116, v120, v121
    v_cvt_pk_bf16_f32 v117, v122, v123
    v_smfmac_f32_16x16x64_bf16 v[224:227], v[204:207], v[180:187], v16
    s_waitcnt lgkmcnt(1)
    ds_read_b128 v[180:183], v15 offset:6400
    ds_read_b128 v[184:187], v13 offset:7680
    ds_read_b128 v[216:219], v21 offset:6400
    v_smfmac_f32_16x16x64_bf16 v[228:231], v[204:207], v[232:239], v16
    ds_read_b128 v[232:235], v15 offset:8960
    ds_read_b128 v[236:239], v13 offset:10240
    ds_read_b128 v[204:207], v22 offset:1808
    v_mfma_f32_32x32x16_bf16 v[32:47], a[228:231], v[56:59], v[32:47]
    v_cvt_pk_bf16_f32 v118, v124, v125
    v_cvt_pk_bf16_f32 v119, v126, v127
    v_permlane16_swap_b32 v112, v116
    v_permlane16_swap_b32 v113, v117
    v_mfma_f32_16x16x32_bf16 v[140:143], v[192:195], a[232:235], 0
    v_permlane16_swap_b32 v114, v118
    v_mfma_f32_16x16x32_bf16 v[164:167], v[192:195], a[244:247], 0
    ds_read_b128 v[192:195], v22 offset:2048
    v_permlane16_swap_b32 v115, v119
    v_cvt_pkrtz_f16_f32 v138, v224, v225
    v_cvt_pkrtz_f16_f32 v162, v228, v229
    v_smfmac_f32_16x16x64_bf16 v[140:143], v[200:203], a[236:243], v16
    v_cvt_pkrtz_f16_f32 v139, v226, v227
    v_smfmac_f32_16x16x64_bf16 v[164:167], v[200:203], a[248:255], v16
    s_waitcnt lgkmcnt(7)
    ds_read_b128 v[200:203], v22 offset:2064
    v_cvt_pkrtz_f16_f32 v163, v230, v231
    v_dot2_f32_f16 v28, v134, v134, v28
    v_dot2_f32_f16 v30, v158, v158, v30
    v_dot2_f32_f16 v27, v134, s58, v27
    v_dot2_f32_f16 v29, v158, s58, v29
    v_dot2_f32_f16 v28, v135, v135, v28
    v_dot2_f32_f16 v30, v159, v159, v30
    v_dot2_f32_f16 v27, v135, s58, v27
    v_dot2_f32_f16 v29, v159, s58, v29
    v_dot2_f32_f16 v28, v136, v136, v28
    v_dot2_f32_f16 v30, v160, v160, v30
    v_dot2_f32_f16 v27, v136, s58, v27
    v_dot2_f32_f16 v29, v160, s58, v29
    v_dot2_f32_f16 v28, v137, v137, v28
    v_dot2_f32_f16 v30, v161, v161, v30
    v_dot2_f32_f16 v27, v137, s58, v27
    v_dot2_f32_f16 v29, v161, s58, v29
    v_dot2_f32_f16 v28, v138, v138, v28
    v_dot2_f32_f16 v30, v162, v162, v30
    v_dot2_f32_f16 v27, v138, s58, v27
    v_dot2_f32_f16 v29, v162, s58, v29
    v_dot2_f32_f16 v28, v139, v139, v28
    v_dot2_f32_f16 v30, v163, v163, v30
    v_dot2_f32_f16 v27, v139, s58, v27
    v_dot2_f32_f16 v29, v163, s58, v29
    v_cvt_pkrtz_f16_f32 v140, v140, v141
    v_cvt_pkrtz_f16_f32 v164, v164, v165
    v_cvt_pkrtz_f16_f32 v141, v142, v143
    v_mfma_f32_16x16x32_bf16 v[224:227], v[196:199], v[176:179], 0
    buffer_store_dwordx4 v[96:99], v26, s[24:27], s82 offen offset:64 sc0 sc1
    v_cvt_pkrtz_f16_f32 v165, v166, v167
    v_mfma_f32_16x16x32_bf16 v[228:231], v[196:199], v[188:191], 0
    s_waitcnt lgkmcnt(2)
    ds_read_b128 v[196:199], v22 offset:2304
    s_nop 0
    v_smfmac_f32_16x16x64_bf16 v[224:227], v[204:207], v[180:187], v16
    s_nop 1
    v_smfmac_f32_16x16x64_bf16 v[228:231], v[204:207], v[232:239], v16
    s_waitcnt lgkmcnt(1)
    ds_read_b128 v[204:207], v22 offset:2320
    s_nop 2
    v_cvt_pkrtz_f16_f32 v142, v224, v225
    v_cvt_pkrtz_f16_f32 v143, v226, v227
    v_dot2_f32_f16 v28, v140, v140, v28
    v_cvt_pkrtz_f16_f32 v166, v228, v229
    v_cvt_pkrtz_f16_f32 v167, v230, v231
    v_dot2_f32_f16 v30, v164, v164, v30
    v_dot2_f32_f16 v27, v140, s58, v27
    v_dot2_f32_f16 v29, v164, s58, v29
    v_dot2_f32_f16 v28, v141, v141, v28
    v_dot2_f32_f16 v30, v165, v165, v30
    v_dot2_f32_f16 v27, v141, s58, v27
    v_dot2_f32_f16 v29, v165, s58, v29
    v_dot2_f32_f16 v28, v142, v142, v28
    v_dot2_f32_f16 v30, v166, v166, v30
    v_dot2_f32_f16 v27, v142, s58, v27
    v_dot2_f32_f16 v29, v166, s58, v29
    v_dot2_f32_f16 v28, v143, v143, v28
    v_dot2_f32_f16 v30, v167, v167, v30
    v_dot2_f32_f16 v27, v143, s58, v27
    v_dot2_f32_f16 v29, v167, s58, v29
    s_waitcnt vmcnt(1)
    ds_read_b128 a[232:235], v8 offset:0
    ds_read_b128 a[244:247], v8 offset:2560
    ds_read_b128 a[236:239], v12 offset:0
    ds_read_b128 a[240:243], v14 offset:1280
    ds_read_b128 a[248:251], v12 offset:2560
    ds_read_b128 a[252:255], v14 offset:3840
    ds_read_b128 v[176:179], v9 offset:0
    ds_read_b128 v[188:191], v9 offset:2560
    ds_read_b128 v[180:183], v13 offset:0
    ds_read_b128 v[184:187], v15 offset:1280
    ds_read_b128 v[232:235], v13 offset:2560
    ds_read_b128 v[236:239], v15 offset:3840
    s_waitcnt lgkmcnt(11)
    v_mfma_f32_16x16x32_bf16 v[144:147], v[192:195], a[232:235], 0
    s_waitcnt lgkmcnt(10)
    ds_read_b128 a[232:235], v10 offset:0
    buffer_store_dwordx4 v[100:103], v26, s[24:27], s83 offen offset:64 sc0 sc1
    v_mfma_f32_16x16x32_bf16 v[168:171], v[192:195], a[244:247], 0
    s_waitcnt lgkmcnt(10)
    ds_read_b128 a[244:247], v10 offset:2560
    ds_read_b128 v[192:195], v22 offset:2560
    s_waitcnt lgkmcnt(11)
    v_smfmac_f32_16x16x64_bf16 v[144:147], v[200:203], a[236:243], v16
    s_waitcnt lgkmcnt(10)
    ds_read_b128 a[236:239], v14 offset:0
    ds_read_b128 a[240:243], v12 offset:1280
    s_waitcnt lgkmcnt(11)
    v_smfmac_f32_16x16x64_bf16 v[168:171], v[200:203], a[248:255], v16
    ds_read_b128 a[248:251], v14 offset:2560
    ds_read_b128 a[252:255], v12 offset:3840
    ds_read_b128 v[200:203], v22 offset:2576
    s_waitcnt lgkmcnt(13)
    v_mfma_f32_16x16x32_bf16 v[224:227], v[196:199], v[176:179], 0
    s_waitcnt lgkmcnt(12)
    ds_read_b128 v[176:179], v11 offset:0
    buffer_store_dwordx4 v[112:115], v26, s[24:27], s82 offen offset:128 sc0 sc1
    ds_read_b128 v[48:51], v25 offset:128
    v_mfma_f32_16x16x32_bf16 v[228:231], v[196:199], v[188:191], 0
    s_waitcnt lgkmcnt(1)
    ds_read_b128 v[188:191], v11 offset:2560
    ds_read_b128 v[196:199], v22 offset:2816
    ds_read_b128 v[52:55], v25 offset:160
    v_cvt_pkrtz_f16_f32 v144, v144, v145
    v_smfmac_f32_16x16x64_bf16 v[224:227], v[204:207], v[180:187], v16
    ds_read_b128 v[180:183], v15 offset:0
    ds_read_b128 v[184:187], v13 offset:1280
    ds_read_b128 v[56:59], v25 offset:192
    v_cvt_pkrtz_f16_f32 v168, v168, v169
    v_cvt_pkrtz_f16_f32 v145, v146, v147
    v_cvt_pkrtz_f16_f32 v169, v170, v171
    v_smfmac_f32_16x16x64_bf16 v[228:231], v[204:207], v[232:239], v16
    ds_read_b128 v[232:235], v15 offset:2560
    ds_read_b128 v[236:239], v13 offset:3840
    ds_read_b128 v[204:207], v22 offset:2832
    ds_read_b128 v[60:63], v25 offset:224
    v_cvt_pkrtz_f16_f32 v146, v224, v225
    v_dot2_f32_f16 v28, v144, v144, v28
    v_dot2_f32_f16 v30, v168, v168, v30
    v_dot2_f32_f16 v27, v144, s58, v27
    v_dot2_f32_f16 v29, v168, s58, v29
    v_dot2_f32_f16 v28, v145, v145, v28
    v_dot2_f32_f16 v30, v169, v169, v30
    v_dot2_f32_f16 v27, v145, s58, v27
    v_dot2_f32_f16 v29, v169, s58, v29
    v_cvt_pkrtz_f16_f32 v170, v228, v229
    v_cvt_pkrtz_f16_f32 v147, v226, v227
    v_cvt_pkrtz_f16_f32 v171, v230, v231
    v_mfma_f32_16x16x32_bf16 v[148:151], v[192:195], a[232:235], 0
    buffer_store_dwordx4 v[116:119], v26, s[24:27], s83 offen offset:128 sc0 sc1
    ds_read_b128 v[64:67], v25 offset:256
    v_mfma_f32_16x16x32_bf16 v[172:175], v[192:195], a[244:247], 0
    ds_read_b128 v[68:71], v25 offset:288
    s_nop 1
    v_smfmac_f32_16x16x64_bf16 v[148:151], v[200:203], a[236:243], v16
    ds_read_b128 v[72:75], v25 offset:320
    s_nop 0
    v_smfmac_f32_16x16x64_bf16 v[172:175], v[200:203], a[248:255], v16
    s_waitcnt lgkmcnt(13)
    ds_read_b128 v[76:79], v25 offset:352
    s_nop 2
    v_cvt_pkrtz_f16_f32 v148, v148, v149
    v_cvt_pkrtz_f16_f32 v149, v150, v151
    s_nop 0
    v_cvt_pkrtz_f16_f32 v172, v172, v173
    v_cvt_pkrtz_f16_f32 v173, v174, v175
    s_waitcnt lgkmcnt(12)
    v_mfma_f32_16x16x32_bf16 v[224:227], v[196:199], v[176:179], 0
    s_waitcnt lgkmcnt(6)
    ds_read_b128 a[232:235], v23 offset:1024
    ds_read_b128 a[236:239], v23 offset:2048
    v_mfma_f32_16x16x32_bf16 v[228:231], v[196:199], v[188:191], 0
    s_add_u32 s80, s80, 786432
    ds_read_b128 a[240:243], v23 offset:4096
    ds_read_b128 a[244:247], v23 offset:5120
    s_add_u32 s81, s81, 786432
    s_add_u32 s82, s82, 786432
    s_add_u32 s83, s83, 786432
    s_waitcnt lgkmcnt(9)
    v_smfmac_f32_16x16x64_bf16 v[224:227], v[204:207], v[180:187], v16
    ds_read_b128 a[248:251], v23 offset:11264
    v_smfmac_f32_16x16x64_bf16 v[228:231], v[204:207], v[232:239], v16
    ds_read_b128 a[252:255], v23 offset:12288
L_mid:
    s_cmp_eq_u32 s52, 3
    s_cselect_b32 s57, 0x40000000, 786432
    v_add_u32 v1, s57, v1
    v_add_u32 v2, s57, v2
    v_add_u32 v3, s57, v3
    v_cvt_pkrtz_f16_f32 v150, v224, v225
    v_cvt_pkrtz_f16_f32 v151, v226, v227
    v_cvt_pkrtz_f16_f32 v174, v228, v229
    v_cvt_pkrtz_f16_f32 v175, v230, v231
    v_add_u32 v4, s57, v4
    v_add_u32 v5, s57, v5
    v_add_u32 v6, s57, v6
    v_add_u32 v7, s57, v7
    v_add_u32 v31, s57, v31
    v_dot2_f32_f16 v28, v146, v146, v28
    v_dot2_f32_f16 v30, v170, v170, v30
    v_dot2_f32_f16 v27, v146, s58, v27
    v_dot2_f32_f16 v29, v170, s58, v29
    v_dot2_f32_f16 v28, v147, v147, v28
    v_dot2_f32_f16 v30, v171, v171, v30
    v_dot2_f32_f16 v27, v147, s58, v27
    v_dot2_f32_f16 v29, v171, s58, v29
    v_dot2_f32_f16 v28, v148, v148, v28
    v_dot2_f32_f16 v30, v172, v172, v30
    v_dot2_f32_f16 v27, v148, s58, v27
    v_dot2_f32_f16 v29, v172, s58, v29
    v_dot2_f32_f16 v28, v149, v149, v28
    v_dot2_f32_f16 v30, v173, v173, v30
    v_dot2_f32_f16 v27, v149, s58, v27
    v_dot2_f32_f16 v29, v173, s58, v29
    v_dot2_f32_f16 v28, v150, v150, v28
    v_dot2_f32_f16 v30, v174, v174, v30
    v_dot2_f32_f16 v27, v150, s58, v27
    v_dot2_f32_f16 v29, v174, s58, v29
    v_dot2_f32_f16 v28, v151, v151, v28
    v_dot2_f32_f16 v30, v175, v175, v30
    v_dot2_f32_f16 v27, v151, s58, v27
    v_dot2_f32_f16 v29, v175, s58, v29
    s_nop 1
    v_permlane32_swap_b32 v27, v28
    s_waitcnt lgkmcnt(10)
    v_mfma_f32_32x32x16_bf16 v[96:111], a[224:227], v[212:215], v[48:63]
    ds_read_b128 v[236:239], v20 offset:2560
    ds_read_b128 v[232:235], v20 offset:0
    v_permlane32_swap_b32 v29, v30
    v_add_f32 v27, v27, v28
    v_add_f32 v29, v29, v30
    v_mfma_f32_32x32x16_bf16 v[48:63], a[224:227], v[208:211], v[48:63]
    ds_read_b128 v[244:247], v21 offset:2560
    ds_read_b128 v[240:243], v21 offset:0
    v_mov_b32 v28, v27
    v_mov_b32 v30, v29
    s_nop 0
    v_permlane32_swap_b32 v27, v28
    v_mfma_f32_32x32x16_bf16 v[96:111], a[228:231], v[220:223], v[96:111]
    v_permlane32_swap_b32 v29, v30
    v_mul_f32 v27, 0x3c2aaaab, v27
    v_mul_f32 v29, 0x3c2aaaab, v29
    v_mul_f32 v28, 0x3c2aaaab, v28
    v_mul_f32 v30, 0x3c2aaaab, v30
    v_mfma_f32_32x32x16_bf16 v[48:63], a[228:231], v[216:219], v[48:63]
    v_fma_f32 v28, -v27, v27, v28
    v_fma_f32 v30, -v29, v29, v30
    v_max_f32 v28, 0, v28
    v_max_f32 v30, 0, v30
    v_add_f32 v28, 0x3727c5ac, v28
    v_add_f32 v30, 0x3727c5ac, v30
    v_rsq_f32 v28, v28
    v_rsq_f32 v30, v30
    v_fma_mixlo_f16 v28, v28, s59, 0
    v_fma_mixlo_f16 v30, v30, s59, 0
    v_fma_mixhi_f16 v28, -v27, v28, 0 op_sel_hi:[0,1,0]
    v_fma_mixhi_f16 v30, -v29, v30, 0 op_sel_hi:[0,1,0]
    v_pk_fma_f16 v128, v128, v28, v28 op_sel:[0,0,1] op_sel_hi:[1,0,1]
    v_pk_fma_f16 v129, v129, v28, v28 op_sel:[0,0,1] op_sel_hi:[1,0,1]
    v_pk_fma_f16 v130, v130, v28, v28 op_sel:[0,0,1] op_sel_hi:[1,0,1]
    v_pk_fma_f16 v131, v131, v28, v28 op_sel:[0,0,1] op_sel_hi:[1,0,1]
    v_pk_fma_f16 v132, v132, v28, v28 op_sel:[0,0,1] op_sel_hi:[1,0,1]
    v_pk_fma_f16 v133, v133, v28, v28 op_sel:[0,0,1] op_sel_hi:[1,0,1]
    v_mfma_f32_32x32x16_f16 v[176:191], a[192:195], v[128:131], 0
    s_waitcnt lgkmcnt(9)
    v_pk_fma_f16 v134, v134, v28, v28 op_sel:[0,0,1] op_sel_hi:[1,0,1]
    v_pk_fma_f16 v135, v135, v28, v28 op_sel:[0,0,1] op_sel_hi:[1,0,1]
    v_pk_fma_f16 v136, v136, v28, v28 op_sel:[0,0,1] op_sel_hi:[1,0,1]
    v_pk_fma_f16 v137, v137, v28, v28 op_sel:[0,0,1] op_sel_hi:[1,0,1]
    v_pk_fma_f16 v138, v138, v28, v28 op_sel:[0,0,1] op_sel_hi:[1,0,1]
    v_pk_fma_f16 v139, v139, v28, v28 op_sel:[0,0,1] op_sel_hi:[1,0,1]
    v_mfma_f32_32x32x16_f16 v[176:191], a[232:235], v[132:135], v[176:191]
    s_waitcnt lgkmcnt(8)
    v_pk_fma_f16 v140, v140, v28, v28 op_sel:[0,0,1] op_sel_hi:[1,0,1]
    v_pk_fma_f16 v141, v141, v28, v28 op_sel:[0,0,1] op_sel_hi:[1,0,1]
    v_pk_fma_f16 v142, v142, v28, v28 op_sel:[0,0,1] op_sel_hi:[1,0,1]
    v_pk_fma_f16 v143, v143, v28, v28 op_sel:[0,0,1] op_sel_hi:[1,0,1]
    v_pk_fma_f16 v144, v144, v28, v28 op_sel:[0,0,1] op_sel_hi:[1,0,1]
    v_pk_fma_f16 v145, v145, v28, v28 op_sel:[0,0,1] op_sel_hi:[1,0,1]
    v_mfma_f32_32x32x16_f16 v[176:191], a[236:239], v[136:139], v[176:191]
    v_pk_fma_f16 v146, v146, v28, v28 op_sel:[0,0,1] op_sel_hi:[1,0,1]
    v_pk_fma_f16 v147, v147, v28, v28 op_sel:[0,0,1] op_sel_hi:[1,0,1]
    v_pk_fma_f16 v151, v151, v28, v28 op_sel:[0,0,1] op_sel_hi:[1,0,1]
    v_pk_fma_f16 v148, v148, v28, v28 op_sel:[0,0,1] op_sel_hi:[1,0,1]
    v_pk_fma_f16 v149, v149, v28, v28 op_sel:[0,0,1] op_sel_hi:[1,0,1]
    v_bfi_b32 v151, v17, v151, s84
    v_mfma_f32_32x32x16_f16 v[176:191], a[196:199], v[140:143], v[176:191]
    s_waitcnt lgkmcnt(7)
    v_pk_fma_f16 v150, v150, v28, v28 op_sel:[0,0,1] op_sel_hi:[1,0,1]
    v_pk_fma_f16 v152, v152, v30, v30 op_sel:[0,0,1] op_sel_hi:[1,0,1]
    v_pk_fma_f16 v153, v153, v30, v30 op_sel:[0,0,1] op_sel_hi:[1,0,1]
    v_pk_fma_f16 v154, v154, v30, v30 op_sel:[0,0,1] op_sel_hi:[1,0,1]
    v_pk_fma_f16 v155, v155, v30, v30 op_sel:[0,0,1] op_sel_hi:[1,0,1]
    v_pk_fma_f16 v156, v156, v30, v30 op_sel:[0,0,1] op_sel_hi:[1,0,1]
    v_mfma_f32_32x32x16_f16 v[176:191], a[240:243], v[144:147], v[176:191]
    s_waitcnt lgkmcnt(6)
    v_pk_fma_f16 v157, v157, v30, v30 op_sel:[0,0,1] op_sel_hi:[1,0,1]
    v_pk_fma_f16 v158, v158, v30, v30 op_sel:[0,0,1] op_sel_hi:[1,0,1]
    v_pk_fma_f16 v159, v159, v30, v30 op_sel:[0,0,1] op_sel_hi:[1,0,1]
    v_pk_fma_f16 v160, v160, v30, v30 op_sel:[0,0,1] op_sel_hi:[1,0,1]
    v_pk_fma_f16 v161, v161, v30, v30 op_sel:[0,0,1] op_sel_hi:[1,0,1]
    v_pk_fma_f16 v162, v162, v30, v30 op_sel:[0,0,1] op_sel_hi:[1,0,1]
    v_mfma_f32_32x32x16_f16 v[176:191], a[244:247], v[148:151], v[176:191]
    v_pk_fma_f16 v163, v163, v30, v30 op_sel:[0,0,1] op_sel_hi:[1,0,1]
    v_pk_fma_f16 v164, v164, v30, v30 op_sel:[0,0,1] op_sel_hi:[1,0,1]
    v_pk_fma_f16 v165, v165, v30, v30 op_sel:[0,0,1] op_sel_hi:[1,0,1]
    v_pk_fma_f16 v166, v166, v30, v30 op_sel:[0,0,1] op_sel_hi:[1,0,1]
    v_pk_fma_f16 v167, v167, v30, v30 op_sel:[0,0,1] op_sel_hi:[1,0,1]
    v_pk_fma_f16 v168, v168, v30, v30 op_sel:[0,0,1] op_sel_hi:[1,0,1]
    v_mfma_f32_32x32x16_f16 v[192:207], a[192:195], v[152:155], 0
    v_pk_fma_f16 v169, v169, v30, v30 op_sel:[0,0,1] op_sel_hi:[1,0,1]
    v_pk_fma_f16 v170, v170, v30, v30 op_sel:[0,0,1] op_sel_hi:[1,0,1]
    v_pk_fma_f16 v171, v171, v30, v30 op_sel:[0,0,1] op_sel_hi:[1,0,1]
    v_pk_fma_f16 v175, v175, v30, v30 op_sel:[0,0,1] op_sel_hi:[1,0,1]
    v_pk_fma_f16 v172, v172, v30, v30 op_sel:[0,0,1] op_sel_hi:[1,0,1]
    v_pk_fma_f16 v173, v173, v30, v30 op_sel:[0,0,1] op_sel_hi:[1,0,1]
    v_mfma_f32_32x32x16_f16 v[192:207], a[232:235], v[156:159], v[192:207]
    ds_read_b128 a[232:235], v23 offset:14336
    v_bfi_b32 v175, v17, v175, s84
    v_pk_fma_f16 v174, v174, v30, v30 op_sel:[0,0,1] op_sel_hi:[1,0,1]
    v_cvt_pkrtz_f16_f32 v208, v176, v177
    v_cvt_pkrtz_f16_f32 v209, v178, v179
    v_cvt_pkrtz_f16_f32 v210, v180, v181
    v_mfma_f32_32x32x16_f16 v[192:207], a[236:239], v[160:163], v[192:207]
    ds_read_b128 a[236:239], v23 offset:15360
    v_cvt_pkrtz_f16_f32 v211, v182, v183
    v_cvt_pkrtz_f16_f32 v212, v184, v185
    v_cvt_pkrtz_f16_f32 v213, v186, v187
    v_cvt_pkrtz_f16_f32 v214, v188, v189
    v_cvt_pkrtz_f16_f32 v215, v190, v191
    v_mfma_f32_32x32x16_f16 v[192:207], a[196:199], v[164:167], v[192:207]
    v_pk_lshrrev_b16 v216, 3, v208 op_sel_hi:[0,1]
    v_pk_lshrrev_b16 v217, 3, v209 op_sel_hi:[0,1]
    v_pk_lshrrev_b16 v218, 3, v210 op_sel_hi:[0,1]
    v_pk_lshrrev_b16 v219, 3, v211 op_sel_hi:[0,1]
    v_pk_lshrrev_b16 v220, 3, v212 op_sel_hi:[0,1]
    v_mad_u32_u16 v224, v216, 2, s85
    v_mfma_f32_32x32x16_f16 v[192:207], a[240:243], v[168:171], v[192:207]
    ds_read_u16 v224, v224
    ds_read_b128 a[240:243], v23 offset:6144
    v_mad_u32_u16 v216, v216, 2, s85 op_sel:[1,0,0,0]
    v_mad_u32_u16 v225, v217, 2, s85
    v_mad_u32_u16 v217, v217, 2, s85 op_sel:[1,0,0,0]
    v_mad_u32_u16 v226, v218, 2, s85
    v_mfma_f32_32x32x16_f16 v[192:207], a[244:247], v[172:175], v[192:207]
    s_waitcnt lgkmcnt(6)
    ds_read_u16_d16_hi v216, v216
    ds_read_u16 v225, v225
    ds_read_u16_d16_hi v217, v217
    v_mad_u32_u16 v218, v218, 2, s85 op_sel:[1,0,0,0]
    v_mad_u32_u16 v227, v219, 2, s85
    v_mad_u32_u16 v219, v219, 2, s85 op_sel:[1,0,0,0]
    v_mfma_f32_32x32x16_bf16 v[112:127], a[224:227], v[236:239], v[64:79]
    s_add_u32 m0, s56, 6336
    ds_read_u16 v226, v226
    ds_read_b128 a[244:247], v23 offset:8192
    ds_read_u16_d16_hi v218, v218
    v_mad_u32_u16 v228, v220, 2, s85
    v_mad_u32_u16 v220, v220, 2, s85 op_sel:[1,0,0,0]
    v_pk_fma_f16 v221, v213, v213, s53
    v_mfma_f32_32x32x16_bf16 v[64:79], a[224:227], v[232:235], v[64:79]
    s_waitcnt lgkmcnt(11)
    ds_read_u16 v227, v227
    ds_read_u16_d16_hi v219, v219
    buffer_load_dwordx4 v1, s[20:23], 0 offen offset:64 lds
    v_pk_fma_f16 v222, v214, v214, s53
    v_pk_fma_f16 v223, v215, v215, s53
    v_mfma_f32_32x32x16_bf16 v[112:127], a[228:231], v[244:247], v[112:127]
    s_waitcnt lgkmcnt(12)
    ds_read_u16 v228, v228
    ds_read_u16_d16_hi v220, v220
    v_pk_mul_f16 v221, v221, v213 neg_lo:[1,0] neg_hi:[1,0]
    v_pk_mul_f16 v222, v222, v214 neg_lo:[1,0] neg_hi:[1,0]
    v_pk_mul_f16 v223, v223, v215 neg_lo:[1,0] neg_hi:[1,0]
    v_exp_f16 v229, v221
    v_mfma_f32_32x32x16_bf16 v[64:79], a[228:231], v[240:243], v[64:79]
    v_exp_f16 v230, v222
    v_exp_f16 v231, v223
    v_exp_f16_sdwa v229, v221 dst_sel:WORD_1 dst_unused:UNUSED_PRESERVE src0_sel:WORD_1
    v_mfma_f32_32x32x16_f16 v[176:191], a[200:203], v[128:131], 0
    s_waitcnt lgkmcnt(7)
    v_exp_f16_sdwa v230, v222 dst_sel:WORD_1 dst_unused:UNUSED_PRESERVE src0_sel:WORD_1
    v_exp_f16_sdwa v231, v223 dst_sel:WORD_1 dst_unused:UNUSED_PRESERVE src0_sel:WORD_1
    v_pk_add_f16 v229, v229, 1.0 op_sel_hi:[1,0]
    v_pk_add_f16 v230, v230, 1.0 op_sel_hi:[1,0]
    v_pk_add_f16 v231, v231, 1.0 op_sel_hi:[1,0]
    v_rcp_f16 v221, v229
    v_rcp_f16 v222, v230
    v_rcp_f16 v223, v231
    v_rcp_f16_sdwa v221, v229 dst_sel:WORD_1 dst_unused:UNUSED_PRESERVE src0_sel:WORD_1
    v_rcp_f16_sdwa v222, v230 dst_sel:WORD_1 dst_unused:UNUSED_PRESERVE src0_sel:WORD_1
    v_rcp_f16_sdwa v223, v231 dst_sel:WORD_1 dst_unused:UNUSED_PRESERVE src0_sel:WORD_1
    v_or_b32 v232, v224, v216
    v_or_b32 v233, v225, v217
    s_waitcnt lgkmcnt(4)
    v_or_b32 v234, v226, v218
    v_pk_mul_f16 v237, v221, v213
    v_pk_mul_f16 v238, v222, v214
    v_pk_mul_f16 v239, v223, v215
    v_cvt_pkrtz_f16_f32 v208, v192, v193
    v_cvt_pkrtz_f16_f32 v209, v194, v195
    s_waitcnt lgkmcnt(2)
    v_or_b32 v235, v227, v219
    v_cvt_pkrtz_f16_f32 v210, v196, v197
    v_cvt_pkrtz_f16_f32 v211, v198, v199
    v_cvt_pkrtz_f16_f32 v212, v200, v201
    v_cvt_pkrtz_f16_f32 v213, v202, v203
    v_cvt_pkrtz_f16_f32 v214, v204, v205
    v_cvt_pkrtz_f16_f32 v215, v206, v207
    v_mfma_f32_32x32x16_f16 v[192:207], a[200:203], v[152:155], 0
    v_pk_lshrrev_b16 v216, 3, v208 op_sel_hi:[0,1]
    v_pk_lshrrev_b16 v217, 3, v209 op_sel_hi:[0,1]
    v_pk_lshrrev_b16 v218, 3, v210 op_sel_hi:[0,1]
    v_pk_lshrrev_b16 v219, 3, v211 op_sel_hi:[0,1]
    v_mad_u32_u16 v224, v216, 2, s85
    v_mad_u32_u16 v216, v216, 2, s85 op_sel:[1,0,0,0]
    v_mfma_f32_32x32x16_f16 v[176:191], a[248:251], v[132:135], v[176:191]
    s_waitcnt lgkmcnt(0)
    ds_read_u16 v224, v224
    ds_read_u16_d16_hi v216, v216
    v_or_b32 v236, v228, v220
    v_pk_lshrrev_b16 v220, 3, v212 op_sel_hi:[0,1]
    v_mad_u32_u16 v225, v217, 2, s85
    v_mad_u32_u16 v217, v217, 2, s85 op_sel:[1,0,0,0]
    v_mfma_f32_32x32x16_f16 v[192:207], a[248:251], v[156:159], v[192:207]
    ds_read_b128 a[248:251], v23 offset:0
    ds_read_u16 v225, v225
    v_mad_u32_u16 v226, v218, 2, s85
    v_mad_u32_u16 v218, v218, 2, s85 op_sel:[1,0,0,0]
    v_mad_u32_u16 v227, v219, 2, s85
    v_mad_u32_u16 v219, v219, 2, s85 op_sel:[1,0,0,0]
    v_mfma_f32_32x32x16_f16 v[176:191], a[252:255], v[136:139], v[176:191]
    ds_read_u16_d16_hi v217, v217
    v_mad_u32_u16 v228, v220, 2, s85
    v_mad_u32_u16 v220, v220, 2, s85 op_sel:[1,0,0,0]
    v_pk_fma_f16 v221, v213, v213, s53
    v_pk_fma_f16 v222, v214, v214, s53
    v_pk_fma_f16 v223, v215, v215, s53
    v_mfma_f32_32x32x16_f16 v[192:207], a[252:255], v[160:163], v[192:207]
    ds_read_b128 a[252:255], v23 offset:7168
    ds_read_u16 v226, v226
    v_pk_mul_f16 v221, v221, v213 neg_lo:[1,0] neg_hi:[1,0]
    v_pk_mul_f16 v222, v222, v214 neg_lo:[1,0] neg_hi:[1,0]
    v_pk_mul_f16 v223, v223, v215 neg_lo:[1,0] neg_hi:[1,0]
    v_exp_f16 v229, v221
    v_mfma_f32_32x32x16_f16 v[176:191], a[204:207], v[140:143], v[176:191]
    s_add_u32 m0, s56, 7360
    ds_read_u16_d16_hi v218, v218
    buffer_load_dwordx4 v2, s[20:23], 0 offen offset:64 lds
    v_exp_f16 v230, v222
    v_exp_f16 v231, v223
    v_mfma_f32_32x32x16_f16 v[192:207], a[204:207], v[164:167], v[192:207]
    ds_read_u16 v227, v227
    v_exp_f16_sdwa v229, v221 dst_sel:WORD_1 dst_unused:UNUSED_PRESERVE src0_sel:WORD_1
    v_exp_f16_sdwa v230, v222 dst_sel:WORD_1 dst_unused:UNUSED_PRESERVE src0_sel:WORD_1
    v_exp_f16_sdwa v231, v223 dst_sel:WORD_1 dst_unused:UNUSED_PRESERVE src0_sel:WORD_1
    v_mfma_f32_32x32x16_f16 v[176:191], a[232:235], v[144:147], v[176:191]
    ds_read_u16_d16_hi v219, v219
    v_pk_add_f16 v229, v229, 1.0 op_sel_hi:[1,0]
    v_pk_add_f16 v230, v230, 1.0 op_sel_hi:[1,0]
    v_pk_add_f16 v231, v231, 1.0 op_sel_hi:[1,0]
    v_rcp_f16 v221, v229
    v_mfma_f32_32x32x16_f16 v[192:207], a[232:235], v[168:171], v[192:207]
    ds_read_b128 a[232:235], v23 offset:9216
    ds_read_u16 v228, v228
    v_rcp_f16 v222, v230
    v_rcp_f16 v223, v231
    v_mfma_f32_32x32x16_f16 v[176:191], a[236:239], v[148:151], v[176:191]
    ds_read_u16_d16_hi v220, v220
    v_rcp_f16_sdwa v221, v229 dst_sel:WORD_1 dst_unused:UNUSED_PRESERVE src0_sel:WORD_1
    v_rcp_f16_sdwa v222, v230 dst_sel:WORD_1 dst_unused:UNUSED_PRESERVE src0_sel:WORD_1
    v_rcp_f16_sdwa v223, v231 dst_sel:WORD_1 dst_unused:UNUSED_PRESERVE src0_sel:WORD_1
    v_mfma_f32_32x32x16_f16 v[192:207], a[236:239], v[172:175], v[192:207]
    s_waitcnt lgkmcnt(3)
    ds_read_b128 a[236:239], v23 offset:3072
    v_or_b32 v240, v224, v216
    v_or_b32 v241, v225, v217
    v_or_b32 v242, v226, v218
    v_or_b32 v243, v227, v219
    v_pk_mul_f16 v245, v221, v213
    v_mfma_f32_32x32x16_f16 v[32:47], a[240:243], v[232:235], v[32:47]
    v_pk_mul_f16 v246, v222, v214
    v_pk_mul_f16 v247, v223, v215
    v_cvt_pkrtz_f16_f32 v208, v176, v177
    v_cvt_pkrtz_f16_f32 v209, v178, v179
    v_cvt_pkrtz_f16_f32 v210, v180, v181
    v_cvt_pkrtz_f16_f32 v211, v182, v183
    v_mfma_f32_32x32x16_f16 v[80:95], a[240:243], v[240:243], v[80:95]
    s_waitcnt lgkmcnt(2)
    ds_read_b128 a[240:243], v23 offset:21504
    v_cvt_pkrtz_f16_f32 v212, v184, v185
    v_cvt_pkrtz_f16_f32 v213, v186, v187
    s_waitcnt lgkmcnt(2)
    v_or_b32 v244, v228, v220
    v_cvt_pkrtz_f16_f32 v214, v188, v189
    v_cvt_pkrtz_f16_f32 v215, v190, v191
    v_mfma_f32_32x32x16_f16 v[48:63], a[244:247], v[232:235], v[48:63]
    v_pk_lshrrev_b16 v216, 3, v208 op_sel_hi:[0,1]
    v_pk_lshrrev_b16 v217, 3, v209 op_sel_hi:[0,1]
    v_pk_lshrrev_b16 v218, 3, v210 op_sel_hi:[0,1]
    v_pk_lshrrev_b16 v219, 3, v211 op_sel_hi:[0,1]
    v_pk_lshrrev_b16 v220, 3, v212 op_sel_hi:[0,1]
    v_mad_u32_u16 v224, v216, 2, s85
    v_mfma_f32_32x32x16_f16 v[96:111], a[244:247], v[240:243], v[96:111]
    ds_read_u16 v224, v224
    ds_read_b128 a[244:247], v23 offset:22528
    v_mad_u32_u16 v216, v216, 2, s85 op_sel:[1,0,0,0]
    v_mad_u32_u16 v225, v217, 2, s85
    v_mad_u32_u16 v217, v217, 2, s85 op_sel:[1,0,0,0]
    v_mad_u32_u16 v226, v218, 2, s85
    v_mfma_f32_32x32x16_f16 v[64:79], a[248:251], v[232:235], v[64:79]
    ds_read_u16_d16_hi v216, v216
    ds_read_u16 v225, v225
    ds_read_u16_d16_hi v217, v217
    v_mad_u32_u16 v218, v218, 2, s85 op_sel:[1,0,0,0]
    v_mad_u32_u16 v227, v219, 2, s85
    v_mad_u32_u16 v219, v219, 2, s85 op_sel:[1,0,0,0]
    v_mfma_f32_32x32x16_f16 v[112:127], a[248:251], v[240:243], v[112:127]
    ds_read_b128 a[248:251], v23 offset:24576
    ds_read_u16 v226, v226
    v_mad_u32_u16 v228, v220, 2, s85
    v_mad_u32_u16 v220, v220, 2, s85 op_sel:[1,0,0,0]
    v_pk_fma_f16 v221, v213, v213, s53
    v_pk_fma_f16 v222, v214, v214, s53
    v_mfma_f32_32x32x16_f16 v[32:47], a[252:255], v[236:239], v[32:47]
    s_add_u32 m0, s56, 8384
    ds_read_u16_d16_hi v218, v218
    buffer_load_dwordx4 v3, s[20:23], 0 offen offset:64 lds
    v_pk_fma_f16 v223, v215, v215, s53
    v_pk_mul_f16 v221, v221, v213 neg_lo:[1,0] neg_hi:[1,0]
    v_pk_mul_f16 v222, v222, v214 neg_lo:[1,0] neg_hi:[1,0]
    v_mfma_f32_32x32x16_f16 v[80:95], a[252:255], v[244:247], v[80:95]
    ds_read_b128 a[252:255], v23 offset:25600
    ds_read_u16 v227, v227
    v_pk_mul_f16 v223, v223, v215 neg_lo:[1,0] neg_hi:[1,0]
    v_exp_f16 v229, v221
    v_exp_f16 v230, v222
    v_mfma_f32_32x32x16_f16 v[48:63], a[232:235], v[236:239], v[48:63]
    ds_read_u16_d16_hi v219, v219
    v_exp_f16 v231, v223
    v_exp_f16_sdwa v229, v221 dst_sel:WORD_1 dst_unused:UNUSED_PRESERVE src0_sel:WORD_1
    v_exp_f16_sdwa v230, v222 dst_sel:WORD_1 dst_unused:UNUSED_PRESERVE src0_sel:WORD_1
    v_mfma_f32_32x32x16_f16 v[96:111], a[232:235], v[244:247], v[96:111]
    s_waitcnt lgkmcnt(12)
    ds_read_b128 a[232:235], v23 offset:16384
    ds_read_u16 v228, v228
    v_exp_f16_sdwa v231, v223 dst_sel:WORD_1 dst_unused:UNUSED_PRESERVE src0_sel:WORD_1
    v_pk_add_f16 v229, v229, 1.0 op_sel_hi:[1,0]
    v_pk_add_f16 v230, v230, 1.0 op_sel_hi:[1,0]
    v_mfma_f32_32x32x16_f16 v[64:79], a[236:239], v[236:239], v[64:79]
    s_waitcnt lgkmcnt(13)
    ds_read_u16_d16_hi v220, v220
    v_pk_add_f16 v231, v231, 1.0 op_sel_hi:[1,0]
    v_rcp_f16 v221, v229
    v_rcp_f16 v222, v230
    v_mfma_f32_32x32x16_f16 v[112:127], a[236:239], v[244:247], v[112:127]
    s_waitcnt lgkmcnt(13)
    ds_read_b128 a[236:239], v23 offset:18432
    v_rcp_f16 v223, v231
    v_rcp_f16_sdwa v221, v229 dst_sel:WORD_1 dst_unused:UNUSED_PRESERVE src0_sel:WORD_1
    v_rcp_f16_sdwa v222, v230 dst_sel:WORD_1 dst_unused:UNUSED_PRESERVE src0_sel:WORD_1
    v_mfma_f32_32x32x16_f16 v[176:191], a[208:211], v[128:131], 0
    s_waitcnt lgkmcnt(5)
    v_rcp_f16_sdwa v223, v231 dst_sel:WORD_1 dst_unused:UNUSED_PRESERVE src0_sel:WORD_1
    v_or_b32 v232, v224, v216
    v_or_b32 v233, v225, v217
    v_or_b32 v234, v226, v218
    s_waitcnt lgkmcnt(4)
    v_or_b32 v235, v227, v219
    v_pk_mul_f16 v237, v221, v213
    v_pk_mul_f16 v238, v222, v214
    v_pk_mul_f16 v239, v223, v215
    v_cvt_pkrtz_f16_f32 v208, v192, v193
    v_cvt_pkrtz_f16_f32 v209, v194, v195
    v_cvt_pkrtz_f16_f32 v210, v196, v197
    v_cvt_pkrtz_f16_f32 v211, v198, v199
    v_cvt_pkrtz_f16_f32 v212, v200, v201
    v_cvt_pkrtz_f16_f32 v213, v202, v203
    v_cvt_pkrtz_f16_f32 v214, v204, v205
    v_cvt_pkrtz_f16_f32 v215, v206, v207
    v_mfma_f32_32x32x16_f16 v[192:207], a[208:211], v[152:155], 0
    s_waitcnt lgkmcnt(2)
    v_pk_lshrrev_b16 v216, 3, v208 op_sel_hi:[0,1]
    v_pk_lshrrev_b16 v217, 3, v209 op_sel_hi:[0,1]
    v_pk_lshrrev_b16 v218, 3, v210 op_sel_hi:[0,1]
    v_pk_lshrrev_b16 v219, 3, v211 op_sel_hi:[0,1]
    v_mad_u32_u16 v224, v216, 2, s85
    s_waitcnt lgkmcnt(1)
    v_or_b32 v236, v228, v220
    v_mfma_f32_32x32x16_f16 v[176:191], a[240:243], v[132:135], v[176:191]
    ds_read_u16 v224, v224
    v_pk_lshrrev_b16 v220, 3, v212 op_sel_hi:[0,1]
    v_mad_u32_u16 v216, v216, 2, s85 op_sel:[1,0,0,0]
    v_mad_u32_u16 v225, v217, 2, s85
    v_mad_u32_u16 v217, v217, 2, s85 op_sel:[1,0,0,0]
    v_mad_u32_u16 v226, v218, 2, s85
    v_mfma_f32_32x32x16_f16 v[192:207], a[240:243], v[156:159], v[192:207]
    ds_read_u16_d16_hi v216, v216
    ds_read_b128 a[240:243], v23 offset:10240
    ds_read_u16 v225, v225
    v_mad_u32_u16 v218, v218, 2, s85 op_sel:[1,0,0,0]
    v_mad_u32_u16 v227, v219, 2, s85
    v_mad_u32_u16 v219, v219, 2, s85 op_sel:[1,0,0,0]
    v_mfma_f32_32x32x16_f16 v[176:191], a[244:247], v[136:139], v[176:191]
    ds_read_u16_d16_hi v217, v217
    v_mad_u32_u16 v228, v220, 2, s85
    v_mad_u32_u16 v220, v220, 2, s85 op_sel:[1,0,0,0]
    v_pk_fma_f16 v221, v213, v213, s53
    v_pk_fma_f16 v222, v214, v214, s53
    v_pk_fma_f16 v223, v215, v215, s53
    v_mfma_f32_32x32x16_f16 v[192:207], a[244:247], v[160:163], v[192:207]
    ds_read_b128 a[244:247], v23 offset:17408
    ds_read_u16 v226, v226
    v_pk_mul_f16 v221, v221, v213 neg_lo:[1,0] neg_hi:[1,0]
    v_pk_mul_f16 v222, v222, v214 neg_lo:[1,0] neg_hi:[1,0]
    v_pk_mul_f16 v223, v223, v215 neg_lo:[1,0] neg_hi:[1,0]
    v_exp_f16 v229, v221
    v_mfma_f32_32x32x16_f16 v[176:191], a[212:215], v[140:143], v[176:191]
    s_add_u32 m0, s56, 9408
    ds_read_u16_d16_hi v218, v218
    buffer_load_dwordx4 v4, s[20:23], 0 offen offset:64 lds
    v_exp_f16 v230, v222
    v_exp_f16 v231, v223
    v_mfma_f32_32x32x16_f16 v[192:207], a[212:215], v[164:167], v[192:207]
    ds_read_u16 v227, v227
    v_exp_f16_sdwa v229, v221 dst_sel:WORD_1 dst_unused:UNUSED_PRESERVE src0_sel:WORD_1
    v_exp_f16_sdwa v230, v222 dst_sel:WORD_1 dst_unused:UNUSED_PRESERVE src0_sel:WORD_1
    v_exp_f16_sdwa v231, v223 dst_sel:WORD_1 dst_unused:UNUSED_PRESERVE src0_sel:WORD_1
    v_mfma_f32_32x32x16_f16 v[176:191], a[248:251], v[144:147], v[176:191]
    ds_read_u16_d16_hi v219, v219
    v_pk_add_f16 v229, v229, 1.0 op_sel_hi:[1,0]
    v_pk_add_f16 v230, v230, 1.0 op_sel_hi:[1,0]
    v_pk_add_f16 v231, v231, 1.0 op_sel_hi:[1,0]
    v_rcp_f16 v221, v229
    v_mfma_f32_32x32x16_f16 v[192:207], a[248:251], v[168:171], v[192:207]
    ds_read_b128 a[248:251], v23 offset:19456
    ds_read_u16 v228, v228
    v_rcp_f16 v222, v230
    v_rcp_f16 v223, v231
    v_mfma_f32_32x32x16_f16 v[176:191], a[252:255], v[148:151], v[176:191]
    ds_read_u16_d16_hi v220, v220
    v_rcp_f16_sdwa v221, v229 dst_sel:WORD_1 dst_unused:UNUSED_PRESERVE src0_sel:WORD_1
    v_rcp_f16_sdwa v222, v230 dst_sel:WORD_1 dst_unused:UNUSED_PRESERVE src0_sel:WORD_1
    v_rcp_f16_sdwa v223, v231 dst_sel:WORD_1 dst_unused:UNUSED_PRESERVE src0_sel:WORD_1
    v_mfma_f32_32x32x16_f16 v[192:207], a[252:255], v[172:175], v[192:207]
    s_waitcnt lgkmcnt(3)
    ds_read_b128 a[252:255], v23 offset:13312
    v_or_b32 v240, v224, v216
    v_or_b32 v241, v225, v217
    v_or_b32 v242, v226, v218
    v_or_b32 v243, v227, v219
    v_pk_mul_f16 v245, v221, v213
    v_mfma_f32_32x32x16_f16 v[32:47], a[232:235], v[232:235], v[32:47]
    v_pk_mul_f16 v246, v222, v214
    v_pk_mul_f16 v247, v223, v215
    v_cvt_pkrtz_f16_f32 v208, v176, v177
    v_cvt_pkrtz_f16_f32 v209, v178, v179
    v_cvt_pkrtz_f16_f32 v210, v180, v181
    v_cvt_pkrtz_f16_f32 v211, v182, v183
    v_mfma_f32_32x32x16_f16 v[80:95], a[232:235], v[240:243], v[80:95]
    s_waitcnt lgkmcnt(2)
    ds_read_b128 a[232:235], v23 offset:31744
    v_cvt_pkrtz_f16_f32 v212, v184, v185
    v_cvt_pkrtz_f16_f32 v213, v186, v187
    v_cvt_pkrtz_f16_f32 v214, v188, v189
    s_waitcnt lgkmcnt(2)
    v_or_b32 v244, v228, v220
    v_cvt_pkrtz_f16_f32 v215, v190, v191
    v_mfma_f32_32x32x16_f16 v[48:63], a[236:239], v[232:235], v[48:63]
    v_pk_lshrrev_b16 v216, 3, v208 op_sel_hi:[0,1]
    v_pk_lshrrev_b16 v217, 3, v209 op_sel_hi:[0,1]
    v_pk_lshrrev_b16 v218, 3, v210 op_sel_hi:[0,1]
    v_pk_lshrrev_b16 v219, 3, v211 op_sel_hi:[0,1]
    v_pk_lshrrev_b16 v220, 3, v212 op_sel_hi:[0,1]
    v_mad_u32_u16 v224, v216, 2, s85
    v_mfma_f32_32x32x16_f16 v[96:111], a[236:239], v[240:243], v[96:111]
    ds_read_u16 v224, v224
    ds_read_b128 a[236:239], v23 offset:32768
    v_mad_u32_u16 v216, v216, 2, s85 op_sel:[1,0,0,0]
    v_mad_u32_u16 v225, v217, 2, s85
    v_mad_u32_u16 v217, v217, 2, s85 op_sel:[1,0,0,0]
    v_mad_u32_u16 v226, v218, 2, s85
    v_mfma_f32_32x32x16_f16 v[64:79], a[240:243], v[232:235], v[64:79]
    ds_read_u16_d16_hi v216, v216
    ds_read_u16 v225, v225
    ds_read_u16_d16_hi v217, v217
    v_mad_u32_u16 v218, v218, 2, s85 op_sel:[1,0,0,0]
    v_mad_u32_u16 v227, v219, 2, s85
    v_mad_u32_u16 v219, v219, 2, s85 op_sel:[1,0,0,0]
    v_mfma_f32_32x32x16_f16 v[112:127], a[240:243], v[240:243], v[112:127]
    ds_read_b128 a[240:243], v23 offset:34816
    ds_read_u16 v226, v226
    v_mad_u32_u16 v228, v220, 2, s85
    v_mad_u32_u16 v220, v220, 2, s85 op_sel:[1,0,0,0]
    v_pk_fma_f16 v221, v213, v213, s53
    v_pk_fma_f16 v222, v214, v214, s53
    v_mfma_f32_32x32x16_f16 v[32:47], a[244:247], v[236:239], v[32:47]
    s_add_u32 m0, s56, 10432
    ds_read_u16_d16_hi v218, v218
    buffer_load_dwordx4 v5, s[20:23], 0 offen offset:64 lds
    v_pk_fma_f16 v223, v215, v215, s53
    v_pk_mul_f16 v221, v221, v213 neg_lo:[1,0] neg_hi:[1,0]
    v_pk_mul_f16 v222, v222, v214 neg_lo:[1,0] neg_hi:[1,0]
    v_mfma_f32_32x32x16_f16 v[80:95], a[244:247], v[244:247], v[80:95]
    ds_read_b128 a[244:247], v23 offset:35840
    ds_read_u16 v227, v227
    v_pk_mul_f16 v223, v223, v215 neg_lo:[1,0] neg_hi:[1,0]
    v_exp_f16 v229, v221
    v_exp_f16 v230, v222
    v_mfma_f32_32x32x16_f16 v[48:63], a[248:251], v[236:239], v[48:63]
    ds_read_u16_d16_hi v219, v219
    v_exp_f16 v231, v223
    v_exp_f16_sdwa v229, v221 dst_sel:WORD_1 dst_unused:UNUSED_PRESERVE src0_sel:WORD_1
    v_exp_f16_sdwa v230, v222 dst_sel:WORD_1 dst_unused:UNUSED_PRESERVE src0_sel:WORD_1
    v_mfma_f32_32x32x16_f16 v[96:111], a[248:251], v[244:247], v[96:111]
    s_waitcnt lgkmcnt(12)
    ds_read_b128 a[248:251], v23 offset:26624
    ds_read_u16 v228, v228
    v_exp_f16_sdwa v231, v223 dst_sel:WORD_1 dst_unused:UNUSED_PRESERVE src0_sel:WORD_1
    v_pk_add_f16 v229, v229, 1.0 op_sel_hi:[1,0]
    v_pk_add_f16 v230, v230, 1.0 op_sel_hi:[1,0]
    v_mfma_f32_32x32x16_f16 v[64:79], a[252:255], v[236:239], v[64:79]
    s_waitcnt lgkmcnt(13)
    ds_read_u16_d16_hi v220, v220
    v_pk_add_f16 v231, v231, 1.0 op_sel_hi:[1,0]
    v_rcp_f16 v221, v229
    v_rcp_f16 v222, v230
    v_mfma_f32_32x32x16_f16 v[112:127], a[252:255], v[244:247], v[112:127]
    s_waitcnt lgkmcnt(13)
    ds_read_b128 a[252:255], v23 offset:28672
    v_rcp_f16 v223, v231
    v_rcp_f16_sdwa v221, v229 dst_sel:WORD_1 dst_unused:UNUSED_PRESERVE src0_sel:WORD_1
    v_rcp_f16_sdwa v222, v230 dst_sel:WORD_1 dst_unused:UNUSED_PRESERVE src0_sel:WORD_1
    v_mfma_f32_32x32x16_f16 v[176:191], a[216:219], v[128:131], 0
    s_waitcnt lgkmcnt(5)
    v_rcp_f16_sdwa v223, v231 dst_sel:WORD_1 dst_unused:UNUSED_PRESERVE src0_sel:WORD_1
    v_or_b32 v232, v224, v216
    v_or_b32 v233, v225, v217
    v_or_b32 v234, v226, v218
    s_waitcnt lgkmcnt(4)
    v_or_b32 v235, v227, v219
    v_pk_mul_f16 v237, v221, v213
    v_pk_mul_f16 v238, v222, v214
    v_pk_mul_f16 v239, v223, v215
    v_cvt_pkrtz_f16_f32 v208, v192, v193
    v_cvt_pkrtz_f16_f32 v209, v194, v195
    v_cvt_pkrtz_f16_f32 v210, v196, v197
    v_cvt_pkrtz_f16_f32 v211, v198, v199
    v_cvt_pkrtz_f16_f32 v212, v200, v201
    v_cvt_pkrtz_f16_f32 v213, v202, v203
    v_cvt_pkrtz_f16_f32 v214, v204, v205
    v_cvt_pkrtz_f16_f32 v215, v206, v207
    v_mfma_f32_32x32x16_f16 v[192:207], a[216:219], v[152:155], 0
    s_waitcnt lgkmcnt(2)
    v_pk_lshrrev_b16 v216, 3, v208 op_sel_hi:[0,1]
    v_pk_lshrrev_b16 v217, 3, v209 op_sel_hi:[0,1]
    v_pk_lshrrev_b16 v218, 3, v210 op_sel_hi:[0,1]
    v_pk_lshrrev_b16 v219, 3, v211 op_sel_hi:[0,1]
    v_mad_u32_u16 v224, v216, 2, s85
    s_waitcnt lgkmcnt(1)
    v_or_b32 v236, v228, v220
    v_mfma_f32_32x32x16_f16 v[176:191], a[232:235], v[132:135], v[176:191]
    ds_read_u16 v224, v224
    v_pk_lshrrev_b16 v220, 3, v212 op_sel_hi:[0,1]
    v_mad_u32_u16 v216, v216, 2, s85 op_sel:[1,0,0,0]
    v_mad_u32_u16 v225, v217, 2, s85
    v_mad_u32_u16 v217, v217, 2, s85 op_sel:[1,0,0,0]
    v_mad_u32_u16 v226, v218, 2, s85
    v_mfma_f32_32x32x16_f16 v[192:207], a[232:235], v[156:159], v[192:207]
    ds_read_u16_d16_hi v216, v216
    ds_read_b128 a[232:235], v23 offset:20480
    ds_read_u16 v225, v225
    v_mad_u32_u16 v218, v218, 2, s85 op_sel:[1,0,0,0]
    v_mad_u32_u16 v227, v219, 2, s85
    v_mad_u32_u16 v219, v219, 2, s85 op_sel:[1,0,0,0]
    v_mfma_f32_32x32x16_f16 v[176:191], a[236:239], v[136:139], v[176:191]
    ds_read_u16_d16_hi v217, v217
    v_mad_u32_u16 v228, v220, 2, s85
    v_mad_u32_u16 v220, v220, 2, s85 op_sel:[1,0,0,0]
    v_pk_fma_f16 v221, v213, v213, s53
    v_pk_fma_f16 v222, v214, v214, s53
    v_pk_fma_f16 v223, v215, v215, s53
    v_mfma_f32_32x32x16_f16 v[192:207], a[236:239], v[160:163], v[192:207]
    ds_read_b128 a[236:239], v23 offset:27648
    ds_read_u16 v226, v226
    v_pk_mul_f16 v221, v221, v213 neg_lo:[1,0] neg_hi:[1,0]
    v_pk_mul_f16 v222, v222, v214 neg_lo:[1,0] neg_hi:[1,0]
    v_pk_mul_f16 v223, v223, v215 neg_lo:[1,0] neg_hi:[1,0]
    v_exp_f16 v229, v221
    v_mfma_f32_32x32x16_f16 v[176:191], a[220:223], v[140:143], v[176:191]
    s_add_u32 m0, s56, 11456
    ds_read_u16_d16_hi v218, v218
    buffer_load_dwordx4 v6, s[20:23], 0 offen offset:64 lds
    v_exp_f16 v230, v222
    v_exp_f16 v231, v223
    v_mfma_f32_32x32x16_f16 v[192:207], a[220:223], v[164:167], v[192:207]
    ds_read_u16 v227, v227
    v_exp_f16_sdwa v229, v221 dst_sel:WORD_1 dst_unused:UNUSED_PRESERVE src0_sel:WORD_1
    v_exp_f16_sdwa v230, v222 dst_sel:WORD_1 dst_unused:UNUSED_PRESERVE src0_sel:WORD_1
    v_exp_f16_sdwa v231, v223 dst_sel:WORD_1 dst_unused:UNUSED_PRESERVE src0_sel:WORD_1
    v_mfma_f32_32x32x16_f16 v[176:191], a[240:243], v[144:147], v[176:191]
    ds_read_u16_d16_hi v219, v219
    v_pk_add_f16 v229, v229, 1.0 op_sel_hi:[1,0]
    v_pk_add_f16 v230, v230, 1.0 op_sel_hi:[1,0]
    v_pk_add_f16 v231, v231, 1.0 op_sel_hi:[1,0]
    v_rcp_f16 v221, v229
    v_mfma_f32_32x32x16_f16 v[192:207], a[240:243], v[168:171], v[192:207]
    ds_read_b128 a[240:243], v23 offset:29696
    ds_read_u16 v228, v228
    v_rcp_f16 v222, v230
    v_rcp_f16 v223, v231
    v_mfma_f32_32x32x16_f16 v[176:191], a[244:247], v[148:151], v[176:191]
    ds_read_u16_d16_hi v220, v220
    v_rcp_f16_sdwa v221, v229 dst_sel:WORD_1 dst_unused:UNUSED_PRESERVE src0_sel:WORD_1
    v_rcp_f16_sdwa v222, v230 dst_sel:WORD_1 dst_unused:UNUSED_PRESERVE src0_sel:WORD_1
    v_rcp_f16_sdwa v223, v231 dst_sel:WORD_1 dst_unused:UNUSED_PRESERVE src0_sel:WORD_1
    v_mfma_f32_32x32x16_f16 v[192:207], a[244:247], v[172:175], v[192:207]
    s_waitcnt lgkmcnt(3)
    ds_read_b128 a[244:247], v23 offset:23552
    v_or_b32 v240, v224, v216
    v_or_b32 v241, v225, v217
    v_or_b32 v242, v226, v218
    v_or_b32 v243, v227, v219
    v_pk_mul_f16 v245, v221, v213
    v_mfma_f32_32x32x16_f16 v[32:47], a[248:251], v[232:235], v[32:47]
    v_pk_mul_f16 v246, v222, v214
    v_pk_mul_f16 v247, v223, v215
    v_cvt_pkrtz_f16_f32 v208, v176, v177
    v_cvt_pkrtz_f16_f32 v209, v178, v179
    v_cvt_pkrtz_f16_f32 v210, v180, v181
    v_cvt_pkrtz_f16_f32 v211, v182, v183
    v_mfma_f32_32x32x16_f16 v[80:95], a[248:251], v[240:243], v[80:95]
    s_waitcnt lgkmcnt(2)
    ds_read_b128 a[248:251], v24 offset:0
    v_cvt_pkrtz_f16_f32 v212, v184, v185
    v_cvt_pkrtz_f16_f32 v213, v186, v187
    v_cvt_pkrtz_f16_f32 v214, v188, v189
    s_waitcnt lgkmcnt(2)
    v_or_b32 v244, v228, v220
    v_cvt_pkrtz_f16_f32 v215, v190, v191
    v_mfma_f32_32x32x16_f16 v[48:63], a[252:255], v[232:235], v[48:63]
    v_pk_lshrrev_b16 v216, 3, v208 op_sel_hi:[0,1]
    v_pk_lshrrev_b16 v217, 3, v209 op_sel_hi:[0,1]
    v_pk_lshrrev_b16 v218, 3, v210 op_sel_hi:[0,1]
    v_pk_lshrrev_b16 v219, 3, v211 op_sel_hi:[0,1]
    v_pk_lshrrev_b16 v220, 3, v212 op_sel_hi:[0,1]
    v_mad_u32_u16 v224, v216, 2, s85
    v_mfma_f32_32x32x16_f16 v[96:111], a[252:255], v[240:243], v[96:111]
    ds_read_u16 v224, v224
    ds_read_b128 a[252:255], v24 offset:1024
    v_mad_u32_u16 v216, v216, 2, s85 op_sel:[1,0,0,0]
    v_mad_u32_u16 v225, v217, 2, s85
    v_mad_u32_u16 v217, v217, 2, s85 op_sel:[1,0,0,0]
    v_mad_u32_u16 v226, v218, 2, s85
    v_mfma_f32_32x32x16_f16 v[64:79], a[232:235], v[232:235], v[64:79]
    ds_read_u16_d16_hi v216, v216
    ds_read_u16 v225, v225
    ds_read_u16_d16_hi v217, v217
    v_mad_u32_u16 v218, v218, 2, s85 op_sel:[1,0,0,0]
    v_mad_u32_u16 v227, v219, 2, s85
    v_mad_u32_u16 v219, v219, 2, s85 op_sel:[1,0,0,0]
    v_mfma_f32_32x32x16_f16 v[112:127], a[232:235], v[240:243], v[112:127]
    ds_read_b128 a[232:235], v24 offset:2048
    ds_read_u16 v226, v226
    v_mad_u32_u16 v228, v220, 2, s85
    v_mad_u32_u16 v220, v220, 2, s85 op_sel:[1,0,0,0]
    v_pk_fma_f16 v221, v213, v213, s53
    v_pk_fma_f16 v222, v214, v214, s53
    v_mfma_f32_32x32x16_f16 v[32:47], a[236:239], v[236:239], v[32:47]
    s_add_u32 m0, s56, 12480
    ds_read_u16_d16_hi v218, v218
    buffer_load_dword v7, s[20:23], 0 offen offset:64 lds
    v_pk_fma_f16 v223, v215, v215, s53
    v_pk_mul_f16 v221, v221, v213 neg_lo:[1,0] neg_hi:[1,0]
    v_pk_mul_f16 v222, v222, v214 neg_lo:[1,0] neg_hi:[1,0]
    v_mfma_f32_32x32x16_f16 v[80:95], a[236:239], v[244:247], v[80:95]
    ds_read_b128 a[236:239], v24 offset:3072
    ds_read_u16 v227, v227
    v_pk_mul_f16 v223, v223, v215 neg_lo:[1,0] neg_hi:[1,0]
    v_exp_f16 v229, v221
    v_exp_f16 v230, v222
    v_mfma_f32_32x32x16_f16 v[48:63], a[240:243], v[236:239], v[48:63]
    ds_read_u16_d16_hi v219, v219
    v_exp_f16 v231, v223
    v_exp_f16_sdwa v229, v221 dst_sel:WORD_1 dst_unused:UNUSED_PRESERVE src0_sel:WORD_1
    v_exp_f16_sdwa v230, v222 dst_sel:WORD_1 dst_unused:UNUSED_PRESERVE src0_sel:WORD_1
    v_mfma_f32_32x32x16_f16 v[96:111], a[240:243], v[244:247], v[96:111]
    s_waitcnt lgkmcnt(12)
    ds_read_b128 a[240:243], v24 offset:4096
    ds_read_u16 v228, v228
    v_exp_f16_sdwa v231, v223 dst_sel:WORD_1 dst_unused:UNUSED_PRESERVE src0_sel:WORD_1
    v_pk_add_f16 v229, v229, 1.0 op_sel_hi:[1,0]
    v_pk_add_f16 v230, v230, 1.0 op_sel_hi:[1,0]
    v_mfma_f32_32x32x16_f16 v[64:79], a[244:247], v[236:239], v[64:79]
    s_waitcnt lgkmcnt(13)
    ds_read_u16_d16_hi v220, v220
    v_pk_add_f16 v231, v231, 1.0 op_sel_hi:[1,0]
    v_rcp_f16 v221, v229
    v_rcp_f16 v222, v230
    v_mfma_f32_32x32x16_f16 v[112:127], a[244:247], v[244:247], v[112:127]
    s_waitcnt lgkmcnt(13)
    ds_read_b128 a[244:247], v24 offset:5120
    v_rcp_f16 v223, v231
    v_rcp_f16_sdwa v221, v229 dst_sel:WORD_1 dst_unused:UNUSED_PRESERVE src0_sel:WORD_1
    v_rcp_f16_sdwa v222, v230 dst_sel:WORD_1 dst_unused:UNUSED_PRESERVE src0_sel:WORD_1
    v_mfma_f32_32x32x16_f16 v[176:191], a[248:251], v[128:131], 0
    s_waitcnt lgkmcnt(5)
    v_rcp_f16_sdwa v223, v231 dst_sel:WORD_1 dst_unused:UNUSED_PRESERVE src0_sel:WORD_1
    v_or_b32 v232, v224, v216
    v_or_b32 v233, v225, v217
    v_or_b32 v234, v226, v218
    s_waitcnt lgkmcnt(4)
    v_or_b32 v235, v227, v219
    v_pk_mul_f16 v237, v221, v213
    v_pk_mul_f16 v238, v222, v214
    v_pk_mul_f16 v239, v223, v215
    v_cvt_pkrtz_f16_f32 v208, v192, v193
    v_cvt_pkrtz_f16_f32 v209, v194, v195
    v_cvt_pkrtz_f16_f32 v210, v196, v197
    v_cvt_pkrtz_f16_f32 v211, v198, v199
    v_cvt_pkrtz_f16_f32 v212, v200, v201
    v_cvt_pkrtz_f16_f32 v213, v202, v203
    v_cvt_pkrtz_f16_f32 v214, v204, v205
    v_cvt_pkrtz_f16_f32 v215, v206, v207
    v_mfma_f32_32x32x16_f16 v[192:207], a[248:251], v[152:155], 0
    s_waitcnt lgkmcnt(2)
    ds_read_b128 a[248:251], v23 offset:36864
    v_pk_lshrrev_b16 v216, 3, v208 op_sel_hi:[0,1]
    v_pk_lshrrev_b16 v217, 3, v209 op_sel_hi:[0,1]
    v_pk_lshrrev_b16 v218, 3, v210 op_sel_hi:[0,1]
    v_pk_lshrrev_b16 v219, 3, v211 op_sel_hi:[0,1]
    s_waitcnt lgkmcnt(2)
    v_or_b32 v236, v228, v220
    v_mfma_f32_32x32x16_f16 v[176:191], a[252:255], v[132:135], v[176:191]
    v_pk_lshrrev_b16 v220, 3, v212 op_sel_hi:[0,1]
    v_mad_u32_u16 v224, v216, 2, s85
    v_mad_u32_u16 v216, v216, 2, s85 op_sel:[1,0,0,0]
    v_mad_u32_u16 v225, v217, 2, s85
    v_mad_u32_u16 v217, v217, 2, s85 op_sel:[1,0,0,0]
    v_mad_u32_u16 v226, v218, 2, s85
    v_mfma_f32_32x32x16_f16 v[192:207], a[252:255], v[156:159], v[192:207]
    ds_read_u16 v224, v224
    ds_read_u16_d16_hi v216, v216
    ds_read_b128 a[252:255], v23 offset:38912
    v_mad_u32_u16 v218, v218, 2, s85 op_sel:[1,0,0,0]
    v_mad_u32_u16 v227, v219, 2, s85
    v_mad_u32_u16 v219, v219, 2, s85 op_sel:[1,0,0,0]
    v_mfma_f32_32x32x16_f16 v[176:191], a[232:235], v[136:139], v[176:191]
    ds_read_u16 v225, v225
    ds_read_u16_d16_hi v217, v217
    v_mad_u32_u16 v228, v220, 2, s85
    v_mad_u32_u16 v220, v220, 2, s85 op_sel:[1,0,0,0]
    v_pk_fma_f16 v221, v213, v213, s53
    v_pk_fma_f16 v222, v214, v214, s53
    v_mfma_f32_32x32x16_f16 v[192:207], a[232:235], v[160:163], v[192:207]
    ds_read_b128 a[232:235], v23 offset:30720
    ds_read_u16 v226, v226
    v_pk_fma_f16 v223, v215, v215, s53
    v_pk_mul_f16 v221, v221, v213 neg_lo:[1,0] neg_hi:[1,0]
    v_pk_mul_f16 v222, v222, v214 neg_lo:[1,0] neg_hi:[1,0]
    v_pk_mul_f16 v223, v223, v215 neg_lo:[1,0] neg_hi:[1,0]
    v_mfma_f32_32x32x16_f16 v[176:191], a[236:239], v[140:143], v[176:191]
    s_add_u32 m0, s56, 0
    ds_read_u16_d16_hi v218, v218
    buffer_load_dwordx4 v1, s[20:23], 0 offen offset:0 lds
    v_exp_f16 v229, v221
    v_exp_f16 v230, v222
    v_mfma_f32_32x32x16_f16 v[192:207], a[236:239], v[164:167], v[192:207]
    ds_read_b128 a[236:239], v23 offset:37888
    ds_read_u16 v227, v227
    v_exp_f16 v231, v223
    v_exp_f16_sdwa v229, v221 dst_sel:WORD_1 dst_unused:UNUSED_PRESERVE src0_sel:WORD_1
    v_mfma_f32_32x32x16_f16 v[176:191], a[240:243], v[144:147], v[176:191]
    ds_read_u16_d16_hi v219, v219
    v_exp_f16_sdwa v230, v222 dst_sel:WORD_1 dst_unused:UNUSED_PRESERVE src0_sel:WORD_1
    v_exp_f16_sdwa v231, v223 dst_sel:WORD_1 dst_unused:UNUSED_PRESERVE src0_sel:WORD_1
    v_pk_add_f16 v229, v229, 1.0 op_sel_hi:[1,0]
    v_mfma_f32_32x32x16_f16 v[192:207], a[240:243], v[168:171], v[192:207]
    s_waitcnt lgkmcnt(12)
    ds_read_b128 a[240:243], v23 offset:39936
    ds_read_u16 v228, v228
    v_pk_add_f16 v230, v230, 1.0 op_sel_hi:[1,0]
    v_pk_add_f16 v231, v231, 1.0 op_sel_hi:[1,0]
    v_rcp_f16 v221, v229
    v_mfma_f32_32x32x16_f16 v[176:191], a[244:247], v[148:151], v[176:191]
    s_waitcnt lgkmcnt(13)
    ds_read_u16_d16_hi v220, v220
    v_rcp_f16 v222, v230
    v_rcp_f16 v223, v231
    v_rcp_f16_sdwa v221, v229 dst_sel:WORD_1 dst_unused:UNUSED_PRESERVE src0_sel:WORD_1
    v_mfma_f32_32x32x16_f16 v[192:207], a[244:247], v[172:175], v[192:207]
    s_waitcnt lgkmcnt(12)
    ds_read_b128 a[244:247], v23 offset:33792
    v_rcp_f16_sdwa v222, v230 dst_sel:WORD_1 dst_unused:UNUSED_PRESERVE src0_sel:WORD_1
    v_rcp_f16_sdwa v223, v231 dst_sel:WORD_1 dst_unused:UNUSED_PRESERVE src0_sel:WORD_1
    v_or_b32 v240, v224, v216
    v_mfma_f32_32x32x16_f16 v[32:47], a[248:251], v[232:235], v[32:47]
    s_waitcnt lgkmcnt(5)
    v_or_b32 v241, v225, v217
    v_or_b32 v242, v226, v218
    v_pk_mul_f16 v245, v221, v213
    v_pk_mul_f16 v246, v222, v214
    v_pk_mul_f16 v247, v223, v215
    v_cvt_pkrtz_f16_f32 v208, v176, v177
    s_waitcnt lgkmcnt(4)
    v_or_b32 v243, v227, v219
    v_cvt_pkrtz_f16_f32 v209, v178, v179
    v_cvt_pkrtz_f16_f32 v210, v180, v181
    v_mfma_f32_32x32x16_f16 v[80:95], a[248:251], v[240:243], v[80:95]
    ds_read_b128 a[248:251], v24 offset:12288
    v_cvt_pkrtz_f16_f32 v211, v182, v183
    v_cvt_pkrtz_f16_f32 v212, v184, v185
    v_cvt_pkrtz_f16_f32 v213, v186, v187
    v_cvt_pkrtz_f16_f32 v214, v188, v189
    v_cvt_pkrtz_f16_f32 v215, v190, v191
    v_mfma_f32_32x32x16_f16 v[48:63], a[252:255], v[232:235], v[48:63]
    v_pk_lshrrev_b16 v216, 3, v208 op_sel_hi:[0,1]
    v_pk_lshrrev_b16 v217, 3, v209 op_sel_hi:[0,1]
    v_pk_lshrrev_b16 v218, 3, v210 op_sel_hi:[0,1]
    v_pk_lshrrev_b16 v219, 3, v211 op_sel_hi:[0,1]
    v_mad_u32_u16 v224, v216, 2, s85
    v_mad_u32_u16 v216, v216, 2, s85 op_sel:[1,0,0,0]
    v_mfma_f32_32x32x16_f16 v[96:111], a[252:255], v[240:243], v[96:111]
    s_waitcnt lgkmcnt(2)
    ds_read_u16 v224, v224
    ds_read_u16_d16_hi v216, v216
    ds_read_b128 a[252:255], v24 offset:13312
    v_or_b32 v244, v228, v220
    v_pk_lshrrev_b16 v220, 3, v212 op_sel_hi:[0,1]
    v_mad_u32_u16 v225, v217, 2, s85
    v_mfma_f32_32x32x16_f16 v[64:79], a[232:235], v[232:235], v[64:79]
    ds_read_u16 v225, v225
    v_mad_u32_u16 v217, v217, 2, s85 op_sel:[1,0,0,0]
    v_mad_u32_u16 v226, v218, 2, s85
    v_mad_u32_u16 v218, v218, 2, s85 op_sel:[1,0,0,0]
    v_mad_u32_u16 v227, v219, 2, s85
    v_mad_u32_u16 v219, v219, 2, s85 op_sel:[1,0,0,0]
    v_mfma_f32_32x32x16_f16 v[112:127], a[232:235], v[240:243], v[112:127]
    ds_read_u16_d16_hi v217, v217
    ds_read_b128 a[232:235], v24 offset:14336
    ds_read_u16 v226, v226
    v_mad_u32_u16 v228, v220, 2, s85
    v_mad_u32_u16 v220, v220, 2, s85 op_sel:[1,0,0,0]
    v_pk_fma_f16 v221, v213, v213, s53
    v_mfma_f32_32x32x16_f16 v[32:47], a[236:239], v[236:239], v[32:47]
    s_add_u32 m0, s56, 1024
    ds_read_u16_d16_hi v218, v218
    buffer_load_dwordx4 v2, s[20:23], 0 offen offset:0 lds
    v_pk_fma_f16 v222, v214, v214, s53
    v_pk_fma_f16 v223, v215, v215, s53
    v_pk_mul_f16 v221, v221, v213 neg_lo:[1,0] neg_hi:[1,0]
    v_mfma_f32_32x32x16_f16 v[80:95], a[236:239], v[244:247], v[80:95]
    ds_read_b128 a[236:239], v24 offset:15360
    ds_read_u16 v227, v227
    v_pk_mul_f16 v222, v222, v214 neg_lo:[1,0] neg_hi:[1,0]
    v_pk_mul_f16 v223, v223, v215 neg_lo:[1,0] neg_hi:[1,0]
    v_exp_f16 v229, v221
    v_mfma_f32_32x32x16_f16 v[48:63], a[240:243], v[236:239], v[48:63]
    ds_read_u16_d16_hi v219, v219
    v_exp_f16 v230, v222
    v_exp_f16 v231, v223
    v_exp_f16_sdwa v229, v221 dst_sel:WORD_1 dst_unused:UNUSED_PRESERVE src0_sel:WORD_1
    v_mfma_f32_32x32x16_f16 v[96:111], a[240:243], v[244:247], v[96:111]
    s_waitcnt lgkmcnt(12)
    ds_read_b128 a[240:243], v24 offset:16384
    ds_read_u16 v228, v228
    v_exp_f16_sdwa v230, v222 dst_sel:WORD_1 dst_unused:UNUSED_PRESERVE src0_sel:WORD_1
    v_exp_f16_sdwa v231, v223 dst_sel:WORD_1 dst_unused:UNUSED_PRESERVE src0_sel:WORD_1
    v_mfma_f32_32x32x16_f16 v[64:79], a[244:247], v[236:239], v[64:79]
    s_waitcnt lgkmcnt(13)
    ds_read_u16_d16_hi v220, v220
    v_pk_add_f16 v229, v229, 1.0 op_sel_hi:[1,0]
    v_pk_add_f16 v230, v230, 1.0 op_sel_hi:[1,0]
    v_pk_add_f16 v231, v231, 1.0 op_sel_hi:[1,0]
    v_rcp_f16 v221, v229
    v_mfma_f32_32x32x16_f16 v[112:127], a[244:247], v[244:247], v[112:127]
    s_waitcnt lgkmcnt(13)
    ds_read_b128 a[244:247], v24 offset:17408
    v_rcp_f16 v222, v230
    v_rcp_f16 v223, v231
    v_rcp_f16_sdwa v221, v229 dst_sel:WORD_1 dst_unused:UNUSED_PRESERVE src0_sel:WORD_1
    v_mfma_f32_32x32x16_f16 v[176:191], a[248:251], v[128:131], 0
    s_waitcnt lgkmcnt(5)
    v_rcp_f16_sdwa v222, v230 dst_sel:WORD_1 dst_unused:UNUSED_PRESERVE src0_sel:WORD_1
    v_rcp_f16_sdwa v223, v231 dst_sel:WORD_1 dst_unused:UNUSED_PRESERVE src0_sel:WORD_1
    v_or_b32 v232, v224, v216
    v_or_b32 v233, v225, v217
    v_or_b32 v234, v226, v218
    s_waitcnt lgkmcnt(4)
    v_or_b32 v235, v227, v219
    v_pk_mul_f16 v237, v221, v213
    v_pk_mul_f16 v238, v222, v214
    v_pk_mul_f16 v239, v223, v215
    v_cvt_pkrtz_f16_f32 v208, v192, v193
    v_cvt_pkrtz_f16_f32 v209, v194, v195
    v_cvt_pkrtz_f16_f32 v210, v196, v197
    v_cvt_pkrtz_f16_f32 v211, v198, v199
    v_cvt_pkrtz_f16_f32 v212, v200, v201
    v_cvt_pkrtz_f16_f32 v213, v202, v203
    v_cvt_pkrtz_f16_f32 v214, v204, v205
    v_cvt_pkrtz_f16_f32 v215, v206, v207
    v_mfma_f32_32x32x16_f16 v[192:207], a[248:251], v[152:155], 0
    s_waitcnt lgkmcnt(2)
    ds_read_b128 a[248:251], v24 offset:6144
    v_pk_lshrrev_b16 v216, 3, v208 op_sel_hi:[0,1]
    v_pk_lshrrev_b16 v217, 3, v209 op_sel_hi:[0,1]
    v_pk_lshrrev_b16 v218, 3, v210 op_sel_hi:[0,1]
    s_waitcnt lgkmcnt(2)
    v_or_b32 v236, v228, v220
    v_pk_lshrrev_b16 v219, 3, v211 op_sel_hi:[0,1]
    v_mfma_f32_32x32x16_f16 v[176:191], a[252:255], v[132:135], v[176:191]
    v_pk_lshrrev_b16 v220, 3, v212 op_sel_hi:[0,1]
    v_mad_u32_u16 v224, v216, 2, s85
    v_mad_u32_u16 v216, v216, 2, s85 op_sel:[1,0,0,0]
    v_mad_u32_u16 v225, v217, 2, s85
    v_mad_u32_u16 v217, v217, 2, s85 op_sel:[1,0,0,0]
    v_mad_u32_u16 v226, v218, 2, s85
    v_mfma_f32_32x32x16_f16 v[192:207], a[252:255], v[156:159], v[192:207]
    ds_read_u16 v224, v224
    ds_read_u16_d16_hi v216, v216
    ds_read_b128 a[252:255], v24 offset:8192
    v_mad_u32_u16 v218, v218, 2, s85 op_sel:[1,0,0,0]
    v_mad_u32_u16 v227, v219, 2, s85
    v_mad_u32_u16 v219, v219, 2, s85 op_sel:[1,0,0,0]
    v_mfma_f32_32x32x16_f16 v[176:191], a[232:235], v[136:139], v[176:191]
    ds_read_u16 v225, v225
    ds_read_u16_d16_hi v217, v217
    v_mad_u32_u16 v228, v220, 2, s85
    v_mad_u32_u16 v220, v220, 2, s85 op_sel:[1,0,0,0]
    v_pk_fma_f16 v221, v213, v213, s53
    v_pk_fma_f16 v222, v214, v214, s53
    v_mfma_f32_32x32x16_f16 v[192:207], a[232:235], v[160:163], v[192:207]
    ds_read_b128 a[232:235], v24 offset:10240
    ds_read_u16 v226, v226
    v_pk_fma_f16 v223, v215, v215, s53
    v_pk_mul_f16 v221, v221, v213 neg_lo:[1,0] neg_hi:[1,0]
    v_pk_mul_f16 v222, v222, v214 neg_lo:[1,0] neg_hi:[1,0]
    v_pk_mul_f16 v223, v223, v215 neg_lo:[1,0] neg_hi:[1,0]
    v_mfma_f32_32x32x16_f16 v[176:191], a[236:239], v[140:143], v[176:191]
    s_add_u32 m0, s56, 2048
    ds_read_u16_d16_hi v218, v218
    buffer_load_dwordx4 v3, s[20:23], 0 offen offset:0 lds
    v_exp_f16 v229, v221
    v_exp_f16 v230, v222
    v_mfma_f32_32x32x16_f16 v[192:207], a[236:239], v[164:167], v[192:207]
    ds_read_b128 a[236:239], v24 offset:7168
    ds_read_u16 v227, v227
    v_exp_f16 v231, v223
    v_exp_f16_sdwa v229, v221 dst_sel:WORD_1 dst_unused:UNUSED_PRESERVE src0_sel:WORD_1
    v_mfma_f32_32x32x16_f16 v[176:191], a[240:243], v[144:147], v[176:191]
    ds_read_u16_d16_hi v219, v219
    v_exp_f16_sdwa v230, v222 dst_sel:WORD_1 dst_unused:UNUSED_PRESERVE src0_sel:WORD_1
    v_exp_f16_sdwa v231, v223 dst_sel:WORD_1 dst_unused:UNUSED_PRESERVE src0_sel:WORD_1
    v_pk_add_f16 v229, v229, 1.0 op_sel_hi:[1,0]
    v_mfma_f32_32x32x16_f16 v[192:207], a[240:243], v[168:171], v[192:207]
    s_waitcnt lgkmcnt(12)
    ds_read_b128 a[240:243], v24 offset:9216
    ds_read_u16 v228, v228
    v_pk_add_f16 v230, v230, 1.0 op_sel_hi:[1,0]
    v_pk_add_f16 v231, v231, 1.0 op_sel_hi:[1,0]
    v_rcp_f16 v221, v229
    v_mfma_f32_32x32x16_f16 v[176:191], a[244:247], v[148:151], v[176:191]
    s_waitcnt lgkmcnt(13)
    ds_read_u16_d16_hi v220, v220
    v_rcp_f16 v222, v230
    v_rcp_f16 v223, v231
    v_rcp_f16_sdwa v221, v229 dst_sel:WORD_1 dst_unused:UNUSED_PRESERVE src0_sel:WORD_1
    v_mfma_f32_32x32x16_f16 v[192:207], a[244:247], v[172:175], v[192:207]
    s_waitcnt lgkmcnt(12)
    ds_read_b128 a[244:247], v24 offset:11264
    v_rcp_f16_sdwa v222, v230 dst_sel:WORD_1 dst_unused:UNUSED_PRESERVE src0_sel:WORD_1
    v_rcp_f16_sdwa v223, v231 dst_sel:WORD_1 dst_unused:UNUSED_PRESERVE src0_sel:WORD_1
    v_or_b32 v240, v224, v216
    v_mfma_f32_32x32x16_f16 v[32:47], a[248:251], v[232:235], v[32:47]
    s_waitcnt lgkmcnt(5)
    v_or_b32 v241, v225, v217
    v_or_b32 v242, v226, v218
    v_pk_mul_f16 v245, v221, v213
    v_pk_mul_f16 v246, v222, v214
    v_pk_mul_f16 v247, v223, v215
    v_cvt_pkrtz_f16_f32 v208, v176, v177
    s_waitcnt lgkmcnt(4)
    v_or_b32 v243, v227, v219
    v_cvt_pkrtz_f16_f32 v209, v178, v179
    v_cvt_pkrtz_f16_f32 v210, v180, v181
    v_mfma_f32_32x32x16_f16 v[80:95], a[248:251], v[240:243], v[80:95]
    ds_read_b128 a[248:251], v24 offset:24576
    v_cvt_pkrtz_f16_f32 v211, v182, v183
    v_cvt_pkrtz_f16_f32 v212, v184, v185
    v_cvt_pkrtz_f16_f32 v213, v186, v187
    v_cvt_pkrtz_f16_f32 v214, v188, v189
    v_cvt_pkrtz_f16_f32 v215, v190, v191
    v_mfma_f32_32x32x16_f16 v[48:63], a[252:255], v[232:235], v[48:63]
    v_pk_lshrrev_b16 v216, 3, v208 op_sel_hi:[0,1]
    v_pk_lshrrev_b16 v217, 3, v209 op_sel_hi:[0,1]
    v_pk_lshrrev_b16 v218, 3, v210 op_sel_hi:[0,1]
    v_pk_lshrrev_b16 v219, 3, v211 op_sel_hi:[0,1]
    v_mad_u32_u16 v224, v216, 2, s85
    v_mad_u32_u16 v216, v216, 2, s85 op_sel:[1,0,0,0]
    v_mfma_f32_32x32x16_f16 v[96:111], a[252:255], v[240:243], v[96:111]
    s_waitcnt lgkmcnt(2)
    ds_read_u16 v224, v224
    ds_read_u16_d16_hi v216, v216
    ds_read_b128 a[252:255], v24 offset:25600
    v_or_b32 v244, v228, v220
    v_pk_lshrrev_b16 v220, 3, v212 op_sel_hi:[0,1]
    v_mad_u32_u16 v225, v217, 2, s85
    v_mfma_f32_32x32x16_f16 v[64:79], a[232:235], v[232:235], v[64:79]
    ds_read_u16 v225, v225
    v_mad_u32_u16 v217, v217, 2, s85 op_sel:[1,0,0,0]
    v_mad_u32_u16 v226, v218, 2, s85
    v_mad_u32_u16 v218, v218, 2, s85 op_sel:[1,0,0,0]
    v_mad_u32_u16 v227, v219, 2, s85
    v_mad_u32_u16 v219, v219, 2, s85 op_sel:[1,0,0,0]
    v_mfma_f32_32x32x16_f16 v[112:127], a[232:235], v[240:243], v[112:127]
    ds_read_u16_d16_hi v217, v217
    ds_read_b128 a[232:235], v24 offset:26624
    ds_read_u16 v226, v226
    v_mad_u32_u16 v228, v220, 2, s85
    v_mad_u32_u16 v220, v220, 2, s85 op_sel:[1,0,0,0]
    v_pk_fma_f16 v221, v213, v213, s53
    v_mfma_f32_32x32x16_f16 v[32:47], a[236:239], v[236:239], v[32:47]
    s_add_u32 m0, s56, 3072
    ds_read_u16_d16_hi v218, v218
    buffer_load_dwordx4 v4, s[20:23], 0 offen offset:0 lds
    v_pk_fma_f16 v222, v214, v214, s53
    v_pk_fma_f16 v223, v215, v215, s53
    v_pk_mul_f16 v221, v221, v213 neg_lo:[1,0] neg_hi:[1,0]
    v_mfma_f32_32x32x16_f16 v[80:95], a[236:239], v[244:247], v[80:95]
    ds_read_b128 a[236:239], v24 offset:27648
    ds_read_u16 v227, v227
    v_pk_mul_f16 v222, v222, v214 neg_lo:[1,0] neg_hi:[1,0]
    v_pk_mul_f16 v223, v223, v215 neg_lo:[1,0] neg_hi:[1,0]
    v_exp_f16 v229, v221
    v_mfma_f32_32x32x16_f16 v[48:63], a[240:243], v[236:239], v[48:63]
    ds_read_u16_d16_hi v219, v219
    v_exp_f16 v230, v222
    v_exp_f16 v231, v223
    v_exp_f16_sdwa v229, v221 dst_sel:WORD_1 dst_unused:UNUSED_PRESERVE src0_sel:WORD_1
    v_mfma_f32_32x32x16_f16 v[96:111], a[240:243], v[244:247], v[96:111]
    s_waitcnt lgkmcnt(12)
    ds_read_b128 a[240:243], v24 offset:28672
    ds_read_u16 v228, v228
    v_exp_f16_sdwa v230, v222 dst_sel:WORD_1 dst_unused:UNUSED_PRESERVE src0_sel:WORD_1
    v_exp_f16_sdwa v231, v223 dst_sel:WORD_1 dst_unused:UNUSED_PRESERVE src0_sel:WORD_1
    v_mfma_f32_32x32x16_f16 v[64:79], a[244:247], v[236:239], v[64:79]
    s_waitcnt lgkmcnt(13)
    ds_read_u16_d16_hi v220, v220
    v_pk_add_f16 v229, v229, 1.0 op_sel_hi:[1,0]
    v_pk_add_f16 v230, v230, 1.0 op_sel_hi:[1,0]
    v_pk_add_f16 v231, v231, 1.0 op_sel_hi:[1,0]
    v_rcp_f16 v221, v229
    v_mfma_f32_32x32x16_f16 v[112:127], a[244:247], v[244:247], v[112:127]
    s_waitcnt lgkmcnt(13)
    ds_read_b128 a[244:247], v24 offset:29696
    v_rcp_f16 v222, v230
    v_rcp_f16 v223, v231
    v_rcp_f16_sdwa v221, v229 dst_sel:WORD_1 dst_unused:UNUSED_PRESERVE src0_sel:WORD_1
    v_mfma_f32_32x32x16_f16 v[176:191], a[248:251], v[128:131], 0
    s_waitcnt lgkmcnt(5)
    v_rcp_f16_sdwa v222, v230 dst_sel:WORD_1 dst_unused:UNUSED_PRESERVE src0_sel:WORD_1
    v_rcp_f16_sdwa v223, v231 dst_sel:WORD_1 dst_unused:UNUSED_PRESERVE src0_sel:WORD_1
    v_or_b32 v232, v224, v216
    v_or_b32 v233, v225, v217
    v_or_b32 v234, v226, v218
    s_waitcnt lgkmcnt(4)
    v_or_b32 v235, v227, v219
    v_pk_mul_f16 v237, v221, v213
    v_pk_mul_f16 v238, v222, v214
    v_pk_mul_f16 v239, v223, v215
    v_cvt_pkrtz_f16_f32 v208, v192, v193
    v_cvt_pkrtz_f16_f32 v209, v194, v195
    v_cvt_pkrtz_f16_f32 v210, v196, v197
    v_cvt_pkrtz_f16_f32 v211, v198, v199
    v_cvt_pkrtz_f16_f32 v212, v200, v201
    v_cvt_pkrtz_f16_f32 v213, v202, v203
    v_cvt_pkrtz_f16_f32 v214, v204, v205
    v_cvt_pkrtz_f16_f32 v215, v206, v207
    v_mfma_f32_32x32x16_f16 v[192:207], a[248:251], v[152:155], 0
    s_waitcnt lgkmcnt(2)
    ds_read_b128 a[248:251], v24 offset:18432
    v_pk_lshrrev_b16 v216, 3, v208 op_sel_hi:[0,1]
    v_pk_lshrrev_b16 v217, 3, v209 op_sel_hi:[0,1]
    v_pk_lshrrev_b16 v218, 3, v210 op_sel_hi:[0,1]
    s_waitcnt lgkmcnt(2)
    v_or_b32 v236, v228, v220
    v_pk_lshrrev_b16 v219, 3, v211 op_sel_hi:[0,1]
    v_mfma_f32_32x32x16_f16 v[176:191], a[252:255], v[132:135], v[176:191]
    v_pk_lshrrev_b16 v220, 3, v212 op_sel_hi:[0,1]
    v_mad_u32_u16 v224, v216, 2, s85
    v_mad_u32_u16 v216, v216, 2, s85 op_sel:[1,0,0,0]
    v_mad_u32_u16 v225, v217, 2, s85
    v_mad_u32_u16 v217, v217, 2, s85 op_sel:[1,0,0,0]
    v_mad_u32_u16 v226, v218, 2, s85
    v_mfma_f32_32x32x16_f16 v[192:207], a[252:255], v[156:159], v[192:207]
    ds_read_u16 v224, v224
    ds_read_u16_d16_hi v216, v216
    ds_read_b128 a[252:255], v24 offset:20480
    v_mad_u32_u16 v218, v218, 2, s85 op_sel:[1,0,0,0]
    v_mad_u32_u16 v227, v219, 2, s85
    v_mad_u32_u16 v219, v219, 2, s85 op_sel:[1,0,0,0]
    v_mfma_f32_32x32x16_f16 v[176:191], a[232:235], v[136:139], v[176:191]
    ds_read_u16 v225, v225
    ds_read_u16_d16_hi v217, v217
    v_mad_u32_u16 v228, v220, 2, s85
    v_mad_u32_u16 v220, v220, 2, s85 op_sel:[1,0,0,0]
    v_pk_fma_f16 v221, v213, v213, s53
    v_pk_fma_f16 v222, v214, v214, s53
    v_mfma_f32_32x32x16_f16 v[192:207], a[232:235], v[160:163], v[192:207]
    ds_read_b128 a[232:235], v24 offset:22528
    ds_read_u16 v226, v226
    v_pk_fma_f16 v223, v215, v215, s53
    v_pk_mul_f16 v221, v221, v213 neg_lo:[1,0] neg_hi:[1,0]
    v_pk_mul_f16 v222, v222, v214 neg_lo:[1,0] neg_hi:[1,0]
    v_pk_mul_f16 v223, v223, v215 neg_lo:[1,0] neg_hi:[1,0]
    v_mfma_f32_32x32x16_f16 v[176:191], a[236:239], v[140:143], v[176:191]
    s_add_u32 m0, s56, 4096
    ds_read_u16_d16_hi v218, v218
    buffer_load_dwordx4 v5, s[20:23], 0 offen offset:0 lds
    v_exp_f16 v229, v221
    v_exp_f16 v230, v222
    v_mfma_f32_32x32x16_f16 v[192:207], a[236:239], v[164:167], v[192:207]
    ds_read_b128 a[236:239], v24 offset:19456
    ds_read_u16 v227, v227
    v_exp_f16 v231, v223
    v_exp_f16_sdwa v229, v221 dst_sel:WORD_1 dst_unused:UNUSED_PRESERVE src0_sel:WORD_1
    v_mfma_f32_32x32x16_f16 v[176:191], a[240:243], v[144:147], v[176:191]
    ds_read_u16_d16_hi v219, v219
    v_exp_f16_sdwa v230, v222 dst_sel:WORD_1 dst_unused:UNUSED_PRESERVE src0_sel:WORD_1
    v_exp_f16_sdwa v231, v223 dst_sel:WORD_1 dst_unused:UNUSED_PRESERVE src0_sel:WORD_1
    v_pk_add_f16 v229, v229, 1.0 op_sel_hi:[1,0]
    v_mfma_f32_32x32x16_f16 v[192:207], a[240:243], v[168:171], v[192:207]
    s_waitcnt lgkmcnt(12)
    ds_read_b128 a[240:243], v24 offset:21504
    ds_read_u16 v228, v228
    v_pk_add_f16 v230, v230, 1.0 op_sel_hi:[1,0]
    v_pk_add_f16 v231, v231, 1.0 op_sel_hi:[1,0]
    v_rcp_f16 v221, v229
    v_mfma_f32_32x32x16_f16 v[176:191], a[244:247], v[148:151], v[176:191]
    s_waitcnt lgkmcnt(13)
    ds_read_u16_d16_hi v220, v220
    v_rcp_f16 v222, v230
    v_rcp_f16 v223, v231
    v_rcp_f16_sdwa v221, v229 dst_sel:WORD_1 dst_unused:UNUSED_PRESERVE src0_sel:WORD_1
    v_mfma_f32_32x32x16_f16 v[192:207], a[244:247], v[172:175], v[192:207]
    s_waitcnt lgkmcnt(12)
    ds_read_b128 a[244:247], v24 offset:23552
    v_rcp_f16_sdwa v222, v230 dst_sel:WORD_1 dst_unused:UNUSED_PRESERVE src0_sel:WORD_1
    v_rcp_f16_sdwa v223, v231 dst_sel:WORD_1 dst_unused:UNUSED_PRESERVE src0_sel:WORD_1
    v_or_b32 v240, v224, v216
    v_mfma_f32_32x32x16_f16 v[32:47], a[248:251], v[232:235], v[32:47]
    s_waitcnt lgkmcnt(5)
    v_or_b32 v241, v225, v217
    v_or_b32 v242, v226, v218
    v_pk_mul_f16 v245, v221, v213
    v_pk_mul_f16 v246, v222, v214
    v_pk_mul_f16 v247, v223, v215
    v_cvt_pkrtz_f16_f32 v208, v176, v177
    s_waitcnt lgkmcnt(4)
    v_or_b32 v243, v227, v219
    v_cvt_pkrtz_f16_f32 v209, v178, v179
    v_cvt_pkrtz_f16_f32 v210, v180, v181
    v_mfma_f32_32x32x16_f16 v[80:95], a[248:251], v[240:243], v[80:95]
    ds_read_b128 a[248:251], v24 offset:36864
    v_cvt_pkrtz_f16_f32 v211, v182, v183
    v_cvt_pkrtz_f16_f32 v212, v184, v185
    v_cvt_pkrtz_f16_f32 v213, v186, v187
    v_cvt_pkrtz_f16_f32 v214, v188, v189
    v_cvt_pkrtz_f16_f32 v215, v190, v191
    v_mfma_f32_32x32x16_f16 v[48:63], a[252:255], v[232:235], v[48:63]
    v_pk_lshrrev_b16 v216, 3, v208 op_sel_hi:[0,1]
    v_pk_lshrrev_b16 v217, 3, v209 op_sel_hi:[0,1]
    v_pk_lshrrev_b16 v218, 3, v210 op_sel_hi:[0,1]
    v_pk_lshrrev_b16 v219, 3, v211 op_sel_hi:[0,1]
    v_mad_u32_u16 v224, v216, 2, s85
    v_mad_u32_u16 v216, v216, 2, s85 op_sel:[1,0,0,0]
    v_mfma_f32_32x32x16_f16 v[96:111], a[252:255], v[240:243], v[96:111]
    s_waitcnt lgkmcnt(2)
    ds_read_u16 v224, v224
    ds_read_u16_d16_hi v216, v216
    ds_read_b128 a[252:255], v24 offset:37888
    v_or_b32 v244, v228, v220
    v_pk_lshrrev_b16 v220, 3, v212 op_sel_hi:[0,1]
    v_mad_u32_u16 v225, v217, 2, s85
    v_mfma_f32_32x32x16_f16 v[64:79], a[232:235], v[232:235], v[64:79]
    ds_read_u16 v225, v225
    v_mad_u32_u16 v217, v217, 2, s85 op_sel:[1,0,0,0]
    v_mad_u32_u16 v226, v218, 2, s85
    v_mad_u32_u16 v218, v218, 2, s85 op_sel:[1,0,0,0]
    v_mad_u32_u16 v227, v219, 2, s85
    v_mad_u32_u16 v219, v219, 2, s85 op_sel:[1,0,0,0]
    v_mfma_f32_32x32x16_f16 v[112:127], a[232:235], v[240:243], v[112:127]
    ds_read_u16_d16_hi v217, v217
    ds_read_b128 a[232:235], v24 offset:38912
    ds_read_u16 v226, v226
    v_mad_u32_u16 v228, v220, 2, s85
    v_mad_u32_u16 v220, v220, 2, s85 op_sel:[1,0,0,0]
    v_pk_fma_f16 v221, v213, v213, s53
    v_mfma_f32_32x32x16_f16 v[32:47], a[236:239], v[236:239], v[32:47]
    s_add_u32 m0, s56, 5120
    ds_read_u16_d16_hi v218, v218
    buffer_load_dwordx4 v6, s[20:23], 0 offen offset:0 lds
    v_pk_fma_f16 v222, v214, v214, s53
    v_pk_fma_f16 v223, v215, v215, s53
    v_pk_mul_f16 v221, v221, v213 neg_lo:[1,0] neg_hi:[1,0]
    v_mfma_f32_32x32x16_f16 v[80:95], a[236:239], v[244:247], v[80:95]
    ds_read_b128 a[236:239], v24 offset:39936
    ds_read_u16 v227, v227
    v_pk_mul_f16 v222, v222, v214 neg_lo:[1,0] neg_hi:[1,0]
    v_pk_mul_f16 v223, v223, v215 neg_lo:[1,0] neg_hi:[1,0]
    v_exp_f16 v229, v221
    v_mfma_f32_32x32x16_f16 v[48:63], a[240:243], v[236:239], v[48:63]
    ds_read_u16_d16_hi v219, v219
    v_exp_f16 v230, v222
    v_exp_f16 v231, v223
    v_exp_f16_sdwa v229, v221 dst_sel:WORD_1 dst_unused:UNUSED_PRESERVE src0_sel:WORD_1
    v_mfma_f32_32x32x16_f16 v[96:111], a[240:243], v[244:247], v[96:111]
    s_waitcnt lgkmcnt(12)
    ds_read_b128 a[240:243], v24 offset:40960
    ds_read_u16 v228, v228
    v_exp_f16_sdwa v230, v222 dst_sel:WORD_1 dst_unused:UNUSED_PRESERVE src0_sel:WORD_1
    v_exp_f16_sdwa v231, v223 dst_sel:WORD_1 dst_unused:UNUSED_PRESERVE src0_sel:WORD_1
    v_mfma_f32_32x32x16_f16 v[64:79], a[244:247], v[236:239], v[64:79]
    s_waitcnt lgkmcnt(13)
    ds_read_u16_d16_hi v220, v220
    v_pk_add_f16 v229, v229, 1.0 op_sel_hi:[1,0]
    v_pk_add_f16 v230, v230, 1.0 op_sel_hi:[1,0]
    v_pk_add_f16 v231, v231, 1.0 op_sel_hi:[1,0]
    v_rcp_f16 v221, v229
    v_mfma_f32_32x32x16_f16 v[112:127], a[244:247], v[244:247], v[112:127]
    s_waitcnt lgkmcnt(13)
    ds_read_b128 a[244:247], v24 offset:41984
    v_rcp_f16 v222, v230
    v_rcp_f16 v223, v231
    v_rcp_f16_sdwa v221, v229 dst_sel:WORD_1 dst_unused:UNUSED_PRESERVE src0_sel:WORD_1
    v_mfma_f32_32x32x16_f16 v[176:191], a[248:251], v[128:131], 0
    s_waitcnt lgkmcnt(5)
    v_rcp_f16_sdwa v222, v230 dst_sel:WORD_1 dst_unused:UNUSED_PRESERVE src0_sel:WORD_1
    v_rcp_f16_sdwa v223, v231 dst_sel:WORD_1 dst_unused:UNUSED_PRESERVE src0_sel:WORD_1
    v_or_b32 v232, v224, v216
    v_or_b32 v233, v225, v217
    v_or_b32 v234, v226, v218
    s_waitcnt lgkmcnt(4)
    v_or_b32 v235, v227, v219
    v_pk_mul_f16 v237, v221, v213
    v_pk_mul_f16 v238, v222, v214
    v_pk_mul_f16 v239, v223, v215
    v_cvt_pkrtz_f16_f32 v208, v192, v193
    v_cvt_pkrtz_f16_f32 v209, v194, v195
    v_cvt_pkrtz_f16_f32 v210, v196, v197
    v_cvt_pkrtz_f16_f32 v211, v198, v199
    v_cvt_pkrtz_f16_f32 v212, v200, v201
    v_cvt_pkrtz_f16_f32 v213, v202, v203
    v_cvt_pkrtz_f16_f32 v214, v204, v205
    v_cvt_pkrtz_f16_f32 v215, v206, v207
    v_mfma_f32_32x32x16_f16 v[192:207], a[248:251], v[152:155], 0
    s_waitcnt lgkmcnt(2)
    ds_read_b128 a[248:251], v24 offset:30720
    v_pk_lshrrev_b16 v216, 3, v208 op_sel_hi:[0,1]
    v_pk_lshrrev_b16 v217, 3, v209 op_sel_hi:[0,1]
    v_pk_lshrrev_b16 v218, 3, v210 op_sel_hi:[0,1]
    s_waitcnt lgkmcnt(2)
    v_or_b32 v236, v228, v220
    v_pk_lshrrev_b16 v219, 3, v211 op_sel_hi:[0,1]
    v_mfma_f32_32x32x16_f16 v[176:191], a[252:255], v[132:135], v[176:191]
    v_pk_lshrrev_b16 v220, 3, v212 op_sel_hi:[0,1]
    v_mad_u32_u16 v224, v216, 2, s85
    v_mad_u32_u16 v216, v216, 2, s85 op_sel:[1,0,0,0]
    v_mad_u32_u16 v225, v217, 2, s85
    v_mad_u32_u16 v217, v217, 2, s85 op_sel:[1,0,0,0]
    v_mad_u32_u16 v226, v218, 2, s85
    v_mfma_f32_32x32x16_f16 v[192:207], a[252:255], v[156:159], v[192:207]
    ds_read_u16 v224, v224
    ds_read_u16_d16_hi v216, v216
    ds_read_b128 a[252:255], v24 offset:32768
    v_mad_u32_u16 v218, v218, 2, s85 op_sel:[1,0,0,0]
    v_mad_u32_u16 v227, v219, 2, s85
    v_mad_u32_u16 v219, v219, 2, s85 op_sel:[1,0,0,0]
    v_mfma_f32_32x32x16_f16 v[176:191], a[232:235], v[136:139], v[176:191]
    ds_read_u16 v225, v225
    ds_read_u16_d16_hi v217, v217
    v_mad_u32_u16 v228, v220, 2, s85
    v_mad_u32_u16 v220, v220, 2, s85 op_sel:[1,0,0,0]
    v_pk_fma_f16 v221, v213, v213, s53
    v_pk_fma_f16 v222, v214, v214, s53
    v_mfma_f32_32x32x16_f16 v[192:207], a[232:235], v[160:163], v[192:207]
    ds_read_b128 a[232:235], v24 offset:34816
    ds_read_u16 v226, v226
    v_pk_fma_f16 v223, v215, v215, s53
    v_pk_mul_f16 v221, v221, v213 neg_lo:[1,0] neg_hi:[1,0]
    v_pk_mul_f16 v222, v222, v214 neg_lo:[1,0] neg_hi:[1,0]
    v_pk_mul_f16 v223, v223, v215 neg_lo:[1,0] neg_hi:[1,0]
    v_mfma_f32_32x32x16_f16 v[176:191], a[236:239], v[140:143], v[176:191]
    s_add_u32 m0, s56, 6144
    ds_read_u16_d16_hi v218, v218
    buffer_load_dword v7, s[20:23], 0 offen offset:0 lds
    v_exp_f16 v229, v221
    v_exp_f16 v230, v222
    v_mfma_f32_32x32x16_f16 v[192:207], a[236:239], v[164:167], v[192:207]
    ds_read_b128 a[236:239], v24 offset:31744
    ds_read_u16 v227, v227
    v_exp_f16 v231, v223
    v_exp_f16_sdwa v229, v221 dst_sel:WORD_1 dst_unused:UNUSED_PRESERVE src0_sel:WORD_1
    v_mfma_f32_32x32x16_f16 v[176:191], a[240:243], v[144:147], v[176:191]
    ds_read_u16_d16_hi v219, v219
    v_exp_f16_sdwa v230, v222 dst_sel:WORD_1 dst_unused:UNUSED_PRESERVE src0_sel:WORD_1
    v_exp_f16_sdwa v231, v223 dst_sel:WORD_1 dst_unused:UNUSED_PRESERVE src0_sel:WORD_1
    v_pk_add_f16 v229, v229, 1.0 op_sel_hi:[1,0]
    v_mfma_f32_32x32x16_f16 v[192:207], a[240:243], v[168:171], v[192:207]
    s_waitcnt lgkmcnt(12)
    ds_read_b128 a[240:243], v24 offset:33792
    ds_read_u16 v228, v228
    v_pk_add_f16 v230, v230, 1.0 op_sel_hi:[1,0]
    v_pk_add_f16 v231, v231, 1.0 op_sel_hi:[1,0]
    v_rcp_f16 v221, v229
    v_mfma_f32_32x32x16_f16 v[176:191], a[244:247], v[148:151], v[176:191]
    s_waitcnt lgkmcnt(13)
    ds_read_u16_d16_hi v220, v220
    v_rcp_f16 v222, v230
    v_rcp_f16 v223, v231
    v_rcp_f16_sdwa v221, v229 dst_sel:WORD_1 dst_unused:UNUSED_PRESERVE src0_sel:WORD_1
    v_mfma_f32_32x32x16_f16 v[192:207], a[244:247], v[172:175], v[192:207]
    s_waitcnt lgkmcnt(12)
    ds_read_b128 a[244:247], v24 offset:35840
    v_rcp_f16_sdwa v222, v230 dst_sel:WORD_1 dst_unused:UNUSED_PRESERVE src0_sel:WORD_1
    v_rcp_f16_sdwa v223, v231 dst_sel:WORD_1 dst_unused:UNUSED_PRESERVE src0_sel:WORD_1
    v_or_b32 v240, v224, v216
    v_mfma_f32_32x32x16_f16 v[32:47], a[248:251], v[232:235], v[32:47]
    s_waitcnt lgkmcnt(5)
    v_or_b32 v241, v225, v217
    v_or_b32 v242, v226, v218
    v_pk_mul_f16 v245, v221, v213
    v_pk_mul_f16 v246, v222, v214
    v_pk_mul_f16 v247, v223, v215
    v_cvt_pkrtz_f16_f32 v208, v176, v177
    s_waitcnt lgkmcnt(4)
    v_or_b32 v243, v227, v219
    v_cvt_pkrtz_f16_f32 v209, v178, v179
    v_cvt_pkrtz_f16_f32 v210, v180, v181
    v_mfma_f32_32x32x16_f16 v[80:95], a[248:251], v[240:243], v[80:95]
    ds_read_b128 a[248:251], v24 offset:43008
    v_cvt_pkrtz_f16_f32 v211, v182, v183
    v_cvt_pkrtz_f16_f32 v212, v184, v185
    v_cvt_pkrtz_f16_f32 v213, v186, v187
    v_cvt_pkrtz_f16_f32 v214, v188, v189
    v_cvt_pkrtz_f16_f32 v215, v190, v191
    v_mfma_f32_32x32x16_f16 v[48:63], a[252:255], v[232:235], v[48:63]
    v_pk_lshrrev_b16 v216, 3, v208 op_sel_hi:[0,1]
    v_pk_lshrrev_b16 v217, 3, v209 op_sel_hi:[0,1]
    v_pk_lshrrev_b16 v218, 3, v210 op_sel_hi:[0,1]
    v_pk_lshrrev_b16 v219, 3, v211 op_sel_hi:[0,1]
    v_mad_u32_u16 v224, v216, 2, s85
    v_mad_u32_u16 v216, v216, 2, s85 op_sel:[1,0,0,0]
    v_mfma_f32_32x32x16_f16 v[96:111], a[252:255], v[240:243], v[96:111]
    s_waitcnt lgkmcnt(2)
    ds_read_u16 v224, v224
    ds_read_u16_d16_hi v216, v216
    ds_read_b128 a[252:255], v24 offset:45056
    v_or_b32 v244, v228, v220
    v_pk_lshrrev_b16 v220, 3, v212 op_sel_hi:[0,1]
    v_mad_u32_u16 v225, v217, 2, s85
    v_mfma_f32_32x32x16_f16 v[64:79], a[232:235], v[232:235], v[64:79]
    ds_read_u16 v225, v225
    v_mad_u32_u16 v217, v217, 2, s85 op_sel:[1,0,0,0]
    v_mad_u32_u16 v226, v218, 2, s85
    v_mad_u32_u16 v218, v218, 2, s85 op_sel:[1,0,0,0]
    v_mad_u32_u16 v227, v219, 2, s85
    v_mad_u32_u16 v219, v219, 2, s85 op_sel:[1,0,0,0]
    v_mfma_f32_32x32x16_f16 v[112:127], a[232:235], v[240:243], v[112:127]
    ds_read_u16_d16_hi v217, v217
    ds_read_b128 a[232:235], v24 offset:47104
    ds_read_u16 v226, v226
    v_mad_u32_u16 v228, v220, 2, s85
    v_mad_u32_u16 v220, v220, 2, s85 op_sel:[1,0,0,0]
    v_pk_fma_f16 v221, v213, v213, s53
    v_mfma_f32_32x32x16_f16 v[32:47], a[236:239], v[236:239], v[32:47]
    ds_read_u16_d16_hi v218, v218
    buffer_load_dword v254, v31, s[20:23], 0 offen
    v_pk_fma_f16 v222, v214, v214, s53
    v_pk_fma_f16 v223, v215, v215, s53
    v_pk_mul_f16 v221, v221, v213 neg_lo:[1,0] neg_hi:[1,0]
    v_pk_mul_f16 v222, v222, v214 neg_lo:[1,0] neg_hi:[1,0]
    v_mfma_f32_32x32x16_f16 v[80:95], a[236:239], v[244:247], v[80:95]
    ds_read_b128 a[236:239], v24 offset:44032
    ds_read_u16 v227, v227
    v_pk_mul_f16 v223, v223, v215 neg_lo:[1,0] neg_hi:[1,0]
    v_exp_f16 v229, v221
    v_exp_f16 v230, v222
    v_mfma_f32_32x32x16_f16 v[48:63], a[240:243], v[236:239], v[48:63]
    ds_read_u16_d16_hi v219, v219
    v_exp_f16 v231, v223
    v_exp_f16_sdwa v229, v221 dst_sel:WORD_1 dst_unused:UNUSED_PRESERVE src0_sel:WORD_1
    v_exp_f16_sdwa v230, v222 dst_sel:WORD_1 dst_unused:UNUSED_PRESERVE src0_sel:WORD_1
    v_mfma_f32_32x32x16_f16 v[96:111], a[240:243], v[244:247], v[96:111]
    s_waitcnt lgkmcnt(12)
    ds_read_b128 a[240:243], v24 offset:46080
    ds_read_u16 v228, v228
    v_exp_f16_sdwa v231, v223 dst_sel:WORD_1 dst_unused:UNUSED_PRESERVE src0_sel:WORD_1
    v_pk_add_f16 v229, v229, 1.0 op_sel_hi:[1,0]
    v_pk_add_f16 v230, v230, 1.0 op_sel_hi:[1,0]
    v_mfma_f32_32x32x16_f16 v[64:79], a[244:247], v[236:239], v[64:79]
    s_waitcnt lgkmcnt(13)
    ds_read_u16_d16_hi v220, v220
    v_pk_add_f16 v231, v231, 1.0 op_sel_hi:[1,0]
    v_rcp_f16 v221, v229
    v_rcp_f16 v222, v230
    v_mfma_f32_32x32x16_f16 v[112:127], a[244:247], v[244:247], v[112:127]
    s_waitcnt lgkmcnt(6)
    ds_read_b128 a[244:247], v24 offset:48128
    v_rcp_f16 v223, v231
    v_rcp_f16_sdwa v221, v229 dst_sel:WORD_1 dst_unused:UNUSED_PRESERVE src0_sel:WORD_1
    v_rcp_f16_sdwa v222, v230 dst_sel:WORD_1 dst_unused:UNUSED_PRESERVE src0_sel:WORD_1
    v_rcp_f16_sdwa v223, v231 dst_sel:WORD_1 dst_unused:UNUSED_PRESERVE src0_sel:WORD_1
    v_or_b32 v232, v224, v216
    v_or_b32 v233, v225, v217
    v_or_b32 v234, v226, v218
    v_pk_mul_f16 v237, v221, v213
    v_pk_mul_f16 v238, v222, v214
    s_waitcnt lgkmcnt(4)
    v_or_b32 v235, v227, v219
    v_pk_mul_f16 v239, v223, v215
    v_cvt_pkrtz_f16_f32 v208, v192, v193
    v_mfma_f32_32x32x16_f16 v[32:47], a[248:251], v[232:235], v[32:47]
    v_cvt_pkrtz_f16_f32 v209, v194, v195
    v_cvt_pkrtz_f16_f32 v210, v196, v197
    v_cvt_pkrtz_f16_f32 v211, v198, v199
    v_cvt_pkrtz_f16_f32 v212, v200, v201
    v_cvt_pkrtz_f16_f32 v213, v202, v203
    v_cvt_pkrtz_f16_f32 v214, v204, v205
    v_mfma_f32_32x32x16_f16 v[176:191], a[0:3], v[128:131], 0
    v_cvt_pkrtz_f16_f32 v215, v206, v207
    v_pk_lshrrev_b16 v216, 3, v208 op_sel_hi:[0,1]
    v_pk_lshrrev_b16 v217, 3, v209 op_sel_hi:[0,1]
    v_pk_lshrrev_b16 v218, 3, v210 op_sel_hi:[0,1]
    v_pk_lshrrev_b16 v219, 3, v211 op_sel_hi:[0,1]
    v_mad_u32_u16 v224, v216, 2, s85
    v_mfma_f32_32x32x16_f16 v[48:63], a[252:255], v[232:235], v[48:63]
    s_waitcnt lgkmcnt(1)
    ds_read_u16 v224, v224
    v_or_b32 v236, v228, v220
    v_pk_lshrrev_b16 v220, 3, v212 op_sel_hi:[0,1]
    v_mad_u32_u16 v216, v216, 2, s85 op_sel:[1,0,0,0]
    v_mad_u32_u16 v225, v217, 2, s85
    v_mad_u32_u16 v217, v217, 2, s85 op_sel:[1,0,0,0]
    v_mfma_f32_32x32x16_f16 v[176:191], a[4:7], v[132:135], v[176:191]
    ds_read_u16_d16_hi v216, v216
    ds_read_u16 v225, v225
    v_mad_u32_u16 v226, v218, 2, s85
    v_mad_u32_u16 v218, v218, 2, s85 op_sel:[1,0,0,0]
    v_mad_u32_u16 v227, v219, 2, s85
    v_mad_u32_u16 v219, v219, 2, s85 op_sel:[1,0,0,0]
    v_mfma_f32_32x32x16_f16 v[64:79], a[232:235], v[232:235], v[64:79]
    ds_read_u16_d16_hi v217, v217
    v_mad_u32_u16 v228, v220, 2, s85
    v_mad_u32_u16 v220, v220, 2, s85 op_sel:[1,0,0,0]
    v_pk_fma_f16 v221, v213, v213, s53
    v_pk_fma_f16 v222, v214, v214, s53
    v_pk_fma_f16 v223, v215, v215, s53
    v_mfma_f32_32x32x16_f16 v[176:191], a[8:11], v[136:139], v[176:191]
    ds_read_u16 v226, v226
    v_pk_mul_f16 v221, v221, v213 neg_lo:[1,0] neg_hi:[1,0]
    v_pk_mul_f16 v222, v222, v214 neg_lo:[1,0] neg_hi:[1,0]
    v_pk_mul_f16 v223, v223, v215 neg_lo:[1,0] neg_hi:[1,0]
    v_exp_f16 v229, v221
    v_mfma_f32_32x32x16_f16 v[32:47], a[236:239], v[236:239], v[32:47]
    ds_read_u16_d16_hi v218, v218
    v_exp_f16 v230, v222
    v_exp_f16 v231, v223
    v_exp_f16_sdwa v229, v221 dst_sel:WORD_1 dst_unused:UNUSED_PRESERVE src0_sel:WORD_1
    v_mfma_f32_32x32x16_f16 v[176:191], a[12:15], v[140:143], v[176:191]
    ds_read_u16 v227, v227
    v_exp_f16_sdwa v230, v222 dst_sel:WORD_1 dst_unused:UNUSED_PRESERVE src0_sel:WORD_1
    v_exp_f16_sdwa v231, v223 dst_sel:WORD_1 dst_unused:UNUSED_PRESERVE src0_sel:WORD_1
    v_pk_add_f16 v229, v229, 1.0 op_sel_hi:[1,0]
    v_mfma_f32_32x32x16_f16 v[176:191], a[16:19], v[144:147], v[176:191]
    ds_read_u16_d16_hi v219, v219
    v_pk_add_f16 v230, v230, 1.0 op_sel_hi:[1,0]
    v_pk_add_f16 v231, v231, 1.0 op_sel_hi:[1,0]
    v_rcp_f16 v221, v229
    v_rcp_f16 v222, v230
    v_mfma_f32_32x32x16_f16 v[176:191], a[20:23], v[148:151], v[176:191]
    ds_read_u16 v228, v228
    v_rcp_f16 v223, v231
    v_rcp_f16_sdwa v221, v229 dst_sel:WORD_1 dst_unused:UNUSED_PRESERVE src0_sel:WORD_1
    v_rcp_f16_sdwa v222, v230 dst_sel:WORD_1 dst_unused:UNUSED_PRESERVE src0_sel:WORD_1
    v_mfma_f32_32x32x16_f16 v[48:63], a[240:243], v[236:239], v[48:63]
    s_waitcnt lgkmcnt(3)
    ds_read_u16_d16_hi v220, v220
    v_rcp_f16_sdwa v223, v231 dst_sel:WORD_1 dst_unused:UNUSED_PRESERVE src0_sel:WORD_1
    v_or_b32 v240, v224, v216
    v_or_b32 v241, v225, v217
    v_or_b32 v242, v226, v218
    v_mfma_f32_32x32x16_f16 v[64:79], a[244:247], v[236:239], v[64:79]
    s_waitcnt lgkmcnt(2)
    v_or_b32 v243, v227, v219
    v_pk_mul_f16 v245, v221, v213
    v_pk_mul_f16 v246, v222, v214
    v_pk_mul_f16 v247, v223, v215
    v_cvt_pkrtz_f16_f32 v208, v176, v177
    v_cvt_pkrtz_f16_f32 v209, v178, v179
    v_mfma_f32_32x32x16_f16 v[80:95], a[248:251], v[240:243], v[80:95]
    s_waitcnt lgkmcnt(1)
    v_cvt_pkrtz_f16_f32 v210, v180, v181
    v_cvt_pkrtz_f16_f32 v211, v182, v183
    s_waitcnt lgkmcnt(0)
    v_or_b32 v244, v228, v220
    v_cvt_pkrtz_f16_f32 v212, v184, v185
    v_cvt_pkrtz_f16_f32 v213, v186, v187
    v_cvt_pkrtz_f16_f32 v214, v188, v189
    v_cvt_pkrtz_f16_f32 v215, v190, v191
    v_mfma_f32_32x32x16_f16 v[176:191], a[48:51], v[128:131], 0
    v_pk_lshrrev_b16 v216, 3, v208 op_sel_hi:[0,1]
    v_pk_lshrrev_b16 v217, 3, v209 op_sel_hi:[0,1]
    v_pk_lshrrev_b16 v218, 3, v210 op_sel_hi:[0,1]
    v_pk_lshrrev_b16 v219, 3, v211 op_sel_hi:[0,1]
    v_pk_lshrrev_b16 v220, 3, v212 op_sel_hi:[0,1]
    v_mad_u32_u16 v224, v216, 2, s85
    v_mfma_f32_32x32x16_f16 v[96:111], a[252:255], v[240:243], v[96:111]
    ds_read_u16 v224, v224
    v_mad_u32_u16 v216, v216, 2, s85 op_sel:[1,0,0,0]
    v_mad_u32_u16 v225, v217, 2, s85
    v_mad_u32_u16 v217, v217, 2, s85 op_sel:[1,0,0,0]
    v_mad_u32_u16 v226, v218, 2, s85
    v_mad_u32_u16 v218, v218, 2, s85 op_sel:[1,0,0,0]
    v_mfma_f32_32x32x16_f16 v[176:191], a[52:55], v[132:135], v[176:191]
    ds_read_u16_d16_hi v216, v216
    ds_read_u16 v225, v225
    v_mad_u32_u16 v227, v219, 2, s85
    v_mad_u32_u16 v219, v219, 2, s85 op_sel:[1,0,0,0]
    v_mad_u32_u16 v228, v220, 2, s85
    v_mad_u32_u16 v220, v220, 2, s85 op_sel:[1,0,0,0]
    v_mfma_f32_32x32x16_f16 v[112:127], a[232:235], v[240:243], v[112:127]
    ds_read_u16_d16_hi v217, v217
    v_pk_fma_f16 v221, v213, v213, s53
    v_pk_fma_f16 v222, v214, v214, s53
    v_pk_fma_f16 v223, v215, v215, s53
    v_pk_mul_f16 v221, v221, v213 neg_lo:[1,0] neg_hi:[1,0]
    v_pk_mul_f16 v222, v222, v214 neg_lo:[1,0] neg_hi:[1,0]
    v_mfma_f32_32x32x16_f16 v[176:191], a[56:59], v[136:139], v[176:191]
    ds_read_u16 v226, v226
    v_pk_mul_f16 v223, v223, v215 neg_lo:[1,0] neg_hi:[1,0]
    v_exp_f16 v229, v221
    v_exp_f16 v230, v222
    v_mfma_f32_32x32x16_f16 v[80:95], a[236:239], v[244:247], v[80:95]
    ds_read_u16_d16_hi v218, v218
    v_exp_f16 v231, v223
    v_exp_f16_sdwa v229, v221 dst_sel:WORD_1 dst_unused:UNUSED_PRESERVE src0_sel:WORD_1
    v_exp_f16_sdwa v230, v222 dst_sel:WORD_1 dst_unused:UNUSED_PRESERVE src0_sel:WORD_1
    v_mfma_f32_32x32x16_f16 v[176:191], a[60:63], v[140:143], v[176:191]
    ds_read_u16 v227, v227
    v_exp_f16_sdwa v231, v223 dst_sel:WORD_1 dst_unused:UNUSED_PRESERVE src0_sel:WORD_1
    v_pk_add_f16 v229, v229, 1.0 op_sel_hi:[1,0]
    v_pk_add_f16 v230, v230, 1.0 op_sel_hi:[1,0]
    v_pk_add_f16 v231, v231, 1.0 op_sel_hi:[1,0]
    v_mfma_f32_32x32x16_f16 v[176:191], a[64:67], v[144:147], v[176:191]
    ds_read_u16_d16_hi v219, v219
    v_rcp_f16 v221, v229
    v_rcp_f16 v222, v230
    v_rcp_f16 v223, v231
    v_mfma_f32_32x32x16_f16 v[176:191], a[68:71], v[148:151], v[176:191]
    ds_read_u16 v228, v228
    v_rcp_f16_sdwa v221, v229 dst_sel:WORD_1 dst_unused:UNUSED_PRESERVE src0_sel:WORD_1
    v_rcp_f16_sdwa v222, v230 dst_sel:WORD_1 dst_unused:UNUSED_PRESERVE src0_sel:WORD_1
    v_rcp_f16_sdwa v223, v231 dst_sel:WORD_1 dst_unused:UNUSED_PRESERVE src0_sel:WORD_1
    v_mfma_f32_32x32x16_f16 v[96:111], a[240:243], v[244:247], v[96:111]
    s_waitcnt lgkmcnt(2)
    ds_read_u16_d16_hi v220, v220
    v_or_b32 v232, v224, v216
    v_or_b32 v233, v225, v217
    v_or_b32 v234, v226, v218
    s_waitcnt lgkmcnt(2)
    v_or_b32 v235, v227, v219
    v_pk_mul_f16 v237, v221, v213
    v_mfma_f32_32x32x16_f16 v[112:127], a[244:247], v[244:247], v[112:127]
    v_pk_mul_f16 v238, v222, v214
    v_pk_mul_f16 v239, v223, v215
    v_cvt_pkrtz_f16_f32 v208, v176, v177
    v_cvt_pkrtz_f16_f32 v209, v178, v179
    v_cvt_pkrtz_f16_f32 v210, v180, v181
    v_cvt_pkrtz_f16_f32 v211, v182, v183
    v_mfma_f32_32x32x16_f16 v[32:47], a[24:27], v[232:235], v[32:47]
    s_waitcnt lgkmcnt(1)
    v_cvt_pkrtz_f16_f32 v212, v184, v185
    v_cvt_pkrtz_f16_f32 v213, v186, v187
    s_waitcnt lgkmcnt(0)
    v_or_b32 v236, v228, v220
    v_cvt_pkrtz_f16_f32 v214, v188, v189
    v_cvt_pkrtz_f16_f32 v215, v190, v191
    v_pk_lshrrev_b16 v216, 3, v208 op_sel_hi:[0,1]
    v_mfma_f32_32x32x16_f16 v[176:191], a[96:99], v[128:131], 0
    v_pk_lshrrev_b16 v217, 3, v209 op_sel_hi:[0,1]
    v_pk_lshrrev_b16 v218, 3, v210 op_sel_hi:[0,1]
    v_pk_lshrrev_b16 v219, 3, v211 op_sel_hi:[0,1]
    v_pk_lshrrev_b16 v220, 3, v212 op_sel_hi:[0,1]
    v_mad_u32_u16 v224, v216, 2, s85
    v_mad_u32_u16 v216, v216, 2, s85 op_sel:[1,0,0,0]
    v_mfma_f32_32x32x16_f16 v[48:63], a[32:35], v[232:235], v[48:63]
    ds_read_u16 v224, v224
    ds_read_u16_d16_hi v216, v216
    v_mad_u32_u16 v225, v217, 2, s85
    v_mad_u32_u16 v217, v217, 2, s85 op_sel:[1,0,0,0]
    v_mad_u32_u16 v226, v218, 2, s85
    v_mad_u32_u16 v218, v218, 2, s85 op_sel:[1,0,0,0]
    v_mfma_f32_32x32x16_f16 v[176:191], a[100:103], v[132:135], v[176:191]
    ds_read_u16 v225, v225
    v_mad_u32_u16 v227, v219, 2, s85
    v_mad_u32_u16 v219, v219, 2, s85 op_sel:[1,0,0,0]
    v_mad_u32_u16 v228, v220, 2, s85
    v_mad_u32_u16 v220, v220, 2, s85 op_sel:[1,0,0,0]
    v_pk_fma_f16 v221, v213, v213, s53
    v_mfma_f32_32x32x16_f16 v[64:79], a[40:43], v[232:235], v[64:79]
    ds_read_u16_d16_hi v217, v217
    v_pk_fma_f16 v222, v214, v214, s53
    v_pk_fma_f16 v223, v215, v215, s53
    v_pk_mul_f16 v221, v221, v213 neg_lo:[1,0] neg_hi:[1,0]
    v_pk_mul_f16 v222, v222, v214 neg_lo:[1,0] neg_hi:[1,0]
    v_pk_mul_f16 v223, v223, v215 neg_lo:[1,0] neg_hi:[1,0]
    v_mfma_f32_32x32x16_f16 v[176:191], a[104:107], v[136:139], v[176:191]
    ds_read_u16 v226, v226
    v_exp_f16 v229, v221
    v_exp_f16 v230, v222
    v_exp_f16 v231, v223
    v_mfma_f32_32x32x16_f16 v[32:47], a[28:31], v[236:239], v[32:47]
    ds_read_u16_d16_hi v218, v218
    v_exp_f16_sdwa v229, v221 dst_sel:WORD_1 dst_unused:UNUSED_PRESERVE src0_sel:WORD_1
    v_exp_f16_sdwa v230, v222 dst_sel:WORD_1 dst_unused:UNUSED_PRESERVE src0_sel:WORD_1
    v_exp_f16_sdwa v231, v223 dst_sel:WORD_1 dst_unused:UNUSED_PRESERVE src0_sel:WORD_1
    v_mfma_f32_32x32x16_f16 v[176:191], a[108:111], v[140:143], v[176:191]
    ds_read_u16 v227, v227
    v_pk_add_f16 v229, v229, 1.0 op_sel_hi:[1,0]
    v_pk_add_f16 v230, v230, 1.0 op_sel_hi:[1,0]
    v_pk_add_f16 v231, v231, 1.0 op_sel_hi:[1,0]
    v_rcp_f16 v221, v229
    v_mfma_f32_32x32x16_f16 v[176:191], a[112:115], v[144:147], v[176:191]
    ds_read_u16_d16_hi v219, v219
    v_rcp_f16 v222, v230
    v_rcp_f16 v223, v231
    v_rcp_f16_sdwa v221, v229 dst_sel:WORD_1 dst_unused:UNUSED_PRESERVE src0_sel:WORD_1
    v_mfma_f32_32x32x16_f16 v[176:191], a[116:119], v[148:151], v[176:191]
    s_waitcnt lgkmcnt(6)
    ds_read_u16 v228, v228
    v_rcp_f16_sdwa v222, v230 dst_sel:WORD_1 dst_unused:UNUSED_PRESERVE src0_sel:WORD_1
    v_rcp_f16_sdwa v223, v231 dst_sel:WORD_1 dst_unused:UNUSED_PRESERVE src0_sel:WORD_1
    v_or_b32 v232, v224, v216
    v_mfma_f32_32x32x16_f16 v[48:63], a[36:39], v[236:239], v[48:63]
    s_waitcnt lgkmcnt(1)
    ds_read_u16_d16_hi v220, v220
    v_or_b32 v233, v225, v217
    v_or_b32 v234, v226, v218
    v_or_b32 v235, v227, v219
    v_mfma_f32_32x32x16_f16 v[64:79], a[44:47], v[236:239], v[64:79]
    v_pk_mul_f16 v237, v221, v213
    v_pk_mul_f16 v238, v222, v214
    v_pk_mul_f16 v239, v223, v215
    v_cvt_pkrtz_f16_f32 v208, v176, v177
    v_cvt_pkrtz_f16_f32 v209, v178, v179
    v_cvt_pkrtz_f16_f32 v210, v180, v181
    v_mfma_f32_32x32x16_f16 v[32:47], a[72:75], v[232:235], v[32:47]
    s_waitcnt lgkmcnt(1)
    v_cvt_pkrtz_f16_f32 v211, v182, v183
    v_cvt_pkrtz_f16_f32 v212, v184, v185
    s_waitcnt lgkmcnt(0)
    v_or_b32 v236, v228, v220
    v_cvt_pkrtz_f16_f32 v213, v186, v187
    v_cvt_pkrtz_f16_f32 v214, v188, v189
    v_cvt_pkrtz_f16_f32 v215, v190, v191
    v_mfma_f32_32x32x16_f16 v[176:191], a[144:147], v[128:131], 0
    v_pk_lshrrev_b16 v216, 3, v208 op_sel_hi:[0,1]
    v_pk_lshrrev_b16 v217, 3, v209 op_sel_hi:[0,1]
    v_pk_lshrrev_b16 v218, 3, v210 op_sel_hi:[0,1]
    v_pk_lshrrev_b16 v219, 3, v211 op_sel_hi:[0,1]
    v_pk_lshrrev_b16 v220, 3, v212 op_sel_hi:[0,1]
    v_mad_u32_u16 v224, v216, 2, s85
    v_mfma_f32_32x32x16_f16 v[48:63], a[80:83], v[232:235], v[48:63]
    ds_read_u16 v224, v224
    v_mad_u32_u16 v216, v216, 2, s85 op_sel:[1,0,0,0]
    v_mad_u32_u16 v225, v217, 2, s85
    v_mad_u32_u16 v217, v217, 2, s85 op_sel:[1,0,0,0]
    v_mad_u32_u16 v226, v218, 2, s85
    v_mad_u32_u16 v218, v218, 2, s85 op_sel:[1,0,0,0]
    v_mfma_f32_32x32x16_f16 v[176:191], a[148:151], v[132:135], v[176:191]
    ds_read_u16_d16_hi v216, v216
    ds_read_u16 v225, v225
    v_mad_u32_u16 v227, v219, 2, s85
    v_mad_u32_u16 v219, v219, 2, s85 op_sel:[1,0,0,0]
    v_mad_u32_u16 v228, v220, 2, s85
    v_mad_u32_u16 v220, v220, 2, s85 op_sel:[1,0,0,0]
    v_mfma_f32_32x32x16_f16 v[64:79], a[88:91], v[232:235], v[64:79]
    ds_read_u16_d16_hi v217, v217
    v_pk_fma_f16 v221, v213, v213, s53
    v_pk_fma_f16 v222, v214, v214, s53
    v_pk_fma_f16 v223, v215, v215, s53
    v_pk_mul_f16 v221, v221, v213 neg_lo:[1,0] neg_hi:[1,0]
    v_pk_mul_f16 v222, v222, v214 neg_lo:[1,0] neg_hi:[1,0]
    v_mfma_f32_32x32x16_f16 v[176:191], a[152:155], v[136:139], v[176:191]
    ds_read_u16 v226, v226
    v_pk_mul_f16 v223, v223, v215 neg_lo:[1,0] neg_hi:[1,0]
    v_exp_f16 v229, v221
    v_exp_f16 v230, v222
    v_mfma_f32_32x32x16_f16 v[32:47], a[76:79], v[236:239], v[32:47]
    ds_read_u16_d16_hi v218, v218
    v_exp_f16 v231, v223
    v_exp_f16_sdwa v229, v221 dst_sel:WORD_1 dst_unused:UNUSED_PRESERVE src0_sel:WORD_1
    v_exp_f16_sdwa v230, v222 dst_sel:WORD_1 dst_unused:UNUSED_PRESERVE src0_sel:WORD_1
    v_mfma_f32_32x32x16_f16 v[176:191], a[156:159], v[140:143], v[176:191]
    ds_read_u16 v227, v227
    v_exp_f16_sdwa v231, v223 dst_sel:WORD_1 dst_unused:UNUSED_PRESERVE src0_sel:WORD_1
    v_pk_add_f16 v229, v229, 1.0 op_sel_hi:[1,0]
    v_pk_add_f16 v230, v230, 1.0 op_sel_hi:[1,0]
    v_pk_add_f16 v231, v231, 1.0 op_sel_hi:[1,0]
    v_mfma_f32_32x32x16_f16 v[176:191], a[160:163], v[144:147], v[176:191]
    ds_read_u16_d16_hi v219, v219
    v_rcp_f16 v221, v229
    v_rcp_f16 v222, v230
    v_rcp_f16 v223, v231
    v_mfma_f32_32x32x16_f16 v[176:191], a[164:167], v[148:151], v[176:191]
    ds_read_u16 v228, v228
    v_rcp_f16_sdwa v221, v229 dst_sel:WORD_1 dst_unused:UNUSED_PRESERVE src0_sel:WORD_1
    v_rcp_f16_sdwa v222, v230 dst_sel:WORD_1 dst_unused:UNUSED_PRESERVE src0_sel:WORD_1
    v_rcp_f16_sdwa v223, v231 dst_sel:WORD_1 dst_unused:UNUSED_PRESERVE src0_sel:WORD_1
    v_mfma_f32_32x32x16_f16 v[48:63], a[84:87], v[236:239], v[48:63]
    s_waitcnt lgkmcnt(2)
    ds_read_u16_d16_hi v220, v220
    v_or_b32 v232, v224, v216
    v_or_b32 v233, v225, v217
    v_or_b32 v234, v226, v218
    s_waitcnt lgkmcnt(2)
    v_or_b32 v235, v227, v219
    v_mfma_f32_32x32x16_f16 v[64:79], a[92:95], v[236:239], v[64:79]
    v_pk_mul_f16 v237, v221, v213
    v_pk_mul_f16 v238, v222, v214
    v_pk_mul_f16 v239, v223, v215
    v_cvt_pkrtz_f16_f32 v208, v176, v177
    v_cvt_pkrtz_f16_f32 v209, v178, v179
    v_cvt_pkrtz_f16_f32 v210, v180, v181
    v_mfma_f32_32x32x16_f16 v[32:47], a[120:123], v[232:235], v[32:47]
    s_waitcnt lgkmcnt(1)
    v_cvt_pkrtz_f16_f32 v211, v182, v183
    v_cvt_pkrtz_f16_f32 v212, v184, v185
    s_waitcnt lgkmcnt(0)
    v_or_b32 v236, v228, v220
    v_cvt_pkrtz_f16_f32 v213, v186, v187
    v_cvt_pkrtz_f16_f32 v214, v188, v189
    v_cvt_pkrtz_f16_f32 v215, v190, v191
    v_mfma_f32_32x32x16_f16 v[192:207], a[0:3], v[152:155], 0
    s_waitcnt vmcnt(1)
    ds_read_b128 a[232:235], v8 offset:0
    v_pk_lshrrev_b16 v216, 3, v208 op_sel_hi:[0,1]
    v_pk_lshrrev_b16 v217, 3, v209 op_sel_hi:[0,1]
    v_pk_lshrrev_b16 v218, 3, v210 op_sel_hi:[0,1]
    v_pk_lshrrev_b16 v219, 3, v211 op_sel_hi:[0,1]
    v_pk_lshrrev_b16 v220, 3, v212 op_sel_hi:[0,1]
    v_mfma_f32_32x32x16_f16 v[48:63], a[128:131], v[232:235], v[48:63]
    v_mad_u32_u16 v224, v216, 2, s85
    v_mad_u32_u16 v216, v216, 2, s85 op_sel:[1,0,0,0]
    v_mad_u32_u16 v225, v217, 2, s85
    v_mad_u32_u16 v217, v217, 2, s85 op_sel:[1,0,0,0]
    v_mad_u32_u16 v226, v218, 2, s85
    v_mad_u32_u16 v218, v218, 2, s85 op_sel:[1,0,0,0]
    v_mfma_f32_32x32x16_f16 v[192:207], a[4:7], v[156:159], v[192:207]
    ds_read_u16 v224, v224
    ds_read_u16_d16_hi v216, v216
    ds_read_u16 v225, v225
    v_mad_u32_u16 v227, v219, 2, s85
    v_mad_u32_u16 v219, v219, 2, s85 op_sel:[1,0,0,0]
    v_mad_u32_u16 v228, v220, 2, s85
    v_mfma_f32_32x32x16_f16 v[64:79], a[136:139], v[232:235], v[64:79]
    ds_read_b128 a[244:247], v8 offset:2560
    ds_read_u16_d16_hi v217, v217
    v_mad_u32_u16 v220, v220, 2, s85 op_sel:[1,0,0,0]
    v_pk_fma_f16 v221, v213, v213, s53
    v_pk_fma_f16 v222, v214, v214, s53
    v_pk_fma_f16 v223, v215, v215, s53
    v_mfma_f32_32x32x16_f16 v[192:207], a[8:11], v[160:163], v[192:207]
    ds_read_u16 v226, v226
    ds_read_b128 a[236:239], v12 offset:0
    v_pk_mul_f16 v221, v221, v213 neg_lo:[1,0] neg_hi:[1,0]
    v_pk_mul_f16 v222, v222, v214 neg_lo:[1,0] neg_hi:[1,0]
    v_pk_mul_f16 v223, v223, v215 neg_lo:[1,0] neg_hi:[1,0]
    v_exp_f16 v229, v221
    v_mfma_f32_32x32x16_f16 v[32:47], a[124:127], v[236:239], v[32:47]
    ds_read_u16_d16_hi v218, v218
    v_exp_f16 v230, v222
    v_exp_f16 v231, v223
    v_exp_f16_sdwa v229, v221 dst_sel:WORD_1 dst_unused:UNUSED_PRESERVE src0_sel:WORD_1
    v_mfma_f32_32x32x16_f16 v[192:207], a[12:15], v[164:167], v[192:207]
    ds_read_u16 v227, v227
    ds_read_b128 a[248:251], v12 offset:2560
    v_exp_f16_sdwa v230, v222 dst_sel:WORD_1 dst_unused:UNUSED_PRESERVE src0_sel:WORD_1
    v_exp_f16_sdwa v231, v223 dst_sel:WORD_1 dst_unused:UNUSED_PRESERVE src0_sel:WORD_1
    v_mfma_f32_32x32x16_f16 v[192:207], a[16:19], v[168:171], v[192:207]
    ds_read_u16_d16_hi v219, v219
    v_pk_add_f16 v229, v229, 1.0 op_sel_hi:[1,0]
    v_pk_add_f16 v230, v230, 1.0 op_sel_hi:[1,0]
    v_pk_add_f16 v231, v231, 1.0 op_sel_hi:[1,0]
    v_rcp_f16 v221, v229
    v_mfma_f32_32x32x16_f16 v[192:207], a[20:23], v[172:175], v[192:207]
    ds_read_u16 v228, v228
    ds_read_b128 a[240:243], v14 offset:1280
    v_rcp_f16 v222, v230
    v_rcp_f16 v223, v231
    v_mfma_f32_32x32x16_f16 v[48:63], a[132:135], v[236:239], v[48:63]
    s_waitcnt lgkmcnt(0)
    ds_read_u16_d16_hi v220, v220
    v_rcp_f16_sdwa v221, v229 dst_sel:WORD_1 dst_unused:UNUSED_PRESERVE src0_sel:WORD_1
    v_rcp_f16_sdwa v222, v230 dst_sel:WORD_1 dst_unused:UNUSED_PRESERVE src0_sel:WORD_1
    v_rcp_f16_sdwa v223, v231 dst_sel:WORD_1 dst_unused:UNUSED_PRESERVE src0_sel:WORD_1
    v_mfma_f32_32x32x16_f16 v[64:79], a[140:143], v[236:239], v[64:79]
    ds_read_b128 a[252:255], v14 offset:3840
    v_or_b32 v232, v224, v216
    v_or_b32 v233, v225, v217
    v_or_b32 v234, v226, v218
    v_pk_mul_f16 v237, v221, v213
    v_pk_mul_f16 v238, v222, v214
    v_pk_mul_f16 v239, v223, v215
    v_cvt_pkrtz_f16_f32 v208, v192, v193
    v_cvt_pkrtz_f16_f32 v209, v194, v195
    v_cvt_pkrtz_f16_f32 v210, v196, v197
    v_cvt_pkrtz_f16_f32 v211, v198, v199
    v_cvt_pkrtz_f16_f32 v212, v200, v201
    v_cvt_pkrtz_f16_f32 v213, v202, v203
    v_or_b32 v235, v227, v219
    v_cvt_pkrtz_f16_f32 v214, v204, v205
    v_cvt_pkrtz_f16_f32 v215, v206, v207
    v_mfma_f32_32x32x16_f16 v[32:47], a[168:171], v[232:235], v[32:47]
    v_pk_lshrrev_b16 v216, 3, v208 op_sel_hi:[0,1]
    v_pk_lshrrev_b16 v217, 3, v209 op_sel_hi:[0,1]
    v_pk_lshrrev_b16 v218, 3, v210 op_sel_hi:[0,1]
    v_pk_lshrrev_b16 v219, 3, v211 op_sel_hi:[0,1]
    v_mad_u32_u16 v224, v216, 2, s85
    v_mad_u32_u16 v216, v216, 2, s85 op_sel:[1,0,0,0]
    v_mfma_f32_32x32x16_f16 v[192:207], a[48:51], v[152:155], 0
    ds_read_u16 v224, v224
    v_mad_u32_u16 v225, v217, 2, s85
    v_mad_u32_u16 v217, v217, 2, s85 op_sel:[1,0,0,0]
    v_mad_u32_u16 v226, v218, 2, s85
    v_mad_u32_u16 v218, v218, 2, s85 op_sel:[1,0,0,0]
    v_mad_u32_u16 v227, v219, 2, s85
    v_mfma_f32_32x32x16_f16 v[48:63], a[176:179], v[232:235], v[48:63]
    s_waitcnt lgkmcnt(2)
    ds_read_u16_d16_hi v216, v216
    v_or_b32 v236, v228, v220
    v_pk_lshrrev_b16 v220, 3, v212 op_sel_hi:[0,1]
    v_mad_u32_u16 v219, v219, 2, s85 op_sel:[1,0,0,0]
    v_mad_u32_u16 v228, v220, 2, s85
    v_mad_u32_u16 v220, v220, 2, s85 op_sel:[1,0,0,0]
    v_mfma_f32_32x32x16_f16 v[192:207], a[52:55], v[156:159], v[192:207]
    ds_read_u16 v225, v225
    v_pk_fma_f16 v221, v213, v213, s53
    v_pk_fma_f16 v222, v214, v214, s53
    v_pk_fma_f16 v223, v215, v215, s53
    v_pk_mul_f16 v221, v221, v213 neg_lo:[1,0] neg_hi:[1,0]
    v_pk_mul_f16 v222, v222, v214 neg_lo:[1,0] neg_hi:[1,0]
    v_mfma_f32_32x32x16_f16 v[64:79], a[184:187], v[232:235], v[64:79]
    ds_read_u16_d16_hi v217, v217
    v_pk_mul_f16 v223, v223, v215 neg_lo:[1,0] neg_hi:[1,0]
    v_exp_f16 v229, v221
    v_exp_f16 v230, v222
    v_mfma_f32_32x32x16_f16 v[192:207], a[56:59], v[160:163], v[192:207]
    ds_read_u16 v226, v226
    v_exp_f16 v231, v223
    v_exp_f16_sdwa v229, v221 dst_sel:WORD_1 dst_unused:UNUSED_PRESERVE src0_sel:WORD_1
    v_exp_f16_sdwa v230, v222 dst_sel:WORD_1 dst_unused:UNUSED_PRESERVE src0_sel:WORD_1
    v_mfma_f32_32x32x16_f16 v[32:47], a[172:175], v[236:239], v[32:47]
    ds_read_u16_d16_hi v218, v218
    v_exp_f16_sdwa v231, v223 dst_sel:WORD_1 dst_unused:UNUSED_PRESERVE src0_sel:WORD_1
    v_pk_add_f16 v229, v229, 1.0 op_sel_hi:[1,0]
    v_pk_add_f16 v230, v230, 1.0 op_sel_hi:[1,0]
    v_pk_add_f16 v231, v231, 1.0 op_sel_hi:[1,0]
    v_mfma_f32_32x32x16_f16 v[192:207], a[60:63], v[164:167], v[192:207]
    ds_read_u16 v227, v227
    v_rcp_f16 v221, v229
    v_rcp_f16 v222, v230
    v_rcp_f16 v223, v231
    v_mfma_f32_32x32x16_f16 v[192:207], a[64:67], v[168:171], v[192:207]
    ds_read_u16_d16_hi v219, v219
    v_rcp_f16_sdwa v221, v229 dst_sel:WORD_1 dst_unused:UNUSED_PRESERVE src0_sel:WORD_1
    v_rcp_f16_sdwa v222, v230 dst_sel:WORD_1 dst_unused:UNUSED_PRESERVE src0_sel:WORD_1
    v_rcp_f16_sdwa v223, v231 dst_sel:WORD_1 dst_unused:UNUSED_PRESERVE src0_sel:WORD_1
    v_mfma_f32_32x32x16_f16 v[192:207], a[68:71], v[172:175], v[192:207]
    s_waitcnt lgkmcnt(2)
    ds_read_u16 v228, v228
    v_or_b32 v240, v224, v216
    v_or_b32 v241, v225, v217
    v_or_b32 v242, v226, v218
    v_pk_mul_f16 v245, v221, v213
    v_pk_mul_f16 v246, v222, v214
    v_mfma_f32_32x32x16_f16 v[48:63], a[180:183], v[236:239], v[48:63]
    s_waitcnt lgkmcnt(1)
    ds_read_u16_d16_hi v220, v220
    v_or_b32 v243, v227, v219
    v_pk_mul_f16 v247, v223, v215
    v_cvt_pk_bf16_f32 v32, v32, v33
    v_cvt_pk_bf16_f32 v33, v34, v35
    v_cvt_pkrtz_f16_f32 v208, v192, v193
    v_mfma_f32_32x32x16_f16 v[64:79], a[188:191], v[236:239], v[64:79]
    v_cvt_pkrtz_f16_f32 v209, v194, v195
    v_cvt_pkrtz_f16_f32 v210, v196, v197
    v_cvt_pkrtz_f16_f32 v211, v198, v199
    v_cvt_pkrtz_f16_f32 v212, v200, v201
    v_cvt_pkrtz_f16_f32 v213, v202, v203
    v_cvt_pkrtz_f16_f32 v214, v204, v205
    v_mfma_f32_32x32x16_f16 v[80:95], a[24:27], v[240:243], v[80:95]
    s_waitcnt lgkmcnt(1)
    v_cvt_pkrtz_f16_f32 v215, v206, v207
    v_pk_lshrrev_b16 v216, 3, v208 op_sel_hi:[0,1]
    s_waitcnt lgkmcnt(0)
    v_or_b32 v244, v228, v220
    v_pk_lshrrev_b16 v217, 3, v209 op_sel_hi:[0,1]
    v_pk_lshrrev_b16 v218, 3, v210 op_sel_hi:[0,1]
    v_pk_lshrrev_b16 v219, 3, v211 op_sel_hi:[0,1]
    v_mfma_f32_32x32x16_f16 v[192:207], a[96:99], v[152:155], 0
    ds_read_b128 v[176:179], v9 offset:0
    v_pk_lshrrev_b16 v220, 3, v212 op_sel_hi:[0,1]
    v_mad_u32_u16 v224, v216, 2, s85
    v_mad_u32_u16 v216, v216, 2, s85 op_sel:[1,0,0,0]
    v_mad_u32_u16 v225, v217, 2, s85
    v_mad_u32_u16 v217, v217, 2, s85 op_sel:[1,0,0,0]
    v_mfma_f32_32x32x16_f16 v[96:111], a[32:35], v[240:243], v[96:111]
    ds_read_u16 v224, v224
    ds_read_u16_d16_hi v216, v216
    v_mad_u32_u16 v226, v218, 2, s85
    v_mad_u32_u16 v218, v218, 2, s85 op_sel:[1,0,0,0]
    v_mad_u32_u16 v227, v219, 2, s85
    v_mad_u32_u16 v219, v219, 2, s85 op_sel:[1,0,0,0]
    v_mfma_f32_32x32x16_f16 v[192:207], a[100:103], v[156:159], v[192:207]
    ds_read_u16 v225, v225
    ds_read_b128 v[188:191], v9 offset:2560
    v_mad_u32_u16 v228, v220, 2, s85
    v_mad_u32_u16 v220, v220, 2, s85 op_sel:[1,0,0,0]
    v_cvt_pk_bf16_f32 v34, v36, v37
    v_cvt_pk_bf16_f32 v35, v38, v39
    v_mfma_f32_32x32x16_f16 v[112:127], a[40:43], v[240:243], v[112:127]
    ds_read_u16_d16_hi v217, v217
    v_cvt_pk_bf16_f32 v36, v40, v41
    v_cvt_pk_bf16_f32 v37, v42, v43
    v_cvt_pk_bf16_f32 v38, v44, v45
    v_cvt_pk_bf16_f32 v39, v46, v47
    v_permlane16_swap_b32 v32, v36
    v_mfma_f32_32x32x16_f16 v[192:207], a[104:107], v[160:163], v[192:207]
    ds_read_u16 v226, v226
    ds_read_b128 v[180:183], v13 offset:0
    v_permlane16_swap_b32 v33, v37
    v_permlane16_swap_b32 v34, v38
    v_mfma_f32_32x32x16_f16 v[80:95], a[28:31], v[244:247], v[80:95]
    ds_read_u16_d16_hi v218, v218
    v_permlane16_swap_b32 v35, v39
    v_cvt_pk_bf16_f32 v48, v48, v49
    v_cvt_pk_bf16_f32 v49, v50, v51
    v_cvt_pk_bf16_f32 v50, v52, v53
    v_mfma_f32_32x32x16_f16 v[192:207], a[108:111], v[164:167], v[192:207]
    buffer_store_dwordx4 v[32:35], v26, s[24:27], s80 offen offset:0 sc0 sc1
    ds_read_u16 v227, v227
    ds_read_b128 v[232:235], v13 offset:2560
    v_cvt_pk_bf16_f32 v51, v54, v55
    v_cvt_pk_bf16_f32 v52, v56, v57
    v_cvt_pk_bf16_f32 v53, v58, v59
    v_mfma_f32_32x32x16_f16 v[192:207], a[112:115], v[168:171], v[192:207]
    ds_read_u16_d16_hi v219, v219
    v_cvt_pk_bf16_f32 v54, v60, v61
    v_cvt_pk_bf16_f32 v55, v62, v63
    v_permlane16_swap_b32 v48, v52
    v_permlane16_swap_b32 v49, v53
    v_mfma_f32_32x32x16_f16 v[192:207], a[116:119], v[172:175], v[192:207]
    ds_read_u16 v228, v228
    ds_read_b128 v[184:187], v15 offset:1280
    v_permlane16_swap_b32 v50, v54
    v_permlane16_swap_b32 v51, v55
    v_mfma_f32_32x32x16_f16 v[96:111], a[36:39], v[244:247], v[96:111]
    s_waitcnt lgkmcnt(0)
    ds_read_u16_d16_hi v220, v220
    buffer_store_dwordx4 v[36:39], v26, s[24:27], s81 offen offset:0 sc0 sc1
    v_pk_fma_f16 v221, v213, v213, s53
    v_pk_fma_f16 v222, v214, v214, s53
    v_pk_fma_f16 v223, v215, v215, s53
    v_pk_mul_f16 v221, v221, v213 neg_lo:[1,0] neg_hi:[1,0]
    v_mfma_f32_32x32x16_f16 v[112:127], a[44:47], v[244:247], v[112:127]
    ds_read_b128 v[236:239], v15 offset:3840
    v_pk_mul_f16 v222, v222, v214 neg_lo:[1,0] neg_hi:[1,0]
    v_pk_mul_f16 v223, v223, v215 neg_lo:[1,0] neg_hi:[1,0]
    v_exp_f16 v229, v221
    v_exp_f16 v230, v222
    v_exp_f16 v231, v223
    v_exp_f16_sdwa v229, v221 dst_sel:WORD_1 dst_unused:UNUSED_PRESERVE src0_sel:WORD_1
    v_exp_f16_sdwa v230, v222 dst_sel:WORD_1 dst_unused:UNUSED_PRESERVE src0_sel:WORD_1
    v_exp_f16_sdwa v231, v223 dst_sel:WORD_1 dst_unused:UNUSED_PRESERVE src0_sel:WORD_1
    v_pk_add_f16 v229, v229, 1.0 op_sel_hi:[1,0]
    v_pk_add_f16 v230, v230, 1.0 op_sel_hi:[1,0]
    v_pk_add_f16 v231, v231, 1.0 op_sel_hi:[1,0]
    v_rcp_f16 v221, v229
    v_rcp_f16 v222, v230
    v_rcp_f16 v223, v231
    v_rcp_f16_sdwa v221, v229 dst_sel:WORD_1 dst_unused:UNUSED_PRESERVE src0_sel:WORD_1
    v_rcp_f16_sdwa v222, v230 dst_sel:WORD_1 dst_unused:UNUSED_PRESERVE src0_sel:WORD_1
    v_rcp_f16_sdwa v223, v231 dst_sel:WORD_1 dst_unused:UNUSED_PRESERVE src0_sel:WORD_1
    v_or_b32 v240, v224, v216
    v_or_b32 v241, v225, v217
    v_or_b32 v242, v226, v218
    v_or_b32 v243, v227, v219
    s_waitcnt lgkmcnt(1)
    v_or_b32 v244, v228, v220
    v_pk_mul_f16 v245, v221, v213
    v_mfma_f32_32x32x16_f16 v[80:95], a[72:75], v[240:243], v[80:95]
    v_pk_mul_f16 v246, v222, v214
    v_pk_mul_f16 v247, v223, v215
    v_cvt_pkrtz_f16_f32 v208, v192, v193
    v_cvt_pkrtz_f16_f32 v209, v194, v195
    v_cvt_pkrtz_f16_f32 v210, v196, v197
    v_cvt_pkrtz_f16_f32 v211, v198, v199
    v_cvt_pkrtz_f16_f32 v212, v200, v201
    v_cvt_pkrtz_f16_f32 v213, v202, v203
    v_cvt_pkrtz_f16_f32 v214, v204, v205
    v_cvt_pkrtz_f16_f32 v215, v206, v207
    v_mfma_f32_32x32x16_f16 v[192:207], a[144:147], v[152:155], 0
    v_pk_lshrrev_b16 v216, 3, v208 op_sel_hi:[0,1]
    v_pk_lshrrev_b16 v217, 3, v209 op_sel_hi:[0,1]
    v_pk_lshrrev_b16 v218, 3, v210 op_sel_hi:[0,1]
    v_pk_lshrrev_b16 v219, 3, v211 op_sel_hi:[0,1]
    v_pk_lshrrev_b16 v220, 3, v212 op_sel_hi:[0,1]
    v_mad_u32_u16 v224, v216, 2, s85
    v_mfma_f32_32x32x16_f16 v[96:111], a[80:83], v[240:243], v[96:111]
    ds_read_u16 v224, v224
    v_mad_u32_u16 v216, v216, 2, s85 op_sel:[1,0,0,0]
    v_mad_u32_u16 v225, v217, 2, s85
    v_mad_u32_u16 v217, v217, 2, s85 op_sel:[1,0,0,0]
    v_mad_u32_u16 v226, v218, 2, s85
    v_mad_u32_u16 v218, v218, 2, s85 op_sel:[1,0,0,0]
    v_mfma_f32_32x32x16_f16 v[192:207], a[148:151], v[156:159], v[192:207]
    ds_read_u16_d16_hi v216, v216
    ds_read_u16 v225, v225
    v_mad_u32_u16 v227, v219, 2, s85
    v_mad_u32_u16 v219, v219, 2, s85 op_sel:[1,0,0,0]
    v_mad_u32_u16 v228, v220, 2, s85
    v_mad_u32_u16 v220, v220, 2, s85 op_sel:[1,0,0,0]
    v_mfma_f32_32x32x16_f16 v[112:127], a[88:91], v[240:243], v[112:127]
    ds_read_u16_d16_hi v217, v217
    buffer_store_dwordx4 v[48:51], v26, s[24:27], s80 offen offset:64 sc0 sc1
    v_cvt_pk_bf16_f32 v64, v64, v65
    v_cvt_pk_bf16_f32 v65, v66, v67
    v_cvt_pk_bf16_f32 v66, v68, v69
    v_cvt_pk_bf16_f32 v67, v70, v71
    v_mfma_f32_32x32x16_f16 v[192:207], a[152:155], v[160:163], v[192:207]
    ds_read_u16 v226, v226
    v_cvt_pk_bf16_f32 v68, v72, v73
    v_cvt_pk_bf16_f32 v69, v74, v75
    v_cvt_pk_bf16_f32 v70, v76, v77
    v_cvt_pk_bf16_f32 v71, v78, v79
    v_permlane16_swap_b32 v64, v68
    v_mfma_f32_32x32x16_f16 v[80:95], a[76:79], v[244:247], v[80:95]
    ds_read_u16_d16_hi v218, v218
    v_permlane16_swap_b32 v65, v69
    v_permlane16_swap_b32 v66, v70
    v_permlane16_swap_b32 v67, v71
    v_mfma_f32_32x32x16_f16 v[192:207], a[156:159], v[164:167], v[192:207]
    ds_read_u16 v227, v227
    v_pk_fma_f16 v221, v213, v213, s53
    v_pk_fma_f16 v222, v214, v214, s53
    v_pk_fma_f16 v223, v215, v215, s53
    v_pk_mul_f16 v221, v221, v213 neg_lo:[1,0] neg_hi:[1,0]
    v_pk_mul_f16 v222, v222, v214 neg_lo:[1,0] neg_hi:[1,0]
    v_mfma_f32_32x32x16_f16 v[192:207], a[160:163], v[168:171], v[192:207]
    ds_read_u16_d16_hi v219, v219
    v_pk_mul_f16 v223, v223, v215 neg_lo:[1,0] neg_hi:[1,0]
    v_exp_f16 v229, v221
    v_exp_f16 v230, v222
    v_mfma_f32_32x32x16_f16 v[192:207], a[164:167], v[172:175], v[192:207]
    ds_read_u16 v228, v228
    v_exp_f16 v231, v223
    v_exp_f16_sdwa v229, v221 dst_sel:WORD_1 dst_unused:UNUSED_PRESERVE src0_sel:WORD_1
    v_exp_f16_sdwa v230, v222 dst_sel:WORD_1 dst_unused:UNUSED_PRESERVE src0_sel:WORD_1
    v_mfma_f32_32x32x16_f16 v[96:111], a[84:87], v[244:247], v[96:111]
    ds_read_u16_d16_hi v220, v220
    buffer_store_dwordx4 v[52:55], v26, s[24:27], s81 offen offset:64 sc0 sc1
    v_exp_f16_sdwa v231, v223 dst_sel:WORD_1 dst_unused:UNUSED_PRESERVE src0_sel:WORD_1
    v_pk_add_f16 v229, v229, 1.0 op_sel_hi:[1,0]
    v_pk_add_f16 v230, v230, 1.0 op_sel_hi:[1,0]
    v_mfma_f32_32x32x16_f16 v[112:127], a[92:95], v[244:247], v[112:127]
    s_waitcnt lgkmcnt(1)
    v_pk_add_f16 v231, v231, 1.0 op_sel_hi:[1,0]
    v_rcp_f16 v221, v229
    v_rcp_f16 v222, v230
    v_rcp_f16 v223, v231
    v_rcp_f16_sdwa v221, v229 dst_sel:WORD_1 dst_unused:UNUSED_PRESERVE src0_sel:WORD_1
    v_rcp_f16_sdwa v222, v230 dst_sel:WORD_1 dst_unused:UNUSED_PRESERVE src0_sel:WORD_1
    v_rcp_f16_sdwa v223, v231 dst_sel:WORD_1 dst_unused:UNUSED_PRESERVE src0_sel:WORD_1
    v_or_b32 v240, v224, v216
    v_or_b32 v241, v225, v217
    v_or_b32 v242, v226, v218
    v_or_b32 v243, v227, v219
    s_waitcnt lgkmcnt(0)
    v_or_b32 v244, v228, v220
    v_pk_mul_f16 v245, v221, v213
    v_mfma_f32_32x32x16_f16 v[80:95], a[120:123], v[240:243], v[80:95]
    v_pk_mul_f16 v246, v222, v214
    v_pk_mul_f16 v247, v223, v215
    v_cvt_pkrtz_f16_f32 v208, v192, v193
    v_cvt_pkrtz_f16_f32 v209, v194, v195
    v_cvt_pkrtz_f16_f32 v210, v196, v197
    v_cvt_pkrtz_f16_f32 v211, v198, v199
    v_mfma_f32_32x32x16_f16 v[96:111], a[128:131], v[240:243], v[96:111]
    ds_read_b128 v[192:195], v22 offset:0
    buffer_store_dwordx4 v[64:67], v26, s[24:27], s80 offen offset:128 sc0 sc1
    v_cvt_pkrtz_f16_f32 v212, v200, v201
    v_cvt_pkrtz_f16_f32 v213, v202, v203
    v_cvt_pkrtz_f16_f32 v214, v204, v205
    v_cvt_pkrtz_f16_f32 v215, v206, v207
    v_mfma_f32_32x32x16_f16 v[112:127], a[136:139], v[240:243], v[112:127]
    ds_read_b128 v[200:203], v22 offset:16
    ds_read_b128 v[196:199], v22 offset:256
    v_pk_lshrrev_b16 v216, 3, v208 op_sel_hi:[0,1]
    v_pk_lshrrev_b16 v217, 3, v209 op_sel_hi:[0,1]
    v_pk_lshrrev_b16 v218, 3, v210 op_sel_hi:[0,1]
    v_pk_lshrrev_b16 v219, 3, v211 op_sel_hi:[0,1]
    v_mfma_f32_32x32x16_f16 v[80:95], a[124:127], v[244:247], v[80:95]
    ds_read_b128 v[204:207], v22 offset:272
    v_pk_lshrrev_b16 v220, 3, v212 op_sel_hi:[0,1]
    v_mad_u32_u16 v224, v216, 2, s85
    v_mad_u32_u16 v216, v216, 2, s85 op_sel:[1,0,0,0]
    v_mad_u32_u16 v225, v217, 2, s85
    v_mad_u32_u16 v217, v217, 2, s85 op_sel:[1,0,0,0]
    v_mfma_f32_32x32x16_f16 v[96:111], a[132:135], v[244:247], v[96:111]
    ds_read_u16 v224, v224
    ds_read_u16_d16_hi v216, v216
    ds_read_u16 v225, v225
    v_mad_u32_u16 v226, v218, 2, s85
    v_mad_u32_u16 v218, v218, 2, s85 op_sel:[1,0,0,0]
    v_mad_u32_u16 v227, v219, 2, s85
    v_mfma_f32_32x32x16_f16 v[112:127], a[140:143], v[244:247], v[112:127]
    s_waitcnt lgkmcnt(5)
    ds_read_u16_d16_hi v217, v217
    ds_read_u16 v226, v226
    ds_read_u16_d16_hi v218, v218
    v_mad_u32_u16 v219, v219, 2, s85 op_sel:[1,0,0,0]
    v_mad_u32_u16 v228, v220, 2, s85
    v_mad_u32_u16 v220, v220, 2, s85 op_sel:[1,0,0,0]
    v_pk_fma_f16 v221, v213, v213, s53
    v_pk_fma_f16 v222, v214, v214, s53
    v_pk_fma_f16 v223, v215, v215, s53
    v_pk_mul_f16 v221, v221, v213 neg_lo:[1,0] neg_hi:[1,0]
    v_pk_mul_f16 v222, v222, v214 neg_lo:[1,0] neg_hi:[1,0]
    v_pk_mul_f16 v223, v223, v215 neg_lo:[1,0] neg_hi:[1,0]
    v_exp_f16 v229, v221
    v_exp_f16 v230, v222
    v_exp_f16 v231, v223
    s_waitcnt lgkmcnt(4)
    v_or_b32 v240, v224, v216
    v_exp_f16_sdwa v229, v221 dst_sel:WORD_1 dst_unused:UNUSED_PRESERVE src0_sel:WORD_1
    v_exp_f16_sdwa v230, v222 dst_sel:WORD_1 dst_unused:UNUSED_PRESERVE src0_sel:WORD_1
    v_exp_f16_sdwa v231, v223 dst_sel:WORD_1 dst_unused:UNUSED_PRESERVE src0_sel:WORD_1
    v_pk_add_f16 v229, v229, 1.0 op_sel_hi:[1,0]
    v_pk_add_f16 v230, v230, 1.0 op_sel_hi:[1,0]
    v_pk_add_f16 v231, v231, 1.0 op_sel_hi:[1,0]
    v_rcp_f16 v221, v229
    v_rcp_f16 v222, v230
    s_waitcnt lgkmcnt(2)
    v_or_b32 v241, v225, v217
    v_rcp_f16 v223, v231
    v_rcp_f16_sdwa v221, v229 dst_sel:WORD_1 dst_unused:UNUSED_PRESERVE src0_sel:WORD_1
    v_rcp_f16_sdwa v222, v230 dst_sel:WORD_1 dst_unused:UNUSED_PRESERVE src0_sel:WORD_1
    v_rcp_f16_sdwa v223, v231 dst_sel:WORD_1 dst_unused:UNUSED_PRESERVE src0_sel:WORD_1
    v_pk_mul_f16 v245, v221, v213
    v_pk_mul_f16 v246, v222, v214
    v_pk_mul_f16 v247, v223, v215
    s_waitcnt lgkmcnt(0)
    v_or_b32 v242, v226, v218
    ds_read_u16 v227, v227
    ds_read_u16_d16_hi v219, v219
    ds_read_b128 v[52:55], v20 offset:2560
    ds_read_u16 v228, v228
    ds_read_u16_d16_hi v220, v220
    buffer_store_dwordx4 v[68:71], v26, s[24:27], s81 offen offset:128 sc0 sc1
    ds_read_b128 v[48:51], v20 offset:0
    s_waitcnt lgkmcnt(4)
    v_or_b32 v243, v227, v219
    s_nop 1
    v_mfma_f32_32x32x16_f16 v[80:95], a[168:171], v[240:243], v[80:95]
    ds_read_b128 v[60:63], v21 offset:2560
    v_mfma_f32_32x32x16_f16 v[96:111], a[176:179], v[240:243], v[96:111]
    s_add_u32 s52, s52, 1
    ds_read_b128 v[56:59], v21 offset:0
    s_cmp_eq_u32 s52, 4
    v_mfma_f32_32x32x16_f16 v[112:127], a[184:187], v[240:243], v[112:127]
    s_waitcnt lgkmcnt(4)
    s_waitcnt lgkmcnt(3)
    v_or_b32 v244, v228, v220
    s_cbranch_scc0 L_conv
L_final:
    s_nop 0
    v_mfma_f32_32x32x16_f16 v[80:95], a[172:175], v[244:247], v[80:95]
    v_mfma_f32_32x32x16_f16 v[96:111], a[180:183], v[244:247], v[96:111]
    v_mfma_f32_32x32x16_f16 v[112:127], a[188:191], v[244:247], v[112:127]
    s_nop 9
    v_cvt_pk_bf16_f32 v80, v80, v81
    v_cvt_pk_bf16_f32 v81, v82, v83
    v_cvt_pk_bf16_f32 v82, v84, v85
    v_cvt_pk_bf16_f32 v83, v86, v87
    v_cvt_pk_bf16_f32 v84, v88, v89
    v_cvt_pk_bf16_f32 v85, v90, v91
    v_cvt_pk_bf16_f32 v86, v92, v93
    v_cvt_pk_bf16_f32 v87, v94, v95
    v_permlane16_swap_b32 v80, v84
    v_permlane16_swap_b32 v81, v85
    v_permlane16_swap_b32 v82, v86
    v_permlane16_swap_b32 v83, v87
    buffer_store_dwordx4 v[80:83], v26, s[24:27], s82 offen offset:0 sc0 sc1
    buffer_store_dwordx4 v[84:87], v26, s[24:27], s83 offen offset:0 sc0 sc1
    v_cvt_pk_bf16_f32 v96, v96, v97
    v_cvt_pk_bf16_f32 v97, v98, v99
    v_cvt_pk_bf16_f32 v98, v100, v101
    v_cvt_pk_bf16_f32 v99, v102, v103
    v_cvt_pk_bf16_f32 v100, v104, v105
    v_cvt_pk_bf16_f32 v101, v106, v107
    v_cvt_pk_bf16_f32 v102, v108, v109
    v_cvt_pk_bf16_f32 v103, v110, v111
    v_permlane16_swap_b32 v96, v100
    v_permlane16_swap_b32 v97, v101
    v_permlane16_swap_b32 v98, v102
    v_permlane16_swap_b32 v99, v103
    buffer_store_dwordx4 v[96:99], v26, s[24:27], s82 offen offset:64 sc0 sc1
    buffer_store_dwordx4 v[100:103], v26, s[24:27], s83 offen offset:64 sc0 sc1
    v_cvt_pk_bf16_f32 v112, v112, v113
    v_cvt_pk_bf16_f32 v113, v114, v115
    v_cvt_pk_bf16_f32 v114, v116, v117
    v_cvt_pk_bf16_f32 v115, v118, v119
    v_cvt_pk_bf16_f32 v116, v120, v121
    v_cvt_pk_bf16_f32 v117, v122, v123
    v_cvt_pk_bf16_f32 v118, v124, v125
    v_cvt_pk_bf16_f32 v119, v126, v127
    v_permlane16_swap_b32 v112, v116
    v_permlane16_swap_b32 v113, v117
    v_permlane16_swap_b32 v114, v118
    v_permlane16_swap_b32 v115, v119
    buffer_store_dwordx4 v[112:115], v26, s[24:27], s82 offen offset:128 sc0 sc1
    buffer_store_dwordx4 v[116:119], v26, s[24:27], s83 offen offset:128 sc0 sc1
L_end:
    s_endpgm
.section .rodata,"a"
.p2align 6
.amdhsa_kernel standalone__modern_conv_block_convnext__vision_kernel
  .amdhsa_next_free_vgpr 512
  .amdhsa_next_free_sgpr 102
  .amdhsa_accum_offset 256
  .amdhsa_group_segment_fixed_size 0
  .amdhsa_kernarg_size 80
  .amdhsa_user_sgpr_count 2
  .amdhsa_user_sgpr_kernarg_segment_ptr 1
  .amdhsa_system_sgpr_workgroup_id_x 1
.end_amdhsa_kernel
```

```asm
; @launch grid=(256,1,1) block=(256,1,1) lds=163840
.amdgcn_target "amdgcn-amd-amdhsa--gfx950"
.text
.globl standalone__modern_conv_block_convnext__vision_kernel
.p2align 8
.type standalone__modern_conv_block_convnext__vision_kernel,@function
standalone__modern_conv_block_convnext__vision_kernel:
    s_cmp_ge_u32 s2, 256
    s_cbranch_scc1 L_end
    s_load_dwordx16 s[4:19], s[0:1], 0
    v_lshrrev_b32 v128, 6, v0
    v_and_b32 v129, 63, v0
    v_readfirstlane_b32 s3, v128
    s_getpc_b64 s[60:61]
L_pc:
    v_lshlrev_b32 v18, 7, v0
    v_add_u32 v20, 256, v18
    v_add_u32 v18, L_end-L_pc-32640, v18
    v_mov_b32 v19, s61
    v_mov_b32 v21, s61
    v_add_co_u32 v20, vcc, s60, v20
    s_nop 1
    v_addc_co_u32 v21, vcc, 0, v21, vcc
    s_nop 1
    v_add_co_u32 v18, vcc, s60, v18
    s_nop 1
    v_addc_co_u32 v19, vcc, 0, v19, vcc
    v_cmp_gt_u32 vcc, (L_end-L_pc-32640-256+127)/128, v0
    s_nop 0
    s_and_saveexec_b64 s[62:63], vcc
    s_cbranch_execz L_cpf
    global_load_dword v250, v[20:21], off
L_cpf:
    s_mov_b64 exec, s[62:63]
    global_load_dword v251, v[18:19], off
    s_and_b32 s60, s2, 7
    s_lshl_b32 s60, s60, 5
    s_lshr_b32 s61, s2, 3
    s_add_u32 s60, s60, s61
    s_lshr_b32 s61, s60, 4
    s_and_b32 s60, s60, 15
    s_lshl_b32 s54, s61, 5
    s_lshl_b32 s60, s60, 5
    s_lshl_b32 s62, s3, 3
    s_add_u32 s55, s60, s62
    s_mul_i32 s61, s54, 98304
    s_mul_i32 s62, s55, 192
    s_add_u32 s63, s61, s62
    s_sub_u32 s64, s63, 98496
    s_sub_u32 s65, s55, 1
    s_mul_i32 s56, s3, 12800
    s_add_u32 s56, s56, 90112
    s_mov_b32 s68, 98304
    s_movk_i32 s69, 192
    v_lshrrev_b32 v128, 2, v129
    v_and_b32 v130, 3, v129
    v_mov_b32 v135, s64
    v_bfrev_b32 v136, 1
    v_mul_u32_u24 v131, 205, v128
    v_lshrrev_b32 v131, 11, v131
    v_mad_i32_i24 v132, v131, -10, v128
    v_bfe_u32 v133, v131, 1, 1
    v_bfe_u32 v134, v132, 2, 1
    v_lshl_or_b32 v133, v133, 1, v134
    v_xor_b32 v133, v133, v130
    v_mad_u32_u24 v131, v131, s68, v135
    v_lshl_add_u32 v131, v133, 4, v131
    v_mad_u32_u24 v131, v132, s69, v131
    v_add_u32 v132, s65, v132
    v_cmp_gt_u32 vcc, 0x200, v132
    s_nop 1
    v_cndmask_b32 v1, v136, v131, vcc
    v_add_u32 v128, 16, v128
    v_mul_u32_u24 v131, 205, v128
    v_lshrrev_b32 v131, 11, v131
    v_mad_i32_i24 v132, v131, -10, v128
    v_bfe_u32 v133, v131, 1, 1
    v_bfe_u32 v134, v132, 2, 1
    v_lshl_or_b32 v133, v133, 1, v134
    v_xor_b32 v133, v133, v130
    v_mad_u32_u24 v131, v131, s68, v135
    v_lshl_add_u32 v131, v133, 4, v131
    v_mad_u32_u24 v131, v132, s69, v131
    v_add_u32 v132, s65, v132
    v_cmp_gt_u32 vcc, 0x200, v132
    s_nop 1
    v_cndmask_b32 v2, v136, v131, vcc
    v_add_u32 v128, 16, v128
    v_mul_u32_u24 v131, 205, v128
    v_lshrrev_b32 v131, 11, v131
    v_mad_i32_i24 v132, v131, -10, v128
    v_bfe_u32 v133, v131, 1, 1
    v_bfe_u32 v134, v132, 2, 1
    v_lshl_or_b32 v133, v133, 1, v134
    v_xor_b32 v133, v133, v130
    v_mad_u32_u24 v131, v131, s68, v135
    v_lshl_add_u32 v131, v133, 4, v131
    v_mad_u32_u24 v131, v132, s69, v131
    v_add_u32 v132, s65, v132
    v_cmp_gt_u32 vcc, 0x200, v132
    s_nop 1
    v_cndmask_b32 v3, v136, v131, vcc
    v_add_u32 v128, 16, v128
    v_mul_u32_u24 v131, 205, v128
    v_lshrrev_b32 v131, 11, v131
    v_mad_i32_i24 v132, v131, -10, v128
    v_bfe_u32 v133, v131, 1, 1
    v_bfe_u32 v134, v132, 2, 1
    v_lshl_or_b32 v133, v133, 1, v134
    v_xor_b32 v133, v133, v130
    v_mad_u32_u24 v131, v131, s68, v135
    v_lshl_add_u32 v131, v133, 4, v131
    v_mad_u32_u24 v131, v132, s69, v131
    v_add_u32 v132, s65, v132
    v_cmp_gt_u32 vcc, 0x200, v132
    s_nop 1
    v_cndmask_b32 v4, v136, v131, vcc
    v_add_u32 v128, 16, v128
    v_mul_u32_u24 v131, 205, v128
    v_lshrrev_b32 v131, 11, v131
    v_mad_i32_i24 v132, v131, -10, v128
    v_bfe_u32 v133, v131, 1, 1
    v_bfe_u32 v134, v132, 2, 1
    v_lshl_or_b32 v133, v133, 1, v134
    v_xor_b32 v133, v133, v130
    v_mad_u32_u24 v131, v131, s68, v135
    v_lshl_add_u32 v131, v133, 4, v131
    v_mad_u32_u24 v131, v132, s69, v131
    v_add_u32 v132, s65, v132
    v_cmp_gt_u32 vcc, 0x200, v132
    s_nop 1
    v_cndmask_b32 v5, v136, v131, vcc
    v_add_u32 v128, 16, v128
    v_mul_u32_u24 v131, 205, v128
    v_lshrrev_b32 v131, 11, v131
    v_mad_i32_i24 v132, v131, -10, v128
    v_bfe_u32 v133, v131, 1, 1
    v_bfe_u32 v134, v132, 2, 1
    v_lshl_or_b32 v133, v133, 1, v134
    v_xor_b32 v133, v133, v130
    v_mad_u32_u24 v131, v131, s68, v135
    v_lshl_add_u32 v131, v133, 4, v131
    v_mad_u32_u24 v131, v132, s69, v131
    v_add_u32 v132, s65, v132
    v_cmp_gt_u32 vcc, 0x200, v132
    s_nop 1
    v_cndmask_b32 v6, v136, v131, vcc
    v_lshrrev_b32 v128, 4, v129
    v_add_u32 v128, 96, v128
    v_bfe_u32 v130, v129, 2, 2
    v_mul_u32_u24 v131, 205, v128
    v_lshrrev_b32 v131, 11, v131
    v_mad_i32_i24 v132, v131, -10, v128
    v_bfe_u32 v133, v131, 1, 1
    v_bfe_u32 v134, v132, 2, 1
    v_lshl_or_b32 v133, v133, 1, v134
    v_xor_b32 v133, v133, v130
    v_mad_u32_u24 v131, v131, s68, v135
    v_lshl_add_u32 v131, v133, 4, v131
    v_mad_u32_u24 v131, v132, s69, v131
    v_add_u32 v132, s65, v132
    v_cmp_gt_u32 vcc, 0x200, v132
    v_and_b32 v133, 3, v129
    v_lshl_add_u32 v131, v133, 2, v131
    v_cndmask_b32 v7, v136, v131, vcc
    s_cmp_lt_u32 s55, 504
    s_cselect_b32 s66, 10, 0
    v_add_u32 v135, 1856, v135
    v_mad_u32_u24 v131, v129, s68, v135
    v_cmp_gt_u32 vcc, s66, v129
    s_nop 1
    v_cndmask_b32 v31, v136, v131, vcc
    v_lshrrev_b32 v138, 5, v129
    v_mul_u32_u24 v139, 1366, v0
    v_lshrrev_b32 v139, 16, v139
    v_mul_u32_u24 v139, 384, v139
    v_lshl_add_u32 v139, v0, 2, v139
    v_lshlrev_b32 v140, 3, v0
    s_lshr_b32 s71, s2, 3
    s_lshl_b32 s71, s71, 2
    s_add_u32 s71, s71, s3
    s_mul_i32 s71, s71, 640
    v_lshlrev_b32 v141, 7, v129
    v_cmp_gt_u32 vcc, 5, v129
    s_nop 1
    v_cndmask_b32 v141, v136, v141, vcc
    s_waitcnt lgkmcnt(0)
    s_mov_b32 s20, s4
    s_mov_b32 s21, s5
    s_mov_b32 s22, 50331648
    s_mov_b32 s23, 0x20000
    s_mov_b32 s28, s6
    s_mov_b32 s29, s7
    s_mov_b32 s30, 1728
    s_mov_b32 s31, 0x20000
    s_mov_b32 s36, s14
    s_mov_b32 s37, s15
    s_mov_b32 s38, 192
    s_mov_b32 s39, 0x20000
    s_mov_b32 s40, s16
    s_mov_b32 s41, s17
    s_mov_b32 s42, 192
    s_mov_b32 s43, 0x20000
    s_mov_b32 s44, s8
    s_mov_b32 s45, s9
    s_mov_b32 s46, 73728
    s_mov_b32 s47, 0x20000
    s_mov_b32 s48, s12
    s_mov_b32 s49, s13
    s_mov_b32 s50, 73728
    s_mov_b32 s51, 0x20000
    s_mov_b32 s32, s10
    s_mov_b32 s33, s11
    s_mov_b32 s34, 768
    s_mov_b32 s35, 0x20000
    buffer_load_dword v142, v141, s[44:47], s71 offen
    buffer_load_dword v143, v141, s[48:51], s71 offen
    v_lshlrev_b32 v147, 7, v129
    buffer_load_dword v147, v147, s[32:35], 0 offen
    buffer_load_dword v144, v139, s[28:31], 0 offen
    buffer_load_dword v145, v139, s[28:31], 0 offen offset:192
    buffer_load_dword v146, v139, s[28:31], 0 offen offset:384
    buffer_load_dwordx2 v[148:149], v140, s[36:39], 0 offen
    buffer_load_dwordx2 v[150:151], v140, s[40:43], 0 offen
    s_cmp_ge_u32 s3, 2
    s_cbranch_scc1 L_prep1
L_prep0:
    v_bfe_u32 v158, v129, 2, 1
    v_bfe_u32 v159, v129, 3, 2
    v_lshl_add_u32 v158, v158, 2, v159
    v_mul_u32_u24 v158, 768, v158
    v_and_b32 v159, 3, v129
    v_lshl_add_u32 v236, v138, 2, v159
    v_lshlrev_b32 v236, 4, v236
    v_add_u32 v232, v158, v236
    v_and_b32 v159, 0x5c, v0
    v_cmp_eq_u32 vcc, 0x5c, v159
    s_mul_i32 s72, s3, 36864
    s_nop 0
    v_cndmask_b32 v237, v136, v236, vcc
    s_add_u32 m0, s56, 0
    s_nop 0
    buffer_load_dwordx4 v1, s[20:23], 0 offen offset:0 lds
    s_add_u32 m0, s56, 1024
    s_nop 0
    buffer_load_dwordx4 v2, s[20:23], 0 offen offset:0 lds
    s_add_u32 m0, s56, 2048
    s_nop 0
    buffer_load_dwordx4 v3, s[20:23], 0 offen offset:0 lds
    s_add_u32 m0, s56, 3072
    s_nop 0
    buffer_load_dwordx4 v4, s[20:23], 0 offen offset:0 lds
    s_add_u32 m0, s56, 4096
    s_nop 0
    buffer_load_dwordx4 v5, s[20:23], 0 offen offset:0 lds
    s_add_u32 m0, s56, 5120
    s_nop 0
    buffer_load_dwordx4 v6, s[20:23], 0 offen offset:0 lds
    s_add_u32 m0, s56, 6144
    s_nop 0
    buffer_load_dword v7, s[20:23], 0 offen offset:0 lds
    v_mov_b32 v157, 268435456
    v_and_b32 v152, 15, v129
    v_lshrrev_b32 v153, 4, v129
    v_add_u32 v154, 4, v152
    v_lshrrev_b32 v154, 3, v154
    v_mad_i32_i24 v155, v154, -4, v152
    v_and_b32 v154, 1, v154
    v_and_b32 v156, 1, v153
    v_lshlrev_b32 v158, 1, v154
    v_mul_u32_u24 v159, 98304, v158
    v_mad_u32_u24 v159, v155, s69, v159
    v_lshl_add_u32 v159, v138, 4, v159
    v_lshl_add_u32 v159, v156, 5, v159
    v_add_u32 v26, s63, v159
    v_xor_b32 v161, v154, v138
    v_add_u32 v159, v158, v153
    v_add_u32 v160, 0, v155
    v_mad_u32_u24 v159, v159, 10, v160
    v_bfe_u32 v160, v160, 2, 1
    v_lshl_or_b32 v160, v161, 1, v160
    v_lshl_add_u32 v160, v159, 2, v160
    v_lshl_add_u32 v8, v160, 4, s56
    v_add_u32 v162, 1, v156
    v_add_u32 v159, v158, v138
    v_add_u32 v160, v162, v155
    v_mad_u32_u24 v159, v159, 10, v160
    v_bfe_u32 v160, v160, 2, 1
    v_lshl_or_b32 v160, v154, 1, v160
    v_lshl_add_u32 v160, v159, 2, v160
    v_lshl_add_u32 v12, v160, 4, s56
    v_xor_b32 v9, 16, v8
    v_xor_b32 v10, 32, v8
    v_xor_b32 v11, 48, v8
    v_xor_b32 v13, 16, v12
    v_xor_b32 v14, 32, v12
    v_xor_b32 v15, 48, v12
    v_xor_b32 v161, v154, v156
    v_add_u32 v159, v158, v162
    v_add_u32 v160, 1, v155
    v_mad_u32_u24 v159, v159, 10, v160
    v_bfe_u32 v160, v160, 2, 1
    v_lshl_or_b32 v160, v161, 1, v160
    v_xor_b32 v160, v138, v160
    v_lshl_add_u32 v160, v159, 2, v160
    v_lshl_add_u32 v20, v160, 4, s56
    v_xor_b32 v21, 32, v20
    v_bfe_u32 v158, v152, 2, 1
    v_sub_u32 v158, v153, v158
    v_and_b32 v159, 3, v152
    v_mul_u32_u24 v16, 0x1111, v159
    v_lshrrev_b32 v160, 3, v152
    v_lshl_add_u32 v159, v160, 2, v159
    v_lshlrev_b32 v159, 5, v159
    v_add_u32 v159, 141312, v159
    s_movk_i32 s70, 3072
    v_cmp_gt_u32 vcc, 3, v158
    v_mad_u32_u24 v159, v158, s70, v159
    s_nop 0
    v_cndmask_b32 v22, v157, v159, vcc
    v_lshlrev_b32 v23, 4, v129
    v_add_u32 v24, 40960, v23
    v_lshlrev_b32 v25, 4, v138
    v_add_u32 v25, 150528, v25
    v_bfe_u32 v158, v129, 1, 1
    v_bfe_u32 v159, v129, 3, 2
    v_lshl_add_u32 v158, v159, 1, v158
    v_bfe_u32 v159, v129, 2, 1
    v_cmp_eq_u32 vcc, v159, v138
    v_and_b32 v160, 1, v129
    v_lshlrev_b32 v160, 4, v160
    v_mov_b32 v161, 0x3f80
    v_lshlrev_b32 v160, v160, v161
    v_cndmask_b32 v158, 15, v158, vcc
    v_cmp_eq_u32 vcc, 0, v158
    s_nop 1
    v_cndmask_b32 v162, 0, v160, vcc
    v_cmp_eq_u32 vcc, 1, v158
    s_nop 1
    v_cndmask_b32 v163, 0, v160, vcc
    v_cmp_eq_u32 vcc, 2, v158
    s_nop 1
    v_cndmask_b32 v164, 0, v160, vcc
    v_cmp_eq_u32 vcc, 3, v158
    s_nop 1
    v_cndmask_b32 v165, 0, v160, vcc
    v_cmp_eq_u32 vcc, 4, v158
    s_nop 1
    v_cndmask_b32 v166, 0, v160, vcc
    v_cmp_eq_u32 vcc, 5, v158
    s_nop 1
    v_cndmask_b32 v167, 0, v160, vcc
    v_cmp_eq_u32 vcc, 6, v158
    s_nop 1
    v_cndmask_b32 v168, 0, v160, vcc
    v_cmp_eq_u32 vcc, 7, v158
    s_nop 1
    v_cndmask_b32 v169, 0, v160, vcc
    v_accvgpr_write_b32 a224, v162
    v_accvgpr_write_b32 a225, v163
    v_accvgpr_write_b32 a226, v164
    v_accvgpr_write_b32 a227, v165
    v_accvgpr_write_b32 a228, v166
    v_accvgpr_write_b32 a229, v167
    v_accvgpr_write_b32 a230, v168
    v_accvgpr_write_b32 a231, v169
    s_mov_b32 s24, s18
    s_mov_b32 s25, s19
    s_mov_b32 s26, 50331648
    s_mov_b32 s27, 0x20000
    s_mov_b32 s52, 0
    s_mov_b32 s80, 0
    s_mov_b32 s81, 98304
    s_mov_b32 s82, 393216
    s_mov_b32 s83, 491520
    s_mov_b32 s53, 1156203754
    s_mov_b32 s58, 0x3c003c00
    s_mov_b32 s85, 150912
    s_mov_b32 s86, 0xffffffff
    s_mov_b32 s59, 0x3eeff558
    s_mov_b32 s84, 0x37800000
    v_lshlrev_b32 v17, 4, v138
    v_lshrrev_b32 v17, v17, -1
    s_mul_i32 s60, s3, 3072
    v_add_u32 v234, s60, v24
    s_mov_b32 s73, 0x409d30fc
    v_mul_u32_u24 v252, 0x100010, v0
    v_add_u32 v252, 0xc0004, v252
    v_lshlrev_b32 v253, 2, v0
    v_add_u32 v253, 150912, v253
    v_add_u32 v80, 0x0, v252
    v_add_u32 v88, 0x10001000, v252
    v_add_u32 v96, 0x20002000, v252
    v_add_u32 v104, 0x30003000, v252
    v_cvt_f32_f16 v81, v80
    v_cvt_f32_f16 v89, v88
    v_cvt_f32_f16 v97, v96
    v_cvt_f32_f16 v105, v104
    v_cvt_f32_f16_sdwa v82, v80 dst_sel:DWORD dst_unused:UNUSED_PAD src0_sel:WORD_1
    v_cvt_f32_f16_sdwa v90, v88 dst_sel:DWORD dst_unused:UNUSED_PAD src0_sel:WORD_1
    v_cvt_f32_f16_sdwa v98, v96 dst_sel:DWORD dst_unused:UNUSED_PAD src0_sel:WORD_1
    v_cvt_f32_f16_sdwa v106, v104 dst_sel:DWORD dst_unused:UNUSED_PAD src0_sel:WORD_1
    v_fma_f32 v83, v81, v81, s73
    v_fma_f32 v91, v89, v89, s73
    v_fma_f32 v99, v97, v97, s73
    v_fma_f32 v107, v105, v105, s73
    v_fma_f32 v84, v82, v82, s73
    v_fma_f32 v92, v90, v90, s73
    v_fma_f32 v100, v98, v98, s73
    v_fma_f32 v108, v106, v106, s73
    v_mul_f32 v83, -v81, v83
    v_mul_f32 v91, -v89, v91
    v_mul_f32 v99, -v97, v99
    v_mul_f32 v107, -v105, v107
    v_mul_f32 v84, -v82, v84
    v_mul_f32 v92, -v90, v92
    v_mul_f32 v100, -v98, v100
    v_mul_f32 v108, -v106, v108
    v_exp_f32 v83, v83
    v_exp_f32 v91, v91
    v_exp_f32 v99, v99
    v_exp_f32 v107, v107
    v_exp_f32 v84, v84
    v_exp_f32 v92, v92
    v_exp_f32 v100, v100
    v_exp_f32 v108, v108
    v_add_f32 v83, 1.0, v83
    v_add_f32 v91, 1.0, v91
    v_add_f32 v99, 1.0, v99
    v_add_f32 v107, 1.0, v107
    v_add_f32 v84, 1.0, v84
    v_add_f32 v92, 1.0, v92
    v_add_f32 v100, 1.0, v100
    v_add_f32 v108, 1.0, v108
    v_rcp_f32 v83, v83
    v_rcp_f32 v91, v91
    v_rcp_f32 v99, v99
    v_rcp_f32 v107, v107
    v_rcp_f32 v84, v84
    v_rcp_f32 v92, v92
    v_rcp_f32 v100, v100
    v_rcp_f32 v108, v108
    v_mul_f32 v83, v81, v83
    v_mul_f32 v91, v89, v91
    v_mul_f32 v99, v97, v99
    v_mul_f32 v107, v105, v107
    v_mul_f32 v84, v82, v84
    v_mul_f32 v92, v90, v92
    v_mul_f32 v100, v98, v100
    v_mul_f32 v108, v106, v108
    v_cvt_pk_bf16_f32 v80, v83, v84
    v_cvt_pk_bf16_f32 v88, v91, v92
    v_cvt_pk_bf16_f32 v96, v99, v100
    v_cvt_pk_bf16_f32 v104, v107, v108
    ds_write_b32 v253, v80 offset:0
    ds_write_b32 v253, v88 offset:1024
    ds_write_b32 v253, v96 offset:2048
    ds_write_b32 v253, v104 offset:3072
    v_add_u32 v80, 0x40004000, v252
    v_add_u32 v88, 0x50005000, v252
    v_add_u32 v96, 0x60006000, v252
    v_cvt_f32_f16 v81, v80
    v_cvt_f32_f16 v89, v88
    v_cvt_f32_f16 v97, v96
    v_cvt_f32_f16_sdwa v82, v80 dst_sel:DWORD dst_unused:UNUSED_PAD src0_sel:WORD_1
    v_cvt_f32_f16_sdwa v90, v88 dst_sel:DWORD dst_unused:UNUSED_PAD src0_sel:WORD_1
    v_cvt_f32_f16_sdwa v98, v96 dst_sel:DWORD dst_unused:UNUSED_PAD src0_sel:WORD_1
    v_fma_f32 v83, v81, v81, s73
    v_fma_f32 v91, v89, v89, s73
    v_fma_f32 v99, v97, v97, s73
    v_fma_f32 v84, v82, v82, s73
    v_fma_f32 v92, v90, v90, s73
    v_fma_f32 v100, v98, v98, s73
    v_mul_f32 v83, -v81, v83
    v_mul_f32 v91, -v89, v91
    v_mul_f32 v99, -v97, v99
    v_mul_f32 v84, -v82, v84
    v_mul_f32 v92, -v90, v92
    v_mul_f32 v100, -v98, v100
    v_exp_f32 v83, v83
    v_exp_f32 v91, v91
    v_exp_f32 v99, v99
    v_exp_f32 v84, v84
    v_exp_f32 v92, v92
    v_exp_f32 v100, v100
    v_add_f32 v83, 1.0, v83
    v_add_f32 v91, 1.0, v91
    v_add_f32 v99, 1.0, v99
    v_add_f32 v84, 1.0, v84
    v_add_f32 v92, 1.0, v92
    v_add_f32 v100, 1.0, v100
    v_rcp_f32 v83, v83
    v_rcp_f32 v91, v91
    v_rcp_f32 v99, v99
    v_rcp_f32 v84, v84
    v_rcp_f32 v92, v92
    v_rcp_f32 v100, v100
    v_mul_f32 v83, v81, v83
    v_mul_f32 v91, v89, v91
    v_mul_f32 v99, v97, v99
    v_mul_f32 v84, v82, v84
    v_mul_f32 v92, v90, v92
    v_mul_f32 v100, v98, v100
    v_cvt_pk_bf16_f32 v80, v83, v84
    v_cvt_pk_bf16_f32 v88, v91, v92
    v_cvt_pk_bf16_f32 v96, v99, v100
    ds_write_b32 v253, v80 offset:4096
    ds_write_b32 v253, v88 offset:5120
    ds_write_b32 v253, v96 offset:6144
    v_add_u32 v80, 0x70007000, v252
    v_add_u32 v88, 0x80008000, v252
    v_add_u32 v96, 0x90009000, v252
    v_cvt_f32_f16 v81, v80
    v_cvt_f32_f16 v89, v88
    v_cvt_f32_f16 v97, v96
    v_cvt_f32_f16_sdwa v82, v80 dst_sel:DWORD dst_unused:UNUSED_PAD src0_sel:WORD_1
    v_cvt_f32_f16_sdwa v90, v88 dst_sel:DWORD dst_unused:UNUSED_PAD src0_sel:WORD_1
    v_cvt_f32_f16_sdwa v98, v96 dst_sel:DWORD dst_unused:UNUSED_PAD src0_sel:WORD_1
    v_fma_f32 v83, v81, v81, s73
    v_fma_f32 v91, v89, v89, s73
    v_fma_f32 v99, v97, v97, s73
    v_fma_f32 v84, v82, v82, s73
    v_fma_f32 v92, v90, v90, s73
    v_fma_f32 v100, v98, v98, s73
    v_mul_f32 v83, -v81, v83
    v_mul_f32 v91, -v89, v91
    v_mul_f32 v99, -v97, v99
    v_mul_f32 v84, -v82, v84
    v_mul_f32 v92, -v90, v92
    v_mul_f32 v100, -v98, v100
    v_exp_f32 v83, v83
    v_exp_f32 v91, v91
    v_exp_f32 v99, v99
    v_exp_f32 v84, v84
    v_exp_f32 v92, v92
    v_exp_f32 v100, v100
    v_add_f32 v83, 1.0, v83
    v_add_f32 v91, 1.0, v91
    v_add_f32 v99, 1.0, v99
    v_add_f32 v84, 1.0, v84
    v_add_f32 v92, 1.0, v92
    v_add_f32 v100, 1.0, v100
    v_rcp_f32 v83, v83
    v_rcp_f32 v91, v91
    v_rcp_f32 v99, v99
    v_rcp_f32 v84, v84
    v_rcp_f32 v92, v92
    v_rcp_f32 v100, v100
    v_mul_f32 v83, v81, v83
    v_mul_f32 v91, v89, v91
    v_mul_f32 v99, v97, v99
    v_mul_f32 v84, v82, v84
    v_mul_f32 v92, v90, v92
    v_mul_f32 v100, v98, v100
    v_cvt_pk_bf16_f32 v80, v83, v84
    v_cvt_pk_bf16_f32 v88, v91, v92
    v_cvt_pk_bf16_f32 v96, v99, v100
    ds_write_b32 v253, v80 offset:7168
    ds_write_b32 v253, v88 offset:8192
    ds_write_b32 v253, v96 offset:9216
    v_add_u32 v80, 0xa000a000, v252
    v_add_u32 v88, 0xb000b000, v252
    v_add_u32 v96, 0xc000c000, v252
    v_cvt_f32_f16 v81, v80
    v_cvt_f32_f16 v89, v88
    v_cvt_f32_f16 v97, v96
    v_cvt_f32_f16_sdwa v82, v80 dst_sel:DWORD dst_unused:UNUSED_PAD src0_sel:WORD_1
    v_cvt_f32_f16_sdwa v90, v88 dst_sel:DWORD dst_unused:UNUSED_PAD src0_sel:WORD_1
    v_cvt_f32_f16_sdwa v98, v96 dst_sel:DWORD dst_unused:UNUSED_PAD src0_sel:WORD_1
    v_fma_f32 v83, v81, v81, s73
    v_fma_f32 v91, v89, v89, s73
    v_fma_f32 v99, v97, v97, s73
    v_fma_f32 v84, v82, v82, s73
    v_fma_f32 v92, v90, v90, s73
    v_fma_f32 v100, v98, v98, s73
    v_mul_f32 v83, -v81, v83
    v_mul_f32 v91, -v89, v91
    v_mul_f32 v99, -v97, v99
    v_mul_f32 v84, -v82, v84
    v_mul_f32 v92, -v90, v92
    v_mul_f32 v100, -v98, v100
    v_exp_f32 v83, v83
    v_exp_f32 v91, v91
    v_exp_f32 v99, v99
    v_exp_f32 v84, v84
    v_exp_f32 v92, v92
    v_exp_f32 v100, v100
    v_add_f32 v83, 1.0, v83
    v_add_f32 v91, 1.0, v91
    v_add_f32 v99, 1.0, v99
    v_add_f32 v84, 1.0, v84
    v_add_f32 v92, 1.0, v92
    v_add_f32 v100, 1.0, v100
    v_rcp_f32 v83, v83
    v_rcp_f32 v91, v91
    v_rcp_f32 v99, v99
    v_rcp_f32 v84, v84
    v_rcp_f32 v92, v92
    v_rcp_f32 v100, v100
    v_mul_f32 v83, v81, v83
    v_mul_f32 v91, v89, v91
    v_mul_f32 v99, v97, v99
    v_mul_f32 v84, v82, v84
    v_mul_f32 v92, v90, v92
    v_mul_f32 v100, v98, v100
    v_cvt_pk_bf16_f32 v80, v83, v84
    v_cvt_pk_bf16_f32 v88, v91, v92
    v_cvt_pk_bf16_f32 v96, v99, v100
    ds_write_b32 v253, v80 offset:10240
    ds_write_b32 v253, v88 offset:11264
    ds_write_b32 v253, v96 offset:12288
    s_mov_b32 s74, 72960
    buffer_load_dwordx4 v[176:179], v236, s[44:47], s74 offen offset:0
    buffer_load_dwordx4 v[180:183], v236, s[44:47], s74 offen offset:128
    s_add_u32 s74, s72, 0
    s_add_u32 s75, s72, 6144
    buffer_load_dwordx4 a[0:3], v232, s[44:47], s74 offen offset:0
    buffer_load_dwordx4 a[4:7], v232, s[44:47], s74 offen offset:128
    buffer_load_dwordx4 a[8:11], v232, s[44:47], s75 offen offset:0
    buffer_load_dwordx4 a[12:15], v232, s[44:47], s75 offen offset:128
    s_add_u32 s74, s72, 12288
    s_add_u32 s75, s72, 18432
    buffer_load_dwordx4 a[16:19], v232, s[44:47], s74 offen offset:0
    buffer_load_dwordx4 a[20:23], v232, s[44:47], s74 offen offset:128
    buffer_load_dwordx4 a[24:27], v232, s[44:47], s75 offen offset:0
    buffer_load_dwordx4 a[28:31], v232, s[44:47], s75 offen offset:128
    v_lshlrev_b32 v158, 6, v0
    v_add_u32 v158, 141312, v158
    v_cmp_gt_u32 vcc, 144, v0
    s_nop 1
    v_cndmask_b32 v158, v157, v158, vcc
    v_and_b32 v159, 3, v0
    v_lshl_add_u32 v160, v159, 2, v158
    v_lshrrev_b32 v159, 1, v159
    v_lshl_add_u32 v159, v159, 2, v158
    v_and_b32 v161, 0x1c, v0
    v_bfe_u32 v162, v0, 1, 1
    v_and_b32 v163, 1, v0
    v_lshl_or_b32 v162, v163, 1, v162
    v_or_b32 v161, v161, v162
    v_lshlrev_b32 v161, 4, v161
    v_add_u32 v161, 150528, v161
    v_cmp_gt_u32 vcc, 24, v0
    s_nop 1
    v_cndmask_b32 v161, v157, v161, vcc
    v_mov_b32 v164, 0
    v_mov_b32 v165, 0
    v_mov_b32 v166, 0
    v_mov_b32 v167, 0
    ds_write_b128 v158, v[164:167]
    ds_write_b128 v158, v[164:167] offset:16
    s_waitcnt lgkmcnt(9)
    ds_write_b128 v158, v[164:167] offset:32
    ds_write_b128 v158, v[164:167] offset:48
    s_waitcnt vmcnt(21)
    ds_write_b16 v160, v144
    ds_write_b16_d16_hi v160, v144 offset:34
    s_waitcnt vmcnt(20)
    ds_write_b16 v159, v145 offset:16
    ds_write_b16_d16_hi v159, v145 offset:48
    s_waitcnt vmcnt(19) lgkmcnt(13)
    ds_write_b16 v159, v146 offset:24
    ds_write_b16_d16_hi v159, v146 offset:56
    s_waitcnt vmcnt(18)
    v_lshlrev_b32 v168, 16, v148
    v_and_b32 v169, 0xffff0000, v148
    v_lshlrev_b32 v170, 16, v149
    v_and_b32 v171, 0xffff0000, v149
    s_waitcnt vmcnt(17)
    v_lshlrev_b32 v172, 16, v150
    v_and_b32 v173, 0xffff0000, v150
    v_lshlrev_b32 v174, 16, v151
    v_and_b32 v175, 0xffff0000, v151
    v_mul_f32 v168, v168, v172
    v_mul_f32 v169, v169, v173
    v_mul_f32 v170, v170, v174
    v_mul_f32 v171, v171, v175
    s_waitcnt lgkmcnt(14)
    ds_write_b128 v161, v[168:171]
    buffer_load_dwordx4 v[200:203], v237, s[32:35], 0 offen offset:0
    buffer_load_dwordx4 v[204:207], v237, s[32:35], 0 offen offset:128
    s_add_u32 s74, s72, 24576
    s_add_u32 s75, s72, 30720
    buffer_load_dwordx4 a[32:35], v232, s[44:47], s74 offen offset:0
    buffer_load_dwordx4 a[36:39], v232, s[44:47], s74 offen offset:128
    buffer_load_dwordx4 a[40:43], v232, s[44:47], s75 offen offset:0
    buffer_load_dwordx4 a[44:47], v232, s[44:47], s75 offen offset:128
    s_mov_b32 s74, 73216
    buffer_load_dwordx4 v[184:187], v236, s[44:47], s74 offen offset:0
    buffer_load_dwordx4 v[188:191], v236, s[44:47], s74 offen offset:128
    s_add_u32 s74, s72, 0
    s_add_u32 s75, s72, 6144
    buffer_load_dwordx4 a[48:51], v232, s[44:47], s74 offen offset:256
    buffer_load_dwordx4 a[52:55], v232, s[44:47], s74 offen offset:384
    buffer_load_dwordx4 a[56:59], v232, s[44:47], s75 offen offset:256
    buffer_load_dwordx4 a[60:63], v232, s[44:47], s75 offen offset:384
    s_add_u32 s74, s72, 12288
    s_add_u32 s75, s72, 18432
    buffer_load_dwordx4 a[64:67], v232, s[44:47], s74 offen offset:256
    buffer_load_dwordx4 a[68:71], v232, s[44:47], s74 offen offset:384
    buffer_load_dwordx4 a[72:75], v232, s[44:47], s75 offen offset:256
    buffer_load_dwordx4 a[76:79], v232, s[44:47], s75 offen offset:384
    s_waitcnt vmcnt(25)
    v_xor_b32 v176, 0x80008000, v176
    v_xor_b32 v177, 0x80008000, v177
    v_xor_b32 v178, 0x80008000, v178
    v_xor_b32 v179, 0x80008000, v179
    s_waitcnt vmcnt(24)
    v_xor_b32 v180, 0x80008000, v180
    v_xor_b32 v181, 0x80008000, v181
    v_xor_b32 v182, 0x80008000, v182
    v_xor_b32 v183, 0x80008000, v183
    v_mfma_f32_32x32x16_bf16 v[144:159], v[176:179], a[224:227], 0
    s_nop 0
    v_mfma_f32_32x32x16_bf16 v[144:159], v[180:183], a[228:231], v[144:159]
    s_waitcnt vmcnt(23)
    s_nop 8
    v_mfma_f32_32x32x16_bf16 v[80:95], a[0:3], a[224:227], v[144:159]
    s_waitcnt vmcnt(21)
    v_mfma_f32_32x32x16_bf16 v[96:111], a[8:11], a[224:227], v[144:159]
    v_mfma_f32_32x32x16_bf16 v[80:95], a[4:7], a[228:231], v[80:95]
    s_waitcnt vmcnt(20)
    v_mfma_f32_32x32x16_bf16 v[96:111], a[12:15], a[228:231], v[96:111]
    s_waitcnt vmcnt(19)
    v_mfma_f32_32x32x16_bf16 v[112:127], a[16:19], a[224:227], v[144:159]
    s_nop 7
    v_cvt_pk_f16_f32 v224, v80, v84
    v_cvt_pk_f16_f32 v225, v88, v92
    v_cvt_pk_f16_f32 v226, v96, v100
    v_cvt_pk_f16_f32 v227, v104, v108
    s_waitcnt lgkmcnt(14)
    ds_write_b128 v234, v[224:227] offset:0
    buffer_load_dwordx4 v[208:211], v237, s[32:35], 0 offen offset:256
    buffer_load_dwordx4 v[212:215], v237, s[32:35], 0 offen offset:384
    s_waitcnt vmcnt(19)
    v_mfma_f32_32x32x16_bf16 v[128:143], a[24:27], a[224:227], v[144:159]
    v_cvt_pk_f16_f32 v228, v81, v85
    v_cvt_pk_f16_f32 v229, v89, v93
    v_cvt_pk_f16_f32 v230, v97, v101
    v_cvt_pk_f16_f32 v231, v105, v109
    s_waitcnt lgkmcnt(14)
    ds_write_b128 v234, v[228:231] offset:12288
    s_add_u32 s74, s72, 24576
    s_add_u32 s75, s72, 30720
    v_mfma_f32_32x32x16_bf16 v[112:127], a[20:23], a[228:231], v[112:127]
    v_cvt_pk_f16_f32 v224, v82, v86
    v_cvt_pk_f16_f32 v225, v90, v94
    v_cvt_pk_f16_f32 v226, v98, v102
    v_cvt_pk_f16_f32 v227, v106, v110
    s_waitcnt lgkmcnt(14)
    ds_write_b128 v234, v[224:227] offset:24576
    buffer_load_dwordx4 a[80:83], v232, s[44:47], s74 offen offset:256
    buffer_load_dwordx4 a[84:87], v232, s[44:47], s74 offen offset:384
    s_waitcnt vmcnt(20)
    v_mfma_f32_32x32x16_bf16 v[128:143], a[28:31], a[228:231], v[128:143]
    v_cvt_pk_f16_f32 v228, v83, v87
    v_cvt_pk_f16_f32 v229, v91, v95
    v_cvt_pk_f16_f32 v230, v99, v103
    v_cvt_pk_f16_f32 v231, v107, v111
    s_waitcnt lgkmcnt(14)
    ds_write_b128 v234, v[228:231] offset:36864
    buffer_load_dwordx4 a[88:91], v232, s[44:47], s75 offen offset:256
    buffer_load_dwordx4 a[92:95], v232, s[44:47], s75 offen offset:384
    s_waitcnt vmcnt(19)
    v_mfma_f32_32x32x16_bf16 v[80:95], a[32:35], a[224:227], v[144:159]
    v_cvt_pk_f16_f32 v224, v112, v116
    v_cvt_pk_f16_f32 v225, v120, v124
    s_waitcnt vmcnt(17)
    v_mfma_f32_32x32x16_bf16 v[96:111], a[40:43], a[224:227], v[144:159]
    v_cvt_pk_f16_f32 v226, v128, v132
    v_cvt_pk_f16_f32 v227, v136, v140
    s_waitcnt lgkmcnt(14)
    ds_write_b128 v234, v[224:227] offset:1024
    s_mov_b32 s74, 73472
    buffer_load_dwordx4 v[192:195], v236, s[44:47], s74 offen offset:0
    buffer_load_dwordx4 v[196:199], v236, s[44:47], s74 offen offset:128
    s_add_u32 s74, s72, 0
    v_mfma_f32_32x32x16_bf16 v[80:95], a[36:39], a[228:231], v[80:95]
    v_cvt_pk_f16_f32 v228, v113, v117
    v_cvt_pk_f16_f32 v229, v121, v125
    s_waitcnt vmcnt(18)
    v_mfma_f32_32x32x16_bf16 v[96:111], a[44:47], a[228:231], v[96:111]
    v_cvt_pk_f16_f32 v230, v129, v133
    v_cvt_pk_f16_f32 v231, v137, v141
    s_waitcnt lgkmcnt(14)
    ds_write_b128 v234, v[228:231] offset:13312
    s_add_u32 s75, s72, 6144
    buffer_load_dwordx4 v[32:35], v232, s[44:47], s74 offen offset:512
    buffer_load_dwordx4 v[36:39], v232, s[44:47], s74 offen offset:640
    buffer_load_dwordx4 v[40:43], v232, s[44:47], s75 offen offset:512
    buffer_load_dwordx4 v[44:47], v232, s[44:47], s75 offen offset:640
    v_mfma_f32_32x32x16_bf16 v[96:111], v[200:203], a[224:227], v[96:111]
    v_cvt_pk_f16_f32 v224, v114, v118
    v_cvt_pk_f16_f32 v225, v122, v126
    v_cvt_pk_f16_f32 v226, v130, v134
    v_cvt_pk_f16_f32 v227, v138, v142
    s_waitcnt lgkmcnt(14)
    ds_write_b128 v234, v[224:227] offset:25600
    s_waitcnt vmcnt(21)
    v_xor_b32 v184, 0x80008000, v184
    v_xor_b32 v185, 0x80008000, v185
    v_xor_b32 v186, 0x80008000, v186
    v_xor_b32 v187, 0x80008000, v187
    s_waitcnt vmcnt(20)
    v_xor_b32 v188, 0x80008000, v188
    v_mfma_f32_32x32x16_bf16 v[96:111], v[204:207], a[228:231], v[96:111]
    v_cvt_pk_f16_f32 v228, v115, v119
    v_cvt_pk_f16_f32 v229, v123, v127
    v_cvt_pk_f16_f32 v230, v131, v135
    v_cvt_pk_f16_f32 v231, v139, v143
    s_waitcnt lgkmcnt(14)
    ds_write_b128 v234, v[228:231] offset:37888
    v_xor_b32 v189, 0x80008000, v189
    v_xor_b32 v190, 0x80008000, v190
    v_xor_b32 v191, 0x80008000, v191
    v_mfma_f32_32x32x16_bf16 v[144:159], v[184:187], a[224:227], 0
    s_nop 0
    v_mfma_f32_32x32x16_bf16 v[144:159], v[188:191], a[228:231], v[144:159]
    s_waitcnt vmcnt(19)
    s_nop 8
    v_mfma_f32_32x32x16_bf16 v[112:127], a[48:51], a[224:227], v[144:159]
    v_cvt_pk_f16_f32 v224, v80, v84
    v_cvt_pk_f16_f32 v225, v88, v92
    v_cvt_pk_f16_f32 v226, v96, v100
    v_cvt_pk_f16_f32 v227, v104, v108
    s_waitcnt lgkmcnt(14)
    ds_write_b128 v234, v[224:227] offset:2048
    s_add_u32 s74, s72, 12288
    s_waitcnt vmcnt(17)
    v_mfma_f32_32x32x16_bf16 v[128:143], a[56:59], a[224:227], v[144:159]
    v_cvt_pk_f16_f32 v228, v81, v85
    v_cvt_pk_f16_f32 v229, v89, v93
    v_cvt_pk_f16_f32 v230, v97, v101
    v_cvt_pk_f16_f32 v231, v105, v109
    s_waitcnt lgkmcnt(14)
    ds_write_b128 v234, v[228:231] offset:14336
    s_add_u32 s75, s72, 18432
    buffer_load_dwordx4 v[48:51], v232, s[44:47], s74 offen offset:512
    v_mfma_f32_32x32x16_bf16 v[112:127], a[52:55], a[228:231], v[112:127]
    v_cvt_pk_f16_f32 v224, v82, v86
    v_cvt_pk_f16_f32 v225, v90, v94
    v_cvt_pk_f16_f32 v226, v98, v102
    v_cvt_pk_f16_f32 v227, v106, v110
    s_waitcnt lgkmcnt(14)
    ds_write_b128 v234, v[224:227] offset:26624
    buffer_load_dwordx4 v[52:55], v232, s[44:47], s74 offen offset:640
    s_waitcnt vmcnt(18)
    v_mfma_f32_32x32x16_bf16 v[128:143], a[60:63], a[228:231], v[128:143]
    v_cvt_pk_f16_f32 v228, v83, v87
    v_cvt_pk_f16_f32 v229, v91, v95
    v_cvt_pk_f16_f32 v230, v99, v103
    v_cvt_pk_f16_f32 v231, v107, v111
    s_waitcnt lgkmcnt(14)
    ds_write_b128 v234, v[228:231] offset:38912
    v_subrev_u32 v234, 40960, v234
    buffer_load_dwordx4 v[56:59], v232, s[44:47], s75 offen offset:512
    buffer_load_dwordx4 v[60:63], v232, s[44:47], s75 offen offset:640
    s_waitcnt vmcnt(19)
    v_mfma_f32_32x32x16_bf16 v[80:95], a[64:67], a[224:227], v[144:159]
    v_cvt_pk_f16_f32 v224, v112, v116
    v_cvt_pk_f16_f32 v225, v120, v124
    v_cvt_pk_f16_f32 v226, v128, v132
    v_cvt_pk_f16_f32 v227, v136, v140
    s_waitcnt lgkmcnt(14)
    ds_write_b128 v234, v[224:227] offset:0
    buffer_load_dwordx4 v[216:219], v237, s[32:35], 0 offen offset:512
    buffer_load_dwordx4 v[220:223], v237, s[32:35], 0 offen offset:640
    s_waitcnt vmcnt(19)
    v_mfma_f32_32x32x16_bf16 v[96:111], a[72:75], a[224:227], v[144:159]
    v_cvt_pk_f16_f32 v228, v113, v117
    v_cvt_pk_f16_f32 v229, v121, v125
    v_cvt_pk_f16_f32 v230, v129, v133
    v_cvt_pk_f16_f32 v231, v137, v141
    s_waitcnt lgkmcnt(14)
    ds_write_b128 v234, v[228:231] offset:10240
    s_add_u32 s74, s72, 24576
    s_add_u32 s75, s72, 30720
    v_mfma_f32_32x32x16_bf16 v[80:95], a[68:71], a[228:231], v[80:95]
    v_cvt_pk_f16_f32 v224, v114, v118
    v_cvt_pk_f16_f32 v225, v122, v126
    v_cvt_pk_f16_f32 v226, v130, v134
    v_cvt_pk_f16_f32 v227, v138, v142
    s_waitcnt lgkmcnt(14)
    ds_write_b128 v234, v[224:227] offset:20480
    buffer_load_dwordx4 v[64:67], v232, s[44:47], s74 offen offset:512
    buffer_load_dwordx4 v[68:71], v232, s[44:47], s74 offen offset:640
    s_waitcnt vmcnt(20)
    v_mfma_f32_32x32x16_bf16 v[96:111], a[76:79], a[228:231], v[96:111]
    v_cvt_pk_f16_f32 v228, v115, v119
    v_cvt_pk_f16_f32 v229, v123, v127
    v_cvt_pk_f16_f32 v230, v131, v135
    v_cvt_pk_f16_f32 v231, v139, v143
    s_waitcnt lgkmcnt(14)
    ds_write_b128 v234, v[228:231] offset:30720
    buffer_load_dwordx4 v[72:75], v232, s[44:47], s75 offen offset:512
    buffer_load_dwordx4 v[76:79], v232, s[44:47], s75 offen offset:640
    s_waitcnt lgkmcnt(0)
    s_barrier
    s_waitcnt vmcnt(19)
    v_mfma_f32_32x32x16_bf16 v[112:127], a[80:83], a[224:227], v[144:159]
    v_cvt_pk_f16_f32 v224, v80, v84
    v_cvt_pk_f16_f32 v225, v88, v92
    s_waitcnt vmcnt(17)
    v_mfma_f32_32x32x16_bf16 v[128:143], a[88:91], a[224:227], v[144:159]
    v_cvt_pk_f16_f32 v226, v96, v100
    v_cvt_pk_f16_f32 v227, v104, v108
    ds_write_b128 v234, v[224:227] offset:1024
    ds_read_b128 a[0:3], v24 offset:0
    ds_read_b128 a[4:7], v24 offset:1024
    ds_read_b128 a[8:11], v24 offset:2048
    ds_read_b128 a[12:15], v24 offset:3072
    ds_read_b128 a[16:19], v24 offset:4096
    ds_read_b128 a[20:23], v24 offset:5120
    s_add_u32 m0, s56, 6336
    s_nop 0
    buffer_load_dwordx4 v1, s[20:23], 0 offen offset:64 lds
    s_add_u32 m0, s56, 7360
    s_nop 0
    buffer_load_dwordx4 v2, s[20:23], 0 offen offset:64 lds
    s_add_u32 m0, s56, 8384
    s_nop 0
    buffer_load_dwordx4 v3, s[20:23], 0 offen offset:64 lds
    v_mfma_f32_32x32x16_bf16 v[112:127], a[84:87], a[228:231], v[112:127]
    v_cvt_pk_f16_f32 v228, v81, v85
    v_cvt_pk_f16_f32 v229, v89, v93
    s_waitcnt vmcnt(19)
    v_mfma_f32_32x32x16_bf16 v[128:143], a[92:95], a[228:231], v[128:143]
    v_cvt_pk_f16_f32 v230, v97, v101
    v_cvt_pk_f16_f32 v231, v105, v109
    ds_write_b128 v234, v[228:231] offset:11264
    ds_read_b128 a[24:27], v24 offset:6144
    ds_read_b128 a[28:31], v24 offset:7168
    ds_read_b128 a[32:35], v24 offset:8192
    ds_read_b128 a[36:39], v24 offset:9216
    ds_read_b128 a[40:43], v24 offset:10240
    ds_read_b128 a[44:47], v24 offset:11264
    s_add_u32 m0, s56, 9408
    s_nop 0
    buffer_load_dwordx4 v4, s[20:23], 0 offen offset:64 lds
    s_add_u32 m0, s56, 10432
    s_nop 0
    buffer_load_dwordx4 v5, s[20:23], 0 offen offset:64 lds
    s_add_u32 m0, s56, 11456
    s_nop 0
    buffer_load_dwordx4 v6, s[20:23], 0 offen offset:64 lds
    v_mfma_f32_32x32x16_bf16 v[128:143], v[208:211], a[224:227], v[128:143]
    v_cvt_pk_f16_f32 v224, v82, v86
    v_cvt_pk_f16_f32 v225, v90, v94
    v_cvt_pk_f16_f32 v226, v98, v102
    v_cvt_pk_f16_f32 v227, v106, v110
    ds_write_b128 v234, v[224:227] offset:21504
    s_waitcnt lgkmcnt(9)
    ds_read_b128 a[96:99], v24 offset:24576
    ds_read_b128 a[100:103], v24 offset:25600
    ds_read_b128 a[104:107], v24 offset:26624
    ds_read_b128 a[108:111], v24 offset:27648
    ds_read_b128 a[112:115], v24 offset:28672
    ds_read_b128 a[116:119], v24 offset:29696
    s_add_u32 m0, s56, 12480
    s_nop 0
    buffer_load_dword v7, s[20:23], 0 offen offset:64 lds
    buffer_load_dword v254, v31, s[20:23], 0 offen
    s_waitcnt vmcnt(23)
    v_xor_b32 v192, 0x80008000, v192
    v_xor_b32 v193, 0x80008000, v193
    v_xor_b32 v194, 0x80008000, v194
    v_mfma_f32_32x32x16_bf16 v[128:143], v[212:215], a[228:231], v[128:143]
    v_cvt_pk_f16_f32 v228, v83, v87
    v_cvt_pk_f16_f32 v229, v91, v95
    v_cvt_pk_f16_f32 v230, v99, v103
    v_cvt_pk_f16_f32 v231, v107, v111
    s_waitcnt lgkmcnt(9)
    ds_write_b128 v234, v[228:231] offset:31744
    ds_read_b128 a[120:123], v24 offset:30720
    ds_read_b128 a[124:127], v24 offset:31744
    ds_read_b128 a[128:131], v24 offset:32768
    ds_read_b128 a[132:135], v24 offset:33792
    ds_read_b128 a[136:139], v24 offset:34816
    s_waitcnt lgkmcnt(14)
    ds_read_b128 a[140:143], v24 offset:35840
    v_xor_b32 v195, 0x80008000, v195
    s_waitcnt vmcnt(22)
    v_xor_b32 v196, 0x80008000, v196
    v_xor_b32 v197, 0x80008000, v197
    v_xor_b32 v198, 0x80008000, v198
    v_xor_b32 v199, 0x80008000, v199
    v_mfma_f32_32x32x16_bf16 v[144:159], v[192:195], a[224:227], 0
    s_nop 0
    v_mfma_f32_32x32x16_bf16 v[144:159], v[196:199], a[228:231], v[144:159]
    s_waitcnt vmcnt(21)
    s_nop 8
    v_mfma_f32_32x32x16_bf16 v[80:95], v[32:35], a[224:227], v[144:159]
    v_cvt_pk_f16_f32 v224, v112, v116
    v_cvt_pk_f16_f32 v225, v120, v124
    v_cvt_pk_f16_f32 v226, v128, v132
    v_cvt_pk_f16_f32 v227, v136, v140
    s_waitcnt lgkmcnt(9)
    ds_write_b128 v234, v[224:227] offset:2048
    ds_read_b128 a[144:147], v24 offset:36864
    ds_read_b128 a[148:151], v24 offset:37888
    ds_read_b128 a[152:155], v24 offset:38912
    ds_read_b128 a[156:159], v24 offset:39936
    ds_read_b128 a[160:163], v24 offset:40960
    s_waitcnt lgkmcnt(14)
    ds_read_b128 a[164:167], v24 offset:41984
    s_waitcnt vmcnt(19)
    v_mfma_f32_32x32x16_bf16 v[96:111], v[40:43], a[224:227], v[144:159]
    v_cvt_pk_f16_f32 v228, v113, v117
    v_cvt_pk_f16_f32 v229, v121, v125
    v_cvt_pk_f16_f32 v230, v129, v133
    v_cvt_pk_f16_f32 v231, v137, v141
    s_waitcnt lgkmcnt(9)
    ds_write_b128 v234, v[228:231] offset:12288
    ds_read_b128 a[168:171], v24 offset:43008
    ds_read_b128 a[172:175], v24 offset:44032
    ds_read_b128 a[176:179], v24 offset:45056
    ds_read_b128 a[180:183], v24 offset:46080
    ds_read_b128 a[184:187], v24 offset:47104
    s_waitcnt lgkmcnt(14)
    ds_read_b128 a[188:191], v24 offset:48128
    v_mfma_f32_32x32x16_bf16 v[80:95], v[36:39], a[228:231], v[80:95]
    v_cvt_pk_f16_f32 v224, v114, v118
    v_cvt_pk_f16_f32 v225, v122, v126
    v_cvt_pk_f16_f32 v226, v130, v134
    v_cvt_pk_f16_f32 v227, v138, v142
    s_waitcnt lgkmcnt(9)
    ds_write_b128 v234, v[224:227] offset:22528
    ds_read_b128 a[192:195], v23 offset:0
    ds_read_b128 a[196:199], v23 offset:3072
    ds_read_b128 a[200:203], v23 offset:10240
    ds_read_b128 a[204:207], v23 offset:13312
    ds_read_b128 a[208:211], v23 offset:20480
    s_waitcnt lgkmcnt(14)
    ds_read_b128 a[212:215], v23 offset:23552
    s_waitcnt vmcnt(18)
    v_mfma_f32_32x32x16_bf16 v[96:111], v[44:47], a[228:231], v[96:111]
    v_cvt_pk_f16_f32 v228, v115, v119
    v_cvt_pk_f16_f32 v229, v123, v127
    v_cvt_pk_f16_f32 v230, v131, v135
    v_cvt_pk_f16_f32 v231, v139, v143
    s_waitcnt lgkmcnt(14)
    ds_write_b128 v234, v[228:231] offset:32768
    v_add_u32 v234, 40960, v234
    s_waitcnt lgkmcnt(13)
    ds_read_b128 a[216:219], v23 offset:30720
    ds_read_b128 a[220:223], v23 offset:33792
    s_waitcnt lgkmcnt(9)
    ds_read_b128 a[48:51], v24 offset:12288
    ds_read_b128 a[52:55], v24 offset:13312
    ds_read_b128 a[56:59], v24 offset:14336
    ds_read_b128 a[60:63], v24 offset:15360
    ds_read_b128 a[64:67], v24 offset:16384
    ds_read_b128 a[68:71], v24 offset:17408
    s_waitcnt lgkmcnt(9)
    ds_read_b128 a[72:75], v24 offset:18432
    ds_read_b128 a[76:79], v24 offset:19456
    ds_read_b128 a[80:83], v24 offset:20480
    ds_read_b128 a[84:87], v24 offset:21504
    ds_read_b128 a[88:91], v24 offset:22528
    ds_read_b128 a[92:95], v24 offset:23552
    s_waitcnt lgkmcnt(0)
    s_barrier
    s_waitcnt vmcnt(17)
    v_mfma_f32_32x32x16_bf16 v[112:127], v[48:51], a[224:227], v[144:159]
    v_cvt_pk_f16_f32 v224, v80, v84
    v_cvt_pk_f16_f32 v225, v88, v92
    v_cvt_pk_f16_f32 v226, v96, v100
    v_cvt_pk_f16_f32 v227, v104, v108
    ds_write_b128 v234, v[224:227] offset:0
    s_waitcnt vmcnt(15)
    v_mfma_f32_32x32x16_bf16 v[128:143], v[56:59], a[224:227], v[144:159]
    v_cvt_pk_f16_f32 v228, v81, v85
    v_cvt_pk_f16_f32 v229, v89, v93
    v_cvt_pk_f16_f32 v230, v97, v101
    v_cvt_pk_f16_f32 v231, v105, v109
    ds_write_b128 v234, v[228:231] offset:12288
    v_mfma_f32_32x32x16_bf16 v[112:127], v[52:55], a[228:231], v[112:127]
    v_cvt_pk_f16_f32 v224, v82, v86
    v_cvt_pk_f16_f32 v225, v90, v94
    v_cvt_pk_f16_f32 v226, v98, v102
    v_cvt_pk_f16_f32 v227, v106, v110
    ds_write_b128 v234, v[224:227] offset:24576
    s_waitcnt vmcnt(14)
    v_mfma_f32_32x32x16_bf16 v[128:143], v[60:63], a[228:231], v[128:143]
    v_cvt_pk_f16_f32 v228, v83, v87
    v_cvt_pk_f16_f32 v229, v91, v95
    v_cvt_pk_f16_f32 v230, v99, v103
    v_cvt_pk_f16_f32 v231, v107, v111
    ds_write_b128 v234, v[228:231] offset:36864
    s_waitcnt vmcnt(11)
    v_mfma_f32_32x32x16_bf16 v[80:95], v[64:67], a[224:227], v[144:159]
    v_cvt_pk_f16_f32 v224, v112, v116
    v_cvt_pk_f16_f32 v225, v120, v124
    s_waitcnt vmcnt(9)
    v_mfma_f32_32x32x16_bf16 v[96:111], v[72:75], a[224:227], v[144:159]
    s_nop 0
    v_cvt_pk_f16_f32 v226, v128, v132
    v_cvt_pk_f16_f32 v227, v136, v140
    ds_write_b128 v234, v[224:227] offset:1024
    v_mfma_f32_32x32x16_bf16 v[80:95], v[68:71], a[228:231], v[80:95]
    v_cvt_pk_f16_f32 v228, v113, v117
    v_cvt_pk_f16_f32 v229, v121, v125
    s_waitcnt vmcnt(8)
    v_mfma_f32_32x32x16_bf16 v[96:111], v[76:79], a[228:231], v[96:111]
    v_cvt_pk_f16_f32 v230, v129, v133
    v_cvt_pk_f16_f32 v231, v137, v141
    ds_write_b128 v234, v[228:231] offset:13312
    v_mfma_f32_32x32x16_bf16 v[96:111], v[216:219], a[224:227], v[96:111]
    v_cvt_pk_f16_f32 v224, v114, v118
    v_cvt_pk_f16_f32 v225, v122, v126
    v_cvt_pk_f16_f32 v226, v130, v134
    v_cvt_pk_f16_f32 v227, v138, v142
    ds_write_b128 v234, v[224:227] offset:25600
    v_mfma_f32_32x32x16_bf16 v[96:111], v[220:223], a[228:231], v[96:111]
    v_cvt_pk_f16_f32 v228, v115, v119
    v_cvt_pk_f16_f32 v229, v123, v127
    v_cvt_pk_f16_f32 v230, v131, v135
    v_cvt_pk_f16_f32 v231, v139, v143
    ds_write_b128 v234, v[228:231] offset:37888
    v_cvt_pk_f16_f32 v224, v80, v84
    v_cvt_pk_f16_f32 v225, v88, v92
    s_nop 4
    v_cvt_pk_f16_f32 v226, v96, v100
    v_cvt_pk_f16_f32 v227, v104, v108
    ds_write_b128 v234, v[224:227] offset:2048
    v_cvt_pk_f16_f32 v228, v81, v85
    v_cvt_pk_f16_f32 v229, v89, v93
    v_cvt_pk_f16_f32 v230, v97, v101
    v_cvt_pk_f16_f32 v231, v105, v109
    ds_write_b128 v234, v[228:231] offset:14336
    v_cvt_pk_f16_f32 v224, v82, v86
    v_cvt_pk_f16_f32 v225, v90, v94
    v_cvt_pk_f16_f32 v226, v98, v102
    v_cvt_pk_f16_f32 v227, v106, v110
    ds_write_b128 v234, v[224:227] offset:26624
    v_cvt_pk_f16_f32 v228, v83, v87
    v_cvt_pk_f16_f32 v229, v91, v95
    v_cvt_pk_f16_f32 v230, v99, v103
    v_cvt_pk_f16_f32 v231, v107, v111
    ds_write_b128 v234, v[228:231] offset:38912
    s_branch L_conv0
L_prep1:
    v_bfe_u32 v158, v129, 2, 1
    v_bfe_u32 v159, v129, 3, 2
    v_lshl_add_u32 v159, v158, 5, v159
    v_lshl_add_u32 v159, v138, 3, v159
    v_and_b32 v160, 3, v129
    v_xor_b32 v161, v138, v160
    v_lshlrev_b32 v161, 4, v161
    v_mad_u32_u24 v232, v159, s69, v161
    s_sub_u32 s60, s3, 2
    s_mul_i32 s72, s60, 3072
    s_mul_i32 s60, s60, 24576
    s_add_u32 s60, s60, 40960
    v_bfe_u32 v159, v129, 3, 1
    v_lshl_add_u32 v161, v159, 2, v160
    v_lshl_add_u32 v161, v158, 3, v161
    v_lshlrev_b32 v236, 1, v161
    v_xor_b32 v237, 16, v236
    v_and_b32 v159, 15, v129
    v_bfe_u32 v160, v129, 4, 1
    v_lshl_add_u32 v160, v160, 1, v138
    v_lshl_add_u32 v159, v160, 5, v159
    v_lshlrev_b32 v238, 11, v158
    v_mul_u32_u24 v158, 768, v158
    v_add_u32 v159, v158, v159
    v_lshl_add_u32 v234, v159, 4, s60
    v_xor_b32 v235, 64, v234
    s_lshl_b32 s60, s3, 12
    s_add_u32 s60, s60, 32768
    v_add_u32 v238, s60, v238
    v_sub_u32 v238, 0, v238
    v_and_b32 v239, 16, v129
    v_lshlrev_b32 v239, 7, v239
    s_add_u32 m0, s56, 0
    s_nop 0
    buffer_load_dwordx4 v1, s[20:23], 0 offen offset:0 lds
    s_add_u32 m0, s56, 1024
    s_nop 0
    buffer_load_dwordx4 v2, s[20:23], 0 offen offset:0 lds
    s_add_u32 m0, s56, 2048
    s_nop 0
    buffer_load_dwordx4 v3, s[20:23], 0 offen offset:0 lds
    s_add_u32 m0, s56, 3072
    s_nop 0
    buffer_load_dwordx4 v4, s[20:23], 0 offen offset:0 lds
    s_add_u32 m0, s56, 4096
    s_nop 0
    buffer_load_dwordx4 v5, s[20:23], 0 offen offset:0 lds
    s_add_u32 m0, s56, 5120
    s_nop 0
    buffer_load_dwordx4 v6, s[20:23], 0 offen offset:0 lds
    s_add_u32 m0, s56, 6144
    s_nop 0
    buffer_load_dword v7, s[20:23], 0 offen offset:0 lds
    v_mov_b32 v157, 268435456
    v_and_b32 v152, 15, v129
    v_lshrrev_b32 v153, 4, v129
    v_add_u32 v154, 4, v152
    v_lshrrev_b32 v154, 3, v154
    v_mad_i32_i24 v155, v154, -4, v152
    v_and_b32 v154, 1, v154
    v_and_b32 v156, 1, v153
    v_lshlrev_b32 v158, 1, v154
    v_mul_u32_u24 v159, 98304, v158
    v_mad_u32_u24 v159, v155, s69, v159
    v_lshl_add_u32 v159, v138, 4, v159
    v_lshl_add_u32 v159, v156, 5, v159
    v_add_u32 v26, s63, v159
    v_xor_b32 v161, v154, v138
    v_add_u32 v159, v158, v153
    v_add_u32 v160, 0, v155
    v_mad_u32_u24 v159, v159, 10, v160
    v_bfe_u32 v160, v160, 2, 1
    v_lshl_or_b32 v160, v161, 1, v160
    v_lshl_add_u32 v160, v159, 2, v160
    v_lshl_add_u32 v8, v160, 4, s56
    v_add_u32 v162, 1, v156
    v_add_u32 v159, v158, v138
    v_add_u32 v160, v162, v155
    v_mad_u32_u24 v159, v159, 10, v160
    v_bfe_u32 v160, v160, 2, 1
    v_lshl_or_b32 v160, v154, 1, v160
    v_lshl_add_u32 v160, v159, 2, v160
    v_lshl_add_u32 v12, v160, 4, s56
    v_xor_b32 v9, 16, v8
    v_xor_b32 v10, 32, v8
    v_xor_b32 v11, 48, v8
    v_xor_b32 v13, 16, v12
    v_xor_b32 v14, 32, v12
    v_xor_b32 v15, 48, v12
    v_xor_b32 v161, v154, v156
    v_add_u32 v159, v158, v162
    v_add_u32 v160, 1, v155
    v_mad_u32_u24 v159, v159, 10, v160
    v_bfe_u32 v160, v160, 2, 1
    v_lshl_or_b32 v160, v161, 1, v160
    v_xor_b32 v160, v138, v160
    v_lshl_add_u32 v160, v159, 2, v160
    v_lshl_add_u32 v20, v160, 4, s56
    v_xor_b32 v21, 32, v20
    v_bfe_u32 v158, v152, 2, 1
    v_sub_u32 v158, v153, v158
    v_and_b32 v159, 3, v152
    v_mul_u32_u24 v16, 0x1111, v159
    v_lshrrev_b32 v160, 3, v152
    v_lshl_add_u32 v159, v160, 2, v159
    v_lshlrev_b32 v159, 5, v159
    v_add_u32 v159, 141312, v159
    s_movk_i32 s70, 3072
    v_cmp_gt_u32 vcc, 3, v158
    v_mad_u32_u24 v159, v158, s70, v159
    s_nop 0
    v_cndmask_b32 v22, v157, v159, vcc
    v_lshlrev_b32 v23, 4, v129
    v_add_u32 v24, 40960, v23
    v_lshlrev_b32 v25, 4, v138
    v_add_u32 v25, 150528, v25
    v_bfe_u32 v158, v129, 1, 1
    v_bfe_u32 v159, v129, 3, 2
    v_lshl_add_u32 v158, v159, 1, v158
    v_bfe_u32 v159, v129, 2, 1
    v_cmp_eq_u32 vcc, v159, v138
    v_and_b32 v160, 1, v129
    v_lshlrev_b32 v160, 4, v160
    v_mov_b32 v161, 0x3f80
    v_lshlrev_b32 v160, v160, v161
    v_cndmask_b32 v158, 15, v158, vcc
    v_cmp_eq_u32 vcc, 0, v158
    s_nop 1
    v_cndmask_b32 v162, 0, v160, vcc
    v_cmp_eq_u32 vcc, 1, v158
    s_nop 1
    v_cndmask_b32 v163, 0, v160, vcc
    v_cmp_eq_u32 vcc, 2, v158
    s_nop 1
    v_cndmask_b32 v164, 0, v160, vcc
    v_cmp_eq_u32 vcc, 3, v158
    s_nop 1
    v_cndmask_b32 v165, 0, v160, vcc
    v_cmp_eq_u32 vcc, 4, v158
    s_nop 1
    v_cndmask_b32 v166, 0, v160, vcc
    v_cmp_eq_u32 vcc, 5, v158
    s_nop 1
    v_cndmask_b32 v167, 0, v160, vcc
    v_cmp_eq_u32 vcc, 6, v158
    s_nop 1
    v_cndmask_b32 v168, 0, v160, vcc
    v_cmp_eq_u32 vcc, 7, v158
    s_nop 1
    v_cndmask_b32 v169, 0, v160, vcc
    v_accvgpr_write_b32 a224, v162
    v_accvgpr_write_b32 a225, v163
    v_accvgpr_write_b32 a226, v164
    v_accvgpr_write_b32 a227, v165
    v_accvgpr_write_b32 a228, v166
    v_accvgpr_write_b32 a229, v167
    v_accvgpr_write_b32 a230, v168
    v_accvgpr_write_b32 a231, v169
    s_mov_b32 s24, s18
    s_mov_b32 s25, s19
    s_mov_b32 s26, 50331648
    s_mov_b32 s27, 0x20000
    s_mov_b32 s52, 0
    s_mov_b32 s80, 0
    s_mov_b32 s81, 98304
    s_mov_b32 s82, 393216
    s_mov_b32 s83, 491520
    s_mov_b32 s53, 1156203754
    s_mov_b32 s58, 0x3c003c00
    s_mov_b32 s85, 150912
    s_mov_b32 s86, 0xffffffff
    s_mov_b32 s59, 0x3eeff558
    s_mov_b32 s84, 0x37800000
    v_lshlrev_b32 v17, 4, v138
    v_lshrrev_b32 v17, v17, -1
    s_mov_b32 s73, 0x409d30fc
    v_mul_u32_u24 v252, 0x100010, v0
    v_add_u32 v252, 0xc0004, v252
    v_lshlrev_b32 v253, 2, v0
    v_add_u32 v253, 150912, v253
    v_add_u32 v80, 0x0, v252
    v_add_u32 v88, 0x10001000, v252
    v_add_u32 v96, 0x20002000, v252
    v_add_u32 v104, 0x30003000, v252
    v_cvt_f32_f16 v81, v80
    v_cvt_f32_f16 v89, v88
    v_cvt_f32_f16 v97, v96
    v_cvt_f32_f16 v105, v104
    v_cvt_f32_f16_sdwa v82, v80 dst_sel:DWORD dst_unused:UNUSED_PAD src0_sel:WORD_1
    v_cvt_f32_f16_sdwa v90, v88 dst_sel:DWORD dst_unused:UNUSED_PAD src0_sel:WORD_1
    v_cvt_f32_f16_sdwa v98, v96 dst_sel:DWORD dst_unused:UNUSED_PAD src0_sel:WORD_1
    v_cvt_f32_f16_sdwa v106, v104 dst_sel:DWORD dst_unused:UNUSED_PAD src0_sel:WORD_1
    v_fma_f32 v83, v81, v81, s73
    v_fma_f32 v91, v89, v89, s73
    v_fma_f32 v99, v97, v97, s73
    v_fma_f32 v107, v105, v105, s73
    v_fma_f32 v84, v82, v82, s73
    v_fma_f32 v92, v90, v90, s73
    v_fma_f32 v100, v98, v98, s73
    v_fma_f32 v108, v106, v106, s73
    v_mul_f32 v83, -v81, v83
    v_mul_f32 v91, -v89, v91
    v_mul_f32 v99, -v97, v99
    v_mul_f32 v107, -v105, v107
    v_mul_f32 v84, -v82, v84
    v_mul_f32 v92, -v90, v92
    v_mul_f32 v100, -v98, v100
    v_mul_f32 v108, -v106, v108
    v_exp_f32 v83, v83
    v_exp_f32 v91, v91
    v_exp_f32 v99, v99
    v_exp_f32 v107, v107
    v_exp_f32 v84, v84
    v_exp_f32 v92, v92
    v_exp_f32 v100, v100
    v_exp_f32 v108, v108
    v_add_f32 v83, 1.0, v83
    v_add_f32 v91, 1.0, v91
    v_add_f32 v99, 1.0, v99
    v_add_f32 v107, 1.0, v107
    v_add_f32 v84, 1.0, v84
    v_add_f32 v92, 1.0, v92
    v_add_f32 v100, 1.0, v100
    v_add_f32 v108, 1.0, v108
    v_rcp_f32 v83, v83
    v_rcp_f32 v91, v91
    v_rcp_f32 v99, v99
    v_rcp_f32 v107, v107
    v_rcp_f32 v84, v84
    v_rcp_f32 v92, v92
    v_rcp_f32 v100, v100
    v_rcp_f32 v108, v108
    v_mul_f32 v83, v81, v83
    v_mul_f32 v91, v89, v91
    v_mul_f32 v99, v97, v99
    v_mul_f32 v107, v105, v107
    v_mul_f32 v84, v82, v84
    v_mul_f32 v92, v90, v92
    v_mul_f32 v100, v98, v100
    v_mul_f32 v108, v106, v108
    v_cvt_pk_bf16_f32 v80, v83, v84
    v_cvt_pk_bf16_f32 v88, v91, v92
    v_cvt_pk_bf16_f32 v96, v99, v100
    v_cvt_pk_bf16_f32 v104, v107, v108
    ds_write_b32 v253, v80 offset:0
    ds_write_b32 v253, v88 offset:1024
    ds_write_b32 v253, v96 offset:2048
    ds_write_b32 v253, v104 offset:3072
    v_add_u32 v80, 0x40004000, v252
    v_add_u32 v88, 0x50005000, v252
    v_add_u32 v96, 0x60006000, v252
    v_cvt_f32_f16 v81, v80
    v_cvt_f32_f16 v89, v88
    v_cvt_f32_f16 v97, v96
    v_cvt_f32_f16_sdwa v82, v80 dst_sel:DWORD dst_unused:UNUSED_PAD src0_sel:WORD_1
    v_cvt_f32_f16_sdwa v90, v88 dst_sel:DWORD dst_unused:UNUSED_PAD src0_sel:WORD_1
    v_cvt_f32_f16_sdwa v98, v96 dst_sel:DWORD dst_unused:UNUSED_PAD src0_sel:WORD_1
    v_fma_f32 v83, v81, v81, s73
    v_fma_f32 v91, v89, v89, s73
    v_fma_f32 v99, v97, v97, s73
    v_fma_f32 v84, v82, v82, s73
    v_fma_f32 v92, v90, v90, s73
    v_fma_f32 v100, v98, v98, s73
    v_mul_f32 v83, -v81, v83
    v_mul_f32 v91, -v89, v91
    v_mul_f32 v99, -v97, v99
    v_mul_f32 v84, -v82, v84
    v_mul_f32 v92, -v90, v92
    v_mul_f32 v100, -v98, v100
    v_exp_f32 v83, v83
    v_exp_f32 v91, v91
    v_exp_f32 v99, v99
    v_exp_f32 v84, v84
    v_exp_f32 v92, v92
    v_exp_f32 v100, v100
    v_add_f32 v83, 1.0, v83
    v_add_f32 v91, 1.0, v91
    v_add_f32 v99, 1.0, v99
    v_add_f32 v84, 1.0, v84
    v_add_f32 v92, 1.0, v92
    v_add_f32 v100, 1.0, v100
    v_rcp_f32 v83, v83
    v_rcp_f32 v91, v91
    v_rcp_f32 v99, v99
    v_rcp_f32 v84, v84
    v_rcp_f32 v92, v92
    v_rcp_f32 v100, v100
    v_mul_f32 v83, v81, v83
    v_mul_f32 v91, v89, v91
    v_mul_f32 v99, v97, v99
    v_mul_f32 v84, v82, v84
    v_mul_f32 v92, v90, v92
    v_mul_f32 v100, v98, v100
    v_cvt_pk_bf16_f32 v80, v83, v84
    v_cvt_pk_bf16_f32 v88, v91, v92
    v_cvt_pk_bf16_f32 v96, v99, v100
    ds_write_b32 v253, v80 offset:4096
    ds_write_b32 v253, v88 offset:5120
    ds_write_b32 v253, v96 offset:6144
    v_add_u32 v80, 0x70007000, v252
    v_add_u32 v88, 0x80008000, v252
    v_add_u32 v96, 0x90009000, v252
    v_cvt_f32_f16 v81, v80
    v_cvt_f32_f16 v89, v88
    v_cvt_f32_f16 v97, v96
    v_cvt_f32_f16_sdwa v82, v80 dst_sel:DWORD dst_unused:UNUSED_PAD src0_sel:WORD_1
    v_cvt_f32_f16_sdwa v90, v88 dst_sel:DWORD dst_unused:UNUSED_PAD src0_sel:WORD_1
    v_cvt_f32_f16_sdwa v98, v96 dst_sel:DWORD dst_unused:UNUSED_PAD src0_sel:WORD_1
    v_fma_f32 v83, v81, v81, s73
    v_fma_f32 v91, v89, v89, s73
    v_fma_f32 v99, v97, v97, s73
    v_fma_f32 v84, v82, v82, s73
    v_fma_f32 v92, v90, v90, s73
    v_fma_f32 v100, v98, v98, s73
    v_mul_f32 v83, -v81, v83
    v_mul_f32 v91, -v89, v91
    v_mul_f32 v99, -v97, v99
    v_mul_f32 v84, -v82, v84
    v_mul_f32 v92, -v90, v92
    v_mul_f32 v100, -v98, v100
    v_exp_f32 v83, v83
    v_exp_f32 v91, v91
    v_exp_f32 v99, v99
    v_exp_f32 v84, v84
    v_exp_f32 v92, v92
    v_exp_f32 v100, v100
    v_add_f32 v83, 1.0, v83
    v_add_f32 v91, 1.0, v91
    v_add_f32 v99, 1.0, v99
    v_add_f32 v84, 1.0, v84
    v_add_f32 v92, 1.0, v92
    v_add_f32 v100, 1.0, v100
    v_rcp_f32 v83, v83
    v_rcp_f32 v91, v91
    v_rcp_f32 v99, v99
    v_rcp_f32 v84, v84
    v_rcp_f32 v92, v92
    v_rcp_f32 v100, v100
    v_mul_f32 v83, v81, v83
    v_mul_f32 v91, v89, v91
    v_mul_f32 v99, v97, v99
    v_mul_f32 v84, v82, v84
    v_mul_f32 v92, v90, v92
    v_mul_f32 v100, v98, v100
    v_cvt_pk_bf16_f32 v80, v83, v84
    v_cvt_pk_bf16_f32 v88, v91, v92
    v_cvt_pk_bf16_f32 v96, v99, v100
    ds_write_b32 v253, v80 offset:7168
    ds_write_b32 v253, v88 offset:8192
    ds_write_b32 v253, v96 offset:9216
    v_add_u32 v80, 0xa000a000, v252
    v_add_u32 v88, 0xb000b000, v252
    v_add_u32 v96, 0xc000c000, v252
    v_cvt_f32_f16 v81, v80
    v_cvt_f32_f16 v89, v88
    v_cvt_f32_f16 v97, v96
    v_cvt_f32_f16_sdwa v82, v80 dst_sel:DWORD dst_unused:UNUSED_PAD src0_sel:WORD_1
    v_cvt_f32_f16_sdwa v90, v88 dst_sel:DWORD dst_unused:UNUSED_PAD src0_sel:WORD_1
    v_cvt_f32_f16_sdwa v98, v96 dst_sel:DWORD dst_unused:UNUSED_PAD src0_sel:WORD_1
    v_fma_f32 v83, v81, v81, s73
    v_fma_f32 v91, v89, v89, s73
    v_fma_f32 v99, v97, v97, s73
    v_fma_f32 v84, v82, v82, s73
    v_fma_f32 v92, v90, v90, s73
    v_fma_f32 v100, v98, v98, s73
    v_mul_f32 v83, -v81, v83
    v_mul_f32 v91, -v89, v91
    v_mul_f32 v99, -v97, v99
    v_mul_f32 v84, -v82, v84
    v_mul_f32 v92, -v90, v92
    v_mul_f32 v100, -v98, v100
    v_exp_f32 v83, v83
    v_exp_f32 v91, v91
    v_exp_f32 v99, v99
    v_exp_f32 v84, v84
    v_exp_f32 v92, v92
    v_exp_f32 v100, v100
    v_add_f32 v83, 1.0, v83
    v_add_f32 v91, 1.0, v91
    v_add_f32 v99, 1.0, v99
    v_add_f32 v84, 1.0, v84
    v_add_f32 v92, 1.0, v92
    v_add_f32 v100, 1.0, v100
    v_rcp_f32 v83, v83
    v_rcp_f32 v91, v91
    v_rcp_f32 v99, v99
    v_rcp_f32 v84, v84
    v_rcp_f32 v92, v92
    v_rcp_f32 v100, v100
    v_mul_f32 v83, v81, v83
    v_mul_f32 v91, v89, v91
    v_mul_f32 v99, v97, v99
    v_mul_f32 v84, v82, v84
    v_mul_f32 v92, v90, v92
    v_mul_f32 v100, v98, v100
    v_cvt_pk_bf16_f32 v80, v83, v84
    v_cvt_pk_bf16_f32 v88, v91, v92
    v_cvt_pk_bf16_f32 v96, v99, v100
    ds_write_b32 v253, v80 offset:10240
    ds_write_b32 v253, v88 offset:11264
    ds_write_b32 v253, v96 offset:12288
    buffer_load_ushort v176, v236, s[40:43], 0 offen offset:0
    buffer_load_ushort v177, v237, s[40:43], 0 offen offset:0
    buffer_load_ushort v178, v236, s[40:43], 0 offen offset:32
    buffer_load_ushort v179, v237, s[40:43], 0 offen offset:32
    buffer_load_ushort v180, v236, s[40:43], 0 offen offset:64
    buffer_load_ushort v181, v237, s[40:43], 0 offen offset:64
    buffer_load_ushort v182, v236, s[40:43], 0 offen offset:96
    buffer_load_ushort v183, v237, s[40:43], 0 offen offset:96
    buffer_load_ushort v184, v236, s[40:43], 0 offen offset:128
    buffer_load_ushort v185, v237, s[40:43], 0 offen offset:128
    buffer_load_ushort v186, v236, s[40:43], 0 offen offset:160
    buffer_load_ushort v187, v237, s[40:43], 0 offen offset:160
    s_add_u32 s74, s72, 0
    s_add_u32 s75, s72, 12288
    buffer_load_dwordx4 a[0:3], v232, s[48:51], s74 offen offset:0
    buffer_load_dwordx4 a[4:7], v232, s[48:51], s75 offen offset:0
    buffer_load_dwordx4 a[8:11], v232, s[48:51], s74 offen offset:768
    buffer_load_dwordx4 a[12:15], v232, s[48:51], s75 offen offset:768
    buffer_load_dwordx4 a[16:19], v232, s[48:51], s74 offen offset:64
    buffer_load_dwordx4 a[20:23], v232, s[48:51], s75 offen offset:64
    buffer_load_dwordx4 a[24:27], v232, s[48:51], s74 offen offset:832
    buffer_load_dwordx4 a[28:31], v232, s[48:51], s75 offen offset:832
    v_lshlrev_b32 v158, 6, v0
    v_add_u32 v158, 141312, v158
    v_cmp_gt_u32 vcc, 144, v0
    s_nop 1
    v_cndmask_b32 v158, v157, v158, vcc
    v_and_b32 v159, 3, v0
    v_lshl_add_u32 v160, v159, 2, v158
    v_lshrrev_b32 v159, 1, v159
    v_lshl_add_u32 v159, v159, 2, v158
    v_and_b32 v161, 0x1c, v0
    v_bfe_u32 v162, v0, 1, 1
    v_and_b32 v163, 1, v0
    v_lshl_or_b32 v162, v163, 1, v162
    v_or_b32 v161, v161, v162
    v_lshlrev_b32 v161, 4, v161
    v_add_u32 v161, 150528, v161
    v_cmp_gt_u32 vcc, 24, v0
    s_nop 1
    v_cndmask_b32 v161, v157, v161, vcc
    v_mov_b32 v164, 0
    v_mov_b32 v165, 0
    v_mov_b32 v166, 0
    v_mov_b32 v167, 0
    ds_write_b128 v158, v[164:167]
    ds_write_b128 v158, v[164:167] offset:16
    s_waitcnt lgkmcnt(9)
    ds_write_b128 v158, v[164:167] offset:32
    ds_write_b128 v158, v[164:167] offset:48
    s_waitcnt vmcnt(31)
    ds_write_b16 v160, v144
    ds_write_b16_d16_hi v160, v144 offset:34
    s_waitcnt vmcnt(30)
    ds_write_b16 v159, v145 offset:16
    ds_write_b16_d16_hi v159, v145 offset:48
    s_waitcnt vmcnt(29) lgkmcnt(13)
    ds_write_b16 v159, v146 offset:24
    ds_write_b16_d16_hi v159, v146 offset:56
    s_waitcnt vmcnt(28)
    v_lshlrev_b32 v168, 16, v148
    v_and_b32 v169, 0xffff0000, v148
    v_lshlrev_b32 v170, 16, v149
    v_and_b32 v171, 0xffff0000, v149
    s_waitcnt vmcnt(27)
    v_lshlrev_b32 v172, 16, v150
    v_and_b32 v173, 0xffff0000, v150
    v_lshlrev_b32 v174, 16, v151
    v_and_b32 v175, 0xffff0000, v151
    v_mul_f32 v168, v168, v172
    v_mul_f32 v169, v169, v173
    v_mul_f32 v170, v170, v174
    v_mul_f32 v171, v171, v175
    s_waitcnt lgkmcnt(14)
    ds_write_b128 v161, v[168:171]
    buffer_load_dwordx4 a[32:35], v232, s[48:51], s74 offen offset:128
    buffer_load_dwordx4 a[36:39], v232, s[48:51], s75 offen offset:128
    buffer_load_dwordx4 a[40:43], v232, s[48:51], s74 offen offset:896
    buffer_load_dwordx4 a[44:47], v232, s[48:51], s75 offen offset:896
    s_add_u32 s74, s72, 24576
    s_add_u32 s75, s72, 36864
    buffer_load_dwordx4 a[48:51], v232, s[48:51], s74 offen offset:0
    buffer_load_dwordx4 a[52:55], v232, s[48:51], s75 offen offset:0
    buffer_load_dwordx4 a[56:59], v232, s[48:51], s74 offen offset:768
    buffer_load_dwordx4 a[60:63], v232, s[48:51], s75 offen offset:768
    buffer_load_dwordx4 a[64:67], v232, s[48:51], s74 offen offset:64
    buffer_load_dwordx4 a[68:71], v232, s[48:51], s75 offen offset:64
    buffer_load_dwordx4 a[72:75], v232, s[48:51], s74 offen offset:832
    buffer_load_dwordx4 a[76:79], v232, s[48:51], s75 offen offset:832
    s_waitcnt vmcnt(31)
    v_lshlrev_b32 v176, 16, v176
    s_waitcnt vmcnt(30)
    v_lshlrev_b32 v177, 16, v177
    s_waitcnt vmcnt(29)
    v_lshlrev_b32 v178, 16, v178
    s_waitcnt vmcnt(28)
    v_lshlrev_b32 v179, 16, v179
    s_waitcnt vmcnt(27)
    v_lshlrev_b32 v180, 16, v180
    s_waitcnt vmcnt(26)
    v_lshlrev_b32 v181, 16, v181
    s_waitcnt vmcnt(25)
    v_lshlrev_b32 v182, 16, v182
    s_waitcnt vmcnt(24)
    v_lshlrev_b32 v183, 16, v183
    s_waitcnt vmcnt(23)
    v_lshlrev_b32 v184, 16, v184
    s_waitcnt vmcnt(22)
    v_lshlrev_b32 v185, 16, v185
    s_waitcnt vmcnt(21)
    v_lshlrev_b32 v186, 16, v186
    s_waitcnt vmcnt(20)
    v_lshlrev_b32 v187, 16, v187
    v_mul_f32 v176, 0x40088e99, v176
    v_mul_f32 v177, 0x40088e99, v177
    v_mul_f32 v178, 0x40088e99, v178
    v_mul_f32 v179, 0x40088e99, v179
    v_mul_f32 v180, 0x40088e99, v180
    v_mul_f32 v181, 0x40088e99, v181
    v_mul_f32 v182, 0x40088e99, v182
    v_mul_f32 v183, 0x40088e99, v183
    v_mul_f32 v184, 0x40088e99, v184
    v_mul_f32 v185, 0x40088e99, v185
    v_mul_f32 v186, 0x40088e99, v186
    v_mul_f32 v187, 0x40088e99, v187
    s_waitcnt vmcnt(19)
    v_mfma_f32_32x32x16_bf16 v[80:95], a[0:3], a[224:227], 0
    s_waitcnt vmcnt(17)
    v_mfma_f32_32x32x16_bf16 v[96:111], a[8:11], a[224:227], 0
    v_mfma_f32_32x32x16_bf16 v[80:95], a[4:7], a[228:231], v[80:95]
    s_waitcnt vmcnt(16)
    v_mfma_f32_32x32x16_bf16 v[96:111], a[12:15], a[228:231], v[96:111]
    s_waitcnt vmcnt(15)
    v_mfma_f32_32x32x16_bf16 v[112:127], a[16:19], a[224:227], 0
    s_nop 7
    v_pk_mul_f32 v[80:81], v[80:81], v[176:177]
    v_pk_mul_f32 v[84:85], v[84:85], v[176:177]
    v_pk_mul_f32 v[88:89], v[88:89], v[176:177]
    v_pk_mul_f32 v[92:93], v[92:93], v[176:177]
    v_pk_mul_f32 v[96:97], v[96:97], v[176:177]
    v_pk_mul_f32 v[100:101], v[100:101], v[176:177]
    v_pk_mul_f32 v[104:105], v[104:105], v[176:177]
    v_pk_mul_f32 v[108:109], v[108:109], v[176:177]
    v_cvt_pk_bf16_f32 v224, v80, v84
    v_cvt_pk_bf16_f32 v225, v88, v92
    v_cvt_pk_bf16_f32 v226, v96, v100
    v_cvt_pk_bf16_f32 v227, v104, v108
    s_waitcnt lgkmcnt(14)
    ds_write_b128 v234, v[224:227] offset:6144
    buffer_load_dwordx4 a[80:83], v232, s[48:51], s74 offen offset:128
    s_waitcnt vmcnt(14)
    v_mfma_f32_32x32x16_bf16 v[128:143], a[24:27], a[224:227], 0
    v_cvt_pk_bf16_f32 v228, v81, v85
    v_cvt_pk_bf16_f32 v229, v89, v93
    v_cvt_pk_bf16_f32 v230, v97, v101
    v_cvt_pk_bf16_f32 v231, v105, v109
    s_waitcnt lgkmcnt(14)
    ds_write_b128 v235, v[228:231] offset:6144
    buffer_load_dwordx4 a[84:87], v232, s[48:51], s75 offen offset:128
    v_mfma_f32_32x32x16_bf16 v[112:127], a[20:23], a[228:231], v[112:127]
    v_pk_mul_f32 v[82:83], v[82:83], v[178:179]
    v_pk_mul_f32 v[86:87], v[86:87], v[178:179]
    v_pk_mul_f32 v[90:91], v[90:91], v[178:179]
    v_pk_mul_f32 v[94:95], v[94:95], v[178:179]
    v_pk_mul_f32 v[98:99], v[98:99], v[178:179]
    v_pk_mul_f32 v[102:103], v[102:103], v[178:179]
    v_pk_mul_f32 v[106:107], v[106:107], v[178:179]
    v_pk_mul_f32 v[110:111], v[110:111], v[178:179]
    v_cvt_pk_bf16_f32 v224, v82, v86
    v_cvt_pk_bf16_f32 v225, v90, v94
    v_cvt_pk_bf16_f32 v226, v98, v102
    v_cvt_pk_bf16_f32 v227, v106, v110
    s_waitcnt lgkmcnt(14)
    ds_write_b128 v234, v[224:227] offset:6400
    buffer_load_dwordx4 a[88:91], v232, s[48:51], s74 offen offset:896
    s_waitcnt vmcnt(15)
    v_mfma_f32_32x32x16_bf16 v[128:143], a[28:31], a[228:231], v[128:143]
    v_cvt_pk_bf16_f32 v228, v83, v87
    v_cvt_pk_bf16_f32 v229, v91, v95
    v_cvt_pk_bf16_f32 v230, v99, v103
    v_cvt_pk_bf16_f32 v231, v107, v111
    s_waitcnt lgkmcnt(14)
    ds_write_b128 v235, v[228:231] offset:6400
    buffer_load_dwordx4 a[92:95], v232, s[48:51], s75 offen offset:896
    s_waitcnt vmcnt(15)
    v_mfma_f32_32x32x16_bf16 v[80:95], a[32:35], a[224:227], 0
    v_pk_mul_f32 v[112:113], v[112:113], v[180:181]
    v_pk_mul_f32 v[116:117], v[116:117], v[180:181]
    v_pk_mul_f32 v[120:121], v[120:121], v[180:181]
    v_pk_mul_f32 v[124:125], v[124:125], v[180:181]
    v_pk_mul_f32 v[128:129], v[128:129], v[180:181]
    v_pk_mul_f32 v[132:133], v[132:133], v[180:181]
    v_pk_mul_f32 v[136:137], v[136:137], v[180:181]
    v_pk_mul_f32 v[140:141], v[140:141], v[180:181]
    v_cvt_pk_bf16_f32 v224, v112, v116
    v_cvt_pk_bf16_f32 v225, v120, v124
    v_cvt_pk_bf16_f32 v226, v128, v132
    v_cvt_pk_bf16_f32 v227, v136, v140
    s_waitcnt lgkmcnt(14)
    ds_write_b128 v234, v[224:227] offset:8192
    s_add_u32 s74, s72, 49152
    s_waitcnt vmcnt(13)
    v_mfma_f32_32x32x16_bf16 v[96:111], a[40:43], a[224:227], 0
    v_cvt_pk_bf16_f32 v228, v113, v117
    v_cvt_pk_bf16_f32 v229, v121, v125
    v_cvt_pk_bf16_f32 v230, v129, v133
    v_cvt_pk_bf16_f32 v231, v137, v141
    s_waitcnt lgkmcnt(14)
    ds_write_b128 v235, v[228:231] offset:8192
    s_add_u32 s75, s72, 61440
    buffer_load_dwordx4 v[32:35], v232, s[48:51], s74 offen offset:0
    v_mfma_f32_32x32x16_bf16 v[80:95], a[36:39], a[228:231], v[80:95]
    v_pk_mul_f32 v[114:115], v[114:115], v[182:183]
    v_pk_mul_f32 v[118:119], v[118:119], v[182:183]
    v_pk_mul_f32 v[122:123], v[122:123], v[182:183]
    v_pk_mul_f32 v[126:127], v[126:127], v[182:183]
    v_pk_mul_f32 v[130:131], v[130:131], v[182:183]
    v_pk_mul_f32 v[134:135], v[134:135], v[182:183]
    v_pk_mul_f32 v[138:139], v[138:139], v[182:183]
    v_pk_mul_f32 v[142:143], v[142:143], v[182:183]
    v_cvt_pk_bf16_f32 v224, v114, v118
    v_cvt_pk_bf16_f32 v225, v122, v126
    v_cvt_pk_bf16_f32 v226, v130, v134
    v_cvt_pk_bf16_f32 v227, v138, v142
    s_waitcnt lgkmcnt(14)
    ds_write_b128 v234, v[224:227] offset:8448
    buffer_load_dwordx4 v[36:39], v232, s[48:51], s75 offen offset:0
    s_waitcnt vmcnt(14)
    v_mfma_f32_32x32x16_bf16 v[96:111], a[44:47], a[228:231], v[96:111]
    v_cvt_pk_bf16_f32 v228, v115, v119
    v_cvt_pk_bf16_f32 v229, v123, v127
    v_cvt_pk_bf16_f32 v230, v131, v135
    v_cvt_pk_bf16_f32 v231, v139, v143
    s_waitcnt lgkmcnt(14)
    ds_write_b128 v235, v[228:231] offset:8448
    buffer_load_dwordx4 v[40:43], v232, s[48:51], s74 offen offset:768
    buffer_load_dwordx4 v[44:47], v232, s[48:51], s75 offen offset:768
    s_waitcnt vmcnt(15)
    v_mfma_f32_32x32x16_bf16 v[112:127], a[48:51], a[224:227], 0
    v_pk_mul_f32 v[80:81], v[80:81], v[184:185]
    v_pk_mul_f32 v[84:85], v[84:85], v[184:185]
    v_pk_mul_f32 v[88:89], v[88:89], v[184:185]
    v_pk_mul_f32 v[92:93], v[92:93], v[184:185]
    v_pk_mul_f32 v[96:97], v[96:97], v[184:185]
    v_pk_mul_f32 v[100:101], v[100:101], v[184:185]
    v_pk_mul_f32 v[104:105], v[104:105], v[184:185]
    v_pk_mul_f32 v[108:109], v[108:109], v[184:185]
    v_cvt_pk_bf16_f32 v224, v80, v84
    v_cvt_pk_bf16_f32 v225, v88, v92
    v_cvt_pk_bf16_f32 v226, v96, v100
    v_cvt_pk_bf16_f32 v227, v104, v108
    s_waitcnt lgkmcnt(14)
    ds_write_b128 v234, v[224:227] offset:10240
    buffer_load_dwordx4 v[48:51], v232, s[48:51], s74 offen offset:64
    s_waitcnt vmcnt(14)
    v_mfma_f32_32x32x16_bf16 v[128:143], a[56:59], a[224:227], 0
    v_cvt_pk_bf16_f32 v228, v81, v85
    v_cvt_pk_bf16_f32 v229, v89, v93
    v_cvt_pk_bf16_f32 v230, v97, v101
    v_cvt_pk_bf16_f32 v231, v105, v109
    s_waitcnt lgkmcnt(14)
    ds_write_b128 v235, v[228:231] offset:10240
    buffer_load_dwordx4 v[52:55], v232, s[48:51], s75 offen offset:64
    v_mfma_f32_32x32x16_bf16 v[112:127], a[52:55], a[228:231], v[112:127]
    v_pk_mul_f32 v[82:83], v[82:83], v[186:187]
    v_pk_mul_f32 v[86:87], v[86:87], v[186:187]
    v_pk_mul_f32 v[90:91], v[90:91], v[186:187]
    v_pk_mul_f32 v[94:95], v[94:95], v[186:187]
    v_pk_mul_f32 v[98:99], v[98:99], v[186:187]
    v_pk_mul_f32 v[102:103], v[102:103], v[186:187]
    v_pk_mul_f32 v[106:107], v[106:107], v[186:187]
    v_pk_mul_f32 v[110:111], v[110:111], v[186:187]
    v_cvt_pk_bf16_f32 v224, v82, v86
    v_cvt_pk_bf16_f32 v225, v90, v94
    v_cvt_pk_bf16_f32 v226, v98, v102
    v_cvt_pk_bf16_f32 v227, v106, v110
    s_waitcnt lgkmcnt(14)
    ds_write_b128 v234, v[224:227] offset:10496
    buffer_load_dwordx4 v[56:59], v232, s[48:51], s74 offen offset:832
    s_waitcnt vmcnt(15)
    v_mfma_f32_32x32x16_bf16 v[128:143], a[60:63], a[228:231], v[128:143]
    v_cvt_pk_bf16_f32 v228, v83, v87
    v_cvt_pk_bf16_f32 v229, v91, v95
    v_cvt_pk_bf16_f32 v230, v99, v103
    v_cvt_pk_bf16_f32 v231, v107, v111
    s_waitcnt lgkmcnt(14)
    ds_write_b128 v235, v[228:231] offset:10496
    v_add_u32 v234, v238, v234
    v_add_u32 v235, v238, v235
    buffer_load_dwordx4 v[60:63], v232, s[48:51], s75 offen offset:832
    s_waitcnt lgkmcnt(0)
    s_barrier
    s_waitcnt vmcnt(15)
    v_mfma_f32_32x32x16_bf16 v[80:95], a[64:67], a[224:227], 0
    v_pk_mul_f32 v[112:113], v[112:113], v[176:177]
    v_pk_mul_f32 v[116:117], v[116:117], v[176:177]
    v_pk_mul_f32 v[120:121], v[120:121], v[176:177]
    v_pk_mul_f32 v[124:125], v[124:125], v[176:177]
    v_pk_mul_f32 v[128:129], v[128:129], v[176:177]
    v_pk_mul_f32 v[132:133], v[132:133], v[176:177]
    v_pk_mul_f32 v[136:137], v[136:137], v[176:177]
    v_pk_mul_f32 v[140:141], v[140:141], v[176:177]
    v_cvt_pk_bf16_f32 v224, v112, v116
    v_cvt_pk_bf16_f32 v225, v120, v124
    v_cvt_pk_bf16_f32 v226, v128, v132
    v_cvt_pk_bf16_f32 v227, v136, v140
    ds_write_b128 v234, v[224:227] offset:6144
    ds_read_b128 a[0:3], v24 offset:0
    ds_read_b128 a[4:7], v24 offset:1024
    ds_read_b128 a[8:11], v24 offset:2048
    ds_read_b128 a[12:15], v24 offset:3072
    ds_read_b128 a[16:19], v24 offset:4096
    ds_read_b128 a[20:23], v24 offset:5120
    buffer_load_dwordx4 v[64:67], v232, s[48:51], s74 offen offset:128
    s_waitcnt vmcnt(14)
    v_mfma_f32_32x32x16_bf16 v[96:111], a[72:75], a[224:227], 0
    v_cvt_pk_bf16_f32 v228, v113, v117
    v_cvt_pk_bf16_f32 v229, v121, v125
    v_cvt_pk_bf16_f32 v230, v129, v133
    v_cvt_pk_bf16_f32 v231, v137, v141
    ds_write_b128 v235, v[228:231] offset:6144
    ds_read_b128 a[24:27], v24 offset:6144
    ds_read_b128 a[28:31], v24 offset:7168
    ds_read_b128 a[32:35], v24 offset:8192
    ds_read_b128 a[36:39], v24 offset:9216
    ds_read_b128 a[40:43], v24 offset:10240
    ds_read_b128 a[44:47], v24 offset:11264
    buffer_load_dwordx4 v[68:71], v232, s[48:51], s75 offen offset:128
    v_mfma_f32_32x32x16_bf16 v[80:95], a[68:71], a[228:231], v[80:95]
    v_pk_mul_f32 v[114:115], v[114:115], v[178:179]
    v_pk_mul_f32 v[118:119], v[118:119], v[178:179]
    v_pk_mul_f32 v[122:123], v[122:123], v[178:179]
    v_pk_mul_f32 v[126:127], v[126:127], v[178:179]
    v_pk_mul_f32 v[130:131], v[130:131], v[178:179]
    v_pk_mul_f32 v[134:135], v[134:135], v[178:179]
    v_pk_mul_f32 v[138:139], v[138:139], v[178:179]
    v_pk_mul_f32 v[142:143], v[142:143], v[178:179]
    v_cvt_pk_bf16_f32 v224, v114, v118
    v_cvt_pk_bf16_f32 v225, v122, v126
    v_cvt_pk_bf16_f32 v226, v130, v134
    v_cvt_pk_bf16_f32 v227, v138, v142
    ds_write_b128 v234, v[224:227] offset:6400
    s_waitcnt lgkmcnt(9)
    ds_read_b128 a[96:99], v24 offset:24576
    ds_read_b128 a[100:103], v24 offset:25600
    ds_read_b128 a[104:107], v24 offset:26624
    ds_read_b128 a[108:111], v24 offset:27648
    ds_read_b128 a[112:115], v24 offset:28672
    ds_read_b128 a[116:119], v24 offset:29696
    buffer_load_dwordx4 v[72:75], v232, s[48:51], s74 offen offset:896
    s_waitcnt vmcnt(15)
    v_mfma_f32_32x32x16_bf16 v[96:111], a[76:79], a[228:231], v[96:111]
    v_cvt_pk_bf16_f32 v228, v115, v119
    v_cvt_pk_bf16_f32 v229, v123, v127
    v_cvt_pk_bf16_f32 v230, v131, v135
    v_cvt_pk_bf16_f32 v231, v139, v143
    s_waitcnt lgkmcnt(9)
    ds_write_b128 v235, v[228:231] offset:6400
    ds_read_b128 a[120:123], v24 offset:30720
    ds_read_b128 a[124:127], v24 offset:31744
    ds_read_b128 a[128:131], v24 offset:32768
    ds_read_b128 a[132:135], v24 offset:33792
    ds_read_b128 a[136:139], v24 offset:34816
    s_waitcnt lgkmcnt(14)
    ds_read_b128 a[140:143], v24 offset:35840
    buffer_load_dwordx4 v[76:79], v232, s[48:51], s75 offen offset:896
    s_waitcnt vmcnt(15)
    v_mfma_f32_32x32x16_bf16 v[112:127], a[80:83], a[224:227], 0
    v_pk_mul_f32 v[80:81], v[80:81], v[180:181]
    v_pk_mul_f32 v[84:85], v[84:85], v[180:181]
    v_pk_mul_f32 v[88:89], v[88:89], v[180:181]
    v_pk_mul_f32 v[92:93], v[92:93], v[180:181]
    v_pk_mul_f32 v[96:97], v[96:97], v[180:181]
    v_pk_mul_f32 v[100:101], v[100:101], v[180:181]
    v_pk_mul_f32 v[104:105], v[104:105], v[180:181]
    v_pk_mul_f32 v[108:109], v[108:109], v[180:181]
    v_cvt_pk_bf16_f32 v224, v80, v84
    v_cvt_pk_bf16_f32 v225, v88, v92
    v_cvt_pk_bf16_f32 v226, v96, v100
    v_cvt_pk_bf16_f32 v227, v104, v108
    s_waitcnt lgkmcnt(9)
    ds_write_b128 v234, v[224:227] offset:8192
    ds_read_b128 a[144:147], v24 offset:36864
    ds_read_b128 a[148:151], v24 offset:37888
    ds_read_b128 a[152:155], v24 offset:38912
    ds_read_b128 a[156:159], v24 offset:39936
    ds_read_b128 a[160:163], v24 offset:40960
    s_waitcnt lgkmcnt(14)
    ds_read_b128 a[164:167], v24 offset:41984
    s_add_u32 m0, s56, 6336
    s_nop 0
    buffer_load_dwordx4 v1, s[20:23], 0 offen offset:64 lds
    s_add_u32 m0, s56, 7360
    s_waitcnt vmcnt(14)
    v_mfma_f32_32x32x16_bf16 v[128:143], a[88:91], a[224:227], 0
    v_cvt_pk_bf16_f32 v228, v81, v85
    v_cvt_pk_bf16_f32 v229, v89, v93
    v_cvt_pk_bf16_f32 v230, v97, v101
    v_cvt_pk_bf16_f32 v231, v105, v109
    s_waitcnt lgkmcnt(9)
    ds_write_b128 v235, v[228:231] offset:8192
    ds_read_b128 a[168:171], v24 offset:43008
    ds_read_b128 a[172:175], v24 offset:44032
    ds_read_b128 a[176:179], v24 offset:45056
    ds_read_b128 a[180:183], v24 offset:46080
    ds_read_b128 a[184:187], v24 offset:47104
    s_waitcnt lgkmcnt(14)
    ds_read_b128 a[188:191], v24 offset:48128
    buffer_load_dwordx4 v2, s[20:23], 0 offen offset:64 lds
    s_add_u32 m0, s56, 8384
    s_nop 0
    buffer_load_dwordx4 v3, s[20:23], 0 offen offset:64 lds
    s_add_u32 m0, s56, 9408
    v_mfma_f32_32x32x16_bf16 v[112:127], a[84:87], a[228:231], v[112:127]
    v_pk_mul_f32 v[82:83], v[82:83], v[182:183]
    v_pk_mul_f32 v[86:87], v[86:87], v[182:183]
    v_pk_mul_f32 v[90:91], v[90:91], v[182:183]
    v_pk_mul_f32 v[94:95], v[94:95], v[182:183]
    v_pk_mul_f32 v[98:99], v[98:99], v[182:183]
    v_pk_mul_f32 v[102:103], v[102:103], v[182:183]
    v_pk_mul_f32 v[106:107], v[106:107], v[182:183]
    v_pk_mul_f32 v[110:111], v[110:111], v[182:183]
    v_cvt_pk_bf16_f32 v224, v82, v86
    v_cvt_pk_bf16_f32 v225, v90, v94
    v_cvt_pk_bf16_f32 v226, v98, v102
    v_cvt_pk_bf16_f32 v227, v106, v110
    s_waitcnt lgkmcnt(9)
    ds_write_b128 v234, v[224:227] offset:8448
    ds_read_b128 a[192:195], v23 offset:0
    ds_read_b128 a[196:199], v23 offset:3072
    ds_read_b128 a[200:203], v23 offset:10240
    ds_read_b128 a[204:207], v23 offset:13312
    ds_read_b128 a[208:211], v23 offset:20480
    s_waitcnt lgkmcnt(14)
    ds_read_b128 a[212:215], v23 offset:23552
    buffer_load_dwordx4 v4, s[20:23], 0 offen offset:64 lds
    s_add_u32 m0, s56, 10432
    s_nop 0
    buffer_load_dwordx4 v5, s[20:23], 0 offen offset:64 lds
    s_add_u32 m0, s56, 11456
    s_waitcnt vmcnt(17)
    v_mfma_f32_32x32x16_bf16 v[128:143], a[92:95], a[228:231], v[128:143]
    v_cvt_pk_bf16_f32 v228, v83, v87
    v_cvt_pk_bf16_f32 v229, v91, v95
    v_cvt_pk_bf16_f32 v230, v99, v103
    v_cvt_pk_bf16_f32 v231, v107, v111
    s_waitcnt lgkmcnt(14)
    ds_write_b128 v235, v[228:231] offset:8448
    v_add_u32 v234, v239, v234
    v_add_u32 v235, v239, v235
    v_add_u32 v238, v238, v239
    s_waitcnt lgkmcnt(13)
    ds_read_b128 a[216:219], v23 offset:30720
    ds_read_b128 a[220:223], v23 offset:33792
    buffer_load_dwordx4 v6, s[20:23], 0 offen offset:64 lds
    s_add_u32 m0, s56, 12480
    s_nop 0
    buffer_load_dword v7, s[20:23], 0 offen offset:64 lds
    buffer_load_dword v254, v31, s[20:23], 0 offen
    s_waitcnt lgkmcnt(9)
    ds_read_b128 a[48:51], v24 offset:12288
    ds_read_b128 a[52:55], v24 offset:13312
    ds_read_b128 a[56:59], v24 offset:14336
    ds_read_b128 a[60:63], v24 offset:15360
    ds_read_b128 a[64:67], v24 offset:16384
    ds_read_b128 a[68:71], v24 offset:17408
    s_waitcnt lgkmcnt(9)
    ds_read_b128 a[72:75], v24 offset:18432
    ds_read_b128 a[76:79], v24 offset:19456
    ds_read_b128 a[80:83], v24 offset:20480
    ds_read_b128 a[84:87], v24 offset:21504
    ds_read_b128 a[88:91], v24 offset:22528
    ds_read_b128 a[92:95], v24 offset:23552
    s_waitcnt lgkmcnt(0)
    s_barrier
    s_waitcnt vmcnt(19)
    v_mfma_f32_32x32x16_bf16 v[80:95], v[32:35], a[224:227], 0
    v_pk_mul_f32 v[112:113], v[112:113], v[184:185]
    v_pk_mul_f32 v[116:117], v[116:117], v[184:185]
    v_pk_mul_f32 v[120:121], v[120:121], v[184:185]
    v_pk_mul_f32 v[124:125], v[124:125], v[184:185]
    v_pk_mul_f32 v[128:129], v[128:129], v[184:185]
    v_pk_mul_f32 v[132:133], v[132:133], v[184:185]
    v_pk_mul_f32 v[136:137], v[136:137], v[184:185]
    v_pk_mul_f32 v[140:141], v[140:141], v[184:185]
    v_cvt_pk_bf16_f32 v224, v112, v116
    v_cvt_pk_bf16_f32 v225, v120, v124
    v_cvt_pk_bf16_f32 v226, v128, v132
    v_cvt_pk_bf16_f32 v227, v136, v140
    ds_write_b128 v234, v[224:227] offset:0
    s_waitcnt vmcnt(17)
    v_mfma_f32_32x32x16_bf16 v[96:111], v[40:43], a[224:227], 0
    v_cvt_pk_bf16_f32 v228, v113, v117
    v_cvt_pk_bf16_f32 v229, v121, v125
    v_cvt_pk_bf16_f32 v230, v129, v133
    v_cvt_pk_bf16_f32 v231, v137, v141
    ds_write_b128 v235, v[228:231] offset:0
    v_mfma_f32_32x32x16_bf16 v[80:95], v[36:39], a[228:231], v[80:95]
    v_pk_mul_f32 v[114:115], v[114:115], v[186:187]
    v_pk_mul_f32 v[118:119], v[118:119], v[186:187]
    v_pk_mul_f32 v[122:123], v[122:123], v[186:187]
    v_pk_mul_f32 v[126:127], v[126:127], v[186:187]
    v_pk_mul_f32 v[130:131], v[130:131], v[186:187]
    v_pk_mul_f32 v[134:135], v[134:135], v[186:187]
    v_pk_mul_f32 v[138:139], v[138:139], v[186:187]
    v_pk_mul_f32 v[142:143], v[142:143], v[186:187]
    v_cvt_pk_bf16_f32 v224, v114, v118
    v_cvt_pk_bf16_f32 v225, v122, v126
    v_cvt_pk_bf16_f32 v226, v130, v134
    v_cvt_pk_bf16_f32 v227, v138, v142
    ds_write_b128 v234, v[224:227] offset:256
    s_waitcnt vmcnt(16)
    v_mfma_f32_32x32x16_bf16 v[96:111], v[44:47], a[228:231], v[96:111]
    v_cvt_pk_bf16_f32 v228, v115, v119
    v_cvt_pk_bf16_f32 v229, v123, v127
    v_cvt_pk_bf16_f32 v230, v131, v135
    v_cvt_pk_bf16_f32 v231, v139, v143
    ds_write_b128 v235, v[228:231] offset:256
    v_sub_u32 v234, v234, v238
    v_sub_u32 v235, v235, v238
    s_waitcnt vmcnt(15)
    v_mfma_f32_32x32x16_bf16 v[112:127], v[48:51], a[224:227], 0
    v_pk_mul_f32 v[80:81], v[80:81], v[176:177]
    v_pk_mul_f32 v[84:85], v[84:85], v[176:177]
    v_pk_mul_f32 v[88:89], v[88:89], v[176:177]
    v_pk_mul_f32 v[92:93], v[92:93], v[176:177]
    v_pk_mul_f32 v[96:97], v[96:97], v[176:177]
    v_pk_mul_f32 v[100:101], v[100:101], v[176:177]
    v_pk_mul_f32 v[104:105], v[104:105], v[176:177]
    v_pk_mul_f32 v[108:109], v[108:109], v[176:177]
    v_cvt_pk_bf16_f32 v224, v80, v84
    v_cvt_pk_bf16_f32 v225, v88, v92
    v_cvt_pk_bf16_f32 v226, v96, v100
    v_cvt_pk_bf16_f32 v227, v104, v108
    ds_write_b128 v234, v[224:227] offset:6144
    s_waitcnt vmcnt(13)
    v_mfma_f32_32x32x16_bf16 v[128:143], v[56:59], a[224:227], 0
    v_cvt_pk_bf16_f32 v228, v81, v85
    v_cvt_pk_bf16_f32 v229, v89, v93
    v_cvt_pk_bf16_f32 v230, v97, v101
    v_cvt_pk_bf16_f32 v231, v105, v109
    ds_write_b128 v235, v[228:231] offset:6144
    v_mfma_f32_32x32x16_bf16 v[112:127], v[52:55], a[228:231], v[112:127]
    v_pk_mul_f32 v[82:83], v[82:83], v[178:179]
    v_pk_mul_f32 v[86:87], v[86:87], v[178:179]
    v_pk_mul_f32 v[90:91], v[90:91], v[178:179]
    v_pk_mul_f32 v[94:95], v[94:95], v[178:179]
    v_pk_mul_f32 v[98:99], v[98:99], v[178:179]
    v_pk_mul_f32 v[102:103], v[102:103], v[178:179]
    v_pk_mul_f32 v[106:107], v[106:107], v[178:179]
    v_pk_mul_f32 v[110:111], v[110:111], v[178:179]
    v_cvt_pk_bf16_f32 v224, v82, v86
    v_cvt_pk_bf16_f32 v225, v90, v94
    v_cvt_pk_bf16_f32 v226, v98, v102
    v_cvt_pk_bf16_f32 v227, v106, v110
    ds_write_b128 v234, v[224:227] offset:6400
    s_waitcnt vmcnt(12)
    v_mfma_f32_32x32x16_bf16 v[128:143], v[60:63], a[228:231], v[128:143]
    v_cvt_pk_bf16_f32 v228, v83, v87
    v_cvt_pk_bf16_f32 v229, v91, v95
    v_cvt_pk_bf16_f32 v230, v99, v103
    v_cvt_pk_bf16_f32 v231, v107, v111
    ds_write_b128 v235, v[228:231] offset:6400
    s_waitcnt vmcnt(11)
    v_mfma_f32_32x32x16_bf16 v[80:95], v[64:67], a[224:227], 0
    v_pk_mul_f32 v[112:113], v[112:113], v[180:181]
    v_pk_mul_f32 v[116:117], v[116:117], v[180:181]
    v_pk_mul_f32 v[120:121], v[120:121], v[180:181]
    v_pk_mul_f32 v[124:125], v[124:125], v[180:181]
    s_nop 0
    v_pk_mul_f32 v[128:129], v[128:129], v[180:181]
    v_pk_mul_f32 v[132:133], v[132:133], v[180:181]
    v_pk_mul_f32 v[136:137], v[136:137], v[180:181]
    v_pk_mul_f32 v[140:141], v[140:141], v[180:181]
    v_cvt_pk_bf16_f32 v224, v112, v116
    v_cvt_pk_bf16_f32 v225, v120, v124
    v_cvt_pk_bf16_f32 v226, v128, v132
    v_cvt_pk_bf16_f32 v227, v136, v140
    ds_write_b128 v234, v[224:227] offset:8192
    s_waitcnt vmcnt(9)
    v_mfma_f32_32x32x16_bf16 v[96:111], v[72:75], a[224:227], 0
    v_cvt_pk_bf16_f32 v228, v113, v117
    v_cvt_pk_bf16_f32 v229, v121, v125
    v_cvt_pk_bf16_f32 v230, v129, v133
    v_cvt_pk_bf16_f32 v231, v137, v141
    ds_write_b128 v235, v[228:231] offset:8192
    v_mfma_f32_32x32x16_bf16 v[80:95], v[68:71], a[228:231], v[80:95]
    v_pk_mul_f32 v[114:115], v[114:115], v[182:183]
    v_pk_mul_f32 v[118:119], v[118:119], v[182:183]
    v_pk_mul_f32 v[122:123], v[122:123], v[182:183]
    v_pk_mul_f32 v[126:127], v[126:127], v[182:183]
    v_pk_mul_f32 v[130:131], v[130:131], v[182:183]
    v_pk_mul_f32 v[134:135], v[134:135], v[182:183]
    v_pk_mul_f32 v[138:139], v[138:139], v[182:183]
    v_pk_mul_f32 v[142:143], v[142:143], v[182:183]
    v_cvt_pk_bf16_f32 v224, v114, v118
    v_cvt_pk_bf16_f32 v225, v122, v126
    v_cvt_pk_bf16_f32 v226, v130, v134
    v_cvt_pk_bf16_f32 v227, v138, v142
    ds_write_b128 v234, v[224:227] offset:8448
    s_waitcnt vmcnt(8)
    v_mfma_f32_32x32x16_bf16 v[96:111], v[76:79], a[228:231], v[96:111]
    v_cvt_pk_bf16_f32 v228, v115, v119
    v_cvt_pk_bf16_f32 v229, v123, v127
    v_cvt_pk_bf16_f32 v230, v131, v135
    v_cvt_pk_bf16_f32 v231, v139, v143
    ds_write_b128 v235, v[228:231] offset:8448
    v_pk_mul_f32 v[80:81], v[80:81], v[184:185]
    v_pk_mul_f32 v[84:85], v[84:85], v[184:185]
    v_pk_mul_f32 v[88:89], v[88:89], v[184:185]
    v_pk_mul_f32 v[92:93], v[92:93], v[184:185]
    s_nop 2
    v_pk_mul_f32 v[96:97], v[96:97], v[184:185]
    v_pk_mul_f32 v[100:101], v[100:101], v[184:185]
    v_pk_mul_f32 v[104:105], v[104:105], v[184:185]
    v_pk_mul_f32 v[108:109], v[108:109], v[184:185]
    v_cvt_pk_bf16_f32 v224, v80, v84
    v_cvt_pk_bf16_f32 v225, v88, v92
    v_cvt_pk_bf16_f32 v226, v96, v100
    v_cvt_pk_bf16_f32 v227, v104, v108
    ds_write_b128 v234, v[224:227] offset:10240
    v_cvt_pk_bf16_f32 v228, v81, v85
    v_cvt_pk_bf16_f32 v229, v89, v93
    v_cvt_pk_bf16_f32 v230, v97, v101
    v_cvt_pk_bf16_f32 v231, v105, v109
    ds_write_b128 v235, v[228:231] offset:10240
    v_pk_mul_f32 v[82:83], v[82:83], v[186:187]
    v_pk_mul_f32 v[86:87], v[86:87], v[186:187]
    v_pk_mul_f32 v[90:91], v[90:91], v[186:187]
    v_pk_mul_f32 v[94:95], v[94:95], v[186:187]
    v_pk_mul_f32 v[98:99], v[98:99], v[186:187]
    v_pk_mul_f32 v[102:103], v[102:103], v[186:187]
    v_pk_mul_f32 v[106:107], v[106:107], v[186:187]
    v_pk_mul_f32 v[110:111], v[110:111], v[186:187]
    v_cvt_pk_bf16_f32 v224, v82, v86
    v_cvt_pk_bf16_f32 v225, v90, v94
    v_cvt_pk_bf16_f32 v226, v98, v102
    v_cvt_pk_bf16_f32 v227, v106, v110
    ds_write_b128 v234, v[224:227] offset:10496
    v_cvt_pk_bf16_f32 v228, v83, v87
    v_cvt_pk_bf16_f32 v229, v91, v95
    v_cvt_pk_bf16_f32 v230, v99, v103
    v_cvt_pk_bf16_f32 v231, v107, v111
    s_waitcnt lgkmcnt(14)
    ds_write_b128 v235, v[228:231] offset:10496
L_conv0:
    s_waitcnt lgkmcnt(9)
    ds_read_b128 v[192:195], v22 offset:0
    ds_read_b128 v[200:203], v22 offset:16
    ds_read_b128 a[232:235], v8 offset:0
    s_waitcnt lgkmcnt(9)
    ds_read_b128 a[244:247], v8 offset:2560
    ds_read_b128 a[236:239], v12 offset:0
    ds_read_b128 a[248:251], v12 offset:2560
    ds_read_b128 a[240:243], v14 offset:1280
    ds_read_b128 a[252:255], v14 offset:3840
    ds_read_b128 v[196:199], v22 offset:256
    s_waitcnt lgkmcnt(9)
    ds_read_b128 v[204:207], v22 offset:272
    ds_read_b128 v[176:179], v9 offset:0
    ds_read_b128 v[188:191], v9 offset:2560
    ds_read_b128 v[180:183], v13 offset:0
    ds_read_b128 v[232:235], v13 offset:2560
    ds_read_b128 v[184:187], v15 offset:1280
    s_waitcnt lgkmcnt(11)
    ds_read_b128 v[236:239], v15 offset:3840
    ds_read_b128 v[52:55], v20 offset:2560
    ds_read_b128 v[48:51], v20 offset:0
    ds_read_b128 v[60:63], v21 offset:2560
    v_mfma_f32_16x16x32_bf16 v[128:131], v[192:195], a[232:235], 0
    s_waitcnt lgkmcnt(0)
    ds_read_b128 v[56:59], v21 offset:0
    ds_read_b128 v[32:35], v25 offset:0
    ds_read_b128 v[36:39], v25 offset:32
    ds_read_b128 v[40:43], v25 offset:64
    ds_read_b128 v[44:47], v25 offset:96
    ds_read_b128 a[232:235], v10 offset:0
    v_mfma_f32_16x16x32_bf16 v[152:155], v[192:195], a[244:247], 0
    ds_read_b128 a[244:247], v10 offset:2560
    ds_read_b128 v[192:195], v22 offset:512
    v_smfmac_f32_16x16x64_bf16 v[128:131], v[200:203], a[236:243], v16
    ds_read_b128 a[236:239], v14 offset:0
    ds_read_b128 a[240:243], v12 offset:1280
    s_nop 0
    v_smfmac_f32_16x16x64_bf16 v[152:155], v[200:203], a[248:255], v16
    ds_read_b128 a[248:251], v14 offset:2560
    ds_read_b128 a[252:255], v12 offset:3840
    ds_read_b128 v[200:203], v22 offset:528
    s_nop 0
    v_cvt_pkrtz_f16_f32 v128, v128, v129
    v_cvt_pkrtz_f16_f32 v129, v130, v131
    v_dot2_f32_f16 v28, v128, v128, 0
    v_dot2_f32_f16 v27, v128, s58, 0
    v_cvt_pkrtz_f16_f32 v152, v152, v153
    v_mfma_f32_16x16x32_bf16 v[224:227], v[196:199], v[176:179], 0
    ds_read_b128 v[176:179], v11 offset:0
    v_cvt_pkrtz_f16_f32 v153, v154, v155
    v_mfma_f32_16x16x32_bf16 v[228:231], v[196:199], v[188:191], 0
    s_waitcnt lgkmcnt(12)
    ds_read_b128 v[188:191], v11 offset:2560
    ds_read_b128 v[196:199], v22 offset:768
    v_dot2_f32_f16 v30, v152, v152, 0
    v_dot2_f32_f16 v29, v152, s58, 0
    v_dot2_f32_f16 v28, v129, v129, v28
    v_dot2_f32_f16 v30, v153, v153, v30
    v_dot2_f32_f16 v27, v129, s58, v27
    v_smfmac_f32_16x16x64_bf16 v[224:227], v[204:207], v[180:187], v16
    s_waitcnt lgkmcnt(1)
    ds_read_b128 v[180:183], v15 offset:0
    ds_read_b128 v[184:187], v13 offset:1280
    v_smfmac_f32_16x16x64_bf16 v[228:231], v[204:207], v[232:239], v16
    s_add_u32 m0, s56, -128
    ds_read_b128 v[232:235], v15 offset:2560
    ds_read_b128 v[236:239], v13 offset:3840
    ds_read_b128 v[204:207], v22 offset:784
    v_cvt_pkrtz_f16_f32 v130, v224, v225
    v_cvt_pkrtz_f16_f32 v131, v226, v227
    v_dot2_f32_f16 v29, v153, s58, v29
    s_nop 0
    v_cvt_pkrtz_f16_f32 v154, v228, v229
    v_cvt_pkrtz_f16_f32 v155, v230, v231
    v_dot2_f32_f16 v28, v130, v130, v28
    v_dot2_f32_f16 v30, v154, v154, v30
    v_dot2_f32_f16 v27, v130, s58, v27
    v_dot2_f32_f16 v29, v154, s58, v29
    v_dot2_f32_f16 v28, v131, v131, v28
    v_dot2_f32_f16 v30, v155, v155, v30
    v_dot2_f32_f16 v27, v131, s58, v27
    v_dot2_f32_f16 v29, v155, s58, v29
    v_mfma_f32_16x16x32_bf16 v[132:135], v[192:195], a[232:235], 0
    s_waitcnt vmcnt(1)
    ds_read_b128 a[232:235], v8 offset:6400
    v_mfma_f32_16x16x32_bf16 v[156:159], v[192:195], a[244:247], 0
    ds_read_b128 a[244:247], v8 offset:8960
    ds_read_b128 v[192:195], v22 offset:1024
    s_nop 0
    v_smfmac_f32_16x16x64_bf16 v[132:135], v[200:203], a[236:243], v16
    ds_read_b128 a[236:239], v12 offset:6400
    ds_read_b128 a[240:243], v14 offset:7680
    v_smfmac_f32_16x16x64_bf16 v[156:159], v[200:203], a[248:255], v16
    ds_read_b128 a[248:251], v12 offset:8960
    ds_read_b128 a[252:255], v14 offset:10240
    ds_read_b128 v[200:203], v22 offset:1040
    s_nop 1
    v_cvt_pkrtz_f16_f32 v132, v132, v133
    s_waitcnt lgkmcnt(13)
    v_mfma_f32_16x16x32_bf16 v[224:227], v[196:199], v[176:179], 0
    ds_read_b128 v[176:179], v9 offset:6400
    v_cvt_pkrtz_f16_f32 v156, v156, v157
    v_mfma_f32_16x16x32_bf16 v[228:231], v[196:199], v[188:191], 0
    s_waitcnt lgkmcnt(10)
    ds_read_b128 v[188:191], v9 offset:8960
    ds_read_b128 v[196:199], v22 offset:1280
    v_cvt_pkrtz_f16_f32 v133, v134, v135
    v_cvt_pkrtz_f16_f32 v157, v158, v159
    v_dot2_f32_f16 v28, v132, v132, v28
    v_dot2_f32_f16 v30, v156, v156, v30
    v_dot2_f32_f16 v27, v132, s58, v27
    v_dot2_f32_f16 v29, v156, s58, v29
    v_dot2_f32_f16 v28, v133, v133, v28
    v_dot2_f32_f16 v30, v157, v157, v30
    v_dot2_f32_f16 v27, v133, s58, v27
    s_waitcnt lgkmcnt(11)
    v_smfmac_f32_16x16x64_bf16 v[224:227], v[204:207], v[180:187], v16
    buffer_load_dwordx4 v1, s[20:23], 0 offen offset:128 lds
    ds_read_b128 v[180:183], v13 offset:6400
    ds_read_b128 v[184:187], v15 offset:7680
    s_add_u32 m0, s56, 896
    v_smfmac_f32_16x16x64_bf16 v[228:231], v[204:207], v[232:239], v16
    s_waitcnt lgkmcnt(0)
    buffer_load_dwordx4 v2, s[20:23], 0 offen offset:128 lds
    ds_read_b128 v[232:235], v13 offset:8960
    ds_read_b128 v[236:239], v15 offset:10240
    ds_read_b128 v[204:207], v22 offset:1296
    v_dot2_f32_f16 v29, v157, s58, v29
    v_cvt_pkrtz_f16_f32 v134, v224, v225
    v_cvt_pkrtz_f16_f32 v135, v226, v227
    v_dot2_f32_f16 v28, v134, v134, v28
    v_mfma_f32_16x16x32_bf16 v[136:139], v[192:195], a[232:235], 0
    s_add_u32 m0, s56, 1920
    ds_read_b128 a[232:235], v10 offset:6400
    buffer_load_dwordx4 v3, s[20:23], 0 offen offset:128 lds
    ds_read_b128 v[212:215], v20 offset:8960
    v_mfma_f32_16x16x32_bf16 v[160:163], v[192:195], a[244:247], 0
    s_add_u32 m0, s56, 2944
    ds_read_b128 a[244:247], v10 offset:8960
    buffer_load_dwordx4 v4, s[20:23], 0 offen offset:128 lds
    ds_read_b128 v[192:195], v22 offset:1536
    v_mfma_f32_32x32x16_bf16 v[80:95], a[224:227], v[52:55], v[32:47]
    s_add_u32 m0, s56, 3968
    v_cvt_pkrtz_f16_f32 v158, v228, v229
    v_cvt_pkrtz_f16_f32 v159, v230, v231
    v_smfmac_f32_16x16x64_bf16 v[136:139], v[200:203], a[236:243], v16
    buffer_load_dwordx4 v5, s[20:23], 0 offen offset:128 lds
    ds_read_b128 a[236:239], v14 offset:6400
    ds_read_b128 a[240:243], v12 offset:7680
    ds_read_b128 v[208:211], v20 offset:6400
    v_smfmac_f32_16x16x64_bf16 v[160:163], v[200:203], a[248:255], v16
    s_add_u32 m0, s56, 4992
    ds_read_b128 a[248:251], v14 offset:8960
    buffer_load_dwordx4 v6, s[20:23], 0 offen offset:128 lds
    ds_read_b128 a[252:255], v12 offset:10240
    ds_read_b128 v[200:203], v22 offset:1552
    v_mfma_f32_32x32x16_bf16 v[32:47], a[224:227], v[48:51], v[32:47]
    s_add_u32 m0, s56, 6016
    v_cvt_pkrtz_f16_f32 v136, v136, v137
    v_cvt_pkrtz_f16_f32 v160, v160, v161
    v_cvt_pkrtz_f16_f32 v137, v138, v139
    v_cvt_pkrtz_f16_f32 v161, v162, v163
    v_mfma_f32_16x16x32_bf16 v[224:227], v[196:199], v[176:179], 0
    s_waitcnt lgkmcnt(1)
    buffer_load_dword v7, s[20:23], 0 offen offset:128 lds
    ds_read_b128 v[176:179], v11 offset:6400
    ds_read_b128 v[220:223], v21 offset:8960
    v_mfma_f32_16x16x32_bf16 v[228:231], v[196:199], v[188:191], 0
    ds_read_b128 v[188:191], v11 offset:8960
    ds_read_b128 v[196:199], v22 offset:1792
    v_mfma_f32_32x32x16_bf16 v[80:95], a[228:231], v[60:63], v[80:95]
    v_smfmac_f32_16x16x64_bf16 v[224:227], v[204:207], v[180:187], v16
    ds_read_b128 v[180:183], v15 offset:6400
    ds_read_b128 v[184:187], v13 offset:7680
    ds_read_b128 v[216:219], v21 offset:6400
    v_smfmac_f32_16x16x64_bf16 v[228:231], v[204:207], v[232:239], v16
    ds_read_b128 v[232:235], v15 offset:8960
    ds_read_b128 v[236:239], v13 offset:10240
    ds_read_b128 v[204:207], v22 offset:1808
    v_mfma_f32_32x32x16_bf16 v[32:47], a[228:231], v[56:59], v[32:47]
    v_cvt_pkrtz_f16_f32 v138, v224, v225
    v_cvt_pkrtz_f16_f32 v139, v226, v227
    s_nop 1
    v_cvt_pkrtz_f16_f32 v162, v228, v229
    v_cvt_pkrtz_f16_f32 v163, v230, v231
    v_mfma_f32_16x16x32_bf16 v[140:143], v[192:195], a[232:235], 0
    v_mfma_f32_16x16x32_bf16 v[164:167], v[192:195], a[244:247], 0
    ds_read_b128 v[192:195], v22 offset:2048
    v_dot2_f32_f16 v30, v158, v158, v30
    v_dot2_f32_f16 v27, v134, s58, v27
    v_dot2_f32_f16 v29, v158, s58, v29
    v_dot2_f32_f16 v28, v135, v135, v28
    v_dot2_f32_f16 v30, v159, v159, v30
    s_waitcnt lgkmcnt(11)
    v_smfmac_f32_16x16x64_bf16 v[140:143], v[200:203], a[236:243], v16
    v_smfmac_f32_16x16x64_bf16 v[164:167], v[200:203], a[248:255], v16
    s_waitcnt lgkmcnt(10)
    ds_read_b128 v[200:203], v22 offset:2064
    v_dot2_f32_f16 v27, v135, s58, v27
    v_dot2_f32_f16 v29, v159, s58, v29
    v_dot2_f32_f16 v28, v136, v136, v28
    v_dot2_f32_f16 v30, v160, v160, v30
    v_dot2_f32_f16 v27, v136, s58, v27
    v_dot2_f32_f16 v29, v160, s58, v29
    v_dot2_f32_f16 v28, v137, v137, v28
    v_dot2_f32_f16 v30, v161, v161, v30
    v_dot2_f32_f16 v27, v137, s58, v27
    v_dot2_f32_f16 v29, v161, s58, v29
    v_dot2_f32_f16 v28, v138, v138, v28
    v_dot2_f32_f16 v30, v162, v162, v30
    v_dot2_f32_f16 v27, v138, s58, v27
    v_dot2_f32_f16 v29, v162, s58, v29
    v_dot2_f32_f16 v28, v139, v139, v28
    v_dot2_f32_f16 v30, v163, v163, v30
    v_dot2_f32_f16 v27, v139, s58, v27
    v_dot2_f32_f16 v29, v163, s58, v29
    v_cvt_pkrtz_f16_f32 v140, v140, v141
    v_cvt_pkrtz_f16_f32 v164, v164, v165
    v_cvt_pkrtz_f16_f32 v141, v142, v143
    s_waitcnt lgkmcnt(8)
    v_mfma_f32_16x16x32_bf16 v[224:227], v[196:199], v[176:179], 0
    v_cvt_pkrtz_f16_f32 v165, v166, v167
    v_mfma_f32_16x16x32_bf16 v[228:231], v[196:199], v[188:191], 0
    s_waitcnt lgkmcnt(6)
    ds_read_b128 v[196:199], v22 offset:2304
    v_dot2_f32_f16 v28, v140, v140, v28
    v_dot2_f32_f16 v30, v164, v164, v30
    v_dot2_f32_f16 v27, v140, s58, v27
    v_dot2_f32_f16 v29, v164, s58, v29
    v_dot2_f32_f16 v28, v141, v141, v28
    s_waitcnt lgkmcnt(3)
    v_smfmac_f32_16x16x64_bf16 v[224:227], v[204:207], v[180:187], v16
    v_smfmac_f32_16x16x64_bf16 v[228:231], v[204:207], v[232:239], v16
    s_waitcnt lgkmcnt(1)
    ds_read_b128 v[204:207], v22 offset:2320
    v_dot2_f32_f16 v30, v165, v165, v30
    v_dot2_f32_f16 v27, v141, s58, v27
    v_dot2_f32_f16 v29, v165, s58, v29
    s_nop 1
    v_cvt_pkrtz_f16_f32 v142, v224, v225
    v_cvt_pkrtz_f16_f32 v166, v228, v229
    v_cvt_pkrtz_f16_f32 v143, v226, v227
    v_cvt_pkrtz_f16_f32 v167, v230, v231
    v_dot2_f32_f16 v28, v142, v142, v28
    v_dot2_f32_f16 v30, v166, v166, v30
    v_dot2_f32_f16 v27, v142, s58, v27
    v_dot2_f32_f16 v29, v166, s58, v29
    v_dot2_f32_f16 v28, v143, v143, v28
    v_dot2_f32_f16 v30, v167, v167, v30
    v_dot2_f32_f16 v27, v143, s58, v27
    v_dot2_f32_f16 v29, v167, s58, v29
    s_waitcnt vmcnt(0)
    ds_read_b128 a[232:235], v8 offset:0
    ds_read_b128 a[244:247], v8 offset:2560
    ds_read_b128 a[236:239], v12 offset:0
    ds_read_b128 a[240:243], v14 offset:1280
    ds_read_b128 a[248:251], v12 offset:2560
    ds_read_b128 a[252:255], v14 offset:3840
    ds_read_b128 v[176:179], v9 offset:0
    ds_read_b128 v[188:191], v9 offset:2560
    ds_read_b128 v[180:183], v13 offset:0
    ds_read_b128 v[184:187], v15 offset:1280
    ds_read_b128 v[232:235], v13 offset:2560
    ds_read_b128 v[236:239], v15 offset:3840
    s_waitcnt lgkmcnt(11)
    v_mfma_f32_16x16x32_bf16 v[144:147], v[192:195], a[232:235], 0
    s_waitcnt lgkmcnt(10)
    ds_read_b128 a[232:235], v10 offset:0
    v_mfma_f32_16x16x32_bf16 v[168:171], v[192:195], a[244:247], 0
    s_waitcnt lgkmcnt(10)
    ds_read_b128 a[244:247], v10 offset:2560
    ds_read_b128 v[192:195], v22 offset:2560
    s_waitcnt lgkmcnt(11)
    v_smfmac_f32_16x16x64_bf16 v[144:147], v[200:203], a[236:243], v16
    s_waitcnt lgkmcnt(10)
    ds_read_b128 a[236:239], v14 offset:0
    ds_read_b128 a[240:243], v12 offset:1280
    s_waitcnt lgkmcnt(11)
    v_smfmac_f32_16x16x64_bf16 v[168:171], v[200:203], a[248:255], v16
    ds_read_b128 a[248:251], v14 offset:2560
    ds_read_b128 a[252:255], v12 offset:3840
    ds_read_b128 v[200:203], v22 offset:2576
    s_waitcnt lgkmcnt(13)
    v_mfma_f32_16x16x32_bf16 v[224:227], v[196:199], v[176:179], 0
    s_waitcnt lgkmcnt(12)
    ds_read_b128 v[176:179], v11 offset:0
    ds_read_b128 v[48:51], v25 offset:128
    v_mfma_f32_16x16x32_bf16 v[228:231], v[196:199], v[188:191], 0
    s_waitcnt lgkmcnt(1)
    ds_read_b128 v[188:191], v11 offset:2560
    ds_read_b128 v[196:199], v22 offset:2816
    ds_read_b128 v[52:55], v25 offset:160
    v_cvt_pkrtz_f16_f32 v144, v144, v145
    v_cvt_pkrtz_f16_f32 v168, v168, v169
    v_smfmac_f32_16x16x64_bf16 v[224:227], v[204:207], v[180:187], v16
    ds_read_b128 v[180:183], v15 offset:0
    ds_read_b128 v[184:187], v13 offset:1280
    ds_read_b128 v[56:59], v25 offset:192
    v_cvt_pkrtz_f16_f32 v145, v146, v147
    v_cvt_pkrtz_f16_f32 v169, v170, v171
    v_dot2_f32_f16 v28, v144, v144, v28
    v_smfmac_f32_16x16x64_bf16 v[228:231], v[204:207], v[232:239], v16
    ds_read_b128 v[232:235], v15 offset:2560
    ds_read_b128 v[236:239], v13 offset:3840
    ds_read_b128 v[204:207], v22 offset:2832
    ds_read_b128 v[60:63], v25 offset:224
    v_cvt_pkrtz_f16_f32 v146, v224, v225
    v_dot2_f32_f16 v30, v168, v168, v30
    v_dot2_f32_f16 v27, v144, s58, v27
    v_dot2_f32_f16 v29, v168, s58, v29
    v_dot2_f32_f16 v28, v145, v145, v28
    v_dot2_f32_f16 v30, v169, v169, v30
    v_dot2_f32_f16 v27, v145, s58, v27
    v_dot2_f32_f16 v29, v169, s58, v29
    v_cvt_pkrtz_f16_f32 v170, v228, v229
    v_cvt_pkrtz_f16_f32 v147, v226, v227
    v_cvt_pkrtz_f16_f32 v171, v230, v231
    v_mfma_f32_16x16x32_bf16 v[148:151], v[192:195], a[232:235], 0
    ds_read_b128 v[64:67], v25 offset:256
    v_mfma_f32_16x16x32_bf16 v[172:175], v[192:195], a[244:247], 0
    ds_read_b128 v[68:71], v25 offset:288
    s_nop 2
    v_smfmac_f32_16x16x64_bf16 v[148:151], v[200:203], a[236:243], v16
    ds_read_b128 v[72:75], v25 offset:320
    v_smfmac_f32_16x16x64_bf16 v[172:175], v[200:203], a[248:255], v16
    s_waitcnt lgkmcnt(13)
    ds_read_b128 v[76:79], v25 offset:352
    s_nop 3
    v_cvt_pkrtz_f16_f32 v148, v148, v149
    v_cvt_pkrtz_f16_f32 v149, v150, v151
    v_cvt_pkrtz_f16_f32 v172, v172, v173
    v_cvt_pkrtz_f16_f32 v173, v174, v175
    s_waitcnt lgkmcnt(12)
    v_mfma_f32_16x16x32_bf16 v[224:227], v[196:199], v[176:179], 0
    ds_read_b128 a[232:235], v23 offset:1024
    ds_read_b128 a[236:239], v23 offset:2048
    v_mfma_f32_16x16x32_bf16 v[228:231], v[196:199], v[188:191], 0
    s_waitcnt lgkmcnt(8)
    ds_read_b128 a[240:243], v23 offset:4096
    ds_read_b128 a[244:247], v23 offset:5120
    s_waitcnt lgkmcnt(9)
    v_smfmac_f32_16x16x64_bf16 v[224:227], v[204:207], v[180:187], v16
    ds_read_b128 a[248:251], v23 offset:11264
    v_smfmac_f32_16x16x64_bf16 v[228:231], v[204:207], v[232:239], v16
    ds_read_b128 a[252:255], v23 offset:12288
    s_waitcnt lgkmcnt(0)
    s_barrier
    s_branch L_mid
L_conv:
    v_mfma_f32_16x16x32_bf16 v[128:131], v[192:195], a[232:235], 0
    ds_read_b128 a[232:235], v10 offset:0
    v_mfma_f32_16x16x32_bf16 v[152:155], v[192:195], a[244:247], 0
    ds_read_b128 a[244:247], v10 offset:2560
    ds_read_b128 v[192:195], v22 offset:512
    s_nop 1
    v_smfmac_f32_16x16x64_bf16 v[128:131], v[200:203], a[236:243], v16
    ds_read_b128 a[236:239], v14 offset:0
    ds_read_b128 a[240:243], v12 offset:1280
    v_smfmac_f32_16x16x64_bf16 v[152:155], v[200:203], a[248:255], v16
    ds_read_b128 a[248:251], v14 offset:2560
    ds_read_b128 a[252:255], v12 offset:3840
    ds_read_b128 v[200:203], v22 offset:528
    v_mfma_f32_16x16x32_bf16 v[224:227], v[196:199], v[176:179], 0
    ds_read_b128 v[176:179], v11 offset:0
    v_cvt_pkrtz_f16_f32 v128, v128, v129
    v_mfma_f32_16x16x32_bf16 v[228:231], v[196:199], v[188:191], 0
    ds_read_b128 v[188:191], v11 offset:2560
    ds_read_b128 v[196:199], v22 offset:768
    v_cvt_pkrtz_f16_f32 v152, v152, v153
    v_smfmac_f32_16x16x64_bf16 v[224:227], v[204:207], v[180:187], v16
    ds_read_b128 v[180:183], v15 offset:0
    s_waitcnt lgkmcnt(14)
    ds_read_b128 v[184:187], v13 offset:1280
    v_smfmac_f32_16x16x64_bf16 v[228:231], v[204:207], v[232:239], v16
    s_waitcnt lgkmcnt(10)
    ds_read_b128 v[232:235], v15 offset:2560
    ds_read_b128 v[236:239], v13 offset:3840
    ds_read_b128 v[204:207], v22 offset:784
    v_mfma_f32_32x32x16_bf16 v[80:95], a[172:175], v[244:247], v[80:95]
    s_add_u32 m0, s56, -128
    v_cvt_pkrtz_f16_f32 v129, v130, v131
    v_cvt_pkrtz_f16_f32 v153, v154, v155
    v_cvt_pkrtz_f16_f32 v130, v224, v225
    v_cvt_pkrtz_f16_f32 v154, v228, v229
    v_cvt_pkrtz_f16_f32 v131, v226, v227
    v_cvt_pkrtz_f16_f32 v155, v230, v231
    v_mfma_f32_16x16x32_bf16 v[132:135], v[192:195], a[232:235], 0
    ds_read_b128 a[232:235], v8 offset:6400
    v_mfma_f32_16x16x32_bf16 v[156:159], v[192:195], a[244:247], 0
    s_waitcnt lgkmcnt(2)
    ds_read_b128 a[244:247], v8 offset:8960
    ds_read_b128 v[192:195], v22 offset:1024
    v_mfma_f32_32x32x16_bf16 v[96:111], a[180:183], v[244:247], v[96:111]
    v_cvt_pk_bf16_f32 v80, v80, v81
    v_cvt_pk_bf16_f32 v81, v82, v83
    v_cvt_pk_bf16_f32 v82, v84, v85
    v_cvt_pk_bf16_f32 v83, v86, v87
    v_cvt_pk_bf16_f32 v84, v88, v89
    v_cvt_pk_bf16_f32 v85, v90, v91
    v_smfmac_f32_16x16x64_bf16 v[132:135], v[200:203], a[236:243], v16
    ds_read_b128 a[236:239], v12 offset:6400
    ds_read_b128 a[240:243], v14 offset:7680
    v_smfmac_f32_16x16x64_bf16 v[156:159], v[200:203], a[248:255], v16
    ds_read_b128 a[248:251], v12 offset:8960
    ds_read_b128 a[252:255], v14 offset:10240
    ds_read_b128 v[200:203], v22 offset:1040
    v_mfma_f32_32x32x16_bf16 v[112:127], a[188:191], v[244:247], v[112:127]
    v_cvt_pk_bf16_f32 v86, v92, v93
    v_cvt_pk_bf16_f32 v87, v94, v95
    v_permlane16_swap_b32 v80, v84
    v_permlane16_swap_b32 v81, v85
    v_mfma_f32_16x16x32_bf16 v[224:227], v[196:199], v[176:179], 0
    ds_read_b128 v[176:179], v9 offset:6400
    ds_read_b128 v[32:35], v25 offset:0
    v_mfma_f32_16x16x32_bf16 v[228:231], v[196:199], v[188:191], 0
    s_waitcnt lgkmcnt(0)
    buffer_load_dwordx4 v1, s[20:23], 0 offen offset:128 lds
    ds_read_b128 v[188:191], v9 offset:8960
    ds_read_b128 v[196:199], v22 offset:1280
    ds_read_b128 v[36:39], v25 offset:32
    v_smfmac_f32_16x16x64_bf16 v[224:227], v[204:207], v[180:187], v16
    s_add_u32 m0, s56, 896
    ds_read_b128 v[180:183], v13 offset:6400
    buffer_load_dwordx4 v2, s[20:23], 0 offen offset:128 lds
    ds_read_b128 v[184:187], v15 offset:7680
    ds_read_b128 v[40:43], v25 offset:64
    v_smfmac_f32_16x16x64_bf16 v[228:231], v[204:207], v[232:239], v16
    s_add_u32 m0, s56, 1920
    ds_read_b128 v[232:235], v13 offset:8960
    buffer_load_dwordx4 v3, s[20:23], 0 offen offset:128 lds
    ds_read_b128 v[236:239], v15 offset:10240
    ds_read_b128 v[204:207], v22 offset:1296
    ds_read_b128 v[44:47], v25 offset:96
    v_permlane16_swap_b32 v82, v86
    v_permlane16_swap_b32 v83, v87
    v_cvt_pkrtz_f16_f32 v132, v132, v133
    v_cvt_pkrtz_f16_f32 v156, v156, v157
    v_cvt_pkrtz_f16_f32 v133, v134, v135
    v_cvt_pkrtz_f16_f32 v157, v158, v159
    v_dot2_f32_f16 v28, v128, v128, 0
    v_dot2_f32_f16 v30, v152, v152, 0
    v_dot2_f32_f16 v27, v128, s58, 0
    v_dot2_f32_f16 v29, v152, s58, 0
    v_dot2_f32_f16 v28, v129, v129, v28
    v_dot2_f32_f16 v30, v153, v153, v30
    v_dot2_f32_f16 v27, v129, s58, v27
    v_dot2_f32_f16 v29, v153, s58, v29
    v_dot2_f32_f16 v28, v130, v130, v28
    v_dot2_f32_f16 v30, v154, v154, v30
    v_dot2_f32_f16 v27, v130, s58, v27
    v_dot2_f32_f16 v29, v154, s58, v29
    v_dot2_f32_f16 v28, v131, v131, v28
    v_dot2_f32_f16 v30, v155, v155, v30
    v_dot2_f32_f16 v27, v131, s58, v27
    v_dot2_f32_f16 v29, v155, s58, v29
    v_dot2_f32_f16 v28, v132, v132, v28
    v_dot2_f32_f16 v30, v156, v156, v30
    v_dot2_f32_f16 v27, v132, s58, v27
    v_dot2_f32_f16 v29, v156, s58, v29
    v_dot2_f32_f16 v28, v133, v133, v28
    v_dot2_f32_f16 v30, v157, v157, v30
    v_dot2_f32_f16 v27, v133, s58, v27
    v_dot2_f32_f16 v29, v157, s58, v29
    v_cvt_pkrtz_f16_f32 v134, v224, v225
    v_cvt_pkrtz_f16_f32 v158, v228, v229
    v_cvt_pkrtz_f16_f32 v135, v226, v227
    v_mfma_f32_16x16x32_bf16 v[136:139], v[192:195], a[232:235], 0
    s_add_u32 m0, s56, 2944
    buffer_store_dwordx4 v[80:83], v26, s[24:27], s82 offen offset:0 sc0 sc1
    buffer_load_dwordx4 v4, s[20:23], 0 offen offset:128 lds
    ds_read_b128 a[232:235], v10 offset:6400
    buffer_store_dwordx4 v[84:87], v26, s[24:27], s83 offen offset:0 sc0 sc1
    ds_read_b128 v[212:215], v20 offset:8960
    v_mfma_f32_16x16x32_bf16 v[160:163], v[192:195], a[244:247], 0
    s_add_u32 m0, s56, 3968
    ds_read_b128 a[244:247], v10 offset:8960
    buffer_load_dwordx4 v5, s[20:23], 0 offen offset:128 lds
    ds_read_b128 v[192:195], v22 offset:1536
    v_cvt_pkrtz_f16_f32 v159, v230, v231
    v_cvt_pk_bf16_f32 v96, v96, v97
    v_cvt_pk_bf16_f32 v97, v98, v99
    v_cvt_pk_bf16_f32 v98, v100, v101
    v_cvt_pk_bf16_f32 v99, v102, v103
    v_cvt_pk_bf16_f32 v100, v104, v105
    v_cvt_pk_bf16_f32 v101, v106, v107
    v_cvt_pk_bf16_f32 v102, v108, v109
    v_cvt_pk_bf16_f32 v103, v110, v111
    v_permlane16_swap_b32 v96, v100
    v_permlane16_swap_b32 v97, v101
    v_permlane16_swap_b32 v98, v102
    s_waitcnt lgkmcnt(4)
    v_mfma_f32_32x32x16_bf16 v[80:95], a[224:227], v[52:55], v[32:47]
    s_add_u32 m0, s56, 4992
    v_permlane16_swap_b32 v99, v103
    v_cvt_pk_bf16_f32 v112, v112, v113
    v_cvt_pk_bf16_f32 v113, v114, v115
    v_cvt_pk_bf16_f32 v114, v116, v117
    v_cvt_pk_bf16_f32 v115, v118, v119
    v_smfmac_f32_16x16x64_bf16 v[136:139], v[200:203], a[236:243], v16
    buffer_load_dwordx4 v6, s[20:23], 0 offen offset:128 lds
    ds_read_b128 a[236:239], v14 offset:6400
    ds_read_b128 a[240:243], v12 offset:7680
    ds_read_b128 v[208:211], v20 offset:6400
    v_smfmac_f32_16x16x64_bf16 v[160:163], v[200:203], a[248:255], v16
    s_add_u32 m0, s56, 6016
    ds_read_b128 a[248:251], v14 offset:8960
    buffer_load_dword v7, s[20:23], 0 offen offset:128 lds
    ds_read_b128 a[252:255], v12 offset:10240
    ds_read_b128 v[200:203], v22 offset:1552
    v_mfma_f32_32x32x16_bf16 v[32:47], a[224:227], v[48:51], v[32:47]
    v_cvt_pkrtz_f16_f32 v136, v136, v137
    v_cvt_pkrtz_f16_f32 v137, v138, v139
    v_cvt_pkrtz_f16_f32 v160, v160, v161
    v_cvt_pkrtz_f16_f32 v161, v162, v163
    v_cvt_pk_bf16_f32 v116, v120, v121
    v_cvt_pk_bf16_f32 v117, v122, v123
    v_mfma_f32_16x16x32_bf16 v[224:227], v[196:199], v[176:179], 0
    ds_read_b128 v[176:179], v11 offset:6400
    ds_read_b128 v[220:223], v21 offset:8960
    v_mfma_f32_16x16x32_bf16 v[228:231], v[196:199], v[188:191], 0
    ds_read_b128 v[188:191], v11 offset:8960
    ds_read_b128 v[196:199], v22 offset:1792
    v_mfma_f32_32x32x16_bf16 v[80:95], a[228:231], v[60:63], v[80:95]
    v_cvt_pk_bf16_f32 v118, v124, v125
    v_cvt_pk_bf16_f32 v119, v126, v127
    v_permlane16_swap_b32 v112, v116
    v_permlane16_swap_b32 v113, v117
    v_smfmac_f32_16x16x64_bf16 v[224:227], v[204:207], v[180:187], v16
    s_waitcnt lgkmcnt(1)
    ds_read_b128 v[180:183], v15 offset:6400
    ds_read_b128 v[184:187], v13 offset:7680
    ds_read_b128 v[216:219], v21 offset:6400
    v_smfmac_f32_16x16x64_bf16 v[228:231], v[204:207], v[232:239], v16
    ds_read_b128 v[232:235], v15 offset:8960
    ds_read_b128 v[236:239], v13 offset:10240
    ds_read_b128 v[204:207], v22 offset:1808
    v_mfma_f32_32x32x16_bf16 v[32:47], a[228:231], v[56:59], v[32:47]
    v_permlane16_swap_b32 v114, v118
    v_permlane16_swap_b32 v115, v119
    v_cvt_pkrtz_f16_f32 v138, v224, v225
    v_cvt_pkrtz_f16_f32 v139, v226, v227
    v_mfma_f32_16x16x32_bf16 v[140:143], v[192:195], a[232:235], 0
    v_cvt_pkrtz_f16_f32 v162, v228, v229
    v_cvt_pkrtz_f16_f32 v163, v230, v231
    v_mfma_f32_16x16x32_bf16 v[164:167], v[192:195], a[244:247], 0
    ds_read_b128 v[192:195], v22 offset:2048
    s_nop 1
    v_smfmac_f32_16x16x64_bf16 v[140:143], v[200:203], a[236:243], v16
    s_nop 1
    v_smfmac_f32_16x16x64_bf16 v[164:167], v[200:203], a[248:255], v16
    s_waitcnt lgkmcnt(7)
    ds_read_b128 v[200:203], v22 offset:2064
    v_dot2_f32_f16 v28, v134, v134, v28
    v_dot2_f32_f16 v30, v158, v158, v30
    v_dot2_f32_f16 v27, v134, s58, v27
    v_dot2_f32_f16 v29, v158, s58, v29
    v_dot2_f32_f16 v28, v135, v135, v28
    v_dot2_f32_f16 v30, v159, v159, v30
    v_dot2_f32_f16 v27, v135, s58, v27
    v_dot2_f32_f16 v29, v159, s58, v29
    v_dot2_f32_f16 v28, v136, v136, v28
    v_dot2_f32_f16 v30, v160, v160, v30
    v_dot2_f32_f16 v27, v136, s58, v27
    v_dot2_f32_f16 v29, v160, s58, v29
    v_dot2_f32_f16 v28, v137, v137, v28
    v_dot2_f32_f16 v30, v161, v161, v30
    v_dot2_f32_f16 v27, v137, s58, v27
    v_dot2_f32_f16 v29, v161, s58, v29
    v_dot2_f32_f16 v28, v138, v138, v28
    v_dot2_f32_f16 v30, v162, v162, v30
    v_dot2_f32_f16 v27, v138, s58, v27
    v_dot2_f32_f16 v29, v162, s58, v29
    v_dot2_f32_f16 v28, v139, v139, v28
    v_dot2_f32_f16 v30, v163, v163, v30
    v_dot2_f32_f16 v27, v139, s58, v27
    v_dot2_f32_f16 v29, v163, s58, v29
    v_cvt_pkrtz_f16_f32 v140, v140, v141
    v_cvt_pkrtz_f16_f32 v164, v164, v165
    v_cvt_pkrtz_f16_f32 v141, v142, v143
    v_mfma_f32_16x16x32_bf16 v[224:227], v[196:199], v[176:179], 0
    buffer_store_dwordx4 v[96:99], v26, s[24:27], s82 offen offset:64 sc0 sc1
    v_cvt_pkrtz_f16_f32 v165, v166, v167
    v_mfma_f32_16x16x32_bf16 v[228:231], v[196:199], v[188:191], 0
    s_waitcnt lgkmcnt(2)
    ds_read_b128 v[196:199], v22 offset:2304
    s_nop 0
    v_smfmac_f32_16x16x64_bf16 v[224:227], v[204:207], v[180:187], v16
    s_nop 1
    v_smfmac_f32_16x16x64_bf16 v[228:231], v[204:207], v[232:239], v16
    s_waitcnt lgkmcnt(1)
    ds_read_b128 v[204:207], v22 offset:2320
    s_nop 2
    v_cvt_pkrtz_f16_f32 v142, v224, v225
    v_cvt_pkrtz_f16_f32 v143, v226, v227
    v_dot2_f32_f16 v28, v140, v140, v28
    v_cvt_pkrtz_f16_f32 v166, v228, v229
    v_cvt_pkrtz_f16_f32 v167, v230, v231
    v_dot2_f32_f16 v30, v164, v164, v30
    v_dot2_f32_f16 v27, v140, s58, v27
    v_dot2_f32_f16 v29, v164, s58, v29
    v_dot2_f32_f16 v28, v141, v141, v28
    v_dot2_f32_f16 v30, v165, v165, v30
    v_dot2_f32_f16 v27, v141, s58, v27
    v_dot2_f32_f16 v29, v165, s58, v29
    v_dot2_f32_f16 v28, v142, v142, v28
    v_dot2_f32_f16 v30, v166, v166, v30
    v_dot2_f32_f16 v27, v142, s58, v27
    v_dot2_f32_f16 v29, v166, s58, v29
    v_dot2_f32_f16 v28, v143, v143, v28
    v_dot2_f32_f16 v30, v167, v167, v30
    v_dot2_f32_f16 v27, v143, s58, v27
    v_dot2_f32_f16 v29, v167, s58, v29
    s_waitcnt vmcnt(1)
    ds_read_b128 a[232:235], v8 offset:0
    ds_read_b128 a[244:247], v8 offset:2560
    ds_read_b128 a[236:239], v12 offset:0
    ds_read_b128 a[240:243], v14 offset:1280
    ds_read_b128 a[248:251], v12 offset:2560
    ds_read_b128 a[252:255], v14 offset:3840
    ds_read_b128 v[176:179], v9 offset:0
    ds_read_b128 v[188:191], v9 offset:2560
    ds_read_b128 v[180:183], v13 offset:0
    ds_read_b128 v[184:187], v15 offset:1280
    ds_read_b128 v[232:235], v13 offset:2560
    ds_read_b128 v[236:239], v15 offset:3840
    s_waitcnt lgkmcnt(11)
    v_mfma_f32_16x16x32_bf16 v[144:147], v[192:195], a[232:235], 0
    s_waitcnt lgkmcnt(10)
    ds_read_b128 a[232:235], v10 offset:0
    buffer_store_dwordx4 v[100:103], v26, s[24:27], s83 offen offset:64 sc0 sc1
    v_mfma_f32_16x16x32_bf16 v[168:171], v[192:195], a[244:247], 0
    s_waitcnt lgkmcnt(10)
    ds_read_b128 a[244:247], v10 offset:2560
    ds_read_b128 v[192:195], v22 offset:2560
    s_waitcnt lgkmcnt(11)
    v_smfmac_f32_16x16x64_bf16 v[144:147], v[200:203], a[236:243], v16
    s_waitcnt lgkmcnt(10)
    ds_read_b128 a[236:239], v14 offset:0
    ds_read_b128 a[240:243], v12 offset:1280
    s_waitcnt lgkmcnt(11)
    v_smfmac_f32_16x16x64_bf16 v[168:171], v[200:203], a[248:255], v16
    ds_read_b128 a[248:251], v14 offset:2560
    ds_read_b128 a[252:255], v12 offset:3840
    ds_read_b128 v[200:203], v22 offset:2576
    s_waitcnt lgkmcnt(13)
    v_mfma_f32_16x16x32_bf16 v[224:227], v[196:199], v[176:179], 0
    s_waitcnt lgkmcnt(12)
    ds_read_b128 v[176:179], v11 offset:0
    buffer_store_dwordx4 v[112:115], v26, s[24:27], s82 offen offset:128 sc0 sc1
    ds_read_b128 v[48:51], v25 offset:128
    v_mfma_f32_16x16x32_bf16 v[228:231], v[196:199], v[188:191], 0
    s_waitcnt lgkmcnt(1)
    ds_read_b128 v[188:191], v11 offset:2560
    ds_read_b128 v[196:199], v22 offset:2816
    ds_read_b128 v[52:55], v25 offset:160
    v_cvt_pkrtz_f16_f32 v144, v144, v145
    v_smfmac_f32_16x16x64_bf16 v[224:227], v[204:207], v[180:187], v16
    ds_read_b128 v[180:183], v15 offset:0
    ds_read_b128 v[184:187], v13 offset:1280
    ds_read_b128 v[56:59], v25 offset:192
    v_cvt_pkrtz_f16_f32 v168, v168, v169
    v_cvt_pkrtz_f16_f32 v145, v146, v147
    v_cvt_pkrtz_f16_f32 v169, v170, v171
    v_smfmac_f32_16x16x64_bf16 v[228:231], v[204:207], v[232:239], v16
    ds_read_b128 v[232:235], v15 offset:2560
    ds_read_b128 v[236:239], v13 offset:3840
    ds_read_b128 v[204:207], v22 offset:2832
    ds_read_b128 v[60:63], v25 offset:224
    v_cvt_pkrtz_f16_f32 v146, v224, v225
    v_dot2_f32_f16 v28, v144, v144, v28
    v_dot2_f32_f16 v30, v168, v168, v30
    v_dot2_f32_f16 v27, v144, s58, v27
    v_dot2_f32_f16 v29, v168, s58, v29
    v_dot2_f32_f16 v28, v145, v145, v28
    v_dot2_f32_f16 v30, v169, v169, v30
    v_dot2_f32_f16 v27, v145, s58, v27
    v_dot2_f32_f16 v29, v169, s58, v29
    v_cvt_pkrtz_f16_f32 v170, v228, v229
    v_cvt_pkrtz_f16_f32 v147, v226, v227
    v_cvt_pkrtz_f16_f32 v171, v230, v231
    v_mfma_f32_16x16x32_bf16 v[148:151], v[192:195], a[232:235], 0
    buffer_store_dwordx4 v[116:119], v26, s[24:27], s83 offen offset:128 sc0 sc1
    ds_read_b128 v[64:67], v25 offset:256
    v_mfma_f32_16x16x32_bf16 v[172:175], v[192:195], a[244:247], 0
    ds_read_b128 v[68:71], v25 offset:288
    s_nop 1
    v_smfmac_f32_16x16x64_bf16 v[148:151], v[200:203], a[236:243], v16
    ds_read_b128 v[72:75], v25 offset:320
    s_nop 0
    v_smfmac_f32_16x16x64_bf16 v[172:175], v[200:203], a[248:255], v16
    s_waitcnt lgkmcnt(13)
    ds_read_b128 v[76:79], v25 offset:352
    s_nop 2
    v_cvt_pkrtz_f16_f32 v148, v148, v149
    v_cvt_pkrtz_f16_f32 v149, v150, v151
    s_nop 0
    v_cvt_pkrtz_f16_f32 v172, v172, v173
    v_cvt_pkrtz_f16_f32 v173, v174, v175
    s_waitcnt lgkmcnt(12)
    v_mfma_f32_16x16x32_bf16 v[224:227], v[196:199], v[176:179], 0
    s_waitcnt lgkmcnt(6)
    ds_read_b128 a[232:235], v23 offset:1024
    ds_read_b128 a[236:239], v23 offset:2048
    v_mfma_f32_16x16x32_bf16 v[228:231], v[196:199], v[188:191], 0
    s_add_u32 s80, s80, 786432
    ds_read_b128 a[240:243], v23 offset:4096
    ds_read_b128 a[244:247], v23 offset:5120
    s_add_u32 s81, s81, 786432
    s_add_u32 s82, s82, 786432
    s_add_u32 s83, s83, 786432
    s_waitcnt lgkmcnt(9)
    v_smfmac_f32_16x16x64_bf16 v[224:227], v[204:207], v[180:187], v16
    ds_read_b128 a[248:251], v23 offset:11264
    v_smfmac_f32_16x16x64_bf16 v[228:231], v[204:207], v[232:239], v16
    ds_read_b128 a[252:255], v23 offset:12288
L_mid:
    s_cmp_eq_u32 s52, 3
    s_cselect_b32 s57, 0x40000000, 786432
    v_add_u32 v1, s57, v1
    v_add_u32 v2, s57, v2
    v_add_u32 v3, s57, v3
    v_cvt_pkrtz_f16_f32 v150, v224, v225
    v_cvt_pkrtz_f16_f32 v151, v226, v227
    v_cvt_pkrtz_f16_f32 v174, v228, v229
    v_cvt_pkrtz_f16_f32 v175, v230, v231
    v_add_u32 v4, s57, v4
    v_add_u32 v5, s57, v5
    v_add_u32 v6, s57, v6
    v_add_u32 v7, s57, v7
    v_add_u32 v31, s57, v31
    v_dot2_f32_f16 v28, v146, v146, v28
    v_dot2_f32_f16 v30, v170, v170, v30
    v_dot2_f32_f16 v27, v146, s58, v27
    v_dot2_f32_f16 v29, v170, s58, v29
    v_dot2_f32_f16 v28, v147, v147, v28
    v_dot2_f32_f16 v30, v171, v171, v30
    v_dot2_f32_f16 v27, v147, s58, v27
    v_dot2_f32_f16 v29, v171, s58, v29
    v_dot2_f32_f16 v28, v148, v148, v28
    v_dot2_f32_f16 v30, v172, v172, v30
    v_dot2_f32_f16 v27, v148, s58, v27
    v_dot2_f32_f16 v29, v172, s58, v29
    v_dot2_f32_f16 v28, v149, v149, v28
    v_dot2_f32_f16 v30, v173, v173, v30
    v_dot2_f32_f16 v27, v149, s58, v27
    v_dot2_f32_f16 v29, v173, s58, v29
    v_dot2_f32_f16 v28, v150, v150, v28
    v_dot2_f32_f16 v30, v174, v174, v30
    v_dot2_f32_f16 v27, v150, s58, v27
    v_dot2_f32_f16 v29, v174, s58, v29
    v_dot2_f32_f16 v28, v151, v151, v28
    v_dot2_f32_f16 v30, v175, v175, v30
    v_dot2_f32_f16 v27, v151, s58, v27
    v_dot2_f32_f16 v29, v175, s58, v29
    s_nop 1
    v_permlane32_swap_b32 v27, v28
    s_waitcnt lgkmcnt(10)
    v_mfma_f32_32x32x16_bf16 v[96:111], a[224:227], v[212:215], v[48:63]
    ds_read_b128 v[236:239], v20 offset:2560
    ds_read_b128 v[232:235], v20 offset:0
    v_permlane32_swap_b32 v29, v30
    v_add_f32 v27, v27, v28
    v_add_f32 v29, v29, v30
    v_mfma_f32_32x32x16_bf16 v[48:63], a[224:227], v[208:211], v[48:63]
    ds_read_b128 v[244:247], v21 offset:2560
    ds_read_b128 v[240:243], v21 offset:0
    v_mov_b32 v28, v27
    v_mov_b32 v30, v29
    s_nop 0
    v_permlane32_swap_b32 v27, v28
    v_mfma_f32_32x32x16_bf16 v[96:111], a[228:231], v[220:223], v[96:111]
    v_permlane32_swap_b32 v29, v30
    v_mul_f32 v27, 0x3c2aaaab, v27
    v_mul_f32 v29, 0x3c2aaaab, v29
    v_mul_f32 v28, 0x3c2aaaab, v28
    v_mul_f32 v30, 0x3c2aaaab, v30
    v_mfma_f32_32x32x16_bf16 v[48:63], a[228:231], v[216:219], v[48:63]
    v_fma_f32 v28, -v27, v27, v28
    v_fma_f32 v30, -v29, v29, v30
    v_max_f32 v28, 0, v28
    v_max_f32 v30, 0, v30
    v_add_f32 v28, 0x3727c5ac, v28
    v_add_f32 v30, 0x3727c5ac, v30
    v_rsq_f32 v28, v28
    v_rsq_f32 v30, v30
    v_fma_mixlo_f16 v28, v28, s59, 0
    v_fma_mixlo_f16 v30, v30, s59, 0
    v_fma_mixhi_f16 v28, -v27, v28, 0 op_sel_hi:[0,1,0]
    v_fma_mixhi_f16 v30, -v29, v30, 0 op_sel_hi:[0,1,0]
    v_pk_fma_f16 v128, v128, v28, v28 op_sel:[0,0,1] op_sel_hi:[1,0,1]
    v_pk_fma_f16 v129, v129, v28, v28 op_sel:[0,0,1] op_sel_hi:[1,0,1]
    v_pk_fma_f16 v130, v130, v28, v28 op_sel:[0,0,1] op_sel_hi:[1,0,1]
    v_pk_fma_f16 v131, v131, v28, v28 op_sel:[0,0,1] op_sel_hi:[1,0,1]
    v_pk_fma_f16 v132, v132, v28, v28 op_sel:[0,0,1] op_sel_hi:[1,0,1]
    v_pk_fma_f16 v133, v133, v28, v28 op_sel:[0,0,1] op_sel_hi:[1,0,1]
    v_mfma_f32_32x32x16_f16 v[176:191], a[192:195], v[128:131], 0
    s_waitcnt lgkmcnt(9)
    v_pk_fma_f16 v134, v134, v28, v28 op_sel:[0,0,1] op_sel_hi:[1,0,1]
    v_pk_fma_f16 v135, v135, v28, v28 op_sel:[0,0,1] op_sel_hi:[1,0,1]
    v_pk_fma_f16 v136, v136, v28, v28 op_sel:[0,0,1] op_sel_hi:[1,0,1]
    v_pk_fma_f16 v137, v137, v28, v28 op_sel:[0,0,1] op_sel_hi:[1,0,1]
    v_pk_fma_f16 v138, v138, v28, v28 op_sel:[0,0,1] op_sel_hi:[1,0,1]
    v_pk_fma_f16 v139, v139, v28, v28 op_sel:[0,0,1] op_sel_hi:[1,0,1]
    v_mfma_f32_32x32x16_f16 v[176:191], a[232:235], v[132:135], v[176:191]
    s_waitcnt lgkmcnt(8)
    v_pk_fma_f16 v140, v140, v28, v28 op_sel:[0,0,1] op_sel_hi:[1,0,1]
    v_pk_fma_f16 v141, v141, v28, v28 op_sel:[0,0,1] op_sel_hi:[1,0,1]
    v_pk_fma_f16 v142, v142, v28, v28 op_sel:[0,0,1] op_sel_hi:[1,0,1]
    v_pk_fma_f16 v143, v143, v28, v28 op_sel:[0,0,1] op_sel_hi:[1,0,1]
    v_pk_fma_f16 v144, v144, v28, v28 op_sel:[0,0,1] op_sel_hi:[1,0,1]
    v_pk_fma_f16 v145, v145, v28, v28 op_sel:[0,0,1] op_sel_hi:[1,0,1]
    v_mfma_f32_32x32x16_f16 v[176:191], a[236:239], v[136:139], v[176:191]
    v_pk_fma_f16 v146, v146, v28, v28 op_sel:[0,0,1] op_sel_hi:[1,0,1]
    v_pk_fma_f16 v147, v147, v28, v28 op_sel:[0,0,1] op_sel_hi:[1,0,1]
    v_pk_fma_f16 v151, v151, v28, v28 op_sel:[0,0,1] op_sel_hi:[1,0,1]
    v_pk_fma_f16 v148, v148, v28, v28 op_sel:[0,0,1] op_sel_hi:[1,0,1]
    v_pk_fma_f16 v149, v149, v28, v28 op_sel:[0,0,1] op_sel_hi:[1,0,1]
    v_bfi_b32 v151, v17, v151, s84
    v_mfma_f32_32x32x16_f16 v[176:191], a[196:199], v[140:143], v[176:191]
    s_waitcnt lgkmcnt(7)
    v_pk_fma_f16 v150, v150, v28, v28 op_sel:[0,0,1] op_sel_hi:[1,0,1]
    v_pk_fma_f16 v152, v152, v30, v30 op_sel:[0,0,1] op_sel_hi:[1,0,1]
    v_pk_fma_f16 v153, v153, v30, v30 op_sel:[0,0,1] op_sel_hi:[1,0,1]
    v_pk_fma_f16 v154, v154, v30, v30 op_sel:[0,0,1] op_sel_hi:[1,0,1]
    v_pk_fma_f16 v155, v155, v30, v30 op_sel:[0,0,1] op_sel_hi:[1,0,1]
    v_pk_fma_f16 v156, v156, v30, v30 op_sel:[0,0,1] op_sel_hi:[1,0,1]
    v_mfma_f32_32x32x16_f16 v[176:191], a[240:243], v[144:147], v[176:191]
    s_waitcnt lgkmcnt(6)
    v_pk_fma_f16 v157, v157, v30, v30 op_sel:[0,0,1] op_sel_hi:[1,0,1]
    v_pk_fma_f16 v158, v158, v30, v30 op_sel:[0,0,1] op_sel_hi:[1,0,1]
    v_pk_fma_f16 v159, v159, v30, v30 op_sel:[0,0,1] op_sel_hi:[1,0,1]
    v_pk_fma_f16 v160, v160, v30, v30 op_sel:[0,0,1] op_sel_hi:[1,0,1]
    v_pk_fma_f16 v161, v161, v30, v30 op_sel:[0,0,1] op_sel_hi:[1,0,1]
    v_pk_fma_f16 v162, v162, v30, v30 op_sel:[0,0,1] op_sel_hi:[1,0,1]
    v_mfma_f32_32x32x16_f16 v[176:191], a[244:247], v[148:151], v[176:191]
    v_pk_fma_f16 v163, v163, v30, v30 op_sel:[0,0,1] op_sel_hi:[1,0,1]
    v_pk_fma_f16 v164, v164, v30, v30 op_sel:[0,0,1] op_sel_hi:[1,0,1]
    v_pk_fma_f16 v165, v165, v30, v30 op_sel:[0,0,1] op_sel_hi:[1,0,1]
    v_pk_fma_f16 v166, v166, v30, v30 op_sel:[0,0,1] op_sel_hi:[1,0,1]
    v_pk_fma_f16 v167, v167, v30, v30 op_sel:[0,0,1] op_sel_hi:[1,0,1]
    v_pk_fma_f16 v168, v168, v30, v30 op_sel:[0,0,1] op_sel_hi:[1,0,1]
    v_mfma_f32_32x32x16_f16 v[192:207], a[192:195], v[152:155], 0
    v_pk_fma_f16 v169, v169, v30, v30 op_sel:[0,0,1] op_sel_hi:[1,0,1]
    v_pk_fma_f16 v170, v170, v30, v30 op_sel:[0,0,1] op_sel_hi:[1,0,1]
    v_pk_fma_f16 v171, v171, v30, v30 op_sel:[0,0,1] op_sel_hi:[1,0,1]
    v_pk_fma_f16 v175, v175, v30, v30 op_sel:[0,0,1] op_sel_hi:[1,0,1]
    v_pk_fma_f16 v172, v172, v30, v30 op_sel:[0,0,1] op_sel_hi:[1,0,1]
    v_pk_fma_f16 v173, v173, v30, v30 op_sel:[0,0,1] op_sel_hi:[1,0,1]
    v_mfma_f32_32x32x16_f16 v[192:207], a[232:235], v[156:159], v[192:207]
    ds_read_b128 a[232:235], v23 offset:14336
    v_bfi_b32 v175, v17, v175, s84
    v_pk_fma_f16 v174, v174, v30, v30 op_sel:[0,0,1] op_sel_hi:[1,0,1]
    v_cvt_pkrtz_f16_f32 v208, v176, v177
    v_cvt_pkrtz_f16_f32 v209, v178, v179
    v_cvt_pkrtz_f16_f32 v210, v180, v181
    v_mfma_f32_32x32x16_f16 v[192:207], a[236:239], v[160:163], v[192:207]
    ds_read_b128 a[236:239], v23 offset:15360
    v_cvt_pkrtz_f16_f32 v211, v182, v183
    v_cvt_pkrtz_f16_f32 v212, v184, v185
    v_cvt_pkrtz_f16_f32 v213, v186, v187
    v_cvt_pkrtz_f16_f32 v214, v188, v189
    v_cvt_pkrtz_f16_f32 v215, v190, v191
    v_mfma_f32_32x32x16_f16 v[192:207], a[196:199], v[164:167], v[192:207]
    v_pk_lshrrev_b16 v216, 3, v208 op_sel_hi:[0,1]
    v_pk_lshrrev_b16 v217, 3, v209 op_sel_hi:[0,1]
    v_pk_lshrrev_b16 v218, 3, v210 op_sel_hi:[0,1]
    v_pk_lshrrev_b16 v219, 3, v211 op_sel_hi:[0,1]
    v_pk_lshrrev_b16 v220, 3, v212 op_sel_hi:[0,1]
    v_pk_lshrrev_b16 v221, 3, v213 op_sel_hi:[0,1]
    v_mfma_f32_32x32x16_f16 v[192:207], a[240:243], v[168:171], v[192:207]
    ds_read_b128 a[240:243], v23 offset:6144
    v_mad_u32_u16 v224, v216, 2, s85
    v_mad_u32_u16 v216, v216, 2, s85 op_sel:[1,0,0,0]
    v_mad_u32_u16 v225, v217, 2, s85
    v_mad_u32_u16 v217, v217, 2, s85 op_sel:[1,0,0,0]
    v_mad_u32_u16 v226, v218, 2, s85
    v_mfma_f32_32x32x16_f16 v[192:207], a[244:247], v[172:175], v[192:207]
    s_waitcnt lgkmcnt(5)
    ds_read_u16 v224, v224
    ds_read_u16_d16_hi v216, v216
    ds_read_u16 v225, v225
    v_mad_u32_u16 v218, v218, 2, s85 op_sel:[1,0,0,0]
    v_mad_u32_u16 v227, v219, 2, s85
    v_mad_u32_u16 v219, v219, 2, s85 op_sel:[1,0,0,0]
    v_mfma_f32_32x32x16_bf16 v[112:127], a[224:227], v[236:239], v[64:79]
    s_add_u32 m0, s56, 6336
    ds_read_u16_d16_hi v217, v217
    ds_read_u16 v226, v226
    ds_read_b128 a[244:247], v23 offset:8192
    v_mad_u32_u16 v228, v220, 2, s85
    v_mad_u32_u16 v220, v220, 2, s85 op_sel:[1,0,0,0]
    v_mad_u32_u16 v229, v221, 2, s85
    v_mfma_f32_32x32x16_bf16 v[64:79], a[224:227], v[232:235], v[64:79]
    s_waitcnt lgkmcnt(10)
    ds_read_u16_d16_hi v218, v218
    ds_read_u16 v227, v227
    ds_read_u16_d16_hi v219, v219
    v_mad_u32_u16 v221, v221, 2, s85 op_sel:[1,0,0,0]
    v_pk_fma_f16 v222, v214, v214, s53
    v_pk_fma_f16 v223, v215, v215, s53
    v_mfma_f32_32x32x16_bf16 v[112:127], a[228:231], v[244:247], v[112:127]
    s_waitcnt lgkmcnt(12)
    buffer_load_dwordx4 v1, s[20:23], 0 offen offset:64 lds
    ds_read_u16 v228, v228
    ds_read_u16_d16_hi v220, v220
    v_pk_mul_f16 v222, v222, v214 neg_lo:[1,0] neg_hi:[1,0]
    v_pk_mul_f16 v223, v223, v215 neg_lo:[1,0] neg_hi:[1,0]
    v_mfma_f32_32x32x16_bf16 v[64:79], a[228:231], v[240:243], v[64:79]
    s_waitcnt lgkmcnt(12)
    ds_read_u16 v229, v229
    ds_read_u16_d16_hi v221, v221
    v_exp_f16 v230, v222
    v_exp_f16 v231, v223
    v_mfma_f32_32x32x16_f16 v[176:191], a[200:203], v[128:131], 0
    s_waitcnt lgkmcnt(9)
    v_exp_f16_sdwa v230, v222 dst_sel:WORD_1 dst_unused:UNUSED_PRESERVE src0_sel:WORD_1
    v_exp_f16_sdwa v231, v223 dst_sel:WORD_1 dst_unused:UNUSED_PRESERVE src0_sel:WORD_1
    v_pk_add_f16 v230, v230, 1.0 op_sel_hi:[1,0]
    v_pk_add_f16 v231, v231, 1.0 op_sel_hi:[1,0]
    v_rcp_f16 v222, v230
    v_rcp_f16 v223, v231
    v_rcp_f16_sdwa v222, v230 dst_sel:WORD_1 dst_unused:UNUSED_PRESERVE src0_sel:WORD_1
    v_rcp_f16_sdwa v223, v231 dst_sel:WORD_1 dst_unused:UNUSED_PRESERVE src0_sel:WORD_1
    v_fma_mix_f32 v230, v222, v214, 0 op_sel_hi:[1,1,0]
    v_fma_mix_f32 v231, v223, v215, 0 op_sel_hi:[1,1,0]
    v_fma_mix_f32 v222, v222, v214, 0 op_sel:[1,1,0] op_sel_hi:[1,1,0]
    v_fma_mix_f32 v223, v223, v215, 0 op_sel:[1,1,0] op_sel_hi:[1,1,0]
    v_or_b32 v232, v224, v216
    v_or_b32 v233, v225, v217
    s_waitcnt lgkmcnt(6)
    v_or_b32 v234, v226, v218
    v_cvt_pk_bf16_f32 v238, v230, v222
    v_cvt_pk_bf16_f32 v239, v231, v223
    v_cvt_pkrtz_f16_f32 v208, v192, v193
    v_cvt_pkrtz_f16_f32 v209, v194, v195
    v_cvt_pkrtz_f16_f32 v210, v196, v197
    v_cvt_pkrtz_f16_f32 v211, v198, v199
    v_cvt_pkrtz_f16_f32 v212, v200, v201
    v_cvt_pkrtz_f16_f32 v213, v202, v203
    v_cvt_pkrtz_f16_f32 v214, v204, v205
    v_cvt_pkrtz_f16_f32 v215, v206, v207
    v_mfma_f32_32x32x16_f16 v[192:207], a[200:203], v[152:155], 0
    s_waitcnt lgkmcnt(4)
    v_or_b32 v235, v227, v219
    v_pk_lshrrev_b16 v216, 3, v208 op_sel_hi:[0,1]
    v_pk_lshrrev_b16 v217, 3, v209 op_sel_hi:[0,1]
    v_pk_lshrrev_b16 v218, 3, v210 op_sel_hi:[0,1]
    v_pk_lshrrev_b16 v219, 3, v211 op_sel_hi:[0,1]
    v_mad_u32_u16 v224, v216, 2, s85
    v_mfma_f32_32x32x16_f16 v[176:191], a[248:251], v[132:135], v[176:191]
    ds_read_u16 v224, v224
    v_mad_u32_u16 v216, v216, 2, s85 op_sel:[1,0,0,0]
    v_mad_u32_u16 v225, v217, 2, s85
    v_mad_u32_u16 v217, v217, 2, s85 op_sel:[1,0,0,0]
    v_mad_u32_u16 v226, v218, 2, s85
    v_mad_u32_u16 v218, v218, 2, s85 op_sel:[1,0,0,0]
    v_mfma_f32_32x32x16_f16 v[192:207], a[248:251], v[156:159], v[192:207]
    s_waitcnt lgkmcnt(3)
    ds_read_u16_d16_hi v216, v216
    ds_read_b128 a[248:251], v23 offset:0
    ds_read_u16 v225, v225
    v_or_b32 v236, v228, v220
    v_pk_lshrrev_b16 v220, 3, v212 op_sel_hi:[0,1]
    v_mad_u32_u16 v227, v219, 2, s85
    v_mfma_f32_32x32x16_f16 v[176:191], a[252:255], v[136:139], v[176:191]
    s_waitcnt lgkmcnt(5)
    ds_read_u16_d16_hi v217, v217
    v_mad_u32_u16 v219, v219, 2, s85 op_sel:[1,0,0,0]
    v_mad_u32_u16 v228, v220, 2, s85
    v_mad_u32_u16 v220, v220, 2, s85 op_sel:[1,0,0,0]
    s_waitcnt lgkmcnt(5)
    v_or_b32 v237, v229, v221
    v_pk_lshrrev_b16 v221, 3, v213 op_sel_hi:[0,1]
    v_mfma_f32_32x32x16_f16 v[192:207], a[252:255], v[160:163], v[192:207]
    ds_read_b128 a[252:255], v23 offset:7168
    ds_read_u16 v226, v226
    v_mad_u32_u16 v229, v221, 2, s85
    v_mad_u32_u16 v221, v221, 2, s85 op_sel:[1,0,0,0]
    v_pk_fma_f16 v222, v214, v214, s53
    v_pk_fma_f16 v223, v215, v215, s53
    v_mfma_f32_32x32x16_f16 v[176:191], a[204:207], v[140:143], v[176:191]
    s_add_u32 m0, s56, 7360
    ds_read_u16_d16_hi v218, v218
    buffer_load_dwordx4 v2, s[20:23], 0 offen offset:64 lds
    v_pk_mul_f16 v222, v222, v214 neg_lo:[1,0] neg_hi:[1,0]
    v_pk_mul_f16 v223, v223, v215 neg_lo:[1,0] neg_hi:[1,0]
    v_exp_f16 v230, v222
    v_mfma_f32_32x32x16_f16 v[192:207], a[204:207], v[164:167], v[192:207]
    ds_read_u16 v227, v227
    v_exp_f16 v231, v223
    v_exp_f16_sdwa v230, v222 dst_sel:WORD_1 dst_unused:UNUSED_PRESERVE src0_sel:WORD_1
    v_exp_f16_sdwa v231, v223 dst_sel:WORD_1 dst_unused:UNUSED_PRESERVE src0_sel:WORD_1
    v_mfma_f32_32x32x16_f16 v[176:191], a[232:235], v[144:147], v[176:191]
    ds_read_u16_d16_hi v219, v219
    v_pk_add_f16 v230, v230, 1.0 op_sel_hi:[1,0]
    v_pk_add_f16 v231, v231, 1.0 op_sel_hi:[1,0]
    v_rcp_f16 v222, v230
    v_rcp_f16 v223, v231
    v_mfma_f32_32x32x16_f16 v[192:207], a[232:235], v[168:171], v[192:207]
    ds_read_b128 a[232:235], v23 offset:9216
    ds_read_u16 v228, v228
    v_rcp_f16_sdwa v222, v230 dst_sel:WORD_1 dst_unused:UNUSED_PRESERVE src0_sel:WORD_1
    v_rcp_f16_sdwa v223, v231 dst_sel:WORD_1 dst_unused:UNUSED_PRESERVE src0_sel:WORD_1
    v_mfma_f32_32x32x16_f16 v[176:191], a[236:239], v[148:151], v[176:191]
    s_waitcnt lgkmcnt(10)
    ds_read_u16_d16_hi v220, v220
    v_fma_mix_f32 v230, v222, v214, 0 op_sel_hi:[1,1,0]
    v_fma_mix_f32 v231, v223, v215, 0 op_sel_hi:[1,1,0]
    v_fma_mix_f32 v222, v222, v214, 0 op_sel:[1,1,0] op_sel_hi:[1,1,0]
    v_fma_mix_f32 v223, v223, v215, 0 op_sel:[1,1,0] op_sel_hi:[1,1,0]
    v_or_b32 v240, v224, v216
    v_mfma_f32_32x32x16_f16 v[192:207], a[236:239], v[172:175], v[192:207]
    s_waitcnt lgkmcnt(5)
    ds_read_b128 a[236:239], v23 offset:3072
    ds_read_u16 v229, v229
    ds_read_u16_d16_hi v221, v221
    v_or_b32 v241, v225, v217
    v_or_b32 v242, v226, v218
    v_cvt_pk_bf16_f32 v246, v230, v222
    v_mfma_f32_32x32x16_bf16 v[32:47], a[240:243], v[232:235], v[32:47]
    s_waitcnt lgkmcnt(7)
    v_cvt_pk_bf16_f32 v247, v231, v223
    v_cvt_pkrtz_f16_f32 v208, v176, v177
    v_cvt_pkrtz_f16_f32 v209, v178, v179
    s_waitcnt lgkmcnt(6)
    v_or_b32 v243, v227, v219
    v_cvt_pkrtz_f16_f32 v210, v180, v181
    v_cvt_pkrtz_f16_f32 v211, v182, v183
    v_mfma_f32_32x32x16_bf16 v[80:95], a[240:243], v[240:243], v[80:95]
    ds_read_b128 a[240:243], v23 offset:21504
    v_cvt_pkrtz_f16_f32 v212, v184, v185
    v_cvt_pkrtz_f16_f32 v213, v186, v187
    v_cvt_pkrtz_f16_f32 v214, v188, v189
    v_cvt_pkrtz_f16_f32 v215, v190, v191
    v_pk_lshrrev_b16 v216, 3, v208 op_sel_hi:[0,1]
    v_mfma_f32_32x32x16_bf16 v[48:63], a[244:247], v[232:235], v[48:63]
    v_pk_lshrrev_b16 v217, 3, v209 op_sel_hi:[0,1]
    v_pk_lshrrev_b16 v218, 3, v210 op_sel_hi:[0,1]
    v_pk_lshrrev_b16 v219, 3, v211 op_sel_hi:[0,1]
    v_mad_u32_u16 v224, v216, 2, s85
    v_mad_u32_u16 v216, v216, 2, s85 op_sel:[1,0,0,0]
    v_mad_u32_u16 v225, v217, 2, s85
    v_mfma_f32_32x32x16_bf16 v[96:111], a[244:247], v[240:243], v[96:111]
    s_waitcnt lgkmcnt(4)
    ds_read_u16 v224, v224
    ds_read_u16_d16_hi v216, v216
    ds_read_b128 a[244:247], v23 offset:22528
    v_or_b32 v244, v228, v220
    v_pk_lshrrev_b16 v220, 3, v212 op_sel_hi:[0,1]
    v_mad_u32_u16 v217, v217, 2, s85 op_sel:[1,0,0,0]
    v_mfma_f32_32x32x16_bf16 v[64:79], a[248:251], v[232:235], v[64:79]
    ds_read_u16 v225, v225
    ds_read_u16_d16_hi v217, v217
    v_mad_u32_u16 v226, v218, 2, s85
    v_mad_u32_u16 v218, v218, 2, s85 op_sel:[1,0,0,0]
    v_mad_u32_u16 v227, v219, 2, s85
    v_mad_u32_u16 v219, v219, 2, s85 op_sel:[1,0,0,0]
    v_mfma_f32_32x32x16_bf16 v[112:127], a[248:251], v[240:243], v[112:127]
    s_waitcnt lgkmcnt(6)
    ds_read_b128 a[248:251], v23 offset:24576
    ds_read_u16 v226, v226
    v_or_b32 v245, v229, v221
    v_pk_lshrrev_b16 v221, 3, v213 op_sel_hi:[0,1]
    v_mad_u32_u16 v228, v220, 2, s85
    v_mad_u32_u16 v220, v220, 2, s85 op_sel:[1,0,0,0]
    v_mfma_f32_32x32x16_bf16 v[32:47], a[252:255], v[236:239], v[32:47]
    s_add_u32 m0, s56, 8384
    ds_read_u16_d16_hi v218, v218
    buffer_load_dwordx4 v3, s[20:23], 0 offen offset:64 lds
    v_mad_u32_u16 v229, v221, 2, s85
    v_mad_u32_u16 v221, v221, 2, s85 op_sel:[1,0,0,0]
    v_pk_fma_f16 v222, v214, v214, s53
    v_mfma_f32_32x32x16_bf16 v[80:95], a[252:255], v[244:247], v[80:95]
    ds_read_b128 a[252:255], v23 offset:25600
    ds_read_u16 v227, v227
    v_pk_fma_f16 v223, v215, v215, s53
    v_pk_mul_f16 v222, v222, v214 neg_lo:[1,0] neg_hi:[1,0]
    v_pk_mul_f16 v223, v223, v215 neg_lo:[1,0] neg_hi:[1,0]
    v_exp_f16 v230, v222
    v_mfma_f32_32x32x16_bf16 v[48:63], a[232:235], v[236:239], v[48:63]
    ds_read_u16_d16_hi v219, v219
    v_exp_f16 v231, v223
    v_exp_f16_sdwa v230, v222 dst_sel:WORD_1 dst_unused:UNUSED_PRESERVE src0_sel:WORD_1
    v_exp_f16_sdwa v231, v223 dst_sel:WORD_1 dst_unused:UNUSED_PRESERVE src0_sel:WORD_1
    v_mfma_f32_32x32x16_bf16 v[96:111], a[232:235], v[244:247], v[96:111]
    ds_read_b128 a[232:235], v23 offset:16384
    ds_read_u16 v228, v228
    v_pk_add_f16 v230, v230, 1.0 op_sel_hi:[1,0]
    v_pk_add_f16 v231, v231, 1.0 op_sel_hi:[1,0]
    v_rcp_f16 v222, v230
    v_mfma_f32_32x32x16_bf16 v[64:79], a[236:239], v[236:239], v[64:79]
    s_waitcnt lgkmcnt(13)
    ds_read_u16_d16_hi v220, v220
    v_rcp_f16 v223, v231
    v_rcp_f16_sdwa v222, v230 dst_sel:WORD_1 dst_unused:UNUSED_PRESERVE src0_sel:WORD_1
    v_rcp_f16_sdwa v223, v231 dst_sel:WORD_1 dst_unused:UNUSED_PRESERVE src0_sel:WORD_1
    v_mfma_f32_32x32x16_bf16 v[112:127], a[236:239], v[244:247], v[112:127]
    s_waitcnt lgkmcnt(11)
    ds_read_b128 a[236:239], v23 offset:18432
    ds_read_u16 v229, v229
    ds_read_u16_d16_hi v221, v221
    v_fma_mix_f32 v230, v222, v214, 0 op_sel_hi:[1,1,0]
    v_fma_mix_f32 v231, v223, v215, 0 op_sel_hi:[1,1,0]
    v_fma_mix_f32 v222, v222, v214, 0 op_sel:[1,1,0] op_sel_hi:[1,1,0]
    v_mfma_f32_32x32x16_f16 v[176:191], a[208:211], v[128:131], 0
    s_waitcnt lgkmcnt(9)
    v_fma_mix_f32 v223, v223, v215, 0 op_sel:[1,1,0] op_sel_hi:[1,1,0]
    v_or_b32 v232, v224, v216
    v_or_b32 v233, v225, v217
    v_or_b32 v234, v226, v218
    v_cvt_pk_bf16_f32 v238, v230, v222
    v_cvt_pk_bf16_f32 v239, v231, v223
    v_cvt_pkrtz_f16_f32 v208, v192, v193
    v_cvt_pkrtz_f16_f32 v209, v194, v195
    v_cvt_pkrtz_f16_f32 v210, v196, v197
    v_cvt_pkrtz_f16_f32 v211, v198, v199
    v_cvt_pkrtz_f16_f32 v212, v200, v201
    v_cvt_pkrtz_f16_f32 v213, v202, v203
    v_cvt_pkrtz_f16_f32 v214, v204, v205
    v_cvt_pkrtz_f16_f32 v215, v206, v207
    v_mfma_f32_32x32x16_f16 v[192:207], a[208:211], v[152:155], 0
    s_waitcnt lgkmcnt(6)
    v_or_b32 v235, v227, v219
    v_pk_lshrrev_b16 v216, 3, v208 op_sel_hi:[0,1]
    v_pk_lshrrev_b16 v217, 3, v209 op_sel_hi:[0,1]
    v_pk_lshrrev_b16 v218, 3, v210 op_sel_hi:[0,1]
    v_pk_lshrrev_b16 v219, 3, v211 op_sel_hi:[0,1]
    v_mad_u32_u16 v224, v216, 2, s85
    v_mfma_f32_32x32x16_f16 v[176:191], a[240:243], v[132:135], v[176:191]
    ds_read_u16 v224, v224
    v_mad_u32_u16 v216, v216, 2, s85 op_sel:[1,0,0,0]
    v_mad_u32_u16 v225, v217, 2, s85
    v_mad_u32_u16 v217, v217, 2, s85 op_sel:[1,0,0,0]
    v_mad_u32_u16 v226, v218, 2, s85
    v_mad_u32_u16 v218, v218, 2, s85 op_sel:[1,0,0,0]
    v_mfma_f32_32x32x16_f16 v[192:207], a[240:243], v[156:159], v[192:207]
    s_waitcnt lgkmcnt(5)
    ds_read_u16_d16_hi v216, v216
    ds_read_b128 a[240:243], v23 offset:10240
    ds_read_u16 v225, v225
    s_waitcnt lgkmcnt(7)
    v_or_b32 v236, v228, v220
    v_pk_lshrrev_b16 v220, 3, v212 op_sel_hi:[0,1]
    v_mad_u32_u16 v227, v219, 2, s85
    v_mfma_f32_32x32x16_f16 v[176:191], a[244:247], v[136:139], v[176:191]
    ds_read_u16_d16_hi v217, v217
    v_mad_u32_u16 v219, v219, 2, s85 op_sel:[1,0,0,0]
    v_mad_u32_u16 v228, v220, 2, s85
    v_mad_u32_u16 v220, v220, 2, s85 op_sel:[1,0,0,0]
    v_pk_fma_f16 v222, v214, v214, s53
    v_pk_fma_f16 v223, v215, v215, s53
    v_mfma_f32_32x32x16_f16 v[192:207], a[244:247], v[160:163], v[192:207]
    s_waitcnt lgkmcnt(6)
    ds_read_b128 a[244:247], v23 offset:17408
    ds_read_u16 v226, v226
    v_pk_mul_f16 v222, v222, v214 neg_lo:[1,0] neg_hi:[1,0]
    v_pk_mul_f16 v223, v223, v215 neg_lo:[1,0] neg_hi:[1,0]
    s_waitcnt lgkmcnt(7)
    v_or_b32 v237, v229, v221
    v_pk_lshrrev_b16 v221, 3, v213 op_sel_hi:[0,1]
    v_mfma_f32_32x32x16_f16 v[176:191], a[212:215], v[140:143], v[176:191]
    s_add_u32 m0, s56, 9408
    ds_read_u16_d16_hi v218, v218
    buffer_load_dwordx4 v4, s[20:23], 0 offen offset:64 lds
    v_mad_u32_u16 v229, v221, 2, s85
    v_mad_u32_u16 v221, v221, 2, s85 op_sel:[1,0,0,0]
    v_exp_f16 v230, v222
    v_mfma_f32_32x32x16_f16 v[192:207], a[212:215], v[164:167], v[192:207]
    ds_read_u16 v227, v227
    v_exp_f16 v231, v223
    v_exp_f16_sdwa v230, v222 dst_sel:WORD_1 dst_unused:UNUSED_PRESERVE src0_sel:WORD_1
    v_exp_f16_sdwa v231, v223 dst_sel:WORD_1 dst_unused:UNUSED_PRESERVE src0_sel:WORD_1
    v_mfma_f32_32x32x16_f16 v[176:191], a[248:251], v[144:147], v[176:191]
    ds_read_u16_d16_hi v219, v219
    v_pk_add_f16 v230, v230, 1.0 op_sel_hi:[1,0]
    v_pk_add_f16 v231, v231, 1.0 op_sel_hi:[1,0]
    v_rcp_f16 v222, v230
    v_rcp_f16 v223, v231
    v_mfma_f32_32x32x16_f16 v[192:207], a[248:251], v[168:171], v[192:207]
    ds_read_b128 a[248:251], v23 offset:19456
    ds_read_u16 v228, v228
    v_rcp_f16_sdwa v222, v230 dst_sel:WORD_1 dst_unused:UNUSED_PRESERVE src0_sel:WORD_1
    v_rcp_f16_sdwa v223, v231 dst_sel:WORD_1 dst_unused:UNUSED_PRESERVE src0_sel:WORD_1
    v_mfma_f32_32x32x16_f16 v[176:191], a[252:255], v[148:151], v[176:191]
    s_waitcnt lgkmcnt(10)
    ds_read_u16_d16_hi v220, v220
    v_fma_mix_f32 v230, v222, v214, 0 op_sel_hi:[1,1,0]
    v_fma_mix_f32 v231, v223, v215, 0 op_sel_hi:[1,1,0]
    v_fma_mix_f32 v222, v222, v214, 0 op_sel:[1,1,0] op_sel_hi:[1,1,0]
    v_fma_mix_f32 v223, v223, v215, 0 op_sel:[1,1,0] op_sel_hi:[1,1,0]
    v_or_b32 v240, v224, v216
    v_mfma_f32_32x32x16_f16 v[192:207], a[252:255], v[172:175], v[192:207]
    s_waitcnt lgkmcnt(6)
    ds_read_b128 a[252:255], v23 offset:13312
    ds_read_u16 v229, v229
    ds_read_u16_d16_hi v221, v221
    v_or_b32 v241, v225, v217
    v_cvt_pk_bf16_f32 v246, v230, v222
    s_waitcnt lgkmcnt(8)
    v_or_b32 v242, v226, v218
    v_mfma_f32_32x32x16_bf16 v[32:47], a[232:235], v[232:235], v[32:47]
    v_cvt_pk_bf16_f32 v247, v231, v223
    v_cvt_pkrtz_f16_f32 v208, v176, v177
    v_cvt_pkrtz_f16_f32 v209, v178, v179
    v_cvt_pkrtz_f16_f32 v210, v180, v181
    v_cvt_pkrtz_f16_f32 v211, v182, v183
    v_cvt_pkrtz_f16_f32 v212, v184, v185
    v_cvt_pkrtz_f16_f32 v213, v186, v187
    v_cvt_pkrtz_f16_f32 v214, v188, v189
    v_cvt_pkrtz_f16_f32 v215, v190, v191
    v_pk_lshrrev_b16 v216, 3, v208 op_sel_hi:[0,1]
    v_pk_lshrrev_b16 v217, 3, v209 op_sel_hi:[0,1]
    s_waitcnt lgkmcnt(6)
    v_or_b32 v243, v227, v219
    v_pk_lshrrev_b16 v218, 3, v210 op_sel_hi:[0,1]
    v_pk_lshrrev_b16 v219, 3, v211 op_sel_hi:[0,1]
    v_mfma_f32_32x32x16_bf16 v[80:95], a[232:235], v[240:243], v[80:95]
    ds_read_b128 a[232:235], v23 offset:31744
    v_mad_u32_u16 v224, v216, 2, s85
    v_mad_u32_u16 v216, v216, 2, s85 op_sel:[1,0,0,0]
    v_mad_u32_u16 v225, v217, 2, s85
    v_mad_u32_u16 v217, v217, 2, s85 op_sel:[1,0,0,0]
    v_mad_u32_u16 v226, v218, 2, s85
    v_mfma_f32_32x32x16_bf16 v[48:63], a[236:239], v[232:235], v[48:63]
    ds_read_u16 v224, v224
    ds_read_u16_d16_hi v216, v216
    v_mad_u32_u16 v218, v218, 2, s85 op_sel:[1,0,0,0]
    v_mad_u32_u16 v227, v219, 2, s85
    v_mad_u32_u16 v219, v219, 2, s85 op_sel:[1,0,0,0]
    v_pk_fma_f16 v222, v214, v214, s53
    v_mfma_f32_32x32x16_bf16 v[96:111], a[236:239], v[240:243], v[96:111]
    s_waitcnt lgkmcnt(6)
    ds_read_b128 a[236:239], v23 offset:32768
    ds_read_u16 v225, v225
    v_or_b32 v244, v228, v220
    v_pk_lshrrev_b16 v220, 3, v212 op_sel_hi:[0,1]
    v_mad_u32_u16 v228, v220, 2, s85
    v_mad_u32_u16 v220, v220, 2, s85 op_sel:[1,0,0,0]
    v_mfma_f32_32x32x16_bf16 v[64:79], a[240:243], v[232:235], v[64:79]
    ds_read_u16_d16_hi v217, v217
    v_pk_fma_f16 v223, v215, v215, s53
    v_pk_mul_f16 v222, v222, v214 neg_lo:[1,0] neg_hi:[1,0]
    v_pk_mul_f16 v223, v223, v215 neg_lo:[1,0] neg_hi:[1,0]
    v_exp_f16 v230, v222
    v_mfma_f32_32x32x16_bf16 v[112:127], a[240:243], v[240:243], v[112:127]
    s_waitcnt lgkmcnt(6)
    ds_read_b128 a[240:243], v23 offset:34816
    ds_read_u16 v226, v226
    v_or_b32 v245, v229, v221
    v_pk_lshrrev_b16 v221, 3, v213 op_sel_hi:[0,1]
    v_mad_u32_u16 v229, v221, 2, s85
    v_mad_u32_u16 v221, v221, 2, s85 op_sel:[1,0,0,0]
    v_mfma_f32_32x32x16_bf16 v[32:47], a[244:247], v[236:239], v[32:47]
    s_add_u32 m0, s56, 10432
    ds_read_u16_d16_hi v218, v218
    buffer_load_dwordx4 v5, s[20:23], 0 offen offset:64 lds
    v_exp_f16 v231, v223
    v_exp_f16_sdwa v230, v222 dst_sel:WORD_1 dst_unused:UNUSED_PRESERVE src0_sel:WORD_1
    v_mfma_f32_32x32x16_bf16 v[80:95], a[244:247], v[244:247], v[80:95]
    ds_read_b128 a[244:247], v23 offset:35840
    ds_read_u16 v227, v227
    v_exp_f16_sdwa v231, v223 dst_sel:WORD_1 dst_unused:UNUSED_PRESERVE src0_sel:WORD_1
    v_pk_add_f16 v230, v230, 1.0 op_sel_hi:[1,0]
    v_pk_add_f16 v231, v231, 1.0 op_sel_hi:[1,0]
    v_mfma_f32_32x32x16_bf16 v[48:63], a[248:251], v[236:239], v[48:63]
    ds_read_u16_d16_hi v219, v219
    v_rcp_f16 v222, v230
    v_rcp_f16 v223, v231
    v_rcp_f16_sdwa v222, v230 dst_sel:WORD_1 dst_unused:UNUSED_PRESERVE src0_sel:WORD_1
    v_mfma_f32_32x32x16_bf16 v[96:111], a[248:251], v[244:247], v[96:111]
    ds_read_b128 a[248:251], v23 offset:26624
    ds_read_u16 v228, v228
    v_rcp_f16_sdwa v223, v231 dst_sel:WORD_1 dst_unused:UNUSED_PRESERVE src0_sel:WORD_1
    v_fma_mix_f32 v230, v222, v214, 0 op_sel_hi:[1,1,0]
    v_fma_mix_f32 v231, v223, v215, 0 op_sel_hi:[1,1,0]
    v_mfma_f32_32x32x16_bf16 v[64:79], a[252:255], v[236:239], v[64:79]
    s_waitcnt lgkmcnt(8)
    ds_read_u16_d16_hi v220, v220
    v_fma_mix_f32 v222, v222, v214, 0 op_sel:[1,1,0] op_sel_hi:[1,1,0]
    v_fma_mix_f32 v223, v223, v215, 0 op_sel:[1,1,0] op_sel_hi:[1,1,0]
    v_or_b32 v232, v224, v216
    v_or_b32 v233, v225, v217
    v_cvt_pk_bf16_f32 v238, v230, v222
    v_mfma_f32_32x32x16_bf16 v[112:127], a[252:255], v[244:247], v[112:127]
    ds_read_b128 a[252:255], v23 offset:28672
    ds_read_u16 v229, v229
    ds_read_u16_d16_hi v221, v221
    v_cvt_pk_bf16_f32 v239, v231, v223
    v_cvt_pkrtz_f16_f32 v208, v192, v193
    v_cvt_pkrtz_f16_f32 v209, v194, v195
    v_mfma_f32_32x32x16_f16 v[176:191], a[216:219], v[128:131], 0
    s_waitcnt lgkmcnt(9)
    v_or_b32 v234, v226, v218
    v_cvt_pkrtz_f16_f32 v210, v196, v197
    v_cvt_pkrtz_f16_f32 v211, v198, v199
    v_cvt_pkrtz_f16_f32 v212, v200, v201
    v_cvt_pkrtz_f16_f32 v213, v202, v203
    v_cvt_pkrtz_f16_f32 v214, v204, v205
    v_cvt_pkrtz_f16_f32 v215, v206, v207
    v_mfma_f32_32x32x16_f16 v[192:207], a[216:219], v[152:155], 0
    v_pk_lshrrev_b16 v216, 3, v208 op_sel_hi:[0,1]
    v_pk_lshrrev_b16 v217, 3, v209 op_sel_hi:[0,1]
    v_pk_lshrrev_b16 v218, 3, v210 op_sel_hi:[0,1]
    v_mad_u32_u16 v224, v216, 2, s85
    v_mad_u32_u16 v216, v216, 2, s85 op_sel:[1,0,0,0]
    v_mad_u32_u16 v225, v217, 2, s85
    v_mfma_f32_32x32x16_f16 v[176:191], a[232:235], v[132:135], v[176:191]
    s_waitcnt lgkmcnt(6)
    ds_read_u16 v224, v224
    ds_read_u16_d16_hi v216, v216
    v_or_b32 v235, v227, v219
    v_pk_lshrrev_b16 v219, 3, v211 op_sel_hi:[0,1]
    v_mad_u32_u16 v217, v217, 2, s85 op_sel:[1,0,0,0]
    v_mad_u32_u16 v226, v218, 2, s85
    v_mfma_f32_32x32x16_f16 v[192:207], a[232:235], v[156:159], v[192:207]
    ds_read_b128 a[232:235], v23 offset:20480
    ds_read_u16 v225, v225
    v_mad_u32_u16 v218, v218, 2, s85 op_sel:[1,0,0,0]
    v_mad_u32_u16 v227, v219, 2, s85
    v_mad_u32_u16 v219, v219, 2, s85 op_sel:[1,0,0,0]
    v_pk_fma_f16 v222, v214, v214, s53
    v_mfma_f32_32x32x16_f16 v[176:191], a[236:239], v[136:139], v[176:191]
    s_waitcnt lgkmcnt(8)
    ds_read_u16_d16_hi v217, v217
    v_pk_fma_f16 v223, v215, v215, s53
    s_waitcnt lgkmcnt(8)
    v_or_b32 v236, v228, v220
    v_pk_lshrrev_b16 v220, 3, v212 op_sel_hi:[0,1]
    v_mad_u32_u16 v228, v220, 2, s85
    v_mad_u32_u16 v220, v220, 2, s85 op_sel:[1,0,0,0]
    v_mfma_f32_32x32x16_f16 v[192:207], a[236:239], v[160:163], v[192:207]
    ds_read_b128 a[236:239], v23 offset:27648
    ds_read_u16 v226, v226
    v_pk_mul_f16 v222, v222, v214 neg_lo:[1,0] neg_hi:[1,0]
    v_pk_mul_f16 v223, v223, v215 neg_lo:[1,0] neg_hi:[1,0]
    v_exp_f16 v230, v222
    v_mfma_f32_32x32x16_f16 v[176:191], a[220:223], v[140:143], v[176:191]
    s_add_u32 m0, s56, 11456
    ds_read_u16_d16_hi v218, v218
    buffer_load_dwordx4 v6, s[20:23], 0 offen offset:64 lds
    v_exp_f16 v231, v223
    s_waitcnt lgkmcnt(8)
    v_or_b32 v237, v229, v221
    v_mfma_f32_32x32x16_f16 v[192:207], a[220:223], v[164:167], v[192:207]
    ds_read_u16 v227, v227
    v_pk_lshrrev_b16 v221, 3, v213 op_sel_hi:[0,1]
    v_mad_u32_u16 v229, v221, 2, s85
    v_mad_u32_u16 v221, v221, 2, s85 op_sel:[1,0,0,0]
    v_exp_f16_sdwa v230, v222 dst_sel:WORD_1 dst_unused:UNUSED_PRESERVE src0_sel:WORD_1
    v_mfma_f32_32x32x16_f16 v[176:191], a[240:243], v[144:147], v[176:191]
    ds_read_u16_d16_hi v219, v219
    v_exp_f16_sdwa v231, v223 dst_sel:WORD_1 dst_unused:UNUSED_PRESERVE src0_sel:WORD_1
    v_pk_add_f16 v230, v230, 1.0 op_sel_hi:[1,0]
    v_pk_add_f16 v231, v231, 1.0 op_sel_hi:[1,0]
    v_rcp_f16 v222, v230
    v_mfma_f32_32x32x16_f16 v[192:207], a[240:243], v[168:171], v[192:207]
    ds_read_b128 a[240:243], v23 offset:29696
    ds_read_u16 v228, v228
    v_rcp_f16 v223, v231
    v_rcp_f16_sdwa v222, v230 dst_sel:WORD_1 dst_unused:UNUSED_PRESERVE src0_sel:WORD_1
    v_mfma_f32_32x32x16_f16 v[176:191], a[244:247], v[148:151], v[176:191]
    ds_read_u16_d16_hi v220, v220
    v_rcp_f16_sdwa v223, v231 dst_sel:WORD_1 dst_unused:UNUSED_PRESERVE src0_sel:WORD_1
    v_fma_mix_f32 v230, v222, v214, 0 op_sel_hi:[1,1,0]
    v_fma_mix_f32 v231, v223, v215, 0 op_sel_hi:[1,1,0]
    v_fma_mix_f32 v222, v222, v214, 0 op_sel:[1,1,0] op_sel_hi:[1,1,0]
    v_mfma_f32_32x32x16_f16 v[192:207], a[244:247], v[172:175], v[192:207]
    s_waitcnt lgkmcnt(8)
    ds_read_b128 a[244:247], v23 offset:23552
    ds_read_u16 v229, v229
    ds_read_u16_d16_hi v221, v221
    v_fma_mix_f32 v223, v223, v215, 0 op_sel:[1,1,0] op_sel_hi:[1,1,0]
    v_or_b32 v240, v224, v216
    v_or_b32 v241, v225, v217
    v_mfma_f32_32x32x16_bf16 v[32:47], a[248:251], v[232:235], v[32:47]
    s_waitcnt lgkmcnt(9)
    v_cvt_pk_bf16_f32 v246, v230, v222
    v_cvt_pk_bf16_f32 v247, v231, v223
    v_cvt_pkrtz_f16_f32 v208, v176, v177
    v_cvt_pkrtz_f16_f32 v209, v178, v179
    v_cvt_pkrtz_f16_f32 v210, v180, v181
    v_cvt_pkrtz_f16_f32 v211, v182, v183
    v_cvt_pkrtz_f16_f32 v212, v184, v185
    s_waitcnt lgkmcnt(8)
    v_or_b32 v242, v226, v218
    v_cvt_pkrtz_f16_f32 v213, v186, v187
    v_cvt_pkrtz_f16_f32 v214, v188, v189
    v_cvt_pkrtz_f16_f32 v215, v190, v191
    v_pk_lshrrev_b16 v216, 3, v208 op_sel_hi:[0,1]
    v_pk_lshrrev_b16 v217, 3, v209 op_sel_hi:[0,1]
    v_pk_lshrrev_b16 v218, 3, v210 op_sel_hi:[0,1]
    v_mad_u32_u16 v224, v216, 2, s85
    v_mad_u32_u16 v216, v216, 2, s85 op_sel:[1,0,0,0]
    v_mad_u32_u16 v225, v217, 2, s85
    v_mad_u32_u16 v217, v217, 2, s85 op_sel:[1,0,0,0]
    v_mad_u32_u16 v226, v218, 2, s85
    v_mad_u32_u16 v218, v218, 2, s85 op_sel:[1,0,0,0]
    v_pk_fma_f16 v222, v214, v214, s53
    s_waitcnt lgkmcnt(6)
    v_or_b32 v243, v227, v219
    v_pk_lshrrev_b16 v219, 3, v211 op_sel_hi:[0,1]
    v_mad_u32_u16 v227, v219, 2, s85
    v_mfma_f32_32x32x16_bf16 v[80:95], a[248:251], v[240:243], v[80:95]
    ds_read_b128 a[248:251], v24 offset:0
    ds_read_u16 v224, v224
    v_mad_u32_u16 v219, v219, 2, s85 op_sel:[1,0,0,0]
    v_pk_fma_f16 v223, v215, v215, s53
    v_pk_mul_f16 v222, v222, v214 neg_lo:[1,0] neg_hi:[1,0]
    v_pk_mul_f16 v223, v223, v215 neg_lo:[1,0] neg_hi:[1,0]
    v_mfma_f32_32x32x16_bf16 v[48:63], a[252:255], v[232:235], v[48:63]
    ds_read_u16_d16_hi v216, v216
    v_exp_f16 v230, v222
    v_exp_f16 v231, v223
    v_exp_f16_sdwa v230, v222 dst_sel:WORD_1 dst_unused:UNUSED_PRESERVE src0_sel:WORD_1
    v_mfma_f32_32x32x16_bf16 v[96:111], a[252:255], v[240:243], v[96:111]
    s_waitcnt lgkmcnt(6)
    ds_read_b128 a[252:255], v24 offset:1024
    ds_read_u16 v225, v225
    v_or_b32 v244, v228, v220
    v_pk_lshrrev_b16 v220, 3, v212 op_sel_hi:[0,1]
    v_mad_u32_u16 v228, v220, 2, s85
    v_mad_u32_u16 v220, v220, 2, s85 op_sel:[1,0,0,0]
    v_mfma_f32_32x32x16_bf16 v[64:79], a[232:235], v[232:235], v[64:79]
    ds_read_u16_d16_hi v217, v217
    v_exp_f16_sdwa v231, v223 dst_sel:WORD_1 dst_unused:UNUSED_PRESERVE src0_sel:WORD_1
    v_pk_add_f16 v230, v230, 1.0 op_sel_hi:[1,0]
    v_pk_add_f16 v231, v231, 1.0 op_sel_hi:[1,0]
    v_rcp_f16 v222, v230
    v_mfma_f32_32x32x16_bf16 v[112:127], a[232:235], v[240:243], v[112:127]
    s_waitcnt lgkmcnt(6)
    ds_read_b128 a[232:235], v24 offset:2048
    ds_read_u16 v226, v226
    v_or_b32 v245, v229, v221
    v_pk_lshrrev_b16 v221, 3, v213 op_sel_hi:[0,1]
    v_mad_u32_u16 v229, v221, 2, s85
    v_mad_u32_u16 v221, v221, 2, s85 op_sel:[1,0,0,0]
    v_mfma_f32_32x32x16_bf16 v[32:47], a[236:239], v[236:239], v[32:47]
    s_add_u32 m0, s56, 12480
    ds_read_u16_d16_hi v218, v218
    buffer_load_dword v7, s[20:23], 0 offen offset:64 lds
    v_rcp_f16 v223, v231
    v_rcp_f16_sdwa v222, v230 dst_sel:WORD_1 dst_unused:UNUSED_PRESERVE src0_sel:WORD_1
    v_mfma_f32_32x32x16_bf16 v[80:95], a[236:239], v[244:247], v[80:95]
    ds_read_b128 a[236:239], v24 offset:3072
    ds_read_u16 v227, v227
    v_rcp_f16_sdwa v223, v231 dst_sel:WORD_1 dst_unused:UNUSED_PRESERVE src0_sel:WORD_1
    v_fma_mix_f32 v230, v222, v214, 0 op_sel_hi:[1,1,0]
    v_fma_mix_f32 v231, v223, v215, 0 op_sel_hi:[1,1,0]
    v_mfma_f32_32x32x16_bf16 v[48:63], a[240:243], v[236:239], v[48:63]
    s_waitcnt lgkmcnt(8)
    ds_read_u16_d16_hi v219, v219
    v_fma_mix_f32 v222, v222, v214, 0 op_sel:[1,1,0] op_sel_hi:[1,1,0]
    v_fma_mix_f32 v223, v223, v215, 0 op_sel:[1,1,0] op_sel_hi:[1,1,0]
    v_or_b32 v232, v224, v216
    v_cvt_pkrtz_f16_f32 v208, v192, v193
    v_cvt_pkrtz_f16_f32 v209, v194, v195
    v_mfma_f32_32x32x16_bf16 v[96:111], a[240:243], v[244:247], v[96:111]
    s_waitcnt lgkmcnt(7)
    ds_read_b128 a[240:243], v24 offset:4096
    ds_read_u16 v228, v228
    s_waitcnt lgkmcnt(8)
    v_or_b32 v233, v225, v217
    v_cvt_pkrtz_f16_f32 v210, v196, v197
    v_cvt_pkrtz_f16_f32 v211, v198, v199
    v_cvt_pkrtz_f16_f32 v212, v200, v201
    v_mfma_f32_32x32x16_bf16 v[64:79], a[244:247], v[236:239], v[64:79]
    ds_read_u16_d16_hi v220, v220
    v_cvt_pk_bf16_f32 v238, v230, v222
    v_cvt_pk_bf16_f32 v239, v231, v223
    v_cvt_pkrtz_f16_f32 v213, v202, v203
    v_cvt_pkrtz_f16_f32 v214, v204, v205
    v_cvt_pkrtz_f16_f32 v215, v206, v207
    v_mfma_f32_32x32x16_bf16 v[112:127], a[244:247], v[244:247], v[112:127]
    s_waitcnt lgkmcnt(7)
    ds_read_b128 a[244:247], v24 offset:5120
    ds_read_u16 v229, v229
    ds_read_u16_d16_hi v221, v221
    v_pk_lshrrev_b16 v216, 3, v208 op_sel_hi:[0,1]
    v_pk_lshrrev_b16 v217, 3, v209 op_sel_hi:[0,1]
    s_waitcnt lgkmcnt(9)
    v_or_b32 v234, v226, v218
    v_mfma_f32_32x32x16_f16 v[176:191], a[248:251], v[128:131], 0
    v_pk_lshrrev_b16 v218, 3, v210 op_sel_hi:[0,1]
    v_mad_u32_u16 v224, v216, 2, s85
    v_mad_u32_u16 v216, v216, 2, s85 op_sel:[1,0,0,0]
    v_mad_u32_u16 v225, v217, 2, s85
    v_mad_u32_u16 v217, v217, 2, s85 op_sel:[1,0,0,0]
    v_mad_u32_u16 v226, v218, 2, s85
    v_mfma_f32_32x32x16_f16 v[192:207], a[248:251], v[152:155], 0
    ds_read_b128 a[248:251], v23 offset:36864
    ds_read_u16 v224, v224
    v_mad_u32_u16 v218, v218, 2, s85 op_sel:[1,0,0,0]
    v_pk_fma_f16 v222, v214, v214, s53
    v_pk_fma_f16 v223, v215, v215, s53
    v_pk_mul_f16 v222, v222, v214 neg_lo:[1,0] neg_hi:[1,0]
    v_mfma_f32_32x32x16_f16 v[176:191], a[252:255], v[132:135], v[176:191]
    s_waitcnt lgkmcnt(8)
    ds_read_u16_d16_hi v216, v216
    v_or_b32 v235, v227, v219
    v_pk_lshrrev_b16 v219, 3, v211 op_sel_hi:[0,1]
    v_mad_u32_u16 v227, v219, 2, s85
    v_mad_u32_u16 v219, v219, 2, s85 op_sel:[1,0,0,0]
    v_pk_mul_f16 v223, v223, v215 neg_lo:[1,0] neg_hi:[1,0]
    v_mfma_f32_32x32x16_f16 v[192:207], a[252:255], v[156:159], v[192:207]
    ds_read_b128 a[252:255], v23 offset:38912
    ds_read_u16 v225, v225
    v_exp_f16 v230, v222
    v_exp_f16 v231, v223
    v_mfma_f32_32x32x16_f16 v[176:191], a[232:235], v[136:139], v[176:191]
    s_waitcnt lgkmcnt(9)
    ds_read_u16_d16_hi v217, v217
    v_exp_f16_sdwa v230, v222 dst_sel:WORD_1 dst_unused:UNUSED_PRESERVE src0_sel:WORD_1
    s_waitcnt lgkmcnt(9)
    v_or_b32 v236, v228, v220
    v_pk_lshrrev_b16 v220, 3, v212 op_sel_hi:[0,1]
    v_mad_u32_u16 v228, v220, 2, s85
    v_mfma_f32_32x32x16_f16 v[192:207], a[232:235], v[160:163], v[192:207]
    ds_read_b128 a[232:235], v23 offset:30720
    ds_read_u16 v226, v226
    v_mad_u32_u16 v220, v220, 2, s85 op_sel:[1,0,0,0]
    v_exp_f16_sdwa v231, v223 dst_sel:WORD_1 dst_unused:UNUSED_PRESERVE src0_sel:WORD_1
    v_pk_add_f16 v230, v230, 1.0 op_sel_hi:[1,0]
    v_mfma_f32_32x32x16_f16 v[176:191], a[236:239], v[140:143], v[176:191]
    s_add_u32 m0, s56, 0
    ds_read_u16_d16_hi v218, v218
    buffer_load_dwordx4 v1, s[20:23], 0 offen offset:0 lds
    v_pk_add_f16 v231, v231, 1.0 op_sel_hi:[1,0]
    s_waitcnt lgkmcnt(9)
    v_or_b32 v237, v229, v221
    v_pk_lshrrev_b16 v221, 3, v213 op_sel_hi:[0,1]
    v_mfma_f32_32x32x16_f16 v[192:207], a[236:239], v[164:167], v[192:207]
    ds_read_b128 a[236:239], v23 offset:37888
    ds_read_u16 v227, v227
    v_mad_u32_u16 v229, v221, 2, s85
    v_mad_u32_u16 v221, v221, 2, s85 op_sel:[1,0,0,0]
    v_rcp_f16 v222, v230
    v_mfma_f32_32x32x16_f16 v[176:191], a[240:243], v[144:147], v[176:191]
    ds_read_u16_d16_hi v219, v219
    v_rcp_f16 v223, v231
    v_rcp_f16_sdwa v222, v230 dst_sel:WORD_1 dst_unused:UNUSED_PRESERVE src0_sel:WORD_1
    v_rcp_f16_sdwa v223, v231 dst_sel:WORD_1 dst_unused:UNUSED_PRESERVE src0_sel:WORD_1
    v_mfma_f32_32x32x16_f16 v[192:207], a[240:243], v[168:171], v[192:207]
    ds_read_b128 a[240:243], v23 offset:39936
    ds_read_u16 v228, v228
    v_fma_mix_f32 v230, v222, v214, 0 op_sel_hi:[1,1,0]
    v_fma_mix_f32 v231, v223, v215, 0 op_sel_hi:[1,1,0]
    v_fma_mix_f32 v222, v222, v214, 0 op_sel:[1,1,0] op_sel_hi:[1,1,0]
    v_fma_mix_f32 v223, v223, v215, 0 op_sel:[1,1,0] op_sel_hi:[1,1,0]
    v_mfma_f32_32x32x16_f16 v[176:191], a[244:247], v[148:151], v[176:191]
    s_waitcnt lgkmcnt(11)
    ds_read_u16_d16_hi v220, v220
    v_or_b32 v240, v224, v216
    v_cvt_pk_bf16_f32 v246, v230, v222
    v_cvt_pk_bf16_f32 v247, v231, v223
    v_mfma_f32_32x32x16_f16 v[192:207], a[244:247], v[172:175], v[192:207]
    s_waitcnt lgkmcnt(9)
    ds_read_b128 a[244:247], v23 offset:33792
    ds_read_u16 v229, v229
    ds_read_u16_d16_hi v221, v221
    v_or_b32 v241, v225, v217
    v_mfma_f32_32x32x16_bf16 v[32:47], a[248:251], v[232:235], v[32:47]
    v_cvt_pkrtz_f16_f32 v208, v176, v177
    v_cvt_pkrtz_f16_f32 v209, v178, v179
    v_cvt_pkrtz_f16_f32 v210, v180, v181
    v_cvt_pkrtz_f16_f32 v211, v182, v183
    v_cvt_pkrtz_f16_f32 v212, v184, v185
    v_cvt_pkrtz_f16_f32 v213, v186, v187
    v_cvt_pkrtz_f16_f32 v214, v188, v189
    v_cvt_pkrtz_f16_f32 v215, v190, v191
    v_pk_lshrrev_b16 v216, 3, v208 op_sel_hi:[0,1]
    v_pk_lshrrev_b16 v217, 3, v209 op_sel_hi:[0,1]
    s_waitcnt lgkmcnt(9)
    v_or_b32 v242, v226, v218
    v_pk_lshrrev_b16 v218, 3, v210 op_sel_hi:[0,1]
    v_mad_u32_u16 v224, v216, 2, s85
    v_mad_u32_u16 v216, v216, 2, s85 op_sel:[1,0,0,0]
    v_mad_u32_u16 v225, v217, 2, s85
    v_mad_u32_u16 v217, v217, 2, s85 op_sel:[1,0,0,0]
    v_mad_u32_u16 v226, v218, 2, s85
    v_mad_u32_u16 v218, v218, 2, s85 op_sel:[1,0,0,0]
    v_pk_fma_f16 v222, v214, v214, s53
    v_pk_fma_f16 v223, v215, v215, s53
    v_pk_mul_f16 v222, v222, v214 neg_lo:[1,0] neg_hi:[1,0]
    v_pk_mul_f16 v223, v223, v215 neg_lo:[1,0] neg_hi:[1,0]
    v_exp_f16 v230, v222
    v_exp_f16 v231, v223
    v_exp_f16_sdwa v230, v222 dst_sel:WORD_1 dst_unused:UNUSED_PRESERVE src0_sel:WORD_1
    s_waitcnt lgkmcnt(6)
    v_or_b32 v243, v227, v219
    v_pk_lshrrev_b16 v219, 3, v211 op_sel_hi:[0,1]
    v_mad_u32_u16 v227, v219, 2, s85
    v_mfma_f32_32x32x16_bf16 v[80:95], a[248:251], v[240:243], v[80:95]
    ds_read_b128 a[248:251], v24 offset:12288
    ds_read_u16 v224, v224
    v_mad_u32_u16 v219, v219, 2, s85 op_sel:[1,0,0,0]
    v_exp_f16_sdwa v231, v223 dst_sel:WORD_1 dst_unused:UNUSED_PRESERVE src0_sel:WORD_1
    v_pk_add_f16 v230, v230, 1.0 op_sel_hi:[1,0]
    v_mfma_f32_32x32x16_bf16 v[48:63], a[252:255], v[232:235], v[48:63]
    ds_read_u16_d16_hi v216, v216
    v_pk_add_f16 v231, v231, 1.0 op_sel_hi:[1,0]
    v_rcp_f16 v222, v230
    v_rcp_f16 v223, v231
    v_mfma_f32_32x32x16_bf16 v[96:111], a[252:255], v[240:243], v[96:111]
    s_waitcnt lgkmcnt(6)
    ds_read_b128 a[252:255], v24 offset:13312
    ds_read_u16 v225, v225
    v_or_b32 v244, v228, v220
    v_pk_lshrrev_b16 v220, 3, v212 op_sel_hi:[0,1]
    v_mad_u32_u16 v228, v220, 2, s85
    v_mad_u32_u16 v220, v220, 2, s85 op_sel:[1,0,0,0]
    v_mfma_f32_32x32x16_bf16 v[64:79], a[232:235], v[232:235], v[64:79]
    ds_read_u16_d16_hi v217, v217
    v_rcp_f16_sdwa v222, v230 dst_sel:WORD_1 dst_unused:UNUSED_PRESERVE src0_sel:WORD_1
    v_rcp_f16_sdwa v223, v231 dst_sel:WORD_1 dst_unused:UNUSED_PRESERVE src0_sel:WORD_1
    v_fma_mix_f32 v230, v222, v214, 0 op_sel_hi:[1,1,0]
    v_mfma_f32_32x32x16_bf16 v[112:127], a[232:235], v[240:243], v[112:127]
    s_waitcnt lgkmcnt(6)
    ds_read_b128 a[232:235], v24 offset:14336
    ds_read_u16 v226, v226
    v_or_b32 v245, v229, v221
    v_pk_lshrrev_b16 v221, 3, v213 op_sel_hi:[0,1]
    v_mad_u32_u16 v229, v221, 2, s85
    v_mad_u32_u16 v221, v221, 2, s85 op_sel:[1,0,0,0]
    v_mfma_f32_32x32x16_bf16 v[32:47], a[236:239], v[236:239], v[32:47]
    s_add_u32 m0, s56, 1024
    ds_read_u16_d16_hi v218, v218
    buffer_load_dwordx4 v2, s[20:23], 0 offen offset:0 lds
    v_fma_mix_f32 v231, v223, v215, 0 op_sel_hi:[1,1,0]
    v_fma_mix_f32 v222, v222, v214, 0 op_sel:[1,1,0] op_sel_hi:[1,1,0]
    v_fma_mix_f32 v223, v223, v215, 0 op_sel:[1,1,0] op_sel_hi:[1,1,0]
    v_mfma_f32_32x32x16_bf16 v[80:95], a[236:239], v[244:247], v[80:95]
    s_waitcnt lgkmcnt(7)
    ds_read_b128 a[236:239], v24 offset:15360
    ds_read_u16 v227, v227
    v_cvt_pkrtz_f16_f32 v208, v192, v193
    s_waitcnt lgkmcnt(8)
    v_or_b32 v232, v224, v216
    v_cvt_pkrtz_f16_f32 v209, v194, v195
    v_cvt_pkrtz_f16_f32 v210, v196, v197
    v_mfma_f32_32x32x16_bf16 v[48:63], a[240:243], v[236:239], v[48:63]
    ds_read_u16_d16_hi v219, v219
    v_cvt_pkrtz_f16_f32 v211, v198, v199
    v_cvt_pkrtz_f16_f32 v212, v200, v201
    v_cvt_pkrtz_f16_f32 v213, v202, v203
    v_cvt_pkrtz_f16_f32 v214, v204, v205
    v_cvt_pkrtz_f16_f32 v215, v206, v207
    v_mfma_f32_32x32x16_bf16 v[96:111], a[240:243], v[244:247], v[96:111]
    s_waitcnt lgkmcnt(7)
    ds_read_b128 a[240:243], v24 offset:16384
    ds_read_u16 v228, v228
    v_pk_lshrrev_b16 v216, 3, v208 op_sel_hi:[0,1]
    v_mad_u32_u16 v224, v216, 2, s85
    v_mad_u32_u16 v216, v216, 2, s85 op_sel:[1,0,0,0]
    s_waitcnt lgkmcnt(8)
    v_or_b32 v233, v225, v217
    v_mfma_f32_32x32x16_bf16 v[64:79], a[244:247], v[236:239], v[64:79]
    ds_read_u16_d16_hi v220, v220
    v_cvt_pk_bf16_f32 v238, v230, v222
    v_cvt_pk_bf16_f32 v239, v231, v223
    v_pk_lshrrev_b16 v217, 3, v209 op_sel_hi:[0,1]
    v_mad_u32_u16 v225, v217, 2, s85
    v_mad_u32_u16 v217, v217, 2, s85 op_sel:[1,0,0,0]
    v_mfma_f32_32x32x16_bf16 v[112:127], a[244:247], v[244:247], v[112:127]
    ds_read_b128 a[244:247], v24 offset:17408
    ds_read_u16 v229, v229
    ds_read_u16_d16_hi v221, v221
    v_pk_fma_f16 v222, v214, v214, s53
    v_pk_fma_f16 v223, v215, v215, s53
    v_pk_mul_f16 v222, v222, v214 neg_lo:[1,0] neg_hi:[1,0]
    v_mfma_f32_32x32x16_f16 v[176:191], a[248:251], v[128:131], 0
    s_waitcnt lgkmcnt(9)
    v_or_b32 v234, v226, v218
    v_pk_lshrrev_b16 v218, 3, v210 op_sel_hi:[0,1]
    v_mad_u32_u16 v226, v218, 2, s85
    v_mad_u32_u16 v218, v218, 2, s85 op_sel:[1,0,0,0]
    v_pk_mul_f16 v223, v223, v215 neg_lo:[1,0] neg_hi:[1,0]
    v_exp_f16 v230, v222
    v_mfma_f32_32x32x16_f16 v[192:207], a[248:251], v[152:155], 0
    ds_read_b128 a[248:251], v24 offset:6144
    ds_read_u16 v224, v224
    v_exp_f16 v231, v223
    v_exp_f16_sdwa v230, v222 dst_sel:WORD_1 dst_unused:UNUSED_PRESERVE src0_sel:WORD_1
    v_mfma_f32_32x32x16_f16 v[176:191], a[252:255], v[132:135], v[176:191]
    s_waitcnt lgkmcnt(8)
    ds_read_u16_d16_hi v216, v216
    v_or_b32 v235, v227, v219
    v_pk_lshrrev_b16 v219, 3, v211 op_sel_hi:[0,1]
    v_mad_u32_u16 v227, v219, 2, s85
    v_mad_u32_u16 v219, v219, 2, s85 op_sel:[1,0,0,0]
    v_exp_f16_sdwa v231, v223 dst_sel:WORD_1 dst_unused:UNUSED_PRESERVE src0_sel:WORD_1
    v_mfma_f32_32x32x16_f16 v[192:207], a[252:255], v[156:159], v[192:207]
    ds_read_b128 a[252:255], v24 offset:8192
    ds_read_u16 v225, v225
    v_pk_add_f16 v230, v230, 1.0 op_sel_hi:[1,0]
    v_pk_add_f16 v231, v231, 1.0 op_sel_hi:[1,0]
    v_rcp_f16 v222, v230
    v_mfma_f32_32x32x16_f16 v[176:191], a[232:235], v[136:139], v[176:191]
    s_waitcnt lgkmcnt(9)
    ds_read_u16_d16_hi v217, v217
    v_rcp_f16 v223, v231
    s_waitcnt lgkmcnt(9)
    v_or_b32 v236, v228, v220
    v_pk_lshrrev_b16 v220, 3, v212 op_sel_hi:[0,1]
    v_mad_u32_u16 v228, v220, 2, s85
    v_mfma_f32_32x32x16_f16 v[192:207], a[232:235], v[160:163], v[192:207]
    ds_read_b128 a[232:235], v24 offset:10240
    ds_read_u16 v226, v226
    v_mad_u32_u16 v220, v220, 2, s85 op_sel:[1,0,0,0]
    v_rcp_f16_sdwa v222, v230 dst_sel:WORD_1 dst_unused:UNUSED_PRESERVE src0_sel:WORD_1
    v_rcp_f16_sdwa v223, v231 dst_sel:WORD_1 dst_unused:UNUSED_PRESERVE src0_sel:WORD_1
    v_mfma_f32_32x32x16_f16 v[176:191], a[236:239], v[140:143], v[176:191]
    s_add_u32 m0, s56, 2048
    ds_read_u16_d16_hi v218, v218
    buffer_load_dwordx4 v3, s[20:23], 0 offen offset:0 lds
    v_fma_mix_f32 v230, v222, v214, 0 op_sel_hi:[1,1,0]
    s_waitcnt lgkmcnt(9)
    v_or_b32 v237, v229, v221
    v_pk_lshrrev_b16 v221, 3, v213 op_sel_hi:[0,1]
    v_mfma_f32_32x32x16_f16 v[192:207], a[236:239], v[164:167], v[192:207]
    ds_read_b128 a[236:239], v24 offset:7168
    ds_read_u16 v227, v227
    v_mad_u32_u16 v229, v221, 2, s85
    v_mad_u32_u16 v221, v221, 2, s85 op_sel:[1,0,0,0]
    v_fma_mix_f32 v231, v223, v215, 0 op_sel_hi:[1,1,0]
    v_fma_mix_f32 v222, v222, v214, 0 op_sel:[1,1,0] op_sel_hi:[1,1,0]
    v_mfma_f32_32x32x16_f16 v[176:191], a[240:243], v[144:147], v[176:191]
    ds_read_u16_d16_hi v219, v219
    v_fma_mix_f32 v223, v223, v215, 0 op_sel:[1,1,0] op_sel_hi:[1,1,0]
    v_cvt_pk_bf16_f32 v246, v230, v222
    v_cvt_pk_bf16_f32 v247, v231, v223
    v_mfma_f32_32x32x16_f16 v[192:207], a[240:243], v[168:171], v[192:207]
    s_waitcnt lgkmcnt(9)
    ds_read_b128 a[240:243], v24 offset:9216
    ds_read_u16 v228, v228
    v_or_b32 v240, v224, v216
    v_mfma_f32_32x32x16_f16 v[176:191], a[244:247], v[148:151], v[176:191]
    ds_read_u16_d16_hi v220, v220
    v_mfma_f32_32x32x16_f16 v[192:207], a[244:247], v[172:175], v[192:207]
    s_waitcnt lgkmcnt(9)
    ds_read_b128 a[244:247], v24 offset:11264
    ds_read_u16 v229, v229
    ds_read_u16_d16_hi v221, v221
    v_or_b32 v241, v225, v217
    v_mfma_f32_32x32x16_bf16 v[32:47], a[248:251], v[232:235], v[32:47]
    s_nop 3
    v_cvt_pkrtz_f16_f32 v208, v176, v177
    v_cvt_pkrtz_f16_f32 v209, v178, v179
    v_cvt_pkrtz_f16_f32 v210, v180, v181
    v_cvt_pkrtz_f16_f32 v211, v182, v183
    v_cvt_pkrtz_f16_f32 v212, v184, v185
    v_cvt_pkrtz_f16_f32 v213, v186, v187
    v_cvt_pkrtz_f16_f32 v214, v188, v189
    v_cvt_pkrtz_f16_f32 v215, v190, v191
    s_waitcnt lgkmcnt(9)
    v_or_b32 v242, v226, v218
    v_pk_lshrrev_b16 v216, 3, v208 op_sel_hi:[0,1]
    v_pk_lshrrev_b16 v217, 3, v209 op_sel_hi:[0,1]
    v_pk_lshrrev_b16 v218, 3, v210 op_sel_hi:[0,1]
    v_mad_u32_u16 v224, v216, 2, s85
    v_mad_u32_u16 v216, v216, 2, s85 op_sel:[1,0,0,0]
    v_mad_u32_u16 v225, v217, 2, s85
    v_mad_u32_u16 v217, v217, 2, s85 op_sel:[1,0,0,0]
    v_mad_u32_u16 v226, v218, 2, s85
    v_mad_u32_u16 v218, v218, 2, s85 op_sel:[1,0,0,0]
    v_pk_fma_f16 v222, v214, v214, s53
    v_pk_fma_f16 v223, v215, v215, s53
    v_pk_mul_f16 v222, v222, v214 neg_lo:[1,0] neg_hi:[1,0]
    v_pk_mul_f16 v223, v223, v215 neg_lo:[1,0] neg_hi:[1,0]
    v_exp_f16 v230, v222
    v_exp_f16 v231, v223
    s_waitcnt lgkmcnt(6)
    v_or_b32 v243, v227, v219
    v_pk_lshrrev_b16 v219, 3, v211 op_sel_hi:[0,1]
    v_mad_u32_u16 v227, v219, 2, s85
    v_mfma_f32_32x32x16_bf16 v[80:95], a[248:251], v[240:243], v[80:95]
    ds_read_b128 a[248:251], v24 offset:24576
    ds_read_u16 v224, v224
    v_mad_u32_u16 v219, v219, 2, s85 op_sel:[1,0,0,0]
    v_exp_f16_sdwa v230, v222 dst_sel:WORD_1 dst_unused:UNUSED_PRESERVE src0_sel:WORD_1
    v_exp_f16_sdwa v231, v223 dst_sel:WORD_1 dst_unused:UNUSED_PRESERVE src0_sel:WORD_1
    v_mfma_f32_32x32x16_bf16 v[48:63], a[252:255], v[232:235], v[48:63]
    s_waitcnt lgkmcnt(6)
    ds_read_u16_d16_hi v216, v216
    v_pk_add_f16 v230, v230, 1.0 op_sel_hi:[1,0]
    v_pk_add_f16 v231, v231, 1.0 op_sel_hi:[1,0]
    v_rcp_f16 v222, v230
    s_waitcnt lgkmcnt(6)
    v_or_b32 v244, v228, v220
    v_mfma_f32_32x32x16_bf16 v[96:111], a[252:255], v[240:243], v[96:111]
    ds_read_b128 a[252:255], v24 offset:25600
    ds_read_u16 v225, v225
    v_pk_lshrrev_b16 v220, 3, v212 op_sel_hi:[0,1]
    v_mad_u32_u16 v228, v220, 2, s85
    v_mad_u32_u16 v220, v220, 2, s85 op_sel:[1,0,0,0]
    v_rcp_f16 v223, v231
    v_mfma_f32_32x32x16_bf16 v[64:79], a[232:235], v[232:235], v[64:79]
    ds_read_u16_d16_hi v217, v217
    v_rcp_f16_sdwa v222, v230 dst_sel:WORD_1 dst_unused:UNUSED_PRESERVE src0_sel:WORD_1
    v_rcp_f16_sdwa v223, v231 dst_sel:WORD_1 dst_unused:UNUSED_PRESERVE src0_sel:WORD_1
    v_fma_mix_f32 v230, v222, v214, 0 op_sel_hi:[1,1,0]
    v_mfma_f32_32x32x16_bf16 v[112:127], a[232:235], v[240:243], v[112:127]
    s_waitcnt lgkmcnt(6)
    ds_read_b128 a[232:235], v24 offset:26624
    ds_read_u16 v226, v226
    v_or_b32 v245, v229, v221
    v_pk_lshrrev_b16 v221, 3, v213 op_sel_hi:[0,1]
    v_mad_u32_u16 v229, v221, 2, s85
    v_mad_u32_u16 v221, v221, 2, s85 op_sel:[1,0,0,0]
    v_mfma_f32_32x32x16_bf16 v[32:47], a[236:239], v[236:239], v[32:47]
    s_add_u32 m0, s56, 3072
    ds_read_u16_d16_hi v218, v218
    buffer_load_dwordx4 v4, s[20:23], 0 offen offset:0 lds
    v_fma_mix_f32 v231, v223, v215, 0 op_sel_hi:[1,1,0]
    v_fma_mix_f32 v222, v222, v214, 0 op_sel:[1,1,0] op_sel_hi:[1,1,0]
    v_fma_mix_f32 v223, v223, v215, 0 op_sel:[1,1,0] op_sel_hi:[1,1,0]
    v_mfma_f32_32x32x16_bf16 v[80:95], a[236:239], v[244:247], v[80:95]
    s_waitcnt lgkmcnt(6)
    ds_read_b128 a[236:239], v24 offset:27648
    ds_read_u16 v227, v227
    v_or_b32 v232, v224, v216
    v_cvt_pkrtz_f16_f32 v208, v192, v193
    v_cvt_pkrtz_f16_f32 v209, v194, v195
    v_cvt_pkrtz_f16_f32 v210, v196, v197
    v_mfma_f32_32x32x16_bf16 v[48:63], a[240:243], v[236:239], v[48:63]
    ds_read_u16_d16_hi v219, v219
    v_cvt_pkrtz_f16_f32 v211, v198, v199
    v_cvt_pkrtz_f16_f32 v212, v200, v201
    v_cvt_pkrtz_f16_f32 v213, v202, v203
    v_cvt_pkrtz_f16_f32 v214, v204, v205
    v_cvt_pkrtz_f16_f32 v215, v206, v207
    v_mfma_f32_32x32x16_bf16 v[96:111], a[240:243], v[244:247], v[96:111]
    s_waitcnt lgkmcnt(7)
    ds_read_b128 a[240:243], v24 offset:28672
    ds_read_u16 v228, v228
    v_pk_lshrrev_b16 v216, 3, v208 op_sel_hi:[0,1]
    s_waitcnt lgkmcnt(8)
    v_or_b32 v233, v225, v217
    v_pk_lshrrev_b16 v217, 3, v209 op_sel_hi:[0,1]
    v_mad_u32_u16 v224, v216, 2, s85
    v_mfma_f32_32x32x16_bf16 v[64:79], a[244:247], v[236:239], v[64:79]
    ds_read_u16_d16_hi v220, v220
    v_cvt_pk_bf16_f32 v238, v230, v222
    v_cvt_pk_bf16_f32 v239, v231, v223
    v_mad_u32_u16 v216, v216, 2, s85 op_sel:[1,0,0,0]
    v_mad_u32_u16 v225, v217, 2, s85
    v_mad_u32_u16 v217, v217, 2, s85 op_sel:[1,0,0,0]
    v_mfma_f32_32x32x16_bf16 v[112:127], a[244:247], v[244:247], v[112:127]
    ds_read_b128 a[244:247], v24 offset:29696
    ds_read_u16 v229, v229
    ds_read_u16_d16_hi v221, v221
    v_pk_fma_f16 v222, v214, v214, s53
    v_pk_fma_f16 v223, v215, v215, s53
    v_pk_mul_f16 v222, v222, v214 neg_lo:[1,0] neg_hi:[1,0]
    v_mfma_f32_32x32x16_f16 v[176:191], a[248:251], v[128:131], 0
    s_waitcnt lgkmcnt(9)
    v_or_b32 v234, v226, v218
    v_pk_lshrrev_b16 v218, 3, v210 op_sel_hi:[0,1]
    v_mad_u32_u16 v226, v218, 2, s85
    v_mad_u32_u16 v218, v218, 2, s85 op_sel:[1,0,0,0]
    v_pk_mul_f16 v223, v223, v215 neg_lo:[1,0] neg_hi:[1,0]
    v_exp_f16 v230, v222
    v_mfma_f32_32x32x16_f16 v[192:207], a[248:251], v[152:155], 0
    ds_read_b128 a[248:251], v24 offset:18432
    ds_read_u16 v224, v224
    v_exp_f16 v231, v223
    v_exp_f16_sdwa v230, v222 dst_sel:WORD_1 dst_unused:UNUSED_PRESERVE src0_sel:WORD_1
    v_mfma_f32_32x32x16_f16 v[176:191], a[252:255], v[132:135], v[176:191]
    s_waitcnt lgkmcnt(8)
    ds_read_u16_d16_hi v216, v216
    v_or_b32 v235, v227, v219
    v_pk_lshrrev_b16 v219, 3, v211 op_sel_hi:[0,1]
    v_mad_u32_u16 v227, v219, 2, s85
    v_mad_u32_u16 v219, v219, 2, s85 op_sel:[1,0,0,0]
    v_exp_f16_sdwa v231, v223 dst_sel:WORD_1 dst_unused:UNUSED_PRESERVE src0_sel:WORD_1
    v_mfma_f32_32x32x16_f16 v[192:207], a[252:255], v[156:159], v[192:207]
    ds_read_b128 a[252:255], v24 offset:20480
    ds_read_u16 v225, v225
    v_pk_add_f16 v230, v230, 1.0 op_sel_hi:[1,0]
    v_pk_add_f16 v231, v231, 1.0 op_sel_hi:[1,0]
    v_rcp_f16 v222, v230
    v_mfma_f32_32x32x16_f16 v[176:191], a[232:235], v[136:139], v[176:191]
    s_waitcnt lgkmcnt(8)
    ds_read_u16_d16_hi v217, v217
    v_or_b32 v236, v228, v220
    v_pk_lshrrev_b16 v220, 3, v212 op_sel_hi:[0,1]
    v_mad_u32_u16 v228, v220, 2, s85
    v_mad_u32_u16 v220, v220, 2, s85 op_sel:[1,0,0,0]
    v_rcp_f16 v223, v231
    v_mfma_f32_32x32x16_f16 v[192:207], a[232:235], v[160:163], v[192:207]
    ds_read_b128 a[232:235], v24 offset:22528
    ds_read_u16 v226, v226
    v_rcp_f16_sdwa v222, v230 dst_sel:WORD_1 dst_unused:UNUSED_PRESERVE src0_sel:WORD_1
    v_rcp_f16_sdwa v223, v231 dst_sel:WORD_1 dst_unused:UNUSED_PRESERVE src0_sel:WORD_1
    v_mfma_f32_32x32x16_f16 v[176:191], a[236:239], v[140:143], v[176:191]
    s_add_u32 m0, s56, 4096
    ds_read_u16_d16_hi v218, v218
    buffer_load_dwordx4 v5, s[20:23], 0 offen offset:0 lds
    s_waitcnt lgkmcnt(9)
    v_or_b32 v237, v229, v221
    v_pk_lshrrev_b16 v221, 3, v213 op_sel_hi:[0,1]
    v_mad_u32_u16 v229, v221, 2, s85
    v_mfma_f32_32x32x16_f16 v[192:207], a[236:239], v[164:167], v[192:207]
    ds_read_b128 a[236:239], v24 offset:19456
    ds_read_u16 v227, v227
    v_mad_u32_u16 v221, v221, 2, s85 op_sel:[1,0,0,0]
    v_fma_mix_f32 v230, v222, v214, 0 op_sel_hi:[1,1,0]
    v_fma_mix_f32 v231, v223, v215, 0 op_sel_hi:[1,1,0]
    v_fma_mix_f32 v222, v222, v214, 0 op_sel:[1,1,0] op_sel_hi:[1,1,0]
    v_mfma_f32_32x32x16_f16 v[176:191], a[240:243], v[144:147], v[176:191]
    s_waitcnt lgkmcnt(9)
    ds_read_u16_d16_hi v219, v219
    v_fma_mix_f32 v223, v223, v215, 0 op_sel:[1,1,0] op_sel_hi:[1,1,0]
    v_cvt_pk_bf16_f32 v246, v230, v222
    v_cvt_pk_bf16_f32 v247, v231, v223
    s_waitcnt lgkmcnt(9)
    v_or_b32 v240, v224, v216
    v_mfma_f32_32x32x16_f16 v[192:207], a[240:243], v[168:171], v[192:207]
    ds_read_b128 a[240:243], v24 offset:21504
    ds_read_u16 v228, v228
    v_mfma_f32_32x32x16_f16 v[176:191], a[244:247], v[148:151], v[176:191]
    ds_read_u16_d16_hi v220, v220
    v_mfma_f32_32x32x16_f16 v[192:207], a[244:247], v[172:175], v[192:207]
    s_waitcnt lgkmcnt(9)
    ds_read_b128 a[244:247], v24 offset:23552
    ds_read_u16 v229, v229
    ds_read_u16_d16_hi v221, v221
    v_or_b32 v241, v225, v217
    v_mfma_f32_32x32x16_bf16 v[32:47], a[248:251], v[232:235], v[32:47]
    s_nop 3
    v_cvt_pkrtz_f16_f32 v208, v176, v177
    v_cvt_pkrtz_f16_f32 v209, v178, v179
    v_cvt_pkrtz_f16_f32 v210, v180, v181
    v_cvt_pkrtz_f16_f32 v211, v182, v183
    v_cvt_pkrtz_f16_f32 v212, v184, v185
    v_cvt_pkrtz_f16_f32 v213, v186, v187
    s_waitcnt lgkmcnt(9)
    v_or_b32 v242, v226, v218
    v_cvt_pkrtz_f16_f32 v214, v188, v189
    v_cvt_pkrtz_f16_f32 v215, v190, v191
    v_pk_lshrrev_b16 v216, 3, v208 op_sel_hi:[0,1]
    v_pk_lshrrev_b16 v217, 3, v209 op_sel_hi:[0,1]
    v_pk_lshrrev_b16 v218, 3, v210 op_sel_hi:[0,1]
    v_mad_u32_u16 v224, v216, 2, s85
    v_mad_u32_u16 v216, v216, 2, s85 op_sel:[1,0,0,0]
    v_mad_u32_u16 v225, v217, 2, s85
    v_mad_u32_u16 v217, v217, 2, s85 op_sel:[1,0,0,0]
    v_mad_u32_u16 v226, v218, 2, s85
    v_mad_u32_u16 v218, v218, 2, s85 op_sel:[1,0,0,0]
    v_pk_fma_f16 v222, v214, v214, s53
    v_pk_fma_f16 v223, v215, v215, s53
    v_pk_mul_f16 v222, v222, v214 neg_lo:[1,0] neg_hi:[1,0]
    v_pk_mul_f16 v223, v223, v215 neg_lo:[1,0] neg_hi:[1,0]
    v_exp_f16 v230, v222
    s_waitcnt lgkmcnt(6)
    v_or_b32 v243, v227, v219
    v_pk_lshrrev_b16 v219, 3, v211 op_sel_hi:[0,1]
    v_mad_u32_u16 v227, v219, 2, s85
    v_mfma_f32_32x32x16_bf16 v[80:95], a[248:251], v[240:243], v[80:95]
    ds_read_b128 a[248:251], v24 offset:36864
    ds_read_u16 v224, v224
    v_mad_u32_u16 v219, v219, 2, s85 op_sel:[1,0,0,0]
    v_exp_f16 v231, v223
    v_exp_f16_sdwa v230, v222 dst_sel:WORD_1 dst_unused:UNUSED_PRESERVE src0_sel:WORD_1
    v_mfma_f32_32x32x16_bf16 v[48:63], a[252:255], v[232:235], v[48:63]
    s_waitcnt lgkmcnt(6)
    ds_read_u16_d16_hi v216, v216
    v_exp_f16_sdwa v231, v223 dst_sel:WORD_1 dst_unused:UNUSED_PRESERVE src0_sel:WORD_1
    v_pk_add_f16 v230, v230, 1.0 op_sel_hi:[1,0]
    v_pk_add_f16 v231, v231, 1.0 op_sel_hi:[1,0]
    s_waitcnt lgkmcnt(6)
    v_or_b32 v244, v228, v220
    v_mfma_f32_32x32x16_bf16 v[96:111], a[252:255], v[240:243], v[96:111]
    ds_read_b128 a[252:255], v24 offset:37888
    ds_read_u16 v225, v225
    v_pk_lshrrev_b16 v220, 3, v212 op_sel_hi:[0,1]
    v_mad_u32_u16 v228, v220, 2, s85
    v_mad_u32_u16 v220, v220, 2, s85 op_sel:[1,0,0,0]
    v_rcp_f16 v222, v230
    v_mfma_f32_32x32x16_bf16 v[64:79], a[232:235], v[232:235], v[64:79]
    ds_read_u16_d16_hi v217, v217
    v_rcp_f16 v223, v231
    v_rcp_f16_sdwa v222, v230 dst_sel:WORD_1 dst_unused:UNUSED_PRESERVE src0_sel:WORD_1
    v_rcp_f16_sdwa v223, v231 dst_sel:WORD_1 dst_unused:UNUSED_PRESERVE src0_sel:WORD_1
    v_mfma_f32_32x32x16_bf16 v[112:127], a[232:235], v[240:243], v[112:127]
    s_waitcnt lgkmcnt(6)
    ds_read_b128 a[232:235], v24 offset:38912
    ds_read_u16 v226, v226
    v_or_b32 v245, v229, v221
    v_pk_lshrrev_b16 v221, 3, v213 op_sel_hi:[0,1]
    v_mad_u32_u16 v229, v221, 2, s85
    v_mad_u32_u16 v221, v221, 2, s85 op_sel:[1,0,0,0]
    v_mfma_f32_32x32x16_bf16 v[32:47], a[236:239], v[236:239], v[32:47]
    s_add_u32 m0, s56, 5120
    ds_read_u16_d16_hi v218, v218
    buffer_load_dwordx4 v6, s[20:23], 0 offen offset:0 lds
    v_fma_mix_f32 v230, v222, v214, 0 op_sel_hi:[1,1,0]
    v_fma_mix_f32 v231, v223, v215, 0 op_sel_hi:[1,1,0]
    v_fma_mix_f32 v222, v222, v214, 0 op_sel:[1,1,0] op_sel_hi:[1,1,0]
    v_mfma_f32_32x32x16_bf16 v[80:95], a[236:239], v[244:247], v[80:95]
    s_waitcnt lgkmcnt(6)
    ds_read_b128 a[236:239], v24 offset:39936
    ds_read_u16 v227, v227
    v_fma_mix_f32 v223, v223, v215, 0 op_sel:[1,1,0] op_sel_hi:[1,1,0]
    v_or_b32 v232, v224, v216
    v_cvt_pkrtz_f16_f32 v208, v192, v193
    v_cvt_pkrtz_f16_f32 v209, v194, v195
    v_mfma_f32_32x32x16_bf16 v[48:63], a[240:243], v[236:239], v[48:63]
    ds_read_u16_d16_hi v219, v219
    v_cvt_pkrtz_f16_f32 v210, v196, v197
    v_cvt_pkrtz_f16_f32 v211, v198, v199
    v_cvt_pkrtz_f16_f32 v212, v200, v201
    v_cvt_pkrtz_f16_f32 v213, v202, v203
    v_cvt_pkrtz_f16_f32 v214, v204, v205
    v_mfma_f32_32x32x16_bf16 v[96:111], a[240:243], v[244:247], v[96:111]
    s_waitcnt lgkmcnt(7)
    ds_read_b128 a[240:243], v24 offset:40960
    ds_read_u16 v228, v228
    s_waitcnt lgkmcnt(8)
    v_or_b32 v233, v225, v217
    v_cvt_pkrtz_f16_f32 v215, v206, v207
    v_pk_lshrrev_b16 v216, 3, v208 op_sel_hi:[0,1]
    v_pk_lshrrev_b16 v217, 3, v209 op_sel_hi:[0,1]
    v_mfma_f32_32x32x16_bf16 v[64:79], a[244:247], v[236:239], v[64:79]
    ds_read_u16_d16_hi v220, v220
    v_cvt_pk_bf16_f32 v238, v230, v222
    v_cvt_pk_bf16_f32 v239, v231, v223
    v_mad_u32_u16 v224, v216, 2, s85
    v_mad_u32_u16 v216, v216, 2, s85 op_sel:[1,0,0,0]
    v_mad_u32_u16 v225, v217, 2, s85
    v_mfma_f32_32x32x16_bf16 v[112:127], a[244:247], v[244:247], v[112:127]
    s_waitcnt lgkmcnt(7)
    ds_read_b128 a[244:247], v24 offset:41984
    ds_read_u16 v229, v229
    ds_read_u16_d16_hi v221, v221
    v_mad_u32_u16 v217, v217, 2, s85 op_sel:[1,0,0,0]
    v_pk_fma_f16 v222, v214, v214, s53
    s_waitcnt lgkmcnt(9)
    v_or_b32 v234, v226, v218
    v_mfma_f32_32x32x16_f16 v[176:191], a[248:251], v[128:131], 0
    v_pk_lshrrev_b16 v218, 3, v210 op_sel_hi:[0,1]
    v_mad_u32_u16 v226, v218, 2, s85
    v_mad_u32_u16 v218, v218, 2, s85 op_sel:[1,0,0,0]
    v_pk_fma_f16 v223, v215, v215, s53
    v_pk_mul_f16 v222, v222, v214 neg_lo:[1,0] neg_hi:[1,0]
    v_pk_mul_f16 v223, v223, v215 neg_lo:[1,0] neg_hi:[1,0]
    v_mfma_f32_32x32x16_f16 v[192:207], a[248:251], v[152:155], 0
    ds_read_b128 a[248:251], v24 offset:30720
    ds_read_u16 v224, v224
    v_exp_f16 v230, v222
    v_exp_f16 v231, v223
    v_mfma_f32_32x32x16_f16 v[176:191], a[252:255], v[132:135], v[176:191]
    s_waitcnt lgkmcnt(8)
    ds_read_u16_d16_hi v216, v216
    v_or_b32 v235, v227, v219
    v_pk_lshrrev_b16 v219, 3, v211 op_sel_hi:[0,1]
    v_mad_u32_u16 v227, v219, 2, s85
    v_mad_u32_u16 v219, v219, 2, s85 op_sel:[1,0,0,0]
    v_exp_f16_sdwa v230, v222 dst_sel:WORD_1 dst_unused:UNUSED_PRESERVE src0_sel:WORD_1
    v_mfma_f32_32x32x16_f16 v[192:207], a[252:255], v[156:159], v[192:207]
    ds_read_b128 a[252:255], v24 offset:32768
    ds_read_u16 v225, v225
    v_exp_f16_sdwa v231, v223 dst_sel:WORD_1 dst_unused:UNUSED_PRESERVE src0_sel:WORD_1
    v_pk_add_f16 v230, v230, 1.0 op_sel_hi:[1,0]
    v_pk_add_f16 v231, v231, 1.0 op_sel_hi:[1,0]
    v_mfma_f32_32x32x16_f16 v[176:191], a[232:235], v[136:139], v[176:191]
    s_waitcnt lgkmcnt(8)
    ds_read_u16_d16_hi v217, v217
    v_or_b32 v236, v228, v220
    v_pk_lshrrev_b16 v220, 3, v212 op_sel_hi:[0,1]
    v_mad_u32_u16 v228, v220, 2, s85
    v_mad_u32_u16 v220, v220, 2, s85 op_sel:[1,0,0,0]
    v_rcp_f16 v222, v230
    v_mfma_f32_32x32x16_f16 v[192:207], a[232:235], v[160:163], v[192:207]
    ds_read_b128 a[232:235], v24 offset:34816
    ds_read_u16 v226, v226
    v_rcp_f16 v223, v231
    v_rcp_f16_sdwa v222, v230 dst_sel:WORD_1 dst_unused:UNUSED_PRESERVE src0_sel:WORD_1
    v_mfma_f32_32x32x16_f16 v[176:191], a[236:239], v[140:143], v[176:191]
    s_add_u32 m0, s56, 6144
    ds_read_u16_d16_hi v218, v218
    buffer_load_dword v7, s[20:23], 0 offen offset:0 lds
    s_waitcnt lgkmcnt(9)
    v_or_b32 v237, v229, v221
    v_pk_lshrrev_b16 v221, 3, v213 op_sel_hi:[0,1]
    v_mad_u32_u16 v229, v221, 2, s85
    v_mfma_f32_32x32x16_f16 v[192:207], a[236:239], v[164:167], v[192:207]
    ds_read_b128 a[236:239], v24 offset:31744
    ds_read_u16 v227, v227
    v_mad_u32_u16 v221, v221, 2, s85 op_sel:[1,0,0,0]
    v_rcp_f16_sdwa v223, v231 dst_sel:WORD_1 dst_unused:UNUSED_PRESERVE src0_sel:WORD_1
    v_fma_mix_f32 v230, v222, v214, 0 op_sel_hi:[1,1,0]
    v_mfma_f32_32x32x16_f16 v[176:191], a[240:243], v[144:147], v[176:191]
    s_waitcnt lgkmcnt(9)
    ds_read_u16_d16_hi v219, v219
    v_fma_mix_f32 v231, v223, v215, 0 op_sel_hi:[1,1,0]
    v_fma_mix_f32 v222, v222, v214, 0 op_sel:[1,1,0] op_sel_hi:[1,1,0]
    v_fma_mix_f32 v223, v223, v215, 0 op_sel:[1,1,0] op_sel_hi:[1,1,0]
    v_cvt_pk_bf16_f32 v246, v230, v222
    s_waitcnt lgkmcnt(9)
    v_or_b32 v240, v224, v216
    v_mfma_f32_32x32x16_f16 v[192:207], a[240:243], v[168:171], v[192:207]
    ds_read_b128 a[240:243], v24 offset:33792
    ds_read_u16 v228, v228
    v_cvt_pk_bf16_f32 v247, v231, v223
    v_mfma_f32_32x32x16_f16 v[176:191], a[244:247], v[148:151], v[176:191]
    ds_read_u16_d16_hi v220, v220
    v_mfma_f32_32x32x16_f16 v[192:207], a[244:247], v[172:175], v[192:207]
    s_waitcnt lgkmcnt(9)
    ds_read_b128 a[244:247], v24 offset:35840
    ds_read_u16 v229, v229
    ds_read_u16_d16_hi v221, v221
    v_or_b32 v241, v225, v217
    v_mfma_f32_32x32x16_bf16 v[32:47], a[248:251], v[232:235], v[32:47]
    s_nop 3
    v_cvt_pkrtz_f16_f32 v208, v176, v177
    v_cvt_pkrtz_f16_f32 v209, v178, v179
    v_cvt_pkrtz_f16_f32 v210, v180, v181
    v_cvt_pkrtz_f16_f32 v211, v182, v183
    v_cvt_pkrtz_f16_f32 v212, v184, v185
    v_cvt_pkrtz_f16_f32 v213, v186, v187
    s_waitcnt lgkmcnt(9)
    v_or_b32 v242, v226, v218
    v_cvt_pkrtz_f16_f32 v214, v188, v189
    v_cvt_pkrtz_f16_f32 v215, v190, v191
    v_pk_lshrrev_b16 v216, 3, v208 op_sel_hi:[0,1]
    v_pk_lshrrev_b16 v217, 3, v209 op_sel_hi:[0,1]
    v_pk_lshrrev_b16 v218, 3, v210 op_sel_hi:[0,1]
    v_mad_u32_u16 v224, v216, 2, s85
    v_mad_u32_u16 v216, v216, 2, s85 op_sel:[1,0,0,0]
    v_mad_u32_u16 v225, v217, 2, s85
    v_mad_u32_u16 v217, v217, 2, s85 op_sel:[1,0,0,0]
    v_mad_u32_u16 v226, v218, 2, s85
    v_mad_u32_u16 v218, v218, 2, s85 op_sel:[1,0,0,0]
    v_pk_fma_f16 v222, v214, v214, s53
    v_pk_fma_f16 v223, v215, v215, s53
    v_pk_mul_f16 v222, v222, v214 neg_lo:[1,0] neg_hi:[1,0]
    v_pk_mul_f16 v223, v223, v215 neg_lo:[1,0] neg_hi:[1,0]
    v_exp_f16 v230, v222
    s_waitcnt lgkmcnt(6)
    v_or_b32 v243, v227, v219
    v_pk_lshrrev_b16 v219, 3, v211 op_sel_hi:[0,1]
    v_mad_u32_u16 v227, v219, 2, s85
    v_mfma_f32_32x32x16_bf16 v[80:95], a[248:251], v[240:243], v[80:95]
    ds_read_b128 a[248:251], v24 offset:43008
    ds_read_u16 v224, v224
    v_mad_u32_u16 v219, v219, 2, s85 op_sel:[1,0,0,0]
    v_exp_f16 v231, v223
    v_exp_f16_sdwa v230, v222 dst_sel:WORD_1 dst_unused:UNUSED_PRESERVE src0_sel:WORD_1
    v_mfma_f32_32x32x16_bf16 v[48:63], a[252:255], v[232:235], v[48:63]
    s_waitcnt lgkmcnt(6)
    ds_read_u16_d16_hi v216, v216
    v_exp_f16_sdwa v231, v223 dst_sel:WORD_1 dst_unused:UNUSED_PRESERVE src0_sel:WORD_1
    v_pk_add_f16 v230, v230, 1.0 op_sel_hi:[1,0]
    v_pk_add_f16 v231, v231, 1.0 op_sel_hi:[1,0]
    s_waitcnt lgkmcnt(6)
    v_or_b32 v244, v228, v220
    v_mfma_f32_32x32x16_bf16 v[96:111], a[252:255], v[240:243], v[96:111]
    ds_read_b128 a[252:255], v24 offset:45056
    ds_read_u16 v225, v225
    v_pk_lshrrev_b16 v220, 3, v212 op_sel_hi:[0,1]
    v_mad_u32_u16 v228, v220, 2, s85
    v_mad_u32_u16 v220, v220, 2, s85 op_sel:[1,0,0,0]
    v_rcp_f16 v222, v230
    v_mfma_f32_32x32x16_bf16 v[64:79], a[232:235], v[232:235], v[64:79]
    ds_read_u16_d16_hi v217, v217
    v_rcp_f16 v223, v231
    v_rcp_f16_sdwa v222, v230 dst_sel:WORD_1 dst_unused:UNUSED_PRESERVE src0_sel:WORD_1
    v_rcp_f16_sdwa v223, v231 dst_sel:WORD_1 dst_unused:UNUSED_PRESERVE src0_sel:WORD_1
    v_mfma_f32_32x32x16_bf16 v[112:127], a[232:235], v[240:243], v[112:127]
    s_waitcnt lgkmcnt(6)
    ds_read_b128 a[232:235], v24 offset:47104
    ds_read_u16 v226, v226
    v_or_b32 v245, v229, v221
    v_pk_lshrrev_b16 v221, 3, v213 op_sel_hi:[0,1]
    v_mad_u32_u16 v229, v221, 2, s85
    v_mad_u32_u16 v221, v221, 2, s85 op_sel:[1,0,0,0]
    v_mfma_f32_32x32x16_bf16 v[32:47], a[236:239], v[236:239], v[32:47]
    ds_read_u16_d16_hi v218, v218
    buffer_load_dword v254, v31, s[20:23], 0 offen
    v_fma_mix_f32 v230, v222, v214, 0 op_sel_hi:[1,1,0]
    v_fma_mix_f32 v231, v223, v215, 0 op_sel_hi:[1,1,0]
    v_fma_mix_f32 v222, v222, v214, 0 op_sel:[1,1,0] op_sel_hi:[1,1,0]
    v_fma_mix_f32 v223, v223, v215, 0 op_sel:[1,1,0] op_sel_hi:[1,1,0]
    v_mfma_f32_32x32x16_bf16 v[80:95], a[236:239], v[244:247], v[80:95]
    s_waitcnt lgkmcnt(6)
    ds_read_b128 a[236:239], v24 offset:44032
    ds_read_u16 v227, v227
    v_or_b32 v232, v224, v216
    v_cvt_pkrtz_f16_f32 v208, v192, v193
    v_cvt_pkrtz_f16_f32 v209, v194, v195
    v_cvt_pkrtz_f16_f32 v210, v196, v197
    v_mfma_f32_32x32x16_bf16 v[48:63], a[240:243], v[236:239], v[48:63]
    ds_read_u16_d16_hi v219, v219
    v_cvt_pkrtz_f16_f32 v211, v198, v199
    v_cvt_pkrtz_f16_f32 v212, v200, v201
    v_cvt_pkrtz_f16_f32 v213, v202, v203
    v_cvt_pkrtz_f16_f32 v214, v204, v205
    v_cvt_pkrtz_f16_f32 v215, v206, v207
    v_mfma_f32_32x32x16_bf16 v[96:111], a[240:243], v[244:247], v[96:111]
    s_waitcnt lgkmcnt(7)
    ds_read_b128 a[240:243], v24 offset:46080
    ds_read_u16 v228, v228
    s_waitcnt lgkmcnt(8)
    v_or_b32 v233, v225, v217
    v_pk_lshrrev_b16 v216, 3, v208 op_sel_hi:[0,1]
    v_pk_lshrrev_b16 v217, 3, v209 op_sel_hi:[0,1]
    v_mad_u32_u16 v224, v216, 2, s85
    v_mfma_f32_32x32x16_bf16 v[64:79], a[244:247], v[236:239], v[64:79]
    ds_read_u16_d16_hi v220, v220
    v_cvt_pk_bf16_f32 v238, v230, v222
    v_cvt_pk_bf16_f32 v239, v231, v223
    v_mad_u32_u16 v216, v216, 2, s85 op_sel:[1,0,0,0]
    v_mad_u32_u16 v225, v217, 2, s85
    v_mad_u32_u16 v217, v217, 2, s85 op_sel:[1,0,0,0]
    v_mfma_f32_32x32x16_bf16 v[112:127], a[244:247], v[244:247], v[112:127]
    s_waitcnt lgkmcnt(7)
    ds_read_b128 a[244:247], v24 offset:48128
    ds_read_u16 v229, v229
    ds_read_u16_d16_hi v221, v221
    v_pk_fma_f16 v222, v214, v214, s53
    v_pk_fma_f16 v223, v215, v215, s53
    s_waitcnt lgkmcnt(9)
    v_or_b32 v234, v226, v218
    v_pk_lshrrev_b16 v218, 3, v210 op_sel_hi:[0,1]
    v_mad_u32_u16 v226, v218, 2, s85
    v_mad_u32_u16 v218, v218, 2, s85 op_sel:[1,0,0,0]
    v_pk_mul_f16 v222, v222, v214 neg_lo:[1,0] neg_hi:[1,0]
    v_pk_mul_f16 v223, v223, v215 neg_lo:[1,0] neg_hi:[1,0]
    v_exp_f16 v230, v222
    v_exp_f16 v231, v223
    v_exp_f16_sdwa v230, v222 dst_sel:WORD_1 dst_unused:UNUSED_PRESERVE src0_sel:WORD_1
    v_exp_f16_sdwa v231, v223 dst_sel:WORD_1 dst_unused:UNUSED_PRESERVE src0_sel:WORD_1
    v_pk_add_f16 v230, v230, 1.0 op_sel_hi:[1,0]
    v_pk_add_f16 v231, v231, 1.0 op_sel_hi:[1,0]
    v_rcp_f16 v222, v230
    s_waitcnt lgkmcnt(6)
    v_or_b32 v235, v227, v219
    v_pk_lshrrev_b16 v219, 3, v211 op_sel_hi:[0,1]
    v_mad_u32_u16 v227, v219, 2, s85
    v_mfma_f32_32x32x16_bf16 v[32:47], a[248:251], v[232:235], v[32:47]
    v_mad_u32_u16 v219, v219, 2, s85 op_sel:[1,0,0,0]
    v_rcp_f16 v223, v231
    v_rcp_f16_sdwa v222, v230 dst_sel:WORD_1 dst_unused:UNUSED_PRESERVE src0_sel:WORD_1
    v_rcp_f16_sdwa v223, v231 dst_sel:WORD_1 dst_unused:UNUSED_PRESERVE src0_sel:WORD_1
    v_mfma_f32_32x32x16_f16 v[176:191], a[0:3], v[128:131], 0
    s_waitcnt lgkmcnt(4)
    ds_read_u16 v224, v224
    v_fma_mix_f32 v230, v222, v214, 0 op_sel_hi:[1,1,0]
    v_fma_mix_f32 v231, v223, v215, 0 op_sel_hi:[1,1,0]
    v_fma_mix_f32 v222, v222, v214, 0 op_sel:[1,1,0] op_sel_hi:[1,1,0]
    v_fma_mix_f32 v223, v223, v215, 0 op_sel:[1,1,0] op_sel_hi:[1,1,0]
    s_waitcnt lgkmcnt(4)
    v_or_b32 v236, v228, v220
    v_mfma_f32_32x32x16_bf16 v[48:63], a[252:255], v[232:235], v[48:63]
    ds_read_u16_d16_hi v216, v216
    v_pk_lshrrev_b16 v220, 3, v212 op_sel_hi:[0,1]
    v_mad_u32_u16 v228, v220, 2, s85
    v_mad_u32_u16 v220, v220, 2, s85 op_sel:[1,0,0,0]
    v_cvt_pk_bf16_f32 v246, v230, v222
    v_cvt_pk_bf16_f32 v247, v231, v223
    v_mfma_f32_32x32x16_f16 v[176:191], a[4:7], v[132:135], v[176:191]
    ds_read_u16 v225, v225
    v_mfma_f32_32x32x16_bf16 v[64:79], a[232:235], v[232:235], v[64:79]
    s_waitcnt lgkmcnt(3)
    ds_read_u16_d16_hi v217, v217
    v_or_b32 v237, v229, v221
    v_pk_lshrrev_b16 v221, 3, v213 op_sel_hi:[0,1]
    v_mad_u32_u16 v229, v221, 2, s85
    v_mad_u32_u16 v221, v221, 2, s85 op_sel:[1,0,0,0]
    v_mfma_f32_32x32x16_f16 v[176:191], a[8:11], v[136:139], v[176:191]
    s_waitcnt lgkmcnt(3)
    ds_read_u16 v226, v226
    s_waitcnt lgkmcnt(3)
    v_or_b32 v240, v224, v216
    v_mfma_f32_32x32x16_bf16 v[32:47], a[236:239], v[236:239], v[32:47]
    ds_read_u16_d16_hi v218, v218
    v_mfma_f32_32x32x16_f16 v[176:191], a[12:15], v[140:143], v[176:191]
    s_waitcnt lgkmcnt(3)
    ds_read_u16 v227, v227
    s_waitcnt lgkmcnt(3)
    v_or_b32 v241, v225, v217
    v_mfma_f32_32x32x16_f16 v[176:191], a[16:19], v[144:147], v[176:191]
    ds_read_u16_d16_hi v219, v219
    v_mfma_f32_32x32x16_f16 v[176:191], a[20:23], v[148:151], v[176:191]
    s_waitcnt lgkmcnt(3)
    ds_read_u16 v228, v228
    s_waitcnt lgkmcnt(3)
    v_or_b32 v242, v226, v218
    v_mfma_f32_32x32x16_bf16 v[48:63], a[240:243], v[236:239], v[48:63]
    ds_read_u16_d16_hi v220, v220
    v_mfma_f32_32x32x16_bf16 v[64:79], a[244:247], v[236:239], v[64:79]
    s_waitcnt lgkmcnt(2)
    ds_read_u16 v229, v229
    ds_read_u16_d16_hi v221, v221
    v_or_b32 v243, v227, v219
    s_nop 1
    v_mfma_f32_32x32x16_bf16 v[80:95], a[248:251], v[240:243], v[80:95]
    s_waitcnt lgkmcnt(3)
    v_cvt_pkrtz_f16_f32 v208, v176, v177
    v_cvt_pkrtz_f16_f32 v209, v178, v179
    v_cvt_pkrtz_f16_f32 v210, v180, v181
    v_cvt_pkrtz_f16_f32 v211, v182, v183
    v_cvt_pkrtz_f16_f32 v212, v184, v185
    v_cvt_pkrtz_f16_f32 v213, v186, v187
    v_cvt_pkrtz_f16_f32 v214, v188, v189
    s_waitcnt lgkmcnt(2)
    v_or_b32 v244, v228, v220
    v_cvt_pkrtz_f16_f32 v215, v190, v191
    v_mfma_f32_32x32x16_f16 v[176:191], a[48:51], v[128:131], 0
    v_pk_lshrrev_b16 v216, 3, v208 op_sel_hi:[0,1]
    v_pk_lshrrev_b16 v217, 3, v209 op_sel_hi:[0,1]
    v_pk_lshrrev_b16 v218, 3, v210 op_sel_hi:[0,1]
    v_pk_lshrrev_b16 v219, 3, v211 op_sel_hi:[0,1]
    v_pk_lshrrev_b16 v220, 3, v212 op_sel_hi:[0,1]
    v_mad_u32_u16 v224, v216, 2, s85
    v_mfma_f32_32x32x16_bf16 v[96:111], a[252:255], v[240:243], v[96:111]
    s_waitcnt lgkmcnt(1)
    ds_read_u16 v224, v224
    v_mad_u32_u16 v216, v216, 2, s85 op_sel:[1,0,0,0]
    v_mad_u32_u16 v225, v217, 2, s85
    s_waitcnt lgkmcnt(1)
    v_or_b32 v245, v229, v221
    v_pk_lshrrev_b16 v221, 3, v213 op_sel_hi:[0,1]
    v_mad_u32_u16 v217, v217, 2, s85 op_sel:[1,0,0,0]
    v_mfma_f32_32x32x16_f16 v[176:191], a[52:55], v[132:135], v[176:191]
    ds_read_u16_d16_hi v216, v216
    ds_read_u16 v225, v225
    v_mad_u32_u16 v226, v218, 2, s85
    v_mad_u32_u16 v218, v218, 2, s85 op_sel:[1,0,0,0]
    v_mad_u32_u16 v227, v219, 2, s85
    v_mad_u32_u16 v219, v219, 2, s85 op_sel:[1,0,0,0]
    v_mfma_f32_32x32x16_bf16 v[112:127], a[232:235], v[240:243], v[112:127]
    ds_read_u16_d16_hi v217, v217
    v_mad_u32_u16 v228, v220, 2, s85
    v_mad_u32_u16 v220, v220, 2, s85 op_sel:[1,0,0,0]
    v_mad_u32_u16 v229, v221, 2, s85
    v_mad_u32_u16 v221, v221, 2, s85 op_sel:[1,0,0,0]
    v_pk_fma_f16 v222, v214, v214, s53
    v_mfma_f32_32x32x16_f16 v[176:191], a[56:59], v[136:139], v[176:191]
    ds_read_u16 v226, v226
    v_pk_fma_f16 v223, v215, v215, s53
    v_pk_mul_f16 v222, v222, v214 neg_lo:[1,0] neg_hi:[1,0]
    v_pk_mul_f16 v223, v223, v215 neg_lo:[1,0] neg_hi:[1,0]
    v_exp_f16 v230, v222
    v_mfma_f32_32x32x16_bf16 v[80:95], a[236:239], v[244:247], v[80:95]
    ds_read_u16_d16_hi v218, v218
    v_exp_f16 v231, v223
    v_exp_f16_sdwa v230, v222 dst_sel:WORD_1 dst_unused:UNUSED_PRESERVE src0_sel:WORD_1
    v_exp_f16_sdwa v231, v223 dst_sel:WORD_1 dst_unused:UNUSED_PRESERVE src0_sel:WORD_1
    v_mfma_f32_32x32x16_f16 v[176:191], a[60:63], v[140:143], v[176:191]
    ds_read_u16 v227, v227
    v_pk_add_f16 v230, v230, 1.0 op_sel_hi:[1,0]
    v_pk_add_f16 v231, v231, 1.0 op_sel_hi:[1,0]
    v_rcp_f16 v222, v230
    v_rcp_f16 v223, v231
    v_mfma_f32_32x32x16_f16 v[176:191], a[64:67], v[144:147], v[176:191]
    ds_read_u16_d16_hi v219, v219
    v_rcp_f16_sdwa v222, v230 dst_sel:WORD_1 dst_unused:UNUSED_PRESERVE src0_sel:WORD_1
    v_rcp_f16_sdwa v223, v231 dst_sel:WORD_1 dst_unused:UNUSED_PRESERVE src0_sel:WORD_1
    v_fma_mix_f32 v230, v222, v214, 0 op_sel_hi:[1,1,0]
    v_mfma_f32_32x32x16_f16 v[176:191], a[68:71], v[148:151], v[176:191]
    s_waitcnt lgkmcnt(4)
    ds_read_u16 v228, v228
    v_fma_mix_f32 v231, v223, v215, 0 op_sel_hi:[1,1,0]
    v_fma_mix_f32 v222, v222, v214, 0 op_sel:[1,1,0] op_sel_hi:[1,1,0]
    v_fma_mix_f32 v223, v223, v215, 0 op_sel:[1,1,0] op_sel_hi:[1,1,0]
    v_or_b32 v232, v224, v216
    v_or_b32 v233, v225, v217
    v_mfma_f32_32x32x16_bf16 v[96:111], a[240:243], v[244:247], v[96:111]
    s_waitcnt lgkmcnt(2)
    ds_read_u16_d16_hi v220, v220
    v_or_b32 v234, v226, v218
    v_cvt_pk_bf16_f32 v238, v230, v222
    s_waitcnt lgkmcnt(2)
    v_or_b32 v235, v227, v219
    v_cvt_pk_bf16_f32 v239, v231, v223
    v_cvt_pkrtz_f16_f32 v208, v176, v177
    v_mfma_f32_32x32x16_bf16 v[112:127], a[244:247], v[244:247], v[112:127]
    ds_read_u16 v229, v229
    ds_read_u16_d16_hi v221, v221
    v_cvt_pkrtz_f16_f32 v209, v178, v179
    v_cvt_pkrtz_f16_f32 v210, v180, v181
    v_cvt_pkrtz_f16_f32 v211, v182, v183
    v_cvt_pkrtz_f16_f32 v212, v184, v185
    v_mfma_f32_32x32x16_bf16 v[32:47], a[24:27], v[232:235], v[32:47]
    s_waitcnt lgkmcnt(3)
    v_cvt_pkrtz_f16_f32 v213, v186, v187
    v_cvt_pkrtz_f16_f32 v214, v188, v189
    s_waitcnt lgkmcnt(2)
    v_or_b32 v236, v228, v220
    v_cvt_pkrtz_f16_f32 v215, v190, v191
    v_pk_lshrrev_b16 v216, 3, v208 op_sel_hi:[0,1]
    v_pk_lshrrev_b16 v217, 3, v209 op_sel_hi:[0,1]
    v_mfma_f32_32x32x16_f16 v[176:191], a[96:99], v[128:131], 0
    v_pk_lshrrev_b16 v218, 3, v210 op_sel_hi:[0,1]
    v_pk_lshrrev_b16 v219, 3, v211 op_sel_hi:[0,1]
    v_pk_lshrrev_b16 v220, 3, v212 op_sel_hi:[0,1]
    v_mad_u32_u16 v224, v216, 2, s85
    v_mad_u32_u16 v216, v216, 2, s85 op_sel:[1,0,0,0]
    v_mad_u32_u16 v225, v217, 2, s85
    v_mfma_f32_32x32x16_bf16 v[48:63], a[32:35], v[232:235], v[48:63]
    s_waitcnt lgkmcnt(0)
    ds_read_u16 v224, v224
    ds_read_u16_d16_hi v216, v216
    v_or_b32 v237, v229, v221
    v_pk_lshrrev_b16 v221, 3, v213 op_sel_hi:[0,1]
    v_mad_u32_u16 v217, v217, 2, s85 op_sel:[1,0,0,0]
    v_mad_u32_u16 v226, v218, 2, s85
    v_mfma_f32_32x32x16_f16 v[176:191], a[100:103], v[132:135], v[176:191]
    ds_read_u16 v225, v225
    v_mad_u32_u16 v218, v218, 2, s85 op_sel:[1,0,0,0]
    v_mad_u32_u16 v227, v219, 2, s85
    v_mad_u32_u16 v219, v219, 2, s85 op_sel:[1,0,0,0]
    v_mad_u32_u16 v228, v220, 2, s85
    v_mad_u32_u16 v220, v220, 2, s85 op_sel:[1,0,0,0]
    v_mfma_f32_32x32x16_bf16 v[64:79], a[40:43], v[232:235], v[64:79]
    ds_read_u16_d16_hi v217, v217
    v_mad_u32_u16 v229, v221, 2, s85
    v_mad_u32_u16 v221, v221, 2, s85 op_sel:[1,0,0,0]
    v_pk_fma_f16 v222, v214, v214, s53
    v_pk_fma_f16 v223, v215, v215, s53
    v_pk_mul_f16 v222, v222, v214 neg_lo:[1,0] neg_hi:[1,0]
    v_mfma_f32_32x32x16_f16 v[176:191], a[104:107], v[136:139], v[176:191]
    ds_read_u16 v226, v226
    v_pk_mul_f16 v223, v223, v215 neg_lo:[1,0] neg_hi:[1,0]
    v_exp_f16 v230, v222
    v_exp_f16 v231, v223
    v_mfma_f32_32x32x16_bf16 v[32:47], a[28:31], v[236:239], v[32:47]
    ds_read_u16_d16_hi v218, v218
    v_exp_f16_sdwa v230, v222 dst_sel:WORD_1 dst_unused:UNUSED_PRESERVE src0_sel:WORD_1
    v_exp_f16_sdwa v231, v223 dst_sel:WORD_1 dst_unused:UNUSED_PRESERVE src0_sel:WORD_1
    v_pk_add_f16 v230, v230, 1.0 op_sel_hi:[1,0]
    v_mfma_f32_32x32x16_f16 v[176:191], a[108:111], v[140:143], v[176:191]
    ds_read_u16 v227, v227
    v_pk_add_f16 v231, v231, 1.0 op_sel_hi:[1,0]
    v_rcp_f16 v222, v230
    v_rcp_f16 v223, v231
    v_mfma_f32_32x32x16_f16 v[176:191], a[112:115], v[144:147], v[176:191]
    ds_read_u16_d16_hi v219, v219
    v_rcp_f16_sdwa v222, v230 dst_sel:WORD_1 dst_unused:UNUSED_PRESERVE src0_sel:WORD_1
    v_rcp_f16_sdwa v223, v231 dst_sel:WORD_1 dst_unused:UNUSED_PRESERVE src0_sel:WORD_1
    v_fma_mix_f32 v230, v222, v214, 0 op_sel_hi:[1,1,0]
    v_mfma_f32_32x32x16_f16 v[176:191], a[116:119], v[148:151], v[176:191]
    s_waitcnt lgkmcnt(4)
    ds_read_u16 v228, v228
    v_fma_mix_f32 v231, v223, v215, 0 op_sel_hi:[1,1,0]
    v_fma_mix_f32 v222, v222, v214, 0 op_sel:[1,1,0] op_sel_hi:[1,1,0]
    v_fma_mix_f32 v223, v223, v215, 0 op_sel:[1,1,0] op_sel_hi:[1,1,0]
    v_or_b32 v232, v224, v216
    v_or_b32 v233, v225, v217
    v_mfma_f32_32x32x16_bf16 v[48:63], a[36:39], v[236:239], v[48:63]
    s_waitcnt lgkmcnt(2)
    ds_read_u16_d16_hi v220, v220
    v_or_b32 v234, v226, v218
    s_waitcnt lgkmcnt(2)
    v_or_b32 v235, v227, v219
    v_mfma_f32_32x32x16_bf16 v[64:79], a[44:47], v[236:239], v[64:79]
    ds_read_u16 v229, v229
    ds_read_u16_d16_hi v221, v221
    v_cvt_pk_bf16_f32 v238, v230, v222
    v_cvt_pk_bf16_f32 v239, v231, v223
    v_cvt_pkrtz_f16_f32 v208, v176, v177
    v_cvt_pkrtz_f16_f32 v209, v178, v179
    v_mfma_f32_32x32x16_bf16 v[32:47], a[72:75], v[232:235], v[32:47]
    s_waitcnt lgkmcnt(3)
    v_cvt_pkrtz_f16_f32 v210, v180, v181
    v_cvt_pkrtz_f16_f32 v211, v182, v183
    v_cvt_pkrtz_f16_f32 v212, v184, v185
    s_waitcnt lgkmcnt(2)
    v_or_b32 v236, v228, v220
    v_cvt_pkrtz_f16_f32 v213, v186, v187
    v_cvt_pkrtz_f16_f32 v214, v188, v189
    v_cvt_pkrtz_f16_f32 v215, v190, v191
    v_mfma_f32_32x32x16_f16 v[176:191], a[144:147], v[128:131], 0
    v_pk_lshrrev_b16 v216, 3, v208 op_sel_hi:[0,1]
    v_pk_lshrrev_b16 v217, 3, v209 op_sel_hi:[0,1]
    v_pk_lshrrev_b16 v218, 3, v210 op_sel_hi:[0,1]
    v_pk_lshrrev_b16 v219, 3, v211 op_sel_hi:[0,1]
    v_pk_lshrrev_b16 v220, 3, v212 op_sel_hi:[0,1]
    v_mad_u32_u16 v224, v216, 2, s85
    v_mfma_f32_32x32x16_bf16 v[48:63], a[80:83], v[232:235], v[48:63]
    s_waitcnt lgkmcnt(0)
    ds_read_u16 v224, v224
    v_or_b32 v237, v229, v221
    v_pk_lshrrev_b16 v221, 3, v213 op_sel_hi:[0,1]
    v_mad_u32_u16 v216, v216, 2, s85 op_sel:[1,0,0,0]
    v_mad_u32_u16 v225, v217, 2, s85
    v_mad_u32_u16 v217, v217, 2, s85 op_sel:[1,0,0,0]
    v_mfma_f32_32x32x16_f16 v[176:191], a[148:151], v[132:135], v[176:191]
    ds_read_u16_d16_hi v216, v216
    ds_read_u16 v225, v225
    v_mad_u32_u16 v226, v218, 2, s85
    v_mad_u32_u16 v218, v218, 2, s85 op_sel:[1,0,0,0]
    v_mad_u32_u16 v227, v219, 2, s85
    v_mad_u32_u16 v219, v219, 2, s85 op_sel:[1,0,0,0]
    v_mfma_f32_32x32x16_bf16 v[64:79], a[88:91], v[232:235], v[64:79]
    ds_read_u16_d16_hi v217, v217
    v_mad_u32_u16 v228, v220, 2, s85
    v_mad_u32_u16 v220, v220, 2, s85 op_sel:[1,0,0,0]
    v_mad_u32_u16 v229, v221, 2, s85
    v_mad_u32_u16 v221, v221, 2, s85 op_sel:[1,0,0,0]
    v_pk_fma_f16 v222, v214, v214, s53
    v_mfma_f32_32x32x16_f16 v[176:191], a[152:155], v[136:139], v[176:191]
    ds_read_u16 v226, v226
    v_pk_fma_f16 v223, v215, v215, s53
    v_pk_mul_f16 v222, v222, v214 neg_lo:[1,0] neg_hi:[1,0]
    v_pk_mul_f16 v223, v223, v215 neg_lo:[1,0] neg_hi:[1,0]
    v_exp_f16 v230, v222
    v_mfma_f32_32x32x16_bf16 v[32:47], a[76:79], v[236:239], v[32:47]
    ds_read_u16_d16_hi v218, v218
    v_exp_f16 v231, v223
    v_exp_f16_sdwa v230, v222 dst_sel:WORD_1 dst_unused:UNUSED_PRESERVE src0_sel:WORD_1
    v_exp_f16_sdwa v231, v223 dst_sel:WORD_1 dst_unused:UNUSED_PRESERVE src0_sel:WORD_1
    v_mfma_f32_32x32x16_f16 v[176:191], a[156:159], v[140:143], v[176:191]
    ds_read_u16 v227, v227
    v_pk_add_f16 v230, v230, 1.0 op_sel_hi:[1,0]
    v_pk_add_f16 v231, v231, 1.0 op_sel_hi:[1,0]
    v_rcp_f16 v222, v230
    v_rcp_f16 v223, v231
    v_mfma_f32_32x32x16_f16 v[176:191], a[160:163], v[144:147], v[176:191]
    ds_read_u16_d16_hi v219, v219
    v_rcp_f16_sdwa v222, v230 dst_sel:WORD_1 dst_unused:UNUSED_PRESERVE src0_sel:WORD_1
    v_rcp_f16_sdwa v223, v231 dst_sel:WORD_1 dst_unused:UNUSED_PRESERVE src0_sel:WORD_1
    v_fma_mix_f32 v230, v222, v214, 0 op_sel_hi:[1,1,0]
    v_mfma_f32_32x32x16_f16 v[176:191], a[164:167], v[148:151], v[176:191]
    s_waitcnt lgkmcnt(4)
    ds_read_u16 v228, v228
    v_fma_mix_f32 v231, v223, v215, 0 op_sel_hi:[1,1,0]
    v_fma_mix_f32 v222, v222, v214, 0 op_sel:[1,1,0] op_sel_hi:[1,1,0]
    v_fma_mix_f32 v223, v223, v215, 0 op_sel:[1,1,0] op_sel_hi:[1,1,0]
    v_or_b32 v232, v224, v216
    v_or_b32 v233, v225, v217
    v_mfma_f32_32x32x16_bf16 v[48:63], a[84:87], v[236:239], v[48:63]
    s_waitcnt lgkmcnt(2)
    ds_read_u16_d16_hi v220, v220
    v_or_b32 v234, v226, v218
    s_waitcnt lgkmcnt(2)
    v_or_b32 v235, v227, v219
    v_cvt_pkrtz_f16_f32 v208, v176, v177
    v_mfma_f32_32x32x16_bf16 v[64:79], a[92:95], v[236:239], v[64:79]
    ds_read_u16 v229, v229
    ds_read_u16_d16_hi v221, v221
    v_cvt_pk_bf16_f32 v238, v230, v222
    v_cvt_pk_bf16_f32 v239, v231, v223
    v_cvt_pkrtz_f16_f32 v209, v178, v179
    v_cvt_pkrtz_f16_f32 v210, v180, v181
    v_mfma_f32_32x32x16_bf16 v[32:47], a[120:123], v[232:235], v[32:47]
    s_waitcnt lgkmcnt(3)
    v_cvt_pkrtz_f16_f32 v211, v182, v183
    v_cvt_pkrtz_f16_f32 v212, v184, v185
    s_waitcnt lgkmcnt(2)
    v_or_b32 v236, v228, v220
    v_cvt_pkrtz_f16_f32 v213, v186, v187
    v_cvt_pkrtz_f16_f32 v214, v188, v189
    v_cvt_pkrtz_f16_f32 v215, v190, v191
    v_mfma_f32_32x32x16_f16 v[192:207], a[0:3], v[152:155], 0
    s_waitcnt vmcnt(1)
    ds_read_b128 a[232:235], v8 offset:0
    v_pk_lshrrev_b16 v216, 3, v208 op_sel_hi:[0,1]
    v_pk_lshrrev_b16 v217, 3, v209 op_sel_hi:[0,1]
    v_pk_lshrrev_b16 v218, 3, v210 op_sel_hi:[0,1]
    v_pk_lshrrev_b16 v219, 3, v211 op_sel_hi:[0,1]
    v_pk_lshrrev_b16 v220, 3, v212 op_sel_hi:[0,1]
    v_mfma_f32_32x32x16_bf16 v[48:63], a[128:131], v[232:235], v[48:63]
    s_waitcnt lgkmcnt(1)
    v_mad_u32_u16 v224, v216, 2, s85
    v_or_b32 v237, v229, v221
    v_pk_lshrrev_b16 v221, 3, v213 op_sel_hi:[0,1]
    v_mad_u32_u16 v216, v216, 2, s85 op_sel:[1,0,0,0]
    v_mad_u32_u16 v225, v217, 2, s85
    v_mad_u32_u16 v217, v217, 2, s85 op_sel:[1,0,0,0]
    v_mfma_f32_32x32x16_f16 v[192:207], a[4:7], v[156:159], v[192:207]
    ds_read_u16 v224, v224
    ds_read_u16_d16_hi v216, v216
    ds_read_u16 v225, v225
    v_mad_u32_u16 v226, v218, 2, s85
    v_mad_u32_u16 v218, v218, 2, s85 op_sel:[1,0,0,0]
    v_mad_u32_u16 v227, v219, 2, s85
    v_mfma_f32_32x32x16_bf16 v[64:79], a[136:139], v[232:235], v[64:79]
    ds_read_b128 a[244:247], v8 offset:2560
    ds_read_u16_d16_hi v217, v217
    v_mad_u32_u16 v219, v219, 2, s85 op_sel:[1,0,0,0]
    v_mad_u32_u16 v228, v220, 2, s85
    v_mad_u32_u16 v220, v220, 2, s85 op_sel:[1,0,0,0]
    v_mad_u32_u16 v229, v221, 2, s85
    v_mfma_f32_32x32x16_f16 v[192:207], a[8:11], v[160:163], v[192:207]
    ds_read_u16 v226, v226
    ds_read_b128 a[236:239], v12 offset:0
    v_mad_u32_u16 v221, v221, 2, s85 op_sel:[1,0,0,0]
    v_pk_fma_f16 v222, v214, v214, s53
    v_pk_fma_f16 v223, v215, v215, s53
    v_pk_mul_f16 v222, v222, v214 neg_lo:[1,0] neg_hi:[1,0]
    v_mfma_f32_32x32x16_bf16 v[32:47], a[124:127], v[236:239], v[32:47]
    ds_read_u16_d16_hi v218, v218
    v_pk_mul_f16 v223, v223, v215 neg_lo:[1,0] neg_hi:[1,0]
    v_exp_f16 v230, v222
    v_exp_f16 v231, v223
    v_mfma_f32_32x32x16_f16 v[192:207], a[12:15], v[164:167], v[192:207]
    ds_read_u16 v227, v227
    ds_read_b128 a[248:251], v12 offset:2560
    v_exp_f16_sdwa v230, v222 dst_sel:WORD_1 dst_unused:UNUSED_PRESERVE src0_sel:WORD_1
    v_exp_f16_sdwa v231, v223 dst_sel:WORD_1 dst_unused:UNUSED_PRESERVE src0_sel:WORD_1
    v_mfma_f32_32x32x16_f16 v[192:207], a[16:19], v[168:171], v[192:207]
    ds_read_u16_d16_hi v219, v219
    v_pk_add_f16 v230, v230, 1.0 op_sel_hi:[1,0]
    v_pk_add_f16 v231, v231, 1.0 op_sel_hi:[1,0]
    v_rcp_f16 v222, v230
    v_rcp_f16 v223, v231
    v_mfma_f32_32x32x16_f16 v[192:207], a[20:23], v[172:175], v[192:207]
    ds_read_u16 v228, v228
    ds_read_b128 a[240:243], v14 offset:1280
    v_rcp_f16_sdwa v222, v230 dst_sel:WORD_1 dst_unused:UNUSED_PRESERVE src0_sel:WORD_1
    v_rcp_f16_sdwa v223, v231 dst_sel:WORD_1 dst_unused:UNUSED_PRESERVE src0_sel:WORD_1
    v_mfma_f32_32x32x16_bf16 v[48:63], a[132:135], v[236:239], v[48:63]
    s_waitcnt lgkmcnt(11)
    ds_read_u16_d16_hi v220, v220
    v_fma_mix_f32 v230, v222, v214, 0 op_sel_hi:[1,1,0]
    v_fma_mix_f32 v231, v223, v215, 0 op_sel_hi:[1,1,0]
    v_fma_mix_f32 v222, v222, v214, 0 op_sel:[1,1,0] op_sel_hi:[1,1,0]
    v_fma_mix_f32 v223, v223, v215, 0 op_sel:[1,1,0] op_sel_hi:[1,1,0]
    v_or_b32 v232, v224, v216
    v_mfma_f32_32x32x16_bf16 v[64:79], a[140:143], v[236:239], v[64:79]
    s_waitcnt lgkmcnt(6)
    ds_read_u16 v229, v229
    ds_read_u16_d16_hi v221, v221
    ds_read_b128 a[252:255], v14 offset:3840
    v_or_b32 v233, v225, v217
    v_or_b32 v234, v226, v218
    v_cvt_pk_bf16_f32 v238, v230, v222
    v_cvt_pk_bf16_f32 v239, v231, v223
    v_cvt_pkrtz_f16_f32 v208, v192, v193
    v_cvt_pkrtz_f16_f32 v209, v194, v195
    v_cvt_pkrtz_f16_f32 v210, v196, v197
    v_cvt_pkrtz_f16_f32 v211, v198, v199
    v_cvt_pkrtz_f16_f32 v212, v200, v201
    v_cvt_pkrtz_f16_f32 v213, v202, v203
    v_cvt_pkrtz_f16_f32 v214, v204, v205
    v_cvt_pkrtz_f16_f32 v215, v206, v207
    s_waitcnt lgkmcnt(6)
    v_or_b32 v235, v227, v219
    v_pk_lshrrev_b16 v216, 3, v208 op_sel_hi:[0,1]
    v_pk_lshrrev_b16 v217, 3, v209 op_sel_hi:[0,1]
    v_mfma_f32_32x32x16_bf16 v[32:47], a[168:171], v[232:235], v[32:47]
    v_pk_lshrrev_b16 v218, 3, v210 op_sel_hi:[0,1]
    v_pk_lshrrev_b16 v219, 3, v211 op_sel_hi:[0,1]
    v_mad_u32_u16 v224, v216, 2, s85
    v_mad_u32_u16 v216, v216, 2, s85 op_sel:[1,0,0,0]
    v_mad_u32_u16 v225, v217, 2, s85
    v_mad_u32_u16 v217, v217, 2, s85 op_sel:[1,0,0,0]
    v_mfma_f32_32x32x16_f16 v[192:207], a[48:51], v[152:155], 0
    ds_read_u16 v224, v224
    v_mad_u32_u16 v226, v218, 2, s85
    v_mad_u32_u16 v218, v218, 2, s85 op_sel:[1,0,0,0]
    v_mad_u32_u16 v227, v219, 2, s85
    v_mad_u32_u16 v219, v219, 2, s85 op_sel:[1,0,0,0]
    v_pk_fma_f16 v222, v214, v214, s53
    v_mfma_f32_32x32x16_bf16 v[48:63], a[176:179], v[232:235], v[48:63]
    s_waitcnt lgkmcnt(4)
    ds_read_u16_d16_hi v216, v216
    v_or_b32 v236, v228, v220
    v_pk_lshrrev_b16 v220, 3, v212 op_sel_hi:[0,1]
    v_mad_u32_u16 v228, v220, 2, s85
    v_mad_u32_u16 v220, v220, 2, s85 op_sel:[1,0,0,0]
    v_pk_fma_f16 v223, v215, v215, s53
    v_mfma_f32_32x32x16_f16 v[192:207], a[52:55], v[156:159], v[192:207]
    s_waitcnt lgkmcnt(4)
    ds_read_u16 v225, v225
    v_pk_mul_f16 v222, v222, v214 neg_lo:[1,0] neg_hi:[1,0]
    v_pk_mul_f16 v223, v223, v215 neg_lo:[1,0] neg_hi:[1,0]
    v_exp_f16 v230, v222
    s_waitcnt lgkmcnt(4)
    v_or_b32 v237, v229, v221
    v_mfma_f32_32x32x16_bf16 v[64:79], a[184:187], v[232:235], v[64:79]
    ds_read_u16_d16_hi v217, v217
    v_pk_lshrrev_b16 v221, 3, v213 op_sel_hi:[0,1]
    v_mad_u32_u16 v229, v221, 2, s85
    v_mad_u32_u16 v221, v221, 2, s85 op_sel:[1,0,0,0]
    v_exp_f16 v231, v223
    v_mfma_f32_32x32x16_f16 v[192:207], a[56:59], v[160:163], v[192:207]
    ds_read_u16 v226, v226
    v_exp_f16_sdwa v230, v222 dst_sel:WORD_1 dst_unused:UNUSED_PRESERVE src0_sel:WORD_1
    v_exp_f16_sdwa v231, v223 dst_sel:WORD_1 dst_unused:UNUSED_PRESERVE src0_sel:WORD_1
    v_pk_add_f16 v230, v230, 1.0 op_sel_hi:[1,0]
    v_mfma_f32_32x32x16_bf16 v[32:47], a[172:175], v[236:239], v[32:47]
    ds_read_u16_d16_hi v218, v218
    v_pk_add_f16 v231, v231, 1.0 op_sel_hi:[1,0]
    v_rcp_f16 v222, v230
    v_rcp_f16 v223, v231
    v_mfma_f32_32x32x16_f16 v[192:207], a[60:63], v[164:167], v[192:207]
    ds_read_u16 v227, v227
    v_rcp_f16_sdwa v222, v230 dst_sel:WORD_1 dst_unused:UNUSED_PRESERVE src0_sel:WORD_1
    v_rcp_f16_sdwa v223, v231 dst_sel:WORD_1 dst_unused:UNUSED_PRESERVE src0_sel:WORD_1
    v_fma_mix_f32 v230, v222, v214, 0 op_sel_hi:[1,1,0]
    v_mfma_f32_32x32x16_f16 v[192:207], a[64:67], v[168:171], v[192:207]
    s_waitcnt lgkmcnt(3)
    ds_read_u16_d16_hi v219, v219
    v_fma_mix_f32 v231, v223, v215, 0 op_sel_hi:[1,1,0]
    v_fma_mix_f32 v222, v222, v214, 0 op_sel:[1,1,0] op_sel_hi:[1,1,0]
    v_fma_mix_f32 v223, v223, v215, 0 op_sel:[1,1,0] op_sel_hi:[1,1,0]
    v_or_b32 v240, v224, v216
    v_or_b32 v241, v225, v217
    v_mfma_f32_32x32x16_f16 v[192:207], a[68:71], v[172:175], v[192:207]
    s_waitcnt lgkmcnt(3)
    ds_read_u16 v228, v228
    v_cvt_pk_bf16_f32 v246, v230, v222
    v_cvt_pk_bf16_f32 v247, v231, v223
    v_cvt_pk_bf16_f32 v32, v32, v33
    s_waitcnt lgkmcnt(3)
    v_or_b32 v242, v226, v218
    v_cvt_pk_bf16_f32 v33, v34, v35
    v_mfma_f32_32x32x16_bf16 v[48:63], a[180:183], v[236:239], v[48:63]
    ds_read_u16_d16_hi v220, v220
    v_cvt_pk_bf16_f32 v34, v36, v37
    v_cvt_pk_bf16_f32 v35, v38, v39
    v_cvt_pk_bf16_f32 v36, v40, v41
    v_cvt_pk_bf16_f32 v37, v42, v43
    v_cvt_pkrtz_f16_f32 v208, v192, v193
    v_mfma_f32_32x32x16_bf16 v[64:79], a[188:191], v[236:239], v[64:79]
    s_waitcnt lgkmcnt(3)
    ds_read_u16 v229, v229
    ds_read_u16_d16_hi v221, v221
    s_waitcnt lgkmcnt(4)
    v_or_b32 v243, v227, v219
    v_cvt_pkrtz_f16_f32 v209, v194, v195
    v_cvt_pkrtz_f16_f32 v210, v196, v197
    v_cvt_pkrtz_f16_f32 v211, v198, v199
    v_mfma_f32_32x32x16_bf16 v[80:95], a[24:27], v[240:243], v[80:95]
    v_cvt_pkrtz_f16_f32 v212, v200, v201
    v_cvt_pkrtz_f16_f32 v213, v202, v203
    v_cvt_pkrtz_f16_f32 v214, v204, v205
    v_cvt_pkrtz_f16_f32 v215, v206, v207
    v_pk_lshrrev_b16 v216, 3, v208 op_sel_hi:[0,1]
    v_pk_lshrrev_b16 v217, 3, v209 op_sel_hi:[0,1]
    v_mfma_f32_32x32x16_f16 v[192:207], a[96:99], v[152:155], 0
    s_waitcnt lgkmcnt(2)
    ds_read_b128 v[176:179], v9 offset:0
    v_or_b32 v244, v228, v220
    v_pk_lshrrev_b16 v218, 3, v210 op_sel_hi:[0,1]
    v_pk_lshrrev_b16 v219, 3, v211 op_sel_hi:[0,1]
    v_pk_lshrrev_b16 v220, 3, v212 op_sel_hi:[0,1]
    v_mad_u32_u16 v224, v216, 2, s85
    v_mfma_f32_32x32x16_bf16 v[96:111], a[32:35], v[240:243], v[96:111]
    ds_read_u16 v224, v224
    v_mad_u32_u16 v216, v216, 2, s85 op_sel:[1,0,0,0]
    v_mad_u32_u16 v225, v217, 2, s85
    v_mad_u32_u16 v217, v217, 2, s85 op_sel:[1,0,0,0]
    v_mad_u32_u16 v226, v218, 2, s85
    v_mad_u32_u16 v218, v218, 2, s85 op_sel:[1,0,0,0]
    v_mfma_f32_32x32x16_f16 v[192:207], a[100:103], v[156:159], v[192:207]
    s_waitcnt lgkmcnt(2)
    ds_read_u16_d16_hi v216, v216
    ds_read_u16 v225, v225
    ds_read_b128 v[188:191], v9 offset:2560
    v_or_b32 v245, v229, v221
    v_pk_lshrrev_b16 v221, 3, v213 op_sel_hi:[0,1]
    v_mad_u32_u16 v227, v219, 2, s85
    v_mfma_f32_32x32x16_bf16 v[112:127], a[40:43], v[240:243], v[112:127]
    ds_read_u16_d16_hi v217, v217
    v_mad_u32_u16 v219, v219, 2, s85 op_sel:[1,0,0,0]
    v_mad_u32_u16 v228, v220, 2, s85
    v_mad_u32_u16 v220, v220, 2, s85 op_sel:[1,0,0,0]
    v_mad_u32_u16 v229, v221, 2, s85
    v_mad_u32_u16 v221, v221, 2, s85 op_sel:[1,0,0,0]
    v_mfma_f32_32x32x16_f16 v[192:207], a[104:107], v[160:163], v[192:207]
    ds_read_u16 v226, v226
    ds_read_b128 v[180:183], v13 offset:0
    v_cvt_pk_bf16_f32 v38, v44, v45
    v_cvt_pk_bf16_f32 v39, v46, v47
    v_permlane16_swap_b32 v32, v36
    v_mfma_f32_32x32x16_bf16 v[80:95], a[28:31], v[244:247], v[80:95]
    ds_read_u16_d16_hi v218, v218
    v_permlane16_swap_b32 v33, v37
    v_permlane16_swap_b32 v34, v38
    v_permlane16_swap_b32 v35, v39
    v_mfma_f32_32x32x16_f16 v[192:207], a[108:111], v[164:167], v[192:207]
    buffer_store_dwordx4 v[32:35], v26, s[24:27], s80 offen offset:0 sc0 sc1
    ds_read_u16 v227, v227
    ds_read_b128 v[232:235], v13 offset:2560
    v_cvt_pk_bf16_f32 v48, v48, v49
    v_cvt_pk_bf16_f32 v49, v50, v51
    v_cvt_pk_bf16_f32 v50, v52, v53
    v_mfma_f32_32x32x16_f16 v[192:207], a[112:115], v[168:171], v[192:207]
    ds_read_u16_d16_hi v219, v219
    v_cvt_pk_bf16_f32 v51, v54, v55
    v_cvt_pk_bf16_f32 v52, v56, v57
    v_cvt_pk_bf16_f32 v53, v58, v59
    v_cvt_pk_bf16_f32 v54, v60, v61
    v_cvt_pk_bf16_f32 v55, v62, v63
    v_mfma_f32_32x32x16_f16 v[192:207], a[116:119], v[172:175], v[192:207]
    ds_read_u16 v228, v228
    ds_read_b128 v[184:187], v15 offset:1280
    v_permlane16_swap_b32 v48, v52
    v_permlane16_swap_b32 v49, v53
    v_mfma_f32_32x32x16_bf16 v[96:111], a[36:39], v[244:247], v[96:111]
    s_waitcnt lgkmcnt(0)
    ds_read_u16_d16_hi v220, v220
    buffer_store_dwordx4 v[36:39], v26, s[24:27], s81 offen offset:0 sc0 sc1
    v_permlane16_swap_b32 v50, v54
    v_permlane16_swap_b32 v51, v55
    v_mfma_f32_32x32x16_bf16 v[112:127], a[44:47], v[244:247], v[112:127]
    ds_read_u16 v229, v229
    ds_read_u16_d16_hi v221, v221
    ds_read_b128 v[236:239], v15 offset:3840
    v_pk_fma_f16 v222, v214, v214, s53
    v_pk_fma_f16 v223, v215, v215, s53
    v_pk_mul_f16 v222, v222, v214 neg_lo:[1,0] neg_hi:[1,0]
    v_pk_mul_f16 v223, v223, v215 neg_lo:[1,0] neg_hi:[1,0]
    v_exp_f16 v230, v222
    v_exp_f16 v231, v223
    v_exp_f16_sdwa v230, v222 dst_sel:WORD_1 dst_unused:UNUSED_PRESERVE src0_sel:WORD_1
    v_exp_f16_sdwa v231, v223 dst_sel:WORD_1 dst_unused:UNUSED_PRESERVE src0_sel:WORD_1
    v_pk_add_f16 v230, v230, 1.0 op_sel_hi:[1,0]
    v_pk_add_f16 v231, v231, 1.0 op_sel_hi:[1,0]
    v_rcp_f16 v222, v230
    v_rcp_f16 v223, v231
    v_rcp_f16_sdwa v222, v230 dst_sel:WORD_1 dst_unused:UNUSED_PRESERVE src0_sel:WORD_1
    v_rcp_f16_sdwa v223, v231 dst_sel:WORD_1 dst_unused:UNUSED_PRESERVE src0_sel:WORD_1
    v_fma_mix_f32 v230, v222, v214, 0 op_sel_hi:[1,1,0]
    v_fma_mix_f32 v231, v223, v215, 0 op_sel_hi:[1,1,0]
    v_fma_mix_f32 v222, v222, v214, 0 op_sel:[1,1,0] op_sel_hi:[1,1,0]
    v_fma_mix_f32 v223, v223, v215, 0 op_sel:[1,1,0] op_sel_hi:[1,1,0]
    v_or_b32 v240, v224, v216
    v_or_b32 v241, v225, v217
    v_or_b32 v242, v226, v218
    v_or_b32 v243, v227, v219
    s_waitcnt lgkmcnt(3)
    v_or_b32 v244, v228, v220
    v_cvt_pk_bf16_f32 v246, v230, v222
    v_mfma_f32_32x32x16_bf16 v[80:95], a[72:75], v[240:243], v[80:95]
    s_waitcnt lgkmcnt(2)
    v_cvt_pk_bf16_f32 v247, v231, v223
    v_cvt_pkrtz_f16_f32 v208, v192, v193
    v_cvt_pkrtz_f16_f32 v209, v194, v195
    v_cvt_pkrtz_f16_f32 v210, v196, v197
    s_waitcnt lgkmcnt(1)
    v_or_b32 v245, v229, v221
    v_cvt_pkrtz_f16_f32 v211, v198, v199
    v_cvt_pkrtz_f16_f32 v212, v200, v201
    v_cvt_pkrtz_f16_f32 v213, v202, v203
    v_cvt_pkrtz_f16_f32 v214, v204, v205
    v_cvt_pkrtz_f16_f32 v215, v206, v207
    v_mfma_f32_32x32x16_f16 v[192:207], a[144:147], v[152:155], 0
    v_pk_lshrrev_b16 v216, 3, v208 op_sel_hi:[0,1]
    v_pk_lshrrev_b16 v217, 3, v209 op_sel_hi:[0,1]
    v_pk_lshrrev_b16 v218, 3, v210 op_sel_hi:[0,1]
    v_pk_lshrrev_b16 v219, 3, v211 op_sel_hi:[0,1]
    v_pk_lshrrev_b16 v220, 3, v212 op_sel_hi:[0,1]
    v_pk_lshrrev_b16 v221, 3, v213 op_sel_hi:[0,1]
    v_mfma_f32_32x32x16_bf16 v[96:111], a[80:83], v[240:243], v[96:111]
    v_mad_u32_u16 v224, v216, 2, s85
    v_mad_u32_u16 v216, v216, 2, s85 op_sel:[1,0,0,0]
    v_mad_u32_u16 v225, v217, 2, s85
    v_mad_u32_u16 v217, v217, 2, s85 op_sel:[1,0,0,0]
    v_mad_u32_u16 v226, v218, 2, s85
    v_mad_u32_u16 v218, v218, 2, s85 op_sel:[1,0,0,0]
    v_mfma_f32_32x32x16_f16 v[192:207], a[148:151], v[156:159], v[192:207]
    ds_read_u16 v224, v224
    ds_read_u16_d16_hi v216, v216
    ds_read_u16 v225, v225
    v_mad_u32_u16 v227, v219, 2, s85
    v_mad_u32_u16 v219, v219, 2, s85 op_sel:[1,0,0,0]
    v_mad_u32_u16 v228, v220, 2, s85
    v_mfma_f32_32x32x16_bf16 v[112:127], a[88:91], v[240:243], v[112:127]
    ds_read_u16_d16_hi v217, v217
    buffer_store_dwordx4 v[48:51], v26, s[24:27], s80 offen offset:64 sc0 sc1
    v_mad_u32_u16 v220, v220, 2, s85 op_sel:[1,0,0,0]
    v_mad_u32_u16 v229, v221, 2, s85
    v_mad_u32_u16 v221, v221, 2, s85 op_sel:[1,0,0,0]
    v_cvt_pk_bf16_f32 v64, v64, v65
    v_mfma_f32_32x32x16_f16 v[192:207], a[152:155], v[160:163], v[192:207]
    ds_read_u16 v226, v226
    v_cvt_pk_bf16_f32 v65, v66, v67
    v_cvt_pk_bf16_f32 v66, v68, v69
    v_cvt_pk_bf16_f32 v67, v70, v71
    v_cvt_pk_bf16_f32 v68, v72, v73
    v_cvt_pk_bf16_f32 v69, v74, v75
    v_mfma_f32_32x32x16_bf16 v[80:95], a[76:79], v[244:247], v[80:95]
    ds_read_u16_d16_hi v218, v218
    v_cvt_pk_bf16_f32 v70, v76, v77
    v_cvt_pk_bf16_f32 v71, v78, v79
    v_permlane16_swap_b32 v64, v68
    v_permlane16_swap_b32 v65, v69
    v_mfma_f32_32x32x16_f16 v[192:207], a[156:159], v[164:167], v[192:207]
    ds_read_u16 v227, v227
    v_permlane16_swap_b32 v66, v70
    v_permlane16_swap_b32 v67, v71
    v_pk_fma_f16 v222, v214, v214, s53
    v_mfma_f32_32x32x16_f16 v[192:207], a[160:163], v[168:171], v[192:207]
    ds_read_u16_d16_hi v219, v219
    v_pk_fma_f16 v223, v215, v215, s53
    v_pk_mul_f16 v222, v222, v214 neg_lo:[1,0] neg_hi:[1,0]
    v_pk_mul_f16 v223, v223, v215 neg_lo:[1,0] neg_hi:[1,0]
    v_exp_f16 v230, v222
    v_mfma_f32_32x32x16_f16 v[192:207], a[164:167], v[172:175], v[192:207]
    ds_read_u16 v228, v228
    v_exp_f16 v231, v223
    v_exp_f16_sdwa v230, v222 dst_sel:WORD_1 dst_unused:UNUSED_PRESERVE src0_sel:WORD_1
    v_exp_f16_sdwa v231, v223 dst_sel:WORD_1 dst_unused:UNUSED_PRESERVE src0_sel:WORD_1
    v_mfma_f32_32x32x16_bf16 v[96:111], a[84:87], v[244:247], v[96:111]
    ds_read_u16_d16_hi v220, v220
    buffer_store_dwordx4 v[52:55], v26, s[24:27], s81 offen offset:64 sc0 sc1
    v_pk_add_f16 v230, v230, 1.0 op_sel_hi:[1,0]
    v_pk_add_f16 v231, v231, 1.0 op_sel_hi:[1,0]
    v_rcp_f16 v222, v230
    v_mfma_f32_32x32x16_bf16 v[112:127], a[92:95], v[244:247], v[112:127]
    s_waitcnt lgkmcnt(3)
    ds_read_u16 v229, v229
    ds_read_u16_d16_hi v221, v221
    v_rcp_f16 v223, v231
    v_rcp_f16_sdwa v222, v230 dst_sel:WORD_1 dst_unused:UNUSED_PRESERVE src0_sel:WORD_1
    v_rcp_f16_sdwa v223, v231 dst_sel:WORD_1 dst_unused:UNUSED_PRESERVE src0_sel:WORD_1
    v_fma_mix_f32 v230, v222, v214, 0 op_sel_hi:[1,1,0]
    v_fma_mix_f32 v231, v223, v215, 0 op_sel_hi:[1,1,0]
    v_fma_mix_f32 v222, v222, v214, 0 op_sel:[1,1,0] op_sel_hi:[1,1,0]
    v_fma_mix_f32 v223, v223, v215, 0 op_sel:[1,1,0] op_sel_hi:[1,1,0]
    v_or_b32 v240, v224, v216
    v_or_b32 v241, v225, v217
    v_or_b32 v242, v226, v218
    s_waitcnt lgkmcnt(4)
    v_or_b32 v243, v227, v219
    v_cvt_pk_bf16_f32 v246, v230, v222
    s_waitcnt lgkmcnt(2)
    v_or_b32 v244, v228, v220
    v_mfma_f32_32x32x16_bf16 v[80:95], a[120:123], v[240:243], v[80:95]
    v_cvt_pk_bf16_f32 v247, v231, v223
    v_cvt_pkrtz_f16_f32 v208, v192, v193
    v_cvt_pkrtz_f16_f32 v209, v194, v195
    v_cvt_pkrtz_f16_f32 v210, v196, v197
    v_cvt_pkrtz_f16_f32 v211, v198, v199
    v_cvt_pkrtz_f16_f32 v212, v200, v201
    v_mfma_f32_32x32x16_bf16 v[96:111], a[128:131], v[240:243], v[96:111]
    s_waitcnt lgkmcnt(1)
    ds_read_b128 v[192:195], v22 offset:0
    buffer_store_dwordx4 v[64:67], v26, s[24:27], s80 offen offset:128 sc0 sc1
    v_cvt_pkrtz_f16_f32 v213, v202, v203
    s_waitcnt lgkmcnt(1)
    v_or_b32 v245, v229, v221
    v_cvt_pkrtz_f16_f32 v214, v204, v205
    v_cvt_pkrtz_f16_f32 v215, v206, v207
    v_mfma_f32_32x32x16_bf16 v[112:127], a[136:139], v[240:243], v[112:127]
    ds_read_b128 v[200:203], v22 offset:16
    ds_read_b128 v[196:199], v22 offset:256
    v_pk_lshrrev_b16 v216, 3, v208 op_sel_hi:[0,1]
    v_pk_lshrrev_b16 v217, 3, v209 op_sel_hi:[0,1]
    v_pk_lshrrev_b16 v218, 3, v210 op_sel_hi:[0,1]
    v_pk_lshrrev_b16 v219, 3, v211 op_sel_hi:[0,1]
    v_mfma_f32_32x32x16_bf16 v[80:95], a[124:127], v[244:247], v[80:95]
    ds_read_b128 v[204:207], v22 offset:272
    v_pk_lshrrev_b16 v220, 3, v212 op_sel_hi:[0,1]
    v_pk_lshrrev_b16 v221, 3, v213 op_sel_hi:[0,1]
    v_mad_u32_u16 v224, v216, 2, s85
    v_mad_u32_u16 v216, v216, 2, s85 op_sel:[1,0,0,0]
    v_mad_u32_u16 v225, v217, 2, s85
    v_mfma_f32_32x32x16_bf16 v[96:111], a[132:135], v[244:247], v[96:111]
    ds_read_u16 v224, v224
    ds_read_u16_d16_hi v216, v216
    ds_read_u16 v225, v225
    v_mad_u32_u16 v217, v217, 2, s85 op_sel:[1,0,0,0]
    v_mad_u32_u16 v226, v218, 2, s85
    v_mad_u32_u16 v218, v218, 2, s85 op_sel:[1,0,0,0]
    v_mfma_f32_32x32x16_bf16 v[112:127], a[140:143], v[244:247], v[112:127]
    s_waitcnt lgkmcnt(3)
    ds_read_u16_d16_hi v217, v217
    ds_read_u16 v226, v226
    ds_read_u16_d16_hi v218, v218
    v_mad_u32_u16 v227, v219, 2, s85
    v_mad_u32_u16 v219, v219, 2, s85 op_sel:[1,0,0,0]
    v_mad_u32_u16 v228, v220, 2, s85
    v_mad_u32_u16 v220, v220, 2, s85 op_sel:[1,0,0,0]
    v_mad_u32_u16 v229, v221, 2, s85
    v_mad_u32_u16 v221, v221, 2, s85 op_sel:[1,0,0,0]
    v_pk_fma_f16 v222, v214, v214, s53
    v_pk_fma_f16 v223, v215, v215, s53
    v_pk_mul_f16 v222, v222, v214 neg_lo:[1,0] neg_hi:[1,0]
    v_pk_mul_f16 v223, v223, v215 neg_lo:[1,0] neg_hi:[1,0]
    v_exp_f16 v230, v222
    v_exp_f16 v231, v223
    s_waitcnt lgkmcnt(4)
    v_or_b32 v240, v224, v216
    v_exp_f16_sdwa v230, v222 dst_sel:WORD_1 dst_unused:UNUSED_PRESERVE src0_sel:WORD_1
    v_exp_f16_sdwa v231, v223 dst_sel:WORD_1 dst_unused:UNUSED_PRESERVE src0_sel:WORD_1
    v_pk_add_f16 v230, v230, 1.0 op_sel_hi:[1,0]
    v_pk_add_f16 v231, v231, 1.0 op_sel_hi:[1,0]
    v_rcp_f16 v222, v230
    v_rcp_f16 v223, v231
    v_rcp_f16_sdwa v222, v230 dst_sel:WORD_1 dst_unused:UNUSED_PRESERVE src0_sel:WORD_1
    v_rcp_f16_sdwa v223, v231 dst_sel:WORD_1 dst_unused:UNUSED_PRESERVE src0_sel:WORD_1
    s_waitcnt lgkmcnt(2)
    v_or_b32 v241, v225, v217
    v_fma_mix_f32 v230, v222, v214, 0 op_sel_hi:[1,1,0]
    v_fma_mix_f32 v231, v223, v215, 0 op_sel_hi:[1,1,0]
    v_fma_mix_f32 v222, v222, v214, 0 op_sel:[1,1,0] op_sel_hi:[1,1,0]
    v_fma_mix_f32 v223, v223, v215, 0 op_sel:[1,1,0] op_sel_hi:[1,1,0]
    v_cvt_pk_bf16_f32 v246, v230, v222
    v_cvt_pk_bf16_f32 v247, v231, v223
    ds_read_u16 v227, v227
    ds_read_u16_d16_hi v219, v219
    ds_read_b128 v[52:55], v20 offset:2560
    ds_read_u16 v228, v228
    ds_read_u16_d16_hi v220, v220
    s_waitcnt lgkmcnt(5)
    v_or_b32 v242, v226, v218
    ds_read_u16 v229, v229
    ds_read_u16_d16_hi v221, v221
    buffer_store_dwordx4 v[68:71], v26, s[24:27], s81 offen offset:128 sc0 sc1
    ds_read_b128 v[48:51], v20 offset:0
    s_waitcnt lgkmcnt(6)
    v_or_b32 v243, v227, v219
    s_nop 1
    v_mfma_f32_32x32x16_bf16 v[80:95], a[168:171], v[240:243], v[80:95]
    ds_read_b128 v[60:63], v21 offset:2560
    v_mfma_f32_32x32x16_bf16 v[96:111], a[176:179], v[240:243], v[96:111]
    s_add_u32 s52, s52, 1
    ds_read_b128 v[56:59], v21 offset:0
    s_cmp_eq_u32 s52, 4
    v_mfma_f32_32x32x16_bf16 v[112:127], a[184:187], v[240:243], v[112:127]
    s_waitcnt lgkmcnt(6)
    s_waitcnt lgkmcnt(5)
    v_or_b32 v244, v228, v220
    s_waitcnt lgkmcnt(3)
    v_or_b32 v245, v229, v221
    s_cbranch_scc0 L_conv
L_final:
    s_nop 0
    v_mfma_f32_32x32x16_bf16 v[80:95], a[172:175], v[244:247], v[80:95]
    v_mfma_f32_32x32x16_bf16 v[96:111], a[180:183], v[244:247], v[96:111]
    v_mfma_f32_32x32x16_bf16 v[112:127], a[188:191], v[244:247], v[112:127]
    s_nop 9
    v_cvt_pk_bf16_f32 v80, v80, v81
    v_cvt_pk_bf16_f32 v81, v82, v83
    v_cvt_pk_bf16_f32 v82, v84, v85
    v_cvt_pk_bf16_f32 v83, v86, v87
    v_cvt_pk_bf16_f32 v84, v88, v89
    v_cvt_pk_bf16_f32 v85, v90, v91
    v_cvt_pk_bf16_f32 v86, v92, v93
    v_cvt_pk_bf16_f32 v87, v94, v95
    v_permlane16_swap_b32 v80, v84
    v_permlane16_swap_b32 v81, v85
    v_permlane16_swap_b32 v82, v86
    v_permlane16_swap_b32 v83, v87
    buffer_store_dwordx4 v[80:83], v26, s[24:27], s82 offen offset:0 sc0 sc1
    buffer_store_dwordx4 v[84:87], v26, s[24:27], s83 offen offset:0 sc0 sc1
    v_cvt_pk_bf16_f32 v96, v96, v97
    v_cvt_pk_bf16_f32 v97, v98, v99
    v_cvt_pk_bf16_f32 v98, v100, v101
    v_cvt_pk_bf16_f32 v99, v102, v103
    v_cvt_pk_bf16_f32 v100, v104, v105
    v_cvt_pk_bf16_f32 v101, v106, v107
    v_cvt_pk_bf16_f32 v102, v108, v109
    v_cvt_pk_bf16_f32 v103, v110, v111
    v_permlane16_swap_b32 v96, v100
    v_permlane16_swap_b32 v97, v101
    v_permlane16_swap_b32 v98, v102
    v_permlane16_swap_b32 v99, v103
    buffer_store_dwordx4 v[96:99], v26, s[24:27], s82 offen offset:64 sc0 sc1
    buffer_store_dwordx4 v[100:103], v26, s[24:27], s83 offen offset:64 sc0 sc1
    v_cvt_pk_bf16_f32 v112, v112, v113
    v_cvt_pk_bf16_f32 v113, v114, v115
    v_cvt_pk_bf16_f32 v114, v116, v117
    v_cvt_pk_bf16_f32 v115, v118, v119
    v_cvt_pk_bf16_f32 v116, v120, v121
    v_cvt_pk_bf16_f32 v117, v122, v123
    v_cvt_pk_bf16_f32 v118, v124, v125
    v_cvt_pk_bf16_f32 v119, v126, v127
    v_permlane16_swap_b32 v112, v116
    v_permlane16_swap_b32 v113, v117
    v_permlane16_swap_b32 v114, v118
    v_permlane16_swap_b32 v115, v119
    buffer_store_dwordx4 v[112:115], v26, s[24:27], s82 offen offset:128 sc0 sc1
    buffer_store_dwordx4 v[116:119], v26, s[24:27], s83 offen offset:128 sc0 sc1
L_end:
    s_endpgm
.section .rodata,"a"
.p2align 6
.amdhsa_kernel standalone__modern_conv_block_convnext__vision_kernel
  .amdhsa_next_free_vgpr 512
  .amdhsa_next_free_sgpr 102
  .amdhsa_accum_offset 256
  .amdhsa_group_segment_fixed_size 0
  .amdhsa_kernarg_size 80
  .amdhsa_user_sgpr_count 2
  .amdhsa_user_sgpr_kernarg_segment_ptr 1
  .amdhsa_system_sgpr_workgroup_id_x 1
.end_amdhsa_kernel
```

```asm
; @launch grid=(256,1,1) block=(256,1,1) lds=163840
.amdgcn_target "amdgcn-amd-amdhsa--gfx950"
.text
.globl standalone__modern_conv_block_convnext__vision_kernel
.p2align 8
.type standalone__modern_conv_block_convnext__vision_kernel,@function
standalone__modern_conv_block_convnext__vision_kernel:
    s_cmp_ge_u32 s2, 256
    s_cbranch_scc1 L_end
    s_load_dwordx16 s[4:19], s[0:1], 0
    v_lshrrev_b32 v128, 6, v0
    v_and_b32 v129, 63, v0
    v_readfirstlane_b32 s3, v128
    s_getpc_b64 s[60:61]
L_pc:
    v_lshlrev_b32 v18, 7, v0
    v_add_u32 v20, 256, v18
    v_add_u32 v18, L_end-L_pc-32640, v18
    v_mov_b32 v19, s61
    v_mov_b32 v21, s61
    v_add_co_u32 v20, vcc, s60, v20
    s_nop 1
    v_addc_co_u32 v21, vcc, 0, v21, vcc
    s_nop 1
    v_add_co_u32 v18, vcc, s60, v18
    s_nop 1
    v_addc_co_u32 v19, vcc, 0, v19, vcc
    v_cmp_gt_u32 vcc, (L_end-L_pc-32640-256+127)/128, v0
    s_nop 0
    s_and_saveexec_b64 s[62:63], vcc
    s_cbranch_execz L_cpf
    global_load_dword v250, v[20:21], off
L_cpf:
    s_mov_b64 exec, s[62:63]
    global_load_dword v251, v[18:19], off
    s_and_b32 s60, s2, 7
    s_lshl_b32 s60, s60, 5
    s_lshr_b32 s61, s2, 3
    s_add_u32 s60, s60, s61
    s_lshr_b32 s61, s60, 4
    s_and_b32 s60, s60, 15
    s_lshl_b32 s54, s61, 5
    s_lshl_b32 s60, s60, 5
    s_lshl_b32 s62, s3, 3
    s_add_u32 s55, s60, s62
    s_mul_i32 s61, s54, 98304
    s_mul_i32 s62, s55, 192
    s_add_u32 s63, s61, s62
    s_sub_u32 s64, s63, 98496
    s_sub_u32 s65, s55, 1
    s_mul_i32 s56, s3, 12800
    s_add_u32 s56, s56, 90112
    s_mov_b32 s68, 98304
    s_movk_i32 s69, 192
    v_lshrrev_b32 v128, 2, v129
    v_and_b32 v130, 3, v129
    v_mov_b32 v135, s64
    v_bfrev_b32 v136, 1
    v_mul_u32_u24 v131, 205, v128
    v_lshrrev_b32 v131, 11, v131
    v_mad_i32_i24 v132, v131, -10, v128
    v_bfe_u32 v133, v131, 1, 1
    v_bfe_u32 v134, v132, 2, 1
    v_lshl_or_b32 v133, v133, 1, v134
    v_xor_b32 v133, v133, v130
    v_mad_u32_u24 v131, v131, s68, v135
    v_lshl_add_u32 v131, v133, 4, v131
    v_mad_u32_u24 v131, v132, s69, v131
    v_add_u32 v132, s65, v132
    v_cmp_gt_u32 vcc, 0x200, v132
    s_nop 1
    v_cndmask_b32 v1, v136, v131, vcc
    v_add_u32 v128, 16, v128
    v_mul_u32_u24 v131, 205, v128
    v_lshrrev_b32 v131, 11, v131
    v_mad_i32_i24 v132, v131, -10, v128
    v_bfe_u32 v133, v131, 1, 1
    v_bfe_u32 v134, v132, 2, 1
    v_lshl_or_b32 v133, v133, 1, v134
    v_xor_b32 v133, v133, v130
    v_mad_u32_u24 v131, v131, s68, v135
    v_lshl_add_u32 v131, v133, 4, v131
    v_mad_u32_u24 v131, v132, s69, v131
    v_add_u32 v132, s65, v132
    v_cmp_gt_u32 vcc, 0x200, v132
    s_nop 1
    v_cndmask_b32 v2, v136, v131, vcc
    v_add_u32 v128, 16, v128
    v_mul_u32_u24 v131, 205, v128
    v_lshrrev_b32 v131, 11, v131
    v_mad_i32_i24 v132, v131, -10, v128
    v_bfe_u32 v133, v131, 1, 1
    v_bfe_u32 v134, v132, 2, 1
    v_lshl_or_b32 v133, v133, 1, v134
    v_xor_b32 v133, v133, v130
    v_mad_u32_u24 v131, v131, s68, v135
    v_lshl_add_u32 v131, v133, 4, v131
    v_mad_u32_u24 v131, v132, s69, v131
    v_add_u32 v132, s65, v132
    v_cmp_gt_u32 vcc, 0x200, v132
    s_nop 1
    v_cndmask_b32 v3, v136, v131, vcc
    v_add_u32 v128, 16, v128
    v_mul_u32_u24 v131, 205, v128
    v_lshrrev_b32 v131, 11, v131
    v_mad_i32_i24 v132, v131, -10, v128
    v_bfe_u32 v133, v131, 1, 1
    v_bfe_u32 v134, v132, 2, 1
    v_lshl_or_b32 v133, v133, 1, v134
    v_xor_b32 v133, v133, v130
    v_mad_u32_u24 v131, v131, s68, v135
    v_lshl_add_u32 v131, v133, 4, v131
    v_mad_u32_u24 v131, v132, s69, v131
    v_add_u32 v132, s65, v132
    v_cmp_gt_u32 vcc, 0x200, v132
    s_nop 1
    v_cndmask_b32 v4, v136, v131, vcc
    v_add_u32 v128, 16, v128
    v_mul_u32_u24 v131, 205, v128
    v_lshrrev_b32 v131, 11, v131
    v_mad_i32_i24 v132, v131, -10, v128
    v_bfe_u32 v133, v131, 1, 1
    v_bfe_u32 v134, v132, 2, 1
    v_lshl_or_b32 v133, v133, 1, v134
    v_xor_b32 v133, v133, v130
    v_mad_u32_u24 v131, v131, s68, v135
    v_lshl_add_u32 v131, v133, 4, v131
    v_mad_u32_u24 v131, v132, s69, v131
    v_add_u32 v132, s65, v132
    v_cmp_gt_u32 vcc, 0x200, v132
    s_nop 1
    v_cndmask_b32 v5, v136, v131, vcc
    v_add_u32 v128, 16, v128
    v_mul_u32_u24 v131, 205, v128
    v_lshrrev_b32 v131, 11, v131
    v_mad_i32_i24 v132, v131, -10, v128
    v_bfe_u32 v133, v131, 1, 1
    v_bfe_u32 v134, v132, 2, 1
    v_lshl_or_b32 v133, v133, 1, v134
    v_xor_b32 v133, v133, v130
    v_mad_u32_u24 v131, v131, s68, v135
    v_lshl_add_u32 v131, v133, 4, v131
    v_mad_u32_u24 v131, v132, s69, v131
    v_add_u32 v132, s65, v132
    v_cmp_gt_u32 vcc, 0x200, v132
    s_nop 1
    v_cndmask_b32 v6, v136, v131, vcc
    v_lshrrev_b32 v128, 4, v129
    v_add_u32 v128, 96, v128
    v_bfe_u32 v130, v129, 2, 2
    v_mul_u32_u24 v131, 205, v128
    v_lshrrev_b32 v131, 11, v131
    v_mad_i32_i24 v132, v131, -10, v128
    v_bfe_u32 v133, v131, 1, 1
    v_bfe_u32 v134, v132, 2, 1
    v_lshl_or_b32 v133, v133, 1, v134
    v_xor_b32 v133, v133, v130
    v_mad_u32_u24 v131, v131, s68, v135
    v_lshl_add_u32 v131, v133, 4, v131
    v_mad_u32_u24 v131, v132, s69, v131
    v_add_u32 v132, s65, v132
    v_cmp_gt_u32 vcc, 0x200, v132
    v_and_b32 v133, 3, v129
    v_lshl_add_u32 v131, v133, 2, v131
    v_cndmask_b32 v7, v136, v131, vcc
    s_cmp_lt_u32 s55, 504
    s_cselect_b32 s66, 10, 0
    v_add_u32 v135, 1856, v135
    v_mad_u32_u24 v131, v129, s68, v135
    v_cmp_gt_u32 vcc, s66, v129
    s_nop 1
    v_cndmask_b32 v31, v136, v131, vcc
    v_lshrrev_b32 v138, 5, v129
    v_mul_u32_u24 v139, 1366, v0
    v_lshrrev_b32 v139, 16, v139
    v_mul_u32_u24 v139, 384, v139
    v_lshl_add_u32 v139, v0, 2, v139
    v_lshlrev_b32 v140, 3, v0
    s_lshr_b32 s71, s2, 3
    s_lshl_b32 s71, s71, 2
    s_add_u32 s71, s71, s3
    s_mul_i32 s71, s71, 640
    v_lshlrev_b32 v141, 7, v129
    v_cmp_gt_u32 vcc, 5, v129
    s_nop 1
    v_cndmask_b32 v141, v136, v141, vcc
    s_waitcnt lgkmcnt(0)
    s_mov_b32 s20, s4
    s_mov_b32 s21, s5
    s_mov_b32 s22, 50331648
    s_mov_b32 s23, 0x20000
    s_mov_b32 s28, s6
    s_mov_b32 s29, s7
    s_mov_b32 s30, 1728
    s_mov_b32 s31, 0x20000
    s_mov_b32 s36, s14
    s_mov_b32 s37, s15
    s_mov_b32 s38, 192
    s_mov_b32 s39, 0x20000
    s_mov_b32 s40, s16
    s_mov_b32 s41, s17
    s_mov_b32 s42, 192
    s_mov_b32 s43, 0x20000
    s_mov_b32 s44, s8
    s_mov_b32 s45, s9
    s_mov_b32 s46, 73728
    s_mov_b32 s47, 0x20000
    s_mov_b32 s48, s12
    s_mov_b32 s49, s13
    s_mov_b32 s50, 73728
    s_mov_b32 s51, 0x20000
    s_mov_b32 s32, s10
    s_mov_b32 s33, s11
    s_mov_b32 s34, 768
    s_mov_b32 s35, 0x20000
    buffer_load_dword v142, v141, s[44:47], s71 offen
    buffer_load_dword v143, v141, s[48:51], s71 offen
    v_lshlrev_b32 v147, 7, v129
    buffer_load_dword v147, v147, s[32:35], 0 offen
    buffer_load_dword v144, v139, s[28:31], 0 offen
    buffer_load_dword v145, v139, s[28:31], 0 offen offset:192
    buffer_load_dword v146, v139, s[28:31], 0 offen offset:384
    buffer_load_dwordx2 v[148:149], v140, s[36:39], 0 offen
    buffer_load_dwordx2 v[150:151], v140, s[40:43], 0 offen
    s_cmp_ge_u32 s3, 2
    s_cbranch_scc1 L_prep1
L_prep0:
    v_bfe_u32 v158, v129, 2, 1
    v_bfe_u32 v159, v129, 3, 2
    v_lshl_add_u32 v159, v158, 2, v159
    v_and_b32 v160, 3, v129
    v_lshl_add_u32 v236, v138, 2, v160
    s_lshl_b32 s60, s3, 7
    v_lshl_add_u32 v236, v236, 4, s60
    v_mul_u32_u24 v159, 768, v159
    v_add_u32 v232, v159, v236
    v_add_u32 v233, 6144, v232
    v_and_b32 v159, 0x1c, v129
    v_cmp_eq_u32 vcc, 0x1c, v159
    s_mov_b32 s72, 72960
    s_mul_i32 s60, s3, 24576
    s_add_u32 s60, s60, 40960
    v_cndmask_b32 v237, v136, v236, vcc
    v_lshl_add_u32 v234, v129, 4, s60
    s_lshl_b32 s60, s3, 12
    s_add_u32 s60, s60, 40960
    v_mov_b32 v238, s60
    s_add_u32 m0, s56, 0
    s_nop 0
    buffer_load_dwordx4 v1, s[20:23], 0 offen offset:0 lds
    s_add_u32 m0, s56, 1024
    s_nop 0
    buffer_load_dwordx4 v2, s[20:23], 0 offen offset:0 lds
    s_add_u32 m0, s56, 2048
    s_nop 0
    buffer_load_dwordx4 v3, s[20:23], 0 offen offset:0 lds
    s_add_u32 m0, s56, 3072
    s_nop 0
    buffer_load_dwordx4 v4, s[20:23], 0 offen offset:0 lds
    s_add_u32 m0, s56, 4096
    s_nop 0
    buffer_load_dwordx4 v5, s[20:23], 0 offen offset:0 lds
    s_add_u32 m0, s56, 5120
    s_nop 0
    buffer_load_dwordx4 v6, s[20:23], 0 offen offset:0 lds
    s_add_u32 m0, s56, 6144
    s_nop 0
    buffer_load_dword v7, s[20:23], 0 offen offset:0 lds
    v_mov_b32 v157, 268435456
    v_and_b32 v152, 15, v129
    v_lshrrev_b32 v153, 4, v129
    v_add_u32 v154, 4, v152
    v_lshrrev_b32 v154, 3, v154
    v_mad_i32_i24 v155, v154, -4, v152
    v_and_b32 v154, 1, v154
    v_and_b32 v156, 1, v153
    v_lshlrev_b32 v158, 1, v154
    v_mul_u32_u24 v159, 98304, v158
    v_mad_u32_u24 v159, v155, s69, v159
    v_lshl_add_u32 v159, v153, 4, v159
    v_add_u32 v26, s63, v159
    v_xor_b32 v161, v154, v138
    v_add_u32 v159, v153, v158
    v_add_u32 v160, 0, v155
    v_mad_u32_u24 v159, v159, 10, v160
    v_bfe_u32 v160, v160, 2, 1
    v_lshl_or_b32 v160, v161, 1, v160
    v_lshl_add_u32 v160, v159, 2, v160
    v_lshl_add_u32 v8, v160, 4, s56
    v_add_u32 v162, 1, v156
    v_add_u32 v159, v138, v158
    v_add_u32 v160, v162, v155
    v_mad_u32_u24 v159, v159, 10, v160
    v_bfe_u32 v160, v160, 2, 1
    v_lshl_or_b32 v160, v154, 1, v160
    v_lshl_add_u32 v160, v159, 2, v160
    v_lshl_add_u32 v12, v160, 4, s56
    v_xor_b32 v9, 16, v8
    v_xor_b32 v10, 32, v8
    v_xor_b32 v11, 48, v8
    v_xor_b32 v13, 16, v12
    v_xor_b32 v14, 32, v12
    v_xor_b32 v15, 48, v12
    v_add_u32 v159, 1, v158
    v_add_u32 v160, 1, v155
    v_mad_u32_u24 v159, v159, 10, v160
    v_bfe_u32 v160, v160, 2, 1
    v_lshl_or_b32 v160, v154, 1, v160
    v_xor_b32 v160, v153, v160
    v_lshl_add_u32 v160, v159, 2, v160
    v_lshl_add_u32 v20, v160, 4, s56
    v_xor_b32 v21, 32, v20
    v_add_u32 v21, 640, v21
    v_bfe_u32 v158, v152, 2, 1
    v_sub_u32 v158, v153, v158
    v_and_b32 v159, 3, v152
    v_mul_u32_u24 v16, 0x1111, v159
    v_lshrrev_b32 v160, 3, v152
    v_lshl_add_u32 v159, v160, 2, v159
    v_lshlrev_b32 v159, 5, v159
    v_add_u32 v159, 141312, v159
    s_movk_i32 s70, 3072
    v_cmp_gt_u32 vcc, 3, v158
    v_mad_u32_u24 v159, v158, s70, v159
    s_nop 0
    v_cndmask_b32 v22, v157, v159, vcc
    v_lshlrev_b32 v23, 4, v129
    v_add_u32 v24, 40960, v23
    v_lshlrev_b32 v25, 5, v153
    v_add_u32 v25, 150528, v25
    v_and_b32 v160, 1, v129
    v_lshlrev_b32 v160, 4, v160
    v_mov_b32 v161, 0x3f80
    v_lshlrev_b32 v160, v160, v161
    v_bfe_u32 v158, v129, 1, 1
    v_bfe_u32 v159, v129, 3, 2
    v_lshl_add_u32 v159, v159, 1, v158
    v_bfe_u32 v161, v129, 2, 1
    v_xor_b32 v161, v161, v138
    v_lshl_add_u32 v159, v161, 3, v159
    v_lshlrev_b32 v159, v159, 1
    v_lshrrev_b32 v161, 2, v152
    v_xor_b32 v161, v161, v153
    v_lshl_add_u32 v158, v161, 1, v158
    v_lshlrev_b32 v158, v158, 1
    v_bfe_i32 v240, v159, 0, 1
    v_bfe_i32 v241, v159, 1, 1
    v_bfe_i32 v242, v159, 2, 1
    v_bfe_i32 v243, v159, 3, 1
    v_bfe_i32 v244, v159, 4, 1
    v_bfe_i32 v245, v159, 5, 1
    v_bfe_i32 v246, v159, 6, 1
    v_bfe_i32 v247, v159, 7, 1
    v_bfe_i32 v18, v158, 0, 1
    v_bfe_i32 v19, v158, 1, 1
    v_and_b32 v240, v160, v240
    v_and_b32 v241, v160, v241
    v_and_b32 v242, v160, v242
    v_and_b32 v243, v160, v243
    v_and_b32 v244, v160, v244
    v_and_b32 v245, v160, v245
    v_and_b32 v246, v160, v246
    v_and_b32 v247, v160, v247
    v_and_b32 v18, v160, v18
    v_and_b32 v19, v160, v19
    s_mov_b32 s24, s18
    s_mov_b32 s25, s19
    s_mov_b32 s26, 50331648
    s_mov_b32 s27, 0x20000
    s_mov_b32 s52, 0
    s_mov_b32 s80, 0
    s_mov_b32 s81, 98304
    s_mov_b32 s82, 393216
    s_mov_b32 s83, 491520
    s_mov_b32 s53, 1156138217
    s_mov_b32 s58, 0x3c003c00
    s_mov_b32 s85, 150912
    s_mov_b32 s86, 0x37803780
    s_mov_b32 s84, 0x37800000
    v_lshlrev_b32 v17, 4, v138
    v_lshrrev_b32 v17, v17, -1
    s_mov_b32 s73, 0x409d2a01
    s_mov_b32 s59, 0x3ef00000
    v_mul_u32_u24 v252, 0x100010, v0
    v_add_u32 v252, 0xc0004, v252
    v_lshlrev_b32 v253, 2, v0
    v_add_u32 v253, 150912, v253
    v_add_u32 v80, 0x0, v252
    v_add_u32 v88, 0x10001000, v252
    v_cvt_f32_f16 v81, v80
    v_cvt_f32_f16 v89, v88
    v_cvt_f32_f16_sdwa v82, v80 dst_sel:DWORD dst_unused:UNUSED_PAD src0_sel:WORD_1
    v_cvt_f32_f16_sdwa v90, v88 dst_sel:DWORD dst_unused:UNUSED_PAD src0_sel:WORD_1
    v_mul_f32 v83, 0x3f7fdde7, v81
    v_mul_f32 v91, 0x3f7fdde7, v89
    v_mul_f32 v84, 0x3f7fdde7, v82
    v_mul_f32 v92, 0x3f7fdde7, v90
    v_fma_f32 v83, v83, v81, s73
    v_fma_f32 v91, v91, v89, s73
    v_fma_f32 v84, v84, v82, s73
    v_fma_f32 v92, v92, v90, s73
    v_mul_f32 v83, -v81, v83
    v_mul_f32 v91, -v89, v91
    v_mul_f32 v84, -v82, v84
    v_mul_f32 v92, -v90, v92
    v_exp_f32 v85, v83
    v_exp_f32 v93, v91
    v_exp_f32 v86, v84
    v_exp_f32 v94, v92
    v_fma_f32 v83, v85, s59, s59
    v_fma_f32 v91, v93, s59, s59
    v_fma_f32 v84, v86, s59, s59
    v_fma_f32 v92, v94, s59, s59
    v_rcp_f32 v83, v83
    v_rcp_f32 v91, v91
    v_rcp_f32 v84, v84
    v_rcp_f32 v92, v92
    v_mul_f32 v83, v81, v83
    v_mul_f32 v91, v89, v91
    v_mul_f32 v84, v82, v84
    v_mul_f32 v92, v90, v92
    v_mul_f32 v85, -v85, v83
    v_mul_f32 v93, -v93, v91
    v_mul_f32 v86, -v86, v84
    v_mul_f32 v94, -v94, v92
    v_cvt_pk_bf16_f32 v87, v85, v86
    v_cvt_pk_bf16_f32 v95, v93, v94
    v_cvt_pk_bf16_f32 v80, v83, v84
    v_cvt_pk_bf16_f32 v88, v91, v92
    ds_write_b32 v253, v87 offset:8192
    ds_write_b32 v253, v80 offset:0
    ds_write_b32 v253, v95 offset:9216
    ds_write_b32 v253, v88 offset:1024
    v_add_u32 v80, 0x20002000, v252
    s_nop 0
    v_add_u32 v88, 0x30003000, v252
    v_cvt_f32_f16 v81, v80
    v_cvt_f32_f16 v89, v88
    v_cvt_f32_f16_sdwa v82, v80 dst_sel:DWORD dst_unused:UNUSED_PAD src0_sel:WORD_1
    v_cvt_f32_f16_sdwa v90, v88 dst_sel:DWORD dst_unused:UNUSED_PAD src0_sel:WORD_1
    v_mul_f32 v83, 0x3f7fdde7, v81
    v_mul_f32 v91, 0x3f7fdde7, v89
    v_mul_f32 v84, 0x3f7fdde7, v82
    v_mul_f32 v92, 0x3f7fdde7, v90
    v_fma_f32 v83, v83, v81, s73
    v_fma_f32 v91, v91, v89, s73
    v_fma_f32 v84, v84, v82, s73
    v_fma_f32 v92, v92, v90, s73
    v_mul_f32 v83, -v81, v83
    v_mul_f32 v91, -v89, v91
    v_mul_f32 v84, -v82, v84
    v_mul_f32 v92, -v90, v92
    v_exp_f32 v85, v83
    v_exp_f32 v93, v91
    v_exp_f32 v86, v84
    v_exp_f32 v94, v92
    v_fma_f32 v83, v85, s59, s59
    v_fma_f32 v91, v93, s59, s59
    v_fma_f32 v84, v86, s59, s59
    v_fma_f32 v92, v94, s59, s59
    v_rcp_f32 v83, v83
    v_rcp_f32 v91, v91
    v_rcp_f32 v84, v84
    v_rcp_f32 v92, v92
    v_mul_f32 v83, v81, v83
    v_mul_f32 v91, v89, v91
    v_mul_f32 v84, v82, v84
    v_mul_f32 v92, v90, v92
    v_mul_f32 v85, -v85, v83
    v_mul_f32 v93, -v93, v91
    v_mul_f32 v86, -v86, v84
    v_mul_f32 v94, -v94, v92
    v_cvt_pk_bf16_f32 v87, v85, v86
    v_cvt_pk_bf16_f32 v95, v93, v94
    v_cvt_pk_bf16_f32 v80, v83, v84
    v_cvt_pk_bf16_f32 v88, v91, v92
    ds_write_b32 v253, v87 offset:10240
    ds_write_b32 v253, v80 offset:2048
    ds_write_b32 v253, v95 offset:11264
    ds_write_b32 v253, v88 offset:3072
    v_add_u32 v80, 0x40004000, v252
    s_nop 0
    v_add_u32 v88, 0x50005000, v252
    v_add_u32 v96, 0x60006000, v252
    v_add_u32 v104, 0x70007000, v252
    v_cvt_f32_f16 v81, v80
    v_cvt_f32_f16 v89, v88
    v_cvt_f32_f16 v97, v96
    v_cvt_f32_f16 v105, v104
    v_cvt_f32_f16_sdwa v82, v80 dst_sel:DWORD dst_unused:UNUSED_PAD src0_sel:WORD_1
    v_cvt_f32_f16_sdwa v90, v88 dst_sel:DWORD dst_unused:UNUSED_PAD src0_sel:WORD_1
    v_cvt_f32_f16_sdwa v98, v96 dst_sel:DWORD dst_unused:UNUSED_PAD src0_sel:WORD_1
    v_cvt_f32_f16_sdwa v106, v104 dst_sel:DWORD dst_unused:UNUSED_PAD src0_sel:WORD_1
    v_mul_f32 v83, 0x3f7fdde7, v81
    v_mul_f32 v91, 0x40088889, v89
    v_mul_f32 v99, 0x40088889, v97
    v_mul_f32 v107, 0x40088889, v105
    v_mul_f32 v84, 0x3f7fdde7, v82
    v_mul_f32 v92, 0x40088889, v90
    v_mul_f32 v100, 0x40088889, v98
    v_mul_f32 v108, 0x40088889, v106
    v_fma_f32 v83, v83, v81, s73
    v_cvt_pk_bf16_f32 v88, v91, v92
    v_cvt_pk_bf16_f32 v96, v99, v100
    v_cvt_pk_bf16_f32 v104, v107, v108
    v_fma_f32 v84, v84, v82, s73
    v_mul_f32 v83, -v81, v83
    v_mul_f32 v84, -v82, v84
    v_exp_f32 v85, v83
    v_exp_f32 v86, v84
    v_fma_f32 v83, v85, s59, s59
    v_fma_f32 v84, v86, s59, s59
    v_rcp_f32 v83, v83
    v_rcp_f32 v84, v84
    v_mul_f32 v83, v81, v83
    v_mul_f32 v84, v82, v84
    v_mul_f32 v85, -v85, v83
    v_mul_f32 v86, -v86, v84
    v_cvt_pk_bf16_f32 v87, v85, v86
    v_cvt_pk_bf16_f32 v80, v83, v84
    ds_write_b32 v253, v87 offset:12288
    ds_write_b32 v253, v80 offset:4096
    ds_write_b32 v253, v88 offset:5120
    ds_write_b32 v253, v96 offset:6144
    ds_write_b32 v253, v104 offset:7168
    buffer_load_dwordx4 v[176:179], v236, s[44:47], s72 offen offset:0
    s_mov_b32 s74, 0
    s_mov_b32 s75, 12288
    buffer_load_dwordx4 a[0:3], v232, s[44:47], s74 offen offset:0
    buffer_load_dwordx4 a[4:7], v232, s[44:47], s75 offen offset:0
    buffer_load_dwordx4 a[8:11], v233, s[44:47], s74 offen offset:0
    buffer_load_dwordx4 a[12:15], v233, s[44:47], s75 offen offset:0
    s_mov_b32 s74, 24576
    s_mov_b32 s75, 36864
    buffer_load_dwordx4 a[16:19], v232, s[44:47], s74 offen offset:0
    buffer_load_dwordx4 a[20:23], v232, s[44:47], s75 offen offset:0
    buffer_load_dwordx4 a[24:27], v233, s[44:47], s74 offen offset:0
    buffer_load_dwordx4 a[28:31], v233, s[44:47], s75 offen offset:0
    v_lshlrev_b32 v158, 6, v0
    v_add_u32 v158, 141312, v158
    v_cmp_gt_u32 vcc, 144, v0
    s_nop 1
    v_cndmask_b32 v158, v157, v158, vcc
    v_and_b32 v159, 3, v0
    v_lshl_add_u32 v160, v159, 2, v158
    v_lshrrev_b32 v159, 1, v159
    v_lshl_add_u32 v159, v159, 2, v158
    v_lshlrev_b32 v161, 4, v0
    v_add_u32 v161, 150528, v161
    v_cmp_gt_u32 vcc, 24, v0
    s_nop 1
    v_cndmask_b32 v161, v157, v161, vcc
    v_mov_b32 v164, 0
    v_mov_b32 v165, 0
    v_mov_b32 v166, 0
    v_mov_b32 v167, 0
    ds_write_b128 v158, v[164:167]
    ds_write_b128 v158, v[164:167] offset:16
    s_waitcnt lgkmcnt(9)
    ds_write_b128 v158, v[164:167] offset:32
    ds_write_b128 v158, v[164:167] offset:48
    s_waitcnt vmcnt(20)
    ds_write_b16 v160, v144
    ds_write_b16_d16_hi v160, v144 offset:34
    s_waitcnt vmcnt(19)
    ds_write_b16 v159, v145 offset:16
    ds_write_b16_d16_hi v159, v145 offset:48
    s_waitcnt vmcnt(18) lgkmcnt(13)
    ds_write_b16 v159, v146 offset:24
    ds_write_b16_d16_hi v159, v146 offset:56
    s_waitcnt vmcnt(17)
    v_lshlrev_b32 v168, 16, v148
    v_and_b32 v169, 0xffff0000, v148
    v_lshlrev_b32 v170, 16, v149
    v_and_b32 v171, 0xffff0000, v149
    s_waitcnt vmcnt(16)
    v_lshlrev_b32 v172, 16, v150
    v_and_b32 v173, 0xffff0000, v150
    v_lshlrev_b32 v174, 16, v151
    v_and_b32 v175, 0xffff0000, v151
    v_mul_f32 v168, v168, v172
    v_mul_f32 v169, v169, v173
    v_mul_f32 v170, v170, v174
    v_mul_f32 v171, v171, v175
    s_waitcnt lgkmcnt(14)
    ds_write_b128 v161, v[168:171]
    buffer_load_dwordx4 v[200:203], v237, s[32:35], 0 offen offset:0
    s_mov_b32 s74, 49152
    s_mov_b32 s75, 61440
    buffer_load_dwordx4 a[32:35], v232, s[44:47], s74 offen offset:0
    buffer_load_dwordx4 a[36:39], v232, s[44:47], s75 offen offset:0
    buffer_load_dwordx4 a[40:43], v233, s[44:47], s74 offen offset:0
    buffer_load_dwordx4 a[44:47], v233, s[44:47], s75 offen offset:0
    buffer_load_dwordx4 v[180:183], v236, s[44:47], s72 offen offset:256
    s_mov_b32 s74, 0
    s_mov_b32 s75, 12288
    buffer_load_dwordx4 a[48:51], v232, s[44:47], s74 offen offset:256
    buffer_load_dwordx4 a[52:55], v232, s[44:47], s75 offen offset:256
    buffer_load_dwordx4 a[56:59], v233, s[44:47], s74 offen offset:256
    buffer_load_dwordx4 a[60:63], v233, s[44:47], s75 offen offset:256
    s_mov_b32 s74, 24576
    s_mov_b32 s75, 36864
    buffer_load_dwordx4 a[64:67], v232, s[44:47], s74 offen offset:256
    buffer_load_dwordx4 a[68:71], v232, s[44:47], s75 offen offset:256
    buffer_load_dwordx4 a[72:75], v233, s[44:47], s74 offen offset:256
    buffer_load_dwordx4 a[76:79], v233, s[44:47], s75 offen offset:256
    s_waitcnt vmcnt(22)
    v_xor_b32 v176, 0x80008000, v176
    v_xor_b32 v177, 0x80008000, v177
    v_xor_b32 v178, 0x80008000, v178
    v_xor_b32 v179, 0x80008000, v179
    s_nop 1
    v_mfma_f32_32x32x16_bf16 v[144:159], v[176:179], v[240:243], 0
    v_mfma_f32_32x32x16_bf16 v[144:159], v[176:179], v[244:247], v[144:159]
    s_waitcnt vmcnt(21)
    s_nop 8
    v_mfma_f32_32x32x16_bf16 v[80:95], a[0:3], v[240:243], v[144:159]
    s_waitcnt vmcnt(19)
    v_mfma_f32_32x32x16_bf16 v[96:111], a[8:11], v[240:243], v[144:159]
    v_mfma_f32_32x32x16_bf16 v[80:95], a[4:7], v[244:247], v[80:95]
    s_waitcnt vmcnt(18)
    v_mfma_f32_32x32x16_bf16 v[96:111], a[12:15], v[244:247], v[96:111]
    s_waitcnt vmcnt(17)
    v_mfma_f32_32x32x16_bf16 v[112:127], a[16:19], v[240:243], v[144:159]
    s_nop 7
    v_cvt_pk_f16_f32 v224, v80, v84
    v_cvt_pk_f16_f32 v225, v88, v92
    v_cvt_pk_f16_f32 v226, v96, v100
    v_cvt_pk_f16_f32 v227, v104, v108
    s_waitcnt lgkmcnt(14)
    ds_write_b128 v234, v[224:227] offset:0
    buffer_load_dwordx4 v[204:207], v237, s[32:35], 0 offen offset:256
    s_waitcnt vmcnt(16)
    v_mfma_f32_32x32x16_bf16 v[128:143], a[24:27], v[240:243], v[144:159]
    v_cvt_pk_f16_f32 v228, v81, v85
    v_cvt_pk_f16_f32 v229, v89, v93
    v_cvt_pk_f16_f32 v230, v97, v101
    v_cvt_pk_f16_f32 v231, v105, v109
    s_waitcnt lgkmcnt(14)
    ds_write_b128 v234, v[228:231] offset:1024
    s_mov_b32 s74, 49152
    s_mov_b32 s75, 61440
    v_mfma_f32_32x32x16_bf16 v[112:127], a[20:23], v[244:247], v[112:127]
    v_cvt_pk_f16_f32 v224, v82, v86
    v_cvt_pk_f16_f32 v225, v90, v94
    v_cvt_pk_f16_f32 v226, v98, v102
    v_cvt_pk_f16_f32 v227, v106, v110
    s_waitcnt lgkmcnt(14)
    ds_write_b128 v234, v[224:227] offset:12288
    buffer_load_dwordx4 a[80:83], v232, s[44:47], s74 offen offset:256
    buffer_load_dwordx4 a[84:87], v232, s[44:47], s75 offen offset:256
    s_waitcnt vmcnt(17)
    v_mfma_f32_32x32x16_bf16 v[128:143], a[28:31], v[244:247], v[128:143]
    v_cvt_pk_f16_f32 v228, v83, v87
    v_cvt_pk_f16_f32 v229, v91, v95
    v_cvt_pk_f16_f32 v230, v99, v103
    v_cvt_pk_f16_f32 v231, v107, v111
    s_waitcnt lgkmcnt(14)
    ds_write_b128 v234, v[228:231] offset:13312
    buffer_load_dwordx4 a[88:91], v233, s[44:47], s74 offen offset:256
    buffer_load_dwordx4 a[92:95], v233, s[44:47], s75 offen offset:256
    s_waitcnt vmcnt(17)
    v_mfma_f32_32x32x16_bf16 v[80:95], a[32:35], v[240:243], v[144:159]
    v_cvt_pk_f16_f32 v224, v112, v116
    v_cvt_pk_f16_f32 v225, v120, v124
    s_waitcnt vmcnt(15)
    v_mfma_f32_32x32x16_bf16 v[96:111], a[40:43], v[240:243], v[144:159]
    v_cvt_pk_f16_f32 v226, v128, v132
    v_cvt_pk_f16_f32 v227, v136, v140
    s_waitcnt lgkmcnt(14)
    ds_write_b128 v234, v[224:227] offset:2048
    buffer_load_dwordx4 v[184:187], v236, s[44:47], s72 offen offset:512
    s_mov_b32 s74, 0
    s_mov_b32 s75, 12288
    v_mfma_f32_32x32x16_bf16 v[80:95], a[36:39], v[244:247], v[80:95]
    v_cvt_pk_f16_f32 v228, v113, v117
    v_cvt_pk_f16_f32 v229, v121, v125
    v_cvt_pk_f16_f32 v230, v129, v133
    v_cvt_pk_f16_f32 v231, v137, v141
    s_waitcnt lgkmcnt(14)
    ds_write_b128 v234, v[228:231] offset:3072
    buffer_load_dwordx4 v[32:35], v232, s[44:47], s74 offen offset:512
    buffer_load_dwordx4 v[36:39], v232, s[44:47], s75 offen offset:512
    buffer_load_dwordx4 v[40:43], v233, s[44:47], s74 offen offset:512
    s_waitcnt vmcnt(18)
    v_mfma_f32_32x32x16_bf16 v[96:111], a[44:47], v[244:247], v[96:111]
    v_cvt_pk_f16_f32 v224, v114, v118
    v_cvt_pk_f16_f32 v225, v122, v126
    v_cvt_pk_f16_f32 v226, v130, v134
    v_cvt_pk_f16_f32 v227, v138, v142
    s_waitcnt lgkmcnt(14)
    ds_write_b128 v234, v[224:227] offset:14336
    buffer_load_dwordx4 v[44:47], v233, s[44:47], s75 offen offset:512
    s_waitcnt vmcnt(18)
    v_xor_b32 v180, 0x80008000, v180
    v_xor_b32 v181, 0x80008000, v181
    v_mfma_f32_32x32x16_bf16 v[96:111], v[200:203], v[244:247], v[96:111]
    v_cvt_pk_f16_f32 v228, v115, v119
    v_cvt_pk_f16_f32 v229, v123, v127
    v_cvt_pk_f16_f32 v230, v131, v135
    v_cvt_pk_f16_f32 v231, v139, v143
    s_waitcnt lgkmcnt(14)
    ds_write_b128 v234, v[228:231] offset:15360
    v_xor_b32 v182, 0x80008000, v182
    v_xor_b32 v183, 0x80008000, v183
    s_nop 1
    v_mfma_f32_32x32x16_bf16 v[144:159], v[180:183], v[240:243], 0
    v_mfma_f32_32x32x16_bf16 v[144:159], v[180:183], v[244:247], v[144:159]
    s_waitcnt vmcnt(17)
    s_nop 8
    v_mfma_f32_32x32x16_bf16 v[112:127], a[48:51], v[240:243], v[144:159]
    v_cvt_pk_f16_f32 v224, v80, v84
    v_cvt_pk_f16_f32 v225, v88, v92
    v_cvt_pk_f16_f32 v226, v96, v100
    v_cvt_pk_f16_f32 v227, v104, v108
    s_waitcnt lgkmcnt(14)
    ds_write_b128 v234, v[224:227] offset:4096
    s_mov_b32 s74, 24576
    s_waitcnt vmcnt(15)
    v_mfma_f32_32x32x16_bf16 v[128:143], a[56:59], v[240:243], v[144:159]
    v_cvt_pk_f16_f32 v228, v81, v85
    v_cvt_pk_f16_f32 v229, v89, v93
    v_cvt_pk_f16_f32 v230, v97, v101
    v_cvt_pk_f16_f32 v231, v105, v109
    s_waitcnt lgkmcnt(14)
    ds_write_b128 v234, v[228:231] offset:5120
    s_mov_b32 s75, 36864
    buffer_load_dwordx4 v[48:51], v232, s[44:47], s74 offen offset:512
    v_mfma_f32_32x32x16_bf16 v[112:127], a[52:55], v[244:247], v[112:127]
    v_cvt_pk_f16_f32 v224, v82, v86
    v_cvt_pk_f16_f32 v225, v90, v94
    v_cvt_pk_f16_f32 v226, v98, v102
    v_cvt_pk_f16_f32 v227, v106, v110
    s_waitcnt lgkmcnt(14)
    ds_write_b128 v234, v[224:227] offset:16384
    buffer_load_dwordx4 v[52:55], v232, s[44:47], s75 offen offset:512
    s_waitcnt vmcnt(16)
    v_mfma_f32_32x32x16_bf16 v[128:143], a[60:63], v[244:247], v[128:143]
    v_cvt_pk_f16_f32 v228, v83, v87
    v_cvt_pk_f16_f32 v229, v91, v95
    v_cvt_pk_f16_f32 v230, v99, v103
    v_cvt_pk_f16_f32 v231, v107, v111
    s_waitcnt lgkmcnt(14)
    ds_write_b128 v234, v[228:231] offset:17408
    v_sub_u32 v234, v234, v238
    buffer_load_dwordx4 v[56:59], v233, s[44:47], s74 offen offset:512
    buffer_load_dwordx4 v[60:63], v233, s[44:47], s75 offen offset:512
    s_waitcnt vmcnt(17)
    v_mfma_f32_32x32x16_bf16 v[80:95], a[64:67], v[240:243], v[144:159]
    v_cvt_pk_f16_f32 v224, v112, v116
    v_cvt_pk_f16_f32 v225, v120, v124
    v_cvt_pk_f16_f32 v226, v128, v132
    v_cvt_pk_f16_f32 v227, v136, v140
    s_waitcnt lgkmcnt(14)
    ds_write_b128 v234, v[224:227] offset:0
    buffer_load_dwordx4 v[208:211], v237, s[32:35], 0 offen offset:512
    s_waitcnt vmcnt(16)
    v_mfma_f32_32x32x16_bf16 v[96:111], a[72:75], v[240:243], v[144:159]
    v_cvt_pk_f16_f32 v228, v113, v117
    v_cvt_pk_f16_f32 v229, v121, v125
    v_cvt_pk_f16_f32 v230, v129, v133
    v_cvt_pk_f16_f32 v231, v137, v141
    s_waitcnt lgkmcnt(14)
    ds_write_b128 v234, v[228:231] offset:1024
    s_mov_b32 s74, 49152
    s_mov_b32 s75, 61440
    v_mfma_f32_32x32x16_bf16 v[80:95], a[68:71], v[244:247], v[80:95]
    v_cvt_pk_f16_f32 v224, v114, v118
    v_cvt_pk_f16_f32 v225, v122, v126
    v_cvt_pk_f16_f32 v226, v130, v134
    v_cvt_pk_f16_f32 v227, v138, v142
    s_waitcnt lgkmcnt(14)
    ds_write_b128 v234, v[224:227] offset:10240
    buffer_load_dwordx4 v[64:67], v232, s[44:47], s74 offen offset:512
    buffer_load_dwordx4 v[68:71], v232, s[44:47], s75 offen offset:512
    s_waitcnt vmcnt(17)
    v_mfma_f32_32x32x16_bf16 v[96:111], a[76:79], v[244:247], v[96:111]
    v_cvt_pk_f16_f32 v228, v115, v119
    v_cvt_pk_f16_f32 v229, v123, v127
    v_cvt_pk_f16_f32 v230, v131, v135
    v_cvt_pk_f16_f32 v231, v139, v143
    s_waitcnt lgkmcnt(14)
    ds_write_b128 v234, v[228:231] offset:11264
    buffer_load_dwordx4 v[72:75], v233, s[44:47], s74 offen offset:512
    buffer_load_dwordx4 v[76:79], v233, s[44:47], s75 offen offset:512
    s_waitcnt lgkmcnt(0)
    s_barrier
    s_waitcnt vmcnt(17)
    v_mfma_f32_32x32x16_bf16 v[112:127], a[80:83], v[240:243], v[144:159]
    v_cvt_pk_f16_f32 v224, v80, v84
    v_cvt_pk_f16_f32 v225, v88, v92
    s_waitcnt vmcnt(15)
    v_mfma_f32_32x32x16_bf16 v[128:143], a[88:91], v[240:243], v[144:159]
    v_cvt_pk_f16_f32 v226, v96, v100
    v_cvt_pk_f16_f32 v227, v104, v108
    ds_write_b128 v234, v[224:227] offset:2048
    ds_read_b128 a[0:3], v24 offset:0
    ds_read_b128 a[4:7], v24 offset:1024
    ds_read_b128 a[8:11], v24 offset:2048
    ds_read_b128 a[12:15], v24 offset:3072
    ds_read_b128 a[16:19], v24 offset:4096
    ds_read_b128 a[20:23], v24 offset:5120
    s_add_u32 m0, s56, 6336
    s_nop 0
    buffer_load_dwordx4 v1, s[20:23], 0 offen offset:64 lds
    s_add_u32 m0, s56, 7360
    s_nop 0
    buffer_load_dwordx4 v2, s[20:23], 0 offen offset:64 lds
    s_add_u32 m0, s56, 8384
    v_mfma_f32_32x32x16_bf16 v[112:127], a[84:87], v[244:247], v[112:127]
    v_cvt_pk_f16_f32 v228, v81, v85
    v_cvt_pk_f16_f32 v229, v89, v93
    v_cvt_pk_f16_f32 v230, v97, v101
    v_cvt_pk_f16_f32 v231, v105, v109
    ds_write_b128 v234, v[228:231] offset:3072
    ds_read_b128 a[24:27], v24 offset:6144
    ds_read_b128 a[28:31], v24 offset:7168
    ds_read_b128 a[32:35], v24 offset:8192
    ds_read_b128 a[36:39], v24 offset:9216
    ds_read_b128 a[40:43], v24 offset:10240
    ds_read_b128 a[44:47], v24 offset:11264
    buffer_load_dwordx4 v3, s[20:23], 0 offen offset:64 lds
    s_add_u32 m0, s56, 9408
    s_nop 0
    buffer_load_dwordx4 v4, s[20:23], 0 offen offset:64 lds
    s_add_u32 m0, s56, 10432
    s_nop 0
    buffer_load_dwordx4 v5, s[20:23], 0 offen offset:64 lds
    s_waitcnt vmcnt(19)
    v_mfma_f32_32x32x16_bf16 v[128:143], a[92:95], v[244:247], v[128:143]
    v_cvt_pk_f16_f32 v224, v82, v86
    v_cvt_pk_f16_f32 v225, v90, v94
    v_cvt_pk_f16_f32 v226, v98, v102
    v_cvt_pk_f16_f32 v227, v106, v110
    ds_write_b128 v234, v[224:227] offset:12288
    s_waitcnt lgkmcnt(9)
    ds_read_b128 a[96:99], v24 offset:24576
    ds_read_b128 a[100:103], v24 offset:25600
    ds_read_b128 a[104:107], v24 offset:26624
    ds_read_b128 a[108:111], v24 offset:27648
    ds_read_b128 a[112:115], v24 offset:28672
    ds_read_b128 a[116:119], v24 offset:29696
    s_add_u32 m0, s56, 11456
    s_nop 0
    buffer_load_dwordx4 v6, s[20:23], 0 offen offset:64 lds
    s_add_u32 m0, s56, 12480
    s_nop 0
    buffer_load_dword v7, s[20:23], 0 offen offset:64 lds
    buffer_load_dword v254, v31, s[20:23], 0 offen
    v_mfma_f32_32x32x16_bf16 v[128:143], v[204:207], v[244:247], v[128:143]
    v_cvt_pk_f16_f32 v228, v83, v87
    v_cvt_pk_f16_f32 v229, v91, v95
    v_cvt_pk_f16_f32 v230, v99, v103
    v_cvt_pk_f16_f32 v231, v107, v111
    s_waitcnt lgkmcnt(9)
    ds_write_b128 v234, v[228:231] offset:13312
    ds_read_b128 a[120:123], v24 offset:30720
    ds_read_b128 a[124:127], v24 offset:31744
    ds_read_b128 a[128:131], v24 offset:32768
    ds_read_b128 a[132:135], v24 offset:33792
    ds_read_b128 a[136:139], v24 offset:34816
    s_waitcnt lgkmcnt(14)
    ds_read_b128 a[140:143], v24 offset:35840
    s_waitcnt vmcnt(21)
    v_xor_b32 v184, 0x80008000, v184
    v_xor_b32 v185, 0x80008000, v185
    v_xor_b32 v186, 0x80008000, v186
    v_xor_b32 v187, 0x80008000, v187
    s_nop 1
    v_mfma_f32_32x32x16_bf16 v[144:159], v[184:187], v[240:243], 0
    v_mfma_f32_32x32x16_bf16 v[144:159], v[184:187], v[244:247], v[144:159]
    s_waitcnt vmcnt(20)
    s_nop 8
    v_mfma_f32_32x32x16_bf16 v[80:95], v[32:35], v[240:243], v[144:159]
    v_cvt_pk_f16_f32 v224, v112, v116
    v_cvt_pk_f16_f32 v225, v120, v124
    v_cvt_pk_f16_f32 v226, v128, v132
    v_cvt_pk_f16_f32 v227, v136, v140
    s_waitcnt lgkmcnt(9)
    ds_write_b128 v234, v[224:227] offset:4096
    ds_read_b128 a[144:147], v24 offset:36864
    ds_read_b128 a[148:151], v24 offset:37888
    ds_read_b128 a[152:155], v24 offset:38912
    ds_read_b128 a[156:159], v24 offset:39936
    ds_read_b128 a[160:163], v24 offset:40960
    s_waitcnt lgkmcnt(14)
    ds_read_b128 a[164:167], v24 offset:41984
    s_waitcnt vmcnt(18)
    v_mfma_f32_32x32x16_bf16 v[96:111], v[40:43], v[240:243], v[144:159]
    v_cvt_pk_f16_f32 v228, v113, v117
    v_cvt_pk_f16_f32 v229, v121, v125
    v_cvt_pk_f16_f32 v230, v129, v133
    v_cvt_pk_f16_f32 v231, v137, v141
    s_waitcnt lgkmcnt(9)
    ds_write_b128 v234, v[228:231] offset:5120
    ds_read_b128 a[168:171], v24 offset:43008
    ds_read_b128 a[172:175], v24 offset:44032
    ds_read_b128 a[176:179], v24 offset:45056
    ds_read_b128 a[180:183], v24 offset:46080
    ds_read_b128 a[184:187], v24 offset:47104
    s_waitcnt lgkmcnt(14)
    ds_read_b128 a[188:191], v24 offset:48128
    v_mfma_f32_32x32x16_bf16 v[80:95], v[36:39], v[244:247], v[80:95]
    v_cvt_pk_f16_f32 v224, v114, v118
    v_cvt_pk_f16_f32 v225, v122, v126
    v_cvt_pk_f16_f32 v226, v130, v134
    v_cvt_pk_f16_f32 v227, v138, v142
    s_waitcnt lgkmcnt(9)
    ds_write_b128 v234, v[224:227] offset:14336
    ds_read_b128 a[192:195], v23 offset:0
    ds_read_b128 a[196:199], v23 offset:1024
    ds_read_b128 a[200:203], v23 offset:10240
    ds_read_b128 a[204:207], v23 offset:11264
    ds_read_b128 a[208:211], v23 offset:20480
    s_waitcnt lgkmcnt(14)
    ds_read_b128 a[212:215], v23 offset:21504
    s_waitcnt vmcnt(17)
    v_mfma_f32_32x32x16_bf16 v[96:111], v[44:47], v[244:247], v[96:111]
    v_cvt_pk_f16_f32 v228, v115, v119
    v_cvt_pk_f16_f32 v229, v123, v127
    v_cvt_pk_f16_f32 v230, v131, v135
    v_cvt_pk_f16_f32 v231, v139, v143
    s_waitcnt lgkmcnt(14)
    ds_write_b128 v234, v[228:231] offset:15360
    v_add_u32 v234, v234, v238
    s_waitcnt lgkmcnt(13)
    ds_read_b128 a[216:219], v23 offset:30720
    ds_read_b128 a[220:223], v23 offset:31744
    s_waitcnt lgkmcnt(9)
    ds_read_b128 a[48:51], v24 offset:12288
    ds_read_b128 a[52:55], v24 offset:13312
    ds_read_b128 a[56:59], v24 offset:14336
    ds_read_b128 a[60:63], v24 offset:15360
    ds_read_b128 a[64:67], v24 offset:16384
    ds_read_b128 a[68:71], v24 offset:17408
    s_waitcnt lgkmcnt(9)
    ds_read_b128 a[72:75], v24 offset:18432
    ds_read_b128 a[76:79], v24 offset:19456
    ds_read_b128 a[80:83], v24 offset:20480
    ds_read_b128 a[84:87], v24 offset:21504
    ds_read_b128 a[88:91], v24 offset:22528
    ds_read_b128 a[92:95], v24 offset:23552
    s_waitcnt lgkmcnt(0)
    s_barrier
    s_waitcnt vmcnt(16)
    v_mfma_f32_32x32x16_bf16 v[112:127], v[48:51], v[240:243], v[144:159]
    v_cvt_pk_f16_f32 v224, v80, v84
    v_cvt_pk_f16_f32 v225, v88, v92
    v_cvt_pk_f16_f32 v226, v96, v100
    v_cvt_pk_f16_f32 v227, v104, v108
    ds_write_b128 v234, v[224:227] offset:0
    s_waitcnt vmcnt(14)
    v_mfma_f32_32x32x16_bf16 v[128:143], v[56:59], v[240:243], v[144:159]
    v_cvt_pk_f16_f32 v228, v81, v85
    v_cvt_pk_f16_f32 v229, v89, v93
    v_cvt_pk_f16_f32 v230, v97, v101
    v_cvt_pk_f16_f32 v231, v105, v109
    ds_write_b128 v234, v[228:231] offset:1024
    v_mfma_f32_32x32x16_bf16 v[112:127], v[52:55], v[244:247], v[112:127]
    v_cvt_pk_f16_f32 v224, v82, v86
    v_cvt_pk_f16_f32 v225, v90, v94
    v_cvt_pk_f16_f32 v226, v98, v102
    v_cvt_pk_f16_f32 v227, v106, v110
    ds_write_b128 v234, v[224:227] offset:12288
    s_waitcnt vmcnt(13)
    v_mfma_f32_32x32x16_bf16 v[128:143], v[60:63], v[244:247], v[128:143]
    v_cvt_pk_f16_f32 v228, v83, v87
    v_cvt_pk_f16_f32 v229, v91, v95
    v_cvt_pk_f16_f32 v230, v99, v103
    v_cvt_pk_f16_f32 v231, v107, v111
    ds_write_b128 v234, v[228:231] offset:13312
    s_waitcnt vmcnt(11)
    v_mfma_f32_32x32x16_bf16 v[80:95], v[64:67], v[240:243], v[144:159]
    v_cvt_pk_f16_f32 v224, v112, v116
    v_cvt_pk_f16_f32 v225, v120, v124
    s_waitcnt vmcnt(9)
    v_mfma_f32_32x32x16_bf16 v[96:111], v[72:75], v[240:243], v[144:159]
    s_nop 0
    v_cvt_pk_f16_f32 v226, v128, v132
    v_cvt_pk_f16_f32 v227, v136, v140
    ds_write_b128 v234, v[224:227] offset:2048
    v_mfma_f32_32x32x16_bf16 v[80:95], v[68:71], v[244:247], v[80:95]
    v_cvt_pk_f16_f32 v228, v113, v117
    v_cvt_pk_f16_f32 v229, v121, v125
    v_cvt_pk_f16_f32 v230, v129, v133
    v_cvt_pk_f16_f32 v231, v137, v141
    ds_write_b128 v234, v[228:231] offset:3072
    s_waitcnt vmcnt(8)
    v_mfma_f32_32x32x16_bf16 v[96:111], v[76:79], v[244:247], v[96:111]
    v_cvt_pk_f16_f32 v224, v114, v118
    v_cvt_pk_f16_f32 v225, v122, v126
    v_cvt_pk_f16_f32 v226, v130, v134
    v_cvt_pk_f16_f32 v227, v138, v142
    ds_write_b128 v234, v[224:227] offset:14336
    v_mfma_f32_32x32x16_bf16 v[96:111], v[208:211], v[244:247], v[96:111]
    v_cvt_pk_f16_f32 v228, v115, v119
    v_cvt_pk_f16_f32 v229, v123, v127
    v_cvt_pk_f16_f32 v230, v131, v135
    v_cvt_pk_f16_f32 v231, v139, v143
    ds_write_b128 v234, v[228:231] offset:15360
    v_cvt_pk_f16_f32 v224, v80, v84
    v_cvt_pk_f16_f32 v225, v88, v92
    s_nop 4
    v_cvt_pk_f16_f32 v226, v96, v100
    v_cvt_pk_f16_f32 v227, v104, v108
    ds_write_b128 v234, v[224:227] offset:4096
    v_cvt_pk_f16_f32 v228, v81, v85
    v_cvt_pk_f16_f32 v229, v89, v93
    v_cvt_pk_f16_f32 v230, v97, v101
    v_cvt_pk_f16_f32 v231, v105, v109
    ds_write_b128 v234, v[228:231] offset:5120
    v_cvt_pk_f16_f32 v224, v82, v86
    v_cvt_pk_f16_f32 v225, v90, v94
    v_cvt_pk_f16_f32 v226, v98, v102
    v_cvt_pk_f16_f32 v227, v106, v110
    ds_write_b128 v234, v[224:227] offset:16384
    v_cvt_pk_f16_f32 v228, v83, v87
    v_cvt_pk_f16_f32 v229, v91, v95
    v_cvt_pk_f16_f32 v230, v99, v103
    v_cvt_pk_f16_f32 v231, v107, v111
    ds_write_b128 v234, v[228:231] offset:17408
    s_branch L_conv0
L_prep1:
    v_bfe_u32 v158, v129, 2, 1
    v_bfe_u32 v159, v129, 3, 2
    v_lshl_add_u32 v159, v158, 2, v159
    v_and_b32 v160, 3, v129
    v_lshl_add_u32 v159, v138, 4, v159
    s_lshl_b32 s60, s3, 6
    s_sub_u32 s60, s60, 128
    v_add_u32 v159, s60, v159
    v_xor_b32 v236, v138, v160
    v_lshlrev_b32 v236, 4, v236
    v_mad_u32_u24 v232, v159, s69, v236
    s_lshl_b32 s60, s3, 1
    s_sub_u32 s60, s60, 4
    v_add_u32 v159, s60, v158
    v_lshlrev_b32 v238, 11, v159
    v_add_u32 v238, 40960, v238
    v_mul_u32_u24 v159, 768, v159
    v_lshl_add_u32 v159, v158, 2, v159
    v_add_u32 v159, v160, v159
    v_bfe_u32 v160, v129, 3, 1
    v_lshl_add_u32 v159, v160, 6, v159
    v_lshrrev_b32 v160, 4, v129
    v_lshl_add_u32 v159, v160, 4, v159
    v_lshlrev_b32 v159, 4, v159
    v_add_u32 v234, 40960, v159
    v_xor_b32 v235, 64, v234
    s_add_u32 m0, s56, 0
    s_nop 0
    buffer_load_dwordx4 v1, s[20:23], 0 offen offset:0 lds
    s_add_u32 m0, s56, 1024
    s_nop 0
    buffer_load_dwordx4 v2, s[20:23], 0 offen offset:0 lds
    s_add_u32 m0, s56, 2048
    s_nop 0
    buffer_load_dwordx4 v3, s[20:23], 0 offen offset:0 lds
    s_add_u32 m0, s56, 3072
    s_nop 0
    buffer_load_dwordx4 v4, s[20:23], 0 offen offset:0 lds
    s_add_u32 m0, s56, 4096
    s_nop 0
    buffer_load_dwordx4 v5, s[20:23], 0 offen offset:0 lds
    s_add_u32 m0, s56, 5120
    s_nop 0
    buffer_load_dwordx4 v6, s[20:23], 0 offen offset:0 lds
    s_add_u32 m0, s56, 6144
    s_nop 0
    buffer_load_dword v7, s[20:23], 0 offen offset:0 lds
    v_mov_b32 v157, 268435456
    v_and_b32 v152, 15, v129
    v_lshrrev_b32 v153, 4, v129
    v_add_u32 v154, 4, v152
    v_lshrrev_b32 v154, 3, v154
    v_mad_i32_i24 v155, v154, -4, v152
    v_and_b32 v154, 1, v154
    v_and_b32 v156, 1, v153
    v_lshlrev_b32 v158, 1, v154
    v_mul_u32_u24 v159, 98304, v158
    v_mad_u32_u24 v159, v155, s69, v159
    v_lshl_add_u32 v159, v153, 4, v159
    v_add_u32 v26, s63, v159
    v_xor_b32 v161, v154, v138
    v_add_u32 v159, v153, v158
    v_add_u32 v160, 0, v155
    v_mad_u32_u24 v159, v159, 10, v160
    v_bfe_u32 v160, v160, 2, 1
    v_lshl_or_b32 v160, v161, 1, v160
    v_lshl_add_u32 v160, v159, 2, v160
    v_lshl_add_u32 v8, v160, 4, s56
    v_add_u32 v162, 1, v156
    v_add_u32 v159, v138, v158
    v_add_u32 v160, v162, v155
    v_mad_u32_u24 v159, v159, 10, v160
    v_bfe_u32 v160, v160, 2, 1
    v_lshl_or_b32 v160, v154, 1, v160
    v_lshl_add_u32 v160, v159, 2, v160
    v_lshl_add_u32 v12, v160, 4, s56
    v_xor_b32 v9, 16, v8
    v_xor_b32 v10, 32, v8
    v_xor_b32 v11, 48, v8
    v_xor_b32 v13, 16, v12
    v_xor_b32 v14, 32, v12
    v_xor_b32 v15, 48, v12
    v_add_u32 v159, 1, v158
    v_add_u32 v160, 1, v155
    v_mad_u32_u24 v159, v159, 10, v160
    v_bfe_u32 v160, v160, 2, 1
    v_lshl_or_b32 v160, v154, 1, v160
    v_xor_b32 v160, v153, v160
    v_lshl_add_u32 v160, v159, 2, v160
    v_lshl_add_u32 v20, v160, 4, s56
    v_xor_b32 v21, 32, v20
    v_add_u32 v21, 640, v21
    v_bfe_u32 v158, v152, 2, 1
    v_sub_u32 v158, v153, v158
    v_and_b32 v159, 3, v152
    v_mul_u32_u24 v16, 0x1111, v159
    v_lshrrev_b32 v160, 3, v152
    v_lshl_add_u32 v159, v160, 2, v159
    v_lshlrev_b32 v159, 5, v159
    v_add_u32 v159, 141312, v159
    s_movk_i32 s70, 3072
    v_cmp_gt_u32 vcc, 3, v158
    v_mad_u32_u24 v159, v158, s70, v159
    s_nop 0
    v_cndmask_b32 v22, v157, v159, vcc
    v_lshlrev_b32 v23, 4, v129
    v_add_u32 v24, 40960, v23
    v_lshlrev_b32 v25, 5, v153
    v_add_u32 v25, 150528, v25
    v_and_b32 v160, 1, v129
    v_lshlrev_b32 v160, 4, v160
    v_mov_b32 v161, 0x3f80
    v_lshlrev_b32 v160, v160, v161
    v_bfe_u32 v158, v129, 1, 1
    v_bfe_u32 v159, v129, 3, 2
    v_lshl_add_u32 v159, v159, 1, v158
    v_bfe_u32 v161, v129, 2, 1
    v_xor_b32 v161, v161, v138
    v_lshl_add_u32 v159, v161, 3, v159
    v_lshlrev_b32 v159, v159, 1
    v_lshrrev_b32 v161, 2, v152
    v_xor_b32 v161, v161, v153
    v_lshl_add_u32 v158, v161, 1, v158
    v_lshlrev_b32 v158, v158, 1
    v_bfe_i32 v240, v159, 0, 1
    v_bfe_i32 v241, v159, 1, 1
    v_bfe_i32 v242, v159, 2, 1
    v_bfe_i32 v243, v159, 3, 1
    v_bfe_i32 v244, v159, 4, 1
    v_bfe_i32 v245, v159, 5, 1
    v_bfe_i32 v246, v159, 6, 1
    v_bfe_i32 v247, v159, 7, 1
    v_bfe_i32 v18, v158, 0, 1
    v_bfe_i32 v19, v158, 1, 1
    v_and_b32 v240, v160, v240
    v_and_b32 v241, v160, v241
    v_and_b32 v242, v160, v242
    v_and_b32 v243, v160, v243
    v_and_b32 v244, v160, v244
    v_and_b32 v245, v160, v245
    v_and_b32 v246, v160, v246
    v_and_b32 v247, v160, v247
    v_and_b32 v18, v160, v18
    v_and_b32 v19, v160, v19
    s_mov_b32 s24, s18
    s_mov_b32 s25, s19
    s_mov_b32 s26, 50331648
    s_mov_b32 s27, 0x20000
    s_mov_b32 s52, 0
    s_mov_b32 s80, 0
    s_mov_b32 s81, 98304
    s_mov_b32 s82, 393216
    s_mov_b32 s83, 491520
    s_mov_b32 s53, 1156138217
    s_mov_b32 s58, 0x3c003c00
    s_mov_b32 s85, 150912
    s_mov_b32 s86, 0x37803780
    s_mov_b32 s84, 0x37800000
    v_lshlrev_b32 v17, 4, v138
    v_lshrrev_b32 v17, v17, -1
    s_mov_b32 s73, 0x409d2a01
    s_mov_b32 s59, 0x3ef00000
    v_mul_u32_u24 v252, 0x100010, v0
    v_add_u32 v252, 0xc0004, v252
    v_lshlrev_b32 v253, 2, v0
    v_add_u32 v253, 150912, v253
    v_add_u32 v80, 0x0, v252
    v_add_u32 v88, 0x10001000, v252
    v_cvt_f32_f16 v81, v80
    v_cvt_f32_f16 v89, v88
    v_cvt_f32_f16_sdwa v82, v80 dst_sel:DWORD dst_unused:UNUSED_PAD src0_sel:WORD_1
    v_cvt_f32_f16_sdwa v90, v88 dst_sel:DWORD dst_unused:UNUSED_PAD src0_sel:WORD_1
    v_mul_f32 v83, 0x3f7fdde7, v81
    v_mul_f32 v91, 0x3f7fdde7, v89
    v_mul_f32 v84, 0x3f7fdde7, v82
    v_mul_f32 v92, 0x3f7fdde7, v90
    v_fma_f32 v83, v83, v81, s73
    v_fma_f32 v91, v91, v89, s73
    v_fma_f32 v84, v84, v82, s73
    v_fma_f32 v92, v92, v90, s73
    v_mul_f32 v83, -v81, v83
    v_mul_f32 v91, -v89, v91
    v_mul_f32 v84, -v82, v84
    v_mul_f32 v92, -v90, v92
    v_exp_f32 v85, v83
    v_exp_f32 v93, v91
    v_exp_f32 v86, v84
    v_exp_f32 v94, v92
    v_fma_f32 v83, v85, s59, s59
    v_fma_f32 v91, v93, s59, s59
    v_fma_f32 v84, v86, s59, s59
    v_fma_f32 v92, v94, s59, s59
    v_rcp_f32 v83, v83
    v_rcp_f32 v91, v91
    v_rcp_f32 v84, v84
    v_rcp_f32 v92, v92
    v_mul_f32 v83, v81, v83
    v_mul_f32 v91, v89, v91
    v_mul_f32 v84, v82, v84
    v_mul_f32 v92, v90, v92
    v_mul_f32 v85, -v85, v83
    v_mul_f32 v93, -v93, v91
    v_mul_f32 v86, -v86, v84
    v_mul_f32 v94, -v94, v92
    v_cvt_pk_bf16_f32 v87, v85, v86
    v_cvt_pk_bf16_f32 v95, v93, v94
    v_cvt_pk_bf16_f32 v80, v83, v84
    v_cvt_pk_bf16_f32 v88, v91, v92
    ds_write_b32 v253, v87 offset:8192
    ds_write_b32 v253, v80 offset:0
    ds_write_b32 v253, v95 offset:9216
    ds_write_b32 v253, v88 offset:1024
    v_add_u32 v80, 0x20002000, v252
    s_nop 0
    v_add_u32 v88, 0x30003000, v252
    v_cvt_f32_f16 v81, v80
    v_cvt_f32_f16 v89, v88
    v_cvt_f32_f16_sdwa v82, v80 dst_sel:DWORD dst_unused:UNUSED_PAD src0_sel:WORD_1
    v_cvt_f32_f16_sdwa v90, v88 dst_sel:DWORD dst_unused:UNUSED_PAD src0_sel:WORD_1
    v_mul_f32 v83, 0x3f7fdde7, v81
    v_mul_f32 v91, 0x3f7fdde7, v89
    v_mul_f32 v84, 0x3f7fdde7, v82
    v_mul_f32 v92, 0x3f7fdde7, v90
    v_fma_f32 v83, v83, v81, s73
    v_fma_f32 v91, v91, v89, s73
    v_fma_f32 v84, v84, v82, s73
    v_fma_f32 v92, v92, v90, s73
    v_mul_f32 v83, -v81, v83
    v_mul_f32 v91, -v89, v91
    v_mul_f32 v84, -v82, v84
    v_mul_f32 v92, -v90, v92
    v_exp_f32 v85, v83
    v_exp_f32 v93, v91
    v_exp_f32 v86, v84
    v_exp_f32 v94, v92
    v_fma_f32 v83, v85, s59, s59
    v_fma_f32 v91, v93, s59, s59
    v_fma_f32 v84, v86, s59, s59
    v_fma_f32 v92, v94, s59, s59
    v_rcp_f32 v83, v83
    v_rcp_f32 v91, v91
    v_rcp_f32 v84, v84
    v_rcp_f32 v92, v92
    v_mul_f32 v83, v81, v83
    v_mul_f32 v91, v89, v91
    v_mul_f32 v84, v82, v84
    v_mul_f32 v92, v90, v92
    v_mul_f32 v85, -v85, v83
    v_mul_f32 v93, -v93, v91
    v_mul_f32 v86, -v86, v84
    v_mul_f32 v94, -v94, v92
    v_cvt_pk_bf16_f32 v87, v85, v86
    v_cvt_pk_bf16_f32 v95, v93, v94
    v_cvt_pk_bf16_f32 v80, v83, v84
    v_cvt_pk_bf16_f32 v88, v91, v92
    ds_write_b32 v253, v87 offset:10240
    ds_write_b32 v253, v80 offset:2048
    ds_write_b32 v253, v95 offset:11264
    ds_write_b32 v253, v88 offset:3072
    v_add_u32 v80, 0x40004000, v252
    s_nop 0
    v_add_u32 v88, 0x50005000, v252
    v_add_u32 v96, 0x60006000, v252
    v_add_u32 v104, 0x70007000, v252
    v_cvt_f32_f16 v81, v80
    v_cvt_f32_f16 v89, v88
    v_cvt_f32_f16 v97, v96
    v_cvt_f32_f16 v105, v104
    v_cvt_f32_f16_sdwa v82, v80 dst_sel:DWORD dst_unused:UNUSED_PAD src0_sel:WORD_1
    v_cvt_f32_f16_sdwa v90, v88 dst_sel:DWORD dst_unused:UNUSED_PAD src0_sel:WORD_1
    v_cvt_f32_f16_sdwa v98, v96 dst_sel:DWORD dst_unused:UNUSED_PAD src0_sel:WORD_1
    v_cvt_f32_f16_sdwa v106, v104 dst_sel:DWORD dst_unused:UNUSED_PAD src0_sel:WORD_1
    v_mul_f32 v83, 0x3f7fdde7, v81
    v_mul_f32 v91, 0x40088889, v89
    v_mul_f32 v99, 0x40088889, v97
    v_mul_f32 v107, 0x40088889, v105
    v_mul_f32 v84, 0x3f7fdde7, v82
    v_mul_f32 v92, 0x40088889, v90
    v_mul_f32 v100, 0x40088889, v98
    v_mul_f32 v108, 0x40088889, v106
    v_fma_f32 v83, v83, v81, s73
    v_cvt_pk_bf16_f32 v88, v91, v92
    v_cvt_pk_bf16_f32 v96, v99, v100
    v_cvt_pk_bf16_f32 v104, v107, v108
    v_fma_f32 v84, v84, v82, s73
    v_mul_f32 v83, -v81, v83
    v_mul_f32 v84, -v82, v84
    v_exp_f32 v85, v83
    v_exp_f32 v86, v84
    v_fma_f32 v83, v85, s59, s59
    v_fma_f32 v84, v86, s59, s59
    v_rcp_f32 v83, v83
    v_rcp_f32 v84, v84
    v_mul_f32 v83, v81, v83
    v_mul_f32 v84, v82, v84
    v_mul_f32 v85, -v85, v83
    v_mul_f32 v86, -v86, v84
    v_cvt_pk_bf16_f32 v87, v85, v86
    v_cvt_pk_bf16_f32 v80, v83, v84
    ds_write_b32 v253, v87 offset:12288
    ds_write_b32 v253, v80 offset:4096
    ds_write_b32 v253, v88 offset:5120
    ds_write_b32 v253, v96 offset:6144
    ds_write_b32 v253, v104 offset:7168
    buffer_load_dwordx4 v[208:211], v236, s[40:43], 0 offen offset:0
    buffer_load_dwordx4 v[212:215], v236, s[40:43], 0 offen offset:64
    buffer_load_dwordx4 v[216:219], v236, s[40:43], 0 offen offset:128
    s_mov_b32 s74, 0
    s_mov_b32 s75, 6144
    buffer_load_dwordx4 a[0:3], v232, s[48:51], s74 offen offset:0
    buffer_load_dwordx4 a[4:7], v232, s[48:51], s75 offen offset:0
    buffer_load_dwordx4 a[8:11], v232, s[48:51], s74 offen offset:1536
    buffer_load_dwordx4 a[12:15], v232, s[48:51], s75 offen offset:1536
    buffer_load_dwordx4 a[16:19], v232, s[48:51], s74 offen offset:64
    buffer_load_dwordx4 a[20:23], v232, s[48:51], s75 offen offset:64
    buffer_load_dwordx4 a[24:27], v232, s[48:51], s74 offen offset:1600
    buffer_load_dwordx4 a[28:31], v232, s[48:51], s75 offen offset:1600
    v_lshlrev_b32 v158, 6, v0
    v_add_u32 v158, 141312, v158
    v_cmp_gt_u32 vcc, 144, v0
    s_nop 1
    v_cndmask_b32 v158, v157, v158, vcc
    v_and_b32 v159, 3, v0
    v_lshl_add_u32 v160, v159, 2, v158
    v_lshrrev_b32 v159, 1, v159
    v_lshl_add_u32 v159, v159, 2, v158
    v_lshlrev_b32 v161, 4, v0
    v_add_u32 v161, 150528, v161
    v_cmp_gt_u32 vcc, 24, v0
    s_nop 1
    v_cndmask_b32 v161, v157, v161, vcc
    v_mov_b32 v164, 0
    v_mov_b32 v165, 0
    v_mov_b32 v166, 0
    v_mov_b32 v167, 0
    ds_write_b128 v158, v[164:167]
    ds_write_b128 v158, v[164:167] offset:16
    s_waitcnt lgkmcnt(9)
    ds_write_b128 v158, v[164:167] offset:32
    ds_write_b128 v158, v[164:167] offset:48
    s_waitcnt vmcnt(22)
    ds_write_b16 v160, v144
    ds_write_b16_d16_hi v160, v144 offset:34
    s_waitcnt vmcnt(21)
    ds_write_b16 v159, v145 offset:16
    ds_write_b16_d16_hi v159, v145 offset:48
    s_waitcnt vmcnt(20) lgkmcnt(13)
    ds_write_b16 v159, v146 offset:24
    ds_write_b16_d16_hi v159, v146 offset:56
    s_waitcnt vmcnt(19)
    v_lshlrev_b32 v168, 16, v148
    v_and_b32 v169, 0xffff0000, v148
    v_lshlrev_b32 v170, 16, v149
    v_and_b32 v171, 0xffff0000, v149
    s_waitcnt vmcnt(18)
    v_lshlrev_b32 v172, 16, v150
    v_and_b32 v173, 0xffff0000, v150
    v_lshlrev_b32 v174, 16, v151
    v_and_b32 v175, 0xffff0000, v151
    v_mul_f32 v168, v168, v172
    v_mul_f32 v169, v169, v173
    v_mul_f32 v170, v170, v174
    v_mul_f32 v171, v171, v175
    s_waitcnt lgkmcnt(14)
    ds_write_b128 v161, v[168:171]
    buffer_load_dwordx4 a[32:35], v232, s[48:51], s74 offen offset:128
    buffer_load_dwordx4 a[36:39], v232, s[48:51], s75 offen offset:128
    buffer_load_dwordx4 a[40:43], v232, s[48:51], s74 offen offset:1664
    buffer_load_dwordx4 a[44:47], v232, s[48:51], s75 offen offset:1664
    s_mov_b32 s74, 24576
    s_mov_b32 s75, 30720
    buffer_load_dwordx4 a[48:51], v232, s[48:51], s74 offen offset:0
    buffer_load_dwordx4 a[52:55], v232, s[48:51], s75 offen offset:0
    buffer_load_dwordx4 a[56:59], v232, s[48:51], s74 offen offset:1536
    buffer_load_dwordx4 a[60:63], v232, s[48:51], s75 offen offset:1536
    buffer_load_dwordx4 a[64:67], v232, s[48:51], s74 offen offset:64
    buffer_load_dwordx4 a[68:71], v232, s[48:51], s75 offen offset:64
    buffer_load_dwordx4 a[72:75], v232, s[48:51], s74 offen offset:1600
    buffer_load_dwordx4 a[76:79], v232, s[48:51], s75 offen offset:1600
    s_waitcnt vmcnt(22)
    v_mfma_f32_32x32x16_bf16 v[176:191], v[208:211], v[240:243], 0
    v_mfma_f32_32x32x16_bf16 v[176:191], v[208:211], v[244:247], v[176:191]
    s_waitcnt vmcnt(21)
    s_nop 10
    v_mfma_f32_32x32x16_bf16 v[180:195], v[212:215], v[240:243], 0
    v_mfma_f32_32x32x16_bf16 v[180:195], v[212:215], v[244:247], v[180:195]
    s_waitcnt vmcnt(20)
    s_nop 10
    v_mfma_f32_32x32x16_bf16 v[184:199], v[216:219], v[240:243], 0
    v_mfma_f32_32x32x16_bf16 v[184:199], v[216:219], v[244:247], v[184:199]
    s_waitcnt vmcnt(19)
    v_mfma_f32_32x32x16_bf16 v[80:95], a[0:3], v[240:243], 0
    s_waitcnt vmcnt(17)
    v_mfma_f32_32x32x16_bf16 v[96:111], a[8:11], v[240:243], 0
    v_mfma_f32_32x32x16_bf16 v[80:95], a[4:7], v[244:247], v[80:95]
    s_waitcnt vmcnt(16)
    v_mfma_f32_32x32x16_bf16 v[96:111], a[12:15], v[244:247], v[96:111]
    s_waitcnt vmcnt(15)
    v_mfma_f32_32x32x16_bf16 v[112:127], a[16:19], v[240:243], 0
    s_nop 7
    v_pk_mul_f32 v[80:81], v[80:81], v[176:177]
    v_pk_mul_f32 v[84:85], v[84:85], v[176:177]
    v_pk_mul_f32 v[88:89], v[88:89], v[176:177]
    v_pk_mul_f32 v[92:93], v[92:93], v[176:177]
    v_pk_mul_f32 v[96:97], v[96:97], v[176:177]
    v_pk_mul_f32 v[100:101], v[100:101], v[176:177]
    v_pk_mul_f32 v[104:105], v[104:105], v[176:177]
    v_pk_mul_f32 v[108:109], v[108:109], v[176:177]
    v_cvt_pk_bf16_f32 v224, v80, v84
    v_cvt_pk_bf16_f32 v225, v88, v92
    v_cvt_pk_bf16_f32 v226, v96, v100
    v_cvt_pk_bf16_f32 v227, v104, v108
    s_waitcnt lgkmcnt(14)
    ds_write_b128 v234, v[224:227] offset:6144
    buffer_load_dwordx4 a[80:83], v232, s[48:51], s74 offen offset:128
    s_waitcnt vmcnt(14)
    v_mfma_f32_32x32x16_bf16 v[128:143], a[24:27], v[240:243], 0
    v_cvt_pk_bf16_f32 v228, v81, v85
    v_cvt_pk_bf16_f32 v229, v89, v93
    v_cvt_pk_bf16_f32 v230, v97, v101
    v_cvt_pk_bf16_f32 v231, v105, v109
    s_waitcnt lgkmcnt(14)
    ds_write_b128 v235, v[228:231] offset:6144
    buffer_load_dwordx4 a[84:87], v232, s[48:51], s75 offen offset:128
    v_mfma_f32_32x32x16_bf16 v[112:127], a[20:23], v[244:247], v[112:127]
    v_pk_mul_f32 v[82:83], v[82:83], v[178:179]
    v_pk_mul_f32 v[86:87], v[86:87], v[178:179]
    v_pk_mul_f32 v[90:91], v[90:91], v[178:179]
    v_pk_mul_f32 v[94:95], v[94:95], v[178:179]
    v_pk_mul_f32 v[98:99], v[98:99], v[178:179]
    v_pk_mul_f32 v[102:103], v[102:103], v[178:179]
    v_pk_mul_f32 v[106:107], v[106:107], v[178:179]
    v_pk_mul_f32 v[110:111], v[110:111], v[178:179]
    v_cvt_pk_bf16_f32 v224, v82, v86
    v_cvt_pk_bf16_f32 v225, v90, v94
    v_cvt_pk_bf16_f32 v226, v98, v102
    v_cvt_pk_bf16_f32 v227, v106, v110
    s_waitcnt lgkmcnt(14)
    ds_write_b128 v234, v[224:227] offset:6272
    buffer_load_dwordx4 a[88:91], v232, s[48:51], s74 offen offset:1664
    s_waitcnt vmcnt(15)
    v_mfma_f32_32x32x16_bf16 v[128:143], a[28:31], v[244:247], v[128:143]
    v_cvt_pk_bf16_f32 v228, v83, v87
    v_cvt_pk_bf16_f32 v229, v91, v95
    v_cvt_pk_bf16_f32 v230, v99, v103
    v_cvt_pk_bf16_f32 v231, v107, v111
    s_waitcnt lgkmcnt(14)
    ds_write_b128 v235, v[228:231] offset:6272
    buffer_load_dwordx4 a[92:95], v232, s[48:51], s75 offen offset:1664
    s_waitcnt vmcnt(15)
    v_mfma_f32_32x32x16_bf16 v[80:95], a[32:35], v[240:243], 0
    v_pk_mul_f32 v[112:113], v[112:113], v[180:181]
    v_pk_mul_f32 v[116:117], v[116:117], v[180:181]
    v_pk_mul_f32 v[120:121], v[120:121], v[180:181]
    v_pk_mul_f32 v[124:125], v[124:125], v[180:181]
    v_pk_mul_f32 v[128:129], v[128:129], v[180:181]
    v_pk_mul_f32 v[132:133], v[132:133], v[180:181]
    v_pk_mul_f32 v[136:137], v[136:137], v[180:181]
    v_pk_mul_f32 v[140:141], v[140:141], v[180:181]
    v_cvt_pk_bf16_f32 v224, v112, v116
    v_cvt_pk_bf16_f32 v225, v120, v124
    v_cvt_pk_bf16_f32 v226, v128, v132
    v_cvt_pk_bf16_f32 v227, v136, v140
    s_waitcnt lgkmcnt(14)
    ds_write_b128 v234, v[224:227] offset:8192
    s_mov_b32 s74, 49152
    s_waitcnt vmcnt(13)
    v_mfma_f32_32x32x16_bf16 v[96:111], a[40:43], v[240:243], 0
    v_cvt_pk_bf16_f32 v228, v113, v117
    v_cvt_pk_bf16_f32 v229, v121, v125
    v_cvt_pk_bf16_f32 v230, v129, v133
    v_cvt_pk_bf16_f32 v231, v137, v141
    s_waitcnt lgkmcnt(14)
    ds_write_b128 v235, v[228:231] offset:8192
    s_mov_b32 s75, 55296
    buffer_load_dwordx4 v[32:35], v232, s[48:51], s74 offen offset:0
    v_mfma_f32_32x32x16_bf16 v[80:95], a[36:39], v[244:247], v[80:95]
    v_pk_mul_f32 v[114:115], v[114:115], v[182:183]
    v_pk_mul_f32 v[118:119], v[118:119], v[182:183]
    v_pk_mul_f32 v[122:123], v[122:123], v[182:183]
    v_pk_mul_f32 v[126:127], v[126:127], v[182:183]
    v_pk_mul_f32 v[130:131], v[130:131], v[182:183]
    v_pk_mul_f32 v[134:135], v[134:135], v[182:183]
    v_pk_mul_f32 v[138:139], v[138:139], v[182:183]
    v_pk_mul_f32 v[142:143], v[142:143], v[182:183]
    v_cvt_pk_bf16_f32 v224, v114, v118
    v_cvt_pk_bf16_f32 v225, v122, v126
    v_cvt_pk_bf16_f32 v226, v130, v134
    v_cvt_pk_bf16_f32 v227, v138, v142
    s_waitcnt lgkmcnt(14)
    ds_write_b128 v234, v[224:227] offset:8320
    buffer_load_dwordx4 v[36:39], v232, s[48:51], s75 offen offset:0
    s_waitcnt vmcnt(14)
    v_mfma_f32_32x32x16_bf16 v[96:111], a[44:47], v[244:247], v[96:111]
    v_cvt_pk_bf16_f32 v228, v115, v119
    v_cvt_pk_bf16_f32 v229, v123, v127
    v_cvt_pk_bf16_f32 v230, v131, v135
    v_cvt_pk_bf16_f32 v231, v139, v143
    s_waitcnt lgkmcnt(14)
    ds_write_b128 v235, v[228:231] offset:8320
    buffer_load_dwordx4 v[40:43], v232, s[48:51], s74 offen offset:1536
    buffer_load_dwordx4 v[44:47], v232, s[48:51], s75 offen offset:1536
    s_waitcnt vmcnt(15)
    v_mfma_f32_32x32x16_bf16 v[112:127], a[48:51], v[240:243], 0
    v_pk_mul_f32 v[80:81], v[80:81], v[184:185]
    v_pk_mul_f32 v[84:85], v[84:85], v[184:185]
    v_pk_mul_f32 v[88:89], v[88:89], v[184:185]
    v_pk_mul_f32 v[92:93], v[92:93], v[184:185]
    v_pk_mul_f32 v[96:97], v[96:97], v[184:185]
    v_pk_mul_f32 v[100:101], v[100:101], v[184:185]
    v_pk_mul_f32 v[104:105], v[104:105], v[184:185]
    v_pk_mul_f32 v[108:109], v[108:109], v[184:185]
    v_cvt_pk_bf16_f32 v224, v80, v84
    v_cvt_pk_bf16_f32 v225, v88, v92
    v_cvt_pk_bf16_f32 v226, v96, v100
    v_cvt_pk_bf16_f32 v227, v104, v108
    s_waitcnt lgkmcnt(14)
    ds_write_b128 v234, v[224:227] offset:10240
    buffer_load_dwordx4 v[48:51], v232, s[48:51], s74 offen offset:64
    s_waitcnt vmcnt(14)
    v_mfma_f32_32x32x16_bf16 v[128:143], a[56:59], v[240:243], 0
    v_cvt_pk_bf16_f32 v228, v81, v85
    v_cvt_pk_bf16_f32 v229, v89, v93
    v_cvt_pk_bf16_f32 v230, v97, v101
    v_cvt_pk_bf16_f32 v231, v105, v109
    s_waitcnt lgkmcnt(14)
    ds_write_b128 v235, v[228:231] offset:10240
    buffer_load_dwordx4 v[52:55], v232, s[48:51], s75 offen offset:64
    v_mfma_f32_32x32x16_bf16 v[112:127], a[52:55], v[244:247], v[112:127]
    v_pk_mul_f32 v[82:83], v[82:83], v[186:187]
    v_pk_mul_f32 v[86:87], v[86:87], v[186:187]
    v_pk_mul_f32 v[90:91], v[90:91], v[186:187]
    v_pk_mul_f32 v[94:95], v[94:95], v[186:187]
    v_pk_mul_f32 v[98:99], v[98:99], v[186:187]
    v_pk_mul_f32 v[102:103], v[102:103], v[186:187]
    v_pk_mul_f32 v[106:107], v[106:107], v[186:187]
    v_pk_mul_f32 v[110:111], v[110:111], v[186:187]
    v_cvt_pk_bf16_f32 v224, v82, v86
    v_cvt_pk_bf16_f32 v225, v90, v94
    v_cvt_pk_bf16_f32 v226, v98, v102
    v_cvt_pk_bf16_f32 v227, v106, v110
    s_waitcnt lgkmcnt(14)
    ds_write_b128 v234, v[224:227] offset:10368
    buffer_load_dwordx4 v[56:59], v232, s[48:51], s74 offen offset:1600
    s_waitcnt vmcnt(15)
    v_mfma_f32_32x32x16_bf16 v[128:143], a[60:63], v[244:247], v[128:143]
    v_cvt_pk_bf16_f32 v228, v83, v87
    v_cvt_pk_bf16_f32 v229, v91, v95
    v_cvt_pk_bf16_f32 v230, v99, v103
    v_cvt_pk_bf16_f32 v231, v107, v111
    s_waitcnt lgkmcnt(14)
    ds_write_b128 v235, v[228:231] offset:10368
    v_sub_u32 v234, v234, v238
    v_sub_u32 v235, v235, v238
    buffer_load_dwordx4 v[60:63], v232, s[48:51], s75 offen offset:1600
    s_waitcnt lgkmcnt(0)
    s_barrier
    s_waitcnt vmcnt(15)
    v_mfma_f32_32x32x16_bf16 v[80:95], a[64:67], v[240:243], 0
    v_pk_mul_f32 v[112:113], v[112:113], v[176:177]
    v_pk_mul_f32 v[116:117], v[116:117], v[176:177]
    v_pk_mul_f32 v[120:121], v[120:121], v[176:177]
    v_pk_mul_f32 v[124:125], v[124:125], v[176:177]
    v_pk_mul_f32 v[128:129], v[128:129], v[176:177]
    v_pk_mul_f32 v[132:133], v[132:133], v[176:177]
    v_pk_mul_f32 v[136:137], v[136:137], v[176:177]
    v_pk_mul_f32 v[140:141], v[140:141], v[176:177]
    v_cvt_pk_bf16_f32 v224, v112, v116
    v_cvt_pk_bf16_f32 v225, v120, v124
    v_cvt_pk_bf16_f32 v226, v128, v132
    v_cvt_pk_bf16_f32 v227, v136, v140
    ds_write_b128 v234, v[224:227] offset:6144
    ds_read_b128 a[0:3], v24 offset:0
    ds_read_b128 a[4:7], v24 offset:1024
    ds_read_b128 a[8:11], v24 offset:2048
    ds_read_b128 a[12:15], v24 offset:3072
    ds_read_b128 a[16:19], v24 offset:4096
    ds_read_b128 a[20:23], v24 offset:5120
    buffer_load_dwordx4 v[64:67], v232, s[48:51], s74 offen offset:128
    s_waitcnt vmcnt(14)
    v_mfma_f32_32x32x16_bf16 v[96:111], a[72:75], v[240:243], 0
    v_cvt_pk_bf16_f32 v228, v113, v117
    v_cvt_pk_bf16_f32 v229, v121, v125
    v_cvt_pk_bf16_f32 v230, v129, v133
    v_cvt_pk_bf16_f32 v231, v137, v141
    ds_write_b128 v235, v[228:231] offset:6144
    ds_read_b128 a[24:27], v24 offset:6144
    ds_read_b128 a[28:31], v24 offset:7168
    ds_read_b128 a[32:35], v24 offset:8192
    ds_read_b128 a[36:39], v24 offset:9216
    ds_read_b128 a[40:43], v24 offset:10240
    ds_read_b128 a[44:47], v24 offset:11264
    buffer_load_dwordx4 v[68:71], v232, s[48:51], s75 offen offset:128
    v_mfma_f32_32x32x16_bf16 v[80:95], a[68:71], v[244:247], v[80:95]
    v_pk_mul_f32 v[114:115], v[114:115], v[178:179]
    v_pk_mul_f32 v[118:119], v[118:119], v[178:179]
    v_pk_mul_f32 v[122:123], v[122:123], v[178:179]
    v_pk_mul_f32 v[126:127], v[126:127], v[178:179]
    v_pk_mul_f32 v[130:131], v[130:131], v[178:179]
    v_pk_mul_f32 v[134:135], v[134:135], v[178:179]
    v_pk_mul_f32 v[138:139], v[138:139], v[178:179]
    v_pk_mul_f32 v[142:143], v[142:143], v[178:179]
    v_cvt_pk_bf16_f32 v224, v114, v118
    v_cvt_pk_bf16_f32 v225, v122, v126
    v_cvt_pk_bf16_f32 v226, v130, v134
    v_cvt_pk_bf16_f32 v227, v138, v142
    ds_write_b128 v234, v[224:227] offset:6272
    s_waitcnt lgkmcnt(9)
    ds_read_b128 a[96:99], v24 offset:24576
    ds_read_b128 a[100:103], v24 offset:25600
    ds_read_b128 a[104:107], v24 offset:26624
    ds_read_b128 a[108:111], v24 offset:27648
    ds_read_b128 a[112:115], v24 offset:28672
    ds_read_b128 a[116:119], v24 offset:29696
    buffer_load_dwordx4 v[72:75], v232, s[48:51], s74 offen offset:1664
    s_waitcnt vmcnt(15)
    v_mfma_f32_32x32x16_bf16 v[96:111], a[76:79], v[244:247], v[96:111]
    v_cvt_pk_bf16_f32 v228, v115, v119
    v_cvt_pk_bf16_f32 v229, v123, v127
    v_cvt_pk_bf16_f32 v230, v131, v135
    v_cvt_pk_bf16_f32 v231, v139, v143
    s_waitcnt lgkmcnt(9)
    ds_write_b128 v235, v[228:231] offset:6272
    ds_read_b128 a[120:123], v24 offset:30720
    ds_read_b128 a[124:127], v24 offset:31744
    ds_read_b128 a[128:131], v24 offset:32768
    ds_read_b128 a[132:135], v24 offset:33792
    ds_read_b128 a[136:139], v24 offset:34816
    s_waitcnt lgkmcnt(14)
    ds_read_b128 a[140:143], v24 offset:35840
    buffer_load_dwordx4 v[76:79], v232, s[48:51], s75 offen offset:1664
    s_waitcnt vmcnt(15)
    v_mfma_f32_32x32x16_bf16 v[112:127], a[80:83], v[240:243], 0
    v_pk_mul_f32 v[80:81], v[80:81], v[180:181]
    v_pk_mul_f32 v[84:85], v[84:85], v[180:181]
    v_pk_mul_f32 v[88:89], v[88:89], v[180:181]
    v_pk_mul_f32 v[92:93], v[92:93], v[180:181]
    v_pk_mul_f32 v[96:97], v[96:97], v[180:181]
    v_pk_mul_f32 v[100:101], v[100:101], v[180:181]
    v_pk_mul_f32 v[104:105], v[104:105], v[180:181]
    v_pk_mul_f32 v[108:109], v[108:109], v[180:181]
    v_cvt_pk_bf16_f32 v224, v80, v84
    v_cvt_pk_bf16_f32 v225, v88, v92
    v_cvt_pk_bf16_f32 v226, v96, v100
    v_cvt_pk_bf16_f32 v227, v104, v108
    s_waitcnt lgkmcnt(9)
    ds_write_b128 v234, v[224:227] offset:8192
    ds_read_b128 a[144:147], v24 offset:36864
    ds_read_b128 a[148:151], v24 offset:37888
    ds_read_b128 a[152:155], v24 offset:38912
    ds_read_b128 a[156:159], v24 offset:39936
    ds_read_b128 a[160:163], v24 offset:40960
    s_waitcnt lgkmcnt(14)
    ds_read_b128 a[164:167], v24 offset:41984
    s_add_u32 m0, s56, 6336
    s_nop 0
    buffer_load_dwordx4 v1, s[20:23], 0 offen offset:64 lds
    s_add_u32 m0, s56, 7360
    s_waitcnt vmcnt(14)
    v_mfma_f32_32x32x16_bf16 v[128:143], a[88:91], v[240:243], 0
    v_cvt_pk_bf16_f32 v228, v81, v85
    v_cvt_pk_bf16_f32 v229, v89, v93
    v_cvt_pk_bf16_f32 v230, v97, v101
    v_cvt_pk_bf16_f32 v231, v105, v109
    s_waitcnt lgkmcnt(9)
    ds_write_b128 v235, v[228:231] offset:8192
    ds_read_b128 a[168:171], v24 offset:43008
    ds_read_b128 a[172:175], v24 offset:44032
    ds_read_b128 a[176:179], v24 offset:45056
    ds_read_b128 a[180:183], v24 offset:46080
    ds_read_b128 a[184:187], v24 offset:47104
    s_waitcnt lgkmcnt(14)
    ds_read_b128 a[188:191], v24 offset:48128
    buffer_load_dwordx4 v2, s[20:23], 0 offen offset:64 lds
    s_add_u32 m0, s56, 8384
    s_nop 0
    buffer_load_dwordx4 v3, s[20:23], 0 offen offset:64 lds
    s_add_u32 m0, s56, 9408
    v_mfma_f32_32x32x16_bf16 v[112:127], a[84:87], v[244:247], v[112:127]
    v_pk_mul_f32 v[82:83], v[82:83], v[182:183]
    v_pk_mul_f32 v[86:87], v[86:87], v[182:183]
    v_pk_mul_f32 v[90:91], v[90:91], v[182:183]
    v_pk_mul_f32 v[94:95], v[94:95], v[182:183]
    v_pk_mul_f32 v[98:99], v[98:99], v[182:183]
    v_pk_mul_f32 v[102:103], v[102:103], v[182:183]
    v_pk_mul_f32 v[106:107], v[106:107], v[182:183]
    v_pk_mul_f32 v[110:111], v[110:111], v[182:183]
    v_cvt_pk_bf16_f32 v224, v82, v86
    v_cvt_pk_bf16_f32 v225, v90, v94
    v_cvt_pk_bf16_f32 v226, v98, v102
    v_cvt_pk_bf16_f32 v227, v106, v110
    s_waitcnt lgkmcnt(9)
    ds_write_b128 v234, v[224:227] offset:8320
    ds_read_b128 a[192:195], v23 offset:0
    ds_read_b128 a[196:199], v23 offset:1024
    ds_read_b128 a[200:203], v23 offset:10240
    ds_read_b128 a[204:207], v23 offset:11264
    ds_read_b128 a[208:211], v23 offset:20480
    s_waitcnt lgkmcnt(14)
    ds_read_b128 a[212:215], v23 offset:21504
    buffer_load_dwordx4 v4, s[20:23], 0 offen offset:64 lds
    s_add_u32 m0, s56, 10432
    s_nop 0
    buffer_load_dwordx4 v5, s[20:23], 0 offen offset:64 lds
    s_add_u32 m0, s56, 11456
    s_waitcnt vmcnt(17)
    v_mfma_f32_32x32x16_bf16 v[128:143], a[92:95], v[244:247], v[128:143]
    v_cvt_pk_bf16_f32 v228, v83, v87
    v_cvt_pk_bf16_f32 v229, v91, v95
    v_cvt_pk_bf16_f32 v230, v99, v103
    v_cvt_pk_bf16_f32 v231, v107, v111
    s_waitcnt lgkmcnt(12)
    ds_write_b128 v235, v[228:231] offset:8320
    ds_read_b128 a[216:219], v23 offset:30720
    ds_read_b128 a[220:223], v23 offset:31744
    buffer_load_dwordx4 v6, s[20:23], 0 offen offset:64 lds
    s_add_u32 m0, s56, 12480
    s_nop 0
    buffer_load_dword v7, s[20:23], 0 offen offset:64 lds
    buffer_load_dword v254, v31, s[20:23], 0 offen
    s_waitcnt lgkmcnt(9)
    ds_read_b128 a[48:51], v24 offset:12288
    ds_read_b128 a[52:55], v24 offset:13312
    ds_read_b128 a[56:59], v24 offset:14336
    ds_read_b128 a[60:63], v24 offset:15360
    ds_read_b128 a[64:67], v24 offset:16384
    ds_read_b128 a[68:71], v24 offset:17408
    s_waitcnt lgkmcnt(9)
    ds_read_b128 a[72:75], v24 offset:18432
    ds_read_b128 a[76:79], v24 offset:19456
    ds_read_b128 a[80:83], v24 offset:20480
    ds_read_b128 a[84:87], v24 offset:21504
    ds_read_b128 a[88:91], v24 offset:22528
    ds_read_b128 a[92:95], v24 offset:23552
    s_waitcnt lgkmcnt(0)
    s_barrier
    s_waitcnt vmcnt(19)
    v_mfma_f32_32x32x16_bf16 v[80:95], v[32:35], v[240:243], 0
    v_pk_mul_f32 v[112:113], v[112:113], v[184:185]
    v_pk_mul_f32 v[116:117], v[116:117], v[184:185]
    v_pk_mul_f32 v[120:121], v[120:121], v[184:185]
    v_pk_mul_f32 v[124:125], v[124:125], v[184:185]
    v_pk_mul_f32 v[128:129], v[128:129], v[184:185]
    v_pk_mul_f32 v[132:133], v[132:133], v[184:185]
    v_pk_mul_f32 v[136:137], v[136:137], v[184:185]
    v_pk_mul_f32 v[140:141], v[140:141], v[184:185]
    v_cvt_pk_bf16_f32 v224, v112, v116
    v_cvt_pk_bf16_f32 v225, v120, v124
    v_cvt_pk_bf16_f32 v226, v128, v132
    v_cvt_pk_bf16_f32 v227, v136, v140
    ds_write_b128 v234, v[224:227] offset:0
    s_waitcnt vmcnt(17)
    v_mfma_f32_32x32x16_bf16 v[96:111], v[40:43], v[240:243], 0
    v_cvt_pk_bf16_f32 v228, v113, v117
    v_cvt_pk_bf16_f32 v229, v121, v125
    v_cvt_pk_bf16_f32 v230, v129, v133
    v_cvt_pk_bf16_f32 v231, v137, v141
    ds_write_b128 v235, v[228:231] offset:0
    v_mfma_f32_32x32x16_bf16 v[80:95], v[36:39], v[244:247], v[80:95]
    v_pk_mul_f32 v[114:115], v[114:115], v[186:187]
    v_pk_mul_f32 v[118:119], v[118:119], v[186:187]
    v_pk_mul_f32 v[122:123], v[122:123], v[186:187]
    v_pk_mul_f32 v[126:127], v[126:127], v[186:187]
    v_pk_mul_f32 v[130:131], v[130:131], v[186:187]
    v_pk_mul_f32 v[134:135], v[134:135], v[186:187]
    v_pk_mul_f32 v[138:139], v[138:139], v[186:187]
    v_pk_mul_f32 v[142:143], v[142:143], v[186:187]
    v_cvt_pk_bf16_f32 v224, v114, v118
    v_cvt_pk_bf16_f32 v225, v122, v126
    v_cvt_pk_bf16_f32 v226, v130, v134
    v_cvt_pk_bf16_f32 v227, v138, v142
    ds_write_b128 v234, v[224:227] offset:128
    s_waitcnt vmcnt(16)
    v_mfma_f32_32x32x16_bf16 v[96:111], v[44:47], v[244:247], v[96:111]
    v_cvt_pk_bf16_f32 v228, v115, v119
    v_cvt_pk_bf16_f32 v229, v123, v127
    v_cvt_pk_bf16_f32 v230, v131, v135
    v_cvt_pk_bf16_f32 v231, v139, v143
    ds_write_b128 v235, v[228:231] offset:128
    v_add_u32 v234, v234, v238
    v_add_u32 v235, v235, v238
    s_waitcnt vmcnt(15)
    v_mfma_f32_32x32x16_bf16 v[112:127], v[48:51], v[240:243], 0
    v_pk_mul_f32 v[80:81], v[80:81], v[176:177]
    v_pk_mul_f32 v[84:85], v[84:85], v[176:177]
    v_pk_mul_f32 v[88:89], v[88:89], v[176:177]
    v_pk_mul_f32 v[92:93], v[92:93], v[176:177]
    v_pk_mul_f32 v[96:97], v[96:97], v[176:177]
    v_pk_mul_f32 v[100:101], v[100:101], v[176:177]
    v_pk_mul_f32 v[104:105], v[104:105], v[176:177]
    v_pk_mul_f32 v[108:109], v[108:109], v[176:177]
    v_cvt_pk_bf16_f32 v224, v80, v84
    v_cvt_pk_bf16_f32 v225, v88, v92
    v_cvt_pk_bf16_f32 v226, v96, v100
    v_cvt_pk_bf16_f32 v227, v104, v108
    ds_write_b128 v234, v[224:227] offset:6144
    s_waitcnt vmcnt(13)
    v_mfma_f32_32x32x16_bf16 v[128:143], v[56:59], v[240:243], 0
    v_cvt_pk_bf16_f32 v228, v81, v85
    v_cvt_pk_bf16_f32 v229, v89, v93
    v_cvt_pk_bf16_f32 v230, v97, v101
    v_cvt_pk_bf16_f32 v231, v105, v109
    ds_write_b128 v235, v[228:231] offset:6144
    v_mfma_f32_32x32x16_bf16 v[112:127], v[52:55], v[244:247], v[112:127]
    v_pk_mul_f32 v[82:83], v[82:83], v[178:179]
    v_pk_mul_f32 v[86:87], v[86:87], v[178:179]
    v_pk_mul_f32 v[90:91], v[90:91], v[178:179]
    v_pk_mul_f32 v[94:95], v[94:95], v[178:179]
    v_pk_mul_f32 v[98:99], v[98:99], v[178:179]
    v_pk_mul_f32 v[102:103], v[102:103], v[178:179]
    v_pk_mul_f32 v[106:107], v[106:107], v[178:179]
    v_pk_mul_f32 v[110:111], v[110:111], v[178:179]
    v_cvt_pk_bf16_f32 v224, v82, v86
    v_cvt_pk_bf16_f32 v225, v90, v94
    v_cvt_pk_bf16_f32 v226, v98, v102
    v_cvt_pk_bf16_f32 v227, v106, v110
    ds_write_b128 v234, v[224:227] offset:6272
    s_waitcnt vmcnt(12)
    v_mfma_f32_32x32x16_bf16 v[128:143], v[60:63], v[244:247], v[128:143]
    v_cvt_pk_bf16_f32 v228, v83, v87
    v_cvt_pk_bf16_f32 v229, v91, v95
    v_cvt_pk_bf16_f32 v230, v99, v103
    v_cvt_pk_bf16_f32 v231, v107, v111
    ds_write_b128 v235, v[228:231] offset:6272
    s_waitcnt vmcnt(11)
    v_mfma_f32_32x32x16_bf16 v[80:95], v[64:67], v[240:243], 0
    v_pk_mul_f32 v[112:113], v[112:113], v[180:181]
    v_pk_mul_f32 v[116:117], v[116:117], v[180:181]
    v_pk_mul_f32 v[120:121], v[120:121], v[180:181]
    v_pk_mul_f32 v[124:125], v[124:125], v[180:181]
    s_nop 0
    v_pk_mul_f32 v[128:129], v[128:129], v[180:181]
    v_pk_mul_f32 v[132:133], v[132:133], v[180:181]
    v_pk_mul_f32 v[136:137], v[136:137], v[180:181]
    v_pk_mul_f32 v[140:141], v[140:141], v[180:181]
    v_cvt_pk_bf16_f32 v224, v112, v116
    v_cvt_pk_bf16_f32 v225, v120, v124
    v_cvt_pk_bf16_f32 v226, v128, v132
    v_cvt_pk_bf16_f32 v227, v136, v140
    ds_write_b128 v234, v[224:227] offset:8192
    s_waitcnt vmcnt(9)
    v_mfma_f32_32x32x16_bf16 v[96:111], v[72:75], v[240:243], 0
    v_cvt_pk_bf16_f32 v228, v113, v117
    v_cvt_pk_bf16_f32 v229, v121, v125
    v_cvt_pk_bf16_f32 v230, v129, v133
    v_cvt_pk_bf16_f32 v231, v137, v141
    ds_write_b128 v235, v[228:231] offset:8192
    v_mfma_f32_32x32x16_bf16 v[80:95], v[68:71], v[244:247], v[80:95]
    v_pk_mul_f32 v[114:115], v[114:115], v[182:183]
    v_pk_mul_f32 v[118:119], v[118:119], v[182:183]
    v_pk_mul_f32 v[122:123], v[122:123], v[182:183]
    v_pk_mul_f32 v[126:127], v[126:127], v[182:183]
    v_pk_mul_f32 v[130:131], v[130:131], v[182:183]
    v_pk_mul_f32 v[134:135], v[134:135], v[182:183]
    v_pk_mul_f32 v[138:139], v[138:139], v[182:183]
    v_pk_mul_f32 v[142:143], v[142:143], v[182:183]
    v_cvt_pk_bf16_f32 v224, v114, v118
    v_cvt_pk_bf16_f32 v225, v122, v126
    v_cvt_pk_bf16_f32 v226, v130, v134
    v_cvt_pk_bf16_f32 v227, v138, v142
    ds_write_b128 v234, v[224:227] offset:8320
    s_waitcnt vmcnt(8)
    v_mfma_f32_32x32x16_bf16 v[96:111], v[76:79], v[244:247], v[96:111]
    v_cvt_pk_bf16_f32 v228, v115, v119
    v_cvt_pk_bf16_f32 v229, v123, v127
    v_cvt_pk_bf16_f32 v230, v131, v135
    v_cvt_pk_bf16_f32 v231, v139, v143
    ds_write_b128 v235, v[228:231] offset:8320
    v_pk_mul_f32 v[80:81], v[80:81], v[184:185]
    v_pk_mul_f32 v[84:85], v[84:85], v[184:185]
    v_pk_mul_f32 v[88:89], v[88:89], v[184:185]
    v_pk_mul_f32 v[92:93], v[92:93], v[184:185]
    s_nop 2
    v_pk_mul_f32 v[96:97], v[96:97], v[184:185]
    v_pk_mul_f32 v[100:101], v[100:101], v[184:185]
    v_pk_mul_f32 v[104:105], v[104:105], v[184:185]
    v_pk_mul_f32 v[108:109], v[108:109], v[184:185]
    v_cvt_pk_bf16_f32 v224, v80, v84
    v_cvt_pk_bf16_f32 v225, v88, v92
    v_cvt_pk_bf16_f32 v226, v96, v100
    v_cvt_pk_bf16_f32 v227, v104, v108
    ds_write_b128 v234, v[224:227] offset:10240
    v_cvt_pk_bf16_f32 v228, v81, v85
    v_cvt_pk_bf16_f32 v229, v89, v93
    v_cvt_pk_bf16_f32 v230, v97, v101
    v_cvt_pk_bf16_f32 v231, v105, v109
    ds_write_b128 v235, v[228:231] offset:10240
    v_pk_mul_f32 v[82:83], v[82:83], v[186:187]
    v_pk_mul_f32 v[86:87], v[86:87], v[186:187]
    v_pk_mul_f32 v[90:91], v[90:91], v[186:187]
    v_pk_mul_f32 v[94:95], v[94:95], v[186:187]
    v_pk_mul_f32 v[98:99], v[98:99], v[186:187]
    v_pk_mul_f32 v[102:103], v[102:103], v[186:187]
    v_pk_mul_f32 v[106:107], v[106:107], v[186:187]
    v_pk_mul_f32 v[110:111], v[110:111], v[186:187]
    v_cvt_pk_bf16_f32 v224, v82, v86
    v_cvt_pk_bf16_f32 v225, v90, v94
    v_cvt_pk_bf16_f32 v226, v98, v102
    v_cvt_pk_bf16_f32 v227, v106, v110
    ds_write_b128 v234, v[224:227] offset:10368
    v_cvt_pk_bf16_f32 v228, v83, v87
    v_cvt_pk_bf16_f32 v229, v91, v95
    v_cvt_pk_bf16_f32 v230, v99, v103
    v_cvt_pk_bf16_f32 v231, v107, v111
    s_waitcnt lgkmcnt(14)
    ds_write_b128 v235, v[228:231] offset:10368
L_conv0:
    s_waitcnt lgkmcnt(9)
    ds_read_b128 v[192:195], v22 offset:0
    ds_read_b128 v[200:203], v22 offset:16
    ds_read_b128 a[232:235], v8 offset:0
    s_waitcnt lgkmcnt(9)
    ds_read_b128 a[244:247], v8 offset:2560
    ds_read_b128 a[236:239], v12 offset:0
    ds_read_b128 a[248:251], v12 offset:2560
    ds_read_b128 a[240:243], v14 offset:1280
    ds_read_b128 a[252:255], v14 offset:3840
    ds_read_b128 v[196:199], v22 offset:256
    s_waitcnt lgkmcnt(9)
    ds_read_b128 v[204:207], v22 offset:272
    ds_read_b128 v[176:179], v9 offset:0
    ds_read_b128 v[188:191], v9 offset:2560
    ds_read_b128 v[180:183], v13 offset:0
    ds_read_b128 v[232:235], v13 offset:2560
    ds_read_b128 v[184:187], v15 offset:1280
    s_waitcnt lgkmcnt(11)
    ds_read_b128 v[236:239], v15 offset:3840
    ds_read_b128 v[56:59], v20 offset:2560
    ds_read_b128 v[60:63], v21 offset:2560
    ds_read_b128 v[52:55], v21 offset:0
    v_mfma_f32_16x16x32_bf16 v[128:131], v[192:195], a[232:235], 0
    s_waitcnt lgkmcnt(10)
    ds_read_b128 v[48:51], v20 offset:0
    ds_read_b128 v[32:35], v25 offset:0
    ds_read_b128 v[36:39], v25 offset:16
    ds_read_b128 a[232:235], v10 offset:0
    v_mfma_f32_16x16x32_bf16 v[152:155], v[192:195], a[244:247], 0
    s_waitcnt lgkmcnt(0)
    ds_read_b128 a[244:247], v10 offset:2560
    ds_read_b128 v[192:195], v22 offset:512
    v_smfmac_f32_16x16x64_bf16 v[128:131], v[200:203], a[236:243], v16
    ds_read_b128 a[236:239], v14 offset:0
    ds_read_b128 a[240:243], v12 offset:1280
    v_smfmac_f32_16x16x64_bf16 v[152:155], v[200:203], a[248:255], v16
    ds_read_b128 a[248:251], v14 offset:2560
    ds_read_b128 a[252:255], v12 offset:3840
    ds_read_b128 v[200:203], v22 offset:528
    s_nop 1
    v_cvt_pkrtz_f16_f32 v128, v128, v129
    v_cvt_pkrtz_f16_f32 v129, v130, v131
    v_dot2_f32_f16 v28, v128, v128, 0
    v_dot2_f32_f16 v27, v128, s58, 0
    v_cvt_pkrtz_f16_f32 v152, v152, v153
    v_mfma_f32_16x16x32_bf16 v[224:227], v[196:199], v[176:179], 0
    ds_read_b128 v[176:179], v11 offset:0
    v_cvt_pkrtz_f16_f32 v153, v154, v155
    v_mfma_f32_16x16x32_bf16 v[228:231], v[196:199], v[188:191], 0
    ds_read_b128 v[188:191], v11 offset:2560
    ds_read_b128 v[196:199], v22 offset:768
    v_dot2_f32_f16 v30, v152, v152, 0
    v_dot2_f32_f16 v29, v152, s58, 0
    v_dot2_f32_f16 v28, v129, v129, v28
    v_dot2_f32_f16 v30, v153, v153, v30
    v_dot2_f32_f16 v27, v129, s58, v27
    v_smfmac_f32_16x16x64_bf16 v[224:227], v[204:207], v[180:187], v16
    s_waitcnt lgkmcnt(1)
    ds_read_b128 v[180:183], v15 offset:0
    ds_read_b128 v[184:187], v13 offset:1280
    v_smfmac_f32_16x16x64_bf16 v[228:231], v[204:207], v[232:239], v16
    s_add_u32 m0, s56, -128
    ds_read_b128 v[232:235], v15 offset:2560
    ds_read_b128 v[236:239], v13 offset:3840
    ds_read_b128 v[204:207], v22 offset:784
    v_cvt_pkrtz_f16_f32 v130, v224, v225
    v_cvt_pkrtz_f16_f32 v131, v226, v227
    v_dot2_f32_f16 v29, v153, s58, v29
    s_nop 0
    v_cvt_pkrtz_f16_f32 v154, v228, v229
    v_cvt_pkrtz_f16_f32 v155, v230, v231
    v_dot2_f32_f16 v28, v130, v130, v28
    v_dot2_f32_f16 v30, v154, v154, v30
    v_dot2_f32_f16 v27, v130, s58, v27
    v_dot2_f32_f16 v29, v154, s58, v29
    v_dot2_f32_f16 v28, v131, v131, v28
    v_dot2_f32_f16 v30, v155, v155, v30
    v_dot2_f32_f16 v27, v131, s58, v27
    v_dot2_f32_f16 v29, v155, s58, v29
    v_mfma_f32_16x16x32_bf16 v[132:135], v[192:195], a[232:235], 0
    s_waitcnt vmcnt(1)
    ds_read_b128 a[232:235], v8 offset:6400
    v_mfma_f32_16x16x32_bf16 v[156:159], v[192:195], a[244:247], 0
    ds_read_b128 a[244:247], v8 offset:8960
    ds_read_b128 v[192:195], v22 offset:1024
    s_nop 0
    v_smfmac_f32_16x16x64_bf16 v[132:135], v[200:203], a[236:243], v16
    ds_read_b128 a[236:239], v12 offset:6400
    ds_read_b128 a[240:243], v14 offset:7680
    v_smfmac_f32_16x16x64_bf16 v[156:159], v[200:203], a[248:255], v16
    ds_read_b128 a[248:251], v12 offset:8960
    ds_read_b128 a[252:255], v14 offset:10240
    ds_read_b128 v[200:203], v22 offset:1040
    s_nop 1
    v_cvt_pkrtz_f16_f32 v132, v132, v133
    s_waitcnt lgkmcnt(13)
    v_mfma_f32_16x16x32_bf16 v[224:227], v[196:199], v[176:179], 0
    ds_read_b128 v[176:179], v9 offset:6400
    v_cvt_pkrtz_f16_f32 v156, v156, v157
    v_cvt_pkrtz_f16_f32 v133, v134, v135
    v_mfma_f32_16x16x32_bf16 v[228:231], v[196:199], v[188:191], 0
    s_waitcnt lgkmcnt(12)
    ds_read_b128 v[188:191], v9 offset:8960
    ds_read_b128 v[196:199], v22 offset:1280
    v_cvt_pkrtz_f16_f32 v157, v158, v159
    v_dot2_f32_f16 v28, v132, v132, v28
    v_dot2_f32_f16 v30, v156, v156, v30
    v_dot2_f32_f16 v27, v132, s58, v27
    v_dot2_f32_f16 v29, v156, s58, v29
    v_dot2_f32_f16 v28, v133, v133, v28
    v_dot2_f32_f16 v30, v157, v157, v30
    v_dot2_f32_f16 v27, v133, s58, v27
    s_waitcnt lgkmcnt(11)
    v_smfmac_f32_16x16x64_bf16 v[224:227], v[204:207], v[180:187], v16
    buffer_load_dwordx4 v1, s[20:23], 0 offen offset:128 lds
    ds_read_b128 v[180:183], v13 offset:6400
    ds_read_b128 v[184:187], v15 offset:7680
    s_add_u32 m0, s56, 896
    v_smfmac_f32_16x16x64_bf16 v[228:231], v[204:207], v[232:239], v16
    s_waitcnt lgkmcnt(0)
    buffer_load_dwordx4 v2, s[20:23], 0 offen offset:128 lds
    ds_read_b128 v[232:235], v13 offset:8960
    ds_read_b128 v[236:239], v15 offset:10240
    ds_read_b128 v[204:207], v22 offset:1296
    v_dot2_f32_f16 v29, v157, s58, v29
    v_cvt_pkrtz_f16_f32 v134, v224, v225
    v_cvt_pkrtz_f16_f32 v135, v226, v227
    v_dot2_f32_f16 v28, v134, v134, v28
    v_mfma_f32_16x16x32_bf16 v[136:139], v[192:195], a[232:235], 0
    s_add_u32 m0, s56, 1920
    ds_read_b128 a[232:235], v10 offset:6400
    buffer_load_dwordx4 v3, s[20:23], 0 offen offset:128 lds
    ds_read_b128 v[216:219], v20 offset:8960
    v_mfma_f32_16x16x32_bf16 v[160:163], v[192:195], a[244:247], 0
    s_add_u32 m0, s56, 2944
    ds_read_b128 a[244:247], v10 offset:8960
    buffer_load_dwordx4 v4, s[20:23], 0 offen offset:128 lds
    ds_read_b128 v[192:195], v22 offset:1536
    v_mfma_f32_16x16x16_bf16 v[80:83], v[18:19], v[56:57], v[32:35]
    s_add_u32 m0, s56, 3968
    v_cvt_pkrtz_f16_f32 v158, v228, v229
    v_cvt_pkrtz_f16_f32 v159, v230, v231
    v_smfmac_f32_16x16x64_bf16 v[136:139], v[200:203], a[236:243], v16
    buffer_load_dwordx4 v5, s[20:23], 0 offen offset:128 lds
    ds_read_b128 a[236:239], v14 offset:6400
    ds_read_b128 a[240:243], v12 offset:7680
    s_add_u32 m0, s56, 4992
    v_mfma_f32_16x16x16_bf16 v[84:87], v[18:19], v[58:59], v[36:39]
    buffer_load_dwordx4 v6, s[20:23], 0 offen offset:128 lds
    ds_read_b128 v[220:223], v21 offset:8960
    s_add_u32 m0, s56, 6016
    v_smfmac_f32_16x16x64_bf16 v[160:163], v[200:203], a[248:255], v16
    buffer_load_dword v7, s[20:23], 0 offen offset:128 lds
    ds_read_b128 a[248:251], v14 offset:8960
    ds_read_b128 a[252:255], v12 offset:10240
    ds_read_b128 v[200:203], v22 offset:1552
    v_mfma_f32_16x16x16_bf16 v[88:91], v[18:19], v[60:61], v[32:35]
    v_cvt_pkrtz_f16_f32 v136, v136, v137
    v_cvt_pkrtz_f16_f32 v137, v138, v139
    v_mfma_f32_16x16x32_bf16 v[224:227], v[196:199], v[176:179], 0
    ds_read_b128 v[176:179], v11 offset:6400
    v_cvt_pkrtz_f16_f32 v160, v160, v161
    v_cvt_pkrtz_f16_f32 v161, v162, v163
    v_mfma_f32_16x16x16_bf16 v[92:95], v[18:19], v[62:63], v[36:39]
    s_waitcnt lgkmcnt(0)
    ds_read_b128 v[212:215], v21 offset:6400
    v_mfma_f32_16x16x32_bf16 v[228:231], v[196:199], v[188:191], 0
    ds_read_b128 v[188:191], v11 offset:8960
    ds_read_b128 v[196:199], v22 offset:1792
    v_mfma_f32_16x16x16_bf16 v[40:43], v[18:19], v[52:53], v[32:35]
    v_smfmac_f32_16x16x64_bf16 v[224:227], v[204:207], v[180:187], v16
    ds_read_b128 v[180:183], v15 offset:6400
    ds_read_b128 v[184:187], v13 offset:7680
    v_mfma_f32_16x16x16_bf16 v[44:47], v[18:19], v[54:55], v[36:39]
    ds_read_b128 v[208:211], v20 offset:6400
    v_smfmac_f32_16x16x64_bf16 v[228:231], v[204:207], v[232:239], v16
    ds_read_b128 v[232:235], v15 offset:8960
    ds_read_b128 v[236:239], v13 offset:10240
    ds_read_b128 v[204:207], v22 offset:1808
    v_mfma_f32_16x16x16_bf16 v[32:35], v[18:19], v[48:49], v[32:35]
    v_cvt_pkrtz_f16_f32 v138, v224, v225
    v_cvt_pkrtz_f16_f32 v139, v226, v227
    v_mfma_f32_16x16x32_bf16 v[140:143], v[192:195], a[232:235], 0
    s_nop 0
    v_cvt_pkrtz_f16_f32 v162, v228, v229
    v_cvt_pkrtz_f16_f32 v163, v230, v231
    v_mfma_f32_16x16x16_bf16 v[36:39], v[18:19], v[50:51], v[36:39]
    v_mfma_f32_16x16x32_bf16 v[164:167], v[192:195], a[244:247], 0
    ds_read_b128 v[192:195], v22 offset:2048
    v_smfmac_f32_16x16x64_bf16 v[140:143], v[200:203], a[236:243], v16
    s_nop 3
    v_smfmac_f32_16x16x64_bf16 v[164:167], v[200:203], a[248:255], v16
    ds_read_b128 v[200:203], v22 offset:2064
    s_nop 1
    v_cvt_pkrtz_f16_f32 v140, v140, v141
    v_cvt_pkrtz_f16_f32 v141, v142, v143
    v_dot2_f32_f16 v30, v158, v158, v30
    v_dot2_f32_f16 v27, v134, s58, v27
    v_dot2_f32_f16 v29, v158, s58, v29
    v_dot2_f32_f16 v28, v135, v135, v28
    v_dot2_f32_f16 v30, v159, v159, v30
    v_dot2_f32_f16 v27, v135, s58, v27
    v_dot2_f32_f16 v29, v159, s58, v29
    v_dot2_f32_f16 v28, v136, v136, v28
    v_dot2_f32_f16 v30, v160, v160, v30
    v_dot2_f32_f16 v27, v136, s58, v27
    v_dot2_f32_f16 v29, v160, s58, v29
    v_dot2_f32_f16 v28, v137, v137, v28
    v_dot2_f32_f16 v30, v161, v161, v30
    v_dot2_f32_f16 v27, v137, s58, v27
    v_dot2_f32_f16 v29, v161, s58, v29
    v_dot2_f32_f16 v28, v138, v138, v28
    v_dot2_f32_f16 v30, v162, v162, v30
    v_dot2_f32_f16 v27, v138, s58, v27
    v_dot2_f32_f16 v29, v162, s58, v29
    v_dot2_f32_f16 v28, v139, v139, v28
    v_dot2_f32_f16 v30, v163, v163, v30
    v_dot2_f32_f16 v27, v139, s58, v27
    v_dot2_f32_f16 v29, v163, s58, v29
    v_cvt_pkrtz_f16_f32 v164, v164, v165
    v_cvt_pkrtz_f16_f32 v165, v166, v167
    v_dot2_f32_f16 v28, v140, v140, v28
    s_waitcnt lgkmcnt(8)
    v_mfma_f32_16x16x32_bf16 v[224:227], v[196:199], v[176:179], 0
    v_mfma_f32_16x16x32_bf16 v[228:231], v[196:199], v[188:191], 0
    s_waitcnt lgkmcnt(2)
    ds_read_b128 v[196:199], v22 offset:2304
    s_nop 2
    v_smfmac_f32_16x16x64_bf16 v[224:227], v[204:207], v[180:187], v16
    v_smfmac_f32_16x16x64_bf16 v[228:231], v[204:207], v[232:239], v16
    s_waitcnt lgkmcnt(1)
    ds_read_b128 v[204:207], v22 offset:2320
    v_dot2_f32_f16 v30, v164, v164, v30
    v_dot2_f32_f16 v27, v140, s58, v27
    v_dot2_f32_f16 v29, v164, s58, v29
    v_dot2_f32_f16 v28, v141, v141, v28
    v_dot2_f32_f16 v30, v165, v165, v30
    v_dot2_f32_f16 v27, v141, s58, v27
    v_cvt_pkrtz_f16_f32 v142, v224, v225
    v_cvt_pkrtz_f16_f32 v166, v228, v229
    v_cvt_pkrtz_f16_f32 v143, v226, v227
    v_cvt_pkrtz_f16_f32 v167, v230, v231
    v_dot2_f32_f16 v29, v165, s58, v29
    v_dot2_f32_f16 v28, v142, v142, v28
    v_dot2_f32_f16 v30, v166, v166, v30
    v_dot2_f32_f16 v27, v142, s58, v27
    v_dot2_f32_f16 v29, v166, s58, v29
    v_dot2_f32_f16 v28, v143, v143, v28
    v_dot2_f32_f16 v30, v167, v167, v30
    v_dot2_f32_f16 v27, v143, s58, v27
    v_dot2_f32_f16 v29, v167, s58, v29
    s_waitcnt vmcnt(0)
    ds_read_b128 a[232:235], v8 offset:0
    ds_read_b128 a[244:247], v8 offset:2560
    ds_read_b128 a[236:239], v12 offset:0
    ds_read_b128 a[240:243], v14 offset:1280
    ds_read_b128 a[248:251], v12 offset:2560
    ds_read_b128 a[252:255], v14 offset:3840
    ds_read_b128 v[176:179], v9 offset:0
    ds_read_b128 v[188:191], v9 offset:2560
    ds_read_b128 v[180:183], v13 offset:0
    ds_read_b128 v[184:187], v15 offset:1280
    ds_read_b128 v[232:235], v13 offset:2560
    ds_read_b128 v[236:239], v15 offset:3840
    s_waitcnt lgkmcnt(11)
    v_mfma_f32_16x16x32_bf16 v[144:147], v[192:195], a[232:235], 0
    s_waitcnt lgkmcnt(10)
    ds_read_b128 a[232:235], v10 offset:0
    v_mfma_f32_16x16x32_bf16 v[168:171], v[192:195], a[244:247], 0
    s_waitcnt lgkmcnt(10)
    ds_read_b128 a[244:247], v10 offset:2560
    ds_read_b128 v[192:195], v22 offset:2560
    s_waitcnt lgkmcnt(11)
    v_smfmac_f32_16x16x64_bf16 v[144:147], v[200:203], a[236:243], v16
    s_waitcnt lgkmcnt(10)
    ds_read_b128 a[236:239], v14 offset:0
    ds_read_b128 a[240:243], v12 offset:1280
    s_waitcnt lgkmcnt(11)
    v_smfmac_f32_16x16x64_bf16 v[168:171], v[200:203], a[248:255], v16
    ds_read_b128 a[248:251], v14 offset:2560
    ds_read_b128 a[252:255], v12 offset:3840
    ds_read_b128 v[200:203], v22 offset:2576
    s_waitcnt lgkmcnt(13)
    v_mfma_f32_16x16x32_bf16 v[224:227], v[196:199], v[176:179], 0
    s_waitcnt lgkmcnt(12)
    ds_read_b128 v[176:179], v11 offset:0
    v_cvt_pkrtz_f16_f32 v144, v144, v145
    v_cvt_pkrtz_f16_f32 v145, v146, v147
    v_mfma_f32_16x16x32_bf16 v[228:231], v[196:199], v[188:191], 0
    s_waitcnt lgkmcnt(12)
    ds_read_b128 v[188:191], v11 offset:2560
    ds_read_b128 v[196:199], v22 offset:2816
    v_cvt_pkrtz_f16_f32 v168, v168, v169
    v_cvt_pkrtz_f16_f32 v169, v170, v171
    s_waitcnt lgkmcnt(13)
    v_smfmac_f32_16x16x64_bf16 v[224:227], v[204:207], v[180:187], v16
    s_waitcnt lgkmcnt(1)
    ds_read_b128 v[180:183], v15 offset:0
    ds_read_b128 v[184:187], v13 offset:1280
    ds_read_b128 v[48:51], v25 offset:128
    v_dot2_f32_f16 v28, v144, v144, v28
    v_smfmac_f32_16x16x64_bf16 v[228:231], v[204:207], v[232:239], v16
    ds_read_b128 v[232:235], v15 offset:2560
    ds_read_b128 v[236:239], v13 offset:3840
    ds_read_b128 v[204:207], v22 offset:2832
    ds_read_b128 v[52:55], v25 offset:144
    v_cvt_pkrtz_f16_f32 v146, v224, v225
    v_dot2_f32_f16 v30, v168, v168, v30
    v_dot2_f32_f16 v27, v144, s58, v27
    v_dot2_f32_f16 v29, v168, s58, v29
    v_dot2_f32_f16 v28, v145, v145, v28
    v_dot2_f32_f16 v30, v169, v169, v30
    v_dot2_f32_f16 v27, v145, s58, v27
    v_dot2_f32_f16 v29, v169, s58, v29
    v_cvt_pkrtz_f16_f32 v170, v228, v229
    v_cvt_pkrtz_f16_f32 v147, v226, v227
    v_cvt_pkrtz_f16_f32 v171, v230, v231
    v_mfma_f32_16x16x32_bf16 v[148:151], v[192:195], a[232:235], 0
    v_mfma_f32_16x16x32_bf16 v[172:175], v[192:195], a[244:247], 0
    ds_read_b128 v[64:67], v25 offset:256
    s_nop 3
    v_smfmac_f32_16x16x64_bf16 v[148:151], v[200:203], a[236:243], v16
    ds_read_b128 v[68:71], v25 offset:272
    v_smfmac_f32_16x16x64_bf16 v[172:175], v[200:203], a[248:255], v16
    s_nop 5
    v_cvt_pkrtz_f16_f32 v148, v148, v149
    s_waitcnt lgkmcnt(9)
    v_mfma_f32_16x16x32_bf16 v[224:227], v[196:199], v[176:179], 0
    ds_read_b128 a[232:235], v23 offset:2048
    ds_read_b128 a[236:239], v23 offset:3072
    v_cvt_pkrtz_f16_f32 v172, v172, v173
    v_mfma_f32_16x16x32_bf16 v[228:231], v[196:199], v[188:191], 0
    s_waitcnt lgkmcnt(9)
    ds_read_b128 a[240:243], v23 offset:4096
    ds_read_b128 a[244:247], v23 offset:5120
    v_cvt_pkrtz_f16_f32 v149, v150, v151
    v_cvt_pkrtz_f16_f32 v173, v174, v175
    s_waitcnt lgkmcnt(7)
    v_smfmac_f32_16x16x64_bf16 v[224:227], v[204:207], v[180:187], v16
    ds_read_b128 a[248:251], v23 offset:12288
    v_smfmac_f32_16x16x64_bf16 v[228:231], v[204:207], v[232:239], v16
    ds_read_b128 a[252:255], v23 offset:13312
    s_waitcnt lgkmcnt(0)
    s_barrier
    s_branch L_mid
L_conv:
    v_mfma_f32_16x16x32_bf16 v[128:131], v[192:195], a[232:235], 0
    ds_read_b128 a[232:235], v10 offset:0
    v_cvt_pk_bf16_f32 v80, v80, v81
    v_cvt_pk_bf16_f32 v81, v82, v83
    v_mfma_f32_16x16x32_bf16 v[152:155], v[192:195], a[244:247], 0
    ds_read_b128 a[244:247], v10 offset:2560
    ds_read_b128 v[192:195], v22 offset:512
    v_cvt_pk_bf16_f32 v82, v84, v85
    v_smfmac_f32_16x16x64_bf16 v[128:131], v[200:203], a[236:243], v16
    ds_read_b128 a[236:239], v14 offset:0
    ds_read_b128 a[240:243], v12 offset:1280
    v_cvt_pk_bf16_f32 v83, v86, v87
    v_smfmac_f32_16x16x64_bf16 v[152:155], v[200:203], a[248:255], v16
    ds_read_b128 a[248:251], v14 offset:2560
    ds_read_b128 a[252:255], v12 offset:3840
    ds_read_b128 v[200:203], v22 offset:528
    v_mfma_f32_16x16x32_bf16 v[224:227], v[196:199], v[176:179], 0
    ds_read_b128 v[176:179], v11 offset:0
    v_cvt_pkrtz_f16_f32 v128, v128, v129
    v_cvt_pkrtz_f16_f32 v129, v130, v131
    v_mfma_f32_16x16x32_bf16 v[228:231], v[196:199], v[188:191], 0
    s_waitcnt lgkmcnt(13)
    ds_read_b128 v[188:191], v11 offset:2560
    ds_read_b128 v[196:199], v22 offset:768
    v_cvt_pkrtz_f16_f32 v152, v152, v153
    v_smfmac_f32_16x16x64_bf16 v[224:227], v[204:207], v[180:187], v16
    s_waitcnt lgkmcnt(13)
    ds_read_b128 v[180:183], v15 offset:0
    ds_read_b128 v[184:187], v13 offset:1280
    v_cvt_pkrtz_f16_f32 v153, v154, v155
    v_smfmac_f32_16x16x64_bf16 v[228:231], v[204:207], v[232:239], v16
    s_waitcnt lgkmcnt(0)
    ds_read_b128 v[232:235], v15 offset:2560
    ds_read_b128 v[236:239], v13 offset:3840
    ds_read_b128 v[204:207], v22 offset:784
    v_mfma_f32_16x16x32_bf16 v[88:91], a[168:171], v[244:247], v[88:91]
    v_cvt_pkrtz_f16_f32 v130, v224, v225
    v_cvt_pkrtz_f16_f32 v131, v226, v227
    v_mfma_f32_16x16x32_bf16 v[92:95], a[172:175], v[244:247], v[92:95]
    s_add_u32 m0, s56, -128
    v_cvt_pkrtz_f16_f32 v154, v228, v229
    v_cvt_pkrtz_f16_f32 v155, v230, v231
    v_mfma_f32_16x16x32_bf16 v[132:135], v[192:195], a[232:235], 0
    ds_read_b128 a[232:235], v8 offset:6400
    v_cvt_pk_bf16_f32 v88, v88, v89
    v_cvt_pk_bf16_f32 v89, v90, v91
    v_mfma_f32_16x16x32_bf16 v[104:107], a[176:179], v[244:247], v[104:107]
    v_cvt_pk_bf16_f32 v90, v92, v93
    v_cvt_pk_bf16_f32 v91, v94, v95
    v_cvt_pk_bf16_f32 v96, v96, v97
    v_mfma_f32_16x16x32_bf16 v[156:159], v[192:195], a[244:247], 0
    ds_read_b128 a[244:247], v8 offset:8960
    ds_read_b128 v[192:195], v22 offset:1024
    v_cvt_pk_bf16_f32 v97, v98, v99
    v_mfma_f32_16x16x32_bf16 v[108:111], a[180:183], v[244:247], v[108:111]
    v_cvt_pk_bf16_f32 v98, v100, v101
    v_cvt_pk_bf16_f32 v99, v102, v103
    v_smfmac_f32_16x16x64_bf16 v[132:135], v[200:203], a[236:243], v16
    ds_read_b128 a[236:239], v12 offset:6400
    ds_read_b128 a[240:243], v14 offset:7680
    v_mfma_f32_16x16x32_bf16 v[120:123], a[184:187], v[244:247], v[120:123]
    v_smfmac_f32_16x16x64_bf16 v[156:159], v[200:203], a[248:255], v16
    s_waitcnt lgkmcnt(6)
    ds_read_b128 a[248:251], v12 offset:8960
    ds_read_b128 a[252:255], v14 offset:10240
    buffer_load_dwordx4 v1, s[20:23], 0 offen offset:128 lds
    ds_read_b128 v[200:203], v22 offset:1040
    v_mfma_f32_16x16x32_bf16 v[124:127], a[188:191], v[244:247], v[124:127]
    s_add_u32 m0, s56, 896
    v_cvt_pkrtz_f16_f32 v132, v132, v133
    v_cvt_pkrtz_f16_f32 v133, v134, v135
    v_cvt_pkrtz_f16_f32 v156, v156, v157
    v_mfma_f32_16x16x32_bf16 v[224:227], v[196:199], v[176:179], 0
    s_waitcnt lgkmcnt(0)
    buffer_load_dwordx4 v2, s[20:23], 0 offen offset:128 lds
    ds_read_b128 v[176:179], v9 offset:6400
    ds_read_b128 v[32:35], v25 offset:0
    v_mfma_f32_16x16x32_bf16 v[228:231], v[196:199], v[188:191], 0
    s_add_u32 m0, s56, 1920
    ds_read_b128 v[188:191], v9 offset:8960
    buffer_load_dwordx4 v3, s[20:23], 0 offen offset:128 lds
    ds_read_b128 v[196:199], v22 offset:1280
    ds_read_b128 v[36:39], v25 offset:16
    v_smfmac_f32_16x16x64_bf16 v[224:227], v[204:207], v[180:187], v16
    s_add_u32 m0, s56, 2944
    ds_read_b128 v[180:183], v13 offset:6400
    buffer_load_dwordx4 v4, s[20:23], 0 offen offset:128 lds
    ds_read_b128 v[184:187], v15 offset:7680
    v_smfmac_f32_16x16x64_bf16 v[228:231], v[204:207], v[232:239], v16
    s_add_u32 m0, s56, 3968
    ds_read_b128 v[232:235], v13 offset:8960
    buffer_load_dwordx4 v5, s[20:23], 0 offen offset:128 lds
    ds_read_b128 v[236:239], v15 offset:10240
    ds_read_b128 v[204:207], v22 offset:1296
    buffer_store_dwordx4 v[80:83], v26, s[24:27], s82 offen offset:0 sc0 sc1
    v_cvt_pkrtz_f16_f32 v157, v158, v159
    v_dot2_f32_f16 v28, v128, v128, 0
    v_dot2_f32_f16 v30, v152, v152, 0
    v_dot2_f32_f16 v27, v128, s58, 0
    v_dot2_f32_f16 v29, v152, s58, 0
    v_dot2_f32_f16 v28, v129, v129, v28
    v_dot2_f32_f16 v30, v153, v153, v30
    v_dot2_f32_f16 v27, v129, s58, v27
    v_dot2_f32_f16 v29, v153, s58, v29
    v_dot2_f32_f16 v28, v130, v130, v28
    v_dot2_f32_f16 v30, v154, v154, v30
    v_dot2_f32_f16 v27, v130, s58, v27
    v_dot2_f32_f16 v29, v154, s58, v29
    v_dot2_f32_f16 v28, v131, v131, v28
    v_dot2_f32_f16 v30, v155, v155, v30
    v_dot2_f32_f16 v27, v131, s58, v27
    v_dot2_f32_f16 v29, v155, s58, v29
    v_dot2_f32_f16 v28, v132, v132, v28
    v_dot2_f32_f16 v30, v156, v156, v30
    v_dot2_f32_f16 v27, v132, s58, v27
    v_dot2_f32_f16 v29, v156, s58, v29
    v_dot2_f32_f16 v28, v133, v133, v28
    v_dot2_f32_f16 v30, v157, v157, v30
    v_dot2_f32_f16 v27, v133, s58, v27
    v_dot2_f32_f16 v29, v157, s58, v29
    v_cvt_pkrtz_f16_f32 v134, v224, v225
    v_cvt_pkrtz_f16_f32 v158, v228, v229
    v_cvt_pkrtz_f16_f32 v135, v226, v227
    v_mfma_f32_16x16x32_bf16 v[136:139], v[192:195], a[232:235], 0
    s_add_u32 m0, s56, 4992
    ds_read_b128 a[232:235], v10 offset:6400
    buffer_load_dwordx4 v6, s[20:23], 0 offen offset:128 lds
    buffer_store_dwordx4 v[88:91], v26, s[24:27], s83 offen offset:0 sc0 sc1
    ds_read_b128 v[216:219], v20 offset:8960
    v_mfma_f32_16x16x32_bf16 v[160:163], v[192:195], a[244:247], 0
    s_add_u32 m0, s56, 6016
    ds_read_b128 a[244:247], v10 offset:8960
    buffer_load_dword v7, s[20:23], 0 offen offset:128 lds
    ds_read_b128 v[192:195], v22 offset:1536
    s_waitcnt lgkmcnt(12)
    v_mfma_f32_16x16x16_bf16 v[80:83], v[18:19], v[56:57], v[32:35]
    v_cvt_pkrtz_f16_f32 v159, v230, v231
    v_cvt_pk_bf16_f32 v104, v104, v105
    v_cvt_pk_bf16_f32 v105, v106, v107
    v_smfmac_f32_16x16x64_bf16 v[136:139], v[200:203], a[236:243], v16
    s_waitcnt lgkmcnt(9)
    ds_read_b128 a[236:239], v14 offset:6400
    ds_read_b128 a[240:243], v12 offset:7680
    v_cvt_pk_bf16_f32 v106, v108, v109
    v_mfma_f32_16x16x16_bf16 v[84:87], v[18:19], v[58:59], v[36:39]
    ds_read_b128 v[220:223], v21 offset:8960
    v_cvt_pk_bf16_f32 v107, v110, v111
    v_cvt_pk_bf16_f32 v112, v112, v113
    v_smfmac_f32_16x16x64_bf16 v[160:163], v[200:203], a[248:255], v16
    s_waitcnt lgkmcnt(0)
    ds_read_b128 a[248:251], v14 offset:8960
    ds_read_b128 a[252:255], v12 offset:10240
    ds_read_b128 v[200:203], v22 offset:1552
    v_mfma_f32_16x16x16_bf16 v[88:91], v[18:19], v[60:61], v[32:35]
    v_cvt_pkrtz_f16_f32 v136, v136, v137
    v_cvt_pkrtz_f16_f32 v137, v138, v139
    v_cvt_pk_bf16_f32 v113, v114, v115
    v_mfma_f32_16x16x32_bf16 v[224:227], v[196:199], v[176:179], 0
    ds_read_b128 v[176:179], v11 offset:6400
    v_cvt_pkrtz_f16_f32 v160, v160, v161
    v_cvt_pkrtz_f16_f32 v161, v162, v163
    v_mfma_f32_16x16x16_bf16 v[92:95], v[18:19], v[62:63], v[36:39]
    ds_read_b128 v[212:215], v21 offset:6400
    v_cvt_pk_bf16_f32 v114, v116, v117
    v_cvt_pk_bf16_f32 v115, v118, v119
    v_mfma_f32_16x16x32_bf16 v[228:231], v[196:199], v[188:191], 0
    ds_read_b128 v[188:191], v11 offset:8960
    ds_read_b128 v[196:199], v22 offset:1792
    v_cvt_pk_bf16_f32 v120, v120, v121
    v_mfma_f32_16x16x16_bf16 v[40:43], v[18:19], v[52:53], v[32:35]
    v_cvt_pk_bf16_f32 v121, v122, v123
    v_cvt_pk_bf16_f32 v122, v124, v125
    v_cvt_pk_bf16_f32 v123, v126, v127
    v_smfmac_f32_16x16x64_bf16 v[224:227], v[204:207], v[180:187], v16
    ds_read_b128 v[180:183], v15 offset:6400
    ds_read_b128 v[184:187], v13 offset:7680
    v_mfma_f32_16x16x16_bf16 v[44:47], v[18:19], v[54:55], v[36:39]
    ds_read_b128 v[208:211], v20 offset:6400
    v_smfmac_f32_16x16x64_bf16 v[228:231], v[204:207], v[232:239], v16
    ds_read_b128 v[232:235], v15 offset:8960
    ds_read_b128 v[236:239], v13 offset:10240
    ds_read_b128 v[204:207], v22 offset:1808
    v_mfma_f32_16x16x16_bf16 v[32:35], v[18:19], v[48:49], v[32:35]
    v_cvt_pkrtz_f16_f32 v138, v224, v225
    v_cvt_pkrtz_f16_f32 v139, v226, v227
    v_mfma_f32_16x16x32_bf16 v[140:143], v[192:195], a[232:235], 0
    s_nop 0
    v_cvt_pkrtz_f16_f32 v162, v228, v229
    v_cvt_pkrtz_f16_f32 v163, v230, v231
    v_mfma_f32_16x16x16_bf16 v[36:39], v[18:19], v[50:51], v[36:39]
    v_mfma_f32_16x16x32_bf16 v[164:167], v[192:195], a[244:247], 0
    s_waitcnt lgkmcnt(10)
    ds_read_b128 v[192:195], v22 offset:2048
    v_smfmac_f32_16x16x64_bf16 v[140:143], v[200:203], a[236:243], v16
    s_nop 2
    v_smfmac_f32_16x16x64_bf16 v[164:167], v[200:203], a[248:255], v16
    s_waitcnt lgkmcnt(7)
    ds_read_b128 v[200:203], v22 offset:2064
    s_nop 1
    v_cvt_pkrtz_f16_f32 v140, v140, v141
    v_cvt_pkrtz_f16_f32 v141, v142, v143
    v_dot2_f32_f16 v28, v134, v134, v28
    v_dot2_f32_f16 v30, v158, v158, v30
    v_dot2_f32_f16 v27, v134, s58, v27
    v_dot2_f32_f16 v29, v158, s58, v29
    v_dot2_f32_f16 v28, v135, v135, v28
    v_dot2_f32_f16 v30, v159, v159, v30
    v_dot2_f32_f16 v27, v135, s58, v27
    v_dot2_f32_f16 v29, v159, s58, v29
    v_dot2_f32_f16 v28, v136, v136, v28
    v_dot2_f32_f16 v30, v160, v160, v30
    v_dot2_f32_f16 v27, v136, s58, v27
    v_dot2_f32_f16 v29, v160, s58, v29
    v_dot2_f32_f16 v28, v137, v137, v28
    v_dot2_f32_f16 v30, v161, v161, v30
    v_dot2_f32_f16 v27, v137, s58, v27
    v_dot2_f32_f16 v29, v161, s58, v29
    v_dot2_f32_f16 v28, v138, v138, v28
    v_dot2_f32_f16 v30, v162, v162, v30
    v_dot2_f32_f16 v27, v138, s58, v27
    v_dot2_f32_f16 v29, v162, s58, v29
    v_dot2_f32_f16 v28, v139, v139, v28
    v_dot2_f32_f16 v30, v163, v163, v30
    v_dot2_f32_f16 v27, v139, s58, v27
    v_dot2_f32_f16 v29, v163, s58, v29
    v_cvt_pkrtz_f16_f32 v164, v164, v165
    v_cvt_pkrtz_f16_f32 v165, v166, v167
    v_dot2_f32_f16 v28, v140, v140, v28
    v_mfma_f32_16x16x32_bf16 v[224:227], v[196:199], v[176:179], 0
    buffer_store_dwordx4 v[96:99], v26, s[24:27], s82 offen offset:64 sc0 sc1
    v_mfma_f32_16x16x32_bf16 v[228:231], v[196:199], v[188:191], 0
    s_waitcnt lgkmcnt(2)
    ds_read_b128 v[196:199], v22 offset:2304
    s_nop 1
    v_smfmac_f32_16x16x64_bf16 v[224:227], v[204:207], v[180:187], v16
    s_nop 0
    v_smfmac_f32_16x16x64_bf16 v[228:231], v[204:207], v[232:239], v16
    s_waitcnt lgkmcnt(1)
    ds_read_b128 v[204:207], v22 offset:2320
    v_dot2_f32_f16 v30, v164, v164, v30
    v_dot2_f32_f16 v27, v140, s58, v27
    v_dot2_f32_f16 v29, v164, s58, v29
    v_dot2_f32_f16 v28, v141, v141, v28
    v_dot2_f32_f16 v30, v165, v165, v30
    v_cvt_pkrtz_f16_f32 v142, v224, v225
    v_cvt_pkrtz_f16_f32 v143, v226, v227
    v_cvt_pkrtz_f16_f32 v166, v228, v229
    v_cvt_pkrtz_f16_f32 v167, v230, v231
    v_dot2_f32_f16 v27, v141, s58, v27
    v_dot2_f32_f16 v29, v165, s58, v29
    v_dot2_f32_f16 v28, v142, v142, v28
    v_dot2_f32_f16 v30, v166, v166, v30
    v_dot2_f32_f16 v27, v142, s58, v27
    v_dot2_f32_f16 v29, v166, s58, v29
    v_dot2_f32_f16 v28, v143, v143, v28
    v_dot2_f32_f16 v30, v167, v167, v30
    v_dot2_f32_f16 v27, v143, s58, v27
    v_dot2_f32_f16 v29, v167, s58, v29
    s_waitcnt vmcnt(1)
    ds_read_b128 a[232:235], v8 offset:0
    ds_read_b128 a[244:247], v8 offset:2560
    ds_read_b128 a[236:239], v12 offset:0
    ds_read_b128 a[240:243], v14 offset:1280
    ds_read_b128 a[248:251], v12 offset:2560
    ds_read_b128 a[252:255], v14 offset:3840
    ds_read_b128 v[176:179], v9 offset:0
    ds_read_b128 v[188:191], v9 offset:2560
    ds_read_b128 v[180:183], v13 offset:0
    ds_read_b128 v[184:187], v15 offset:1280
    ds_read_b128 v[232:235], v13 offset:2560
    ds_read_b128 v[236:239], v15 offset:3840
    s_waitcnt lgkmcnt(11)
    v_mfma_f32_16x16x32_bf16 v[144:147], v[192:195], a[232:235], 0
    s_waitcnt lgkmcnt(10)
    ds_read_b128 a[232:235], v10 offset:0
    buffer_store_dwordx4 v[104:107], v26, s[24:27], s83 offen offset:64 sc0 sc1
    v_mfma_f32_16x16x32_bf16 v[168:171], v[192:195], a[244:247], 0
    s_waitcnt lgkmcnt(10)
    ds_read_b128 a[244:247], v10 offset:2560
    ds_read_b128 v[192:195], v22 offset:2560
    s_waitcnt lgkmcnt(11)
    v_smfmac_f32_16x16x64_bf16 v[144:147], v[200:203], a[236:243], v16
    s_waitcnt lgkmcnt(10)
    ds_read_b128 a[236:239], v14 offset:0
    ds_read_b128 a[240:243], v12 offset:1280
    s_waitcnt lgkmcnt(11)
    v_smfmac_f32_16x16x64_bf16 v[168:171], v[200:203], a[248:255], v16
    ds_read_b128 a[248:251], v14 offset:2560
    ds_read_b128 a[252:255], v12 offset:3840
    ds_read_b128 v[200:203], v22 offset:2576
    s_waitcnt lgkmcnt(13)
    v_mfma_f32_16x16x32_bf16 v[224:227], v[196:199], v[176:179], 0
    s_waitcnt lgkmcnt(12)
    ds_read_b128 v[176:179], v11 offset:0
    buffer_store_dwordx4 v[112:115], v26, s[24:27], s82 offen offset:128 sc0 sc1
    v_cvt_pkrtz_f16_f32 v144, v144, v145
    v_mfma_f32_16x16x32_bf16 v[228:231], v[196:199], v[188:191], 0
    s_waitcnt lgkmcnt(12)
    ds_read_b128 v[188:191], v11 offset:2560
    ds_read_b128 v[196:199], v22 offset:2816
    v_cvt_pkrtz_f16_f32 v168, v168, v169
    v_cvt_pkrtz_f16_f32 v145, v146, v147
    s_waitcnt lgkmcnt(13)
    v_smfmac_f32_16x16x64_bf16 v[224:227], v[204:207], v[180:187], v16
    s_waitcnt lgkmcnt(1)
    ds_read_b128 v[180:183], v15 offset:0
    ds_read_b128 v[184:187], v13 offset:1280
    ds_read_b128 v[48:51], v25 offset:128
    v_cvt_pkrtz_f16_f32 v169, v170, v171
    v_dot2_f32_f16 v28, v144, v144, v28
    v_smfmac_f32_16x16x64_bf16 v[228:231], v[204:207], v[232:239], v16
    ds_read_b128 v[232:235], v15 offset:2560
    ds_read_b128 v[236:239], v13 offset:3840
    ds_read_b128 v[204:207], v22 offset:2832
    ds_read_b128 v[52:55], v25 offset:144
    v_cvt_pkrtz_f16_f32 v146, v224, v225
    v_dot2_f32_f16 v30, v168, v168, v30
    v_dot2_f32_f16 v27, v144, s58, v27
    v_dot2_f32_f16 v29, v168, s58, v29
    v_dot2_f32_f16 v28, v145, v145, v28
    v_dot2_f32_f16 v30, v169, v169, v30
    v_dot2_f32_f16 v27, v145, s58, v27
    v_dot2_f32_f16 v29, v169, s58, v29
    v_cvt_pkrtz_f16_f32 v170, v228, v229
    v_cvt_pkrtz_f16_f32 v147, v226, v227
    v_cvt_pkrtz_f16_f32 v171, v230, v231
    v_mfma_f32_16x16x32_bf16 v[148:151], v[192:195], a[232:235], 0
    buffer_store_dwordx4 v[120:123], v26, s[24:27], s83 offen offset:128 sc0 sc1
    v_mfma_f32_16x16x32_bf16 v[172:175], v[192:195], a[244:247], 0
    ds_read_b128 v[64:67], v25 offset:256
    s_nop 2
    v_smfmac_f32_16x16x64_bf16 v[148:151], v[200:203], a[236:243], v16
    ds_read_b128 v[68:71], v25 offset:272
    v_smfmac_f32_16x16x64_bf16 v[172:175], v[200:203], a[248:255], v16
    s_nop 5
    v_cvt_pkrtz_f16_f32 v148, v148, v149
    s_waitcnt lgkmcnt(9)
    v_mfma_f32_16x16x32_bf16 v[224:227], v[196:199], v[176:179], 0
    ds_read_b128 a[232:235], v23 offset:2048
    ds_read_b128 a[236:239], v23 offset:3072
    v_cvt_pkrtz_f16_f32 v172, v172, v173
    v_mfma_f32_16x16x32_bf16 v[228:231], v[196:199], v[188:191], 0
    s_add_u32 s80, s80, 786432
    ds_read_b128 a[240:243], v23 offset:4096
    ds_read_b128 a[244:247], v23 offset:5120
    v_cvt_pkrtz_f16_f32 v149, v150, v151
    v_cvt_pkrtz_f16_f32 v173, v174, v175
    s_add_u32 s81, s81, 786432
    s_add_u32 s82, s82, 786432
    s_add_u32 s83, s83, 786432
    s_waitcnt lgkmcnt(7)
    v_smfmac_f32_16x16x64_bf16 v[224:227], v[204:207], v[180:187], v16
    ds_read_b128 a[248:251], v23 offset:12288
    v_smfmac_f32_16x16x64_bf16 v[228:231], v[204:207], v[232:239], v16
    ds_read_b128 a[252:255], v23 offset:13312
L_mid:
    s_cmp_eq_u32 s52, 3
    s_cselect_b32 s57, 0x40000000, 786432
    v_add_u32 v1, s57, v1
    v_add_u32 v2, s57, v2
    v_add_u32 v3, s57, v3
    v_cvt_pkrtz_f16_f32 v150, v224, v225
    v_cvt_pkrtz_f16_f32 v151, v226, v227
    v_cvt_pkrtz_f16_f32 v174, v228, v229
    v_cvt_pkrtz_f16_f32 v175, v230, v231
    v_add_u32 v4, s57, v4
    v_add_u32 v5, s57, v5
    v_add_u32 v6, s57, v6
    v_add_u32 v7, s57, v7
    v_add_u32 v31, s57, v31
    v_dot2_f32_f16 v28, v146, v146, v28
    v_dot2_f32_f16 v30, v170, v170, v30
    v_dot2_f32_f16 v27, v146, s58, v27
    v_dot2_f32_f16 v29, v170, s58, v29
    v_dot2_f32_f16 v28, v147, v147, v28
    v_dot2_f32_f16 v30, v171, v171, v30
    v_dot2_f32_f16 v27, v147, s58, v27
    v_dot2_f32_f16 v29, v171, s58, v29
    v_dot2_f32_f16 v28, v148, v148, v28
    v_dot2_f32_f16 v30, v172, v172, v30
    v_dot2_f32_f16 v27, v148, s58, v27
    v_dot2_f32_f16 v29, v172, s58, v29
    v_dot2_f32_f16 v28, v149, v149, v28
    v_dot2_f32_f16 v30, v173, v173, v30
    v_dot2_f32_f16 v27, v149, s58, v27
    v_dot2_f32_f16 v29, v173, s58, v29
    v_dot2_f32_f16 v28, v150, v150, v28
    v_dot2_f32_f16 v30, v174, v174, v30
    v_dot2_f32_f16 v27, v150, s58, v27
    v_dot2_f32_f16 v29, v174, s58, v29
    v_dot2_f32_f16 v28, v151, v151, v28
    v_dot2_f32_f16 v30, v175, v175, v30
    v_dot2_f32_f16 v27, v151, s58, v27
    v_dot2_f32_f16 v29, v175, s58, v29
    s_nop 1
    v_permlane32_swap_b32 v27, v28
    v_mfma_f32_16x16x16_bf16 v[96:99], v[18:19], v[216:217], v[48:51]
    s_waitcnt lgkmcnt(8)
    ds_read_b128 v[240:243], v20 offset:2560
    ds_read_b128 v[244:247], v21 offset:2560
    v_permlane32_swap_b32 v29, v30
    v_mfma_f32_16x16x16_bf16 v[100:103], v[18:19], v[218:219], v[52:55]
    ds_read_b128 v[236:239], v21 offset:0
    ds_read_b128 v[232:235], v20 offset:0
    v_add_f32 v27, v27, v28
    v_mfma_f32_16x16x16_bf16 v[104:107], v[18:19], v[220:221], v[48:51]
    v_add_f32 v29, v29, v30
    v_mov_b32 v28, v27
    v_mov_b32 v30, v29
    v_mfma_f32_16x16x16_bf16 v[108:111], v[18:19], v[222:223], v[52:55]
    v_permlane32_swap_b32 v27, v28
    v_permlane32_swap_b32 v29, v30
    v_mfma_f32_16x16x16_bf16 v[56:59], v[18:19], v[212:213], v[48:51]
    v_mul_f32 v27, 0x3c2aaaab, v27
    v_mul_f32 v29, 0x3c2aaaab, v29
    v_mul_f32 v28, 0x3c2aaaab, v28
    v_mfma_f32_16x16x16_bf16 v[60:63], v[18:19], v[214:215], v[52:55]
    v_mul_f32 v30, 0x3c2aaaab, v30
    v_fma_f32 v28, -v27, v27, v28
    v_fma_f32 v30, -v29, v29, v30
    v_mfma_f32_16x16x16_bf16 v[48:51], v[18:19], v[208:209], v[48:51]
    v_max_f32 v28, 0, v28
    v_max_f32 v30, 0, v30
    v_add_f32 v28, 0x3727c5ac, v28
    v_mfma_f32_16x16x16_bf16 v[52:55], v[18:19], v[210:211], v[52:55]
    v_add_f32 v30, 0x3727c5ac, v30
    v_rsq_f32 v28, v28
    v_rsq_f32 v30, v30
    v_fma_mixlo_f16 v28, v28, s59, 0
    v_fma_mixlo_f16 v30, v30, s59, 0
    v_fma_mixhi_f16 v28, -v27, v28, 0 op_sel_hi:[0,1,0]
    v_fma_mixhi_f16 v30, -v29, v30, 0 op_sel_hi:[0,1,0]
    v_pk_fma_f16 v128, v128, v28, v28 op_sel:[0,0,1] op_sel_hi:[1,0,1]
    v_pk_fma_f16 v129, v129, v28, v28 op_sel:[0,0,1] op_sel_hi:[1,0,1]
    v_pk_fma_f16 v130, v130, v28, v28 op_sel:[0,0,1] op_sel_hi:[1,0,1]
    v_pk_fma_f16 v131, v131, v28, v28 op_sel:[0,0,1] op_sel_hi:[1,0,1]
    v_pk_fma_f16 v132, v132, v28, v28 op_sel:[0,0,1] op_sel_hi:[1,0,1]
    v_pk_fma_f16 v133, v133, v28, v28 op_sel:[0,0,1] op_sel_hi:[1,0,1]
    v_pk_fma_f16 v134, v134, v28, v28 op_sel:[0,0,1] op_sel_hi:[1,0,1]
    v_pk_fma_f16 v135, v135, v28, v28 op_sel:[0,0,1] op_sel_hi:[1,0,1]
    v_permlane16_swap_b32 v128, v132
    v_permlane16_swap_b32 v129, v133
    v_permlane16_swap_b32 v130, v134
    v_permlane16_swap_b32 v131, v135
    v_pk_fma_f16 v136, v136, v28, v28 op_sel:[0,0,1] op_sel_hi:[1,0,1]
    v_pk_fma_f16 v137, v137, v28, v28 op_sel:[0,0,1] op_sel_hi:[1,0,1]
    v_mfma_f32_16x16x32_f16 v[176:179], a[192:195], v[128:131], 0
    v_pk_fma_f16 v138, v138, v28, v28 op_sel:[0,0,1] op_sel_hi:[1,0,1]
    v_pk_fma_f16 v139, v139, v28, v28 op_sel:[0,0,1] op_sel_hi:[1,0,1]
    v_pk_fma_f16 v140, v140, v28, v28 op_sel:[0,0,1] op_sel_hi:[1,0,1]
    v_mfma_f32_16x16x32_f16 v[184:187], a[192:195], v[132:135], 0
    v_pk_fma_f16 v141, v141, v28, v28 op_sel:[0,0,1] op_sel_hi:[1,0,1]
    v_pk_fma_f16 v142, v142, v28, v28 op_sel:[0,0,1] op_sel_hi:[1,0,1]
    v_pk_fma_f16 v143, v143, v28, v28 op_sel:[0,0,1] op_sel_hi:[1,0,1]
    v_mfma_f32_16x16x32_f16 v[180:183], a[196:199], v[128:131], 0
    v_permlane16_swap_b32 v136, v140
    v_permlane16_swap_b32 v137, v141
    v_mfma_f32_16x16x32_f16 v[188:191], a[196:199], v[132:135], 0
    s_waitcnt lgkmcnt(9)
    v_permlane16_swap_b32 v138, v142
    v_permlane16_swap_b32 v139, v143
    v_pk_fma_f16 v144, v144, v28, v28 op_sel:[0,0,1] op_sel_hi:[1,0,1]
    v_pk_fma_f16 v145, v145, v28, v28 op_sel:[0,0,1] op_sel_hi:[1,0,1]
    v_mfma_f32_16x16x32_f16 v[176:179], a[232:235], v[136:139], v[176:179]
    v_pk_fma_f16 v146, v146, v28, v28 op_sel:[0,0,1] op_sel_hi:[1,0,1]
    v_pk_fma_f16 v147, v147, v28, v28 op_sel:[0,0,1] op_sel_hi:[1,0,1]
    v_pk_fma_f16 v151, v151, v28, v28 op_sel:[0,0,1] op_sel_hi:[1,0,1]
    v_mfma_f32_16x16x32_f16 v[184:187], a[232:235], v[140:143], v[184:187]
    s_waitcnt lgkmcnt(8)
    v_pk_fma_f16 v148, v148, v28, v28 op_sel:[0,0,1] op_sel_hi:[1,0,1]
    v_pk_fma_f16 v149, v149, v28, v28 op_sel:[0,0,1] op_sel_hi:[1,0,1]
    v_bfi_b32 v151, v17, v151, s84
    v_mfma_f32_16x16x32_f16 v[180:183], a[236:239], v[136:139], v[180:183]
    v_pk_fma_f16 v150, v150, v28, v28 op_sel:[0,0,1] op_sel_hi:[1,0,1]
    v_permlane16_swap_b32 v144, v148
    v_mfma_f32_16x16x32_f16 v[188:191], a[236:239], v[140:143], v[188:191]
    s_waitcnt lgkmcnt(7)
    v_permlane16_swap_b32 v145, v149
    v_permlane16_swap_b32 v146, v150
    v_permlane16_swap_b32 v147, v151
    v_pk_fma_f16 v152, v152, v30, v30 op_sel:[0,0,1] op_sel_hi:[1,0,1]
    v_pk_fma_f16 v153, v153, v30, v30 op_sel:[0,0,1] op_sel_hi:[1,0,1]
    v_mfma_f32_16x16x32_f16 v[176:179], a[240:243], v[144:147], v[176:179]
    v_pk_fma_f16 v154, v154, v30, v30 op_sel:[0,0,1] op_sel_hi:[1,0,1]
    v_pk_fma_f16 v155, v155, v30, v30 op_sel:[0,0,1] op_sel_hi:[1,0,1]
    v_pk_fma_f16 v156, v156, v30, v30 op_sel:[0,0,1] op_sel_hi:[1,0,1]
    v_mfma_f32_16x16x32_f16 v[184:187], a[240:243], v[148:151], v[184:187]
    s_waitcnt lgkmcnt(6)
    v_pk_fma_f16 v157, v157, v30, v30 op_sel:[0,0,1] op_sel_hi:[1,0,1]
    v_pk_fma_f16 v158, v158, v30, v30 op_sel:[0,0,1] op_sel_hi:[1,0,1]
    v_pk_fma_f16 v159, v159, v30, v30 op_sel:[0,0,1] op_sel_hi:[1,0,1]
    v_mfma_f32_16x16x32_f16 v[180:183], a[244:247], v[144:147], v[180:183]
    v_permlane16_swap_b32 v152, v156
    v_permlane16_swap_b32 v153, v157
    v_mfma_f32_16x16x32_f16 v[188:191], a[244:247], v[148:151], v[188:191]
    v_permlane16_swap_b32 v154, v158
    v_permlane16_swap_b32 v155, v159
    v_pk_fma_f16 v160, v160, v30, v30 op_sel:[0,0,1] op_sel_hi:[1,0,1]
    v_pk_fma_f16 v161, v161, v30, v30 op_sel:[0,0,1] op_sel_hi:[1,0,1]
    v_mfma_f32_16x16x32_f16 v[192:195], a[192:195], v[152:155], 0
    v_pk_fma_f16 v162, v162, v30, v30 op_sel:[0,0,1] op_sel_hi:[1,0,1]
    v_pk_fma_f16 v163, v163, v30, v30 op_sel:[0,0,1] op_sel_hi:[1,0,1]
    v_pk_fma_f16 v164, v164, v30, v30 op_sel:[0,0,1] op_sel_hi:[1,0,1]
    v_mfma_f32_16x16x32_f16 v[200:203], a[192:195], v[156:159], 0
    v_pk_fma_f16 v165, v165, v30, v30 op_sel:[0,0,1] op_sel_hi:[1,0,1]
    v_pk_fma_f16 v166, v166, v30, v30 op_sel:[0,0,1] op_sel_hi:[1,0,1]
    v_pk_fma_f16 v167, v167, v30, v30 op_sel:[0,0,1] op_sel_hi:[1,0,1]
    v_mfma_f32_16x16x32_f16 v[196:199], a[196:199], v[152:155], 0
    v_permlane16_swap_b32 v160, v164
    v_permlane16_swap_b32 v161, v165
    v_mfma_f32_16x16x32_f16 v[204:207], a[196:199], v[156:159], 0
    v_permlane16_swap_b32 v162, v166
    v_permlane16_swap_b32 v163, v167
    v_pk_fma_f16 v168, v168, v30, v30 op_sel:[0,0,1] op_sel_hi:[1,0,1]
    v_pk_fma_f16 v169, v169, v30, v30 op_sel:[0,0,1] op_sel_hi:[1,0,1]
    v_mfma_f32_16x16x32_f16 v[192:195], a[232:235], v[160:163], v[192:195]
    v_pk_fma_f16 v170, v170, v30, v30 op_sel:[0,0,1] op_sel_hi:[1,0,1]
    v_pk_fma_f16 v171, v171, v30, v30 op_sel:[0,0,1] op_sel_hi:[1,0,1]
    v_pk_fma_f16 v175, v175, v30, v30 op_sel:[0,0,1] op_sel_hi:[1,0,1]
    v_mfma_f32_16x16x32_f16 v[200:203], a[232:235], v[164:167], v[200:203]
    ds_read_b128 a[232:235], v23 offset:14336
    v_pk_fma_f16 v172, v172, v30, v30 op_sel:[0,0,1] op_sel_hi:[1,0,1]
    v_pk_fma_f16 v173, v173, v30, v30 op_sel:[0,0,1] op_sel_hi:[1,0,1]
    v_mfma_f32_16x16x32_f16 v[196:199], a[236:239], v[160:163], v[196:199]
    s_add_u32 m0, s56, 6336
    v_bfi_b32 v175, v17, v175, s84
    v_pk_fma_f16 v174, v174, v30, v30 op_sel:[0,0,1] op_sel_hi:[1,0,1]
    v_permlane16_swap_b32 v168, v172
    v_mfma_f32_16x16x32_f16 v[204:207], a[236:239], v[164:167], v[204:207]
    buffer_load_dwordx4 v1, s[20:23], 0 offen offset:64 lds
    ds_read_b128 a[236:239], v23 offset:15360
    v_permlane16_swap_b32 v169, v173
    v_permlane16_swap_b32 v170, v174
    v_permlane16_swap_b32 v171, v175
    v_cvt_pkrtz_f16_f32 v208, v176, v177
    v_cvt_pkrtz_f16_f32 v210, v178, v179
    v_mfma_f32_16x16x32_f16 v[192:195], a[240:243], v[168:171], v[192:195]
    v_pk_lshrrev_b16 v208, 3, v208 op_sel_hi:[0,1]
    v_pk_lshrrev_b16 v210, 3, v210 op_sel_hi:[0,1]
    v_mad_u32_u16 v209, v208, 2, s85
    v_mfma_f32_16x16x32_f16 v[200:203], a[240:243], v[172:175], v[200:203]
    ds_read_u16 v209, v209
    ds_read_b128 a[240:243], v23 offset:6144
    v_mad_u32_u16 v208, v208, 2, s85 op_sel:[1,0,0,0]
    v_mfma_f32_16x16x32_f16 v[196:199], a[244:247], v[168:171], v[196:199]
    ds_read_u16_d16_hi v208, v208
    v_mad_u32_u16 v211, v210, 2, s85
    v_mad_u32_u16 v210, v210, 2, s85 op_sel:[1,0,0,0]
    v_mfma_f32_16x16x32_f16 v[204:207], a[244:247], v[172:175], v[204:207]
    s_waitcnt lgkmcnt(8)
    ds_read_u16 v211, v211
    ds_read_u16_d16_hi v210, v210
    v_cvt_pkrtz_f16_f32 v212, v180, v181
    v_mfma_f32_16x16x16_bf16 v[112:115], v[18:19], v[240:241], v[64:67]
    ds_read_b128 a[244:247], v23 offset:7168
    v_cvt_pkrtz_f16_f32 v214, v182, v183
    v_pk_lshrrev_b16 v212, 3, v212 op_sel_hi:[0,1]
    v_mfma_f32_16x16x16_bf16 v[116:119], v[18:19], v[242:243], v[68:71]
    s_waitcnt lgkmcnt(10)
    v_pk_lshrrev_b16 v214, 3, v214 op_sel_hi:[0,1]
    v_mad_u32_u16 v213, v212, 2, s85
    v_mad_u32_u16 v212, v212, 2, s85 op_sel:[1,0,0,0]
    v_mfma_f32_16x16x16_bf16 v[120:123], v[18:19], v[244:245], v[64:67]
    ds_read_u16 v213, v213
    ds_read_u16_d16_hi v212, v212
    v_mad_u32_u16 v215, v214, 2, s85
    v_mfma_f32_16x16x16_bf16 v[124:127], v[18:19], v[246:247], v[68:71]
    s_waitcnt lgkmcnt(11)
    ds_read_u16 v215, v215
    v_mad_u32_u16 v214, v214, 2, s85 op_sel:[1,0,0,0]
    v_cvt_pkrtz_f16_f32 v216, v184, v185
    v_mfma_f32_16x16x16_bf16 v[72:75], v[18:19], v[236:237], v[64:67]
    ds_read_u16_d16_hi v214, v214
    v_cvt_pkrtz_f16_f32 v218, v186, v187
    v_pk_lshrrev_b16 v216, 3, v216 op_sel_hi:[0,1]
    v_mfma_f32_16x16x16_bf16 v[76:79], v[18:19], v[238:239], v[68:71]
    s_waitcnt lgkmcnt(12)
    v_pk_lshrrev_b16 v218, 3, v218 op_sel_hi:[0,1]
    v_mad_u32_u16 v217, v216, 2, s85
    v_mad_u32_u16 v216, v216, 2, s85 op_sel:[1,0,0,0]
    v_mfma_f32_16x16x16_bf16 v[64:67], v[18:19], v[232:233], v[64:67]
    ds_read_u16 v217, v217
    ds_read_u16_d16_hi v216, v216
    v_mad_u32_u16 v219, v218, 2, s85
    v_mfma_f32_16x16x16_bf16 v[68:71], v[18:19], v[234:235], v[68:71]
    s_waitcnt lgkmcnt(13)
    ds_read_u16 v219, v219
    v_mad_u32_u16 v218, v218, 2, s85 op_sel:[1,0,0,0]
    v_cvt_pkrtz_f16_f32 v220, v188, v189
    v_mfma_f32_16x16x32_f16 v[176:179], a[200:203], v[128:131], 0
    s_waitcnt lgkmcnt(13)
    ds_read_u16_d16_hi v218, v218
    v_cvt_pkrtz_f16_f32 v224, v190, v191
    v_pk_lshrrev_b16 v220, 3, v220 op_sel_hi:[0,1]
    v_mfma_f32_16x16x32_f16 v[184:187], a[200:203], v[132:135], 0
    s_waitcnt lgkmcnt(7)
    v_mad_u32_u16 v221, v220, 2, s85
    v_mad_u32_u16 v220, v220, 2, s85 op_sel:[1,0,0,0]
    v_pk_fma_f16 v222, v224, v224, s53
    v_pk_mul_f16 v222, v222, v224 neg_lo:[1,0] neg_hi:[1,0]
    v_exp_f16 v223, v222
    v_or_b32 v232, v209, v208
    v_exp_f16_sdwa v223, v222 dst_sel:WORD_1 dst_unused:UNUSED_PRESERVE src0_sel:WORD_1
    v_or_b32 v233, v211, v210
    v_pk_fma_f16 v223, v223, s86, s86
    v_rcp_f16 v222, v223
    s_waitcnt lgkmcnt(6)
    v_or_b32 v234, v213, v212
    v_rcp_f16_sdwa v222, v223 dst_sel:WORD_1 dst_unused:UNUSED_PRESERVE src0_sel:WORD_1
    s_waitcnt lgkmcnt(4)
    v_or_b32 v235, v215, v214
    v_fma_mix_f32 v223, v222, v224, 0 op_sel_hi:[1,1,0]
    v_fma_mix_f32 v222, v222, v224, 0 op_sel:[1,1,0] op_sel_hi:[1,1,0]
    v_cvt_pk_bf16_f32 v239, v223, v222
    v_cvt_pkrtz_f16_f32 v225, v192, v193
    v_cvt_pkrtz_f16_f32 v227, v194, v195
    v_mfma_f32_16x16x32_f16 v[192:195], a[200:203], v[152:155], 0
    s_waitcnt lgkmcnt(3)
    ds_read_u16 v221, v221
    ds_read_u16_d16_hi v220, v220
    v_pk_lshrrev_b16 v225, 3, v225 op_sel_hi:[0,1]
    v_pk_lshrrev_b16 v227, 3, v227 op_sel_hi:[0,1]
    v_cvt_pkrtz_f16_f32 v229, v196, v197
    v_cvt_pkrtz_f16_f32 v231, v198, v199
    v_cvt_pkrtz_f16_f32 v249, v200, v201
    s_waitcnt lgkmcnt(4)
    v_or_b32 v236, v217, v216
    v_cvt_pkrtz_f16_f32 v251, v202, v203
    v_mfma_f32_16x16x32_f16 v[200:203], a[200:203], v[156:159], 0
    v_cvt_pkrtz_f16_f32 v253, v204, v205
    v_cvt_pkrtz_f16_f32 v210, v206, v207
    v_mad_u32_u16 v226, v225, 2, s85
    v_mfma_f32_16x16x32_f16 v[180:183], a[204:207], v[128:131], 0
    ds_read_u16 v226, v226
    v_mad_u32_u16 v225, v225, 2, s85 op_sel:[1,0,0,0]
    v_mad_u32_u16 v228, v227, 2, s85
    v_mfma_f32_16x16x32_f16 v[188:191], a[204:207], v[132:135], 0
    s_waitcnt lgkmcnt(3)
    ds_read_u16_d16_hi v225, v225
    ds_read_u16 v228, v228
    v_or_b32 v237, v219, v218
    v_mfma_f32_16x16x32_f16 v[196:199], a[204:207], v[152:155], 0
    v_mad_u32_u16 v227, v227, 2, s85 op_sel:[1,0,0,0]
    v_pk_lshrrev_b16 v229, 3, v229 op_sel_hi:[0,1]
    v_pk_lshrrev_b16 v231, 3, v231 op_sel_hi:[0,1]
    v_mfma_f32_16x16x32_f16 v[204:207], a[204:207], v[156:159], 0
    ds_read_u16_d16_hi v227, v227
    v_mad_u32_u16 v230, v229, 2, s85
    v_mad_u32_u16 v229, v229, 2, s85 op_sel:[1,0,0,0]
    v_mfma_f32_16x16x32_f16 v[176:179], a[248:251], v[136:139], v[176:179]
    s_waitcnt lgkmcnt(4)
    ds_read_u16 v230, v230
    ds_read_u16_d16_hi v229, v229
    v_or_b32 v238, v221, v220
    v_mfma_f32_16x16x32_f16 v[184:187], a[248:251], v[140:143], v[184:187]
    v_mad_u32_u16 v248, v231, 2, s85
    v_mad_u32_u16 v231, v231, 2, s85 op_sel:[1,0,0,0]
    v_pk_lshrrev_b16 v249, 3, v249 op_sel_hi:[0,1]
    v_mfma_f32_16x16x32_f16 v[192:195], a[248:251], v[160:163], v[192:195]
    ds_read_u16 v248, v248
    ds_read_u16_d16_hi v231, v231
    v_pk_lshrrev_b16 v251, 3, v251 op_sel_hi:[0,1]
    v_mfma_f32_16x16x32_f16 v[200:203], a[248:251], v[164:167], v[200:203]
    ds_read_b128 a[248:251], v23 offset:8192
    v_mad_u32_u16 v250, v249, 2, s85
    v_mad_u32_u16 v249, v249, 2, s85 op_sel:[1,0,0,0]
    v_mfma_f32_16x16x32_f16 v[180:183], a[252:255], v[136:139], v[180:183]
    s_add_u32 m0, s56, 7360
    ds_read_u16 v250, v250
    ds_read_u16_d16_hi v249, v249
    v_mad_u32_u16 v252, v251, 2, s85
    v_mfma_f32_16x16x32_f16 v[188:191], a[252:255], v[140:143], v[188:191]
    ds_read_u16 v252, v252
    buffer_load_dwordx4 v2, s[20:23], 0 offen offset:64 lds
    v_mfma_f32_16x16x32_f16 v[196:199], a[252:255], v[160:163], v[196:199]
    v_mad_u32_u16 v251, v251, 2, s85 op_sel:[1,0,0,0]
    v_pk_lshrrev_b16 v253, 3, v253 op_sel_hi:[0,1]
    v_mad_u32_u16 v0, v253, 2, s85
    v_mfma_f32_16x16x32_f16 v[204:207], a[252:255], v[164:167], v[204:207]
    ds_read_u16_d16_hi v251, v251
    ds_read_u16 v0, v0
    v_mad_u32_u16 v253, v253, 2, s85 op_sel:[1,0,0,0]
    v_mfma_f32_16x16x32_f16 v[176:179], a[232:235], v[144:147], v[176:179]
    s_waitcnt lgkmcnt(12)
    ds_read_u16_d16_hi v253, v253
    ds_read_b128 a[252:255], v23 offset:9216
    v_pk_fma_f16 v208, v210, v210, s53
    v_mfma_f32_16x16x32_f16 v[184:187], a[232:235], v[148:151], v[184:187]
    v_pk_mul_f16 v208, v208, v210 neg_lo:[1,0] neg_hi:[1,0]
    v_exp_f16 v209, v208
    v_mfma_f32_16x16x32_f16 v[192:195], a[232:235], v[168:171], v[192:195]
    v_exp_f16_sdwa v209, v208 dst_sel:WORD_1 dst_unused:UNUSED_PRESERVE src0_sel:WORD_1
    v_or_b32 v240, v226, v225
    v_mfma_f32_16x16x32_f16 v[200:203], a[232:235], v[172:175], v[200:203]
    s_waitcnt lgkmcnt(13)
    ds_read_b128 a[232:235], v23 offset:0
    v_pk_fma_f16 v209, v209, s86, s86
    v_rcp_f16 v208, v209
    v_mfma_f32_16x16x32_f16 v[180:183], a[236:239], v[144:147], v[180:183]
    s_waitcnt lgkmcnt(13)
    v_rcp_f16_sdwa v208, v209 dst_sel:WORD_1 dst_unused:UNUSED_PRESERVE src0_sel:WORD_1
    v_or_b32 v241, v228, v227
    v_mfma_f32_16x16x32_f16 v[188:191], a[236:239], v[148:151], v[188:191]
    s_waitcnt lgkmcnt(11)
    v_fma_mix_f32 v209, v208, v210, 0 op_sel_hi:[1,1,0]
    v_fma_mix_f32 v208, v208, v210, 0 op_sel:[1,1,0] op_sel_hi:[1,1,0]
    v_or_b32 v242, v230, v229
    v_mfma_f32_16x16x32_f16 v[196:199], a[236:239], v[168:171], v[196:199]
    s_waitcnt lgkmcnt(9)
    v_or_b32 v243, v248, v231
    v_cvt_pk_bf16_f32 v247, v209, v208
    v_cvt_pkrtz_f16_f32 v211, v176, v177
    v_mfma_f32_16x16x32_f16 v[204:207], a[236:239], v[172:175], v[204:207]
    s_waitcnt lgkmcnt(6)
    ds_read_b128 a[236:239], v23 offset:1024
    v_or_b32 v244, v250, v249
    v_cvt_pkrtz_f16_f32 v213, v178, v179
    v_mfma_f32_16x16x32_bf16 v[32:35], a[240:243], v[232:235], v[32:35]
    v_pk_lshrrev_b16 v211, 3, v211 op_sel_hi:[0,1]
    v_pk_lshrrev_b16 v213, 3, v213 op_sel_hi:[0,1]
    v_mad_u32_u16 v212, v211, 2, s85
    v_mfma_f32_16x16x32_bf16 v[40:43], a[240:243], v[236:239], v[40:43]
    ds_read_u16 v212, v212
    v_mad_u32_u16 v211, v211, 2, s85 op_sel:[1,0,0,0]
    v_mad_u32_u16 v214, v213, 2, s85
    v_mfma_f32_16x16x32_bf16 v[80:83], a[240:243], v[240:243], v[80:83]
    s_waitcnt lgkmcnt(6)
    ds_read_u16_d16_hi v211, v211
    ds_read_u16 v214, v214
    v_or_b32 v245, v252, v251
    v_mad_u32_u16 v213, v213, 2, s85 op_sel:[1,0,0,0]
    v_cvt_pkrtz_f16_f32 v215, v180, v181
    v_cvt_pkrtz_f16_f32 v217, v182, v183
    v_pk_lshrrev_b16 v215, 3, v215 op_sel_hi:[0,1]
    v_pk_lshrrev_b16 v217, 3, v217 op_sel_hi:[0,1]
    v_mad_u32_u16 v216, v215, 2, s85
    v_mad_u32_u16 v215, v215, 2, s85 op_sel:[1,0,0,0]
    v_mad_u32_u16 v218, v217, 2, s85
    v_mad_u32_u16 v217, v217, 2, s85 op_sel:[1,0,0,0]
    v_cvt_pkrtz_f16_f32 v219, v184, v185
    v_cvt_pkrtz_f16_f32 v221, v186, v187
    s_waitcnt lgkmcnt(6)
    v_or_b32 v246, v0, v253
    v_pk_lshrrev_b16 v219, 3, v219 op_sel_hi:[0,1]
    v_pk_lshrrev_b16 v221, 3, v221 op_sel_hi:[0,1]
    v_mfma_f32_16x16x32_bf16 v[88:91], a[240:243], v[244:247], v[88:91]
    ds_read_u16_d16_hi v213, v213
    ds_read_u16 v216, v216
    v_mad_u32_u16 v220, v219, 2, s85
    v_mfma_f32_16x16x32_bf16 v[36:39], a[244:247], v[232:235], v[36:39]
    ds_read_u16_d16_hi v215, v215
    ds_read_u16 v218, v218
    v_mad_u32_u16 v219, v219, 2, s85 op_sel:[1,0,0,0]
    v_mfma_f32_16x16x32_bf16 v[44:47], a[244:247], v[236:239], v[44:47]
    ds_read_u16_d16_hi v217, v217
    ds_read_u16 v220, v220
    v_mad_u32_u16 v222, v221, 2, s85
    v_mfma_f32_16x16x32_bf16 v[84:87], a[244:247], v[240:243], v[84:87]
    ds_read_u16_d16_hi v219, v219
    ds_read_u16 v222, v222
    v_mad_u32_u16 v221, v221, 2, s85 op_sel:[1,0,0,0]
    v_mfma_f32_16x16x32_bf16 v[92:95], a[244:247], v[244:247], v[92:95]
    s_waitcnt lgkmcnt(12)
    ds_read_u16_d16_hi v221, v221
    ds_read_b128 a[240:243], v23 offset:22528
    v_cvt_pkrtz_f16_f32 v223, v188, v189
    v_mfma_f32_16x16x32_bf16 v[48:51], a[248:251], v[232:235], v[48:51]
    s_waitcnt lgkmcnt(13)
    ds_read_b128 a[244:247], v23 offset:23552
    v_cvt_pkrtz_f16_f32 v227, v190, v191
    v_pk_lshrrev_b16 v223, 3, v223 op_sel_hi:[0,1]
    v_mfma_f32_16x16x32_bf16 v[56:59], a[248:251], v[236:239], v[56:59]
    v_mad_u32_u16 v224, v223, 2, s85
    v_mad_u32_u16 v223, v223, 2, s85 op_sel:[1,0,0,0]
    v_pk_fma_f16 v225, v227, v227, s53
    v_mfma_f32_16x16x32_bf16 v[96:99], a[248:251], v[240:243], v[96:99]
    s_waitcnt lgkmcnt(12)
    ds_read_u16 v224, v224
    ds_read_u16_d16_hi v223, v223
    v_pk_mul_f16 v225, v225, v227 neg_lo:[1,0] neg_hi:[1,0]
    v_mfma_f32_16x16x32_bf16 v[104:107], a[248:251], v[244:247], v[104:107]
    s_waitcnt lgkmcnt(13)
    ds_read_b128 a[248:251], v23 offset:24576
    v_exp_f16 v226, v225
    v_mfma_f32_16x16x32_bf16 v[52:55], a[252:255], v[232:235], v[52:55]
    s_add_u32 m0, s56, 8384
    v_exp_f16_sdwa v226, v225 dst_sel:WORD_1 dst_unused:UNUSED_PRESERVE src0_sel:WORD_1
    v_cvt_pkrtz_f16_f32 v228, v192, v193
    v_mfma_f32_16x16x32_bf16 v[60:63], a[252:255], v[236:239], v[60:63]
    buffer_load_dwordx4 v3, s[20:23], 0 offen offset:64 lds
    v_pk_fma_f16 v226, v226, s86, s86
    v_mfma_f32_16x16x32_bf16 v[100:103], a[252:255], v[240:243], v[100:103]
    v_rcp_f16 v225, v226
    v_cvt_pkrtz_f16_f32 v230, v194, v195
    v_mfma_f32_16x16x32_bf16 v[108:111], a[252:255], v[244:247], v[108:111]
    s_waitcnt lgkmcnt(13)
    ds_read_b128 a[252:255], v23 offset:25600
    v_rcp_f16_sdwa v225, v226 dst_sel:WORD_1 dst_unused:UNUSED_PRESERVE src0_sel:WORD_1
    v_mfma_f32_16x16x32_bf16 v[64:67], a[232:235], v[232:235], v[64:67]
    v_fma_mix_f32 v226, v225, v227, 0 op_sel_hi:[1,1,0]
    v_fma_mix_f32 v225, v225, v227, 0 op_sel:[1,1,0] op_sel_hi:[1,1,0]
    v_pk_lshrrev_b16 v228, 3, v228 op_sel_hi:[0,1]
    v_mfma_f32_16x16x32_bf16 v[72:75], a[232:235], v[236:239], v[72:75]
    v_pk_lshrrev_b16 v230, 3, v230 op_sel_hi:[0,1]
    v_cvt_pkrtz_f16_f32 v248, v196, v197
    v_cvt_pkrtz_f16_f32 v250, v198, v199
    v_mfma_f32_16x16x32_bf16 v[112:115], a[232:235], v[240:243], v[112:115]
    v_cvt_pkrtz_f16_f32 v252, v200, v201
    v_cvt_pkrtz_f16_f32 v0, v202, v203
    v_cvt_pkrtz_f16_f32 v209, v204, v205
    v_mfma_f32_16x16x32_bf16 v[120:123], a[232:235], v[244:247], v[120:123]
    s_waitcnt lgkmcnt(13)
    ds_read_b128 a[232:235], v23 offset:16384
    v_mad_u32_u16 v229, v228, 2, s85
    v_mad_u32_u16 v228, v228, 2, s85 op_sel:[1,0,0,0]
    v_mfma_f32_16x16x32_bf16 v[68:71], a[236:239], v[232:235], v[68:71]
    s_waitcnt lgkmcnt(12)
    ds_read_u16 v229, v229
    ds_read_u16_d16_hi v228, v228
    v_or_b32 v232, v212, v211
    v_mfma_f32_16x16x32_bf16 v[76:79], a[236:239], v[236:239], v[76:79]
    s_waitcnt lgkmcnt(13)
    v_or_b32 v233, v214, v213
    v_or_b32 v234, v216, v215
    v_or_b32 v235, v218, v217
    v_mfma_f32_16x16x32_bf16 v[116:119], a[236:239], v[240:243], v[116:119]
    s_waitcnt lgkmcnt(9)
    v_or_b32 v236, v220, v219
    v_or_b32 v237, v222, v221
    v_cvt_pk_bf16_f32 v239, v226, v225
    v_mfma_f32_16x16x32_bf16 v[124:127], a[236:239], v[244:247], v[124:127]
    ds_read_b128 a[236:239], v23 offset:17408
    v_cvt_pkrtz_f16_f32 v213, v206, v207
    v_mad_u32_u16 v231, v230, 2, s85
    v_mfma_f32_16x16x32_f16 v[176:179], a[208:211], v[128:131], 0
    ds_read_u16 v231, v231
    v_mad_u32_u16 v230, v230, 2, s85 op_sel:[1,0,0,0]
    v_pk_lshrrev_b16 v248, 3, v248 op_sel_hi:[0,1]
    v_mfma_f32_16x16x32_f16 v[184:187], a[208:211], v[132:135], 0
    ds_read_u16_d16_hi v230, v230
    v_pk_lshrrev_b16 v250, 3, v250 op_sel_hi:[0,1]
    v_mad_u32_u16 v249, v248, 2, s85
    v_mfma_f32_16x16x32_f16 v[192:195], a[208:211], v[152:155], 0
    s_waitcnt lgkmcnt(9)
    ds_read_u16 v249, v249
    v_mad_u32_u16 v248, v248, 2, s85 op_sel:[1,0,0,0]
    s_waitcnt lgkmcnt(9)
    v_or_b32 v238, v224, v223
    v_mfma_f32_16x16x32_f16 v[200:203], a[208:211], v[156:159], 0
    ds_read_u16_d16_hi v248, v248
    v_mad_u32_u16 v251, v250, 2, s85
    v_mad_u32_u16 v250, v250, 2, s85 op_sel:[1,0,0,0]
    v_mfma_f32_16x16x32_f16 v[180:183], a[212:215], v[128:131], 0
    ds_read_u16 v251, v251
    ds_read_u16_d16_hi v250, v250
    v_pk_lshrrev_b16 v252, 3, v252 op_sel_hi:[0,1]
    v_mfma_f32_16x16x32_f16 v[188:191], a[212:215], v[132:135], 0
    v_pk_lshrrev_b16 v0, 3, v0 op_sel_hi:[0,1]
    v_mad_u32_u16 v253, v252, 2, s85
    v_mad_u32_u16 v252, v252, 2, s85 op_sel:[1,0,0,0]
    v_mfma_f32_16x16x32_f16 v[196:199], a[212:215], v[152:155], 0
    ds_read_u16 v253, v253
    ds_read_u16_d16_hi v252, v252
    v_mad_u32_u16 v208, v0, 2, s85
    v_mfma_f32_16x16x32_f16 v[204:207], a[212:215], v[156:159], 0
    s_waitcnt lgkmcnt(13)
    ds_read_u16 v208, v208
    v_mad_u32_u16 v0, v0, 2, s85 op_sel:[1,0,0,0]
    v_pk_lshrrev_b16 v209, 3, v209 op_sel_hi:[0,1]
    v_mfma_f32_16x16x32_f16 v[176:179], a[240:243], v[136:139], v[176:179]
    s_waitcnt lgkmcnt(13)
    ds_read_u16_d16_hi v0, v0
    v_mad_u32_u16 v210, v209, 2, s85
    v_mad_u32_u16 v209, v209, 2, s85 op_sel:[1,0,0,0]
    v_mfma_f32_16x16x32_f16 v[184:187], a[240:243], v[140:143], v[184:187]
    s_waitcnt lgkmcnt(12)
    ds_read_u16 v210, v210
    ds_read_u16_d16_hi v209, v209
    v_pk_fma_f16 v211, v213, v213, s53
    v_mfma_f32_16x16x32_f16 v[192:195], a[240:243], v[160:163], v[192:195]
    v_pk_mul_f16 v211, v211, v213 neg_lo:[1,0] neg_hi:[1,0]
    v_exp_f16 v212, v211
    v_mfma_f32_16x16x32_f16 v[200:203], a[240:243], v[164:167], v[200:203]
    s_waitcnt lgkmcnt(13)
    ds_read_b128 a[240:243], v23 offset:18432
    v_exp_f16_sdwa v212, v211 dst_sel:WORD_1 dst_unused:UNUSED_PRESERVE src0_sel:WORD_1
    v_mfma_f32_16x16x32_f16 v[180:183], a[244:247], v[136:139], v[180:183]
    s_add_u32 m0, s56, 9408
    v_pk_fma_f16 v212, v212, s86, s86
    v_rcp_f16 v211, v212
    v_mfma_f32_16x16x32_f16 v[188:191], a[244:247], v[140:143], v[188:191]
    buffer_load_dwordx4 v4, s[20:23], 0 offen offset:64 lds
    v_rcp_f16_sdwa v211, v212 dst_sel:WORD_1 dst_unused:UNUSED_PRESERVE src0_sel:WORD_1
    v_mfma_f32_16x16x32_f16 v[196:199], a[244:247], v[160:163], v[196:199]
    v_fma_mix_f32 v212, v211, v213, 0 op_sel_hi:[1,1,0]
    v_fma_mix_f32 v211, v211, v213, 0 op_sel:[1,1,0] op_sel_hi:[1,1,0]
    v_or_b32 v240, v229, v228
    v_mfma_f32_16x16x32_f16 v[204:207], a[244:247], v[164:167], v[204:207]
    s_waitcnt lgkmcnt(9)
    ds_read_b128 a[244:247], v23 offset:19456
    v_or_b32 v241, v231, v230
    v_or_b32 v242, v249, v248
    v_mfma_f32_16x16x32_f16 v[176:179], a[248:251], v[144:147], v[176:179]
    v_cvt_pk_bf16_f32 v247, v212, v211
    v_mfma_f32_16x16x32_f16 v[184:187], a[248:251], v[148:151], v[184:187]
    s_waitcnt lgkmcnt(8)
    v_or_b32 v243, v251, v250
    v_mfma_f32_16x16x32_f16 v[192:195], a[248:251], v[168:171], v[192:195]
    v_mfma_f32_16x16x32_f16 v[200:203], a[248:251], v[172:175], v[200:203]
    ds_read_b128 a[248:251], v23 offset:10240
    v_mfma_f32_16x16x32_f16 v[180:183], a[252:255], v[144:147], v[180:183]
    v_cvt_pkrtz_f16_f32 v214, v176, v177
    v_cvt_pkrtz_f16_f32 v216, v178, v179
    v_pk_lshrrev_b16 v214, 3, v214 op_sel_hi:[0,1]
    v_mfma_f32_16x16x32_f16 v[188:191], a[252:255], v[148:151], v[188:191]
    s_waitcnt lgkmcnt(7)
    v_or_b32 v244, v253, v252
    v_pk_lshrrev_b16 v216, 3, v216 op_sel_hi:[0,1]
    v_mad_u32_u16 v215, v214, 2, s85
    v_mfma_f32_16x16x32_f16 v[196:199], a[252:255], v[168:171], v[196:199]
    ds_read_u16 v215, v215
    v_mad_u32_u16 v214, v214, 2, s85 op_sel:[1,0,0,0]
    v_mad_u32_u16 v217, v216, 2, s85
    v_mfma_f32_16x16x32_f16 v[204:207], a[252:255], v[172:175], v[204:207]
    ds_read_b128 a[252:255], v23 offset:11264
    ds_read_u16_d16_hi v214, v214
    v_mad_u32_u16 v216, v216, 2, s85 op_sel:[1,0,0,0]
    v_mfma_f32_16x16x32_bf16 v[32:35], a[232:235], v[232:235], v[32:35]
    s_waitcnt lgkmcnt(8)
    ds_read_u16 v217, v217
    ds_read_u16_d16_hi v216, v216
    v_or_b32 v245, v208, v0
    v_mfma_f32_16x16x32_bf16 v[40:43], a[232:235], v[236:239], v[40:43]
    v_cvt_pkrtz_f16_f32 v218, v180, v181
    v_cvt_pkrtz_f16_f32 v220, v182, v183
    v_pk_lshrrev_b16 v218, 3, v218 op_sel_hi:[0,1]
    v_mfma_f32_16x16x32_bf16 v[80:83], a[232:235], v[240:243], v[80:83]
    s_waitcnt lgkmcnt(9)
    v_pk_lshrrev_b16 v220, 3, v220 op_sel_hi:[0,1]
    v_mad_u32_u16 v219, v218, 2, s85
    s_waitcnt lgkmcnt(8)
    v_or_b32 v246, v210, v209
    v_mad_u32_u16 v218, v218, 2, s85 op_sel:[1,0,0,0]
    v_mad_u32_u16 v221, v220, 2, s85
    v_mfma_f32_16x16x32_bf16 v[88:91], a[232:235], v[244:247], v[88:91]
    ds_read_u16 v219, v219
    ds_read_u16_d16_hi v218, v218
    v_mad_u32_u16 v220, v220, 2, s85 op_sel:[1,0,0,0]
    v_mfma_f32_16x16x32_bf16 v[36:39], a[236:239], v[232:235], v[36:39]
    ds_read_u16 v221, v221
    ds_read_u16_d16_hi v220, v220
    v_cvt_pkrtz_f16_f32 v222, v184, v185
    v_mfma_f32_16x16x32_bf16 v[44:47], a[236:239], v[236:239], v[44:47]
    ds_read_b128 a[232:235], v23 offset:32768
    v_cvt_pkrtz_f16_f32 v224, v186, v187
    v_pk_lshrrev_b16 v222, 3, v222 op_sel_hi:[0,1]
    v_mfma_f32_16x16x32_bf16 v[84:87], a[236:239], v[240:243], v[84:87]
    v_pk_lshrrev_b16 v224, 3, v224 op_sel_hi:[0,1]
    v_mad_u32_u16 v223, v222, 2, s85
    v_mad_u32_u16 v222, v222, 2, s85 op_sel:[1,0,0,0]
    v_mfma_f32_16x16x32_bf16 v[92:95], a[236:239], v[244:247], v[92:95]
    s_waitcnt lgkmcnt(12)
    ds_read_u16 v223, v223
    ds_read_u16_d16_hi v222, v222
    v_mad_u32_u16 v225, v224, 2, s85
    v_mfma_f32_16x16x32_bf16 v[48:51], a[240:243], v[232:235], v[48:51]
    s_waitcnt lgkmcnt(12)
    ds_read_u16 v225, v225
    ds_read_b128 a[236:239], v23 offset:33792
    v_mad_u32_u16 v224, v224, 2, s85 op_sel:[1,0,0,0]
    v_mfma_f32_16x16x32_bf16 v[56:59], a[240:243], v[236:239], v[56:59]
    s_waitcnt lgkmcnt(13)
    ds_read_u16_d16_hi v224, v224
    v_cvt_pkrtz_f16_f32 v226, v188, v189
    v_cvt_pkrtz_f16_f32 v230, v190, v191
    v_mfma_f32_16x16x32_bf16 v[96:99], a[240:243], v[240:243], v[96:99]
    v_pk_lshrrev_b16 v226, 3, v226 op_sel_hi:[0,1]
    v_mad_u32_u16 v227, v226, 2, s85
    v_mad_u32_u16 v226, v226, 2, s85 op_sel:[1,0,0,0]
    v_mfma_f32_16x16x32_bf16 v[104:107], a[240:243], v[244:247], v[104:107]
    s_waitcnt lgkmcnt(11)
    ds_read_u16 v227, v227
    ds_read_u16_d16_hi v226, v226
    v_pk_fma_f16 v228, v230, v230, s53
    v_mfma_f32_16x16x32_bf16 v[52:55], a[244:247], v[232:235], v[52:55]
    s_add_u32 m0, s56, 10432
    ds_read_b128 a[240:243], v23 offset:34816
    buffer_load_dwordx4 v5, s[20:23], 0 offen offset:64 lds
    v_mfma_f32_16x16x32_bf16 v[60:63], a[244:247], v[236:239], v[60:63]
    v_pk_mul_f16 v228, v228, v230 neg_lo:[1,0] neg_hi:[1,0]
    v_exp_f16 v229, v228
    v_mfma_f32_16x16x32_bf16 v[100:103], a[244:247], v[240:243], v[100:103]
    v_exp_f16_sdwa v229, v228 dst_sel:WORD_1 dst_unused:UNUSED_PRESERVE src0_sel:WORD_1
    v_cvt_pkrtz_f16_f32 v231, v192, v193
    v_mfma_f32_16x16x32_bf16 v[108:111], a[244:247], v[244:247], v[108:111]
    s_waitcnt lgkmcnt(13)
    ds_read_b128 a[244:247], v23 offset:35840
    v_pk_fma_f16 v229, v229, s86, s86
    v_rcp_f16 v228, v229
    v_mfma_f32_16x16x32_bf16 v[64:67], a[248:251], v[232:235], v[64:67]
    v_rcp_f16_sdwa v228, v229 dst_sel:WORD_1 dst_unused:UNUSED_PRESERVE src0_sel:WORD_1
    v_cvt_pkrtz_f16_f32 v249, v194, v195
    v_mfma_f32_16x16x32_bf16 v[72:75], a[248:251], v[236:239], v[72:75]
    v_fma_mix_f32 v229, v228, v230, 0 op_sel_hi:[1,1,0]
    v_fma_mix_f32 v228, v228, v230, 0 op_sel:[1,1,0] op_sel_hi:[1,1,0]
    v_pk_lshrrev_b16 v231, 3, v231 op_sel_hi:[0,1]
    v_mfma_f32_16x16x32_bf16 v[112:115], a[248:251], v[240:243], v[112:115]
    v_pk_lshrrev_b16 v249, 3, v249 op_sel_hi:[0,1]
    v_cvt_pkrtz_f16_f32 v251, v196, v197
    v_cvt_pkrtz_f16_f32 v253, v198, v199
    v_mfma_f32_16x16x32_bf16 v[120:123], a[248:251], v[244:247], v[120:123]
    s_waitcnt lgkmcnt(13)
    ds_read_b128 a[248:251], v23 offset:26624
    v_cvt_pkrtz_f16_f32 v208, v200, v201
    v_cvt_pkrtz_f16_f32 v210, v202, v203
    v_mfma_f32_16x16x32_bf16 v[68:71], a[252:255], v[232:235], v[68:71]
    s_waitcnt lgkmcnt(13)
    v_or_b32 v232, v215, v214
    v_or_b32 v233, v217, v216
    v_or_b32 v234, v219, v218
    v_mfma_f32_16x16x32_bf16 v[76:79], a[252:255], v[236:239], v[76:79]
    s_waitcnt lgkmcnt(8)
    v_or_b32 v235, v221, v220
    v_or_b32 v236, v223, v222
    v_cvt_pk_bf16_f32 v239, v229, v228
    v_mfma_f32_16x16x32_bf16 v[116:119], a[252:255], v[240:243], v[116:119]
    v_cvt_pkrtz_f16_f32 v212, v204, v205
    v_cvt_pkrtz_f16_f32 v216, v206, v207
    v_mad_u32_u16 v248, v231, 2, s85
    v_mfma_f32_16x16x32_bf16 v[124:127], a[252:255], v[244:247], v[124:127]
    ds_read_b128 a[252:255], v23 offset:27648
    ds_read_u16 v248, v248
    v_mad_u32_u16 v231, v231, 2, s85 op_sel:[1,0,0,0]
    v_mfma_f32_16x16x32_f16 v[176:179], a[216:219], v[128:131], 0
    s_waitcnt lgkmcnt(7)
    ds_read_u16_d16_hi v231, v231
    v_or_b32 v237, v225, v224
    v_mad_u32_u16 v250, v249, 2, s85
    v_mfma_f32_16x16x32_f16 v[184:187], a[216:219], v[132:135], 0
    ds_read_u16 v250, v250
    v_mad_u32_u16 v249, v249, 2, s85 op_sel:[1,0,0,0]
    v_pk_lshrrev_b16 v251, 3, v251 op_sel_hi:[0,1]
    v_mfma_f32_16x16x32_f16 v[192:195], a[216:219], v[152:155], 0
    ds_read_u16_d16_hi v249, v249
    v_pk_lshrrev_b16 v253, 3, v253 op_sel_hi:[0,1]
    v_mad_u32_u16 v252, v251, 2, s85
    v_mfma_f32_16x16x32_f16 v[200:203], a[216:219], v[156:159], 0
    s_waitcnt lgkmcnt(8)
    ds_read_u16 v252, v252
    v_or_b32 v238, v227, v226
    v_mad_u32_u16 v251, v251, 2, s85 op_sel:[1,0,0,0]
    v_mfma_f32_16x16x32_f16 v[180:183], a[220:223], v[128:131], 0
    ds_read_u16_d16_hi v251, v251
    v_mad_u32_u16 v0, v253, 2, s85
    v_mad_u32_u16 v253, v253, 2, s85 op_sel:[1,0,0,0]
    v_mfma_f32_16x16x32_f16 v[188:191], a[220:223], v[132:135], 0
    ds_read_u16 v0, v0
    ds_read_u16_d16_hi v253, v253
    v_pk_lshrrev_b16 v208, 3, v208 op_sel_hi:[0,1]
    v_mfma_f32_16x16x32_f16 v[196:199], a[220:223], v[152:155], 0
    v_pk_lshrrev_b16 v210, 3, v210 op_sel_hi:[0,1]
    v_mad_u32_u16 v209, v208, 2, s85
    v_mad_u32_u16 v208, v208, 2, s85 op_sel:[1,0,0,0]
    v_mfma_f32_16x16x32_f16 v[204:207], a[220:223], v[156:159], 0
    ds_read_u16 v209, v209
    ds_read_u16_d16_hi v208, v208
    v_mad_u32_u16 v211, v210, 2, s85
    v_mfma_f32_16x16x32_f16 v[176:179], a[232:235], v[136:139], v[176:179]
    s_waitcnt lgkmcnt(13)
    ds_read_u16 v211, v211
    v_mad_u32_u16 v210, v210, 2, s85 op_sel:[1,0,0,0]
    v_pk_lshrrev_b16 v212, 3, v212 op_sel_hi:[0,1]
    v_mfma_f32_16x16x32_f16 v[184:187], a[232:235], v[140:143], v[184:187]
    s_waitcnt lgkmcnt(13)
    ds_read_u16_d16_hi v210, v210
    v_mad_u32_u16 v213, v212, 2, s85
    v_mad_u32_u16 v212, v212, 2, s85 op_sel:[1,0,0,0]
    v_mfma_f32_16x16x32_f16 v[192:195], a[232:235], v[160:163], v[192:195]
    s_waitcnt lgkmcnt(12)
    ds_read_u16 v213, v213
    ds_read_u16_d16_hi v212, v212
    v_pk_fma_f16 v214, v216, v216, s53
    v_mfma_f32_16x16x32_f16 v[200:203], a[232:235], v[164:167], v[200:203]
    s_waitcnt lgkmcnt(12)
    ds_read_b128 a[232:235], v23 offset:28672
    v_pk_mul_f16 v214, v214, v216 neg_lo:[1,0] neg_hi:[1,0]
    v_exp_f16 v215, v214
    v_mfma_f32_16x16x32_f16 v[180:183], a[236:239], v[136:139], v[180:183]
    s_add_u32 m0, s56, 11456
    v_exp_f16_sdwa v215, v214 dst_sel:WORD_1 dst_unused:UNUSED_PRESERVE src0_sel:WORD_1
    v_or_b32 v240, v248, v231
    v_mfma_f32_16x16x32_f16 v[188:191], a[236:239], v[140:143], v[188:191]
    buffer_load_dwordx4 v6, s[20:23], 0 offen offset:64 lds
    v_pk_fma_f16 v215, v215, s86, s86
    v_mfma_f32_16x16x32_f16 v[196:199], a[236:239], v[160:163], v[196:199]
    s_waitcnt lgkmcnt(11)
    v_rcp_f16 v214, v215
    v_or_b32 v241, v250, v249
    v_mfma_f32_16x16x32_f16 v[204:207], a[236:239], v[164:167], v[204:207]
    ds_read_b128 a[236:239], v23 offset:29696
    v_rcp_f16_sdwa v214, v215 dst_sel:WORD_1 dst_unused:UNUSED_PRESERVE src0_sel:WORD_1
    v_mfma_f32_16x16x32_f16 v[176:179], a[240:243], v[144:147], v[176:179]
    s_waitcnt lgkmcnt(10)
    v_fma_mix_f32 v215, v214, v216, 0 op_sel_hi:[1,1,0]
    v_fma_mix_f32 v214, v214, v216, 0 op_sel:[1,1,0] op_sel_hi:[1,1,0]
    v_or_b32 v242, v252, v251
    v_mfma_f32_16x16x32_f16 v[184:187], a[240:243], v[148:151], v[184:187]
    v_cvt_pk_bf16_f32 v247, v215, v214
    v_mfma_f32_16x16x32_f16 v[192:195], a[240:243], v[168:171], v[192:195]
    s_waitcnt lgkmcnt(8)
    v_or_b32 v243, v0, v253
    v_mfma_f32_16x16x32_f16 v[200:203], a[240:243], v[172:175], v[200:203]
    ds_read_b128 a[240:243], v23 offset:20480
    v_cvt_pkrtz_f16_f32 v217, v176, v177
    v_cvt_pkrtz_f16_f32 v219, v178, v179
    v_mfma_f32_16x16x32_f16 v[180:183], a[244:247], v[144:147], v[180:183]
    v_pk_lshrrev_b16 v217, 3, v217 op_sel_hi:[0,1]
    v_pk_lshrrev_b16 v219, 3, v219 op_sel_hi:[0,1]
    v_mad_u32_u16 v218, v217, 2, s85
    v_mfma_f32_16x16x32_f16 v[188:191], a[244:247], v[148:151], v[188:191]
    s_waitcnt lgkmcnt(7)
    ds_read_u16 v218, v218
    v_or_b32 v244, v209, v208
    v_mad_u32_u16 v217, v217, 2, s85 op_sel:[1,0,0,0]
    v_mfma_f32_16x16x32_f16 v[196:199], a[244:247], v[168:171], v[196:199]
    ds_read_u16_d16_hi v217, v217
    v_mad_u32_u16 v220, v219, 2, s85
    v_mad_u32_u16 v219, v219, 2, s85 op_sel:[1,0,0,0]
    v_mfma_f32_16x16x32_f16 v[204:207], a[244:247], v[172:175], v[204:207]
    ds_read_b128 a[244:247], v23 offset:21504
    ds_read_u16 v220, v220
    v_cvt_pkrtz_f16_f32 v221, v180, v181
    v_mfma_f32_16x16x32_bf16 v[32:35], a[248:251], v[232:235], v[32:35]
    s_waitcnt lgkmcnt(9)
    ds_read_u16_d16_hi v219, v219
    v_or_b32 v245, v211, v210
    v_cvt_pkrtz_f16_f32 v223, v182, v183
    v_mfma_f32_16x16x32_bf16 v[40:43], a[248:251], v[236:239], v[40:43]
    v_pk_lshrrev_b16 v221, 3, v221 op_sel_hi:[0,1]
    v_pk_lshrrev_b16 v223, 3, v223 op_sel_hi:[0,1]
    v_mad_u32_u16 v222, v221, 2, s85
    v_mfma_f32_16x16x32_bf16 v[80:83], a[248:251], v[240:243], v[80:83]
    s_waitcnt lgkmcnt(9)
    ds_read_u16 v222, v222
    v_mad_u32_u16 v221, v221, 2, s85 op_sel:[1,0,0,0]
    v_mad_u32_u16 v224, v223, 2, s85
    s_waitcnt lgkmcnt(9)
    v_or_b32 v246, v213, v212
    v_mad_u32_u16 v223, v223, 2, s85 op_sel:[1,0,0,0]
    v_cvt_pkrtz_f16_f32 v225, v184, v185
    v_mfma_f32_16x16x32_bf16 v[88:91], a[248:251], v[244:247], v[88:91]
    ds_read_u16_d16_hi v221, v221
    ds_read_u16 v224, v224
    v_cvt_pkrtz_f16_f32 v227, v186, v187
    v_mfma_f32_16x16x32_bf16 v[36:39], a[252:255], v[232:235], v[36:39]
    ds_read_u16_d16_hi v223, v223
    ds_read_b128 a[248:251], v24 offset:0
    v_pk_lshrrev_b16 v225, 3, v225 op_sel_hi:[0,1]
    v_mfma_f32_16x16x32_bf16 v[44:47], a[252:255], v[236:239], v[44:47]
    v_pk_lshrrev_b16 v227, 3, v227 op_sel_hi:[0,1]
    v_mad_u32_u16 v226, v225, 2, s85
    v_mad_u32_u16 v225, v225, 2, s85 op_sel:[1,0,0,0]
    v_mfma_f32_16x16x32_bf16 v[84:87], a[252:255], v[240:243], v[84:87]
    s_waitcnt lgkmcnt(12)
    ds_read_u16 v226, v226
    ds_read_u16_d16_hi v225, v225
    v_mad_u32_u16 v228, v227, 2, s85
    v_mfma_f32_16x16x32_bf16 v[92:95], a[252:255], v[244:247], v[92:95]
    s_waitcnt lgkmcnt(12)
    ds_read_u16 v228, v228
    ds_read_b128 a[252:255], v24 offset:1024
    v_mad_u32_u16 v227, v227, 2, s85 op_sel:[1,0,0,0]
    v_mfma_f32_16x16x32_bf16 v[48:51], a[232:235], v[232:235], v[48:51]
    s_waitcnt lgkmcnt(13)
    ds_read_u16_d16_hi v227, v227
    v_cvt_pkrtz_f16_f32 v229, v188, v189
    v_cvt_pkrtz_f16_f32 v249, v190, v191
    v_mfma_f32_16x16x32_bf16 v[56:59], a[232:235], v[236:239], v[56:59]
    v_pk_lshrrev_b16 v229, 3, v229 op_sel_hi:[0,1]
    v_mad_u32_u16 v230, v229, 2, s85
    v_mad_u32_u16 v229, v229, 2, s85 op_sel:[1,0,0,0]
    v_mfma_f32_16x16x32_bf16 v[96:99], a[232:235], v[240:243], v[96:99]
    s_waitcnt lgkmcnt(12)
    ds_read_u16 v230, v230
    ds_read_u16_d16_hi v229, v229
    v_pk_fma_f16 v231, v249, v249, s53
    v_mfma_f32_16x16x32_bf16 v[104:107], a[232:235], v[244:247], v[104:107]
    s_waitcnt lgkmcnt(13)
    ds_read_b128 a[232:235], v24 offset:2048
    v_pk_mul_f16 v231, v231, v249 neg_lo:[1,0] neg_hi:[1,0]
    v_exp_f16 v248, v231
    v_mfma_f32_16x16x32_bf16 v[52:55], a[236:239], v[232:235], v[52:55]
    s_add_u32 m0, s56, 12480
    v_exp_f16_sdwa v248, v231 dst_sel:WORD_1 dst_unused:UNUSED_PRESERVE src0_sel:WORD_1
    v_cvt_pkrtz_f16_f32 v250, v192, v193
    v_mfma_f32_16x16x32_bf16 v[60:63], a[236:239], v[236:239], v[60:63]
    buffer_load_dword v7, s[20:23], 0 offen offset:64 lds
    v_pk_fma_f16 v248, v248, s86, s86
    v_mfma_f32_16x16x32_bf16 v[100:103], a[236:239], v[240:243], v[100:103]
    v_rcp_f16 v231, v248
    v_cvt_pkrtz_f16_f32 v252, v194, v195
    v_mfma_f32_16x16x32_bf16 v[108:111], a[236:239], v[244:247], v[108:111]
    s_waitcnt lgkmcnt(13)
    ds_read_b128 a[236:239], v24 offset:3072
    v_rcp_f16_sdwa v231, v248 dst_sel:WORD_1 dst_unused:UNUSED_PRESERVE src0_sel:WORD_1
    v_mfma_f32_16x16x32_bf16 v[64:67], a[240:243], v[232:235], v[64:67]
    v_fma_mix_f32 v248, v231, v249, 0 op_sel_hi:[1,1,0]
    v_fma_mix_f32 v231, v231, v249, 0 op_sel:[1,1,0] op_sel_hi:[1,1,0]
    v_pk_lshrrev_b16 v250, 3, v250 op_sel_hi:[0,1]
    v_mfma_f32_16x16x32_bf16 v[72:75], a[240:243], v[236:239], v[72:75]
    v_pk_lshrrev_b16 v252, 3, v252 op_sel_hi:[0,1]
    v_cvt_pkrtz_f16_f32 v0, v196, v197
    v_cvt_pkrtz_f16_f32 v209, v198, v199
    v_mfma_f32_16x16x32_bf16 v[112:115], a[240:243], v[240:243], v[112:115]
    v_cvt_pkrtz_f16_f32 v211, v200, v201
    v_cvt_pkrtz_f16_f32 v213, v202, v203
    v_cvt_pkrtz_f16_f32 v215, v204, v205
    v_mfma_f32_16x16x32_bf16 v[120:123], a[240:243], v[244:247], v[120:123]
    s_waitcnt lgkmcnt(13)
    ds_read_b128 a[240:243], v24 offset:4096
    v_mad_u32_u16 v251, v250, 2, s85
    v_mad_u32_u16 v250, v250, 2, s85 op_sel:[1,0,0,0]
    v_mfma_f32_16x16x32_bf16 v[68:71], a[244:247], v[232:235], v[68:71]
    s_waitcnt lgkmcnt(12)
    ds_read_u16 v251, v251
    ds_read_u16_d16_hi v250, v250
    v_or_b32 v232, v218, v217
    v_mfma_f32_16x16x32_bf16 v[76:79], a[244:247], v[236:239], v[76:79]
    s_waitcnt lgkmcnt(13)
    v_or_b32 v233, v220, v219
    v_or_b32 v234, v222, v221
    v_or_b32 v235, v224, v223
    v_mfma_f32_16x16x32_bf16 v[116:119], a[244:247], v[240:243], v[116:119]
    s_waitcnt lgkmcnt(10)
    v_or_b32 v236, v226, v225
    v_cvt_pk_bf16_f32 v239, v248, v231
    v_cvt_pkrtz_f16_f32 v219, v206, v207
    v_mfma_f32_16x16x32_bf16 v[124:127], a[244:247], v[244:247], v[124:127]
    ds_read_b128 a[244:247], v24 offset:5120
    v_mad_u32_u16 v253, v252, 2, s85
    v_mad_u32_u16 v252, v252, 2, s85 op_sel:[1,0,0,0]
    v_mfma_f32_16x16x32_f16 v[176:179], a[248:251], v[128:131], 0
    s_waitcnt lgkmcnt(8)
    ds_read_u16 v253, v253
    ds_read_u16_d16_hi v252, v252
    v_or_b32 v237, v228, v227
    v_mfma_f32_16x16x32_f16 v[184:187], a[248:251], v[132:135], 0
    v_pk_lshrrev_b16 v0, 3, v0 op_sel_hi:[0,1]
    v_pk_lshrrev_b16 v209, 3, v209 op_sel_hi:[0,1]
    v_mad_u32_u16 v208, v0, 2, s85
    v_mfma_f32_16x16x32_f16 v[192:195], a[248:251], v[152:155], 0
    ds_read_u16 v208, v208
    v_mad_u32_u16 v0, v0, 2, s85 op_sel:[1,0,0,0]
    v_mad_u32_u16 v210, v209, 2, s85
    v_mfma_f32_16x16x32_f16 v[200:203], a[248:251], v[156:159], 0
    s_waitcnt lgkmcnt(9)
    ds_read_u16_d16_hi v0, v0
    ds_read_u16 v210, v210
    v_or_b32 v238, v230, v229
    v_mfma_f32_16x16x32_f16 v[180:183], a[252:255], v[128:131], 0
    ds_read_b128 a[248:251], v23 offset:36864
    v_mad_u32_u16 v209, v209, 2, s85 op_sel:[1,0,0,0]
    v_pk_lshrrev_b16 v211, 3, v211 op_sel_hi:[0,1]
    v_mfma_f32_16x16x32_f16 v[188:191], a[252:255], v[132:135], 0
    ds_read_u16_d16_hi v209, v209
    v_pk_lshrrev_b16 v213, 3, v213 op_sel_hi:[0,1]
    v_mad_u32_u16 v212, v211, 2, s85
    v_mfma_f32_16x16x32_f16 v[196:199], a[252:255], v[152:155], 0
    ds_read_u16 v212, v212
    v_mad_u32_u16 v211, v211, 2, s85 op_sel:[1,0,0,0]
    v_mad_u32_u16 v214, v213, 2, s85
    v_mfma_f32_16x16x32_f16 v[204:207], a[252:255], v[156:159], 0
    s_waitcnt lgkmcnt(12)
    ds_read_u16_d16_hi v211, v211
    ds_read_u16 v214, v214
    v_mad_u32_u16 v213, v213, 2, s85 op_sel:[1,0,0,0]
    v_mfma_f32_16x16x32_f16 v[176:179], a[232:235], v[136:139], v[176:179]
    s_waitcnt lgkmcnt(12)
    ds_read_u16_d16_hi v213, v213
    ds_read_b128 a[252:255], v23 offset:37888
    v_pk_lshrrev_b16 v215, 3, v215 op_sel_hi:[0,1]
    v_mfma_f32_16x16x32_f16 v[184:187], a[232:235], v[140:143], v[184:187]
    v_mad_u32_u16 v216, v215, 2, s85
    v_mad_u32_u16 v215, v215, 2, s85 op_sel:[1,0,0,0]
    v_pk_fma_f16 v217, v219, v219, s53
    v_mfma_f32_16x16x32_f16 v[192:195], a[232:235], v[160:163], v[192:195]
    s_waitcnt lgkmcnt(12)
    ds_read_u16 v216, v216
    ds_read_u16_d16_hi v215, v215
    v_pk_mul_f16 v217, v217, v219 neg_lo:[1,0] neg_hi:[1,0]
    v_mfma_f32_16x16x32_f16 v[200:203], a[232:235], v[164:167], v[200:203]
    s_waitcnt lgkmcnt(13)
    ds_read_b128 a[232:235], v23 offset:38912
    v_exp_f16 v218, v217
    v_mfma_f32_16x16x32_f16 v[180:183], a[236:239], v[136:139], v[180:183]
    s_add_u32 m0, s56, 0
    v_exp_f16_sdwa v218, v217 dst_sel:WORD_1 dst_unused:UNUSED_PRESERVE src0_sel:WORD_1
    v_or_b32 v240, v251, v250
    v_mfma_f32_16x16x32_f16 v[188:191], a[236:239], v[140:143], v[188:191]
    buffer_load_dwordx4 v1, s[20:23], 0 offen offset:0 lds
    v_pk_fma_f16 v218, v218, s86, s86
    v_mfma_f32_16x16x32_f16 v[196:199], a[236:239], v[160:163], v[196:199]
    s_waitcnt lgkmcnt(13)
    v_rcp_f16 v217, v218
    v_or_b32 v241, v253, v252
    v_mfma_f32_16x16x32_f16 v[204:207], a[236:239], v[164:167], v[204:207]
    ds_read_b128 a[236:239], v23 offset:39936
    v_rcp_f16_sdwa v217, v218 dst_sel:WORD_1 dst_unused:UNUSED_PRESERVE src0_sel:WORD_1
    v_mfma_f32_16x16x32_f16 v[176:179], a[240:243], v[144:147], v[176:179]
    s_waitcnt lgkmcnt(12)
    v_fma_mix_f32 v218, v217, v219, 0 op_sel_hi:[1,1,0]
    v_fma_mix_f32 v217, v217, v219, 0 op_sel:[1,1,0] op_sel_hi:[1,1,0]
    v_or_b32 v242, v208, v0
    v_mfma_f32_16x16x32_f16 v[184:187], a[240:243], v[148:151], v[184:187]
    v_cvt_pk_bf16_f32 v247, v218, v217
    v_mfma_f32_16x16x32_f16 v[192:195], a[240:243], v[168:171], v[192:195]
    s_nop 0
    v_cvt_pkrtz_f16_f32 v220, v176, v177
    v_cvt_pkrtz_f16_f32 v222, v178, v179
    v_mfma_f32_16x16x32_f16 v[200:203], a[240:243], v[172:175], v[200:203]
    s_waitcnt lgkmcnt(9)
    ds_read_b128 a[240:243], v23 offset:30720
    v_or_b32 v243, v210, v209
    v_pk_lshrrev_b16 v220, 3, v220 op_sel_hi:[0,1]
    v_mfma_f32_16x16x32_f16 v[180:183], a[244:247], v[144:147], v[180:183]
    v_pk_lshrrev_b16 v222, 3, v222 op_sel_hi:[0,1]
    v_mad_u32_u16 v221, v220, 2, s85
    v_mad_u32_u16 v220, v220, 2, s85 op_sel:[1,0,0,0]
    v_mfma_f32_16x16x32_f16 v[188:191], a[244:247], v[148:151], v[188:191]
    ds_read_u16 v221, v221
    ds_read_u16_d16_hi v220, v220
    v_mad_u32_u16 v223, v222, 2, s85
    v_mfma_f32_16x16x32_f16 v[196:199], a[244:247], v[168:171], v[196:199]
    s_waitcnt lgkmcnt(10)
    ds_read_u16 v223, v223
    v_or_b32 v244, v212, v211
    v_mad_u32_u16 v222, v222, 2, s85 op_sel:[1,0,0,0]
    v_mfma_f32_16x16x32_f16 v[204:207], a[244:247], v[172:175], v[204:207]
    ds_read_b128 a[244:247], v23 offset:31744
    ds_read_u16_d16_hi v222, v222
    v_cvt_pkrtz_f16_f32 v224, v180, v181
    v_mfma_f32_16x16x32_bf16 v[32:35], a[248:251], v[232:235], v[32:35]
    v_cvt_pkrtz_f16_f32 v226, v182, v183
    v_pk_lshrrev_b16 v224, 3, v224 op_sel_hi:[0,1]
    v_pk_lshrrev_b16 v226, 3, v226 op_sel_hi:[0,1]
    v_mfma_f32_16x16x32_bf16 v[40:43], a[248:251], v[236:239], v[40:43]
    s_waitcnt lgkmcnt(11)
    v_or_b32 v245, v214, v213
    v_mad_u32_u16 v225, v224, 2, s85
    v_mad_u32_u16 v224, v224, 2, s85 op_sel:[1,0,0,0]
    v_mfma_f32_16x16x32_bf16 v[80:83], a[248:251], v[240:243], v[80:83]
    ds_read_u16 v225, v225
    ds_read_u16_d16_hi v224, v224
    v_mad_u32_u16 v227, v226, 2, s85
    v_mad_u32_u16 v226, v226, 2, s85 op_sel:[1,0,0,0]
    v_cvt_pkrtz_f16_f32 v228, v184, v185
    v_cvt_pkrtz_f16_f32 v230, v186, v187
    v_pk_lshrrev_b16 v228, 3, v228 op_sel_hi:[0,1]
    v_pk_lshrrev_b16 v230, 3, v230 op_sel_hi:[0,1]
    v_mad_u32_u16 v229, v228, 2, s85
    v_mad_u32_u16 v228, v228, 2, s85 op_sel:[1,0,0,0]
    v_mad_u32_u16 v231, v230, 2, s85
    s_waitcnt lgkmcnt(10)
    v_or_b32 v246, v216, v215
    v_mad_u32_u16 v230, v230, 2, s85 op_sel:[1,0,0,0]
    v_cvt_pkrtz_f16_f32 v248, v188, v189
    v_mfma_f32_16x16x32_bf16 v[88:91], a[248:251], v[244:247], v[88:91]
    ds_read_u16 v227, v227
    ds_read_u16_d16_hi v226, v226
    v_cvt_pkrtz_f16_f32 v252, v190, v191
    v_mfma_f32_16x16x32_bf16 v[36:39], a[252:255], v[232:235], v[36:39]
    ds_read_u16 v229, v229
    ds_read_u16_d16_hi v228, v228
    v_pk_lshrrev_b16 v248, 3, v248 op_sel_hi:[0,1]
    v_mfma_f32_16x16x32_bf16 v[44:47], a[252:255], v[236:239], v[44:47]
    s_waitcnt lgkmcnt(12)
    ds_read_u16 v231, v231
    ds_read_u16_d16_hi v230, v230
    v_mad_u32_u16 v249, v248, 2, s85
    v_mfma_f32_16x16x32_bf16 v[84:87], a[252:255], v[240:243], v[84:87]
    s_waitcnt lgkmcnt(12)
    ds_read_u16 v249, v249
    ds_read_b128 a[248:251], v24 offset:12288
    v_mad_u32_u16 v248, v248, 2, s85 op_sel:[1,0,0,0]
    v_mfma_f32_16x16x32_bf16 v[92:95], a[252:255], v[244:247], v[92:95]
    s_waitcnt lgkmcnt(12)
    ds_read_u16_d16_hi v248, v248
    ds_read_b128 a[252:255], v24 offset:13312
    v_pk_fma_f16 v250, v252, v252, s53
    v_mfma_f32_16x16x32_bf16 v[48:51], a[232:235], v[232:235], v[48:51]
    v_pk_mul_f16 v250, v250, v252 neg_lo:[1,0] neg_hi:[1,0]
    v_exp_f16 v251, v250
    v_mfma_f32_16x16x32_bf16 v[56:59], a[232:235], v[236:239], v[56:59]
    v_exp_f16_sdwa v251, v250 dst_sel:WORD_1 dst_unused:UNUSED_PRESERVE src0_sel:WORD_1
    v_cvt_pkrtz_f16_f32 v253, v192, v193
    v_mfma_f32_16x16x32_bf16 v[96:99], a[232:235], v[240:243], v[96:99]
    v_pk_fma_f16 v251, v251, s86, s86
    v_rcp_f16 v250, v251
    v_mfma_f32_16x16x32_bf16 v[104:107], a[232:235], v[244:247], v[104:107]
    s_waitcnt lgkmcnt(13)
    ds_read_b128 a[232:235], v24 offset:14336
    v_rcp_f16_sdwa v250, v251 dst_sel:WORD_1 dst_unused:UNUSED_PRESERVE src0_sel:WORD_1
    v_mfma_f32_16x16x32_bf16 v[52:55], a[236:239], v[232:235], v[52:55]
    s_add_u32 m0, s56, 1024
    v_fma_mix_f32 v251, v250, v252, 0 op_sel_hi:[1,1,0]
    v_fma_mix_f32 v250, v250, v252, 0 op_sel:[1,1,0] op_sel_hi:[1,1,0]
    v_cvt_pkrtz_f16_f32 v208, v194, v195
    v_mfma_f32_16x16x32_bf16 v[60:63], a[236:239], v[236:239], v[60:63]
    buffer_load_dwordx4 v2, s[20:23], 0 offen offset:0 lds
    v_pk_lshrrev_b16 v253, 3, v253 op_sel_hi:[0,1]
    v_mfma_f32_16x16x32_bf16 v[100:103], a[236:239], v[240:243], v[100:103]
    v_pk_lshrrev_b16 v208, 3, v208 op_sel_hi:[0,1]
    v_cvt_pkrtz_f16_f32 v210, v196, v197
    v_cvt_pkrtz_f16_f32 v212, v198, v199
    v_mfma_f32_16x16x32_bf16 v[108:111], a[236:239], v[244:247], v[108:111]
    s_waitcnt lgkmcnt(13)
    ds_read_b128 a[236:239], v24 offset:15360
    v_cvt_pkrtz_f16_f32 v214, v200, v201
    v_cvt_pkrtz_f16_f32 v216, v202, v203
    v_mfma_f32_16x16x32_bf16 v[64:67], a[240:243], v[232:235], v[64:67]
    v_cvt_pkrtz_f16_f32 v218, v204, v205
    v_mad_u32_u16 v0, v253, 2, s85
    v_mad_u32_u16 v253, v253, 2, s85 op_sel:[1,0,0,0]
    v_mfma_f32_16x16x32_bf16 v[72:75], a[240:243], v[236:239], v[72:75]
    s_waitcnt lgkmcnt(12)
    ds_read_u16 v0, v0
    ds_read_u16_d16_hi v253, v253
    v_mad_u32_u16 v209, v208, 2, s85
    v_mfma_f32_16x16x32_bf16 v[112:115], a[240:243], v[240:243], v[112:115]
    s_waitcnt lgkmcnt(13)
    ds_read_u16 v209, v209
    v_mad_u32_u16 v208, v208, 2, s85 op_sel:[1,0,0,0]
    v_pk_lshrrev_b16 v210, 3, v210 op_sel_hi:[0,1]
    v_mfma_f32_16x16x32_bf16 v[120:123], a[240:243], v[244:247], v[120:123]
    s_waitcnt lgkmcnt(12)
    ds_read_b128 a[240:243], v24 offset:16384
    ds_read_u16_d16_hi v208, v208
    v_pk_lshrrev_b16 v212, 3, v212 op_sel_hi:[0,1]
    v_mfma_f32_16x16x32_bf16 v[68:71], a[244:247], v[232:235], v[68:71]
    v_or_b32 v232, v221, v220
    v_or_b32 v233, v223, v222
    v_or_b32 v234, v225, v224
    v_mfma_f32_16x16x32_bf16 v[76:79], a[244:247], v[236:239], v[76:79]
    s_waitcnt lgkmcnt(13)
    v_or_b32 v235, v227, v226
    v_or_b32 v236, v229, v228
    v_cvt_pk_bf16_f32 v239, v251, v250
    v_mfma_f32_16x16x32_bf16 v[116:119], a[244:247], v[240:243], v[116:119]
    v_cvt_pkrtz_f16_f32 v222, v206, v207
    v_mad_u32_u16 v211, v210, 2, s85
    v_mad_u32_u16 v210, v210, 2, s85 op_sel:[1,0,0,0]
    v_mfma_f32_16x16x32_bf16 v[124:127], a[244:247], v[244:247], v[124:127]
    s_waitcnt lgkmcnt(11)
    ds_read_b128 a[244:247], v24 offset:17408
    ds_read_u16 v211, v211
    v_or_b32 v237, v231, v230
    v_mad_u32_u16 v213, v212, 2, s85
    v_mad_u32_u16 v212, v212, 2, s85 op_sel:[1,0,0,0]
    v_pk_lshrrev_b16 v214, 3, v214 op_sel_hi:[0,1]
    v_pk_lshrrev_b16 v216, 3, v216 op_sel_hi:[0,1]
    v_mad_u32_u16 v215, v214, 2, s85
    v_mad_u32_u16 v214, v214, 2, s85 op_sel:[1,0,0,0]
    v_mad_u32_u16 v217, v216, 2, s85
    s_waitcnt lgkmcnt(11)
    v_mfma_f32_16x16x32_f16 v[176:179], a[248:251], v[128:131], 0
    ds_read_u16_d16_hi v210, v210
    ds_read_u16 v213, v213
    v_mad_u32_u16 v216, v216, 2, s85 op_sel:[1,0,0,0]
    v_mfma_f32_16x16x32_f16 v[184:187], a[248:251], v[132:135], 0
    s_waitcnt lgkmcnt(12)
    ds_read_u16_d16_hi v212, v212
    ds_read_u16 v215, v215
    v_or_b32 v238, v249, v248
    v_mfma_f32_16x16x32_f16 v[192:195], a[248:251], v[152:155], 0
    s_waitcnt lgkmcnt(12)
    ds_read_u16_d16_hi v214, v214
    ds_read_u16 v217, v217
    v_pk_lshrrev_b16 v218, 3, v218 op_sel_hi:[0,1]
    v_mfma_f32_16x16x32_f16 v[200:203], a[248:251], v[156:159], 0
    s_waitcnt lgkmcnt(12)
    ds_read_u16_d16_hi v216, v216
    ds_read_b128 a[248:251], v24 offset:6144
    v_mad_u32_u16 v219, v218, 2, s85
    v_mfma_f32_16x16x32_f16 v[180:183], a[252:255], v[128:131], 0
    s_waitcnt lgkmcnt(13)
    ds_read_u16 v219, v219
    v_mad_u32_u16 v218, v218, 2, s85 op_sel:[1,0,0,0]
    v_pk_fma_f16 v220, v222, v222, s53
    v_mfma_f32_16x16x32_f16 v[188:191], a[252:255], v[132:135], 0
    s_waitcnt lgkmcnt(13)
    ds_read_u16_d16_hi v218, v218
    v_pk_mul_f16 v220, v220, v222 neg_lo:[1,0] neg_hi:[1,0]
    v_exp_f16 v221, v220
    v_mfma_f32_16x16x32_f16 v[196:199], a[252:255], v[152:155], 0
    v_exp_f16_sdwa v221, v220 dst_sel:WORD_1 dst_unused:UNUSED_PRESERVE src0_sel:WORD_1
    v_or_b32 v240, v0, v253
    v_mfma_f32_16x16x32_f16 v[204:207], a[252:255], v[156:159], 0
    s_waitcnt lgkmcnt(13)
    ds_read_b128 a[252:255], v24 offset:7168
    v_pk_fma_f16 v221, v221, s86, s86
    v_rcp_f16 v220, v221
    v_mfma_f32_16x16x32_f16 v[176:179], a[232:235], v[136:139], v[176:179]
    v_rcp_f16_sdwa v220, v221 dst_sel:WORD_1 dst_unused:UNUSED_PRESERVE src0_sel:WORD_1
    v_mfma_f32_16x16x32_f16 v[184:187], a[232:235], v[140:143], v[184:187]
    v_fma_mix_f32 v221, v220, v222, 0 op_sel_hi:[1,1,0]
    v_fma_mix_f32 v220, v220, v222, 0 op_sel:[1,1,0] op_sel_hi:[1,1,0]
    v_cvt_pk_bf16_f32 v247, v221, v220
    v_mfma_f32_16x16x32_f16 v[192:195], a[232:235], v[160:163], v[192:195]
    s_waitcnt lgkmcnt(13)
    v_or_b32 v241, v209, v208
    v_mfma_f32_16x16x32_f16 v[200:203], a[232:235], v[164:167], v[200:203]
    ds_read_b128 a[232:235], v24 offset:8192
    v_mfma_f32_16x16x32_f16 v[180:183], a[236:239], v[136:139], v[180:183]
    s_add_u32 m0, s56, 2048
    v_mfma_f32_16x16x32_f16 v[188:191], a[236:239], v[140:143], v[188:191]
    buffer_load_dwordx4 v3, s[20:23], 0 offen offset:0 lds
    v_mfma_f32_16x16x32_f16 v[196:199], a[236:239], v[160:163], v[196:199]
    s_waitcnt lgkmcnt(11)
    v_or_b32 v242, v211, v210
    v_mfma_f32_16x16x32_f16 v[204:207], a[236:239], v[164:167], v[204:207]
    ds_read_b128 a[236:239], v24 offset:9216
    v_mfma_f32_16x16x32_f16 v[176:179], a[240:243], v[144:147], v[176:179]
    v_mfma_f32_16x16x32_f16 v[184:187], a[240:243], v[148:151], v[184:187]
    v_mfma_f32_16x16x32_f16 v[192:195], a[240:243], v[168:171], v[192:195]
    s_waitcnt lgkmcnt(10)
    v_or_b32 v243, v213, v212
    v_mfma_f32_16x16x32_f16 v[200:203], a[240:243], v[172:175], v[200:203]
    ds_read_b128 a[240:243], v24 offset:10240
    v_mfma_f32_16x16x32_f16 v[180:183], a[244:247], v[144:147], v[180:183]
    s_nop 0
    v_cvt_pkrtz_f16_f32 v223, v176, v177
    v_cvt_pkrtz_f16_f32 v225, v178, v179
    v_mfma_f32_16x16x32_f16 v[188:191], a[244:247], v[148:151], v[188:191]
    s_waitcnt lgkmcnt(9)
    v_pk_lshrrev_b16 v223, 3, v223 op_sel_hi:[0,1]
    v_or_b32 v244, v215, v214
    v_pk_lshrrev_b16 v225, 3, v225 op_sel_hi:[0,1]
    v_mfma_f32_16x16x32_f16 v[196:199], a[244:247], v[168:171], v[196:199]
    v_mad_u32_u16 v224, v223, 2, s85
    v_mad_u32_u16 v223, v223, 2, s85 op_sel:[1,0,0,0]
    v_mad_u32_u16 v226, v225, 2, s85
    v_mfma_f32_16x16x32_f16 v[204:207], a[244:247], v[172:175], v[204:207]
    s_waitcnt lgkmcnt(8)
    ds_read_b128 a[244:247], v24 offset:11264
    ds_read_u16 v224, v224
    v_mad_u32_u16 v225, v225, 2, s85 op_sel:[1,0,0,0]
    v_cvt_pkrtz_f16_f32 v227, v180, v181
    v_cvt_pkrtz_f16_f32 v229, v182, v183
    v_pk_lshrrev_b16 v227, 3, v227 op_sel_hi:[0,1]
    s_waitcnt lgkmcnt(9)
    v_or_b32 v245, v217, v216
    v_pk_lshrrev_b16 v229, 3, v229 op_sel_hi:[0,1]
    v_mad_u32_u16 v228, v227, 2, s85
    v_mad_u32_u16 v227, v227, 2, s85 op_sel:[1,0,0,0]
    s_waitcnt lgkmcnt(8)
    v_mfma_f32_16x16x32_bf16 v[32:35], a[248:251], v[232:235], v[32:35]
    ds_read_u16_d16_hi v223, v223
    ds_read_u16 v226, v226
    v_mad_u32_u16 v230, v229, 2, s85
    v_mfma_f32_16x16x32_bf16 v[40:43], a[248:251], v[236:239], v[40:43]
    ds_read_u16_d16_hi v225, v225
    ds_read_u16 v228, v228
    v_mad_u32_u16 v229, v229, 2, s85 op_sel:[1,0,0,0]
    v_mfma_f32_16x16x32_bf16 v[80:83], a[248:251], v[240:243], v[80:83]
    s_waitcnt lgkmcnt(11)
    ds_read_u16_d16_hi v227, v227
    ds_read_u16 v230, v230
    s_waitcnt lgkmcnt(12)
    v_or_b32 v246, v219, v218
    v_cvt_pkrtz_f16_f32 v231, v184, v185
    v_cvt_pkrtz_f16_f32 v249, v186, v187
    v_mfma_f32_16x16x32_bf16 v[88:91], a[248:251], v[244:247], v[88:91]
    s_waitcnt lgkmcnt(11)
    ds_read_u16_d16_hi v229, v229
    ds_read_b128 a[248:251], v24 offset:24576
    v_pk_lshrrev_b16 v231, 3, v231 op_sel_hi:[0,1]
    v_mfma_f32_16x16x32_bf16 v[36:39], a[252:255], v[232:235], v[36:39]
    v_pk_lshrrev_b16 v249, 3, v249 op_sel_hi:[0,1]
    v_mad_u32_u16 v248, v231, 2, s85
    v_mad_u32_u16 v231, v231, 2, s85 op_sel:[1,0,0,0]
    v_mfma_f32_16x16x32_bf16 v[44:47], a[252:255], v[236:239], v[44:47]
    s_waitcnt lgkmcnt(12)
    ds_read_u16 v248, v248
    ds_read_u16_d16_hi v231, v231
    v_mad_u32_u16 v250, v249, 2, s85
    v_mfma_f32_16x16x32_bf16 v[84:87], a[252:255], v[240:243], v[84:87]
    s_waitcnt lgkmcnt(13)
    ds_read_u16 v250, v250
    v_mad_u32_u16 v249, v249, 2, s85 op_sel:[1,0,0,0]
    v_cvt_pkrtz_f16_f32 v251, v188, v189
    v_mfma_f32_16x16x32_bf16 v[92:95], a[252:255], v[244:247], v[92:95]
    s_waitcnt lgkmcnt(12)
    ds_read_u16_d16_hi v249, v249
    ds_read_b128 a[252:255], v24 offset:25600
    v_cvt_pkrtz_f16_f32 v208, v190, v191
    v_mfma_f32_16x16x32_bf16 v[48:51], a[232:235], v[232:235], v[48:51]
    v_pk_lshrrev_b16 v251, 3, v251 op_sel_hi:[0,1]
    v_mad_u32_u16 v252, v251, 2, s85
    v_mad_u32_u16 v251, v251, 2, s85 op_sel:[1,0,0,0]
    v_mfma_f32_16x16x32_bf16 v[56:59], a[232:235], v[236:239], v[56:59]
    s_waitcnt lgkmcnt(12)
    ds_read_u16 v252, v252
    ds_read_u16_d16_hi v251, v251
    v_pk_fma_f16 v253, v208, v208, s53
    v_mfma_f32_16x16x32_bf16 v[96:99], a[232:235], v[240:243], v[96:99]
    v_pk_mul_f16 v253, v253, v208 neg_lo:[1,0] neg_hi:[1,0]
    v_exp_f16 v0, v253
    v_mfma_f32_16x16x32_bf16 v[104:107], a[232:235], v[244:247], v[104:107]
    s_waitcnt lgkmcnt(13)
    ds_read_b128 a[232:235], v24 offset:26624
    v_exp_f16_sdwa v0, v253 dst_sel:WORD_1 dst_unused:UNUSED_PRESERVE src0_sel:WORD_1
    v_mfma_f32_16x16x32_bf16 v[52:55], a[236:239], v[232:235], v[52:55]
    s_add_u32 m0, s56, 3072
    v_pk_fma_f16 v0, v0, s86, s86
    v_rcp_f16 v253, v0
    v_mfma_f32_16x16x32_bf16 v[60:63], a[236:239], v[236:239], v[60:63]
    buffer_load_dwordx4 v4, s[20:23], 0 offen offset:0 lds
    v_rcp_f16_sdwa v253, v0 dst_sel:WORD_1 dst_unused:UNUSED_PRESERVE src0_sel:WORD_1
    v_mfma_f32_16x16x32_bf16 v[100:103], a[236:239], v[240:243], v[100:103]
    v_fma_mix_f32 v0, v253, v208, 0 op_sel_hi:[1,1,0]
    v_fma_mix_f32 v253, v253, v208, 0 op_sel:[1,1,0] op_sel_hi:[1,1,0]
    v_cvt_pkrtz_f16_f32 v209, v192, v193
    v_mfma_f32_16x16x32_bf16 v[108:111], a[236:239], v[244:247], v[108:111]
    s_waitcnt lgkmcnt(13)
    ds_read_b128 a[236:239], v24 offset:27648
    v_cvt_pkrtz_f16_f32 v211, v194, v195
    v_pk_lshrrev_b16 v209, 3, v209 op_sel_hi:[0,1]
    v_mfma_f32_16x16x32_bf16 v[64:67], a[240:243], v[232:235], v[64:67]
    v_pk_lshrrev_b16 v211, 3, v211 op_sel_hi:[0,1]
    v_cvt_pkrtz_f16_f32 v213, v196, v197
    v_cvt_pkrtz_f16_f32 v215, v198, v199
    v_mfma_f32_16x16x32_bf16 v[72:75], a[240:243], v[236:239], v[72:75]
    v_cvt_pkrtz_f16_f32 v217, v200, v201
    v_cvt_pkrtz_f16_f32 v219, v202, v203
    v_cvt_pkrtz_f16_f32 v221, v204, v205
    v_mfma_f32_16x16x32_bf16 v[112:115], a[240:243], v[240:243], v[112:115]
    v_mad_u32_u16 v210, v209, 2, s85
    v_mad_u32_u16 v209, v209, 2, s85 op_sel:[1,0,0,0]
    v_mad_u32_u16 v212, v211, 2, s85
    v_mfma_f32_16x16x32_bf16 v[120:123], a[240:243], v[244:247], v[120:123]
    s_waitcnt lgkmcnt(12)
    ds_read_b128 a[240:243], v24 offset:28672
    ds_read_u16 v210, v210
    v_mad_u32_u16 v211, v211, 2, s85 op_sel:[1,0,0,0]
    v_mfma_f32_16x16x32_bf16 v[68:71], a[244:247], v[232:235], v[68:71]
    s_waitcnt lgkmcnt(12)
    ds_read_u16_d16_hi v209, v209
    ds_read_u16 v212, v212
    v_or_b32 v232, v224, v223
    v_mfma_f32_16x16x32_bf16 v[76:79], a[244:247], v[236:239], v[76:79]
    s_waitcnt lgkmcnt(13)
    ds_read_u16_d16_hi v211, v211
    v_or_b32 v233, v226, v225
    v_or_b32 v234, v228, v227
    v_mfma_f32_16x16x32_bf16 v[116:119], a[244:247], v[240:243], v[116:119]
    s_waitcnt lgkmcnt(12)
    v_or_b32 v235, v230, v229
    v_or_b32 v236, v248, v231
    v_cvt_pk_bf16_f32 v239, v0, v253
    v_mfma_f32_16x16x32_bf16 v[124:127], a[244:247], v[244:247], v[124:127]
    ds_read_b128 a[244:247], v24 offset:29696
    v_cvt_pkrtz_f16_f32 v225, v206, v207
    v_pk_lshrrev_b16 v213, 3, v213 op_sel_hi:[0,1]
    v_mfma_f32_16x16x32_f16 v[176:179], a[248:251], v[128:131], 0
    s_waitcnt lgkmcnt(11)
    v_or_b32 v237, v250, v249
    v_pk_lshrrev_b16 v215, 3, v215 op_sel_hi:[0,1]
    v_mad_u32_u16 v214, v213, 2, s85
    v_mfma_f32_16x16x32_f16 v[184:187], a[248:251], v[132:135], 0
    ds_read_u16 v214, v214
    v_mad_u32_u16 v213, v213, 2, s85 op_sel:[1,0,0,0]
    v_mad_u32_u16 v216, v215, 2, s85
    v_mfma_f32_16x16x32_f16 v[192:195], a[248:251], v[152:155], 0
    ds_read_u16_d16_hi v213, v213
    ds_read_u16 v216, v216
    v_mad_u32_u16 v215, v215, 2, s85 op_sel:[1,0,0,0]
    v_mfma_f32_16x16x32_f16 v[200:203], a[248:251], v[156:159], 0
    s_waitcnt lgkmcnt(12)
    ds_read_u16_d16_hi v215, v215
    ds_read_b128 a[248:251], v24 offset:18432
    v_pk_lshrrev_b16 v217, 3, v217 op_sel_hi:[0,1]
    v_mfma_f32_16x16x32_f16 v[180:183], a[252:255], v[128:131], 0
    s_waitcnt lgkmcnt(13)
    v_or_b32 v238, v252, v251
    v_pk_lshrrev_b16 v219, 3, v219 op_sel_hi:[0,1]
    v_mad_u32_u16 v218, v217, 2, s85
    v_mfma_f32_16x16x32_f16 v[188:191], a[252:255], v[132:135], 0
    ds_read_u16 v218, v218
    v_mad_u32_u16 v217, v217, 2, s85 op_sel:[1,0,0,0]
    v_mad_u32_u16 v220, v219, 2, s85
    v_mfma_f32_16x16x32_f16 v[196:199], a[252:255], v[152:155], 0
    s_waitcnt lgkmcnt(12)
    ds_read_u16_d16_hi v217, v217
    ds_read_u16 v220, v220
    v_mad_u32_u16 v219, v219, 2, s85 op_sel:[1,0,0,0]
    v_mfma_f32_16x16x32_f16 v[204:207], a[252:255], v[156:159], 0
    s_waitcnt lgkmcnt(12)
    ds_read_u16_d16_hi v219, v219
    ds_read_b128 a[252:255], v24 offset:19456
    v_pk_lshrrev_b16 v221, 3, v221 op_sel_hi:[0,1]
    v_mfma_f32_16x16x32_f16 v[176:179], a[232:235], v[136:139], v[176:179]
    v_mad_u32_u16 v222, v221, 2, s85
    v_mad_u32_u16 v221, v221, 2, s85 op_sel:[1,0,0,0]
    v_pk_fma_f16 v223, v225, v225, s53
    v_mfma_f32_16x16x32_f16 v[184:187], a[232:235], v[140:143], v[184:187]
    s_waitcnt lgkmcnt(12)
    ds_read_u16 v222, v222
    ds_read_u16_d16_hi v221, v221
    v_pk_mul_f16 v223, v223, v225 neg_lo:[1,0] neg_hi:[1,0]
    v_mfma_f32_16x16x32_f16 v[192:195], a[232:235], v[160:163], v[192:195]
    v_exp_f16 v224, v223
    v_or_b32 v240, v210, v209
    v_mfma_f32_16x16x32_f16 v[200:203], a[232:235], v[164:167], v[200:203]
    s_waitcnt lgkmcnt(13)
    ds_read_b128 a[232:235], v24 offset:20480
    v_exp_f16_sdwa v224, v223 dst_sel:WORD_1 dst_unused:UNUSED_PRESERVE src0_sel:WORD_1
    v_mfma_f32_16x16x32_f16 v[180:183], a[236:239], v[136:139], v[180:183]
    s_add_u32 m0, s56, 4096
    v_pk_fma_f16 v224, v224, s86, s86
    v_rcp_f16 v223, v224
    v_mfma_f32_16x16x32_f16 v[188:191], a[236:239], v[140:143], v[188:191]
    buffer_load_dwordx4 v5, s[20:23], 0 offen offset:0 lds
    v_rcp_f16_sdwa v223, v224 dst_sel:WORD_1 dst_unused:UNUSED_PRESERVE src0_sel:WORD_1
    v_mfma_f32_16x16x32_f16 v[196:199], a[236:239], v[160:163], v[196:199]
    v_fma_mix_f32 v224, v223, v225, 0 op_sel_hi:[1,1,0]
    v_fma_mix_f32 v223, v223, v225, 0 op_sel:[1,1,0] op_sel_hi:[1,1,0]
    v_or_b32 v241, v212, v211
    v_mfma_f32_16x16x32_f16 v[204:207], a[236:239], v[164:167], v[204:207]
    s_waitcnt lgkmcnt(12)
    ds_read_b128 a[236:239], v24 offset:21504
    v_cvt_pk_bf16_f32 v247, v224, v223
    s_waitcnt lgkmcnt(12)
    v_or_b32 v242, v214, v213
    v_mfma_f32_16x16x32_f16 v[176:179], a[240:243], v[144:147], v[176:179]
    v_mfma_f32_16x16x32_f16 v[184:187], a[240:243], v[148:151], v[184:187]
    v_mfma_f32_16x16x32_f16 v[192:195], a[240:243], v[168:171], v[192:195]
    v_mfma_f32_16x16x32_f16 v[200:203], a[240:243], v[172:175], v[200:203]
    s_waitcnt lgkmcnt(10)
    ds_read_b128 a[240:243], v24 offset:22528
    v_or_b32 v243, v216, v215
    v_mfma_f32_16x16x32_f16 v[180:183], a[244:247], v[144:147], v[180:183]
    s_nop 0
    v_cvt_pkrtz_f16_f32 v226, v176, v177
    v_cvt_pkrtz_f16_f32 v228, v178, v179
    v_mfma_f32_16x16x32_f16 v[188:191], a[244:247], v[148:151], v[188:191]
    v_pk_lshrrev_b16 v226, 3, v226 op_sel_hi:[0,1]
    v_pk_lshrrev_b16 v228, 3, v228 op_sel_hi:[0,1]
    v_mad_u32_u16 v227, v226, 2, s85
    v_mfma_f32_16x16x32_f16 v[196:199], a[244:247], v[168:171], v[196:199]
    ds_read_u16 v227, v227
    v_mad_u32_u16 v226, v226, 2, s85 op_sel:[1,0,0,0]
    v_mad_u32_u16 v229, v228, 2, s85
    v_mfma_f32_16x16x32_f16 v[204:207], a[244:247], v[172:175], v[204:207]
    s_waitcnt lgkmcnt(9)
    ds_read_b128 a[244:247], v24 offset:23552
    ds_read_u16_d16_hi v226, v226
    v_or_b32 v244, v218, v217
    v_mfma_f32_16x16x32_bf16 v[32:35], a[248:251], v[232:235], v[32:35]
    ds_read_u16 v229, v229
    v_mad_u32_u16 v228, v228, 2, s85 op_sel:[1,0,0,0]
    v_cvt_pkrtz_f16_f32 v230, v180, v181
    v_mfma_f32_16x16x32_bf16 v[40:43], a[248:251], v[236:239], v[40:43]
    ds_read_u16_d16_hi v228, v228
    v_cvt_pkrtz_f16_f32 v248, v182, v183
    v_pk_lshrrev_b16 v230, 3, v230 op_sel_hi:[0,1]
    v_mfma_f32_16x16x32_bf16 v[80:83], a[248:251], v[240:243], v[80:83]
    s_waitcnt lgkmcnt(11)
    v_or_b32 v245, v220, v219
    v_pk_lshrrev_b16 v248, 3, v248 op_sel_hi:[0,1]
    v_mad_u32_u16 v231, v230, 2, s85
    v_mad_u32_u16 v230, v230, 2, s85 op_sel:[1,0,0,0]
    v_mad_u32_u16 v249, v248, 2, s85
    v_mad_u32_u16 v248, v248, 2, s85 op_sel:[1,0,0,0]
    v_cvt_pkrtz_f16_f32 v250, v184, v185
    v_cvt_pkrtz_f16_f32 v252, v186, v187
    v_pk_lshrrev_b16 v250, 3, v250 op_sel_hi:[0,1]
    v_pk_lshrrev_b16 v252, 3, v252 op_sel_hi:[0,1]
    v_mad_u32_u16 v251, v250, 2, s85
    v_mad_u32_u16 v250, v250, 2, s85 op_sel:[1,0,0,0]
    v_mad_u32_u16 v253, v252, 2, s85
    v_mad_u32_u16 v252, v252, 2, s85 op_sel:[1,0,0,0]
    v_cvt_pkrtz_f16_f32 v0, v188, v189
    v_cvt_pkrtz_f16_f32 v211, v190, v191
    v_pk_lshrrev_b16 v0, 3, v0 op_sel_hi:[0,1]
    s_waitcnt lgkmcnt(8)
    v_or_b32 v246, v222, v221
    v_mad_u32_u16 v208, v0, 2, s85
    v_mad_u32_u16 v0, v0, 2, s85 op_sel:[1,0,0,0]
    v_mfma_f32_16x16x32_bf16 v[88:91], a[248:251], v[244:247], v[88:91]
    ds_read_u16 v231, v231
    ds_read_u16_d16_hi v230, v230
    v_pk_fma_f16 v209, v211, v211, s53
    v_mfma_f32_16x16x32_bf16 v[36:39], a[252:255], v[232:235], v[36:39]
    ds_read_u16 v249, v249
    ds_read_u16_d16_hi v248, v248
    v_pk_mul_f16 v209, v209, v211 neg_lo:[1,0] neg_hi:[1,0]
    v_mfma_f32_16x16x32_bf16 v[44:47], a[252:255], v[236:239], v[44:47]
    ds_read_u16 v251, v251
    ds_read_u16_d16_hi v250, v250
    v_exp_f16 v210, v209
    v_mfma_f32_16x16x32_bf16 v[84:87], a[252:255], v[240:243], v[84:87]
    s_waitcnt lgkmcnt(12)
    ds_read_u16 v253, v253
    ds_read_u16_d16_hi v252, v252
    v_exp_f16_sdwa v210, v209 dst_sel:WORD_1 dst_unused:UNUSED_PRESERVE src0_sel:WORD_1
    v_mfma_f32_16x16x32_bf16 v[92:95], a[252:255], v[244:247], v[92:95]
    s_waitcnt lgkmcnt(12)
    ds_read_u16 v208, v208
    ds_read_u16_d16_hi v0, v0
    v_pk_fma_f16 v210, v210, s86, s86
    v_mfma_f32_16x16x32_bf16 v[48:51], a[232:235], v[232:235], v[48:51]
    s_waitcnt lgkmcnt(12)
    ds_read_b128 a[248:251], v24 offset:36864
    ds_read_b128 a[252:255], v24 offset:37888
    v_rcp_f16 v209, v210
    v_mfma_f32_16x16x32_bf16 v[56:59], a[232:235], v[236:239], v[56:59]
    v_rcp_f16_sdwa v209, v210 dst_sel:WORD_1 dst_unused:UNUSED_PRESERVE src0_sel:WORD_1
    v_cvt_pkrtz_f16_f32 v212, v192, v193
    v_mfma_f32_16x16x32_bf16 v[96:99], a[232:235], v[240:243], v[96:99]
    v_fma_mix_f32 v210, v209, v211, 0 op_sel_hi:[1,1,0]
    v_fma_mix_f32 v209, v209, v211, 0 op_sel:[1,1,0] op_sel_hi:[1,1,0]
    v_cvt_pkrtz_f16_f32 v214, v194, v195
    v_mfma_f32_16x16x32_bf16 v[104:107], a[232:235], v[244:247], v[104:107]
    s_waitcnt lgkmcnt(13)
    ds_read_b128 a[232:235], v24 offset:38912
    v_pk_lshrrev_b16 v212, 3, v212 op_sel_hi:[0,1]
    v_pk_lshrrev_b16 v214, 3, v214 op_sel_hi:[0,1]
    v_mfma_f32_16x16x32_bf16 v[52:55], a[236:239], v[232:235], v[52:55]
    s_add_u32 m0, s56, 5120
    v_cvt_pkrtz_f16_f32 v216, v196, v197
    v_cvt_pkrtz_f16_f32 v218, v198, v199
    v_cvt_pkrtz_f16_f32 v220, v200, v201
    v_mfma_f32_16x16x32_bf16 v[60:63], a[236:239], v[236:239], v[60:63]
    buffer_load_dwordx4 v6, s[20:23], 0 offen offset:0 lds
    v_cvt_pkrtz_f16_f32 v222, v202, v203
    v_mfma_f32_16x16x32_bf16 v[100:103], a[236:239], v[240:243], v[100:103]
    v_cvt_pkrtz_f16_f32 v224, v204, v205
    v_mad_u32_u16 v213, v212, 2, s85
    v_mad_u32_u16 v212, v212, 2, s85 op_sel:[1,0,0,0]
    v_mfma_f32_16x16x32_bf16 v[108:111], a[236:239], v[244:247], v[108:111]
    s_waitcnt lgkmcnt(12)
    ds_read_b128 a[236:239], v24 offset:39936
    ds_read_u16 v213, v213
    v_mad_u32_u16 v215, v214, 2, s85
    v_mfma_f32_16x16x32_bf16 v[64:67], a[240:243], v[232:235], v[64:67]
    s_waitcnt lgkmcnt(12)
    ds_read_u16_d16_hi v212, v212
    ds_read_u16 v215, v215
    v_mad_u32_u16 v214, v214, 2, s85 op_sel:[1,0,0,0]
    v_mfma_f32_16x16x32_bf16 v[72:75], a[240:243], v[236:239], v[72:75]
    s_waitcnt lgkmcnt(13)
    ds_read_u16_d16_hi v214, v214
    v_pk_lshrrev_b16 v216, 3, v216 op_sel_hi:[0,1]
    v_pk_lshrrev_b16 v218, 3, v218 op_sel_hi:[0,1]
    v_mfma_f32_16x16x32_bf16 v[112:115], a[240:243], v[240:243], v[112:115]
    v_mad_u32_u16 v217, v216, 2, s85
    v_mad_u32_u16 v216, v216, 2, s85 op_sel:[1,0,0,0]
    v_mad_u32_u16 v219, v218, 2, s85
    v_mfma_f32_16x16x32_bf16 v[120:123], a[240:243], v[244:247], v[120:123]
    s_waitcnt lgkmcnt(12)
    ds_read_b128 a[240:243], v24 offset:40960
    ds_read_u16 v217, v217
    v_mad_u32_u16 v218, v218, 2, s85 op_sel:[1,0,0,0]
    v_mfma_f32_16x16x32_bf16 v[68:71], a[244:247], v[232:235], v[68:71]
    s_waitcnt lgkmcnt(12)
    ds_read_u16_d16_hi v216, v216
    ds_read_u16 v219, v219
    v_or_b32 v232, v227, v226
    v_mfma_f32_16x16x32_bf16 v[76:79], a[244:247], v[236:239], v[76:79]
    s_waitcnt lgkmcnt(13)
    ds_read_u16_d16_hi v218, v218
    v_or_b32 v233, v229, v228
    v_or_b32 v234, v231, v230
    v_mfma_f32_16x16x32_bf16 v[116:119], a[244:247], v[240:243], v[116:119]
    v_or_b32 v235, v249, v248
    v_or_b32 v236, v251, v250
    v_or_b32 v237, v253, v252
    v_mfma_f32_16x16x32_bf16 v[124:127], a[244:247], v[244:247], v[124:127]
    s_waitcnt lgkmcnt(13)
    ds_read_b128 a[244:247], v24 offset:41984
    v_cvt_pk_bf16_f32 v239, v210, v209
    v_cvt_pkrtz_f16_f32 v228, v206, v207
    v_pk_lshrrev_b16 v220, 3, v220 op_sel_hi:[0,1]
    v_pk_lshrrev_b16 v222, 3, v222 op_sel_hi:[0,1]
    v_mad_u32_u16 v221, v220, 2, s85
    v_mad_u32_u16 v220, v220, 2, s85 op_sel:[1,0,0,0]
    v_mad_u32_u16 v223, v222, 2, s85
    v_mad_u32_u16 v222, v222, 2, s85 op_sel:[1,0,0,0]
    v_pk_lshrrev_b16 v224, 3, v224 op_sel_hi:[0,1]
    v_or_b32 v238, v208, v0
    v_mad_u32_u16 v225, v224, 2, s85
    v_mad_u32_u16 v224, v224, 2, s85 op_sel:[1,0,0,0]
    v_pk_fma_f16 v226, v228, v228, s53
    s_waitcnt lgkmcnt(13)
    v_mfma_f32_16x16x32_f16 v[176:179], a[248:251], v[128:131], 0
    s_waitcnt lgkmcnt(12)
    ds_read_u16 v221, v221
    ds_read_u16_d16_hi v220, v220
    v_pk_mul_f16 v226, v226, v228 neg_lo:[1,0] neg_hi:[1,0]
    v_mfma_f32_16x16x32_f16 v[184:187], a[248:251], v[132:135], 0
    s_waitcnt lgkmcnt(12)
    ds_read_u16 v223, v223
    ds_read_u16_d16_hi v222, v222
    v_exp_f16 v227, v226
    v_mfma_f32_16x16x32_f16 v[192:195], a[248:251], v[152:155], 0
    s_waitcnt lgkmcnt(12)
    ds_read_u16 v225, v225
    ds_read_u16_d16_hi v224, v224
    v_exp_f16_sdwa v227, v226 dst_sel:WORD_1 dst_unused:UNUSED_PRESERVE src0_sel:WORD_1
    v_mfma_f32_16x16x32_f16 v[200:203], a[248:251], v[156:159], 0
    s_waitcnt lgkmcnt(13)
    ds_read_b128 a[248:251], v24 offset:30720
    v_pk_fma_f16 v227, v227, s86, s86
    v_rcp_f16 v226, v227
    v_mfma_f32_16x16x32_f16 v[180:183], a[252:255], v[128:131], 0
    v_rcp_f16_sdwa v226, v227 dst_sel:WORD_1 dst_unused:UNUSED_PRESERVE src0_sel:WORD_1
    v_or_b32 v240, v213, v212
    v_mfma_f32_16x16x32_f16 v[188:191], a[252:255], v[132:135], 0
    v_fma_mix_f32 v227, v226, v228, 0 op_sel_hi:[1,1,0]
    v_fma_mix_f32 v226, v226, v228, 0 op_sel:[1,1,0] op_sel_hi:[1,1,0]
    v_cvt_pk_bf16_f32 v247, v227, v226
    v_mfma_f32_16x16x32_f16 v[196:199], a[252:255], v[152:155], 0
    v_mfma_f32_16x16x32_f16 v[204:207], a[252:255], v[156:159], 0
    s_waitcnt lgkmcnt(13)
    ds_read_b128 a[252:255], v24 offset:31744
    v_or_b32 v241, v215, v214
    v_mfma_f32_16x16x32_f16 v[176:179], a[232:235], v[136:139], v[176:179]
    v_mfma_f32_16x16x32_f16 v[184:187], a[232:235], v[140:143], v[184:187]
    v_mfma_f32_16x16x32_f16 v[192:195], a[232:235], v[160:163], v[192:195]
    v_mfma_f32_16x16x32_f16 v[200:203], a[232:235], v[164:167], v[200:203]
    s_waitcnt lgkmcnt(12)
    ds_read_b128 a[232:235], v24 offset:32768
    v_mfma_f32_16x16x32_f16 v[180:183], a[236:239], v[136:139], v[180:183]
    s_add_u32 m0, s56, 6144
    s_waitcnt lgkmcnt(12)
    v_or_b32 v242, v217, v216
    v_mfma_f32_16x16x32_f16 v[188:191], a[236:239], v[140:143], v[188:191]
    buffer_load_dword v7, s[20:23], 0 offen offset:0 lds
    v_mfma_f32_16x16x32_f16 v[196:199], a[236:239], v[160:163], v[196:199]
    v_mfma_f32_16x16x32_f16 v[204:207], a[236:239], v[164:167], v[204:207]
    ds_read_b128 a[236:239], v24 offset:33792
    v_mfma_f32_16x16x32_f16 v[176:179], a[240:243], v[144:147], v[176:179]
    s_waitcnt lgkmcnt(11)
    v_or_b32 v243, v219, v218
    v_mfma_f32_16x16x32_f16 v[184:187], a[240:243], v[148:151], v[184:187]
    v_mfma_f32_16x16x32_f16 v[192:195], a[240:243], v[168:171], v[192:195]
    v_mfma_f32_16x16x32_f16 v[200:203], a[240:243], v[172:175], v[200:203]
    s_waitcnt lgkmcnt(10)
    ds_read_b128 a[240:243], v24 offset:34816
    v_mfma_f32_16x16x32_f16 v[180:183], a[244:247], v[144:147], v[180:183]
    s_waitcnt lgkmcnt(9)
    v_or_b32 v244, v221, v220
    v_mfma_f32_16x16x32_f16 v[188:191], a[244:247], v[148:151], v[188:191]
    v_cvt_pkrtz_f16_f32 v229, v176, v177
    v_cvt_pkrtz_f16_f32 v231, v178, v179
    v_pk_lshrrev_b16 v229, 3, v229 op_sel_hi:[0,1]
    v_mfma_f32_16x16x32_f16 v[196:199], a[244:247], v[168:171], v[196:199]
    v_pk_lshrrev_b16 v231, 3, v231 op_sel_hi:[0,1]
    v_mad_u32_u16 v230, v229, 2, s85
    v_mad_u32_u16 v229, v229, 2, s85 op_sel:[1,0,0,0]
    v_mfma_f32_16x16x32_f16 v[204:207], a[244:247], v[172:175], v[204:207]
    s_waitcnt lgkmcnt(7)
    ds_read_b128 a[244:247], v24 offset:35840
    ds_read_u16 v230, v230
    v_or_b32 v245, v223, v222
    v_mad_u32_u16 v248, v231, 2, s85
    v_mad_u32_u16 v231, v231, 2, s85 op_sel:[1,0,0,0]
    v_cvt_pkrtz_f16_f32 v249, v180, v181
    v_cvt_pkrtz_f16_f32 v251, v182, v183
    v_pk_lshrrev_b16 v249, 3, v249 op_sel_hi:[0,1]
    v_pk_lshrrev_b16 v251, 3, v251 op_sel_hi:[0,1]
    v_mad_u32_u16 v250, v249, 2, s85
    v_mad_u32_u16 v249, v249, 2, s85 op_sel:[1,0,0,0]
    v_mad_u32_u16 v252, v251, 2, s85
    v_mad_u32_u16 v251, v251, 2, s85 op_sel:[1,0,0,0]
    v_cvt_pkrtz_f16_f32 v253, v184, v185
    v_cvt_pkrtz_f16_f32 v208, v186, v187
    v_pk_lshrrev_b16 v253, 3, v253 op_sel_hi:[0,1]
    s_waitcnt lgkmcnt(7)
    v_or_b32 v246, v225, v224
    v_pk_lshrrev_b16 v208, 3, v208 op_sel_hi:[0,1]
    v_mad_u32_u16 v0, v253, 2, s85
    v_mad_u32_u16 v253, v253, 2, s85 op_sel:[1,0,0,0]
    s_waitcnt lgkmcnt(6)
    v_mfma_f32_16x16x32_bf16 v[32:35], a[248:251], v[232:235], v[32:35]
    ds_read_u16_d16_hi v229, v229
    ds_read_u16 v248, v248
    v_mad_u32_u16 v209, v208, 2, s85
    v_mfma_f32_16x16x32_bf16 v[40:43], a[248:251], v[236:239], v[40:43]
    ds_read_u16_d16_hi v231, v231
    ds_read_u16 v250, v250
    v_mad_u32_u16 v208, v208, 2, s85 op_sel:[1,0,0,0]
    v_mfma_f32_16x16x32_bf16 v[80:83], a[248:251], v[240:243], v[80:83]
    ds_read_u16_d16_hi v249, v249
    ds_read_u16 v252, v252
    v_cvt_pkrtz_f16_f32 v210, v188, v189
    v_mfma_f32_16x16x32_bf16 v[88:91], a[248:251], v[244:247], v[88:91]
    s_waitcnt lgkmcnt(11)
    ds_read_u16_d16_hi v251, v251
    ds_read_u16 v0, v0
    v_cvt_pkrtz_f16_f32 v214, v190, v191
    v_mfma_f32_16x16x32_bf16 v[36:39], a[252:255], v[232:235], v[36:39]
    s_waitcnt lgkmcnt(12)
    ds_read_u16_d16_hi v253, v253
    ds_read_u16 v209, v209
    v_pk_lshrrev_b16 v210, 3, v210 op_sel_hi:[0,1]
    v_mfma_f32_16x16x32_bf16 v[44:47], a[252:255], v[236:239], v[44:47]
    s_waitcnt lgkmcnt(12)
    ds_read_u16_d16_hi v208, v208
    ds_read_b128 a[248:251], v24 offset:43008
    v_mad_u32_u16 v211, v210, 2, s85
    v_mfma_f32_16x16x32_bf16 v[84:87], a[252:255], v[240:243], v[84:87]
    s_waitcnt lgkmcnt(13)
    ds_read_u16 v211, v211
    v_mad_u32_u16 v210, v210, 2, s85 op_sel:[1,0,0,0]
    v_pk_fma_f16 v212, v214, v214, s53
    v_mfma_f32_16x16x32_bf16 v[92:95], a[252:255], v[244:247], v[92:95]
    s_waitcnt lgkmcnt(12)
    ds_read_u16_d16_hi v210, v210
    ds_read_b128 a[252:255], v24 offset:44032
    v_pk_mul_f16 v212, v212, v214 neg_lo:[1,0] neg_hi:[1,0]
    v_mfma_f32_16x16x32_bf16 v[48:51], a[232:235], v[232:235], v[48:51]
    v_exp_f16 v213, v212
    v_cvt_pkrtz_f16_f32 v215, v192, v193
    v_mfma_f32_16x16x32_bf16 v[56:59], a[232:235], v[236:239], v[56:59]
    v_exp_f16_sdwa v213, v212 dst_sel:WORD_1 dst_unused:UNUSED_PRESERVE src0_sel:WORD_1
    v_cvt_pkrtz_f16_f32 v217, v194, v195
    v_mfma_f32_16x16x32_bf16 v[96:99], a[232:235], v[240:243], v[96:99]
    v_pk_fma_f16 v213, v213, s86, s86
    v_rcp_f16 v212, v213
    v_mfma_f32_16x16x32_bf16 v[104:107], a[232:235], v[244:247], v[104:107]
    s_waitcnt lgkmcnt(13)
    ds_read_b128 a[232:235], v24 offset:45056
    v_rcp_f16_sdwa v212, v213 dst_sel:WORD_1 dst_unused:UNUSED_PRESERVE src0_sel:WORD_1
    v_mfma_f32_16x16x32_bf16 v[52:55], a[236:239], v[232:235], v[52:55]
    buffer_load_dword v254, v31, s[20:23], 0 offen
    v_fma_mix_f32 v213, v212, v214, 0 op_sel_hi:[1,1,0]
    v_fma_mix_f32 v212, v212, v214, 0 op_sel:[1,1,0] op_sel_hi:[1,1,0]
    v_mfma_f32_16x16x32_bf16 v[60:63], a[236:239], v[236:239], v[60:63]
    v_pk_lshrrev_b16 v215, 3, v215 op_sel_hi:[0,1]
    v_pk_lshrrev_b16 v217, 3, v217 op_sel_hi:[0,1]
    v_cvt_pkrtz_f16_f32 v219, v196, v197
    v_mfma_f32_16x16x32_bf16 v[100:103], a[236:239], v[240:243], v[100:103]
    v_cvt_pkrtz_f16_f32 v221, v198, v199
    v_cvt_pkrtz_f16_f32 v223, v200, v201
    v_cvt_pkrtz_f16_f32 v225, v202, v203
    v_mfma_f32_16x16x32_bf16 v[108:111], a[236:239], v[244:247], v[108:111]
    s_waitcnt lgkmcnt(13)
    ds_read_b128 a[236:239], v24 offset:46080
    v_cvt_pkrtz_f16_f32 v227, v204, v205
    v_mad_u32_u16 v216, v215, 2, s85
    v_mfma_f32_16x16x32_bf16 v[64:67], a[240:243], v[232:235], v[64:67]
    s_waitcnt lgkmcnt(13)
    ds_read_u16 v216, v216
    v_mad_u32_u16 v215, v215, 2, s85 op_sel:[1,0,0,0]
    v_mad_u32_u16 v218, v217, 2, s85
    v_mfma_f32_16x16x32_bf16 v[72:75], a[240:243], v[236:239], v[72:75]
    s_waitcnt lgkmcnt(12)
    ds_read_u16_d16_hi v215, v215
    ds_read_u16 v218, v218
    v_mad_u32_u16 v217, v217, 2, s85 op_sel:[1,0,0,0]
    v_mfma_f32_16x16x32_bf16 v[112:115], a[240:243], v[240:243], v[112:115]
    s_waitcnt lgkmcnt(13)
    ds_read_u16_d16_hi v217, v217
    v_pk_lshrrev_b16 v219, 3, v219 op_sel_hi:[0,1]
    v_pk_lshrrev_b16 v221, 3, v221 op_sel_hi:[0,1]
    v_mfma_f32_16x16x32_bf16 v[120:123], a[240:243], v[244:247], v[120:123]
    s_waitcnt lgkmcnt(13)
    ds_read_b128 a[240:243], v24 offset:47104
    v_mad_u32_u16 v220, v219, 2, s85
    v_mad_u32_u16 v219, v219, 2, s85 op_sel:[1,0,0,0]
    v_mfma_f32_16x16x32_bf16 v[68:71], a[244:247], v[232:235], v[68:71]
    s_waitcnt lgkmcnt(12)
    ds_read_u16 v220, v220
    ds_read_u16_d16_hi v219, v219
    v_or_b32 v232, v230, v229
    v_mfma_f32_16x16x32_bf16 v[76:79], a[244:247], v[236:239], v[76:79]
    v_or_b32 v233, v248, v231
    v_or_b32 v234, v250, v249
    v_or_b32 v235, v252, v251
    v_mfma_f32_16x16x32_bf16 v[116:119], a[244:247], v[240:243], v[116:119]
    s_waitcnt lgkmcnt(13)
    v_or_b32 v236, v0, v253
    v_or_b32 v237, v209, v208
    v_cvt_pk_bf16_f32 v239, v213, v212
    v_mfma_f32_16x16x32_bf16 v[124:127], a[244:247], v[244:247], v[124:127]
    s_waitcnt lgkmcnt(12)
    ds_read_b128 a[244:247], v24 offset:48128
    v_cvt_pkrtz_f16_f32 v231, v206, v207
    v_mad_u32_u16 v222, v221, 2, s85
    v_mfma_f32_16x16x32_bf16 v[32:35], a[248:251], v[232:235], v[32:35]
    s_waitcnt lgkmcnt(12)
    ds_read_u16 v222, v222
    v_mad_u32_u16 v221, v221, 2, s85 op_sel:[1,0,0,0]
    v_pk_lshrrev_b16 v223, 3, v223 op_sel_hi:[0,1]
    s_waitcnt lgkmcnt(12)
    v_or_b32 v238, v211, v210
    v_pk_lshrrev_b16 v225, 3, v225 op_sel_hi:[0,1]
    v_mad_u32_u16 v224, v223, 2, s85
    v_mad_u32_u16 v223, v223, 2, s85 op_sel:[1,0,0,0]
    s_waitcnt lgkmcnt(11)
    v_mfma_f32_16x16x32_bf16 v[36:39], a[252:255], v[232:235], v[36:39]
    ds_read_u16_d16_hi v221, v221
    ds_read_u16 v224, v224
    v_mad_u32_u16 v226, v225, 2, s85
    v_mfma_f32_16x16x32_f16 v[176:179], a[0:3], v[128:131], 0
    s_waitcnt lgkmcnt(12)
    ds_read_u16_d16_hi v223, v223
    ds_read_u16 v226, v226
    v_mad_u32_u16 v225, v225, 2, s85 op_sel:[1,0,0,0]
    v_mfma_f32_16x16x32_bf16 v[48:51], a[232:235], v[232:235], v[48:51]
    s_waitcnt lgkmcnt(13)
    ds_read_u16_d16_hi v225, v225
    v_pk_lshrrev_b16 v227, 3, v227 op_sel_hi:[0,1]
    v_mad_u32_u16 v228, v227, 2, s85
    v_mfma_f32_16x16x32_f16 v[180:183], a[4:7], v[128:131], 0
    s_waitcnt lgkmcnt(13)
    ds_read_u16 v228, v228
    v_mad_u32_u16 v227, v227, 2, s85 op_sel:[1,0,0,0]
    v_pk_fma_f16 v229, v231, v231, s53
    v_mfma_f32_16x16x32_bf16 v[52:55], a[236:239], v[232:235], v[52:55]
    s_waitcnt lgkmcnt(13)
    ds_read_u16_d16_hi v227, v227
    v_pk_mul_f16 v229, v229, v231 neg_lo:[1,0] neg_hi:[1,0]
    v_exp_f16 v230, v229
    v_mfma_f32_16x16x32_f16 v[176:179], a[8:11], v[136:139], v[176:179]
    v_exp_f16_sdwa v230, v229 dst_sel:WORD_1 dst_unused:UNUSED_PRESERVE src0_sel:WORD_1
    v_or_b32 v240, v216, v215
    v_pk_fma_f16 v230, v230, s86, s86
    v_rcp_f16 v229, v230
    s_nop 0
    v_rcp_f16_sdwa v229, v230 dst_sel:WORD_1 dst_unused:UNUSED_PRESERVE src0_sel:WORD_1
    s_waitcnt lgkmcnt(12)
    v_or_b32 v241, v218, v217
    v_fma_mix_f32 v230, v229, v231, 0 op_sel_hi:[1,1,0]
    v_fma_mix_f32 v229, v229, v231, 0 op_sel:[1,1,0] op_sel_hi:[1,1,0]
    v_cvt_pk_bf16_f32 v247, v230, v229
    s_waitcnt lgkmcnt(11)
    v_mfma_f32_16x16x32_bf16 v[64:67], a[240:243], v[232:235], v[64:67]
    v_mfma_f32_16x16x32_f16 v[180:183], a[12:15], v[136:139], v[180:183]
    s_waitcnt lgkmcnt(9)
    v_or_b32 v242, v220, v219
    s_waitcnt lgkmcnt(8)
    v_mfma_f32_16x16x32_bf16 v[68:71], a[244:247], v[232:235], v[68:71]
    v_mfma_f32_16x16x32_f16 v[176:179], a[16:19], v[144:147], v[176:179]
    v_mfma_f32_16x16x32_bf16 v[40:43], a[248:251], v[236:239], v[40:43]
    v_mfma_f32_16x16x32_f16 v[180:183], a[20:23], v[144:147], v[180:183]
    s_waitcnt lgkmcnt(6)
    v_or_b32 v243, v222, v221
    v_mfma_f32_16x16x32_bf16 v[44:47], a[252:255], v[236:239], v[44:47]
    v_mfma_f32_16x16x32_f16 v[184:187], a[0:3], v[132:135], 0
    v_mfma_f32_16x16x32_bf16 v[56:59], a[232:235], v[236:239], v[56:59]
    s_nop 0
    v_cvt_pkrtz_f16_f32 v248, v176, v177
    v_cvt_pkrtz_f16_f32 v250, v178, v179
    v_mfma_f32_16x16x32_f16 v[188:191], a[4:7], v[132:135], 0
    s_waitcnt lgkmcnt(4)
    v_or_b32 v244, v224, v223
    v_pk_lshrrev_b16 v248, 3, v248 op_sel_hi:[0,1]
    v_pk_lshrrev_b16 v250, 3, v250 op_sel_hi:[0,1]
    v_mfma_f32_16x16x32_bf16 v[60:63], a[236:239], v[236:239], v[60:63]
    v_mad_u32_u16 v249, v248, 2, s85
    v_mad_u32_u16 v248, v248, 2, s85 op_sel:[1,0,0,0]
    v_mad_u32_u16 v251, v250, 2, s85
    v_mfma_f32_16x16x32_f16 v[184:187], a[8:11], v[140:143], v[184:187]
    ds_read_u16 v249, v249
    ds_read_u16_d16_hi v248, v248
    v_mad_u32_u16 v250, v250, 2, s85 op_sel:[1,0,0,0]
    v_mfma_f32_16x16x32_f16 v[188:191], a[12:15], v[140:143], v[188:191]
    s_waitcnt lgkmcnt(4)
    ds_read_u16 v251, v251
    ds_read_u16_d16_hi v250, v250
    v_or_b32 v245, v226, v225
    v_mfma_f32_16x16x32_f16 v[184:187], a[16:19], v[148:151], v[184:187]
    v_cvt_pkrtz_f16_f32 v252, v180, v181
    v_cvt_pkrtz_f16_f32 v0, v182, v183
    v_pk_lshrrev_b16 v252, 3, v252 op_sel_hi:[0,1]
    v_mfma_f32_16x16x32_f16 v[188:191], a[20:23], v[148:151], v[188:191]
    s_waitcnt lgkmcnt(5)
    v_pk_lshrrev_b16 v0, 3, v0 op_sel_hi:[0,1]
    v_mad_u32_u16 v253, v252, 2, s85
    s_waitcnt lgkmcnt(4)
    v_or_b32 v246, v228, v227
    v_mfma_f32_16x16x32_bf16 v[72:75], a[240:243], v[236:239], v[72:75]
    ds_read_u16 v253, v253
    v_mad_u32_u16 v252, v252, 2, s85 op_sel:[1,0,0,0]
    v_mad_u32_u16 v208, v0, 2, s85
    v_mfma_f32_16x16x32_bf16 v[76:79], a[244:247], v[236:239], v[76:79]
    ds_read_u16_d16_hi v252, v252
    ds_read_u16 v208, v208
    v_mad_u32_u16 v0, v0, 2, s85 op_sel:[1,0,0,0]
    v_mfma_f32_16x16x32_bf16 v[80:83], a[248:251], v[240:243], v[80:83]
    ds_read_u16_d16_hi v0, v0
    v_cvt_pkrtz_f16_f32 v209, v184, v185
    v_cvt_pkrtz_f16_f32 v211, v186, v187
    v_mfma_f32_16x16x32_bf16 v[84:87], a[252:255], v[240:243], v[84:87]
    v_pk_lshrrev_b16 v209, 3, v209 op_sel_hi:[0,1]
    v_pk_lshrrev_b16 v211, 3, v211 op_sel_hi:[0,1]
    v_mad_u32_u16 v210, v209, 2, s85
    v_mfma_f32_16x16x32_f16 v[176:179], a[48:51], v[128:131], 0
    ds_read_u16 v210, v210
    v_mad_u32_u16 v209, v209, 2, s85 op_sel:[1,0,0,0]
    v_mad_u32_u16 v212, v211, 2, s85
    v_mfma_f32_16x16x32_bf16 v[96:99], a[232:235], v[240:243], v[96:99]
    ds_read_u16_d16_hi v209, v209
    ds_read_u16 v212, v212
    v_mad_u32_u16 v211, v211, 2, s85 op_sel:[1,0,0,0]
    v_mfma_f32_16x16x32_f16 v[180:183], a[52:55], v[128:131], 0
    ds_read_u16_d16_hi v211, v211
    v_cvt_pkrtz_f16_f32 v213, v188, v189
    v_cvt_pkrtz_f16_f32 v215, v190, v191
    v_mfma_f32_16x16x32_bf16 v[100:103], a[236:239], v[240:243], v[100:103]
    v_pk_lshrrev_b16 v213, 3, v213 op_sel_hi:[0,1]
    v_pk_lshrrev_b16 v215, 3, v215 op_sel_hi:[0,1]
    v_mad_u32_u16 v214, v213, 2, s85
    v_mfma_f32_16x16x32_f16 v[176:179], a[56:59], v[136:139], v[176:179]
    ds_read_u16 v214, v214
    v_mad_u32_u16 v213, v213, 2, s85 op_sel:[1,0,0,0]
    v_mad_u32_u16 v216, v215, 2, s85
    v_mfma_f32_16x16x32_bf16 v[112:115], a[240:243], v[240:243], v[112:115]
    s_waitcnt lgkmcnt(12)
    ds_read_u16_d16_hi v213, v213
    ds_read_u16 v216, v216
    v_mad_u32_u16 v215, v215, 2, s85 op_sel:[1,0,0,0]
    v_mfma_f32_16x16x32_f16 v[180:183], a[60:63], v[136:139], v[180:183]
    s_waitcnt lgkmcnt(11)
    ds_read_u16_d16_hi v215, v215
    v_or_b32 v232, v249, v248
    v_or_b32 v233, v251, v250
    v_mfma_f32_16x16x32_bf16 v[116:119], a[244:247], v[240:243], v[116:119]
    s_waitcnt lgkmcnt(8)
    v_or_b32 v234, v253, v252
    v_or_b32 v235, v208, v0
    v_mfma_f32_16x16x32_f16 v[176:179], a[64:67], v[144:147], v[176:179]
    v_mfma_f32_16x16x32_bf16 v[88:91], a[248:251], v[244:247], v[88:91]
    v_mfma_f32_16x16x32_f16 v[180:183], a[68:71], v[144:147], v[180:183]
    v_mfma_f32_16x16x32_bf16 v[92:95], a[252:255], v[244:247], v[92:95]
    s_waitcnt lgkmcnt(6)
    v_or_b32 v236, v210, v209
    v_mfma_f32_16x16x32_f16 v[184:187], a[48:51], v[132:135], 0
    v_mfma_f32_16x16x32_bf16 v[104:107], a[232:235], v[244:247], v[104:107]
    s_nop 0
    v_cvt_pkrtz_f16_f32 v217, v176, v177
    v_cvt_pkrtz_f16_f32 v219, v178, v179
    v_mfma_f32_16x16x32_f16 v[188:191], a[52:55], v[132:135], 0
    s_waitcnt lgkmcnt(4)
    v_or_b32 v237, v212, v211
    v_pk_lshrrev_b16 v217, 3, v217 op_sel_hi:[0,1]
    v_pk_lshrrev_b16 v219, 3, v219 op_sel_hi:[0,1]
    v_mfma_f32_16x16x32_bf16 v[108:111], a[236:239], v[244:247], v[108:111]
    v_mad_u32_u16 v218, v217, 2, s85
    v_mad_u32_u16 v217, v217, 2, s85 op_sel:[1,0,0,0]
    v_mad_u32_u16 v220, v219, 2, s85
    v_mfma_f32_16x16x32_f16 v[184:187], a[56:59], v[140:143], v[184:187]
    ds_read_u16 v218, v218
    ds_read_u16_d16_hi v217, v217
    v_mad_u32_u16 v219, v219, 2, s85 op_sel:[1,0,0,0]
    v_mfma_f32_16x16x32_f16 v[188:191], a[60:63], v[140:143], v[188:191]
    s_waitcnt lgkmcnt(4)
    ds_read_u16 v220, v220
    ds_read_u16_d16_hi v219, v219
    v_or_b32 v238, v214, v213
    v_mfma_f32_16x16x32_f16 v[184:187], a[64:67], v[148:151], v[184:187]
    v_cvt_pkrtz_f16_f32 v221, v180, v181
    v_cvt_pkrtz_f16_f32 v223, v182, v183
    v_pk_lshrrev_b16 v221, 3, v221 op_sel_hi:[0,1]
    v_mfma_f32_16x16x32_f16 v[188:191], a[68:71], v[148:151], v[188:191]
    v_pk_lshrrev_b16 v223, 3, v223 op_sel_hi:[0,1]
    v_mad_u32_u16 v222, v221, 2, s85
    v_mad_u32_u16 v221, v221, 2, s85 op_sel:[1,0,0,0]
    v_mfma_f32_16x16x32_bf16 v[120:123], a[240:243], v[244:247], v[120:123]
    s_waitcnt lgkmcnt(4)
    ds_read_u16 v222, v222
    ds_read_u16_d16_hi v221, v221
    v_or_b32 v239, v216, v215
    v_mfma_f32_16x16x32_bf16 v[124:127], a[244:247], v[244:247], v[124:127]
    v_mad_u32_u16 v224, v223, 2, s85
    v_mad_u32_u16 v223, v223, 2, s85 op_sel:[1,0,0,0]
    v_cvt_pkrtz_f16_f32 v225, v184, v185
    v_mfma_f32_16x16x32_bf16 v[32:35], a[24:27], v[232:235], v[32:35]
    ds_read_u16 v224, v224
    ds_read_u16_d16_hi v223, v223
    v_cvt_pkrtz_f16_f32 v227, v186, v187
    v_mfma_f32_16x16x32_bf16 v[36:39], a[28:31], v[232:235], v[36:39]
    v_pk_lshrrev_b16 v225, 3, v225 op_sel_hi:[0,1]
    v_pk_lshrrev_b16 v227, 3, v227 op_sel_hi:[0,1]
    v_mad_u32_u16 v226, v225, 2, s85
    v_mfma_f32_16x16x32_f16 v[176:179], a[96:99], v[128:131], 0
    ds_read_u16 v226, v226
    v_mad_u32_u16 v225, v225, 2, s85 op_sel:[1,0,0,0]
    v_mad_u32_u16 v228, v227, 2, s85
    v_mfma_f32_16x16x32_bf16 v[48:51], a[32:35], v[232:235], v[48:51]
    ds_read_u16_d16_hi v225, v225
    ds_read_u16 v228, v228
    v_mad_u32_u16 v227, v227, 2, s85 op_sel:[1,0,0,0]
    v_mfma_f32_16x16x32_f16 v[180:183], a[100:103], v[128:131], 0
    ds_read_u16_d16_hi v227, v227
    v_cvt_pkrtz_f16_f32 v229, v188, v189
    v_cvt_pkrtz_f16_f32 v231, v190, v191
    v_mfma_f32_16x16x32_bf16 v[52:55], a[36:39], v[232:235], v[52:55]
    v_pk_lshrrev_b16 v229, 3, v229 op_sel_hi:[0,1]
    v_pk_lshrrev_b16 v231, 3, v231 op_sel_hi:[0,1]
    v_mad_u32_u16 v230, v229, 2, s85
    v_mfma_f32_16x16x32_f16 v[176:179], a[104:107], v[136:139], v[176:179]
    ds_read_u16 v230, v230
    v_mad_u32_u16 v229, v229, 2, s85 op_sel:[1,0,0,0]
    v_mad_u32_u16 v248, v231, 2, s85
    v_mfma_f32_16x16x32_bf16 v[64:67], a[40:43], v[232:235], v[64:67]
    s_waitcnt lgkmcnt(12)
    ds_read_u16_d16_hi v229, v229
    ds_read_u16 v248, v248
    v_mad_u32_u16 v231, v231, 2, s85 op_sel:[1,0,0,0]
    v_mfma_f32_16x16x32_f16 v[180:183], a[108:111], v[136:139], v[180:183]
    s_waitcnt lgkmcnt(13)
    ds_read_u16_d16_hi v231, v231
    v_mfma_f32_16x16x32_bf16 v[68:71], a[44:47], v[232:235], v[68:71]
    s_waitcnt lgkmcnt(10)
    v_or_b32 v232, v218, v217
    v_or_b32 v233, v220, v219
    v_or_b32 v234, v222, v221
    v_mfma_f32_16x16x32_f16 v[176:179], a[112:115], v[144:147], v[176:179]
    s_waitcnt lgkmcnt(8)
    v_or_b32 v235, v224, v223
    v_mfma_f32_16x16x32_bf16 v[40:43], a[24:27], v[236:239], v[40:43]
    v_mfma_f32_16x16x32_f16 v[180:183], a[116:119], v[144:147], v[180:183]
    v_mfma_f32_16x16x32_bf16 v[44:47], a[28:31], v[236:239], v[44:47]
    v_mfma_f32_16x16x32_f16 v[184:187], a[96:99], v[132:135], 0
    v_mfma_f32_16x16x32_bf16 v[56:59], a[32:35], v[236:239], v[56:59]
    s_nop 0
    v_cvt_pkrtz_f16_f32 v249, v176, v177
    v_cvt_pkrtz_f16_f32 v251, v178, v179
    v_mfma_f32_16x16x32_f16 v[188:191], a[100:103], v[132:135], 0
    v_pk_lshrrev_b16 v249, 3, v249 op_sel_hi:[0,1]
    v_pk_lshrrev_b16 v251, 3, v251 op_sel_hi:[0,1]
    v_mad_u32_u16 v250, v249, 2, s85
    v_mfma_f32_16x16x32_bf16 v[60:63], a[36:39], v[236:239], v[60:63]
    ds_read_u16 v250, v250
    v_mad_u32_u16 v249, v249, 2, s85 op_sel:[1,0,0,0]
    v_mad_u32_u16 v252, v251, 2, s85
    v_mfma_f32_16x16x32_f16 v[184:187], a[104:107], v[140:143], v[184:187]
    ds_read_u16_d16_hi v249, v249
    ds_read_u16 v252, v252
    v_mad_u32_u16 v251, v251, 2, s85 op_sel:[1,0,0,0]
    v_mfma_f32_16x16x32_f16 v[188:191], a[108:111], v[140:143], v[188:191]
    ds_read_u16_d16_hi v251, v251
    v_cvt_pkrtz_f16_f32 v253, v180, v181
    v_cvt_pkrtz_f16_f32 v208, v182, v183
    v_mfma_f32_16x16x32_f16 v[184:187], a[112:115], v[148:151], v[184:187]
    v_pk_lshrrev_b16 v253, 3, v253 op_sel_hi:[0,1]
    v_pk_lshrrev_b16 v208, 3, v208 op_sel_hi:[0,1]
    v_mad_u32_u16 v0, v253, 2, s85
    v_mfma_f32_16x16x32_f16 v[188:191], a[116:119], v[148:151], v[188:191]
    ds_read_u16 v0, v0
    v_mad_u32_u16 v253, v253, 2, s85 op_sel:[1,0,0,0]
    v_mad_u32_u16 v209, v208, 2, s85
    v_mfma_f32_16x16x32_bf16 v[72:75], a[40:43], v[236:239], v[72:75]
    s_waitcnt lgkmcnt(12)
    ds_read_u16_d16_hi v253, v253
    ds_read_u16 v209, v209
    v_mad_u32_u16 v208, v208, 2, s85 op_sel:[1,0,0,0]
    v_mfma_f32_16x16x32_bf16 v[76:79], a[44:47], v[236:239], v[76:79]
    s_waitcnt lgkmcnt(11)
    ds_read_u16_d16_hi v208, v208
    v_or_b32 v236, v226, v225
    v_or_b32 v237, v228, v227
    v_mfma_f32_16x16x32_bf16 v[32:35], a[72:75], v[232:235], v[32:35]
    s_waitcnt lgkmcnt(8)
    v_or_b32 v238, v230, v229
    v_or_b32 v239, v248, v231
    v_cvt_pkrtz_f16_f32 v210, v184, v185
    v_mfma_f32_16x16x32_bf16 v[36:39], a[76:79], v[232:235], v[36:39]
    v_cvt_pkrtz_f16_f32 v212, v186, v187
    v_pk_lshrrev_b16 v210, 3, v210 op_sel_hi:[0,1]
    v_pk_lshrrev_b16 v212, 3, v212 op_sel_hi:[0,1]
    v_mfma_f32_16x16x32_f16 v[176:179], a[144:147], v[128:131], 0
    v_mad_u32_u16 v211, v210, 2, s85
    v_mad_u32_u16 v210, v210, 2, s85 op_sel:[1,0,0,0]
    v_mad_u32_u16 v213, v212, 2, s85
    v_mfma_f32_16x16x32_bf16 v[48:51], a[80:83], v[232:235], v[48:51]
    ds_read_u16 v211, v211
    ds_read_u16_d16_hi v210, v210
    v_mad_u32_u16 v212, v212, 2, s85 op_sel:[1,0,0,0]
    v_mfma_f32_16x16x32_f16 v[180:183], a[148:151], v[128:131], 0
    ds_read_u16 v213, v213
    ds_read_u16_d16_hi v212, v212
    v_cvt_pkrtz_f16_f32 v214, v188, v189
    v_mfma_f32_16x16x32_bf16 v[52:55], a[84:87], v[232:235], v[52:55]
    v_cvt_pkrtz_f16_f32 v216, v190, v191
    v_pk_lshrrev_b16 v214, 3, v214 op_sel_hi:[0,1]
    v_pk_lshrrev_b16 v216, 3, v216 op_sel_hi:[0,1]
    v_mfma_f32_16x16x32_f16 v[176:179], a[152:155], v[136:139], v[176:179]
    v_mad_u32_u16 v215, v214, 2, s85
    v_mad_u32_u16 v214, v214, 2, s85 op_sel:[1,0,0,0]
    v_mad_u32_u16 v217, v216, 2, s85
    v_mfma_f32_16x16x32_bf16 v[64:67], a[88:91], v[232:235], v[64:67]
    ds_read_u16 v215, v215
    ds_read_u16_d16_hi v214, v214
    v_mad_u32_u16 v216, v216, 2, s85 op_sel:[1,0,0,0]
    v_mfma_f32_16x16x32_f16 v[180:183], a[156:159], v[136:139], v[180:183]
    s_waitcnt lgkmcnt(12)
    ds_read_u16 v217, v217
    ds_read_u16_d16_hi v216, v216
    v_mfma_f32_16x16x32_bf16 v[68:71], a[92:95], v[232:235], v[68:71]
    s_waitcnt lgkmcnt(10)
    v_or_b32 v232, v250, v249
    v_or_b32 v233, v252, v251
    v_or_b32 v234, v0, v253
    v_mfma_f32_16x16x32_f16 v[176:179], a[160:163], v[144:147], v[176:179]
    s_waitcnt lgkmcnt(8)
    v_or_b32 v235, v209, v208
    v_mfma_f32_16x16x32_bf16 v[40:43], a[72:75], v[236:239], v[40:43]
    v_mfma_f32_16x16x32_f16 v[180:183], a[164:167], v[144:147], v[180:183]
    v_mfma_f32_16x16x32_bf16 v[44:47], a[76:79], v[236:239], v[44:47]
    v_mfma_f32_16x16x32_f16 v[184:187], a[144:147], v[132:135], 0
    v_mfma_f32_16x16x32_bf16 v[56:59], a[80:83], v[236:239], v[56:59]
    s_nop 0
    v_cvt_pkrtz_f16_f32 v218, v176, v177
    v_cvt_pkrtz_f16_f32 v220, v178, v179
    v_mfma_f32_16x16x32_f16 v[188:191], a[148:151], v[132:135], 0
    v_pk_lshrrev_b16 v218, 3, v218 op_sel_hi:[0,1]
    v_pk_lshrrev_b16 v220, 3, v220 op_sel_hi:[0,1]
    v_mad_u32_u16 v219, v218, 2, s85
    v_mfma_f32_16x16x32_bf16 v[60:63], a[84:87], v[236:239], v[60:63]
    ds_read_u16 v219, v219
    v_mad_u32_u16 v218, v218, 2, s85 op_sel:[1,0,0,0]
    v_mad_u32_u16 v221, v220, 2, s85
    v_mfma_f32_16x16x32_f16 v[184:187], a[152:155], v[140:143], v[184:187]
    ds_read_u16_d16_hi v218, v218
    ds_read_u16 v221, v221
    v_mad_u32_u16 v220, v220, 2, s85 op_sel:[1,0,0,0]
    v_mfma_f32_16x16x32_f16 v[188:191], a[156:159], v[140:143], v[188:191]
    ds_read_u16_d16_hi v220, v220
    v_cvt_pkrtz_f16_f32 v222, v180, v181
    v_cvt_pkrtz_f16_f32 v224, v182, v183
    v_mfma_f32_16x16x32_f16 v[184:187], a[160:163], v[148:151], v[184:187]
    v_pk_lshrrev_b16 v222, 3, v222 op_sel_hi:[0,1]
    v_pk_lshrrev_b16 v224, 3, v224 op_sel_hi:[0,1]
    v_mad_u32_u16 v223, v222, 2, s85
    v_mfma_f32_16x16x32_f16 v[188:191], a[164:167], v[148:151], v[188:191]
    ds_read_u16 v223, v223
    v_mad_u32_u16 v222, v222, 2, s85 op_sel:[1,0,0,0]
    v_mad_u32_u16 v225, v224, 2, s85
    v_mfma_f32_16x16x32_bf16 v[72:75], a[88:91], v[236:239], v[72:75]
    s_waitcnt lgkmcnt(12)
    ds_read_u16_d16_hi v222, v222
    ds_read_u16 v225, v225
    v_mad_u32_u16 v224, v224, 2, s85 op_sel:[1,0,0,0]
    v_mfma_f32_16x16x32_bf16 v[76:79], a[92:95], v[236:239], v[76:79]
    s_waitcnt lgkmcnt(11)
    ds_read_u16_d16_hi v224, v224
    v_or_b32 v236, v211, v210
    v_or_b32 v237, v213, v212
    v_mfma_f32_16x16x32_bf16 v[32:35], a[120:123], v[232:235], v[32:35]
    s_waitcnt lgkmcnt(8)
    v_or_b32 v238, v215, v214
    v_or_b32 v239, v217, v216
    v_cvt_pkrtz_f16_f32 v226, v184, v185
    v_mfma_f32_16x16x32_bf16 v[36:39], a[124:127], v[232:235], v[36:39]
    v_cvt_pkrtz_f16_f32 v228, v186, v187
    v_pk_lshrrev_b16 v226, 3, v226 op_sel_hi:[0,1]
    v_pk_lshrrev_b16 v228, 3, v228 op_sel_hi:[0,1]
    v_mfma_f32_16x16x32_f16 v[192:195], a[0:3], v[152:155], 0
    s_waitcnt vmcnt(1)
    ds_read_b128 a[232:235], v8 offset:0
    v_mad_u32_u16 v227, v226, 2, s85
    v_mad_u32_u16 v226, v226, 2, s85 op_sel:[1,0,0,0]
    v_mfma_f32_16x16x32_bf16 v[48:51], a[128:131], v[232:235], v[48:51]
    ds_read_u16 v227, v227
    ds_read_u16_d16_hi v226, v226
    v_mad_u32_u16 v229, v228, 2, s85
    v_mfma_f32_16x16x32_f16 v[196:199], a[4:7], v[152:155], 0
    ds_read_u16 v229, v229
    v_mad_u32_u16 v228, v228, 2, s85 op_sel:[1,0,0,0]
    v_cvt_pkrtz_f16_f32 v230, v188, v189
    v_mfma_f32_16x16x32_bf16 v[52:55], a[132:135], v[232:235], v[52:55]
    ds_read_u16_d16_hi v228, v228
    v_cvt_pkrtz_f16_f32 v248, v190, v191
    v_pk_lshrrev_b16 v230, 3, v230 op_sel_hi:[0,1]
    v_mfma_f32_16x16x32_f16 v[192:195], a[8:11], v[160:163], v[192:195]
    ds_read_b128 a[244:247], v8 offset:2560
    v_pk_lshrrev_b16 v248, 3, v248 op_sel_hi:[0,1]
    v_mad_u32_u16 v231, v230, 2, s85
    v_mfma_f32_16x16x32_bf16 v[64:67], a[136:139], v[232:235], v[64:67]
    s_waitcnt lgkmcnt(13)
    ds_read_u16 v231, v231
    v_mad_u32_u16 v230, v230, 2, s85 op_sel:[1,0,0,0]
    v_mad_u32_u16 v249, v248, 2, s85
    v_mfma_f32_16x16x32_f16 v[196:199], a[12:15], v[160:163], v[196:199]
    s_waitcnt lgkmcnt(12)
    ds_read_u16_d16_hi v230, v230
    ds_read_u16 v249, v249
    v_mad_u32_u16 v248, v248, 2, s85 op_sel:[1,0,0,0]
    v_mfma_f32_16x16x32_bf16 v[68:71], a[140:143], v[232:235], v[68:71]
    s_waitcnt lgkmcnt(13)
    ds_read_u16_d16_hi v248, v248
    v_or_b32 v232, v219, v218
    v_or_b32 v233, v221, v220
    v_mfma_f32_16x16x32_f16 v[192:195], a[16:19], v[168:171], v[192:195]
    s_waitcnt lgkmcnt(10)
    ds_read_b128 a[236:239], v12 offset:0
    v_or_b32 v234, v223, v222
    v_or_b32 v235, v225, v224
    v_mfma_f32_16x16x32_bf16 v[40:43], a[120:123], v[236:239], v[40:43]
    v_mfma_f32_16x16x32_f16 v[196:199], a[20:23], v[168:171], v[196:199]
    v_mfma_f32_16x16x32_bf16 v[44:47], a[124:127], v[236:239], v[44:47]
    s_nop 0
    v_cvt_pkrtz_f16_f32 v250, v192, v193
    v_cvt_pkrtz_f16_f32 v252, v194, v195
    v_mfma_f32_16x16x32_f16 v[200:203], a[0:3], v[156:159], 0
    ds_read_b128 a[248:251], v12 offset:2560
    v_pk_lshrrev_b16 v250, 3, v250 op_sel_hi:[0,1]
    v_pk_lshrrev_b16 v252, 3, v252 op_sel_hi:[0,1]
    v_mfma_f32_16x16x32_bf16 v[56:59], a[128:131], v[236:239], v[56:59]
    v_cvt_pkrtz_f16_f32 v0, v196, v197
    v_cvt_pkrtz_f16_f32 v209, v198, v199
    v_mad_u32_u16 v251, v250, 2, s85
    v_mfma_f32_16x16x32_f16 v[204:207], a[4:7], v[156:159], 0
    ds_read_u16 v251, v251
    v_mad_u32_u16 v250, v250, 2, s85 op_sel:[1,0,0,0]
    v_mad_u32_u16 v253, v252, 2, s85
    v_mfma_f32_16x16x32_bf16 v[60:63], a[132:135], v[236:239], v[60:63]
    s_waitcnt lgkmcnt(1)
    ds_read_u16_d16_hi v250, v250
    ds_read_u16 v253, v253
    v_mad_u32_u16 v252, v252, 2, s85 op_sel:[1,0,0,0]
    v_mfma_f32_16x16x32_f16 v[200:203], a[8:11], v[164:167], v[200:203]
    ds_read_b128 a[240:243], v14 offset:1280
    ds_read_u16_d16_hi v252, v252
    v_pk_lshrrev_b16 v0, 3, v0 op_sel_hi:[0,1]
    v_mfma_f32_16x16x32_f16 v[204:207], a[12:15], v[164:167], v[204:207]
    v_pk_lshrrev_b16 v209, 3, v209 op_sel_hi:[0,1]
    v_mad_u32_u16 v208, v0, 2, s85
    v_mad_u32_u16 v0, v0, 2, s85 op_sel:[1,0,0,0]
    v_mfma_f32_16x16x32_f16 v[200:203], a[16:19], v[172:175], v[200:203]
    ds_read_u16 v208, v208
    ds_read_u16_d16_hi v0, v0
    v_mad_u32_u16 v210, v209, 2, s85
    v_mfma_f32_16x16x32_f16 v[204:207], a[20:23], v[172:175], v[204:207]
    ds_read_u16 v210, v210
    v_mad_u32_u16 v209, v209, 2, s85 op_sel:[1,0,0,0]
    v_mfma_f32_16x16x32_bf16 v[72:75], a[136:139], v[236:239], v[72:75]
    ds_read_b128 a[252:255], v14 offset:3840
    ds_read_u16_d16_hi v209, v209
    v_cvt_pkrtz_f16_f32 v211, v200, v201
    v_mfma_f32_16x16x32_bf16 v[76:79], a[140:143], v[236:239], v[76:79]
    v_or_b32 v236, v227, v226
    v_or_b32 v237, v229, v228
    v_or_b32 v238, v231, v230
    v_mfma_f32_16x16x32_bf16 v[32:35], a[168:171], v[232:235], v[32:35]
    v_or_b32 v239, v249, v248
    v_cvt_pkrtz_f16_f32 v213, v202, v203
    v_cvt_pkrtz_f16_f32 v215, v204, v205
    v_mfma_f32_16x16x32_bf16 v[36:39], a[172:175], v[232:235], v[36:39]
    v_cvt_pkrtz_f16_f32 v217, v206, v207
    v_pk_lshrrev_b16 v211, 3, v211 op_sel_hi:[0,1]
    v_pk_lshrrev_b16 v213, 3, v213 op_sel_hi:[0,1]
    v_mfma_f32_16x16x32_f16 v[192:195], a[48:51], v[152:155], 0
    v_mad_u32_u16 v212, v211, 2, s85
    v_mad_u32_u16 v211, v211, 2, s85 op_sel:[1,0,0,0]
    v_mad_u32_u16 v214, v213, 2, s85
    v_mfma_f32_16x16x32_bf16 v[48:51], a[176:179], v[232:235], v[48:51]
    ds_read_u16 v212, v212
    ds_read_u16_d16_hi v211, v211
    v_mad_u32_u16 v213, v213, 2, s85 op_sel:[1,0,0,0]
    v_mfma_f32_16x16x32_f16 v[196:199], a[52:55], v[152:155], 0
    ds_read_u16 v214, v214
    ds_read_u16_d16_hi v213, v213
    v_pk_lshrrev_b16 v215, 3, v215 op_sel_hi:[0,1]
    v_mfma_f32_16x16x32_bf16 v[52:55], a[180:183], v[232:235], v[52:55]
    v_pk_lshrrev_b16 v217, 3, v217 op_sel_hi:[0,1]
    v_mad_u32_u16 v216, v215, 2, s85
    v_mad_u32_u16 v215, v215, 2, s85 op_sel:[1,0,0,0]
    v_mfma_f32_16x16x32_f16 v[192:195], a[56:59], v[160:163], v[192:195]
    s_waitcnt lgkmcnt(12)
    ds_read_u16 v216, v216
    ds_read_u16_d16_hi v215, v215
    v_mad_u32_u16 v218, v217, 2, s85
    v_mfma_f32_16x16x32_bf16 v[64:67], a[184:187], v[232:235], v[64:67]
    s_waitcnt lgkmcnt(13)
    ds_read_u16 v218, v218
    v_mad_u32_u16 v217, v217, 2, s85 op_sel:[1,0,0,0]
    v_or_b32 v240, v251, v250
    v_mfma_f32_16x16x32_f16 v[196:199], a[60:63], v[160:163], v[196:199]
    s_waitcnt lgkmcnt(12)
    ds_read_u16_d16_hi v217, v217
    v_or_b32 v241, v253, v252
    v_cvt_pk_bf16_f32 v32, v32, v33
    v_mfma_f32_16x16x32_bf16 v[68:71], a[188:191], v[232:235], v[68:71]
    v_cvt_pk_bf16_f32 v33, v34, v35
    v_cvt_pk_bf16_f32 v34, v36, v37
    v_cvt_pk_bf16_f32 v35, v38, v39
    v_mfma_f32_16x16x32_f16 v[192:195], a[64:67], v[168:171], v[192:195]
    v_mfma_f32_16x16x32_bf16 v[40:43], a[168:171], v[236:239], v[40:43]
    s_waitcnt lgkmcnt(12)
    s_waitcnt lgkmcnt(11)
    v_or_b32 v242, v208, v0
    v_mfma_f32_16x16x32_f16 v[196:199], a[68:71], v[168:171], v[196:199]
    v_mfma_f32_16x16x32_bf16 v[44:47], a[172:175], v[236:239], v[44:47]
    v_mfma_f32_16x16x32_f16 v[200:203], a[48:51], v[156:159], 0
    v_mfma_f32_16x16x32_bf16 v[56:59], a[176:179], v[236:239], v[56:59]
    v_cvt_pkrtz_f16_f32 v219, v192, v193
    v_cvt_pkrtz_f16_f32 v221, v194, v195
    v_mfma_f32_16x16x32_f16 v[204:207], a[52:55], v[156:159], 0
    s_waitcnt lgkmcnt(8)
    v_or_b32 v243, v210, v209
    v_pk_lshrrev_b16 v219, 3, v219 op_sel_hi:[0,1]
    v_pk_lshrrev_b16 v221, 3, v221 op_sel_hi:[0,1]
    v_mfma_f32_16x16x32_bf16 v[60:63], a[180:183], v[236:239], v[60:63]
    v_cvt_pkrtz_f16_f32 v223, v196, v197
    v_cvt_pkrtz_f16_f32 v225, v198, v199
    v_mad_u32_u16 v220, v219, 2, s85
    v_mfma_f32_16x16x32_f16 v[200:203], a[56:59], v[164:167], v[200:203]
    ds_read_u16 v220, v220
    v_mad_u32_u16 v219, v219, 2, s85 op_sel:[1,0,0,0]
    v_mad_u32_u16 v222, v221, 2, s85
    v_mfma_f32_16x16x32_f16 v[204:207], a[60:63], v[164:167], v[204:207]
    s_waitcnt lgkmcnt(7)
    ds_read_u16_d16_hi v219, v219
    ds_read_u16 v222, v222
    v_or_b32 v244, v212, v211
    v_mfma_f32_16x16x32_f16 v[200:203], a[64:67], v[172:175], v[200:203]
    v_mad_u32_u16 v221, v221, 2, s85 op_sel:[1,0,0,0]
    v_pk_lshrrev_b16 v223, 3, v223 op_sel_hi:[0,1]
    v_pk_lshrrev_b16 v225, 3, v225 op_sel_hi:[0,1]
    v_mfma_f32_16x16x32_f16 v[204:207], a[68:71], v[172:175], v[204:207]
    ds_read_u16_d16_hi v221, v221
    v_mad_u32_u16 v224, v223, 2, s85
    v_mad_u32_u16 v223, v223, 2, s85 op_sel:[1,0,0,0]
    v_mfma_f32_16x16x32_bf16 v[72:75], a[184:187], v[236:239], v[72:75]
    s_waitcnt lgkmcnt(8)
    ds_read_u16 v224, v224
    ds_read_u16_d16_hi v223, v223
    v_or_b32 v245, v214, v213
    v_mfma_f32_16x16x32_bf16 v[76:79], a[188:191], v[236:239], v[76:79]
    v_cvt_pkrtz_f16_f32 v227, v200, v201
    v_cvt_pkrtz_f16_f32 v229, v202, v203
    v_cvt_pkrtz_f16_f32 v231, v204, v205
    v_mfma_f32_16x16x32_bf16 v[80:83], a[24:27], v[240:243], v[80:83]
    s_waitcnt lgkmcnt(9)
    v_cvt_pkrtz_f16_f32 v249, v206, v207
    v_mad_u32_u16 v226, v225, 2, s85
    s_waitcnt lgkmcnt(8)
    v_or_b32 v246, v216, v215
    v_mfma_f32_16x16x32_bf16 v[84:87], a[28:31], v[240:243], v[84:87]
    ds_read_u16 v226, v226
    v_mad_u32_u16 v225, v225, 2, s85 op_sel:[1,0,0,0]
    v_pk_lshrrev_b16 v227, 3, v227 op_sel_hi:[0,1]
    v_mfma_f32_16x16x32_f16 v[192:195], a[96:99], v[152:155], 0
    ds_read_u16_d16_hi v225, v225
    ds_read_b128 v[176:179], v9 offset:0
    v_pk_lshrrev_b16 v229, 3, v229 op_sel_hi:[0,1]
    v_mfma_f32_16x16x32_bf16 v[96:99], a[32:35], v[240:243], v[96:99]
    s_waitcnt lgkmcnt(10)
    v_mad_u32_u16 v228, v227, 2, s85
    v_mad_u32_u16 v227, v227, 2, s85 op_sel:[1,0,0,0]
    s_waitcnt lgkmcnt(9)
    v_or_b32 v247, v218, v217
    v_mfma_f32_16x16x32_f16 v[196:199], a[100:103], v[152:155], 0
    ds_read_u16 v228, v228
    ds_read_u16_d16_hi v227, v227
    v_mad_u32_u16 v230, v229, 2, s85
    v_mfma_f32_16x16x32_bf16 v[100:103], a[36:39], v[240:243], v[100:103]
    ds_read_u16 v230, v230
    v_mad_u32_u16 v229, v229, 2, s85 op_sel:[1,0,0,0]
    v_pk_lshrrev_b16 v231, 3, v231 op_sel_hi:[0,1]
    v_mfma_f32_16x16x32_f16 v[192:195], a[104:107], v[160:163], v[192:195]
    ds_read_u16_d16_hi v229, v229
    buffer_store_dwordx4 v[32:35], v26, s[24:27], s80 offen offset:0 sc0 sc1
    v_pk_lshrrev_b16 v249, 3, v249 op_sel_hi:[0,1]
    v_mfma_f32_16x16x32_bf16 v[112:115], a[40:43], v[240:243], v[112:115]
    ds_read_b128 v[188:191], v9 offset:2560
    v_mad_u32_u16 v248, v231, 2, s85
    v_mad_u32_u16 v231, v231, 2, s85 op_sel:[1,0,0,0]
    v_mfma_f32_16x16x32_f16 v[196:199], a[108:111], v[160:163], v[196:199]
    s_waitcnt lgkmcnt(12)
    ds_read_u16 v248, v248
    ds_read_u16_d16_hi v231, v231
    v_mad_u32_u16 v250, v249, 2, s85
    v_mfma_f32_16x16x32_bf16 v[116:119], a[44:47], v[240:243], v[116:119]
    s_waitcnt lgkmcnt(13)
    ds_read_u16 v250, v250
    v_mad_u32_u16 v249, v249, 2, s85 op_sel:[1,0,0,0]
    v_cvt_pk_bf16_f32 v40, v40, v41
    v_mfma_f32_16x16x32_f16 v[192:195], a[112:115], v[168:171], v[192:195]
    s_waitcnt lgkmcnt(12)
    ds_read_u16_d16_hi v249, v249
    ds_read_b128 v[180:183], v13 offset:0
    v_cvt_pk_bf16_f32 v41, v42, v43
    v_mfma_f32_16x16x32_bf16 v[88:91], a[24:27], v[244:247], v[88:91]
    v_cvt_pk_bf16_f32 v42, v44, v45
    v_cvt_pk_bf16_f32 v43, v46, v47
    v_or_b32 v240, v220, v219
    v_mfma_f32_16x16x32_f16 v[196:199], a[116:119], v[168:171], v[196:199]
    s_waitcnt lgkmcnt(13)
    v_or_b32 v241, v222, v221
    v_or_b32 v242, v224, v223
    v_cvt_pkrtz_f16_f32 v251, v192, v193
    v_mfma_f32_16x16x32_bf16 v[92:95], a[28:31], v[244:247], v[92:95]
    v_cvt_pkrtz_f16_f32 v253, v194, v195
    v_pk_lshrrev_b16 v251, 3, v251 op_sel_hi:[0,1]
    v_pk_lshrrev_b16 v253, 3, v253 op_sel_hi:[0,1]
    v_mfma_f32_16x16x32_f16 v[200:203], a[96:99], v[156:159], 0
    ds_read_b128 v[232:235], v13 offset:2560
    v_cvt_pkrtz_f16_f32 v208, v196, v197
    v_cvt_pkrtz_f16_f32 v210, v198, v199
    v_mfma_f32_16x16x32_bf16 v[104:107], a[32:35], v[244:247], v[104:107]
    s_waitcnt lgkmcnt(12)
    v_or_b32 v243, v226, v225
    v_mad_u32_u16 v252, v251, 2, s85
    v_mad_u32_u16 v251, v251, 2, s85 op_sel:[1,0,0,0]
    v_mfma_f32_16x16x32_f16 v[204:207], a[100:103], v[156:159], 0
    buffer_store_dwordx4 v[40:43], v26, s[24:27], s81 offen offset:0 sc0 sc1
    v_mad_u32_u16 v0, v253, 2, s85
    v_mad_u32_u16 v253, v253, 2, s85 op_sel:[1,0,0,0]
    v_mfma_f32_16x16x32_bf16 v[108:111], a[36:39], v[244:247], v[108:111]
    ds_read_u16 v252, v252
    ds_read_u16_d16_hi v251, v251
    v_pk_lshrrev_b16 v208, 3, v208 op_sel_hi:[0,1]
    v_mfma_f32_16x16x32_f16 v[200:203], a[104:107], v[164:167], v[200:203]
    s_waitcnt lgkmcnt(12)
    ds_read_b128 v[184:187], v15 offset:1280
    ds_read_u16 v0, v0
    v_pk_lshrrev_b16 v210, 3, v210 op_sel_hi:[0,1]
    v_mfma_f32_16x16x32_f16 v[204:207], a[108:111], v[164:167], v[204:207]
    s_waitcnt lgkmcnt(13)
    ds_read_u16_d16_hi v253, v253
    v_mad_u32_u16 v209, v208, 2, s85
    v_mad_u32_u16 v208, v208, 2, s85 op_sel:[1,0,0,0]
    v_mfma_f32_16x16x32_f16 v[200:203], a[112:115], v[172:175], v[200:203]
    s_waitcnt lgkmcnt(12)
    ds_read_u16 v209, v209
    ds_read_u16_d16_hi v208, v208
    v_mad_u32_u16 v211, v210, 2, s85
    v_mfma_f32_16x16x32_f16 v[204:207], a[116:119], v[172:175], v[204:207]
    s_waitcnt lgkmcnt(4)
    ds_read_u16 v211, v211
    v_mad_u32_u16 v210, v210, 2, s85 op_sel:[1,0,0,0]
    v_cvt_pk_bf16_f32 v48, v48, v49
    v_mfma_f32_16x16x32_bf16 v[120:123], a[40:43], v[244:247], v[120:123]
    ds_read_b128 v[236:239], v15 offset:3840
    ds_read_u16_d16_hi v210, v210
    v_cvt_pkrtz_f16_f32 v212, v200, v201
    v_mfma_f32_16x16x32_bf16 v[124:127], a[44:47], v[244:247], v[124:127]
    v_or_b32 v244, v228, v227
    v_or_b32 v245, v230, v229
    v_cvt_pkrtz_f16_f32 v214, v202, v203
    v_mfma_f32_16x16x32_bf16 v[80:83], a[72:75], v[240:243], v[80:83]
    v_cvt_pkrtz_f16_f32 v216, v204, v205
    v_cvt_pkrtz_f16_f32 v218, v206, v207
    v_pk_lshrrev_b16 v212, 3, v212 op_sel_hi:[0,1]
    v_mfma_f32_16x16x32_bf16 v[84:87], a[76:79], v[240:243], v[84:87]
    v_pk_lshrrev_b16 v214, 3, v214 op_sel_hi:[0,1]
    v_or_b32 v246, v248, v231
    v_mad_u32_u16 v213, v212, 2, s85
    v_mfma_f32_16x16x32_f16 v[192:195], a[144:147], v[152:155], 0
    ds_read_u16 v213, v213
    v_mad_u32_u16 v212, v212, 2, s85 op_sel:[1,0,0,0]
    v_mad_u32_u16 v215, v214, 2, s85
    v_mfma_f32_16x16x32_bf16 v[96:99], a[80:83], v[240:243], v[96:99]
    ds_read_u16_d16_hi v212, v212
    ds_read_u16 v215, v215
    v_mad_u32_u16 v214, v214, 2, s85 op_sel:[1,0,0,0]
    v_mfma_f32_16x16x32_f16 v[196:199], a[148:151], v[152:155], 0
    ds_read_u16_d16_hi v214, v214
    v_or_b32 v247, v250, v249
    v_pk_lshrrev_b16 v216, 3, v216 op_sel_hi:[0,1]
    v_mfma_f32_16x16x32_bf16 v[100:103], a[84:87], v[240:243], v[100:103]
    v_pk_lshrrev_b16 v218, 3, v218 op_sel_hi:[0,1]
    v_mad_u32_u16 v217, v216, 2, s85
    v_mad_u32_u16 v216, v216, 2, s85 op_sel:[1,0,0,0]
    v_mfma_f32_16x16x32_f16 v[192:195], a[152:155], v[160:163], v[192:195]
    ds_read_u16 v217, v217
    ds_read_u16_d16_hi v216, v216
    v_mad_u32_u16 v219, v218, 2, s85
    v_mfma_f32_16x16x32_bf16 v[112:115], a[88:91], v[240:243], v[112:115]
    ds_read_u16 v219, v219
    v_mad_u32_u16 v218, v218, 2, s85 op_sel:[1,0,0,0]
    v_cvt_pk_bf16_f32 v49, v50, v51
    v_mfma_f32_16x16x32_f16 v[196:199], a[156:159], v[160:163], v[196:199]
    s_waitcnt lgkmcnt(13)
    ds_read_u16_d16_hi v218, v218
    v_cvt_pk_bf16_f32 v50, v52, v53
    v_cvt_pk_bf16_f32 v51, v54, v55
    v_mfma_f32_16x16x32_bf16 v[116:119], a[92:95], v[240:243], v[116:119]
    buffer_store_dwordx4 v[48:51], v26, s[24:27], s80 offen offset:64 sc0 sc1
    v_cvt_pk_bf16_f32 v56, v56, v57
    v_cvt_pk_bf16_f32 v57, v58, v59
    v_mfma_f32_16x16x32_f16 v[192:195], a[160:163], v[168:171], v[192:195]
    v_cvt_pk_bf16_f32 v58, v60, v61
    v_cvt_pk_bf16_f32 v59, v62, v63
    v_cvt_pk_bf16_f32 v64, v64, v65
    v_mfma_f32_16x16x32_bf16 v[88:91], a[72:75], v[244:247], v[88:91]
    v_cvt_pk_bf16_f32 v65, v66, v67
    v_cvt_pk_bf16_f32 v66, v68, v69
    v_cvt_pk_bf16_f32 v67, v70, v71
    v_mfma_f32_16x16x32_f16 v[196:199], a[164:167], v[168:171], v[196:199]
    buffer_store_dwordx4 v[56:59], v26, s[24:27], s81 offen offset:64 sc0 sc1
    v_or_b32 v240, v252, v251
    s_waitcnt lgkmcnt(13)
    v_or_b32 v241, v0, v253
    v_mfma_f32_16x16x32_bf16 v[92:95], a[76:79], v[244:247], v[92:95]
    v_cvt_pkrtz_f16_f32 v220, v192, v193
    v_cvt_pkrtz_f16_f32 v222, v194, v195
    v_pk_lshrrev_b16 v220, 3, v220 op_sel_hi:[0,1]
    v_mfma_f32_16x16x32_f16 v[200:203], a[144:147], v[156:159], 0
    v_pk_lshrrev_b16 v222, 3, v222 op_sel_hi:[0,1]
    v_cvt_pkrtz_f16_f32 v224, v196, v197
    v_cvt_pkrtz_f16_f32 v226, v198, v199
    v_mfma_f32_16x16x32_bf16 v[104:107], a[80:83], v[244:247], v[104:107]
    s_waitcnt lgkmcnt(11)
    v_mad_u32_u16 v221, v220, 2, s85
    v_or_b32 v242, v209, v208
    v_mad_u32_u16 v220, v220, 2, s85 op_sel:[1,0,0,0]
    v_mfma_f32_16x16x32_f16 v[204:207], a[148:151], v[156:159], 0
    ds_read_u16 v221, v221
    ds_read_u16_d16_hi v220, v220
    v_mad_u32_u16 v223, v222, 2, s85
    v_mfma_f32_16x16x32_bf16 v[108:111], a[84:87], v[244:247], v[108:111]
    ds_read_u16 v223, v223
    v_mad_u32_u16 v222, v222, 2, s85 op_sel:[1,0,0,0]
    v_pk_lshrrev_b16 v224, 3, v224 op_sel_hi:[0,1]
    v_mfma_f32_16x16x32_f16 v[200:203], a[152:155], v[164:167], v[200:203]
    s_waitcnt lgkmcnt(13)
    ds_read_u16_d16_hi v222, v222
    v_pk_lshrrev_b16 v226, 3, v226 op_sel_hi:[0,1]
    v_mad_u32_u16 v225, v224, 2, s85
    v_mfma_f32_16x16x32_f16 v[204:207], a[156:159], v[164:167], v[204:207]
    s_waitcnt lgkmcnt(12)
    ds_read_u16 v225, v225
    v_or_b32 v243, v211, v210
    v_mad_u32_u16 v224, v224, 2, s85 op_sel:[1,0,0,0]
    v_mfma_f32_16x16x32_f16 v[200:203], a[160:163], v[172:175], v[200:203]
    ds_read_u16_d16_hi v224, v224
    v_mad_u32_u16 v227, v226, 2, s85
    v_mad_u32_u16 v226, v226, 2, s85 op_sel:[1,0,0,0]
    v_mfma_f32_16x16x32_f16 v[204:207], a[164:167], v[172:175], v[204:207]
    s_waitcnt lgkmcnt(12)
    ds_read_u16 v227, v227
    ds_read_u16_d16_hi v226, v226
    v_cvt_pk_bf16_f32 v72, v72, v73
    v_mfma_f32_16x16x32_bf16 v[120:123], a[88:91], v[244:247], v[120:123]
    buffer_store_dwordx4 v[64:67], v26, s[24:27], s80 offen offset:128 sc0 sc1
    v_cvt_pkrtz_f16_f32 v228, v200, v201
    v_cvt_pkrtz_f16_f32 v230, v202, v203
    v_mfma_f32_16x16x32_bf16 v[124:127], a[92:95], v[244:247], v[124:127]
    v_or_b32 v244, v213, v212
    v_cvt_pkrtz_f16_f32 v248, v204, v205
    v_cvt_pkrtz_f16_f32 v250, v206, v207
    v_mfma_f32_16x16x32_bf16 v[80:83], a[120:123], v[240:243], v[80:83]
    s_waitcnt lgkmcnt(13)
    ds_read_b128 v[192:195], v22 offset:0
    v_pk_lshrrev_b16 v228, 3, v228 op_sel_hi:[0,1]
    v_pk_lshrrev_b16 v230, 3, v230 op_sel_hi:[0,1]
    v_mfma_f32_16x16x32_bf16 v[84:87], a[124:127], v[240:243], v[84:87]
    s_waitcnt lgkmcnt(13)
    v_or_b32 v245, v215, v214
    v_mad_u32_u16 v229, v228, 2, s85
    v_mad_u32_u16 v228, v228, 2, s85 op_sel:[1,0,0,0]
    v_mfma_f32_16x16x32_bf16 v[96:99], a[128:131], v[240:243], v[96:99]
    s_waitcnt lgkmcnt(12)
    ds_read_u16 v229, v229
    ds_read_u16_d16_hi v228, v228
    v_mad_u32_u16 v231, v230, 2, s85
    v_mfma_f32_16x16x32_bf16 v[100:103], a[132:135], v[240:243], v[100:103]
    s_waitcnt lgkmcnt(12)
    ds_read_u16 v231, v231
    ds_read_b128 v[200:203], v22 offset:16
    v_mad_u32_u16 v230, v230, 2, s85 op_sel:[1,0,0,0]
    v_mfma_f32_16x16x32_bf16 v[112:115], a[136:139], v[240:243], v[112:115]
    s_waitcnt lgkmcnt(12)
    ds_read_u16_d16_hi v230, v230
    ds_read_b128 v[196:199], v22 offset:256
    v_or_b32 v246, v217, v216
    v_mfma_f32_16x16x32_bf16 v[116:119], a[140:143], v[240:243], v[116:119]
    v_pk_lshrrev_b16 v248, 3, v248 op_sel_hi:[0,1]
    v_pk_lshrrev_b16 v250, 3, v250 op_sel_hi:[0,1]
    v_mad_u32_u16 v249, v248, 2, s85
    v_mad_u32_u16 v248, v248, 2, s85 op_sel:[1,0,0,0]
    v_mad_u32_u16 v251, v250, 2, s85
    v_mad_u32_u16 v250, v250, 2, s85 op_sel:[1,0,0,0]
    v_cvt_pk_bf16_f32 v73, v74, v75
    v_cvt_pk_bf16_f32 v74, v76, v77
    v_or_b32 v247, v219, v218
    v_cvt_pk_bf16_f32 v75, v78, v79
    s_nop 0
    v_mfma_f32_16x16x32_bf16 v[88:91], a[120:123], v[244:247], v[88:91]
    s_waitcnt lgkmcnt(12)
    ds_read_u16 v249, v249
    ds_read_u16_d16_hi v248, v248
    v_mfma_f32_16x16x32_bf16 v[92:95], a[124:127], v[244:247], v[92:95]
    s_waitcnt lgkmcnt(12)
    ds_read_u16 v251, v251
    ds_read_u16_d16_hi v250, v250
    v_mfma_f32_16x16x32_bf16 v[104:107], a[128:131], v[244:247], v[104:107]
    s_waitcnt lgkmcnt(13)
    ds_read_b128 v[204:207], v22 offset:272
    buffer_store_dwordx4 v[72:75], v26, s[24:27], s81 offen offset:128 sc0 sc1
    v_or_b32 v240, v221, v220
    v_mfma_f32_16x16x32_bf16 v[108:111], a[132:135], v[244:247], v[108:111]
    s_waitcnt lgkmcnt(13)
    ds_read_b128 v[56:59], v20 offset:2560
    v_mfma_f32_16x16x32_bf16 v[120:123], a[136:139], v[244:247], v[120:123]
    s_waitcnt lgkmcnt(13)
    ds_read_b128 v[60:63], v21 offset:2560
    v_mfma_f32_16x16x32_bf16 v[124:127], a[140:143], v[244:247], v[124:127]
    s_waitcnt lgkmcnt(13)
    ds_read_b128 v[52:55], v21 offset:0
    v_or_b32 v241, v223, v222
    v_or_b32 v242, v225, v224
    v_or_b32 v243, v227, v226
    s_nop 1
    v_mfma_f32_16x16x32_bf16 v[80:83], a[168:171], v[240:243], v[80:83]
    s_waitcnt lgkmcnt(13)
    ds_read_b128 v[48:51], v20 offset:0
    v_mfma_f32_16x16x32_bf16 v[84:87], a[172:175], v[240:243], v[84:87]
    v_mfma_f32_16x16x32_bf16 v[96:99], a[176:179], v[240:243], v[96:99]
    s_add_u32 s52, s52, 1
    v_mfma_f32_16x16x32_bf16 v[100:103], a[180:183], v[240:243], v[100:103]
    s_cmp_eq_u32 s52, 4
    s_waitcnt lgkmcnt(13)
    v_or_b32 v244, v229, v228
    v_mfma_f32_16x16x32_bf16 v[112:115], a[184:187], v[240:243], v[112:115]
    v_mfma_f32_16x16x32_bf16 v[116:119], a[188:191], v[240:243], v[116:119]
    s_waitcnt lgkmcnt(12)
    s_waitcnt lgkmcnt(10)
    v_or_b32 v245, v231, v230
    s_waitcnt lgkmcnt(7)
    v_or_b32 v246, v249, v248
    s_waitcnt lgkmcnt(5)
    v_or_b32 v247, v251, v250
    s_cbranch_scc0 L_conv
L_final:
    s_nop 0
    v_mfma_f32_16x16x32_bf16 v[88:91], a[168:171], v[244:247], v[88:91]
    v_cvt_pk_bf16_f32 v80, v80, v81
    v_cvt_pk_bf16_f32 v81, v82, v83
    v_cvt_pk_bf16_f32 v82, v84, v85
    v_mfma_f32_16x16x32_bf16 v[92:95], a[172:175], v[244:247], v[92:95]
    v_cvt_pk_bf16_f32 v83, v86, v87
    v_cvt_pk_bf16_f32 v96, v96, v97
    v_cvt_pk_bf16_f32 v97, v98, v99
    v_mfma_f32_16x16x32_bf16 v[104:107], a[176:179], v[244:247], v[104:107]
    buffer_store_dwordx4 v[80:83], v26, s[24:27], s82 offen offset:0 sc0 sc1
    v_cvt_pk_bf16_f32 v98, v100, v101
    v_cvt_pk_bf16_f32 v99, v102, v103
    v_mfma_f32_16x16x32_bf16 v[108:111], a[180:183], v[244:247], v[108:111]
    buffer_store_dwordx4 v[96:99], v26, s[24:27], s82 offen offset:64 sc0 sc1
    v_cvt_pk_bf16_f32 v112, v112, v113
    v_cvt_pk_bf16_f32 v113, v114, v115
    v_mfma_f32_16x16x32_bf16 v[120:123], a[184:187], v[244:247], v[120:123]
    v_cvt_pk_bf16_f32 v114, v116, v117
    v_cvt_pk_bf16_f32 v115, v118, v119
    v_cvt_pk_bf16_f32 v88, v88, v89
    v_mfma_f32_16x16x32_bf16 v[124:127], a[188:191], v[244:247], v[124:127]
    buffer_store_dwordx4 v[112:115], v26, s[24:27], s82 offen offset:128 sc0 sc1
    v_cvt_pk_bf16_f32 v89, v90, v91
    v_cvt_pk_bf16_f32 v90, v92, v93
    v_cvt_pk_bf16_f32 v91, v94, v95
    v_cvt_pk_bf16_f32 v104, v104, v105
    v_cvt_pk_bf16_f32 v105, v106, v107
    v_cvt_pk_bf16_f32 v106, v108, v109
    v_cvt_pk_bf16_f32 v107, v110, v111
    v_cvt_pk_bf16_f32 v120, v120, v121
    v_cvt_pk_bf16_f32 v121, v122, v123
    v_cvt_pk_bf16_f32 v122, v124, v125
    v_cvt_pk_bf16_f32 v123, v126, v127
    buffer_store_dwordx4 v[88:91], v26, s[24:27], s83 offen offset:0 sc0 sc1
    buffer_store_dwordx4 v[104:107], v26, s[24:27], s83 offen offset:64 sc0 sc1
    buffer_store_dwordx4 v[120:123], v26, s[24:27], s83 offen offset:128 sc0 sc1
L_end:
    s_endpgm
.section .rodata,"a"
.p2align 6
.amdhsa_kernel standalone__modern_conv_block_convnext__vision_kernel
  .amdhsa_next_free_vgpr 512
  .amdhsa_next_free_sgpr 102
  .amdhsa_accum_offset 256
  .amdhsa_group_segment_fixed_size 0
  .amdhsa_kernarg_size 80
  .amdhsa_user_sgpr_count 2
  .amdhsa_user_sgpr_kernarg_segment_ptr 1
  .amdhsa_system_sgpr_workgroup_id_x 1
.end_amdhsa_kernel
```

```asm
; @launch grid=(256,1,1) block=(256,1,1) lds=163840
.amdgcn_target "amdgcn-amd-amdhsa--gfx950"
.text
.globl standalone__modern_conv_block_convnext__vision_kernel
.p2align 8
.type standalone__modern_conv_block_convnext__vision_kernel,@function
standalone__modern_conv_block_convnext__vision_kernel:
    s_cmp_ge_u32 s2, 256
    s_cbranch_scc1 L_end
    s_load_dwordx16 s[4:19], s[0:1], 0
    v_lshrrev_b32 v128, 6, v0
    v_and_b32 v129, 63, v0
    v_readfirstlane_b32 s3, v128
    s_getpc_b64 s[60:61]
L_pc:
    v_lshlrev_b32 v18, 7, v0
    v_add_u32 v20, 256, v18
    v_add_u32 v18, L_end-L_pc-32640, v18
    v_mov_b32 v19, s61
    v_mov_b32 v21, s61
    v_add_co_u32 v20, vcc, s60, v20
    s_nop 1
    v_addc_co_u32 v21, vcc, 0, v21, vcc
    s_nop 1
    v_add_co_u32 v18, vcc, s60, v18
    s_nop 1
    v_addc_co_u32 v19, vcc, 0, v19, vcc
    v_cmp_gt_u32 vcc, (L_end-L_pc-32640-256+127)/128, v0
    s_nop 0
    s_and_saveexec_b64 s[62:63], vcc
    s_cbranch_execz L_cpf
    global_load_dword v250, v[20:21], off
L_cpf:
    s_mov_b64 exec, s[62:63]
    global_load_dword v251, v[18:19], off
    s_and_b32 s60, s2, 7
    s_lshl_b32 s60, s60, 5
    s_lshr_b32 s61, s2, 3
    s_add_u32 s60, s60, s61
    s_lshr_b32 s61, s60, 4
    s_and_b32 s60, s60, 15
    s_lshl_b32 s54, s61, 5
    s_lshl_b32 s60, s60, 5
    s_lshl_b32 s62, s3, 3
    s_add_u32 s55, s60, s62
    s_mul_i32 s61, s54, 98304
    s_mul_i32 s62, s55, 192
    s_add_u32 s63, s61, s62
    s_sub_u32 s64, s63, 98496
    s_sub_u32 s65, s55, 1
    s_mul_i32 s56, s3, 12800
    s_add_u32 s56, s56, 90112
    s_mov_b32 s68, 98304
    s_movk_i32 s69, 192
    v_lshrrev_b32 v128, 2, v129
    v_and_b32 v130, 3, v129
    v_mov_b32 v135, s64
    v_bfrev_b32 v136, 1
    v_mul_u32_u24 v131, 205, v128
    v_lshrrev_b32 v131, 11, v131
    v_mad_i32_i24 v132, v131, -10, v128
    v_bfe_u32 v133, v131, 1, 1
    v_bfe_u32 v134, v132, 2, 1
    v_lshl_or_b32 v133, v133, 1, v134
    v_xor_b32 v133, v133, v130
    v_mad_u32_u24 v131, v131, s68, v135
    v_lshl_add_u32 v131, v133, 4, v131
    v_mad_u32_u24 v131, v132, s69, v131
    v_add_u32 v132, s65, v132
    v_cmp_gt_u32 vcc, 0x200, v132
    s_nop 1
    v_cndmask_b32 v1, v136, v131, vcc
    v_add_u32 v128, 16, v128
    v_mul_u32_u24 v131, 205, v128
    v_lshrrev_b32 v131, 11, v131
    v_mad_i32_i24 v132, v131, -10, v128
    v_bfe_u32 v133, v131, 1, 1
    v_bfe_u32 v134, v132, 2, 1
    v_lshl_or_b32 v133, v133, 1, v134
    v_xor_b32 v133, v133, v130
    v_mad_u32_u24 v131, v131, s68, v135
    v_lshl_add_u32 v131, v133, 4, v131
    v_mad_u32_u24 v131, v132, s69, v131
    v_add_u32 v132, s65, v132
    v_cmp_gt_u32 vcc, 0x200, v132
    s_nop 1
    v_cndmask_b32 v2, v136, v131, vcc
    v_add_u32 v128, 16, v128
    v_mul_u32_u24 v131, 205, v128
    v_lshrrev_b32 v131, 11, v131
    v_mad_i32_i24 v132, v131, -10, v128
    v_bfe_u32 v133, v131, 1, 1
    v_bfe_u32 v134, v132, 2, 1
    v_lshl_or_b32 v133, v133, 1, v134
    v_xor_b32 v133, v133, v130
    v_mad_u32_u24 v131, v131, s68, v135
    v_lshl_add_u32 v131, v133, 4, v131
    v_mad_u32_u24 v131, v132, s69, v131
    v_add_u32 v132, s65, v132
    v_cmp_gt_u32 vcc, 0x200, v132
    s_nop 1
    v_cndmask_b32 v3, v136, v131, vcc
    v_add_u32 v128, 16, v128
    v_mul_u32_u24 v131, 205, v128
    v_lshrrev_b32 v131, 11, v131
    v_mad_i32_i24 v132, v131, -10, v128
    v_bfe_u32 v133, v131, 1, 1
    v_bfe_u32 v134, v132, 2, 1
    v_lshl_or_b32 v133, v133, 1, v134
    v_xor_b32 v133, v133, v130
    v_mad_u32_u24 v131, v131, s68, v135
    v_lshl_add_u32 v131, v133, 4, v131
    v_mad_u32_u24 v131, v132, s69, v131
    v_add_u32 v132, s65, v132
    v_cmp_gt_u32 vcc, 0x200, v132
    s_nop 1
    v_cndmask_b32 v4, v136, v131, vcc
    v_add_u32 v128, 16, v128
    v_mul_u32_u24 v131, 205, v128
    v_lshrrev_b32 v131, 11, v131
    v_mad_i32_i24 v132, v131, -10, v128
    v_bfe_u32 v133, v131, 1, 1
    v_bfe_u32 v134, v132, 2, 1
    v_lshl_or_b32 v133, v133, 1, v134
    v_xor_b32 v133, v133, v130
    v_mad_u32_u24 v131, v131, s68, v135
    v_lshl_add_u32 v131, v133, 4, v131
    v_mad_u32_u24 v131, v132, s69, v131
    v_add_u32 v132, s65, v132
    v_cmp_gt_u32 vcc, 0x200, v132
    s_nop 1
    v_cndmask_b32 v5, v136, v131, vcc
    v_add_u32 v128, 16, v128
    v_mul_u32_u24 v131, 205, v128
    v_lshrrev_b32 v131, 11, v131
    v_mad_i32_i24 v132, v131, -10, v128
    v_bfe_u32 v133, v131, 1, 1
    v_bfe_u32 v134, v132, 2, 1
    v_lshl_or_b32 v133, v133, 1, v134
    v_xor_b32 v133, v133, v130
    v_mad_u32_u24 v131, v131, s68, v135
    v_lshl_add_u32 v131, v133, 4, v131
    v_mad_u32_u24 v131, v132, s69, v131
    v_add_u32 v132, s65, v132
    v_cmp_gt_u32 vcc, 0x200, v132
    s_nop 1
    v_cndmask_b32 v6, v136, v131, vcc
    v_lshrrev_b32 v128, 4, v129
    v_add_u32 v128, 96, v128
    v_bfe_u32 v130, v129, 2, 2
    v_mul_u32_u24 v131, 205, v128
    v_lshrrev_b32 v131, 11, v131
    v_mad_i32_i24 v132, v131, -10, v128
    v_bfe_u32 v133, v131, 1, 1
    v_bfe_u32 v134, v132, 2, 1
    v_lshl_or_b32 v133, v133, 1, v134
    v_xor_b32 v133, v133, v130
    v_mad_u32_u24 v131, v131, s68, v135
    v_lshl_add_u32 v131, v133, 4, v131
    v_mad_u32_u24 v131, v132, s69, v131
    v_add_u32 v132, s65, v132
    v_cmp_gt_u32 vcc, 0x200, v132
    v_and_b32 v133, 3, v129
    v_lshl_add_u32 v131, v133, 2, v131
    v_cndmask_b32 v7, v136, v131, vcc
    s_cmp_lt_u32 s55, 504
    s_cselect_b32 s66, 10, 0
    v_add_u32 v135, 1856, v135
    v_mad_u32_u24 v131, v129, s68, v135
    v_cmp_gt_u32 vcc, s66, v129
    s_nop 1
    v_cndmask_b32 v31, v136, v131, vcc
    v_lshrrev_b32 v138, 5, v129
    v_mul_u32_u24 v139, 1366, v0
    v_lshrrev_b32 v139, 16, v139
    v_mul_u32_u24 v139, 384, v139
    v_lshl_add_u32 v139, v0, 2, v139
    v_lshlrev_b32 v140, 3, v0
    s_lshr_b32 s71, s2, 3
    s_lshl_b32 s71, s71, 2
    s_add_u32 s71, s71, s3
    s_mul_i32 s71, s71, 640
    v_lshlrev_b32 v141, 7, v129
    v_cmp_gt_u32 vcc, 5, v129
    s_nop 1
    v_cndmask_b32 v141, v136, v141, vcc
    s_waitcnt lgkmcnt(0)
    s_mov_b32 s20, s4
    s_mov_b32 s21, s5
    s_mov_b32 s22, 50331648
    s_mov_b32 s23, 0x20000
    s_mov_b32 s28, s6
    s_mov_b32 s29, s7
    s_mov_b32 s30, 1728
    s_mov_b32 s31, 0x20000
    s_mov_b32 s36, s14
    s_mov_b32 s37, s15
    s_mov_b32 s38, 192
    s_mov_b32 s39, 0x20000
    s_mov_b32 s40, s16
    s_mov_b32 s41, s17
    s_mov_b32 s42, 192
    s_mov_b32 s43, 0x20000
    s_mov_b32 s44, s8
    s_mov_b32 s45, s9
    s_mov_b32 s46, 73728
    s_mov_b32 s47, 0x20000
    s_mov_b32 s48, s12
    s_mov_b32 s49, s13
    s_mov_b32 s50, 73728
    s_mov_b32 s51, 0x20000
    s_mov_b32 s32, s10
    s_mov_b32 s33, s11
    s_mov_b32 s34, 768
    s_mov_b32 s35, 0x20000
    buffer_load_dword v142, v141, s[44:47], s71 offen
    buffer_load_dword v143, v141, s[48:51], s71 offen
    buffer_load_dword v144, v139, s[28:31], 0 offen
    buffer_load_dword v145, v139, s[28:31], 0 offen offset:192
    buffer_load_dword v146, v139, s[28:31], 0 offen offset:384
    buffer_load_dwordx2 v[148:149], v140, s[36:39], 0 offen
    buffer_load_dwordx2 v[150:151], v140, s[40:43], 0 offen
    s_cmp_ge_u32 s3, 2
    s_cbranch_scc1 L_prep1
L_prep0:
    v_bfe_u32 v158, v129, 2, 1
    v_bfe_u32 v159, v129, 3, 2
    v_lshl_add_u32 v159, v158, 2, v159
    v_and_b32 v160, 3, v129
    v_lshl_add_u32 v236, v138, 2, v160
    s_lshl_b32 s60, s3, 7
    v_lshl_add_u32 v236, v236, 4, s60
    v_mul_u32_u24 v159, 768, v159
    v_add_u32 v232, v159, v236
    v_add_u32 v233, 6144, v232
    v_and_b32 v159, 0x1c, v129
    v_cmp_eq_u32 vcc, 0x1c, v159
    s_mov_b32 s72, 72960
    s_mul_i32 s60, s3, 24576
    s_add_u32 s60, s60, 40960
    v_cndmask_b32 v237, v136, v236, vcc
    v_lshl_add_u32 v234, v129, 4, s60
    s_lshl_b32 s60, s3, 12
    s_add_u32 s60, s60, 40960
    v_mov_b32 v238, s60
    buffer_load_dwordx4 v[176:179], v236, s[44:47], s72 offen offset:0
    buffer_load_dwordx4 a[232:235], v237, s[32:35], 0 offen offset:0
    buffer_load_dwordx4 v[180:183], v236, s[44:47], s72 offen offset:256
    buffer_load_dwordx4 a[236:239], v237, s[32:35], 0 offen offset:256
    buffer_load_dwordx4 v[184:187], v236, s[44:47], s72 offen offset:512
    buffer_load_dwordx4 a[240:243], v237, s[32:35], 0 offen offset:512
    s_add_u32 m0, s56, 0
    s_nop 0
    buffer_load_dwordx4 v1, s[20:23], 0 offen offset:0 lds
    s_add_u32 m0, s56, 1024
    s_nop 0
    buffer_load_dwordx4 v2, s[20:23], 0 offen offset:0 lds
    s_add_u32 m0, s56, 2048
    s_nop 0
    buffer_load_dwordx4 v3, s[20:23], 0 offen offset:0 lds
    s_add_u32 m0, s56, 3072
    s_nop 0
    buffer_load_dwordx4 v4, s[20:23], 0 offen offset:0 lds
    s_add_u32 m0, s56, 4096
    s_nop 0
    buffer_load_dwordx4 v5, s[20:23], 0 offen offset:0 lds
    s_add_u32 m0, s56, 5120
    s_nop 0
    buffer_load_dwordx4 v6, s[20:23], 0 offen offset:0 lds
    s_add_u32 m0, s56, 6144
    s_nop 0
    buffer_load_dword v7, s[20:23], 0 offen offset:0 lds
    v_mov_b32 v157, 268435456
    v_and_b32 v152, 15, v129
    v_lshrrev_b32 v153, 4, v129
    v_add_u32 v154, 4, v152
    v_lshrrev_b32 v154, 3, v154
    v_mad_i32_i24 v155, v154, -4, v152
    v_and_b32 v154, 1, v154
    v_and_b32 v156, 1, v153
    v_lshlrev_b32 v158, 1, v154
    v_mul_u32_u24 v159, 98304, v158
    v_mad_u32_u24 v159, v155, s69, v159
    v_lshl_add_u32 v159, v153, 4, v159
    v_add_u32 v26, s63, v159
    v_xor_b32 v161, v154, v138
    v_add_u32 v159, v153, v158
    v_add_u32 v160, 0, v155
    v_mad_u32_u24 v159, v159, 10, v160
    v_bfe_u32 v160, v160, 2, 1
    v_lshl_or_b32 v160, v161, 1, v160
    v_lshl_add_u32 v160, v159, 2, v160
    v_lshl_add_u32 v8, v160, 4, s56
    v_add_u32 v162, 1, v156
    v_add_u32 v159, v138, v158
    v_add_u32 v160, v162, v155
    v_mad_u32_u24 v159, v159, 10, v160
    v_bfe_u32 v160, v160, 2, 1
    v_lshl_or_b32 v160, v154, 1, v160
    v_lshl_add_u32 v160, v159, 2, v160
    v_lshl_add_u32 v12, v160, 4, s56
    v_xor_b32 v9, 16, v8
    v_xor_b32 v10, 32, v8
    v_xor_b32 v11, 48, v8
    v_xor_b32 v13, 16, v12
    v_xor_b32 v14, 32, v12
    v_xor_b32 v15, 48, v12
    v_add_u32 v159, 1, v158
    v_add_u32 v160, 1, v155
    v_mad_u32_u24 v159, v159, 10, v160
    v_bfe_u32 v160, v160, 2, 1
    v_lshl_or_b32 v160, v154, 1, v160
    v_xor_b32 v160, v153, v160
    v_lshl_add_u32 v160, v159, 2, v160
    v_lshl_add_u32 v20, v160, 4, s56
    v_xor_b32 v21, 32, v20
    v_add_u32 v21, 640, v21
    v_bfe_u32 v158, v152, 2, 1
    v_sub_u32 v158, v153, v158
    v_and_b32 v159, 3, v152
    v_mul_u32_u24 v16, 0x1111, v159
    v_lshrrev_b32 v160, 3, v152
    v_lshl_add_u32 v159, v160, 2, v159
    v_lshlrev_b32 v159, 5, v159
    v_add_u32 v159, 141312, v159
    s_movk_i32 s70, 3072
    v_cmp_gt_u32 vcc, 3, v158
    v_mad_u32_u24 v159, v158, s70, v159
    s_nop 0
    v_cndmask_b32 v22, v157, v159, vcc
    v_lshlrev_b32 v23, 4, v129
    v_add_u32 v24, 40960, v23
    v_lshlrev_b32 v25, 5, v153
    v_add_u32 v25, 150528, v25
    v_and_b32 v160, 1, v129
    v_lshlrev_b32 v160, 4, v160
    v_mov_b32 v161, 0x3f80
    v_lshlrev_b32 v160, v160, v161
    v_bfe_u32 v158, v129, 1, 1
    v_bfe_u32 v159, v129, 3, 2
    v_lshl_add_u32 v159, v159, 1, v158
    v_bfe_u32 v161, v129, 2, 1
    v_xor_b32 v161, v161, v138
    v_lshl_add_u32 v159, v161, 3, v159
    v_lshlrev_b32 v159, v159, 1
    v_lshrrev_b32 v161, 2, v152
    v_xor_b32 v161, v161, v153
    v_lshl_add_u32 v158, v161, 1, v158
    v_lshlrev_b32 v158, v158, 1
    v_bfe_i32 v240, v159, 0, 1
    v_bfe_i32 v241, v159, 1, 1
    v_bfe_i32 v242, v159, 2, 1
    v_bfe_i32 v243, v159, 3, 1
    v_bfe_i32 v244, v159, 4, 1
    v_bfe_i32 v245, v159, 5, 1
    v_bfe_i32 v246, v159, 6, 1
    v_bfe_i32 v247, v159, 7, 1
    v_bfe_i32 v18, v158, 0, 1
    v_bfe_i32 v19, v158, 1, 1
    v_and_b32 v240, v160, v240
    v_and_b32 v241, v160, v241
    v_and_b32 v242, v160, v242
    v_and_b32 v243, v160, v243
    v_and_b32 v244, v160, v244
    v_and_b32 v245, v160, v245
    v_and_b32 v246, v160, v246
    v_and_b32 v247, v160, v247
    v_and_b32 v18, v160, v18
    v_and_b32 v19, v160, v19
    s_mov_b32 s24, s18
    s_mov_b32 s25, s19
    s_mov_b32 s26, 50331648
    s_mov_b32 s27, 0x20000
    s_mov_b32 s52, 0
    s_mov_b32 s80, 0
    s_mov_b32 s81, 98304
    s_mov_b32 s82, 393216
    s_mov_b32 s83, 491520
    s_mov_b32 s53, 1156138217
    s_mov_b32 s58, 0x3c003c00
    s_mov_b32 s85, 150912
    s_mov_b32 s86, 0x37803780
    s_mov_b32 s84, 0x37800000
    v_lshlrev_b32 v17, 4, v138
    v_lshrrev_b32 v17, v17, -1
    s_mov_b32 s73, 0x409d2a01
    s_mov_b32 s59, 0x3ef00000
    v_mul_u32_u24 v252, 0x100010, v0
    v_add_u32 v252, 0xc0004, v252
    v_lshlrev_b32 v253, 2, v0
    v_add_u32 v253, 150912, v253
    v_add_u32 v160, 0x0, v252
    v_add_u32 v168, 0x10001000, v252
    v_cvt_f32_f16 v161, v160
    v_cvt_f32_f16 v169, v168
    v_cvt_f32_f16_sdwa v162, v160 dst_sel:DWORD dst_unused:UNUSED_PAD src0_sel:WORD_1
    v_cvt_f32_f16_sdwa v170, v168 dst_sel:DWORD dst_unused:UNUSED_PAD src0_sel:WORD_1
    v_mul_f32 v163, 0x3f7fdde7, v161
    v_mul_f32 v171, 0x3f7fdde7, v169
    v_mul_f32 v164, 0x3f7fdde7, v162
    v_mul_f32 v172, 0x3f7fdde7, v170
    v_fma_f32 v163, v163, v161, s73
    v_fma_f32 v171, v171, v169, s73
    v_fma_f32 v164, v164, v162, s73
    v_fma_f32 v172, v172, v170, s73
    v_mul_f32 v163, -v161, v163
    v_mul_f32 v171, -v169, v171
    v_mul_f32 v164, -v162, v164
    v_mul_f32 v172, -v170, v172
    v_exp_f32 v165, v163
    v_exp_f32 v173, v171
    v_exp_f32 v166, v164
    v_exp_f32 v174, v172
    v_fma_f32 v163, v165, s59, s59
    v_fma_f32 v171, v173, s59, s59
    v_fma_f32 v164, v166, s59, s59
    v_fma_f32 v172, v174, s59, s59
    v_rcp_f32 v163, v163
    v_rcp_f32 v171, v171
    v_rcp_f32 v164, v164
    v_rcp_f32 v172, v172
    v_mul_f32 v163, v161, v163
    v_mul_f32 v171, v169, v171
    v_mul_f32 v164, v162, v164
    v_mul_f32 v172, v170, v172
    v_mul_f32 v165, -v165, v163
    v_mul_f32 v173, -v173, v171
    v_mul_f32 v166, -v166, v164
    v_mul_f32 v174, -v174, v172
    v_cvt_pk_bf16_f32 v167, v165, v166
    v_cvt_pk_bf16_f32 v175, v173, v174
    v_cvt_pk_bf16_f32 v160, v163, v164
    v_cvt_pk_bf16_f32 v168, v171, v172
    ds_write_b32 v253, v167 offset:8192
    ds_write_b32 v253, v160 offset:0
    ds_write_b32 v253, v175 offset:9216
    ds_write_b32 v253, v168 offset:1024
    v_add_u32 v160, 0x20002000, v252
    s_nop 0
    v_add_u32 v168, 0x30003000, v252
    v_cvt_f32_f16 v161, v160
    v_cvt_f32_f16 v169, v168
    v_cvt_f32_f16_sdwa v162, v160 dst_sel:DWORD dst_unused:UNUSED_PAD src0_sel:WORD_1
    v_cvt_f32_f16_sdwa v170, v168 dst_sel:DWORD dst_unused:UNUSED_PAD src0_sel:WORD_1
    v_mul_f32 v163, 0x3f7fdde7, v161
    v_mul_f32 v171, 0x3f7fdde7, v169
    v_mul_f32 v164, 0x3f7fdde7, v162
    v_mul_f32 v172, 0x3f7fdde7, v170
    v_fma_f32 v163, v163, v161, s73
    v_fma_f32 v171, v171, v169, s73
    v_fma_f32 v164, v164, v162, s73
    v_fma_f32 v172, v172, v170, s73
    v_mul_f32 v163, -v161, v163
    v_mul_f32 v171, -v169, v171
    v_mul_f32 v164, -v162, v164
    v_mul_f32 v172, -v170, v172
    v_exp_f32 v165, v163
    v_exp_f32 v173, v171
    v_exp_f32 v166, v164
    v_exp_f32 v174, v172
    v_fma_f32 v163, v165, s59, s59
    v_fma_f32 v171, v173, s59, s59
    v_fma_f32 v164, v166, s59, s59
    v_fma_f32 v172, v174, s59, s59
    v_rcp_f32 v163, v163
    v_rcp_f32 v171, v171
    v_rcp_f32 v164, v164
    v_rcp_f32 v172, v172
    v_mul_f32 v163, v161, v163
    v_mul_f32 v171, v169, v171
    v_mul_f32 v164, v162, v164
    v_mul_f32 v172, v170, v172
    v_mul_f32 v165, -v165, v163
    v_mul_f32 v173, -v173, v171
    v_mul_f32 v166, -v166, v164
    v_mul_f32 v174, -v174, v172
    v_cvt_pk_bf16_f32 v167, v165, v166
    v_cvt_pk_bf16_f32 v175, v173, v174
    v_cvt_pk_bf16_f32 v160, v163, v164
    v_cvt_pk_bf16_f32 v168, v171, v172
    ds_write_b32 v253, v167 offset:10240
    ds_write_b32 v253, v160 offset:2048
    ds_write_b32 v253, v175 offset:11264
    ds_write_b32 v253, v168 offset:3072
    v_add_u32 v160, 0x40004000, v252
    s_nop 0
    v_add_u32 v168, 0x50005000, v252
    v_cvt_f32_f16 v161, v160
    v_cvt_f32_f16 v169, v168
    v_cvt_f32_f16_sdwa v162, v160 dst_sel:DWORD dst_unused:UNUSED_PAD src0_sel:WORD_1
    v_cvt_f32_f16_sdwa v170, v168 dst_sel:DWORD dst_unused:UNUSED_PAD src0_sel:WORD_1
    v_mul_f32 v163, 0x3f7fdde7, v161
    v_mul_f32 v171, 0x40088889, v169
    v_mul_f32 v164, 0x3f7fdde7, v162
    v_mul_f32 v172, 0x40088889, v170
    v_fma_f32 v163, v163, v161, s73
    v_cvt_pk_bf16_f32 v168, v171, v172
    v_fma_f32 v164, v164, v162, s73
    v_mul_f32 v163, -v161, v163
    v_mul_f32 v164, -v162, v164
    v_exp_f32 v165, v163
    v_exp_f32 v166, v164
    v_fma_f32 v163, v165, s59, s59
    v_fma_f32 v164, v166, s59, s59
    v_rcp_f32 v163, v163
    v_rcp_f32 v164, v164
    v_mul_f32 v163, v161, v163
    v_mul_f32 v164, v162, v164
    v_mul_f32 v165, -v165, v163
    v_mul_f32 v166, -v166, v164
    v_cvt_pk_bf16_f32 v167, v165, v166
    v_cvt_pk_bf16_f32 v160, v163, v164
    ds_write_b32 v253, v167 offset:12288
    ds_write_b32 v253, v160 offset:4096
    ds_write_b32 v253, v168 offset:5120
    s_nop 0
    v_add_u32 v160, 0x60006000, v252
    v_add_u32 v168, 0x70007000, v252
    v_cvt_f32_f16 v161, v160
    v_cvt_f32_f16 v169, v168
    v_cvt_f32_f16_sdwa v162, v160 dst_sel:DWORD dst_unused:UNUSED_PAD src0_sel:WORD_1
    v_cvt_f32_f16_sdwa v170, v168 dst_sel:DWORD dst_unused:UNUSED_PAD src0_sel:WORD_1
    v_mul_f32 v163, 0x40088889, v161
    v_mul_f32 v171, 0x40088889, v169
    v_mul_f32 v164, 0x40088889, v162
    v_mul_f32 v172, 0x40088889, v170
    v_cvt_pk_bf16_f32 v160, v163, v164
    v_cvt_pk_bf16_f32 v168, v171, v172
    ds_write_b32 v253, v160 offset:6144
    ds_write_b32 v253, v168 offset:7168
    v_lshlrev_b32 v158, 6, v0
    v_add_u32 v158, 141312, v158
    v_cmp_gt_u32 vcc, 144, v0
    s_nop 1
    v_cndmask_b32 v158, v157, v158, vcc
    v_and_b32 v159, 3, v0
    v_lshl_add_u32 v160, v159, 2, v158
    v_lshrrev_b32 v159, 1, v159
    v_lshl_add_u32 v159, v159, 2, v158
    v_lshlrev_b32 v161, 4, v0
    v_add_u32 v161, 150528, v161
    v_cmp_gt_u32 vcc, 24, v0
    s_nop 1
    v_cndmask_b32 v161, v157, v161, vcc
    v_mov_b32 v164, 0
    v_mov_b32 v165, 0
    v_mov_b32 v166, 0
    v_mov_b32 v167, 0
    ds_write_b128 v158, v[164:167]
    ds_write_b128 v158, v[164:167] offset:16
    s_waitcnt lgkmcnt(9)
    ds_write_b128 v158, v[164:167] offset:32
    ds_write_b128 v158, v[164:167] offset:48
    s_waitcnt vmcnt(17)
    ds_write_b16 v160, v144
    ds_write_b16_d16_hi v160, v144 offset:34
    s_waitcnt vmcnt(16)
    ds_write_b16 v159, v145 offset:16
    ds_write_b16_d16_hi v159, v145 offset:48
    s_waitcnt vmcnt(15) lgkmcnt(13)
    ds_write_b16 v159, v146 offset:24
    ds_write_b16_d16_hi v159, v146 offset:56
    s_waitcnt vmcnt(14)
    v_lshlrev_b32 v168, 16, v148
    v_and_b32 v169, 0xffff0000, v148
    v_lshlrev_b32 v170, 16, v149
    v_and_b32 v171, 0xffff0000, v149
    s_waitcnt vmcnt(13)
    v_lshlrev_b32 v172, 16, v150
    v_and_b32 v173, 0xffff0000, v150
    v_lshlrev_b32 v174, 16, v151
    v_and_b32 v175, 0xffff0000, v151
    v_mul_f32 v168, v168, v172
    v_mul_f32 v169, v169, v173
    v_mul_f32 v170, v170, v174
    v_mul_f32 v171, v171, v175
    s_waitcnt lgkmcnt(14)
    ds_write_b128 v161, v[168:171]
    s_waitcnt vmcnt(12)
    v_xor_b32 v176, 0x80008000, v176
    v_xor_b32 v177, 0x80008000, v177
    v_xor_b32 v178, 0x80008000, v178
    v_xor_b32 v179, 0x80008000, v179
    s_nop 1
    v_mfma_f32_32x32x16_bf16 v[208:223], v[176:179], v[240:243], 0
    v_mfma_f32_32x32x16_bf16 v[208:223], v[176:179], v[244:247], v[208:223]
    s_waitcnt vmcnt(10)
    v_xor_b32 v180, 0x80008000, v180
    v_xor_b32 v181, 0x80008000, v181
    v_xor_b32 v182, 0x80008000, v182
    v_xor_b32 v183, 0x80008000, v183
    s_nop 1
    v_mfma_f32_32x32x16_bf16 v[192:207], v[180:183], v[240:243], 0
    v_mfma_f32_32x32x16_bf16 v[192:207], v[180:183], v[244:247], v[192:207]
    s_mov_b32 s74, 0
    s_mov_b32 s75, 12288
    buffer_load_dwordx4 a[0:3], v232, s[44:47], s74 offen offset:0
    buffer_load_dwordx4 a[4:7], v232, s[44:47], s75 offen offset:0
    buffer_load_dwordx4 a[8:11], v233, s[44:47], s74 offen offset:0
    buffer_load_dwordx4 a[12:15], v233, s[44:47], s75 offen offset:0
    s_mov_b32 s74, 24576
    s_mov_b32 s75, 36864
    buffer_load_dwordx4 a[16:19], v232, s[44:47], s74 offen offset:0
    buffer_load_dwordx4 a[20:23], v232, s[44:47], s75 offen offset:0
    buffer_load_dwordx4 a[24:27], v233, s[44:47], s74 offen offset:0
    buffer_load_dwordx4 a[28:31], v233, s[44:47], s75 offen offset:0
    s_mov_b32 s74, 49152
    s_mov_b32 s75, 61440
    buffer_load_dwordx4 a[32:35], v232, s[44:47], s74 offen offset:0
    buffer_load_dwordx4 a[36:39], v232, s[44:47], s75 offen offset:0
    buffer_load_dwordx4 a[40:43], v233, s[44:47], s74 offen offset:0
    buffer_load_dwordx4 a[44:47], v233, s[44:47], s75 offen offset:0
    s_mov_b32 s74, 0
    s_mov_b32 s75, 12288
    buffer_load_dwordx4 a[48:51], v232, s[44:47], s74 offen offset:256
    buffer_load_dwordx4 a[52:55], v232, s[44:47], s75 offen offset:256
    buffer_load_dwordx4 a[56:59], v233, s[44:47], s74 offen offset:256
    buffer_load_dwordx4 a[60:63], v233, s[44:47], s75 offen offset:256
    s_mov_b32 s74, 24576
    s_mov_b32 s75, 36864
    buffer_load_dwordx4 a[64:67], v232, s[44:47], s74 offen offset:256
    buffer_load_dwordx4 a[68:71], v232, s[44:47], s75 offen offset:256
    buffer_load_dwordx4 a[72:75], v233, s[44:47], s74 offen offset:256
    buffer_load_dwordx4 a[76:79], v233, s[44:47], s75 offen offset:256
    s_mov_b32 s74, 49152
    s_mov_b32 s75, 61440
    buffer_load_dwordx4 a[80:83], v232, s[44:47], s74 offen offset:256
    buffer_load_dwordx4 a[84:87], v232, s[44:47], s75 offen offset:256
    buffer_load_dwordx4 a[88:91], v233, s[44:47], s74 offen offset:256
    buffer_load_dwordx4 a[92:95], v233, s[44:47], s75 offen offset:256
    s_waitcnt vmcnt(23)
    v_mfma_f32_32x32x16_bf16 v[80:95], a[0:3], v[240:243], v[208:223]
    s_waitcnt vmcnt(21)
    v_mfma_f32_32x32x16_bf16 v[96:111], a[8:11], v[240:243], v[208:223]
    v_mfma_f32_32x32x16_bf16 v[80:95], a[4:7], v[244:247], v[80:95]
    s_waitcnt vmcnt(20)
    v_mfma_f32_32x32x16_bf16 v[96:111], a[12:15], v[244:247], v[96:111]
    s_waitcnt vmcnt(19)
    v_mfma_f32_32x32x16_bf16 v[112:127], a[16:19], v[240:243], v[208:223]
    s_waitcnt vmcnt(17)
    v_mfma_f32_32x32x16_bf16 v[128:143], a[24:27], v[240:243], v[208:223]
    v_mfma_f32_32x32x16_bf16 v[112:127], a[20:23], v[244:247], v[112:127]
    s_waitcnt vmcnt(16)
    v_mfma_f32_32x32x16_bf16 v[128:143], a[28:31], v[244:247], v[128:143]
    s_nop 2
    v_cvt_pk_f16_f32 v224, v80, v84
    v_cvt_pk_f16_f32 v225, v88, v92
    v_cvt_pk_f16_f32 v226, v96, v100
    v_cvt_pk_f16_f32 v227, v104, v108
    s_waitcnt vmcnt(15)
    v_mfma_f32_32x32x16_bf16 v[144:159], a[32:35], v[240:243], v[208:223]
    s_waitcnt lgkmcnt(14)
    ds_write_b128 v234, v[224:227] offset:0
    s_mov_b32 s74, 0
    v_cvt_pk_f16_f32 v228, v81, v85
    v_cvt_pk_f16_f32 v229, v89, v93
    v_cvt_pk_f16_f32 v230, v97, v101
    v_cvt_pk_f16_f32 v231, v105, v109
    s_waitcnt vmcnt(13)
    v_mfma_f32_32x32x16_bf16 v[160:175], a[40:43], v[240:243], v[208:223]
    s_waitcnt lgkmcnt(14)
    ds_write_b128 v234, v[228:231] offset:1024
    s_mov_b32 s75, 12288
    buffer_load_dwordx4 v[32:35], v232, s[44:47], s74 offen offset:512
    v_cvt_pk_f16_f32 v224, v82, v86
    v_cvt_pk_f16_f32 v225, v90, v94
    v_cvt_pk_f16_f32 v226, v98, v102
    v_cvt_pk_f16_f32 v227, v106, v110
    v_mfma_f32_32x32x16_bf16 v[144:159], a[36:39], v[244:247], v[144:159]
    s_waitcnt lgkmcnt(14)
    ds_write_b128 v234, v[224:227] offset:12288
    buffer_load_dwordx4 v[36:39], v232, s[44:47], s75 offen offset:512
    v_cvt_pk_f16_f32 v228, v83, v87
    v_cvt_pk_f16_f32 v229, v91, v95
    v_cvt_pk_f16_f32 v230, v99, v103
    v_cvt_pk_f16_f32 v231, v107, v111
    s_waitcnt vmcnt(14)
    v_mfma_f32_32x32x16_bf16 v[160:175], a[44:47], v[244:247], v[160:175]
    s_waitcnt vmcnt(10)
    s_waitcnt lgkmcnt(14)
    ds_write_b128 v234, v[228:231] offset:13312
    buffer_load_dwordx4 v[40:43], v233, s[44:47], s74 offen offset:512
    buffer_load_dwordx4 v[44:47], v233, s[44:47], s75 offen offset:512
    v_mfma_f32_32x32x16_bf16 v[160:175], a[232:235], v[244:247], v[160:175]
    v_cvt_pk_f16_f32 v224, v112, v116
    v_cvt_pk_f16_f32 v225, v120, v124
    v_cvt_pk_f16_f32 v226, v128, v132
    v_cvt_pk_f16_f32 v227, v136, v140
    v_mfma_f32_32x32x16_bf16 v[80:95], a[48:51], v[240:243], v[192:207]
    s_waitcnt lgkmcnt(14)
    ds_write_b128 v234, v[224:227] offset:2048
    s_mov_b32 s74, 24576
    v_cvt_pk_f16_f32 v228, v113, v117
    v_cvt_pk_f16_f32 v229, v121, v125
    v_cvt_pk_f16_f32 v230, v129, v133
    v_cvt_pk_f16_f32 v231, v137, v141
    v_mfma_f32_32x32x16_bf16 v[96:111], a[56:59], v[240:243], v[192:207]
    s_waitcnt lgkmcnt(14)
    ds_write_b128 v234, v[228:231] offset:3072
    s_mov_b32 s75, 36864
    buffer_load_dwordx4 v[48:51], v232, s[44:47], s74 offen offset:512
    v_cvt_pk_f16_f32 v224, v114, v118
    v_cvt_pk_f16_f32 v225, v122, v126
    v_cvt_pk_f16_f32 v226, v130, v134
    v_cvt_pk_f16_f32 v227, v138, v142
    v_mfma_f32_32x32x16_bf16 v[80:95], a[52:55], v[244:247], v[80:95]
    s_waitcnt lgkmcnt(14)
    ds_write_b128 v234, v[224:227] offset:14336
    buffer_load_dwordx4 v[52:55], v232, s[44:47], s75 offen offset:512
    v_cvt_pk_f16_f32 v228, v115, v119
    v_cvt_pk_f16_f32 v229, v123, v127
    v_cvt_pk_f16_f32 v230, v131, v135
    v_cvt_pk_f16_f32 v231, v139, v143
    v_mfma_f32_32x32x16_bf16 v[96:111], a[60:63], v[244:247], v[96:111]
    s_waitcnt vmcnt(10)
    s_waitcnt lgkmcnt(14)
    ds_write_b128 v234, v[228:231] offset:15360
    buffer_load_dwordx4 v[56:59], v233, s[44:47], s74 offen offset:512
    buffer_load_dwordx4 v[60:63], v233, s[44:47], s75 offen offset:512
    v_xor_b32 v184, 0x80008000, v184
    v_xor_b32 v185, 0x80008000, v185
    v_xor_b32 v186, 0x80008000, v186
    v_xor_b32 v187, 0x80008000, v187
    v_cvt_pk_f16_f32 v224, v144, v148
    v_cvt_pk_f16_f32 v225, v152, v156
    v_cvt_pk_f16_f32 v226, v160, v164
    v_cvt_pk_f16_f32 v227, v168, v172
    v_mfma_f32_32x32x16_bf16 v[112:127], a[64:67], v[240:243], v[192:207]
    s_waitcnt lgkmcnt(14)
    ds_write_b128 v234, v[224:227] offset:4096
    s_mov_b32 s74, 49152
    v_cvt_pk_f16_f32 v228, v145, v149
    v_cvt_pk_f16_f32 v229, v153, v157
    v_cvt_pk_f16_f32 v230, v161, v165
    v_cvt_pk_f16_f32 v231, v169, v173
    v_mfma_f32_32x32x16_bf16 v[128:143], a[72:75], v[240:243], v[192:207]
    s_waitcnt lgkmcnt(14)
    ds_write_b128 v234, v[228:231] offset:5120
    s_mov_b32 s75, 61440
    buffer_load_dwordx4 v[64:67], v232, s[44:47], s74 offen offset:512
    v_cvt_pk_f16_f32 v224, v146, v150
    v_cvt_pk_f16_f32 v225, v154, v158
    v_cvt_pk_f16_f32 v226, v162, v166
    v_cvt_pk_f16_f32 v227, v170, v174
    v_mfma_f32_32x32x16_bf16 v[112:127], a[68:71], v[244:247], v[112:127]
    s_waitcnt lgkmcnt(14)
    ds_write_b128 v234, v[224:227] offset:16384
    buffer_load_dwordx4 v[68:71], v232, s[44:47], s75 offen offset:512
    v_cvt_pk_f16_f32 v228, v147, v151
    v_cvt_pk_f16_f32 v229, v155, v159
    v_cvt_pk_f16_f32 v230, v163, v167
    v_cvt_pk_f16_f32 v231, v171, v175
    v_mfma_f32_32x32x16_bf16 v[128:143], a[76:79], v[244:247], v[128:143]
    s_waitcnt vmcnt(10)
    s_waitcnt lgkmcnt(14)
    ds_write_b128 v234, v[228:231] offset:17408
    buffer_load_dwordx4 v[72:75], v233, s[44:47], s74 offen offset:512
    buffer_load_dwordx4 v[76:79], v233, s[44:47], s75 offen offset:512
    v_sub_u32 v234, v234, v238
    v_mfma_f32_32x32x16_bf16 v[208:223], v[184:187], v[240:243], 0
    v_mfma_f32_32x32x16_bf16 v[208:223], v[184:187], v[244:247], v[208:223]
    v_cvt_pk_f16_f32 v224, v80, v84
    v_cvt_pk_f16_f32 v225, v88, v92
    v_cvt_pk_f16_f32 v226, v96, v100
    v_cvt_pk_f16_f32 v227, v104, v108
    v_mfma_f32_32x32x16_bf16 v[144:159], a[80:83], v[240:243], v[192:207]
    s_waitcnt lgkmcnt(14)
    ds_write_b128 v234, v[224:227] offset:0
    s_add_u32 m0, s56, 6336
    s_nop 0
    buffer_load_dwordx4 v1, s[20:23], 0 offen offset:64 lds
    v_cvt_pk_f16_f32 v228, v81, v85
    v_cvt_pk_f16_f32 v229, v89, v93
    v_cvt_pk_f16_f32 v230, v97, v101
    v_cvt_pk_f16_f32 v231, v105, v109
    v_mfma_f32_32x32x16_bf16 v[160:175], a[88:91], v[240:243], v[192:207]
    s_waitcnt lgkmcnt(14)
    ds_write_b128 v234, v[228:231] offset:1024
    s_add_u32 m0, s56, 7360
    s_nop 0
    buffer_load_dwordx4 v2, s[20:23], 0 offen offset:64 lds
    v_cvt_pk_f16_f32 v224, v82, v86
    v_cvt_pk_f16_f32 v225, v90, v94
    v_cvt_pk_f16_f32 v226, v98, v102
    v_cvt_pk_f16_f32 v227, v106, v110
    v_mfma_f32_32x32x16_bf16 v[144:159], a[84:87], v[244:247], v[144:159]
    s_waitcnt lgkmcnt(14)
    ds_write_b128 v234, v[224:227] offset:10240
    s_add_u32 m0, s56, 8384
    s_nop 0
    buffer_load_dwordx4 v3, s[20:23], 0 offen offset:64 lds
    v_cvt_pk_f16_f32 v228, v83, v87
    v_cvt_pk_f16_f32 v229, v91, v95
    v_cvt_pk_f16_f32 v230, v99, v103
    v_cvt_pk_f16_f32 v231, v107, v111
    v_mfma_f32_32x32x16_bf16 v[160:175], a[92:95], v[244:247], v[160:175]
    s_waitcnt vmcnt(11)
    s_waitcnt lgkmcnt(14)
    ds_write_b128 v234, v[228:231] offset:11264
    s_add_u32 m0, s56, 9408
    s_nop 0
    buffer_load_dwordx4 v4, s[20:23], 0 offen offset:64 lds
    v_mfma_f32_32x32x16_bf16 v[160:175], a[236:239], v[244:247], v[160:175]
    v_cvt_pk_f16_f32 v224, v112, v116
    v_cvt_pk_f16_f32 v225, v120, v124
    v_cvt_pk_f16_f32 v226, v128, v132
    v_cvt_pk_f16_f32 v227, v136, v140
    v_mfma_f32_32x32x16_bf16 v[80:95], v[32:35], v[240:243], v[208:223]
    s_waitcnt lgkmcnt(0)
    s_barrier
    ds_write_b128 v234, v[224:227] offset:2048
    ds_read_b128 a[0:3], v24 offset:0
    ds_read_b128 a[4:7], v24 offset:1024
    ds_read_b128 a[8:11], v24 offset:2048
    ds_read_b128 a[12:15], v24 offset:3072
    ds_read_b128 a[16:19], v24 offset:4096
    ds_read_b128 a[20:23], v24 offset:5120
    s_add_u32 m0, s56, 10432
    v_cvt_pk_f16_f32 v228, v113, v117
    v_cvt_pk_f16_f32 v229, v121, v125
    v_cvt_pk_f16_f32 v230, v129, v133
    v_cvt_pk_f16_f32 v231, v137, v141
    v_mfma_f32_32x32x16_bf16 v[96:111], v[40:43], v[240:243], v[208:223]
    ds_write_b128 v234, v[228:231] offset:3072
    ds_read_b128 a[24:27], v24 offset:6144
    ds_read_b128 a[28:31], v24 offset:7168
    ds_read_b128 a[32:35], v24 offset:8192
    ds_read_b128 a[36:39], v24 offset:9216
    ds_read_b128 a[40:43], v24 offset:10240
    ds_read_b128 a[44:47], v24 offset:11264
    buffer_load_dwordx4 v5, s[20:23], 0 offen offset:64 lds
    s_add_u32 m0, s56, 11456
    v_cvt_pk_f16_f32 v224, v114, v118
    v_cvt_pk_f16_f32 v225, v122, v126
    v_cvt_pk_f16_f32 v226, v130, v134
    v_cvt_pk_f16_f32 v227, v138, v142
    v_mfma_f32_32x32x16_bf16 v[80:95], v[36:39], v[244:247], v[80:95]
    ds_write_b128 v234, v[224:227] offset:12288
    s_waitcnt lgkmcnt(9)
    ds_read_b128 a[96:99], v24 offset:24576
    ds_read_b128 a[100:103], v24 offset:25600
    ds_read_b128 a[104:107], v24 offset:26624
    ds_read_b128 a[108:111], v24 offset:27648
    ds_read_b128 a[112:115], v24 offset:28672
    ds_read_b128 a[116:119], v24 offset:29696
    buffer_load_dwordx4 v6, s[20:23], 0 offen offset:64 lds
    s_add_u32 m0, s56, 12480
    v_cvt_pk_f16_f32 v228, v115, v119
    v_cvt_pk_f16_f32 v229, v123, v127
    v_cvt_pk_f16_f32 v230, v131, v135
    v_cvt_pk_f16_f32 v231, v139, v143
    v_mfma_f32_32x32x16_bf16 v[96:111], v[44:47], v[244:247], v[96:111]
    s_waitcnt vmcnt(10)
    s_waitcnt lgkmcnt(9)
    ds_write_b128 v234, v[228:231] offset:13312
    ds_read_b128 a[120:123], v24 offset:30720
    ds_read_b128 a[124:127], v24 offset:31744
    ds_read_b128 a[128:131], v24 offset:32768
    ds_read_b128 a[132:135], v24 offset:33792
    ds_read_b128 a[136:139], v24 offset:34816
    s_waitcnt lgkmcnt(14)
    ds_read_b128 a[140:143], v24 offset:35840
    buffer_load_dword v7, s[20:23], 0 offen offset:64 lds
    buffer_load_dword v254, v31, s[20:23], 0 offen
    v_cvt_pk_f16_f32 v224, v144, v148
    v_cvt_pk_f16_f32 v225, v152, v156
    v_cvt_pk_f16_f32 v226, v160, v164
    v_cvt_pk_f16_f32 v227, v168, v172
    v_mfma_f32_32x32x16_bf16 v[112:127], v[48:51], v[240:243], v[208:223]
    s_waitcnt lgkmcnt(9)
    ds_write_b128 v234, v[224:227] offset:4096
    ds_read_b128 a[144:147], v24 offset:36864
    ds_read_b128 a[148:151], v24 offset:37888
    ds_read_b128 a[152:155], v24 offset:38912
    ds_read_b128 a[156:159], v24 offset:39936
    ds_read_b128 a[160:163], v24 offset:40960
    s_waitcnt lgkmcnt(14)
    ds_read_b128 a[164:167], v24 offset:41984
    v_cvt_pk_f16_f32 v228, v145, v149
    v_cvt_pk_f16_f32 v229, v153, v157
    v_cvt_pk_f16_f32 v230, v161, v165
    v_cvt_pk_f16_f32 v231, v169, v173
    v_mfma_f32_32x32x16_bf16 v[128:143], v[56:59], v[240:243], v[208:223]
    s_waitcnt lgkmcnt(9)
    ds_write_b128 v234, v[228:231] offset:5120
    ds_read_b128 a[168:171], v24 offset:43008
    ds_read_b128 a[172:175], v24 offset:44032
    ds_read_b128 a[176:179], v24 offset:45056
    ds_read_b128 a[180:183], v24 offset:46080
    ds_read_b128 a[184:187], v24 offset:47104
    s_waitcnt lgkmcnt(14)
    ds_read_b128 a[188:191], v24 offset:48128
    v_cvt_pk_f16_f32 v224, v146, v150
    v_cvt_pk_f16_f32 v225, v154, v158
    v_cvt_pk_f16_f32 v226, v162, v166
    v_cvt_pk_f16_f32 v227, v170, v174
    v_mfma_f32_32x32x16_bf16 v[112:127], v[52:55], v[244:247], v[112:127]
    s_waitcnt lgkmcnt(9)
    ds_write_b128 v234, v[224:227] offset:14336
    ds_read_b128 a[192:195], v23 offset:0
    ds_read_b128 a[196:199], v23 offset:1024
    ds_read_b128 a[200:203], v23 offset:10240
    ds_read_b128 a[204:207], v23 offset:11264
    ds_read_b128 a[208:211], v23 offset:20480
    s_waitcnt lgkmcnt(14)
    ds_read_b128 a[212:215], v23 offset:21504
    v_cvt_pk_f16_f32 v228, v147, v151
    v_cvt_pk_f16_f32 v229, v155, v159
    v_cvt_pk_f16_f32 v230, v163, v167
    v_cvt_pk_f16_f32 v231, v171, v175
    v_mfma_f32_32x32x16_bf16 v[128:143], v[60:63], v[244:247], v[128:143]
    s_waitcnt vmcnt(8)
    s_waitcnt lgkmcnt(9)
    ds_write_b128 v234, v[228:231] offset:15360
    ds_read_b128 a[216:219], v23 offset:30720
    ds_read_b128 a[220:223], v23 offset:31744
    ds_read_b128 a[48:51], v24 offset:12288
    ds_read_b128 a[52:55], v24 offset:13312
    ds_read_b128 a[56:59], v24 offset:14336
    s_waitcnt lgkmcnt(14)
    ds_read_b128 a[60:63], v24 offset:15360
    v_add_u32 v234, v234, v238
    v_cvt_pk_f16_f32 v224, v80, v84
    v_cvt_pk_f16_f32 v225, v88, v92
    v_cvt_pk_f16_f32 v226, v96, v100
    v_cvt_pk_f16_f32 v227, v104, v108
    v_mfma_f32_32x32x16_bf16 v[144:159], v[64:67], v[240:243], v[208:223]
    s_waitcnt lgkmcnt(9)
    ds_read_b128 a[64:67], v24 offset:16384
    ds_read_b128 a[68:71], v24 offset:17408
    ds_read_b128 a[72:75], v24 offset:18432
    ds_read_b128 a[76:79], v24 offset:19456
    ds_read_b128 a[80:83], v24 offset:20480
    ds_read_b128 a[84:87], v24 offset:21504
    s_waitcnt lgkmcnt(13)
    ds_read_b128 a[88:91], v24 offset:22528
    ds_read_b128 a[92:95], v24 offset:23552
    s_waitcnt lgkmcnt(0)
    s_barrier
    ds_write_b128 v234, v[224:227] offset:0
    v_cvt_pk_f16_f32 v228, v81, v85
    v_cvt_pk_f16_f32 v229, v89, v93
    v_cvt_pk_f16_f32 v230, v97, v101
    v_cvt_pk_f16_f32 v231, v105, v109
    v_mfma_f32_32x32x16_bf16 v[160:175], v[72:75], v[240:243], v[208:223]
    ds_write_b128 v234, v[228:231] offset:1024
    v_cvt_pk_f16_f32 v224, v82, v86
    v_cvt_pk_f16_f32 v225, v90, v94
    v_cvt_pk_f16_f32 v226, v98, v102
    v_cvt_pk_f16_f32 v227, v106, v110
    v_mfma_f32_32x32x16_bf16 v[144:159], v[68:71], v[244:247], v[144:159]
    ds_write_b128 v234, v[224:227] offset:12288
    v_cvt_pk_f16_f32 v228, v83, v87
    v_cvt_pk_f16_f32 v229, v91, v95
    v_cvt_pk_f16_f32 v230, v99, v103
    v_cvt_pk_f16_f32 v231, v107, v111
    v_mfma_f32_32x32x16_bf16 v[160:175], v[76:79], v[244:247], v[160:175]
    ds_write_b128 v234, v[228:231] offset:13312
    v_mfma_f32_32x32x16_bf16 v[160:175], a[240:243], v[244:247], v[160:175]
    v_cvt_pk_f16_f32 v224, v112, v116
    v_cvt_pk_f16_f32 v225, v120, v124
    v_cvt_pk_f16_f32 v226, v128, v132
    v_cvt_pk_f16_f32 v227, v136, v140
    ds_write_b128 v234, v[224:227] offset:2048
    v_cvt_pk_f16_f32 v228, v113, v117
    v_cvt_pk_f16_f32 v229, v121, v125
    v_cvt_pk_f16_f32 v230, v129, v133
    v_cvt_pk_f16_f32 v231, v137, v141
    ds_write_b128 v234, v[228:231] offset:3072
    v_cvt_pk_f16_f32 v224, v114, v118
    v_cvt_pk_f16_f32 v225, v122, v126
    v_cvt_pk_f16_f32 v226, v130, v134
    v_cvt_pk_f16_f32 v227, v138, v142
    ds_write_b128 v234, v[224:227] offset:14336
    v_cvt_pk_f16_f32 v228, v115, v119
    v_cvt_pk_f16_f32 v229, v123, v127
    v_cvt_pk_f16_f32 v230, v131, v135
    v_cvt_pk_f16_f32 v231, v139, v143
    ds_write_b128 v234, v[228:231] offset:15360
    v_cvt_pk_f16_f32 v224, v144, v148
    v_cvt_pk_f16_f32 v225, v152, v156
    v_cvt_pk_f16_f32 v226, v160, v164
    v_cvt_pk_f16_f32 v227, v168, v172
    ds_write_b128 v234, v[224:227] offset:4096
    v_cvt_pk_f16_f32 v228, v145, v149
    v_cvt_pk_f16_f32 v229, v153, v157
    v_cvt_pk_f16_f32 v230, v161, v165
    v_cvt_pk_f16_f32 v231, v169, v173
    ds_write_b128 v234, v[228:231] offset:5120
    v_cvt_pk_f16_f32 v224, v146, v150
    v_cvt_pk_f16_f32 v225, v154, v158
    v_cvt_pk_f16_f32 v226, v162, v166
    v_cvt_pk_f16_f32 v227, v170, v174
    ds_write_b128 v234, v[224:227] offset:16384
    v_cvt_pk_f16_f32 v228, v147, v151
    v_cvt_pk_f16_f32 v229, v155, v159
    v_cvt_pk_f16_f32 v230, v163, v167
    v_cvt_pk_f16_f32 v231, v171, v175
    ds_write_b128 v234, v[228:231] offset:17408
    s_branch L_conv0
L_prep1:
    v_bfe_u32 v158, v129, 2, 1
    v_bfe_u32 v159, v129, 3, 2
    v_lshl_add_u32 v159, v158, 2, v159
    v_and_b32 v160, 3, v129
    v_lshl_add_u32 v159, v138, 4, v159
    s_lshl_b32 s60, s3, 6
    s_sub_u32 s60, s60, 128
    v_add_u32 v159, s60, v159
    v_xor_b32 v236, v138, v160
    v_lshlrev_b32 v236, 4, v236
    v_mad_u32_u24 v232, v159, s69, v236
    s_lshl_b32 s60, s3, 1
    s_sub_u32 s60, s60, 4
    v_add_u32 v159, s60, v158
    v_lshlrev_b32 v238, 11, v159
    v_add_u32 v238, 40960, v238
    v_mul_u32_u24 v159, 768, v159
    v_lshl_add_u32 v159, v158, 2, v159
    v_add_u32 v159, v160, v159
    v_bfe_u32 v160, v129, 3, 1
    v_lshl_add_u32 v159, v160, 6, v159
    v_lshrrev_b32 v160, 4, v129
    v_lshl_add_u32 v159, v160, 4, v159
    v_lshlrev_b32 v159, 4, v159
    v_add_u32 v234, 40960, v159
    v_xor_b32 v235, 64, v234
    buffer_load_dwordx4 v[208:211], v236, s[40:43], 0 offen offset:0
    buffer_load_dwordx4 v[212:215], v236, s[40:43], 0 offen offset:64
    buffer_load_dwordx4 v[216:219], v236, s[40:43], 0 offen offset:128
    s_add_u32 m0, s56, 0
    s_nop 0
    buffer_load_dwordx4 v1, s[20:23], 0 offen offset:0 lds
    s_add_u32 m0, s56, 1024
    s_nop 0
    buffer_load_dwordx4 v2, s[20:23], 0 offen offset:0 lds
    s_add_u32 m0, s56, 2048
    s_nop 0
    buffer_load_dwordx4 v3, s[20:23], 0 offen offset:0 lds
    s_add_u32 m0, s56, 3072
    s_nop 0
    buffer_load_dwordx4 v4, s[20:23], 0 offen offset:0 lds
    s_add_u32 m0, s56, 4096
    s_nop 0
    buffer_load_dwordx4 v5, s[20:23], 0 offen offset:0 lds
    s_add_u32 m0, s56, 5120
    s_nop 0
    buffer_load_dwordx4 v6, s[20:23], 0 offen offset:0 lds
    s_add_u32 m0, s56, 6144
    s_nop 0
    buffer_load_dword v7, s[20:23], 0 offen offset:0 lds
    v_mov_b32 v157, 268435456
    v_and_b32 v152, 15, v129
    v_lshrrev_b32 v153, 4, v129
    v_add_u32 v154, 4, v152
    v_lshrrev_b32 v154, 3, v154
    v_mad_i32_i24 v155, v154, -4, v152
    v_and_b32 v154, 1, v154
    v_and_b32 v156, 1, v153
    v_lshlrev_b32 v158, 1, v154
    v_mul_u32_u24 v159, 98304, v158
    v_mad_u32_u24 v159, v155, s69, v159
    v_lshl_add_u32 v159, v153, 4, v159
    v_add_u32 v26, s63, v159
    v_xor_b32 v161, v154, v138
    v_add_u32 v159, v153, v158
    v_add_u32 v160, 0, v155
    v_mad_u32_u24 v159, v159, 10, v160
    v_bfe_u32 v160, v160, 2, 1
    v_lshl_or_b32 v160, v161, 1, v160
    v_lshl_add_u32 v160, v159, 2, v160
    v_lshl_add_u32 v8, v160, 4, s56
    v_add_u32 v162, 1, v156
    v_add_u32 v159, v138, v158
    v_add_u32 v160, v162, v155
    v_mad_u32_u24 v159, v159, 10, v160
    v_bfe_u32 v160, v160, 2, 1
    v_lshl_or_b32 v160, v154, 1, v160
    v_lshl_add_u32 v160, v159, 2, v160
    v_lshl_add_u32 v12, v160, 4, s56
    v_xor_b32 v9, 16, v8
    v_xor_b32 v10, 32, v8
    v_xor_b32 v11, 48, v8
    v_xor_b32 v13, 16, v12
    v_xor_b32 v14, 32, v12
    v_xor_b32 v15, 48, v12
    v_add_u32 v159, 1, v158
    v_add_u32 v160, 1, v155
    v_mad_u32_u24 v159, v159, 10, v160
    v_bfe_u32 v160, v160, 2, 1
    v_lshl_or_b32 v160, v154, 1, v160
    v_xor_b32 v160, v153, v160
    v_lshl_add_u32 v160, v159, 2, v160
    v_lshl_add_u32 v20, v160, 4, s56
    v_xor_b32 v21, 32, v20
    v_add_u32 v21, 640, v21
    v_bfe_u32 v158, v152, 2, 1
    v_sub_u32 v158, v153, v158
    v_and_b32 v159, 3, v152
    v_mul_u32_u24 v16, 0x1111, v159
    v_lshrrev_b32 v160, 3, v152
    v_lshl_add_u32 v159, v160, 2, v159
    v_lshlrev_b32 v159, 5, v159
    v_add_u32 v159, 141312, v159
    s_movk_i32 s70, 3072
    v_cmp_gt_u32 vcc, 3, v158
    v_mad_u32_u24 v159, v158, s70, v159
    s_nop 0
    v_cndmask_b32 v22, v157, v159, vcc
    v_lshlrev_b32 v23, 4, v129
    v_add_u32 v24, 40960, v23
    v_lshlrev_b32 v25, 5, v153
    v_add_u32 v25, 150528, v25
    v_and_b32 v160, 1, v129
    v_lshlrev_b32 v160, 4, v160
    v_mov_b32 v161, 0x3f80
    v_lshlrev_b32 v160, v160, v161
    v_bfe_u32 v158, v129, 1, 1
    v_bfe_u32 v159, v129, 3, 2
    v_lshl_add_u32 v159, v159, 1, v158
    v_bfe_u32 v161, v129, 2, 1
    v_xor_b32 v161, v161, v138
    v_lshl_add_u32 v159, v161, 3, v159
    v_lshlrev_b32 v159, v159, 1
    v_lshrrev_b32 v161, 2, v152
    v_xor_b32 v161, v161, v153
    v_lshl_add_u32 v158, v161, 1, v158
    v_lshlrev_b32 v158, v158, 1
    v_bfe_i32 v240, v159, 0, 1
    v_bfe_i32 v241, v159, 1, 1
    v_bfe_i32 v242, v159, 2, 1
    v_bfe_i32 v243, v159, 3, 1
    v_bfe_i32 v244, v159, 4, 1
    v_bfe_i32 v245, v159, 5, 1
    v_bfe_i32 v246, v159, 6, 1
    v_bfe_i32 v247, v159, 7, 1
    v_bfe_i32 v18, v158, 0, 1
    v_bfe_i32 v19, v158, 1, 1
    v_and_b32 v240, v160, v240
    v_and_b32 v241, v160, v241
    v_and_b32 v242, v160, v242
    v_and_b32 v243, v160, v243
    v_and_b32 v244, v160, v244
    v_and_b32 v245, v160, v245
    v_and_b32 v246, v160, v246
    v_and_b32 v247, v160, v247
    v_and_b32 v18, v160, v18
    v_and_b32 v19, v160, v19
    s_mov_b32 s24, s18
    s_mov_b32 s25, s19
    s_mov_b32 s26, 50331648
    s_mov_b32 s27, 0x20000
    s_mov_b32 s52, 0
    s_mov_b32 s80, 0
    s_mov_b32 s81, 98304
    s_mov_b32 s82, 393216
    s_mov_b32 s83, 491520
    s_mov_b32 s53, 1156138217
    s_mov_b32 s58, 0x3c003c00
    s_mov_b32 s85, 150912
    s_mov_b32 s86, 0x37803780
    s_mov_b32 s84, 0x37800000
    v_lshlrev_b32 v17, 4, v138
    v_lshrrev_b32 v17, v17, -1
    s_mov_b32 s73, 0x409d2a01
    s_mov_b32 s59, 0x3ef00000
    v_mul_u32_u24 v252, 0x100010, v0
    v_add_u32 v252, 0xc0004, v252
    v_lshlrev_b32 v253, 2, v0
    v_add_u32 v253, 150912, v253
    v_add_u32 v160, 0x0, v252
    v_add_u32 v168, 0x10001000, v252
    v_cvt_f32_f16 v161, v160
    v_cvt_f32_f16 v169, v168
    v_cvt_f32_f16_sdwa v162, v160 dst_sel:DWORD dst_unused:UNUSED_PAD src0_sel:WORD_1
    v_cvt_f32_f16_sdwa v170, v168 dst_sel:DWORD dst_unused:UNUSED_PAD src0_sel:WORD_1
    v_mul_f32 v163, 0x3f7fdde7, v161
    v_mul_f32 v171, 0x3f7fdde7, v169
    v_mul_f32 v164, 0x3f7fdde7, v162
    v_mul_f32 v172, 0x3f7fdde7, v170
    v_fma_f32 v163, v163, v161, s73
    v_fma_f32 v171, v171, v169, s73
    v_fma_f32 v164, v164, v162, s73
    v_fma_f32 v172, v172, v170, s73
    v_mul_f32 v163, -v161, v163
    v_mul_f32 v171, -v169, v171
    v_mul_f32 v164, -v162, v164
    v_mul_f32 v172, -v170, v172
    v_exp_f32 v165, v163
    v_exp_f32 v173, v171
    v_exp_f32 v166, v164
    v_exp_f32 v174, v172
    v_fma_f32 v163, v165, s59, s59
    v_fma_f32 v171, v173, s59, s59
    v_fma_f32 v164, v166, s59, s59
    v_fma_f32 v172, v174, s59, s59
    v_rcp_f32 v163, v163
    v_rcp_f32 v171, v171
    v_rcp_f32 v164, v164
    v_rcp_f32 v172, v172
    v_mul_f32 v163, v161, v163
    v_mul_f32 v171, v169, v171
    v_mul_f32 v164, v162, v164
    v_mul_f32 v172, v170, v172
    v_mul_f32 v165, -v165, v163
    v_mul_f32 v173, -v173, v171
    v_mul_f32 v166, -v166, v164
    v_mul_f32 v174, -v174, v172
    v_cvt_pk_bf16_f32 v167, v165, v166
    v_cvt_pk_bf16_f32 v175, v173, v174
    v_cvt_pk_bf16_f32 v160, v163, v164
    v_cvt_pk_bf16_f32 v168, v171, v172
    ds_write_b32 v253, v167 offset:8192
    ds_write_b32 v253, v160 offset:0
    ds_write_b32 v253, v175 offset:9216
    ds_write_b32 v253, v168 offset:1024
    v_add_u32 v160, 0x20002000, v252
    s_nop 0
    v_add_u32 v168, 0x30003000, v252
    v_cvt_f32_f16 v161, v160
    v_cvt_f32_f16 v169, v168
    v_cvt_f32_f16_sdwa v162, v160 dst_sel:DWORD dst_unused:UNUSED_PAD src0_sel:WORD_1
    v_cvt_f32_f16_sdwa v170, v168 dst_sel:DWORD dst_unused:UNUSED_PAD src0_sel:WORD_1
    v_mul_f32 v163, 0x3f7fdde7, v161
    v_mul_f32 v171, 0x3f7fdde7, v169
    v_mul_f32 v164, 0x3f7fdde7, v162
    v_mul_f32 v172, 0x3f7fdde7, v170
    v_fma_f32 v163, v163, v161, s73
    v_fma_f32 v171, v171, v169, s73
    v_fma_f32 v164, v164, v162, s73
    v_fma_f32 v172, v172, v170, s73
    v_mul_f32 v163, -v161, v163
    v_mul_f32 v171, -v169, v171
    v_mul_f32 v164, -v162, v164
    v_mul_f32 v172, -v170, v172
    v_exp_f32 v165, v163
    v_exp_f32 v173, v171
    v_exp_f32 v166, v164
    v_exp_f32 v174, v172
    v_fma_f32 v163, v165, s59, s59
    v_fma_f32 v171, v173, s59, s59
    v_fma_f32 v164, v166, s59, s59
    v_fma_f32 v172, v174, s59, s59
    v_rcp_f32 v163, v163
    v_rcp_f32 v171, v171
    v_rcp_f32 v164, v164
    v_rcp_f32 v172, v172
    v_mul_f32 v163, v161, v163
    v_mul_f32 v171, v169, v171
    v_mul_f32 v164, v162, v164
    v_mul_f32 v172, v170, v172
    v_mul_f32 v165, -v165, v163
    v_mul_f32 v173, -v173, v171
    v_mul_f32 v166, -v166, v164
    v_mul_f32 v174, -v174, v172
    v_cvt_pk_bf16_f32 v167, v165, v166
    v_cvt_pk_bf16_f32 v175, v173, v174
    v_cvt_pk_bf16_f32 v160, v163, v164
    v_cvt_pk_bf16_f32 v168, v171, v172
    ds_write_b32 v253, v167 offset:10240
    ds_write_b32 v253, v160 offset:2048
    ds_write_b32 v253, v175 offset:11264
    ds_write_b32 v253, v168 offset:3072
    v_add_u32 v160, 0x40004000, v252
    s_nop 0
    v_add_u32 v168, 0x50005000, v252
    v_cvt_f32_f16 v161, v160
    v_cvt_f32_f16 v169, v168
    v_cvt_f32_f16_sdwa v162, v160 dst_sel:DWORD dst_unused:UNUSED_PAD src0_sel:WORD_1
    v_cvt_f32_f16_sdwa v170, v168 dst_sel:DWORD dst_unused:UNUSED_PAD src0_sel:WORD_1
    v_mul_f32 v163, 0x3f7fdde7, v161
    v_mul_f32 v171, 0x40088889, v169
    v_mul_f32 v164, 0x3f7fdde7, v162
    v_mul_f32 v172, 0x40088889, v170
    v_fma_f32 v163, v163, v161, s73
    v_cvt_pk_bf16_f32 v168, v171, v172
    v_fma_f32 v164, v164, v162, s73
    v_mul_f32 v163, -v161, v163
    v_mul_f32 v164, -v162, v164
    v_exp_f32 v165, v163
    v_exp_f32 v166, v164
    v_fma_f32 v163, v165, s59, s59
    v_fma_f32 v164, v166, s59, s59
    v_rcp_f32 v163, v163
    v_rcp_f32 v164, v164
    v_mul_f32 v163, v161, v163
    v_mul_f32 v164, v162, v164
    v_mul_f32 v165, -v165, v163
    v_mul_f32 v166, -v166, v164
    v_cvt_pk_bf16_f32 v167, v165, v166
    v_cvt_pk_bf16_f32 v160, v163, v164
    ds_write_b32 v253, v167 offset:12288
    ds_write_b32 v253, v160 offset:4096
    ds_write_b32 v253, v168 offset:5120
    s_nop 0
    v_add_u32 v160, 0x60006000, v252
    v_add_u32 v168, 0x70007000, v252
    v_cvt_f32_f16 v161, v160
    v_cvt_f32_f16 v169, v168
    v_cvt_f32_f16_sdwa v162, v160 dst_sel:DWORD dst_unused:UNUSED_PAD src0_sel:WORD_1
    v_cvt_f32_f16_sdwa v170, v168 dst_sel:DWORD dst_unused:UNUSED_PAD src0_sel:WORD_1
    v_mul_f32 v163, 0x40088889, v161
    v_mul_f32 v171, 0x40088889, v169
    v_mul_f32 v164, 0x40088889, v162
    v_mul_f32 v172, 0x40088889, v170
    v_cvt_pk_bf16_f32 v160, v163, v164
    v_cvt_pk_bf16_f32 v168, v171, v172
    ds_write_b32 v253, v160 offset:6144
    ds_write_b32 v253, v168 offset:7168
    v_lshlrev_b32 v158, 6, v0
    v_add_u32 v158, 141312, v158
    v_cmp_gt_u32 vcc, 144, v0
    s_nop 1
    v_cndmask_b32 v158, v157, v158, vcc
    v_and_b32 v159, 3, v0
    v_lshl_add_u32 v160, v159, 2, v158
    v_lshrrev_b32 v159, 1, v159
    v_lshl_add_u32 v159, v159, 2, v158
    v_lshlrev_b32 v161, 4, v0
    v_add_u32 v161, 150528, v161
    v_cmp_gt_u32 vcc, 24, v0
    s_nop 1
    v_cndmask_b32 v161, v157, v161, vcc
    v_mov_b32 v164, 0
    v_mov_b32 v165, 0
    v_mov_b32 v166, 0
    v_mov_b32 v167, 0
    ds_write_b128 v158, v[164:167]
    ds_write_b128 v158, v[164:167] offset:16
    s_waitcnt lgkmcnt(9)
    ds_write_b128 v158, v[164:167] offset:32
    ds_write_b128 v158, v[164:167] offset:48
    s_waitcnt vmcnt(14)
    ds_write_b16 v160, v144
    ds_write_b16_d16_hi v160, v144 offset:34
    s_waitcnt vmcnt(13)
    ds_write_b16 v159, v145 offset:16
    ds_write_b16_d16_hi v159, v145 offset:48
    s_waitcnt vmcnt(12) lgkmcnt(13)
    ds_write_b16 v159, v146 offset:24
    ds_write_b16_d16_hi v159, v146 offset:56
    s_waitcnt vmcnt(11)
    v_lshlrev_b32 v168, 16, v148
    v_and_b32 v169, 0xffff0000, v148
    v_lshlrev_b32 v170, 16, v149
    v_and_b32 v171, 0xffff0000, v149
    s_waitcnt vmcnt(10)
    v_lshlrev_b32 v172, 16, v150
    v_and_b32 v173, 0xffff0000, v150
    v_lshlrev_b32 v174, 16, v151
    v_and_b32 v175, 0xffff0000, v151
    v_mul_f32 v168, v168, v172
    v_mul_f32 v169, v169, v173
    v_mul_f32 v170, v170, v174
    v_mul_f32 v171, v171, v175
    s_waitcnt lgkmcnt(14)
    ds_write_b128 v161, v[168:171]
    s_waitcnt vmcnt(9)
    v_mfma_f32_32x32x16_bf16 v[176:191], v[208:211], v[240:243], 0
    v_mfma_f32_32x32x16_bf16 v[176:191], v[208:211], v[244:247], v[176:191]
    s_waitcnt vmcnt(8)
    s_nop 10
    v_mfma_f32_32x32x16_bf16 v[180:195], v[212:215], v[240:243], 0
    v_mfma_f32_32x32x16_bf16 v[180:195], v[212:215], v[244:247], v[180:195]
    s_waitcnt vmcnt(7)
    s_nop 10
    v_mfma_f32_32x32x16_bf16 v[184:199], v[216:219], v[240:243], 0
    v_mfma_f32_32x32x16_bf16 v[184:199], v[216:219], v[244:247], v[184:199]
    s_mov_b32 s74, 0
    s_mov_b32 s75, 6144
    buffer_load_dwordx4 a[0:3], v232, s[48:51], s74 offen offset:0
    buffer_load_dwordx4 a[4:7], v232, s[48:51], s75 offen offset:0
    buffer_load_dwordx4 a[8:11], v232, s[48:51], s74 offen offset:1536
    buffer_load_dwordx4 a[12:15], v232, s[48:51], s75 offen offset:1536
    buffer_load_dwordx4 a[16:19], v232, s[48:51], s74 offen offset:64
    buffer_load_dwordx4 a[20:23], v232, s[48:51], s75 offen offset:64
    buffer_load_dwordx4 a[24:27], v232, s[48:51], s74 offen offset:1600
    buffer_load_dwordx4 a[28:31], v232, s[48:51], s75 offen offset:1600
    buffer_load_dwordx4 a[32:35], v232, s[48:51], s74 offen offset:128
    buffer_load_dwordx4 a[36:39], v232, s[48:51], s75 offen offset:128
    buffer_load_dwordx4 a[40:43], v232, s[48:51], s74 offen offset:1664
    buffer_load_dwordx4 a[44:47], v232, s[48:51], s75 offen offset:1664
    s_mov_b32 s74, 24576
    s_mov_b32 s75, 30720
    buffer_load_dwordx4 a[48:51], v232, s[48:51], s74 offen offset:0
    buffer_load_dwordx4 a[52:55], v232, s[48:51], s75 offen offset:0
    buffer_load_dwordx4 a[56:59], v232, s[48:51], s74 offen offset:1536
    buffer_load_dwordx4 a[60:63], v232, s[48:51], s75 offen offset:1536
    buffer_load_dwordx4 a[64:67], v232, s[48:51], s74 offen offset:64
    buffer_load_dwordx4 a[68:71], v232, s[48:51], s75 offen offset:64
    buffer_load_dwordx4 a[72:75], v232, s[48:51], s74 offen offset:1600
    buffer_load_dwordx4 a[76:79], v232, s[48:51], s75 offen offset:1600
    buffer_load_dwordx4 a[80:83], v232, s[48:51], s74 offen offset:128
    buffer_load_dwordx4 a[84:87], v232, s[48:51], s75 offen offset:128
    buffer_load_dwordx4 a[88:91], v232, s[48:51], s74 offen offset:1664
    buffer_load_dwordx4 a[92:95], v232, s[48:51], s75 offen offset:1664
    s_waitcnt vmcnt(23)
    v_mfma_f32_32x32x16_bf16 v[80:95], a[0:3], v[240:243], 0
    s_waitcnt vmcnt(21)
    v_mfma_f32_32x32x16_bf16 v[96:111], a[8:11], v[240:243], 0
    v_mfma_f32_32x32x16_bf16 v[80:95], a[4:7], v[244:247], v[80:95]
    s_waitcnt vmcnt(20)
    v_mfma_f32_32x32x16_bf16 v[96:111], a[12:15], v[244:247], v[96:111]
    s_waitcnt vmcnt(19)
    v_mfma_f32_32x32x16_bf16 v[112:127], a[16:19], v[240:243], 0
    s_waitcnt vmcnt(17)
    v_mfma_f32_32x32x16_bf16 v[128:143], a[24:27], v[240:243], 0
    v_mfma_f32_32x32x16_bf16 v[112:127], a[20:23], v[244:247], v[112:127]
    s_waitcnt vmcnt(16)
    v_mfma_f32_32x32x16_bf16 v[128:143], a[28:31], v[244:247], v[128:143]
    s_nop 2
    v_pk_mul_f32 v[80:81], v[80:81], v[176:177]
    v_pk_mul_f32 v[84:85], v[84:85], v[176:177]
    v_pk_mul_f32 v[88:89], v[88:89], v[176:177]
    v_pk_mul_f32 v[92:93], v[92:93], v[176:177]
    v_pk_mul_f32 v[96:97], v[96:97], v[176:177]
    v_pk_mul_f32 v[100:101], v[100:101], v[176:177]
    v_pk_mul_f32 v[104:105], v[104:105], v[176:177]
    v_pk_mul_f32 v[108:109], v[108:109], v[176:177]
    v_cvt_pk_bf16_f32 v224, v80, v84
    v_cvt_pk_bf16_f32 v225, v88, v92
    v_cvt_pk_bf16_f32 v226, v96, v100
    v_cvt_pk_bf16_f32 v227, v104, v108
    s_waitcnt vmcnt(15)
    v_mfma_f32_32x32x16_bf16 v[144:159], a[32:35], v[240:243], 0
    s_waitcnt lgkmcnt(14)
    ds_write_b128 v234, v[224:227] offset:6144
    s_mov_b32 s74, 49152
    v_cvt_pk_bf16_f32 v228, v81, v85
    v_cvt_pk_bf16_f32 v229, v89, v93
    v_cvt_pk_bf16_f32 v230, v97, v101
    v_cvt_pk_bf16_f32 v231, v105, v109
    s_waitcnt vmcnt(13)
    v_mfma_f32_32x32x16_bf16 v[160:175], a[40:43], v[240:243], 0
    s_waitcnt lgkmcnt(14)
    ds_write_b128 v235, v[228:231] offset:6144
    s_mov_b32 s75, 55296
    buffer_load_dwordx4 v[32:35], v232, s[48:51], s74 offen offset:0
    v_pk_mul_f32 v[82:83], v[82:83], v[178:179]
    v_pk_mul_f32 v[86:87], v[86:87], v[178:179]
    v_pk_mul_f32 v[90:91], v[90:91], v[178:179]
    v_pk_mul_f32 v[94:95], v[94:95], v[178:179]
    v_pk_mul_f32 v[98:99], v[98:99], v[178:179]
    v_pk_mul_f32 v[102:103], v[102:103], v[178:179]
    v_pk_mul_f32 v[106:107], v[106:107], v[178:179]
    v_pk_mul_f32 v[110:111], v[110:111], v[178:179]
    v_cvt_pk_bf16_f32 v224, v82, v86
    v_cvt_pk_bf16_f32 v225, v90, v94
    v_cvt_pk_bf16_f32 v226, v98, v102
    v_cvt_pk_bf16_f32 v227, v106, v110
    v_mfma_f32_32x32x16_bf16 v[144:159], a[36:39], v[244:247], v[144:159]
    s_waitcnt lgkmcnt(14)
    ds_write_b128 v234, v[224:227] offset:6272
    buffer_load_dwordx4 v[36:39], v232, s[48:51], s75 offen offset:0
    v_cvt_pk_bf16_f32 v228, v83, v87
    v_cvt_pk_bf16_f32 v229, v91, v95
    v_cvt_pk_bf16_f32 v230, v99, v103
    v_cvt_pk_bf16_f32 v231, v107, v111
    s_waitcnt vmcnt(14)
    v_mfma_f32_32x32x16_bf16 v[160:175], a[44:47], v[244:247], v[160:175]
    s_waitcnt vmcnt(10)
    s_waitcnt lgkmcnt(14)
    ds_write_b128 v235, v[228:231] offset:6272
    buffer_load_dwordx4 v[40:43], v232, s[48:51], s74 offen offset:1536
    buffer_load_dwordx4 v[44:47], v232, s[48:51], s75 offen offset:1536
    v_pk_mul_f32 v[112:113], v[112:113], v[180:181]
    v_pk_mul_f32 v[116:117], v[116:117], v[180:181]
    v_pk_mul_f32 v[120:121], v[120:121], v[180:181]
    v_pk_mul_f32 v[124:125], v[124:125], v[180:181]
    v_pk_mul_f32 v[128:129], v[128:129], v[180:181]
    v_pk_mul_f32 v[132:133], v[132:133], v[180:181]
    v_pk_mul_f32 v[136:137], v[136:137], v[180:181]
    v_pk_mul_f32 v[140:141], v[140:141], v[180:181]
    v_cvt_pk_bf16_f32 v224, v112, v116
    v_cvt_pk_bf16_f32 v225, v120, v124
    v_cvt_pk_bf16_f32 v226, v128, v132
    v_cvt_pk_bf16_f32 v227, v136, v140
    v_mfma_f32_32x32x16_bf16 v[80:95], a[48:51], v[240:243], 0
    s_waitcnt lgkmcnt(14)
    ds_write_b128 v234, v[224:227] offset:8192
    buffer_load_dwordx4 v[48:51], v232, s[48:51], s74 offen offset:64
    v_cvt_pk_bf16_f32 v228, v113, v117
    v_cvt_pk_bf16_f32 v229, v121, v125
    v_cvt_pk_bf16_f32 v230, v129, v133
    v_cvt_pk_bf16_f32 v231, v137, v141
    v_mfma_f32_32x32x16_bf16 v[96:111], a[56:59], v[240:243], 0
    s_waitcnt lgkmcnt(14)
    ds_write_b128 v235, v[228:231] offset:8192
    buffer_load_dwordx4 v[52:55], v232, s[48:51], s75 offen offset:64
    v_pk_mul_f32 v[114:115], v[114:115], v[182:183]
    v_pk_mul_f32 v[118:119], v[118:119], v[182:183]
    v_pk_mul_f32 v[122:123], v[122:123], v[182:183]
    v_pk_mul_f32 v[126:127], v[126:127], v[182:183]
    v_pk_mul_f32 v[130:131], v[130:131], v[182:183]
    v_pk_mul_f32 v[134:135], v[134:135], v[182:183]
    v_pk_mul_f32 v[138:139], v[138:139], v[182:183]
    v_pk_mul_f32 v[142:143], v[142:143], v[182:183]
    v_cvt_pk_bf16_f32 v224, v114, v118
    v_cvt_pk_bf16_f32 v225, v122, v126
    v_cvt_pk_bf16_f32 v226, v130, v134
    v_cvt_pk_bf16_f32 v227, v138, v142
    v_mfma_f32_32x32x16_bf16 v[80:95], a[52:55], v[244:247], v[80:95]
    s_waitcnt lgkmcnt(14)
    ds_write_b128 v234, v[224:227] offset:8320
    buffer_load_dwordx4 v[56:59], v232, s[48:51], s74 offen offset:1600
    v_cvt_pk_bf16_f32 v228, v115, v119
    v_cvt_pk_bf16_f32 v229, v123, v127
    v_cvt_pk_bf16_f32 v230, v131, v135
    v_cvt_pk_bf16_f32 v231, v139, v143
    v_mfma_f32_32x32x16_bf16 v[96:111], a[60:63], v[244:247], v[96:111]
    s_waitcnt vmcnt(11)
    s_waitcnt lgkmcnt(14)
    ds_write_b128 v235, v[228:231] offset:8320
    buffer_load_dwordx4 v[60:63], v232, s[48:51], s75 offen offset:1600
    v_pk_mul_f32 v[144:145], v[144:145], v[184:185]
    v_pk_mul_f32 v[148:149], v[148:149], v[184:185]
    v_pk_mul_f32 v[152:153], v[152:153], v[184:185]
    v_pk_mul_f32 v[156:157], v[156:157], v[184:185]
    v_pk_mul_f32 v[160:161], v[160:161], v[184:185]
    v_pk_mul_f32 v[164:165], v[164:165], v[184:185]
    v_pk_mul_f32 v[168:169], v[168:169], v[184:185]
    v_pk_mul_f32 v[172:173], v[172:173], v[184:185]
    v_cvt_pk_bf16_f32 v224, v144, v148
    v_cvt_pk_bf16_f32 v225, v152, v156
    v_cvt_pk_bf16_f32 v226, v160, v164
    v_cvt_pk_bf16_f32 v227, v168, v172
    v_mfma_f32_32x32x16_bf16 v[112:127], a[64:67], v[240:243], 0
    s_waitcnt lgkmcnt(14)
    ds_write_b128 v234, v[224:227] offset:10240
    buffer_load_dwordx4 v[64:67], v232, s[48:51], s74 offen offset:128
    v_cvt_pk_bf16_f32 v228, v145, v149
    v_cvt_pk_bf16_f32 v229, v153, v157
    v_cvt_pk_bf16_f32 v230, v161, v165
    v_cvt_pk_bf16_f32 v231, v169, v173
    v_mfma_f32_32x32x16_bf16 v[128:143], a[72:75], v[240:243], 0
    s_waitcnt lgkmcnt(14)
    ds_write_b128 v235, v[228:231] offset:10240
    buffer_load_dwordx4 v[68:71], v232, s[48:51], s75 offen offset:128
    v_pk_mul_f32 v[146:147], v[146:147], v[186:187]
    v_pk_mul_f32 v[150:151], v[150:151], v[186:187]
    v_pk_mul_f32 v[154:155], v[154:155], v[186:187]
    v_pk_mul_f32 v[158:159], v[158:159], v[186:187]
    v_pk_mul_f32 v[162:163], v[162:163], v[186:187]
    v_pk_mul_f32 v[166:167], v[166:167], v[186:187]
    v_pk_mul_f32 v[170:171], v[170:171], v[186:187]
    v_pk_mul_f32 v[174:175], v[174:175], v[186:187]
    v_cvt_pk_bf16_f32 v224, v146, v150
    v_cvt_pk_bf16_f32 v225, v154, v158
    v_cvt_pk_bf16_f32 v226, v162, v166
    v_cvt_pk_bf16_f32 v227, v170, v174
    v_mfma_f32_32x32x16_bf16 v[112:127], a[68:71], v[244:247], v[112:127]
    s_waitcnt lgkmcnt(14)
    ds_write_b128 v234, v[224:227] offset:10368
    buffer_load_dwordx4 v[72:75], v232, s[48:51], s74 offen offset:1664
    v_cvt_pk_bf16_f32 v228, v147, v151
    v_cvt_pk_bf16_f32 v229, v155, v159
    v_cvt_pk_bf16_f32 v230, v163, v167
    v_cvt_pk_bf16_f32 v231, v171, v175
    v_mfma_f32_32x32x16_bf16 v[128:143], a[76:79], v[244:247], v[128:143]
    s_waitcnt vmcnt(11)
    s_waitcnt lgkmcnt(14)
    ds_write_b128 v235, v[228:231] offset:10368
    buffer_load_dwordx4 v[76:79], v232, s[48:51], s75 offen offset:1664
    v_sub_u32 v234, v234, v238
    v_sub_u32 v235, v235, v238
    v_pk_mul_f32 v[80:81], v[80:81], v[176:177]
    v_pk_mul_f32 v[84:85], v[84:85], v[176:177]
    v_pk_mul_f32 v[88:89], v[88:89], v[176:177]
    v_pk_mul_f32 v[92:93], v[92:93], v[176:177]
    v_pk_mul_f32 v[96:97], v[96:97], v[176:177]
    v_pk_mul_f32 v[100:101], v[100:101], v[176:177]
    v_pk_mul_f32 v[104:105], v[104:105], v[176:177]
    v_pk_mul_f32 v[108:109], v[108:109], v[176:177]
    v_cvt_pk_bf16_f32 v224, v80, v84
    v_cvt_pk_bf16_f32 v225, v88, v92
    v_cvt_pk_bf16_f32 v226, v96, v100
    v_cvt_pk_bf16_f32 v227, v104, v108
    v_mfma_f32_32x32x16_bf16 v[144:159], a[80:83], v[240:243], 0
    s_waitcnt lgkmcnt(0)
    s_barrier
    ds_write_b128 v234, v[224:227] offset:6144
    ds_read_b128 a[0:3], v24 offset:0
    ds_read_b128 a[4:7], v24 offset:1024
    ds_read_b128 a[8:11], v24 offset:2048
    ds_read_b128 a[12:15], v24 offset:3072
    ds_read_b128 a[16:19], v24 offset:4096
    ds_read_b128 a[20:23], v24 offset:5120
    s_add_u32 m0, s56, 6336
    s_nop 0
    buffer_load_dwordx4 v1, s[20:23], 0 offen offset:64 lds
    v_cvt_pk_bf16_f32 v228, v81, v85
    v_cvt_pk_bf16_f32 v229, v89, v93
    v_cvt_pk_bf16_f32 v230, v97, v101
    v_cvt_pk_bf16_f32 v231, v105, v109
    v_mfma_f32_32x32x16_bf16 v[160:175], a[88:91], v[240:243], 0
    ds_write_b128 v235, v[228:231] offset:6144
    ds_read_b128 a[24:27], v24 offset:6144
    ds_read_b128 a[28:31], v24 offset:7168
    ds_read_b128 a[32:35], v24 offset:8192
    ds_read_b128 a[36:39], v24 offset:9216
    ds_read_b128 a[40:43], v24 offset:10240
    ds_read_b128 a[44:47], v24 offset:11264
    s_add_u32 m0, s56, 7360
    s_nop 0
    buffer_load_dwordx4 v2, s[20:23], 0 offen offset:64 lds
    v_pk_mul_f32 v[82:83], v[82:83], v[178:179]
    v_pk_mul_f32 v[86:87], v[86:87], v[178:179]
    v_pk_mul_f32 v[90:91], v[90:91], v[178:179]
    v_pk_mul_f32 v[94:95], v[94:95], v[178:179]
    v_pk_mul_f32 v[98:99], v[98:99], v[178:179]
    v_pk_mul_f32 v[102:103], v[102:103], v[178:179]
    v_pk_mul_f32 v[106:107], v[106:107], v[178:179]
    v_pk_mul_f32 v[110:111], v[110:111], v[178:179]
    v_cvt_pk_bf16_f32 v224, v82, v86
    v_cvt_pk_bf16_f32 v225, v90, v94
    v_cvt_pk_bf16_f32 v226, v98, v102
    v_cvt_pk_bf16_f32 v227, v106, v110
    v_mfma_f32_32x32x16_bf16 v[144:159], a[84:87], v[244:247], v[144:159]
    ds_write_b128 v234, v[224:227] offset:6272
    s_waitcnt lgkmcnt(9)
    ds_read_b128 a[96:99], v24 offset:24576
    ds_read_b128 a[100:103], v24 offset:25600
    ds_read_b128 a[104:107], v24 offset:26624
    ds_read_b128 a[108:111], v24 offset:27648
    ds_read_b128 a[112:115], v24 offset:28672
    ds_read_b128 a[116:119], v24 offset:29696
    s_add_u32 m0, s56, 8384
    s_nop 0
    buffer_load_dwordx4 v3, s[20:23], 0 offen offset:64 lds
    v_cvt_pk_bf16_f32 v228, v83, v87
    v_cvt_pk_bf16_f32 v229, v91, v95
    v_cvt_pk_bf16_f32 v230, v99, v103
    v_cvt_pk_bf16_f32 v231, v107, v111
    v_mfma_f32_32x32x16_bf16 v[160:175], a[92:95], v[244:247], v[160:175]
    s_waitcnt vmcnt(11)
    s_waitcnt lgkmcnt(9)
    ds_write_b128 v235, v[228:231] offset:6272
    ds_read_b128 a[120:123], v24 offset:30720
    ds_read_b128 a[124:127], v24 offset:31744
    ds_read_b128 a[128:131], v24 offset:32768
    ds_read_b128 a[132:135], v24 offset:33792
    ds_read_b128 a[136:139], v24 offset:34816
    s_waitcnt lgkmcnt(14)
    ds_read_b128 a[140:143], v24 offset:35840
    s_add_u32 m0, s56, 9408
    s_nop 0
    buffer_load_dwordx4 v4, s[20:23], 0 offen offset:64 lds
    v_pk_mul_f32 v[112:113], v[112:113], v[180:181]
    v_pk_mul_f32 v[116:117], v[116:117], v[180:181]
    v_pk_mul_f32 v[120:121], v[120:121], v[180:181]
    v_pk_mul_f32 v[124:125], v[124:125], v[180:181]
    v_pk_mul_f32 v[128:129], v[128:129], v[180:181]
    v_pk_mul_f32 v[132:133], v[132:133], v[180:181]
    v_pk_mul_f32 v[136:137], v[136:137], v[180:181]
    v_pk_mul_f32 v[140:141], v[140:141], v[180:181]
    v_cvt_pk_bf16_f32 v224, v112, v116
    v_cvt_pk_bf16_f32 v225, v120, v124
    v_cvt_pk_bf16_f32 v226, v128, v132
    v_cvt_pk_bf16_f32 v227, v136, v140
    v_mfma_f32_32x32x16_bf16 v[80:95], v[32:35], v[240:243], 0
    s_waitcnt lgkmcnt(9)
    ds_write_b128 v234, v[224:227] offset:8192
    ds_read_b128 a[144:147], v24 offset:36864
    ds_read_b128 a[148:151], v24 offset:37888
    ds_read_b128 a[152:155], v24 offset:38912
    ds_read_b128 a[156:159], v24 offset:39936
    ds_read_b128 a[160:163], v24 offset:40960
    s_waitcnt lgkmcnt(14)
    ds_read_b128 a[164:167], v24 offset:41984
    s_add_u32 m0, s56, 10432
    v_cvt_pk_bf16_f32 v228, v113, v117
    v_cvt_pk_bf16_f32 v229, v121, v125
    v_cvt_pk_bf16_f32 v230, v129, v133
    v_cvt_pk_bf16_f32 v231, v137, v141
    v_mfma_f32_32x32x16_bf16 v[96:111], v[40:43], v[240:243], 0
    s_waitcnt lgkmcnt(9)
    ds_write_b128 v235, v[228:231] offset:8192
    ds_read_b128 a[168:171], v24 offset:43008
    ds_read_b128 a[172:175], v24 offset:44032
    ds_read_b128 a[176:179], v24 offset:45056
    ds_read_b128 a[180:183], v24 offset:46080
    ds_read_b128 a[184:187], v24 offset:47104
    s_waitcnt lgkmcnt(14)
    ds_read_b128 a[188:191], v24 offset:48128
    buffer_load_dwordx4 v5, s[20:23], 0 offen offset:64 lds
    s_add_u32 m0, s56, 11456
    v_pk_mul_f32 v[114:115], v[114:115], v[182:183]
    v_pk_mul_f32 v[118:119], v[118:119], v[182:183]
    v_pk_mul_f32 v[122:123], v[122:123], v[182:183]
    v_pk_mul_f32 v[126:127], v[126:127], v[182:183]
    v_pk_mul_f32 v[130:131], v[130:131], v[182:183]
    v_pk_mul_f32 v[134:135], v[134:135], v[182:183]
    v_pk_mul_f32 v[138:139], v[138:139], v[182:183]
    v_pk_mul_f32 v[142:143], v[142:143], v[182:183]
    v_cvt_pk_bf16_f32 v224, v114, v118
    v_cvt_pk_bf16_f32 v225, v122, v126
    v_cvt_pk_bf16_f32 v226, v130, v134
    v_cvt_pk_bf16_f32 v227, v138, v142
    v_mfma_f32_32x32x16_bf16 v[80:95], v[36:39], v[244:247], v[80:95]
    s_waitcnt lgkmcnt(9)
    ds_write_b128 v234, v[224:227] offset:8320
    ds_read_b128 a[192:195], v23 offset:0
    ds_read_b128 a[196:199], v23 offset:1024
    ds_read_b128 a[200:203], v23 offset:10240
    ds_read_b128 a[204:207], v23 offset:11264
    ds_read_b128 a[208:211], v23 offset:20480
    s_waitcnt lgkmcnt(14)
    ds_read_b128 a[212:215], v23 offset:21504
    buffer_load_dwordx4 v6, s[20:23], 0 offen offset:64 lds
    s_add_u32 m0, s56, 12480
    v_cvt_pk_bf16_f32 v228, v115, v119
    v_cvt_pk_bf16_f32 v229, v123, v127
    v_cvt_pk_bf16_f32 v230, v131, v135
    v_cvt_pk_bf16_f32 v231, v139, v143
    v_mfma_f32_32x32x16_bf16 v[96:111], v[44:47], v[244:247], v[96:111]
    s_waitcnt vmcnt(10)
    s_waitcnt lgkmcnt(9)
    ds_write_b128 v235, v[228:231] offset:8320
    ds_read_b128 a[216:219], v23 offset:30720
    ds_read_b128 a[220:223], v23 offset:31744
    ds_read_b128 a[48:51], v24 offset:12288
    ds_read_b128 a[52:55], v24 offset:13312
    ds_read_b128 a[56:59], v24 offset:14336
    s_waitcnt lgkmcnt(14)
    ds_read_b128 a[60:63], v24 offset:15360
    buffer_load_dword v7, s[20:23], 0 offen offset:64 lds
    buffer_load_dword v254, v31, s[20:23], 0 offen
    v_pk_mul_f32 v[144:145], v[144:145], v[184:185]
    v_pk_mul_f32 v[148:149], v[148:149], v[184:185]
    v_pk_mul_f32 v[152:153], v[152:153], v[184:185]
    v_pk_mul_f32 v[156:157], v[156:157], v[184:185]
    v_pk_mul_f32 v[160:161], v[160:161], v[184:185]
    v_pk_mul_f32 v[164:165], v[164:165], v[184:185]
    v_pk_mul_f32 v[168:169], v[168:169], v[184:185]
    v_pk_mul_f32 v[172:173], v[172:173], v[184:185]
    v_cvt_pk_bf16_f32 v224, v144, v148
    v_cvt_pk_bf16_f32 v225, v152, v156
    v_cvt_pk_bf16_f32 v226, v160, v164
    v_cvt_pk_bf16_f32 v227, v168, v172
    v_mfma_f32_32x32x16_bf16 v[112:127], v[48:51], v[240:243], 0
    s_waitcnt lgkmcnt(9)
    ds_read_b128 a[64:67], v24 offset:16384
    ds_read_b128 a[68:71], v24 offset:17408
    ds_read_b128 a[72:75], v24 offset:18432
    ds_read_b128 a[76:79], v24 offset:19456
    ds_read_b128 a[80:83], v24 offset:20480
    ds_read_b128 a[84:87], v24 offset:21504
    s_waitcnt lgkmcnt(13)
    ds_read_b128 a[88:91], v24 offset:22528
    ds_read_b128 a[92:95], v24 offset:23552
    s_waitcnt lgkmcnt(0)
    s_barrier
    ds_write_b128 v234, v[224:227] offset:0
    v_cvt_pk_bf16_f32 v228, v145, v149
    v_cvt_pk_bf16_f32 v229, v153, v157
    v_cvt_pk_bf16_f32 v230, v161, v165
    v_cvt_pk_bf16_f32 v231, v169, v173
    v_mfma_f32_32x32x16_bf16 v[128:143], v[56:59], v[240:243], 0
    ds_write_b128 v235, v[228:231] offset:0
    v_pk_mul_f32 v[146:147], v[146:147], v[186:187]
    v_pk_mul_f32 v[150:151], v[150:151], v[186:187]
    v_pk_mul_f32 v[154:155], v[154:155], v[186:187]
    v_pk_mul_f32 v[158:159], v[158:159], v[186:187]
    v_pk_mul_f32 v[162:163], v[162:163], v[186:187]
    v_pk_mul_f32 v[166:167], v[166:167], v[186:187]
    v_pk_mul_f32 v[170:171], v[170:171], v[186:187]
    v_pk_mul_f32 v[174:175], v[174:175], v[186:187]
    v_cvt_pk_bf16_f32 v224, v146, v150
    v_cvt_pk_bf16_f32 v225, v154, v158
    v_cvt_pk_bf16_f32 v226, v162, v166
    v_cvt_pk_bf16_f32 v227, v170, v174
    v_mfma_f32_32x32x16_bf16 v[112:127], v[52:55], v[244:247], v[112:127]
    ds_write_b128 v234, v[224:227] offset:128
    v_cvt_pk_bf16_f32 v228, v147, v151
    v_cvt_pk_bf16_f32 v229, v155, v159
    v_cvt_pk_bf16_f32 v230, v163, v167
    v_cvt_pk_bf16_f32 v231, v171, v175
    v_mfma_f32_32x32x16_bf16 v[128:143], v[60:63], v[244:247], v[128:143]
    s_waitcnt vmcnt(8)
    ds_write_b128 v235, v[228:231] offset:128
    v_add_u32 v234, v234, v238
    v_add_u32 v235, v235, v238
    v_pk_mul_f32 v[80:81], v[80:81], v[176:177]
    v_pk_mul_f32 v[84:85], v[84:85], v[176:177]
    v_pk_mul_f32 v[88:89], v[88:89], v[176:177]
    v_pk_mul_f32 v[92:93], v[92:93], v[176:177]
    v_pk_mul_f32 v[96:97], v[96:97], v[176:177]
    v_pk_mul_f32 v[100:101], v[100:101], v[176:177]
    v_pk_mul_f32 v[104:105], v[104:105], v[176:177]
    v_pk_mul_f32 v[108:109], v[108:109], v[176:177]
    v_cvt_pk_bf16_f32 v224, v80, v84
    v_cvt_pk_bf16_f32 v225, v88, v92
    v_cvt_pk_bf16_f32 v226, v96, v100
    v_cvt_pk_bf16_f32 v227, v104, v108
    v_mfma_f32_32x32x16_bf16 v[144:159], v[64:67], v[240:243], 0
    ds_write_b128 v234, v[224:227] offset:6144
    v_cvt_pk_bf16_f32 v228, v81, v85
    v_cvt_pk_bf16_f32 v229, v89, v93
    v_cvt_pk_bf16_f32 v230, v97, v101
    v_cvt_pk_bf16_f32 v231, v105, v109
    v_mfma_f32_32x32x16_bf16 v[160:175], v[72:75], v[240:243], 0
    ds_write_b128 v235, v[228:231] offset:6144
    v_pk_mul_f32 v[82:83], v[82:83], v[178:179]
    v_pk_mul_f32 v[86:87], v[86:87], v[178:179]
    v_pk_mul_f32 v[90:91], v[90:91], v[178:179]
    v_pk_mul_f32 v[94:95], v[94:95], v[178:179]
    v_pk_mul_f32 v[98:99], v[98:99], v[178:179]
    v_pk_mul_f32 v[102:103], v[102:103], v[178:179]
    v_pk_mul_f32 v[106:107], v[106:107], v[178:179]
    v_pk_mul_f32 v[110:111], v[110:111], v[178:179]
    v_cvt_pk_bf16_f32 v224, v82, v86
    v_cvt_pk_bf16_f32 v225, v90, v94
    v_cvt_pk_bf16_f32 v226, v98, v102
    v_cvt_pk_bf16_f32 v227, v106, v110
    v_mfma_f32_32x32x16_bf16 v[144:159], v[68:71], v[244:247], v[144:159]
    ds_write_b128 v234, v[224:227] offset:6272
    v_cvt_pk_bf16_f32 v228, v83, v87
    v_cvt_pk_bf16_f32 v229, v91, v95
    v_cvt_pk_bf16_f32 v230, v99, v103
    v_cvt_pk_bf16_f32 v231, v107, v111
    v_mfma_f32_32x32x16_bf16 v[160:175], v[76:79], v[244:247], v[160:175]
    ds_write_b128 v235, v[228:231] offset:6272
    v_pk_mul_f32 v[112:113], v[112:113], v[180:181]
    v_pk_mul_f32 v[116:117], v[116:117], v[180:181]
    v_pk_mul_f32 v[120:121], v[120:121], v[180:181]
    v_pk_mul_f32 v[124:125], v[124:125], v[180:181]
    v_pk_mul_f32 v[128:129], v[128:129], v[180:181]
    v_pk_mul_f32 v[132:133], v[132:133], v[180:181]
    v_pk_mul_f32 v[136:137], v[136:137], v[180:181]
    v_pk_mul_f32 v[140:141], v[140:141], v[180:181]
    v_cvt_pk_bf16_f32 v224, v112, v116
    v_cvt_pk_bf16_f32 v225, v120, v124
    v_cvt_pk_bf16_f32 v226, v128, v132
    v_cvt_pk_bf16_f32 v227, v136, v140
    ds_write_b128 v234, v[224:227] offset:8192
    v_cvt_pk_bf16_f32 v228, v113, v117
    v_cvt_pk_bf16_f32 v229, v121, v125
    v_cvt_pk_bf16_f32 v230, v129, v133
    v_cvt_pk_bf16_f32 v231, v137, v141
    ds_write_b128 v235, v[228:231] offset:8192
    v_pk_mul_f32 v[114:115], v[114:115], v[182:183]
    v_pk_mul_f32 v[118:119], v[118:119], v[182:183]
    v_pk_mul_f32 v[122:123], v[122:123], v[182:183]
    v_pk_mul_f32 v[126:127], v[126:127], v[182:183]
    v_pk_mul_f32 v[130:131], v[130:131], v[182:183]
    v_pk_mul_f32 v[134:135], v[134:135], v[182:183]
    v_pk_mul_f32 v[138:139], v[138:139], v[182:183]
    v_pk_mul_f32 v[142:143], v[142:143], v[182:183]
    v_cvt_pk_bf16_f32 v224, v114, v118
    v_cvt_pk_bf16_f32 v225, v122, v126
    v_cvt_pk_bf16_f32 v226, v130, v134
    v_cvt_pk_bf16_f32 v227, v138, v142
    ds_write_b128 v234, v[224:227] offset:8320
    v_cvt_pk_bf16_f32 v228, v115, v119
    v_cvt_pk_bf16_f32 v229, v123, v127
    v_cvt_pk_bf16_f32 v230, v131, v135
    v_cvt_pk_bf16_f32 v231, v139, v143
    ds_write_b128 v235, v[228:231] offset:8320
    v_pk_mul_f32 v[144:145], v[144:145], v[184:185]
    v_pk_mul_f32 v[148:149], v[148:149], v[184:185]
    v_pk_mul_f32 v[152:153], v[152:153], v[184:185]
    v_pk_mul_f32 v[156:157], v[156:157], v[184:185]
    v_pk_mul_f32 v[160:161], v[160:161], v[184:185]
    v_pk_mul_f32 v[164:165], v[164:165], v[184:185]
    v_pk_mul_f32 v[168:169], v[168:169], v[184:185]
    v_pk_mul_f32 v[172:173], v[172:173], v[184:185]
    v_cvt_pk_bf16_f32 v224, v144, v148
    v_cvt_pk_bf16_f32 v225, v152, v156
    v_cvt_pk_bf16_f32 v226, v160, v164
    v_cvt_pk_bf16_f32 v227, v168, v172
    ds_write_b128 v234, v[224:227] offset:10240
    v_cvt_pk_bf16_f32 v228, v145, v149
    v_cvt_pk_bf16_f32 v229, v153, v157
    v_cvt_pk_bf16_f32 v230, v161, v165
    v_cvt_pk_bf16_f32 v231, v169, v173
    ds_write_b128 v235, v[228:231] offset:10240
    v_pk_mul_f32 v[146:147], v[146:147], v[186:187]
    v_pk_mul_f32 v[150:151], v[150:151], v[186:187]
    v_pk_mul_f32 v[154:155], v[154:155], v[186:187]
    v_pk_mul_f32 v[158:159], v[158:159], v[186:187]
    v_pk_mul_f32 v[162:163], v[162:163], v[186:187]
    v_pk_mul_f32 v[166:167], v[166:167], v[186:187]
    v_pk_mul_f32 v[170:171], v[170:171], v[186:187]
    v_pk_mul_f32 v[174:175], v[174:175], v[186:187]
    v_cvt_pk_bf16_f32 v224, v146, v150
    v_cvt_pk_bf16_f32 v225, v154, v158
    v_cvt_pk_bf16_f32 v226, v162, v166
    v_cvt_pk_bf16_f32 v227, v170, v174
    ds_write_b128 v234, v[224:227] offset:10368
    v_cvt_pk_bf16_f32 v228, v147, v151
    v_cvt_pk_bf16_f32 v229, v155, v159
    v_cvt_pk_bf16_f32 v230, v163, v167
    v_cvt_pk_bf16_f32 v231, v171, v175
    s_waitcnt lgkmcnt(14)
    ds_write_b128 v235, v[228:231] offset:10368
L_conv0:
    s_waitcnt lgkmcnt(9)
    ds_read_b128 v[192:195], v22 offset:0
    ds_read_b128 v[200:203], v22 offset:16
    ds_read_b128 a[232:235], v8 offset:0
    s_waitcnt lgkmcnt(9)
    ds_read_b128 a[244:247], v8 offset:2560
    ds_read_b128 a[236:239], v12 offset:0
    ds_read_b128 a[248:251], v12 offset:2560
    ds_read_b128 a[240:243], v14 offset:1280
    ds_read_b128 a[252:255], v14 offset:3840
    ds_read_b128 v[196:199], v22 offset:256
    s_waitcnt lgkmcnt(12)
    ds_read_b128 v[204:207], v22 offset:272
    ds_read_b128 v[176:179], v9 offset:0
    ds_read_b128 v[188:191], v9 offset:2560
    s_waitcnt lgkmcnt(9)
    v_mfma_f32_16x16x32_bf16 v[128:131], v[192:195], a[232:235], 0
    s_waitcnt lgkmcnt(8)
    ds_read_b128 v[180:183], v13 offset:0
    ds_read_b128 v[232:235], v13 offset:2560
    ds_read_b128 v[184:187], v15 offset:1280
    v_mfma_f32_16x16x32_bf16 v[152:155], v[192:195], a[244:247], 0
    s_waitcnt lgkmcnt(10)
    ds_read_b128 v[236:239], v15 offset:3840
    ds_read_b128 v[56:59], v20 offset:2560
    s_waitcnt lgkmcnt(10)
    v_smfmac_f32_16x16x64_bf16 v[128:131], v[200:203], a[236:243], v16
    s_waitcnt lgkmcnt(9)
    ds_read_b128 v[60:63], v21 offset:2560
    v_smfmac_f32_16x16x64_bf16 v[152:155], v[200:203], a[248:255], v16
    s_waitcnt lgkmcnt(9)
    ds_read_b128 v[52:55], v21 offset:0
    ds_read_b128 v[48:51], v20 offset:0
    s_nop 1
    v_cvt_pkrtz_f16_f32 v128, v128, v129
    v_cvt_pkrtz_f16_f32 v129, v130, v131
    v_dot2_f32_f16 v28, v128, v128, 0
    v_dot2_f32_f16 v27, v128, s58, 0
    v_cvt_pkrtz_f16_f32 v152, v152, v153
    s_waitcnt lgkmcnt(9)
    v_mfma_f32_16x16x32_bf16 v[224:227], v[196:199], v[176:179], 0
    s_waitcnt lgkmcnt(8)
    ds_read_b128 v[32:35], v25 offset:0
    ds_read_b128 v[36:39], v25 offset:16
    ds_read_b128 a[232:235], v10 offset:0
    v_mfma_f32_16x16x32_bf16 v[228:231], v[196:199], v[188:191], 0
    s_waitcnt lgkmcnt(10)
    v_cvt_pkrtz_f16_f32 v153, v154, v155
    ds_read_b128 a[244:247], v10 offset:2560
    ds_read_b128 v[192:195], v22 offset:512
    v_dot2_f32_f16 v30, v152, v152, 0
    v_dot2_f32_f16 v29, v152, s58, 0
    v_dot2_f32_f16 v28, v129, v129, v28
    s_waitcnt lgkmcnt(10)
    v_smfmac_f32_16x16x64_bf16 v[224:227], v[204:207], v[180:187], v16
    s_waitcnt lgkmcnt(4)
    ds_read_b128 a[236:239], v14 offset:0
    v_smfmac_f32_16x16x64_bf16 v[228:231], v[204:207], v[232:239], v16
    s_add_u32 m0, s56, -128
    ds_read_b128 a[240:243], v12 offset:1280
    ds_read_b128 a[248:251], v14 offset:2560
    v_dot2_f32_f16 v30, v153, v153, v30
    v_dot2_f32_f16 v27, v129, s58, v27
    v_dot2_f32_f16 v29, v153, s58, v29
    v_cvt_pkrtz_f16_f32 v130, v224, v225
    v_cvt_pkrtz_f16_f32 v131, v226, v227
    v_cvt_pkrtz_f16_f32 v154, v228, v229
    v_cvt_pkrtz_f16_f32 v155, v230, v231
    v_dot2_f32_f16 v28, v130, v130, v28
    v_dot2_f32_f16 v30, v154, v154, v30
    v_dot2_f32_f16 v27, v130, s58, v27
    v_dot2_f32_f16 v29, v154, s58, v29
    v_dot2_f32_f16 v28, v131, v131, v28
    v_dot2_f32_f16 v30, v155, v155, v30
    v_dot2_f32_f16 v27, v131, s58, v27
    v_dot2_f32_f16 v29, v155, s58, v29
    ds_read_b128 a[252:255], v12 offset:3840
    ds_read_b128 v[200:203], v22 offset:528
    ds_read_b128 v[176:179], v11 offset:0
    ds_read_b128 v[188:191], v11 offset:2560
    ds_read_b128 v[196:199], v22 offset:768
    ds_read_b128 v[180:183], v15 offset:0
    ds_read_b128 v[184:187], v13 offset:1280
    s_waitcnt lgkmcnt(10)
    v_mfma_f32_16x16x32_bf16 v[132:135], v[192:195], a[232:235], 0
    ds_read_b128 v[232:235], v15 offset:2560
    v_mfma_f32_16x16x32_bf16 v[156:159], v[192:195], a[244:247], 0
    s_waitcnt lgkmcnt(9)
    ds_read_b128 v[236:239], v13 offset:3840
    ds_read_b128 v[204:207], v22 offset:784
    s_waitcnt vmcnt(1)
    ds_read_b128 a[232:235], v8 offset:6400
    ds_read_b128 a[244:247], v8 offset:8960
    s_waitcnt lgkmcnt(10)
    v_smfmac_f32_16x16x64_bf16 v[132:135], v[200:203], a[236:243], v16
    ds_read_b128 v[192:195], v22 offset:1024
    v_smfmac_f32_16x16x64_bf16 v[156:159], v[200:203], a[248:255], v16
    s_waitcnt lgkmcnt(10)
    ds_read_b128 a[236:239], v12 offset:6400
    ds_read_b128 a[240:243], v14 offset:7680
    s_waitcnt lgkmcnt(10)
    v_mfma_f32_16x16x32_bf16 v[224:227], v[196:199], v[176:179], 0
    ds_read_b128 a[248:251], v12 offset:8960
    v_mfma_f32_16x16x32_bf16 v[228:231], v[196:199], v[188:191], 0
    s_waitcnt lgkmcnt(9)
    ds_read_b128 a[252:255], v14 offset:10240
    v_cvt_pkrtz_f16_f32 v132, v132, v133
    v_cvt_pkrtz_f16_f32 v133, v134, v135
    v_cvt_pkrtz_f16_f32 v156, v156, v157
    v_cvt_pkrtz_f16_f32 v157, v158, v159
    v_dot2_f32_f16 v28, v132, v132, v28
    v_dot2_f32_f16 v30, v156, v156, v30
    v_dot2_f32_f16 v27, v132, s58, v27
    v_dot2_f32_f16 v29, v156, s58, v29
    v_dot2_f32_f16 v28, v133, v133, v28
    v_dot2_f32_f16 v30, v157, v157, v30
    v_dot2_f32_f16 v27, v133, s58, v27
    v_dot2_f32_f16 v29, v157, s58, v29
    s_waitcnt lgkmcnt(7)
    v_smfmac_f32_16x16x64_bf16 v[224:227], v[204:207], v[180:187], v16
    s_waitcnt lgkmcnt(0)
    buffer_load_dwordx4 v1, s[20:23], 0 offen offset:128 lds
    ds_read_b128 v[200:203], v22 offset:1040
    ds_read_b128 v[176:179], v9 offset:6400
    v_smfmac_f32_16x16x64_bf16 v[228:231], v[204:207], v[232:239], v16
    s_add_u32 m0, s56, 896
    ds_read_b128 v[188:191], v9 offset:8960
    buffer_load_dwordx4 v2, s[20:23], 0 offen offset:128 lds
    ds_read_b128 v[196:199], v22 offset:1280
    v_mfma_f32_16x16x32_bf16 v[136:139], v[192:195], a[232:235], 0
    s_add_u32 m0, s56, 1920
    ds_read_b128 v[180:183], v13 offset:6400
    buffer_load_dwordx4 v3, s[20:23], 0 offen offset:128 lds
    ds_read_b128 v[184:187], v15 offset:7680
    v_mfma_f32_16x16x32_bf16 v[160:163], v[192:195], a[244:247], 0
    s_add_u32 m0, s56, 2944
    ds_read_b128 v[232:235], v13 offset:8960
    buffer_load_dwordx4 v4, s[20:23], 0 offen offset:128 lds
    ds_read_b128 v[236:239], v15 offset:10240
    v_cvt_pkrtz_f16_f32 v134, v224, v225
    v_cvt_pkrtz_f16_f32 v158, v228, v229
    v_cvt_pkrtz_f16_f32 v135, v226, v227
    v_cvt_pkrtz_f16_f32 v159, v230, v231
    v_dot2_f32_f16 v28, v134, v134, v28
    v_dot2_f32_f16 v30, v158, v158, v30
    v_dot2_f32_f16 v27, v134, s58, v27
    v_dot2_f32_f16 v29, v158, s58, v29
    s_waitcnt lgkmcnt(7)
    v_smfmac_f32_16x16x64_bf16 v[136:139], v[200:203], a[236:243], v16
    s_add_u32 m0, s56, 3968
    ds_read_b128 v[204:207], v22 offset:1296
    buffer_load_dwordx4 v5, s[20:23], 0 offen offset:128 lds
    ds_read_b128 v[216:219], v20 offset:8960
    v_mfma_f32_16x16x16_bf16 v[80:83], v[18:19], v[56:57], v[32:35]
    s_add_u32 m0, s56, 4992
    ds_read_b128 a[232:235], v10 offset:6400
    buffer_load_dwordx4 v6, s[20:23], 0 offen offset:128 lds
    ds_read_b128 a[244:247], v10 offset:8960
    v_smfmac_f32_16x16x64_bf16 v[160:163], v[200:203], a[248:255], v16
    s_add_u32 m0, s56, 6016
    ds_read_b128 v[192:195], v22 offset:1536
    buffer_load_dword v7, s[20:23], 0 offen offset:128 lds
    ds_read_b128 a[236:239], v14 offset:6400
    v_cvt_pkrtz_f16_f32 v136, v136, v137
    v_dot2_f32_f16 v28, v135, v135, v28
    v_dot2_f32_f16 v30, v159, v159, v30
    v_dot2_f32_f16 v27, v135, s58, v27
    v_dot2_f32_f16 v29, v159, s58, v29
    v_cvt_pkrtz_f16_f32 v160, v160, v161
    v_cvt_pkrtz_f16_f32 v137, v138, v139
    v_cvt_pkrtz_f16_f32 v161, v162, v163
    s_waitcnt lgkmcnt(10)
    v_mfma_f32_16x16x32_bf16 v[224:227], v[196:199], v[176:179], 0
    ds_read_b128 a[240:243], v12 offset:7680
    ds_read_b128 v[220:223], v21 offset:8960
    ds_read_b128 a[248:251], v14 offset:8960
    v_mfma_f32_16x16x32_bf16 v[228:231], v[196:199], v[188:191], 0
    s_waitcnt lgkmcnt(11)
    ds_read_b128 a[252:255], v12 offset:10240
    ds_read_b128 v[200:203], v22 offset:1552
    ds_read_b128 v[176:179], v11 offset:6400
    v_mfma_f32_16x16x16_bf16 v[84:87], v[18:19], v[58:59], v[36:39]
    s_waitcnt lgkmcnt(13)
    ds_read_b128 v[188:191], v11 offset:8960
    v_mfma_f32_16x16x16_bf16 v[88:91], v[18:19], v[60:61], v[32:35]
    s_waitcnt lgkmcnt(12)
    ds_read_b128 v[196:199], v22 offset:1792
    v_smfmac_f32_16x16x64_bf16 v[224:227], v[204:207], v[180:187], v16
    ds_read_b128 v[180:183], v15 offset:6400
    v_mfma_f32_16x16x16_bf16 v[92:95], v[18:19], v[62:63], v[36:39]
    s_waitcnt lgkmcnt(13)
    ds_read_b128 v[184:187], v13 offset:7680
    v_smfmac_f32_16x16x64_bf16 v[228:231], v[204:207], v[232:239], v16
    s_waitcnt lgkmcnt(13)
    ds_read_b128 v[232:235], v15 offset:8960
    v_mfma_f32_16x16x16_bf16 v[40:43], v[18:19], v[52:53], v[32:35]
    s_waitcnt lgkmcnt(12)
    ds_read_b128 v[236:239], v13 offset:10240
    v_mfma_f32_16x16x32_bf16 v[140:143], v[192:195], a[232:235], 0
    ds_read_b128 v[204:207], v22 offset:1808
    v_cvt_pkrtz_f16_f32 v138, v224, v225
    v_cvt_pkrtz_f16_f32 v139, v226, v227
    v_mfma_f32_16x16x16_bf16 v[44:47], v[18:19], v[54:55], v[36:39]
    v_cvt_pkrtz_f16_f32 v162, v228, v229
    v_cvt_pkrtz_f16_f32 v163, v230, v231
    v_mfma_f32_16x16x32_bf16 v[164:167], v[192:195], a[244:247], 0
    s_waitcnt lgkmcnt(8)
    ds_read_b128 v[192:195], v22 offset:2048
    v_smfmac_f32_16x16x64_bf16 v[140:143], v[200:203], a[236:243], v16
    ds_read_b128 v[212:215], v21 offset:6400
    s_nop 1
    v_smfmac_f32_16x16x64_bf16 v[164:167], v[200:203], a[248:255], v16
    s_waitcnt lgkmcnt(7)
    ds_read_b128 v[200:203], v22 offset:2064
    s_nop 1
    v_cvt_pkrtz_f16_f32 v140, v140, v141
    v_cvt_pkrtz_f16_f32 v141, v142, v143
    v_dot2_f32_f16 v28, v136, v136, v28
    v_dot2_f32_f16 v30, v160, v160, v30
    v_dot2_f32_f16 v27, v136, s58, v27
    v_dot2_f32_f16 v29, v160, s58, v29
    v_dot2_f32_f16 v28, v137, v137, v28
    v_dot2_f32_f16 v30, v161, v161, v30
    v_dot2_f32_f16 v27, v137, s58, v27
    v_dot2_f32_f16 v29, v161, s58, v29
    v_dot2_f32_f16 v28, v138, v138, v28
    v_dot2_f32_f16 v30, v162, v162, v30
    v_dot2_f32_f16 v27, v138, s58, v27
    v_dot2_f32_f16 v29, v162, s58, v29
    v_dot2_f32_f16 v28, v139, v139, v28
    v_dot2_f32_f16 v30, v163, v163, v30
    v_dot2_f32_f16 v27, v139, s58, v27
    v_dot2_f32_f16 v29, v163, s58, v29
    v_cvt_pkrtz_f16_f32 v164, v164, v165
    v_cvt_pkrtz_f16_f32 v165, v166, v167
    v_dot2_f32_f16 v28, v140, v140, v28
    v_mfma_f32_16x16x32_bf16 v[224:227], v[196:199], v[176:179], 0
    v_mfma_f32_16x16x32_bf16 v[228:231], v[196:199], v[188:191], 0
    s_waitcnt lgkmcnt(3)
    ds_read_b128 v[196:199], v22 offset:2304
    s_nop 2
    v_smfmac_f32_16x16x64_bf16 v[224:227], v[204:207], v[180:187], v16
    v_smfmac_f32_16x16x64_bf16 v[228:231], v[204:207], v[232:239], v16
    ds_read_b128 v[204:207], v22 offset:2320
    v_mfma_f32_16x16x16_bf16 v[32:35], v[18:19], v[48:49], v[32:35]
    s_waitcnt lgkmcnt(3)
    s_nop 3
    v_cvt_pkrtz_f16_f32 v142, v224, v225
    v_cvt_pkrtz_f16_f32 v166, v228, v229
    v_cvt_pkrtz_f16_f32 v143, v226, v227
    v_cvt_pkrtz_f16_f32 v167, v230, v231
    v_dot2_f32_f16 v30, v164, v164, v30
    v_dot2_f32_f16 v27, v140, s58, v27
    v_dot2_f32_f16 v29, v164, s58, v29
    v_dot2_f32_f16 v28, v141, v141, v28
    v_dot2_f32_f16 v30, v165, v165, v30
    v_dot2_f32_f16 v27, v141, s58, v27
    v_dot2_f32_f16 v29, v165, s58, v29
    v_dot2_f32_f16 v28, v142, v142, v28
    v_dot2_f32_f16 v30, v166, v166, v30
    v_dot2_f32_f16 v27, v142, s58, v27
    v_dot2_f32_f16 v29, v166, s58, v29
    v_dot2_f32_f16 v28, v143, v143, v28
    v_dot2_f32_f16 v30, v167, v167, v30
    v_dot2_f32_f16 v27, v143, s58, v27
    v_dot2_f32_f16 v29, v167, s58, v29
    s_waitcnt vmcnt(0)
    ds_read_b128 a[232:235], v8 offset:0
    ds_read_b128 a[244:247], v8 offset:2560
    ds_read_b128 a[236:239], v12 offset:0
    ds_read_b128 a[240:243], v14 offset:1280
    ds_read_b128 a[248:251], v12 offset:2560
    ds_read_b128 a[252:255], v14 offset:3840
    ds_read_b128 v[176:179], v9 offset:0
    ds_read_b128 v[188:191], v9 offset:2560
    ds_read_b128 v[180:183], v13 offset:0
    ds_read_b128 v[184:187], v15 offset:1280
    ds_read_b128 v[232:235], v13 offset:2560
    s_waitcnt lgkmcnt(10)
    v_mfma_f32_16x16x32_bf16 v[144:147], v[192:195], a[232:235], 0
    s_waitcnt lgkmcnt(9)
    ds_read_b128 v[236:239], v15 offset:3840
    ds_read_b128 a[232:235], v10 offset:0
    v_mfma_f32_16x16x32_bf16 v[168:171], v[192:195], a[244:247], 0
    s_waitcnt lgkmcnt(9)
    ds_read_b128 a[244:247], v10 offset:2560
    v_smfmac_f32_16x16x64_bf16 v[144:147], v[200:203], a[236:243], v16
    s_waitcnt lgkmcnt(9)
    ds_read_b128 v[192:195], v22 offset:2560
    ds_read_b128 a[236:239], v14 offset:0
    s_waitcnt lgkmcnt(10)
    v_smfmac_f32_16x16x64_bf16 v[168:171], v[200:203], a[248:255], v16
    s_waitcnt lgkmcnt(9)
    ds_read_b128 a[240:243], v12 offset:1280
    v_mfma_f32_16x16x32_bf16 v[224:227], v[196:199], v[176:179], 0
    s_waitcnt lgkmcnt(9)
    ds_read_b128 a[248:251], v14 offset:2560
    v_mfma_f32_16x16x32_bf16 v[228:231], v[196:199], v[188:191], 0
    ds_read_b128 a[252:255], v12 offset:3840
    v_cvt_pkrtz_f16_f32 v144, v144, v145
    v_cvt_pkrtz_f16_f32 v145, v146, v147
    v_mfma_f32_16x16x16_bf16 v[36:39], v[18:19], v[50:51], v[36:39]
    s_waitcnt lgkmcnt(9)
    ds_read_b128 v[200:203], v22 offset:2576
    ds_read_b128 v[176:179], v11 offset:0
    v_cvt_pkrtz_f16_f32 v168, v168, v169
    v_smfmac_f32_16x16x64_bf16 v[224:227], v[204:207], v[180:187], v16
    s_waitcnt lgkmcnt(10)
    ds_read_b128 v[188:191], v11 offset:2560
    v_cvt_pkrtz_f16_f32 v169, v170, v171
    s_waitcnt lgkmcnt(10)
    v_smfmac_f32_16x16x64_bf16 v[228:231], v[204:207], v[232:239], v16
    s_waitcnt lgkmcnt(9)
    ds_read_b128 v[196:199], v22 offset:2816
    ds_read_b128 v[180:183], v15 offset:0
    v_dot2_f32_f16 v28, v144, v144, v28
    v_dot2_f32_f16 v30, v168, v168, v30
    v_dot2_f32_f16 v27, v144, s58, v27
    v_cvt_pkrtz_f16_f32 v146, v224, v225
    v_cvt_pkrtz_f16_f32 v147, v226, v227
    s_waitcnt lgkmcnt(9)
    v_mfma_f32_16x16x32_bf16 v[148:151], v[192:195], a[232:235], 0
    ds_read_b128 v[184:187], v13 offset:1280
    ds_read_b128 v[232:235], v15 offset:2560
    ds_read_b128 v[236:239], v13 offset:3840
    v_mfma_f32_16x16x32_bf16 v[172:175], v[192:195], a[244:247], 0
    s_waitcnt lgkmcnt(10)
    v_cvt_pkrtz_f16_f32 v170, v228, v229
    v_cvt_pkrtz_f16_f32 v171, v230, v231
    ds_read_b128 v[204:207], v22 offset:2832
    v_dot2_f32_f16 v29, v168, s58, v29
    v_dot2_f32_f16 v28, v145, v145, v28
    v_dot2_f32_f16 v30, v169, v169, v30
    v_dot2_f32_f16 v27, v145, s58, v27
    v_dot2_f32_f16 v29, v169, s58, v29
    v_dot2_f32_f16 v28, v146, v146, v28
    v_dot2_f32_f16 v30, v170, v170, v30
    v_dot2_f32_f16 v27, v146, s58, v27
    s_waitcnt lgkmcnt(8)
    v_smfmac_f32_16x16x64_bf16 v[148:151], v[200:203], a[236:243], v16
    ds_read_b128 v[48:51], v25 offset:128
    ds_read_b128 v[52:55], v25 offset:144
    ds_read_b128 v[64:67], v25 offset:256
    v_smfmac_f32_16x16x64_bf16 v[172:175], v[200:203], a[248:255], v16
    s_waitcnt lgkmcnt(10)
    ds_read_b128 v[68:71], v25 offset:272
    ds_read_b128 v[208:211], v20 offset:6400
    s_nop 0
    v_cvt_pkrtz_f16_f32 v148, v148, v149
    v_dot2_f32_f16 v29, v170, s58, v29
    v_dot2_f32_f16 v28, v147, v147, v28
    v_dot2_f32_f16 v30, v171, v171, v30
    v_dot2_f32_f16 v27, v147, s58, v27
    v_dot2_f32_f16 v29, v171, s58, v29
    v_cvt_pkrtz_f16_f32 v172, v172, v173
    v_cvt_pkrtz_f16_f32 v149, v150, v151
    v_cvt_pkrtz_f16_f32 v173, v174, v175
    s_waitcnt lgkmcnt(10)
    v_mfma_f32_16x16x32_bf16 v[224:227], v[196:199], v[176:179], 0
    ds_read_b128 a[232:235], v23 offset:2048
    ds_read_b128 a[236:239], v23 offset:3072
    ds_read_b128 a[240:243], v23 offset:4096
    v_mfma_f32_16x16x32_bf16 v[228:231], v[196:199], v[188:191], 0
    s_waitcnt lgkmcnt(11)
    ds_read_b128 a[244:247], v23 offset:5120
    ds_read_b128 a[248:251], v23 offset:12288
    s_waitcnt lgkmcnt(10)
    v_smfmac_f32_16x16x64_bf16 v[224:227], v[204:207], v[180:187], v16
    ds_read_b128 a[252:255], v23 offset:13312
    v_smfmac_f32_16x16x64_bf16 v[228:231], v[204:207], v[232:239], v16
    s_waitcnt lgkmcnt(0)
    s_barrier
    s_branch L_mid
L_conv:
    v_mfma_f32_16x16x32_bf16 v[128:131], v[192:195], a[232:235], 0
    ds_read_b128 a[232:235], v10 offset:0
    v_cvt_pk_bf16_f32 v80, v80, v81
    v_cvt_pk_bf16_f32 v81, v82, v83
    v_mfma_f32_16x16x32_bf16 v[152:155], v[192:195], a[244:247], 0
    s_waitcnt lgkmcnt(2)
    ds_read_b128 a[244:247], v10 offset:2560
    ds_read_b128 v[192:195], v22 offset:512
    v_cvt_pk_bf16_f32 v82, v84, v85
    v_cvt_pk_bf16_f32 v83, v86, v87
    v_smfmac_f32_16x16x64_bf16 v[128:131], v[200:203], a[236:243], v16
    ds_read_b128 a[236:239], v14 offset:0
    ds_read_b128 a[240:243], v12 offset:1280
    v_cvt_pk_bf16_f32 v96, v96, v97
    v_smfmac_f32_16x16x64_bf16 v[152:155], v[200:203], a[248:255], v16
    ds_read_b128 a[248:251], v14 offset:2560
    ds_read_b128 a[252:255], v12 offset:3840
    ds_read_b128 v[200:203], v22 offset:528
    v_mfma_f32_16x16x32_bf16 v[88:91], a[168:171], v[244:247], v[88:91]
    v_cvt_pkrtz_f16_f32 v128, v128, v129
    v_cvt_pkrtz_f16_f32 v129, v130, v131
    v_cvt_pk_bf16_f32 v97, v98, v99
    v_mfma_f32_16x16x32_bf16 v[224:227], v[196:199], v[176:179], 0
    ds_read_b128 v[176:179], v11 offset:0
    v_cvt_pkrtz_f16_f32 v152, v152, v153
    v_cvt_pkrtz_f16_f32 v153, v154, v155
    v_mfma_f32_16x16x32_bf16 v[92:95], a[172:175], v[244:247], v[92:95]
    v_cvt_pk_bf16_f32 v88, v88, v89
    v_cvt_pk_bf16_f32 v89, v90, v91
    v_cvt_pk_bf16_f32 v98, v100, v101
    v_mfma_f32_16x16x32_bf16 v[228:231], v[196:199], v[188:191], 0
    ds_read_b128 v[188:191], v11 offset:2560
    ds_read_b128 v[196:199], v22 offset:768
    v_cvt_pk_bf16_f32 v99, v102, v103
    v_smfmac_f32_16x16x64_bf16 v[224:227], v[204:207], v[180:187], v16
    ds_read_b128 v[180:183], v15 offset:0
    ds_read_b128 v[184:187], v13 offset:1280
    v_cvt_pk_bf16_f32 v90, v92, v93
    v_smfmac_f32_16x16x64_bf16 v[228:231], v[204:207], v[232:239], v16
    s_waitcnt lgkmcnt(10)
    ds_read_b128 v[232:235], v15 offset:2560
    ds_read_b128 v[236:239], v13 offset:3840
    ds_read_b128 v[204:207], v22 offset:784
    v_mfma_f32_16x16x32_bf16 v[104:107], a[176:179], v[244:247], v[104:107]
    s_add_u32 m0, s56, -128
    v_cvt_pkrtz_f16_f32 v130, v224, v225
    v_cvt_pkrtz_f16_f32 v131, v226, v227
    v_cvt_pk_bf16_f32 v91, v94, v95
    v_mfma_f32_16x16x32_bf16 v[132:135], v[192:195], a[232:235], 0
    ds_read_b128 a[232:235], v8 offset:6400
    v_cvt_pkrtz_f16_f32 v154, v228, v229
    v_cvt_pkrtz_f16_f32 v155, v230, v231
    v_mfma_f32_16x16x32_bf16 v[156:159], v[192:195], a[244:247], 0
    s_waitcnt lgkmcnt(9)
    ds_read_b128 a[244:247], v8 offset:8960
    ds_read_b128 v[192:195], v22 offset:1024
    ds_read_b128 v[32:35], v25 offset:0
    v_smfmac_f32_16x16x64_bf16 v[132:135], v[200:203], a[236:243], v16
    ds_read_b128 a[236:239], v12 offset:6400
    ds_read_b128 a[240:243], v14 offset:7680
    v_cvt_pk_bf16_f32 v104, v104, v105
    v_smfmac_f32_16x16x64_bf16 v[156:159], v[200:203], a[248:255], v16
    s_waitcnt lgkmcnt(7)
    ds_read_b128 a[248:251], v12 offset:8960
    ds_read_b128 a[252:255], v14 offset:10240
    buffer_load_dwordx4 v1, s[20:23], 0 offen offset:128 lds
    v_mfma_f32_16x16x32_bf16 v[108:111], a[180:183], v[244:247], v[108:111]
    s_add_u32 m0, s56, 896
    ds_read_b128 v[200:203], v22 offset:1040
    buffer_load_dwordx4 v2, s[20:23], 0 offen offset:128 lds
    v_mfma_f32_16x16x32_bf16 v[224:227], v[196:199], v[176:179], 0
    s_add_u32 m0, s56, 1920
    ds_read_b128 v[176:179], v9 offset:6400
    buffer_load_dwordx4 v3, s[20:23], 0 offen offset:128 lds
    v_mfma_f32_16x16x32_bf16 v[120:123], a[184:187], v[244:247], v[120:123]
    s_add_u32 m0, s56, 2944
    v_cvt_pkrtz_f16_f32 v132, v132, v133
    v_cvt_pkrtz_f16_f32 v156, v156, v157
    v_cvt_pkrtz_f16_f32 v133, v134, v135
    v_mfma_f32_16x16x32_bf16 v[228:231], v[196:199], v[188:191], 0
    s_waitcnt lgkmcnt(7)
    buffer_load_dwordx4 v4, s[20:23], 0 offen offset:128 lds
    ds_read_b128 v[188:191], v9 offset:8960
    ds_read_b128 v[196:199], v22 offset:1280
    v_mfma_f32_16x16x32_bf16 v[124:127], a[188:191], v[244:247], v[124:127]
    s_add_u32 m0, s56, 3968
    ds_read_b128 v[36:39], v25 offset:16
    buffer_load_dwordx4 v5, s[20:23], 0 offen offset:128 lds
    v_smfmac_f32_16x16x64_bf16 v[224:227], v[204:207], v[180:187], v16
    s_add_u32 m0, s56, 4992
    ds_read_b128 v[180:183], v13 offset:6400
    buffer_load_dwordx4 v6, s[20:23], 0 offen offset:128 lds
    ds_read_b128 v[184:187], v15 offset:7680
    v_smfmac_f32_16x16x64_bf16 v[228:231], v[204:207], v[232:239], v16
    s_add_u32 m0, s56, 6016
    ds_read_b128 v[232:235], v13 offset:8960
    buffer_load_dword v7, s[20:23], 0 offen offset:128 lds
    ds_read_b128 v[236:239], v15 offset:10240
    v_mfma_f32_16x16x32_bf16 v[136:139], v[192:195], a[232:235], 0
    s_waitcnt lgkmcnt(12)
    ds_read_b128 v[204:207], v22 offset:1296
    buffer_store_dwordx4 v[80:83], v26, s[24:27], s82 offen offset:0 sc0 sc1
    ds_read_b128 v[216:219], v20 offset:8960
    v_mfma_f32_16x16x32_bf16 v[160:163], v[192:195], a[244:247], 0
    s_waitcnt lgkmcnt(10)
    ds_read_b128 a[232:235], v10 offset:6400
    ds_read_b128 a[244:247], v10 offset:8960
    ds_read_b128 v[192:195], v22 offset:1536
    v_smfmac_f32_16x16x64_bf16 v[136:139], v[200:203], a[236:243], v16
    ds_read_b128 a[236:239], v14 offset:6400
    v_cvt_pkrtz_f16_f32 v157, v158, v159
    v_cvt_pkrtz_f16_f32 v134, v224, v225
    v_mfma_f32_16x16x16_bf16 v[80:83], v[18:19], v[56:57], v[32:35]
    s_waitcnt lgkmcnt(13)
    ds_read_b128 a[240:243], v12 offset:7680
    v_cvt_pkrtz_f16_f32 v158, v228, v229
    v_cvt_pkrtz_f16_f32 v135, v226, v227
    v_smfmac_f32_16x16x64_bf16 v[160:163], v[200:203], a[248:255], v16
    s_waitcnt lgkmcnt(12)
    ds_read_b128 v[220:223], v21 offset:8960
    v_cvt_pkrtz_f16_f32 v159, v230, v231
    v_cvt_pk_bf16_f32 v105, v106, v107
    v_cvt_pk_bf16_f32 v106, v108, v109
    v_cvt_pk_bf16_f32 v107, v110, v111
    v_dot2_f32_f16 v28, v128, v128, 0
    v_dot2_f32_f16 v30, v152, v152, 0
    v_dot2_f32_f16 v27, v128, s58, 0
    v_dot2_f32_f16 v29, v152, s58, 0
    v_dot2_f32_f16 v28, v129, v129, v28
    v_dot2_f32_f16 v30, v153, v153, v30
    v_dot2_f32_f16 v27, v129, s58, v27
    v_dot2_f32_f16 v29, v153, s58, v29
    v_dot2_f32_f16 v28, v130, v130, v28
    v_dot2_f32_f16 v30, v154, v154, v30
    v_dot2_f32_f16 v27, v130, s58, v27
    v_dot2_f32_f16 v29, v154, s58, v29
    v_dot2_f32_f16 v28, v131, v131, v28
    v_dot2_f32_f16 v30, v155, v155, v30
    v_dot2_f32_f16 v27, v131, s58, v27
    v_dot2_f32_f16 v29, v155, s58, v29
    v_dot2_f32_f16 v28, v132, v132, v28
    v_dot2_f32_f16 v30, v156, v156, v30
    v_dot2_f32_f16 v27, v132, s58, v27
    v_dot2_f32_f16 v29, v156, s58, v29
    v_dot2_f32_f16 v28, v133, v133, v28
    v_dot2_f32_f16 v30, v157, v157, v30
    v_dot2_f32_f16 v27, v133, s58, v27
    v_dot2_f32_f16 v29, v157, s58, v29
    v_dot2_f32_f16 v28, v134, v134, v28
    v_dot2_f32_f16 v30, v158, v158, v30
    v_dot2_f32_f16 v27, v134, s58, v27
    v_dot2_f32_f16 v29, v158, s58, v29
    v_dot2_f32_f16 v28, v135, v135, v28
    v_dot2_f32_f16 v30, v159, v159, v30
    v_dot2_f32_f16 v27, v135, s58, v27
    v_dot2_f32_f16 v29, v159, s58, v29
    v_cvt_pkrtz_f16_f32 v136, v136, v137
    v_cvt_pkrtz_f16_f32 v160, v160, v161
    v_cvt_pkrtz_f16_f32 v137, v138, v139
    v_mfma_f32_16x16x32_bf16 v[224:227], v[196:199], v[176:179], 0
    s_waitcnt lgkmcnt(11)
    ds_read_b128 a[248:251], v14 offset:8960
    ds_read_b128 a[252:255], v12 offset:10240
    ds_read_b128 v[200:203], v22 offset:1552
    v_mfma_f32_16x16x32_bf16 v[228:231], v[196:199], v[188:191], 0
    s_waitcnt lgkmcnt(11)
    ds_read_b128 v[176:179], v11 offset:6400
    ds_read_b128 v[188:191], v11 offset:8960
    ds_read_b128 v[196:199], v22 offset:1792
    v_mfma_f32_16x16x16_bf16 v[84:87], v[18:19], v[58:59], v[36:39]
    buffer_store_dwordx4 v[88:91], v26, s[24:27], s83 offen offset:0 sc0 sc1
    v_cvt_pkrtz_f16_f32 v161, v162, v163
    v_cvt_pk_bf16_f32 v112, v112, v113
    v_mfma_f32_16x16x16_bf16 v[88:91], v[18:19], v[60:61], v[32:35]
    s_waitcnt lgkmcnt(13)
    v_cvt_pk_bf16_f32 v113, v114, v115
    v_cvt_pk_bf16_f32 v114, v116, v117
    v_cvt_pk_bf16_f32 v115, v118, v119
    v_smfmac_f32_16x16x64_bf16 v[224:227], v[204:207], v[180:187], v16
    s_waitcnt lgkmcnt(12)
    ds_read_b128 v[180:183], v15 offset:6400
    ds_read_b128 v[184:187], v13 offset:7680
    v_cvt_pk_bf16_f32 v120, v120, v121
    v_mfma_f32_16x16x16_bf16 v[92:95], v[18:19], v[62:63], v[36:39]
    v_cvt_pk_bf16_f32 v121, v122, v123
    v_cvt_pk_bf16_f32 v122, v124, v125
    v_cvt_pk_bf16_f32 v123, v126, v127
    v_smfmac_f32_16x16x64_bf16 v[228:231], v[204:207], v[232:239], v16
    s_waitcnt lgkmcnt(11)
    ds_read_b128 v[232:235], v15 offset:8960
    ds_read_b128 v[236:239], v13 offset:10240
    ds_read_b128 v[204:207], v22 offset:1808
    v_mfma_f32_16x16x16_bf16 v[40:43], v[18:19], v[52:53], v[32:35]
    v_cvt_pkrtz_f16_f32 v138, v224, v225
    v_cvt_pkrtz_f16_f32 v139, v226, v227
    v_mfma_f32_16x16x32_bf16 v[140:143], v[192:195], a[232:235], 0
    v_cvt_pkrtz_f16_f32 v162, v228, v229
    v_cvt_pkrtz_f16_f32 v163, v230, v231
    v_mfma_f32_16x16x16_bf16 v[44:47], v[18:19], v[54:55], v[36:39]
    v_mfma_f32_16x16x32_bf16 v[164:167], v[192:195], a[244:247], 0
    s_waitcnt lgkmcnt(8)
    ds_read_b128 v[192:195], v22 offset:2048
    v_smfmac_f32_16x16x64_bf16 v[140:143], v[200:203], a[236:243], v16
    ds_read_b128 v[212:215], v21 offset:6400
    s_nop 1
    v_smfmac_f32_16x16x64_bf16 v[164:167], v[200:203], a[248:255], v16
    s_waitcnt lgkmcnt(7)
    ds_read_b128 v[200:203], v22 offset:2064
    s_nop 1
    v_cvt_pkrtz_f16_f32 v140, v140, v141
    v_cvt_pkrtz_f16_f32 v141, v142, v143
    v_dot2_f32_f16 v28, v136, v136, v28
    v_dot2_f32_f16 v30, v160, v160, v30
    v_dot2_f32_f16 v27, v136, s58, v27
    v_dot2_f32_f16 v29, v160, s58, v29
    v_dot2_f32_f16 v28, v137, v137, v28
    v_dot2_f32_f16 v30, v161, v161, v30
    v_dot2_f32_f16 v27, v137, s58, v27
    v_dot2_f32_f16 v29, v161, s58, v29
    v_dot2_f32_f16 v28, v138, v138, v28
    v_dot2_f32_f16 v30, v162, v162, v30
    v_dot2_f32_f16 v27, v138, s58, v27
    v_dot2_f32_f16 v29, v162, s58, v29
    v_dot2_f32_f16 v28, v139, v139, v28
    v_dot2_f32_f16 v30, v163, v163, v30
    v_dot2_f32_f16 v27, v139, s58, v27
    v_dot2_f32_f16 v29, v163, s58, v29
    v_cvt_pkrtz_f16_f32 v164, v164, v165
    v_cvt_pkrtz_f16_f32 v165, v166, v167
    v_dot2_f32_f16 v28, v140, v140, v28
    v_mfma_f32_16x16x32_bf16 v[224:227], v[196:199], v[176:179], 0
    v_mfma_f32_16x16x32_bf16 v[228:231], v[196:199], v[188:191], 0
    s_waitcnt lgkmcnt(3)
    ds_read_b128 v[196:199], v22 offset:2304
    s_nop 2
    v_smfmac_f32_16x16x64_bf16 v[224:227], v[204:207], v[180:187], v16
    v_smfmac_f32_16x16x64_bf16 v[228:231], v[204:207], v[232:239], v16
    ds_read_b128 v[204:207], v22 offset:2320
    v_mfma_f32_16x16x16_bf16 v[32:35], v[18:19], v[48:49], v[32:35]
    s_waitcnt lgkmcnt(3)
    s_nop 3
    v_cvt_pkrtz_f16_f32 v142, v224, v225
    v_cvt_pkrtz_f16_f32 v166, v228, v229
    v_cvt_pkrtz_f16_f32 v143, v226, v227
    v_cvt_pkrtz_f16_f32 v167, v230, v231
    v_dot2_f32_f16 v30, v164, v164, v30
    v_dot2_f32_f16 v27, v140, s58, v27
    v_dot2_f32_f16 v29, v164, s58, v29
    v_dot2_f32_f16 v28, v141, v141, v28
    v_dot2_f32_f16 v30, v165, v165, v30
    v_dot2_f32_f16 v27, v141, s58, v27
    v_dot2_f32_f16 v29, v165, s58, v29
    v_dot2_f32_f16 v28, v142, v142, v28
    v_dot2_f32_f16 v30, v166, v166, v30
    v_dot2_f32_f16 v27, v142, s58, v27
    v_dot2_f32_f16 v29, v166, s58, v29
    v_dot2_f32_f16 v28, v143, v143, v28
    v_dot2_f32_f16 v30, v167, v167, v30
    v_dot2_f32_f16 v27, v143, s58, v27
    v_dot2_f32_f16 v29, v167, s58, v29
    s_waitcnt vmcnt(2)
    ds_read_b128 a[232:235], v8 offset:0
    ds_read_b128 a[244:247], v8 offset:2560
    ds_read_b128 a[236:239], v12 offset:0
    ds_read_b128 a[240:243], v14 offset:1280
    ds_read_b128 a[248:251], v12 offset:2560
    ds_read_b128 a[252:255], v14 offset:3840
    ds_read_b128 v[176:179], v9 offset:0
    ds_read_b128 v[188:191], v9 offset:2560
    ds_read_b128 v[180:183], v13 offset:0
    ds_read_b128 v[184:187], v15 offset:1280
    ds_read_b128 v[232:235], v13 offset:2560
    s_waitcnt lgkmcnt(10)
    v_mfma_f32_16x16x32_bf16 v[144:147], v[192:195], a[232:235], 0
    s_waitcnt lgkmcnt(9)
    buffer_store_dwordx4 v[96:99], v26, s[24:27], s82 offen offset:64 sc0 sc1
    ds_read_b128 v[236:239], v15 offset:3840
    ds_read_b128 a[232:235], v10 offset:0
    v_mfma_f32_16x16x32_bf16 v[168:171], v[192:195], a[244:247], 0
    s_waitcnt lgkmcnt(9)
    ds_read_b128 a[244:247], v10 offset:2560
    ds_read_b128 v[192:195], v22 offset:2560
    v_smfmac_f32_16x16x64_bf16 v[144:147], v[200:203], a[236:243], v16
    s_waitcnt lgkmcnt(10)
    ds_read_b128 a[236:239], v14 offset:0
    s_waitcnt lgkmcnt(10)
    v_smfmac_f32_16x16x64_bf16 v[168:171], v[200:203], a[248:255], v16
    s_waitcnt lgkmcnt(9)
    buffer_store_dwordx4 v[104:107], v26, s[24:27], s83 offen offset:64 sc0 sc1
    ds_read_b128 a[240:243], v12 offset:1280
    ds_read_b128 a[248:251], v14 offset:2560
    v_mfma_f32_16x16x32_bf16 v[224:227], v[196:199], v[176:179], 0
    s_waitcnt lgkmcnt(10)
    v_cvt_pkrtz_f16_f32 v144, v144, v145
    v_cvt_pkrtz_f16_f32 v145, v146, v147
    v_mfma_f32_16x16x32_bf16 v[228:231], v[196:199], v[188:191], 0
    ds_read_b128 a[252:255], v12 offset:3840
    ds_read_b128 v[200:203], v22 offset:2576
    v_cvt_pkrtz_f16_f32 v168, v168, v169
    v_mfma_f32_16x16x16_bf16 v[36:39], v[18:19], v[50:51], v[36:39]
    s_waitcnt lgkmcnt(10)
    buffer_store_dwordx4 v[112:115], v26, s[24:27], s82 offen offset:128 sc0 sc1
    ds_read_b128 v[176:179], v11 offset:0
    v_cvt_pkrtz_f16_f32 v169, v170, v171
    v_smfmac_f32_16x16x64_bf16 v[224:227], v[204:207], v[180:187], v16
    s_waitcnt lgkmcnt(9)
    ds_read_b128 v[188:191], v11 offset:2560
    v_smfmac_f32_16x16x64_bf16 v[228:231], v[204:207], v[232:239], v16
    s_waitcnt lgkmcnt(9)
    ds_read_b128 v[196:199], v22 offset:2816
    ds_read_b128 v[180:183], v15 offset:0
    v_dot2_f32_f16 v28, v144, v144, v28
    v_dot2_f32_f16 v30, v168, v168, v30
    v_dot2_f32_f16 v27, v144, s58, v27
    v_dot2_f32_f16 v29, v168, s58, v29
    v_cvt_pkrtz_f16_f32 v146, v224, v225
    s_waitcnt lgkmcnt(9)
    v_mfma_f32_16x16x32_bf16 v[148:151], v[192:195], a[232:235], 0
    ds_read_b128 v[184:187], v13 offset:1280
    ds_read_b128 v[232:235], v15 offset:2560
    ds_read_b128 v[236:239], v13 offset:3840
    v_mfma_f32_16x16x32_bf16 v[172:175], v[192:195], a[244:247], 0
    s_waitcnt lgkmcnt(10)
    v_cvt_pkrtz_f16_f32 v170, v228, v229
    v_cvt_pkrtz_f16_f32 v147, v226, v227
    v_cvt_pkrtz_f16_f32 v171, v230, v231
    ds_read_b128 v[204:207], v22 offset:2832
    v_dot2_f32_f16 v28, v145, v145, v28
    v_dot2_f32_f16 v30, v169, v169, v30
    v_dot2_f32_f16 v27, v145, s58, v27
    v_dot2_f32_f16 v29, v169, s58, v29
    v_dot2_f32_f16 v28, v146, v146, v28
    v_dot2_f32_f16 v30, v170, v170, v30
    v_dot2_f32_f16 v27, v146, s58, v27
    s_waitcnt lgkmcnt(8)
    v_smfmac_f32_16x16x64_bf16 v[148:151], v[200:203], a[236:243], v16
    ds_read_b128 v[48:51], v25 offset:128
    ds_read_b128 v[52:55], v25 offset:144
    ds_read_b128 v[64:67], v25 offset:256
    v_smfmac_f32_16x16x64_bf16 v[172:175], v[200:203], a[248:255], v16
    s_waitcnt lgkmcnt(10)
    ds_read_b128 v[68:71], v25 offset:272
    ds_read_b128 v[208:211], v20 offset:6400
    buffer_store_dwordx4 v[120:123], v26, s[24:27], s83 offen offset:128 sc0 sc1
    v_cvt_pkrtz_f16_f32 v148, v148, v149
    v_dot2_f32_f16 v29, v170, s58, v29
    v_dot2_f32_f16 v28, v147, v147, v28
    v_dot2_f32_f16 v30, v171, v171, v30
    v_dot2_f32_f16 v27, v147, s58, v27
    v_dot2_f32_f16 v29, v171, s58, v29
    v_cvt_pkrtz_f16_f32 v172, v172, v173
    v_cvt_pkrtz_f16_f32 v149, v150, v151
    v_cvt_pkrtz_f16_f32 v173, v174, v175
    s_waitcnt lgkmcnt(10)
    v_mfma_f32_16x16x32_bf16 v[224:227], v[196:199], v[176:179], 0
    s_waitcnt lgkmcnt(7)
    ds_read_b128 a[232:235], v23 offset:2048
    ds_read_b128 a[236:239], v23 offset:3072
    ds_read_b128 a[240:243], v23 offset:4096
    v_mfma_f32_16x16x32_bf16 v[228:231], v[196:199], v[188:191], 0
    s_add_u32 s80, s80, 786432
    ds_read_b128 a[244:247], v23 offset:5120
    ds_read_b128 a[248:251], v23 offset:12288
    s_waitcnt lgkmcnt(10)
    v_smfmac_f32_16x16x64_bf16 v[224:227], v[204:207], v[180:187], v16
    s_add_u32 s81, s81, 786432
    s_add_u32 s82, s82, 786432
    ds_read_b128 a[252:255], v23 offset:13312
    v_smfmac_f32_16x16x64_bf16 v[228:231], v[204:207], v[232:239], v16
    s_add_u32 s83, s83, 786432
L_mid:
    s_cmp_eq_u32 s52, 3
    s_cselect_b32 s57, 0x40000000, 786432
    v_add_u32 v1, s57, v1
    v_cvt_pkrtz_f16_f32 v150, v224, v225
    v_cvt_pkrtz_f16_f32 v151, v226, v227
    v_add_u32 v2, s57, v2
    v_add_u32 v3, s57, v3
    v_cvt_pkrtz_f16_f32 v174, v228, v229
    v_cvt_pkrtz_f16_f32 v175, v230, v231
    v_add_u32 v4, s57, v4
    v_add_u32 v5, s57, v5
    v_add_u32 v6, s57, v6
    v_add_u32 v7, s57, v7
    v_add_u32 v31, s57, v31
    v_dot2_f32_f16 v28, v148, v148, v28
    v_dot2_f32_f16 v30, v172, v172, v30
    v_dot2_f32_f16 v27, v148, s58, v27
    v_dot2_f32_f16 v29, v172, s58, v29
    v_dot2_f32_f16 v28, v149, v149, v28
    v_dot2_f32_f16 v30, v173, v173, v30
    v_dot2_f32_f16 v27, v149, s58, v27
    v_dot2_f32_f16 v29, v173, s58, v29
    v_dot2_f32_f16 v28, v150, v150, v28
    v_dot2_f32_f16 v30, v174, v174, v30
    v_dot2_f32_f16 v27, v150, s58, v27
    v_dot2_f32_f16 v29, v174, s58, v29
    v_dot2_f32_f16 v28, v151, v151, v28
    v_dot2_f32_f16 v30, v175, v175, v30
    v_dot2_f32_f16 v27, v151, s58, v27
    v_dot2_f32_f16 v29, v175, s58, v29
    s_nop 1
    v_permlane32_swap_b32 v27, v28
    s_waitcnt lgkmcnt(10)
    v_mfma_f32_16x16x16_bf16 v[96:99], v[18:19], v[216:217], v[48:51]
    s_waitcnt lgkmcnt(9)
    ds_read_b128 v[240:243], v20 offset:2560
    ds_read_b128 v[244:247], v21 offset:2560
    v_permlane32_swap_b32 v29, v30
    v_mfma_f32_16x16x16_bf16 v[100:103], v[18:19], v[218:219], v[52:55]
    ds_read_b128 v[236:239], v21 offset:0
    ds_read_b128 v[232:235], v20 offset:0
    v_add_f32 v27, v27, v28
    v_mfma_f32_16x16x16_bf16 v[104:107], v[18:19], v[220:221], v[48:51]
    v_add_f32 v29, v29, v30
    v_mov_b32 v28, v27
    v_mov_b32 v30, v29
    v_mfma_f32_16x16x16_bf16 v[108:111], v[18:19], v[222:223], v[52:55]
    v_permlane32_swap_b32 v27, v28
    v_permlane32_swap_b32 v29, v30
    v_mfma_f32_16x16x16_bf16 v[56:59], v[18:19], v[212:213], v[48:51]
    v_mul_f32 v27, 0x3c2aaaab, v27
    v_mul_f32 v29, 0x3c2aaaab, v29
    v_mul_f32 v28, 0x3c2aaaab, v28
    v_mfma_f32_16x16x16_bf16 v[60:63], v[18:19], v[214:215], v[52:55]
    s_waitcnt lgkmcnt(10)
    v_mul_f32 v30, 0x3c2aaaab, v30
    v_fma_f32 v28, -v27, v27, v28
    v_fma_f32 v30, -v29, v29, v30
    v_mfma_f32_16x16x16_bf16 v[48:51], v[18:19], v[208:209], v[48:51]
    v_max_f32 v28, 0, v28
    v_max_f32 v30, 0, v30
    v_add_f32 v28, 0x3727c5ac, v28
    v_mfma_f32_16x16x16_bf16 v[52:55], v[18:19], v[210:211], v[52:55]
    v_add_f32 v30, 0x3727c5ac, v30
    v_rsq_f32 v28, v28
    v_rsq_f32 v30, v30
    v_fma_mixlo_f16 v28, v28, s59, 0
    v_fma_mixlo_f16 v30, v30, s59, 0
    v_fma_mixhi_f16 v28, -v27, v28, 0 op_sel_hi:[0,1,0]
    v_fma_mixhi_f16 v30, -v29, v30, 0 op_sel_hi:[0,1,0]
    v_pk_fma_f16 v128, v128, v28, v28 op_sel:[0,0,1] op_sel_hi:[1,0,1]
    v_pk_fma_f16 v129, v129, v28, v28 op_sel:[0,0,1] op_sel_hi:[1,0,1]
    v_pk_fma_f16 v130, v130, v28, v28 op_sel:[0,0,1] op_sel_hi:[1,0,1]
    v_pk_fma_f16 v131, v131, v28, v28 op_sel:[0,0,1] op_sel_hi:[1,0,1]
    v_pk_fma_f16 v132, v132, v28, v28 op_sel:[0,0,1] op_sel_hi:[1,0,1]
    v_pk_fma_f16 v133, v133, v28, v28 op_sel:[0,0,1] op_sel_hi:[1,0,1]
    v_pk_fma_f16 v134, v134, v28, v28 op_sel:[0,0,1] op_sel_hi:[1,0,1]
    v_pk_fma_f16 v135, v135, v28, v28 op_sel:[0,0,1] op_sel_hi:[1,0,1]
    v_permlane16_swap_b32 v128, v132
    v_permlane16_swap_b32 v129, v133
    v_permlane16_swap_b32 v130, v134
    v_permlane16_swap_b32 v131, v135
    v_pk_fma_f16 v136, v136, v28, v28 op_sel:[0,0,1] op_sel_hi:[1,0,1]
    v_pk_fma_f16 v137, v137, v28, v28 op_sel:[0,0,1] op_sel_hi:[1,0,1]
    v_mfma_f32_16x16x32_f16 v[176:179], a[192:195], v[128:131], 0
    v_pk_fma_f16 v138, v138, v28, v28 op_sel:[0,0,1] op_sel_hi:[1,0,1]
    v_pk_fma_f16 v139, v139, v28, v28 op_sel:[0,0,1] op_sel_hi:[1,0,1]
    v_pk_fma_f16 v140, v140, v28, v28 op_sel:[0,0,1] op_sel_hi:[1,0,1]
    v_mfma_f32_16x16x32_f16 v[184:187], a[192:195], v[132:135], 0
    v_pk_fma_f16 v141, v141, v28, v28 op_sel:[0,0,1] op_sel_hi:[1,0,1]
    v_pk_fma_f16 v142, v142, v28, v28 op_sel:[0,0,1] op_sel_hi:[1,0,1]
    v_pk_fma_f16 v143, v143, v28, v28 op_sel:[0,0,1] op_sel_hi:[1,0,1]
    v_mfma_f32_16x16x32_f16 v[180:183], a[196:199], v[128:131], 0
    v_permlane16_swap_b32 v136, v140
    v_permlane16_swap_b32 v137, v141
    v_mfma_f32_16x16x32_f16 v[188:191], a[196:199], v[132:135], 0
    s_waitcnt lgkmcnt(9)
    v_permlane16_swap_b32 v138, v142
    v_permlane16_swap_b32 v139, v143
    v_pk_fma_f16 v144, v144, v28, v28 op_sel:[0,0,1] op_sel_hi:[1,0,1]
    v_pk_fma_f16 v145, v145, v28, v28 op_sel:[0,0,1] op_sel_hi:[1,0,1]
    v_mfma_f32_16x16x32_f16 v[176:179], a[232:235], v[136:139], v[176:179]
    v_pk_fma_f16 v146, v146, v28, v28 op_sel:[0,0,1] op_sel_hi:[1,0,1]
    v_pk_fma_f16 v147, v147, v28, v28 op_sel:[0,0,1] op_sel_hi:[1,0,1]
    v_pk_fma_f16 v151, v151, v28, v28 op_sel:[0,0,1] op_sel_hi:[1,0,1]
    v_mfma_f32_16x16x32_f16 v[184:187], a[232:235], v[140:143], v[184:187]
    s_waitcnt lgkmcnt(8)
    v_pk_fma_f16 v148, v148, v28, v28 op_sel:[0,0,1] op_sel_hi:[1,0,1]
    v_pk_fma_f16 v149, v149, v28, v28 op_sel:[0,0,1] op_sel_hi:[1,0,1]
    v_bfi_b32 v151, v17, v151, s84
    v_mfma_f32_16x16x32_f16 v[180:183], a[236:239], v[136:139], v[180:183]
    v_pk_fma_f16 v150, v150, v28, v28 op_sel:[0,0,1] op_sel_hi:[1,0,1]
    v_permlane16_swap_b32 v144, v148
    v_mfma_f32_16x16x32_f16 v[188:191], a[236:239], v[140:143], v[188:191]
    s_waitcnt lgkmcnt(7)
    v_permlane16_swap_b32 v145, v149
    v_permlane16_swap_b32 v146, v150
    v_permlane16_swap_b32 v147, v151
    v_pk_fma_f16 v152, v152, v30, v30 op_sel:[0,0,1] op_sel_hi:[1,0,1]
    v_pk_fma_f16 v153, v153, v30, v30 op_sel:[0,0,1] op_sel_hi:[1,0,1]
    v_mfma_f32_16x16x32_f16 v[176:179], a[240:243], v[144:147], v[176:179]
    v_pk_fma_f16 v154, v154, v30, v30 op_sel:[0,0,1] op_sel_hi:[1,0,1]
    v_pk_fma_f16 v155, v155, v30, v30 op_sel:[0,0,1] op_sel_hi:[1,0,1]
    v_pk_fma_f16 v156, v156, v30, v30 op_sel:[0,0,1] op_sel_hi:[1,0,1]
    v_mfma_f32_16x16x32_f16 v[184:187], a[240:243], v[148:151], v[184:187]
    s_waitcnt lgkmcnt(6)
    v_pk_fma_f16 v157, v157, v30, v30 op_sel:[0,0,1] op_sel_hi:[1,0,1]
    v_pk_fma_f16 v158, v158, v30, v30 op_sel:[0,0,1] op_sel_hi:[1,0,1]
    v_pk_fma_f16 v159, v159, v30, v30 op_sel:[0,0,1] op_sel_hi:[1,0,1]
    v_mfma_f32_16x16x32_f16 v[180:183], a[244:247], v[144:147], v[180:183]
    v_permlane16_swap_b32 v152, v156
    v_permlane16_swap_b32 v153, v157
    v_mfma_f32_16x16x32_f16 v[188:191], a[244:247], v[148:151], v[188:191]
    v_permlane16_swap_b32 v154, v158
    v_permlane16_swap_b32 v155, v159
    v_pk_fma_f16 v160, v160, v30, v30 op_sel:[0,0,1] op_sel_hi:[1,0,1]
    v_pk_fma_f16 v161, v161, v30, v30 op_sel:[0,0,1] op_sel_hi:[1,0,1]
    v_mfma_f32_16x16x32_f16 v[192:195], a[192:195], v[152:155], 0
    v_pk_fma_f16 v162, v162, v30, v30 op_sel:[0,0,1] op_sel_hi:[1,0,1]
    v_pk_fma_f16 v163, v163, v30, v30 op_sel:[0,0,1] op_sel_hi:[1,0,1]
    v_pk_fma_f16 v164, v164, v30, v30 op_sel:[0,0,1] op_sel_hi:[1,0,1]
    v_mfma_f32_16x16x32_f16 v[200:203], a[192:195], v[156:159], 0
    v_pk_fma_f16 v165, v165, v30, v30 op_sel:[0,0,1] op_sel_hi:[1,0,1]
    v_pk_fma_f16 v166, v166, v30, v30 op_sel:[0,0,1] op_sel_hi:[1,0,1]
    v_pk_fma_f16 v167, v167, v30, v30 op_sel:[0,0,1] op_sel_hi:[1,0,1]
    v_mfma_f32_16x16x32_f16 v[196:199], a[196:199], v[152:155], 0
    v_permlane16_swap_b32 v160, v164
    v_permlane16_swap_b32 v161, v165
    v_mfma_f32_16x16x32_f16 v[204:207], a[196:199], v[156:159], 0
    v_permlane16_swap_b32 v162, v166
    v_permlane16_swap_b32 v163, v167
    v_pk_fma_f16 v168, v168, v30, v30 op_sel:[0,0,1] op_sel_hi:[1,0,1]
    v_pk_fma_f16 v169, v169, v30, v30 op_sel:[0,0,1] op_sel_hi:[1,0,1]
    v_mfma_f32_16x16x32_f16 v[192:195], a[232:235], v[160:163], v[192:195]
    v_pk_fma_f16 v170, v170, v30, v30 op_sel:[0,0,1] op_sel_hi:[1,0,1]
    v_pk_fma_f16 v171, v171, v30, v30 op_sel:[0,0,1] op_sel_hi:[1,0,1]
    v_pk_fma_f16 v175, v175, v30, v30 op_sel:[0,0,1] op_sel_hi:[1,0,1]
    v_mfma_f32_16x16x32_f16 v[200:203], a[232:235], v[164:167], v[200:203]
    ds_read_b128 a[232:235], v23 offset:14336
    v_pk_fma_f16 v172, v172, v30, v30 op_sel:[0,0,1] op_sel_hi:[1,0,1]
    v_pk_fma_f16 v173, v173, v30, v30 op_sel:[0,0,1] op_sel_hi:[1,0,1]
    v_mfma_f32_16x16x32_f16 v[196:199], a[236:239], v[160:163], v[196:199]
    v_bfi_b32 v175, v17, v175, s84
    v_pk_fma_f16 v174, v174, v30, v30 op_sel:[0,0,1] op_sel_hi:[1,0,1]
    v_permlane16_swap_b32 v168, v172
    v_mfma_f32_16x16x32_f16 v[204:207], a[236:239], v[164:167], v[204:207]
    ds_read_b128 a[236:239], v23 offset:15360
    v_permlane16_swap_b32 v169, v173
    v_permlane16_swap_b32 v170, v174
    v_permlane16_swap_b32 v171, v175
    v_cvt_pkrtz_f16_f32 v208, v176, v177
    v_pk_lshrrev_b16 v208, 3, v208 op_sel_hi:[0,1]
    v_mfma_f32_16x16x32_f16 v[192:195], a[240:243], v[168:171], v[192:195]
    v_mad_u32_u16 v209, v208, 2, s85
    v_mad_u32_u16 v208, v208, 2, s85 op_sel:[1,0,0,0]
    v_cvt_pkrtz_f16_f32 v210, v178, v179
    v_mfma_f32_16x16x32_f16 v[200:203], a[240:243], v[172:175], v[200:203]
    ds_read_u16 v209, v209
    ds_read_u16_d16_hi v208, v208
    v_pk_lshrrev_b16 v210, 3, v210 op_sel_hi:[0,1]
    v_mfma_f32_16x16x32_f16 v[196:199], a[244:247], v[168:171], v[196:199]
    ds_read_b128 a[240:243], v23 offset:6144
    v_mad_u32_u16 v211, v210, 2, s85
    v_mad_u32_u16 v210, v210, 2, s85 op_sel:[1,0,0,0]
    v_mfma_f32_16x16x32_f16 v[204:207], a[244:247], v[172:175], v[204:207]
    s_waitcnt lgkmcnt(8)
    ds_read_u16 v211, v211
    ds_read_u16_d16_hi v210, v210
    v_cvt_pkrtz_f16_f32 v212, v180, v181
    v_mfma_f32_16x16x16_bf16 v[112:115], v[18:19], v[240:241], v[64:67]
    s_waitcnt lgkmcnt(9)
    ds_read_b128 a[244:247], v23 offset:7168
    v_pk_lshrrev_b16 v212, 3, v212 op_sel_hi:[0,1]
    v_mad_u32_u16 v213, v212, 2, s85
    v_mfma_f32_16x16x16_bf16 v[116:119], v[18:19], v[242:243], v[68:71]
    s_add_u32 m0, s56, 6336
    ds_read_u16 v213, v213
    buffer_load_dwordx4 v1, s[20:23], 0 offen offset:64 lds
    v_mfma_f32_16x16x16_bf16 v[120:123], v[18:19], v[244:245], v[64:67]
    v_mad_u32_u16 v212, v212, 2, s85 op_sel:[1,0,0,0]
    v_cvt_pkrtz_f16_f32 v214, v182, v183
    v_pk_lshrrev_b16 v214, 3, v214 op_sel_hi:[0,1]
    v_mfma_f32_16x16x16_bf16 v[124:127], v[18:19], v[246:247], v[68:71]
    s_waitcnt lgkmcnt(10)
    ds_read_u16_d16_hi v212, v212
    v_mad_u32_u16 v215, v214, 2, s85
    v_mad_u32_u16 v214, v214, 2, s85 op_sel:[1,0,0,0]
    v_mfma_f32_16x16x16_bf16 v[72:75], v[18:19], v[236:237], v[64:67]
    ds_read_u16 v215, v215
    ds_read_u16_d16_hi v214, v214
    v_cvt_pkrtz_f16_f32 v216, v184, v185
    v_mfma_f32_16x16x16_bf16 v[76:79], v[18:19], v[238:239], v[68:71]
    s_waitcnt lgkmcnt(12)
    v_pk_lshrrev_b16 v216, 3, v216 op_sel_hi:[0,1]
    v_mad_u32_u16 v217, v216, 2, s85
    v_mad_u32_u16 v216, v216, 2, s85 op_sel:[1,0,0,0]
    v_mfma_f32_16x16x16_bf16 v[64:67], v[18:19], v[232:233], v[64:67]
    ds_read_u16 v217, v217
    ds_read_u16_d16_hi v216, v216
    v_cvt_pkrtz_f16_f32 v218, v186, v187
    v_mfma_f32_16x16x16_bf16 v[68:71], v[18:19], v[234:235], v[68:71]
    v_pk_lshrrev_b16 v218, 3, v218 op_sel_hi:[0,1]
    v_mad_u32_u16 v219, v218, 2, s85
    v_mad_u32_u16 v218, v218, 2, s85 op_sel:[1,0,0,0]
    v_mfma_f32_16x16x32_f16 v[176:179], a[200:203], v[128:131], 0
    s_waitcnt lgkmcnt(12)
    ds_read_u16 v219, v219
    ds_read_u16_d16_hi v218, v218
    v_cvt_pkrtz_f16_f32 v220, v188, v189
    v_mfma_f32_16x16x32_f16 v[184:187], a[200:203], v[132:135], 0
    v_pk_lshrrev_b16 v220, 3, v220 op_sel_hi:[0,1]
    v_mad_u32_u16 v221, v220, 2, s85
    v_mad_u32_u16 v220, v220, 2, s85 op_sel:[1,0,0,0]
    v_mfma_f32_16x16x32_f16 v[180:183], a[204:207], v[128:131], 0
    s_waitcnt lgkmcnt(12)
    ds_read_u16 v221, v221
    ds_read_u16_d16_hi v220, v220
    v_cvt_pkrtz_f16_f32 v224, v190, v191
    v_mfma_f32_16x16x32_f16 v[188:191], a[204:207], v[132:135], 0
    s_waitcnt lgkmcnt(7)
    v_pk_fma_f16 v222, v224, v224, s53
    v_pk_mul_f16 v222, v222, v224 neg_lo:[1,0] neg_hi:[1,0]
    v_exp_f16 v223, v222
    v_or_b32 v232, v209, v208
    v_exp_f16_sdwa v223, v222 dst_sel:WORD_1 dst_unused:UNUSED_PRESERVE src0_sel:WORD_1
    v_or_b32 v233, v211, v210
    v_pk_fma_f16 v223, v223, s86, s86
    v_rcp_f16 v222, v223
    v_or_b32 v234, v213, v212
    v_rcp_f16_sdwa v222, v223 dst_sel:WORD_1 dst_unused:UNUSED_PRESERVE src0_sel:WORD_1
    s_waitcnt lgkmcnt(6)
    v_or_b32 v235, v215, v214
    v_fma_mix_f32 v223, v222, v224, 0 op_sel_hi:[1,1,0]
    v_fma_mix_f32 v222, v222, v224, 0 op_sel:[1,1,0] op_sel_hi:[1,1,0]
    v_cvt_pk_bf16_f32 v239, v223, v222
    v_cvt_pkrtz_f16_f32 v225, v192, v193
    v_pk_lshrrev_b16 v225, 3, v225 op_sel_hi:[0,1]
    v_cvt_pkrtz_f16_f32 v227, v194, v195
    v_mfma_f32_16x16x32_f16 v[192:195], a[200:203], v[152:155], 0
    s_waitcnt lgkmcnt(4)
    v_or_b32 v236, v217, v216
    v_cvt_pkrtz_f16_f32 v229, v196, v197
    v_cvt_pkrtz_f16_f32 v231, v198, v199
    v_cvt_pkrtz_f16_f32 v249, v200, v201
    v_cvt_pkrtz_f16_f32 v251, v202, v203
    v_mfma_f32_16x16x32_f16 v[200:203], a[200:203], v[156:159], 0
    v_cvt_pkrtz_f16_f32 v253, v204, v205
    v_cvt_pkrtz_f16_f32 v210, v206, v207
    v_mad_u32_u16 v226, v225, 2, s85
    v_mfma_f32_16x16x32_f16 v[176:179], a[248:251], v[136:139], v[176:179]
    s_waitcnt lgkmcnt(2)
    ds_read_u16 v226, v226
    v_or_b32 v237, v219, v218
    v_mad_u32_u16 v225, v225, 2, s85 op_sel:[1,0,0,0]
    v_mfma_f32_16x16x32_f16 v[184:187], a[248:251], v[140:143], v[184:187]
    ds_read_u16_d16_hi v225, v225
    v_pk_lshrrev_b16 v227, 3, v227 op_sel_hi:[0,1]
    v_mad_u32_u16 v228, v227, 2, s85
    v_mfma_f32_16x16x32_f16 v[196:199], a[204:207], v[152:155], 0
    ds_read_u16 v228, v228
    v_mad_u32_u16 v227, v227, 2, s85 op_sel:[1,0,0,0]
    v_pk_lshrrev_b16 v229, 3, v229 op_sel_hi:[0,1]
    v_mfma_f32_16x16x32_f16 v[204:207], a[204:207], v[156:159], 0
    s_waitcnt lgkmcnt(3)
    ds_read_u16_d16_hi v227, v227
    v_or_b32 v238, v221, v220
    v_mad_u32_u16 v230, v229, 2, s85
    v_mfma_f32_16x16x32_f16 v[180:183], a[252:255], v[136:139], v[180:183]
    ds_read_u16 v230, v230
    v_mad_u32_u16 v229, v229, 2, s85 op_sel:[1,0,0,0]
    v_pk_lshrrev_b16 v231, 3, v231 op_sel_hi:[0,1]
    v_mfma_f32_16x16x32_f16 v[188:191], a[252:255], v[140:143], v[188:191]
    ds_read_u16_d16_hi v229, v229
    v_mad_u32_u16 v248, v231, 2, s85
    v_mad_u32_u16 v231, v231, 2, s85 op_sel:[1,0,0,0]
    v_mfma_f32_16x16x32_f16 v[192:195], a[248:251], v[160:163], v[192:195]
    s_add_u32 m0, s56, 7360
    ds_read_u16 v248, v248
    ds_read_u16_d16_hi v231, v231
    v_pk_lshrrev_b16 v249, 3, v249 op_sel_hi:[0,1]
    v_mfma_f32_16x16x32_f16 v[200:203], a[248:251], v[164:167], v[200:203]
    buffer_load_dwordx4 v2, s[20:23], 0 offen offset:64 lds
    ds_read_b128 a[248:251], v23 offset:8192
    v_mfma_f32_16x16x32_f16 v[176:179], a[232:235], v[144:147], v[176:179]
    v_mad_u32_u16 v250, v249, 2, s85
    v_mad_u32_u16 v249, v249, 2, s85 op_sel:[1,0,0,0]
    v_pk_lshrrev_b16 v251, 3, v251 op_sel_hi:[0,1]
    v_mfma_f32_16x16x32_f16 v[184:187], a[232:235], v[148:151], v[184:187]
    ds_read_u16 v250, v250
    ds_read_u16_d16_hi v249, v249
    v_mad_u32_u16 v252, v251, 2, s85
    v_mfma_f32_16x16x32_f16 v[196:199], a[252:255], v[160:163], v[196:199]
    ds_read_u16 v252, v252
    v_mad_u32_u16 v251, v251, 2, s85 op_sel:[1,0,0,0]
    v_pk_lshrrev_b16 v253, 3, v253 op_sel_hi:[0,1]
    v_mfma_f32_16x16x32_f16 v[204:207], a[252:255], v[164:167], v[204:207]
    ds_read_u16_d16_hi v251, v251
    ds_read_b128 a[252:255], v23 offset:9216
    v_mad_u32_u16 v0, v253, 2, s85
    v_mfma_f32_16x16x32_f16 v[180:183], a[236:239], v[144:147], v[180:183]
    s_waitcnt lgkmcnt(13)
    ds_read_u16 v0, v0
    v_mad_u32_u16 v253, v253, 2, s85 op_sel:[1,0,0,0]
    v_pk_fma_f16 v208, v210, v210, s53
    v_mfma_f32_16x16x32_f16 v[188:191], a[236:239], v[148:151], v[188:191]
    s_waitcnt lgkmcnt(13)
    ds_read_u16_d16_hi v253, v253
    v_pk_mul_f16 v208, v208, v210 neg_lo:[1,0] neg_hi:[1,0]
    v_exp_f16 v209, v208
    v_mfma_f32_16x16x32_f16 v[192:195], a[232:235], v[168:171], v[192:195]
    v_exp_f16_sdwa v209, v208 dst_sel:WORD_1 dst_unused:UNUSED_PRESERVE src0_sel:WORD_1
    v_or_b32 v240, v226, v225
    v_mfma_f32_16x16x32_f16 v[200:203], a[232:235], v[172:175], v[200:203]
    s_waitcnt lgkmcnt(13)
    ds_read_b128 a[232:235], v23 offset:0
    v_pk_fma_f16 v209, v209, s86, s86
    v_rcp_f16 v208, v209
    v_mfma_f32_16x16x32_f16 v[196:199], a[236:239], v[168:171], v[196:199]
    s_waitcnt lgkmcnt(13)
    v_rcp_f16_sdwa v208, v209 dst_sel:WORD_1 dst_unused:UNUSED_PRESERVE src0_sel:WORD_1
    v_or_b32 v241, v228, v227
    v_mfma_f32_16x16x32_f16 v[204:207], a[236:239], v[172:175], v[204:207]
    ds_read_b128 a[236:239], v23 offset:1024
    v_fma_mix_f32 v209, v208, v210, 0 op_sel_hi:[1,1,0]
    v_fma_mix_f32 v208, v208, v210, 0 op_sel:[1,1,0] op_sel_hi:[1,1,0]
    v_mfma_f32_16x16x32_bf16 v[32:35], a[240:243], v[232:235], v[32:35]
    s_waitcnt lgkmcnt(7)
    v_or_b32 v242, v230, v229
    v_or_b32 v243, v248, v231
    v_or_b32 v244, v250, v249
    v_mfma_f32_16x16x32_bf16 v[40:43], a[240:243], v[236:239], v[40:43]
    v_cvt_pk_bf16_f32 v247, v209, v208
    v_cvt_pkrtz_f16_f32 v211, v176, v177
    v_pk_lshrrev_b16 v211, 3, v211 op_sel_hi:[0,1]
    v_mfma_f32_16x16x32_bf16 v[36:39], a[244:247], v[232:235], v[36:39]
    v_mad_u32_u16 v212, v211, 2, s85
    v_mad_u32_u16 v211, v211, 2, s85 op_sel:[1,0,0,0]
    v_cvt_pkrtz_f16_f32 v213, v178, v179
    v_mfma_f32_16x16x32_bf16 v[44:47], a[244:247], v[236:239], v[44:47]
    s_waitcnt lgkmcnt(5)
    ds_read_u16 v212, v212
    ds_read_u16_d16_hi v211, v211
    v_or_b32 v245, v252, v251
    v_mfma_f32_16x16x32_bf16 v[80:83], a[240:243], v[240:243], v[80:83]
    v_pk_lshrrev_b16 v213, 3, v213 op_sel_hi:[0,1]
    v_mad_u32_u16 v214, v213, 2, s85
    v_mad_u32_u16 v213, v213, 2, s85 op_sel:[1,0,0,0]
    v_cvt_pkrtz_f16_f32 v215, v180, v181
    v_pk_lshrrev_b16 v215, 3, v215 op_sel_hi:[0,1]
    v_mad_u32_u16 v216, v215, 2, s85
    v_mad_u32_u16 v215, v215, 2, s85 op_sel:[1,0,0,0]
    v_cvt_pkrtz_f16_f32 v217, v182, v183
    v_pk_lshrrev_b16 v217, 3, v217 op_sel_hi:[0,1]
    v_mad_u32_u16 v218, v217, 2, s85
    v_mad_u32_u16 v217, v217, 2, s85 op_sel:[1,0,0,0]
    v_cvt_pkrtz_f16_f32 v219, v184, v185
    s_waitcnt lgkmcnt(4)
    v_or_b32 v246, v0, v253
    v_pk_lshrrev_b16 v219, 3, v219 op_sel_hi:[0,1]
    v_mad_u32_u16 v220, v219, 2, s85
    v_mfma_f32_16x16x32_bf16 v[88:91], a[240:243], v[244:247], v[88:91]
    ds_read_u16 v214, v214
    ds_read_u16_d16_hi v213, v213
    v_mad_u32_u16 v219, v219, 2, s85 op_sel:[1,0,0,0]
    v_mfma_f32_16x16x32_bf16 v[48:51], a[248:251], v[232:235], v[48:51]
    ds_read_u16 v216, v216
    ds_read_u16_d16_hi v215, v215
    v_cvt_pkrtz_f16_f32 v221, v186, v187
    v_mfma_f32_16x16x32_bf16 v[56:59], a[248:251], v[236:239], v[56:59]
    ds_read_u16 v218, v218
    ds_read_u16_d16_hi v217, v217
    v_pk_lshrrev_b16 v221, 3, v221 op_sel_hi:[0,1]
    v_mfma_f32_16x16x32_bf16 v[84:87], a[244:247], v[240:243], v[84:87]
    ds_read_u16 v220, v220
    ds_read_u16_d16_hi v219, v219
    v_mad_u32_u16 v222, v221, 2, s85
    v_mfma_f32_16x16x32_bf16 v[92:95], a[244:247], v[244:247], v[92:95]
    ds_read_u16 v222, v222
    ds_read_b128 a[240:243], v23 offset:22528
    v_mad_u32_u16 v221, v221, 2, s85 op_sel:[1,0,0,0]
    v_mfma_f32_16x16x32_bf16 v[52:55], a[252:255], v[232:235], v[52:55]
    s_waitcnt lgkmcnt(12)
    ds_read_u16_d16_hi v221, v221
    ds_read_b128 a[244:247], v23 offset:23552
    v_cvt_pkrtz_f16_f32 v223, v188, v189
    v_mfma_f32_16x16x32_bf16 v[60:63], a[252:255], v[236:239], v[60:63]
    v_pk_lshrrev_b16 v223, 3, v223 op_sel_hi:[0,1]
    v_mad_u32_u16 v224, v223, 2, s85
    v_mad_u32_u16 v223, v223, 2, s85 op_sel:[1,0,0,0]
    v_mfma_f32_16x16x32_bf16 v[96:99], a[248:251], v[240:243], v[96:99]
    s_waitcnt lgkmcnt(13)
    ds_read_u16 v224, v224
    v_cvt_pkrtz_f16_f32 v227, v190, v191
    v_pk_fma_f16 v225, v227, v227, s53
    v_mfma_f32_16x16x32_bf16 v[104:107], a[248:251], v[244:247], v[104:107]
    s_waitcnt lgkmcnt(13)
    ds_read_u16_d16_hi v223, v223
    v_pk_mul_f16 v225, v225, v227 neg_lo:[1,0] neg_hi:[1,0]
    v_exp_f16 v226, v225
    v_mfma_f32_16x16x32_bf16 v[64:67], a[232:235], v[232:235], v[64:67]
    s_waitcnt lgkmcnt(13)
    v_exp_f16_sdwa v226, v225 dst_sel:WORD_1 dst_unused:UNUSED_PRESERVE src0_sel:WORD_1
    v_cvt_pkrtz_f16_f32 v228, v192, v193
    v_mfma_f32_16x16x32_bf16 v[72:75], a[232:235], v[236:239], v[72:75]
    s_add_u32 m0, s56, 8384
    ds_read_b128 a[248:251], v23 offset:24576
    buffer_load_dwordx4 v3, s[20:23], 0 offen offset:64 lds
    v_mfma_f32_16x16x32_bf16 v[100:103], a[252:255], v[240:243], v[100:103]
    v_pk_fma_f16 v226, v226, s86, s86
    v_rcp_f16 v225, v226
    v_mfma_f32_16x16x32_bf16 v[108:111], a[252:255], v[244:247], v[108:111]
    s_waitcnt lgkmcnt(13)
    ds_read_b128 a[252:255], v23 offset:25600
    v_rcp_f16_sdwa v225, v226 dst_sel:WORD_1 dst_unused:UNUSED_PRESERVE src0_sel:WORD_1
    v_mfma_f32_16x16x32_bf16 v[68:71], a[236:239], v[232:235], v[68:71]
    v_fma_mix_f32 v226, v225, v227, 0 op_sel_hi:[1,1,0]
    v_fma_mix_f32 v225, v225, v227, 0 op_sel:[1,1,0] op_sel_hi:[1,1,0]
    v_or_b32 v232, v212, v211
    v_mfma_f32_16x16x32_bf16 v[76:79], a[236:239], v[236:239], v[76:79]
    s_waitcnt lgkmcnt(10)
    v_or_b32 v233, v214, v213
    v_or_b32 v234, v216, v215
    v_or_b32 v235, v218, v217
    v_mfma_f32_16x16x32_bf16 v[112:115], a[232:235], v[240:243], v[112:115]
    s_waitcnt lgkmcnt(8)
    v_or_b32 v236, v220, v219
    v_cvt_pk_bf16_f32 v239, v226, v225
    v_pk_lshrrev_b16 v228, 3, v228 op_sel_hi:[0,1]
    v_mfma_f32_16x16x32_bf16 v[120:123], a[232:235], v[244:247], v[120:123]
    ds_read_b128 a[232:235], v23 offset:16384
    v_cvt_pkrtz_f16_f32 v230, v194, v195
    v_cvt_pkrtz_f16_f32 v248, v196, v197
    v_mfma_f32_16x16x32_bf16 v[116:119], a[236:239], v[240:243], v[116:119]
    v_cvt_pkrtz_f16_f32 v250, v198, v199
    v_cvt_pkrtz_f16_f32 v252, v200, v201
    v_cvt_pkrtz_f16_f32 v0, v202, v203
    v_mfma_f32_16x16x32_bf16 v[124:127], a[236:239], v[244:247], v[124:127]
    ds_read_b128 a[236:239], v23 offset:17408
    v_cvt_pkrtz_f16_f32 v209, v204, v205
    v_cvt_pkrtz_f16_f32 v211, v206, v207
    v_mfma_f32_16x16x32_f16 v[176:179], a[208:211], v[128:131], 0
    s_waitcnt lgkmcnt(7)
    v_or_b32 v237, v222, v221
    v_mad_u32_u16 v229, v228, 2, s85
    v_mad_u32_u16 v228, v228, 2, s85 op_sel:[1,0,0,0]
    v_mfma_f32_16x16x32_f16 v[184:187], a[208:211], v[132:135], 0
    ds_read_u16 v229, v229
    ds_read_u16_d16_hi v228, v228
    v_pk_lshrrev_b16 v230, 3, v230 op_sel_hi:[0,1]
    v_mfma_f32_16x16x32_f16 v[180:183], a[212:215], v[128:131], 0
    v_mad_u32_u16 v231, v230, 2, s85
    v_mad_u32_u16 v230, v230, 2, s85 op_sel:[1,0,0,0]
    v_pk_lshrrev_b16 v248, 3, v248 op_sel_hi:[0,1]
    v_mfma_f32_16x16x32_f16 v[188:191], a[212:215], v[132:135], 0
    s_waitcnt lgkmcnt(6)
    ds_read_u16 v231, v231
    ds_read_u16_d16_hi v230, v230
    v_or_b32 v238, v224, v223
    v_mfma_f32_16x16x32_f16 v[192:195], a[208:211], v[152:155], 0
    v_mad_u32_u16 v249, v248, 2, s85
    v_mad_u32_u16 v248, v248, 2, s85 op_sel:[1,0,0,0]
    v_pk_lshrrev_b16 v250, 3, v250 op_sel_hi:[0,1]
    v_mfma_f32_16x16x32_f16 v[200:203], a[208:211], v[156:159], 0
    ds_read_u16 v249, v249
    ds_read_u16_d16_hi v248, v248
    v_mad_u32_u16 v251, v250, 2, s85
    v_mfma_f32_16x16x32_f16 v[176:179], a[240:243], v[136:139], v[176:179]
    ds_read_u16 v251, v251
    v_mad_u32_u16 v250, v250, 2, s85 op_sel:[1,0,0,0]
    v_pk_lshrrev_b16 v252, 3, v252 op_sel_hi:[0,1]
    v_mfma_f32_16x16x32_f16 v[184:187], a[240:243], v[140:143], v[184:187]
    ds_read_u16_d16_hi v250, v250
    v_mad_u32_u16 v253, v252, 2, s85
    v_mad_u32_u16 v252, v252, 2, s85 op_sel:[1,0,0,0]
    v_mfma_f32_16x16x32_f16 v[196:199], a[212:215], v[152:155], 0
    ds_read_u16 v253, v253
    ds_read_u16_d16_hi v252, v252
    v_pk_lshrrev_b16 v0, 3, v0 op_sel_hi:[0,1]
    v_mfma_f32_16x16x32_f16 v[204:207], a[212:215], v[156:159], 0
    v_mad_u32_u16 v208, v0, 2, s85
    v_mad_u32_u16 v0, v0, 2, s85 op_sel:[1,0,0,0]
    v_pk_lshrrev_b16 v209, 3, v209 op_sel_hi:[0,1]
    v_mfma_f32_16x16x32_f16 v[180:183], a[244:247], v[136:139], v[180:183]
    s_waitcnt lgkmcnt(12)
    ds_read_u16 v208, v208
    ds_read_u16_d16_hi v0, v0
    v_mad_u32_u16 v210, v209, 2, s85
    v_mfma_f32_16x16x32_f16 v[188:191], a[244:247], v[140:143], v[188:191]
    s_waitcnt lgkmcnt(13)
    ds_read_u16 v210, v210
    v_mad_u32_u16 v209, v209, 2, s85 op_sel:[1,0,0,0]
    v_pk_lshrrev_b16 v211, 3, v211 op_sel_hi:[0,1]
    v_mfma_f32_16x16x32_f16 v[192:195], a[240:243], v[160:163], v[192:195]
    s_waitcnt lgkmcnt(11)
    ds_read_u16_d16_hi v209, v209
    v_mad_u32_u16 v212, v211, 2, s85
    v_mad_u32_u16 v211, v211, 2, s85 op_sel:[1,0,0,0]
    v_mfma_f32_16x16x32_f16 v[200:203], a[240:243], v[164:167], v[200:203]
    s_add_u32 m0, s56, 9408
    ds_read_u16 v212, v212
    buffer_load_dwordx4 v4, s[20:23], 0 offen offset:64 lds
    v_mfma_f32_16x16x32_f16 v[176:179], a[248:251], v[144:147], v[176:179]
    s_add_u32 m0, s56, 10432
    ds_read_u16_d16_hi v211, v211
    buffer_load_dwordx4 v5, s[20:23], 0 offen offset:64 lds
    v_mfma_f32_16x16x32_f16 v[184:187], a[248:251], v[148:151], v[184:187]
    s_waitcnt lgkmcnt(10)
    v_or_b32 v240, v229, v228
    v_or_b32 v241, v231, v230
    v_or_b32 v242, v249, v248
    v_mfma_f32_16x16x32_f16 v[196:199], a[244:247], v[160:163], v[196:199]
    ds_read_b128 a[240:243], v23 offset:18432
    v_cvt_pkrtz_f16_f32 v213, v176, v177
    v_pk_lshrrev_b16 v213, 3, v213 op_sel_hi:[0,1]
    v_mfma_f32_16x16x32_f16 v[204:207], a[244:247], v[164:167], v[204:207]
    ds_read_b128 a[244:247], v23 offset:19456
    v_mad_u32_u16 v214, v213, 2, s85
    v_mad_u32_u16 v213, v213, 2, s85 op_sel:[1,0,0,0]
    v_mfma_f32_16x16x32_f16 v[180:183], a[252:255], v[144:147], v[180:183]
    s_waitcnt lgkmcnt(10)
    v_cvt_pkrtz_f16_f32 v215, v178, v179
    v_or_b32 v243, v251, v250
    v_pk_lshrrev_b16 v215, 3, v215 op_sel_hi:[0,1]
    v_mfma_f32_16x16x32_f16 v[188:191], a[252:255], v[148:151], v[188:191]
    ds_read_u16 v214, v214
    v_mad_u32_u16 v216, v215, 2, s85
    v_mad_u32_u16 v215, v215, 2, s85 op_sel:[1,0,0,0]
    v_mfma_f32_16x16x32_f16 v[192:195], a[248:251], v[168:171], v[192:195]
    ds_read_u16_d16_hi v213, v213
    v_cvt_pkrtz_f16_f32 v217, v180, v181
    v_pk_lshrrev_b16 v217, 3, v217 op_sel_hi:[0,1]
    v_mfma_f32_16x16x32_f16 v[200:203], a[248:251], v[172:175], v[200:203]
    s_waitcnt lgkmcnt(10)
    ds_read_b128 a[248:251], v23 offset:10240
    v_or_b32 v244, v253, v252
    v_mad_u32_u16 v218, v217, 2, s85
    v_mfma_f32_16x16x32_f16 v[196:199], a[252:255], v[168:171], v[196:199]
    v_mad_u32_u16 v217, v217, 2, s85 op_sel:[1,0,0,0]
    v_cvt_pkrtz_f16_f32 v219, v182, v183
    v_pk_lshrrev_b16 v219, 3, v219 op_sel_hi:[0,1]
    v_mfma_f32_16x16x32_f16 v[204:207], a[252:255], v[172:175], v[204:207]
    ds_read_b128 a[252:255], v23 offset:11264
    v_mad_u32_u16 v220, v219, 2, s85
    v_mad_u32_u16 v219, v219, 2, s85 op_sel:[1,0,0,0]
    v_mfma_f32_16x16x32_bf16 v[32:35], a[232:235], v[232:235], v[32:35]
    s_waitcnt lgkmcnt(10)
    ds_read_u16 v216, v216
    v_or_b32 v245, v208, v0
    v_cvt_pkrtz_f16_f32 v221, v184, v185
    v_mfma_f32_16x16x32_bf16 v[40:43], a[232:235], v[236:239], v[40:43]
    v_pk_lshrrev_b16 v221, 3, v221 op_sel_hi:[0,1]
    v_mad_u32_u16 v222, v221, 2, s85
    v_mad_u32_u16 v221, v221, 2, s85 op_sel:[1,0,0,0]
    v_mfma_f32_16x16x32_bf16 v[36:39], a[236:239], v[232:235], v[36:39]
    ds_read_u16_d16_hi v215, v215
    v_cvt_pkrtz_f16_f32 v223, v186, v187
    v_pk_lshrrev_b16 v223, 3, v223 op_sel_hi:[0,1]
    v_mfma_f32_16x16x32_bf16 v[44:47], a[236:239], v[236:239], v[44:47]
    s_waitcnt lgkmcnt(10)
    ds_read_u16 v218, v218
    v_or_b32 v246, v210, v209
    v_mad_u32_u16 v224, v223, 2, s85
    v_mfma_f32_16x16x32_bf16 v[80:83], a[232:235], v[240:243], v[80:83]
    s_waitcnt lgkmcnt(10)
    v_mad_u32_u16 v223, v223, 2, s85 op_sel:[1,0,0,0]
    v_cvt_pkrtz_f16_f32 v225, v188, v189
    v_pk_lshrrev_b16 v225, 3, v225 op_sel_hi:[0,1]
    v_mad_u32_u16 v226, v225, 2, s85
    v_mad_u32_u16 v225, v225, 2, s85 op_sel:[1,0,0,0]
    v_cvt_pkrtz_f16_f32 v229, v190, v191
    v_pk_fma_f16 v227, v229, v229, s53
    v_pk_mul_f16 v227, v227, v229 neg_lo:[1,0] neg_hi:[1,0]
    v_exp_f16 v228, v227
    s_waitcnt lgkmcnt(9)
    v_or_b32 v247, v212, v211
    v_exp_f16_sdwa v228, v227 dst_sel:WORD_1 dst_unused:UNUSED_PRESERVE src0_sel:WORD_1
    v_cvt_pkrtz_f16_f32 v230, v192, v193
    v_mfma_f32_16x16x32_bf16 v[88:91], a[232:235], v[244:247], v[88:91]
    s_waitcnt lgkmcnt(8)
    ds_read_u16_d16_hi v217, v217
    ds_read_u16 v220, v220
    v_pk_fma_f16 v228, v228, s86, s86
    v_mfma_f32_16x16x32_bf16 v[48:51], a[240:243], v[232:235], v[48:51]
    ds_read_u16_d16_hi v219, v219
    ds_read_u16 v222, v222
    v_rcp_f16 v227, v228
    v_mfma_f32_16x16x32_bf16 v[56:59], a[240:243], v[236:239], v[56:59]
    ds_read_u16_d16_hi v221, v221
    v_rcp_f16_sdwa v227, v228 dst_sel:WORD_1 dst_unused:UNUSED_PRESERVE src0_sel:WORD_1
    v_mfma_f32_16x16x32_bf16 v[84:87], a[236:239], v[240:243], v[84:87]
    ds_read_u16 v224, v224
    v_fma_mix_f32 v228, v227, v229, 0 op_sel_hi:[1,1,0]
    v_fma_mix_f32 v227, v227, v229, 0 op_sel:[1,1,0] op_sel_hi:[1,1,0]
    v_mfma_f32_16x16x32_bf16 v[92:95], a[236:239], v[244:247], v[92:95]
    s_waitcnt lgkmcnt(13)
    ds_read_u16_d16_hi v223, v223
    v_pk_lshrrev_b16 v230, 3, v230 op_sel_hi:[0,1]
    v_cvt_pkrtz_f16_f32 v248, v194, v195
    v_mfma_f32_16x16x32_bf16 v[52:55], a[244:247], v[232:235], v[52:55]
    s_waitcnt lgkmcnt(13)
    ds_read_u16 v226, v226
    v_cvt_pkrtz_f16_f32 v250, v196, v197
    v_cvt_pkrtz_f16_f32 v252, v198, v199
    v_mfma_f32_16x16x32_bf16 v[60:63], a[244:247], v[236:239], v[60:63]
    s_waitcnt lgkmcnt(13)
    ds_read_u16_d16_hi v225, v225
    v_cvt_pkrtz_f16_f32 v0, v200, v201
    v_cvt_pkrtz_f16_f32 v209, v202, v203
    v_mfma_f32_16x16x32_bf16 v[96:99], a[240:243], v[240:243], v[96:99]
    v_cvt_pkrtz_f16_f32 v211, v204, v205
    v_mad_u32_u16 v231, v230, 2, s85
    v_mad_u32_u16 v230, v230, 2, s85 op_sel:[1,0,0,0]
    v_mfma_f32_16x16x32_bf16 v[104:107], a[240:243], v[244:247], v[104:107]
    s_waitcnt lgkmcnt(13)
    ds_read_b128 a[232:235], v23 offset:32768
    v_pk_lshrrev_b16 v248, 3, v248 op_sel_hi:[0,1]
    v_mad_u32_u16 v249, v248, 2, s85
    v_mfma_f32_16x16x32_bf16 v[64:67], a[248:251], v[232:235], v[64:67]
    s_waitcnt lgkmcnt(13)
    ds_read_b128 a[236:239], v23 offset:33792
    v_mad_u32_u16 v248, v248, 2, s85 op_sel:[1,0,0,0]
    v_pk_lshrrev_b16 v250, 3, v250 op_sel_hi:[0,1]
    v_mfma_f32_16x16x32_bf16 v[72:75], a[248:251], v[236:239], v[72:75]
    v_mad_u32_u16 v251, v250, 2, s85
    v_mad_u32_u16 v250, v250, 2, s85 op_sel:[1,0,0,0]
    v_pk_lshrrev_b16 v252, 3, v252 op_sel_hi:[0,1]
    v_mfma_f32_16x16x32_bf16 v[100:103], a[244:247], v[240:243], v[100:103]
    s_waitcnt lgkmcnt(13)
    ds_read_b128 a[240:243], v23 offset:34816
    v_mad_u32_u16 v253, v252, 2, s85
    v_mad_u32_u16 v252, v252, 2, s85 op_sel:[1,0,0,0]
    v_mfma_f32_16x16x32_bf16 v[108:111], a[244:247], v[244:247], v[108:111]
    s_waitcnt lgkmcnt(13)
    ds_read_b128 a[244:247], v23 offset:35840
    v_pk_lshrrev_b16 v0, 3, v0 op_sel_hi:[0,1]
    v_mad_u32_u16 v208, v0, 2, s85
    v_mfma_f32_16x16x32_bf16 v[68:71], a[252:255], v[232:235], v[68:71]
    s_waitcnt lgkmcnt(12)
    v_or_b32 v232, v214, v213
    v_or_b32 v233, v216, v215
    v_or_b32 v234, v218, v217
    v_mfma_f32_16x16x32_bf16 v[76:79], a[252:255], v[236:239], v[76:79]
    s_waitcnt lgkmcnt(10)
    ds_read_u16 v231, v231
    v_or_b32 v235, v220, v219
    v_cvt_pk_bf16_f32 v239, v228, v227
    v_mfma_f32_16x16x32_bf16 v[112:115], a[248:251], v[240:243], v[112:115]
    ds_read_u16_d16_hi v230, v230
    v_cvt_pkrtz_f16_f32 v215, v206, v207
    v_mad_u32_u16 v0, v0, 2, s85 op_sel:[1,0,0,0]
    v_mfma_f32_16x16x32_bf16 v[120:123], a[248:251], v[244:247], v[120:123]
    s_waitcnt lgkmcnt(10)
    ds_read_b128 a[248:251], v23 offset:26624
    v_or_b32 v236, v222, v221
    v_pk_lshrrev_b16 v209, 3, v209 op_sel_hi:[0,1]
    v_mfma_f32_16x16x32_bf16 v[116:119], a[252:255], v[240:243], v[116:119]
    v_mad_u32_u16 v210, v209, 2, s85
    v_mad_u32_u16 v209, v209, 2, s85 op_sel:[1,0,0,0]
    v_pk_lshrrev_b16 v211, 3, v211 op_sel_hi:[0,1]
    v_mfma_f32_16x16x32_bf16 v[124:127], a[252:255], v[244:247], v[124:127]
    ds_read_b128 a[252:255], v23 offset:27648
    v_mad_u32_u16 v212, v211, 2, s85
    v_mad_u32_u16 v211, v211, 2, s85 op_sel:[1,0,0,0]
    v_mfma_f32_16x16x32_f16 v[176:179], a[216:219], v[128:131], 0
    s_waitcnt lgkmcnt(10)
    ds_read_u16 v249, v249
    v_or_b32 v237, v224, v223
    v_pk_fma_f16 v213, v215, v215, s53
    v_mfma_f32_16x16x32_f16 v[184:187], a[216:219], v[132:135], 0
    v_pk_mul_f16 v213, v213, v215 neg_lo:[1,0] neg_hi:[1,0]
    v_exp_f16 v214, v213
    v_mfma_f32_16x16x32_f16 v[180:183], a[220:223], v[128:131], 0
    ds_read_u16_d16_hi v248, v248
    v_exp_f16_sdwa v214, v213 dst_sel:WORD_1 dst_unused:UNUSED_PRESERVE src0_sel:WORD_1
    v_mfma_f32_16x16x32_f16 v[188:191], a[220:223], v[132:135], 0
    s_waitcnt lgkmcnt(10)
    ds_read_u16 v251, v251
    v_or_b32 v238, v226, v225
    v_pk_fma_f16 v214, v214, s86, s86
    v_mfma_f32_16x16x32_f16 v[192:195], a[216:219], v[152:155], 0
    ds_read_u16_d16_hi v250, v250
    v_rcp_f16 v213, v214
    v_mfma_f32_16x16x32_f16 v[200:203], a[216:219], v[156:159], 0
    s_waitcnt lgkmcnt(11)
    ds_read_u16 v253, v253
    ds_read_u16_d16_hi v252, v252
    v_rcp_f16_sdwa v213, v214 dst_sel:WORD_1 dst_unused:UNUSED_PRESERVE src0_sel:WORD_1
    v_mfma_f32_16x16x32_f16 v[176:179], a[232:235], v[136:139], v[176:179]
    ds_read_u16 v208, v208
    v_fma_mix_f32 v214, v213, v215, 0 op_sel_hi:[1,1,0]
    v_fma_mix_f32 v213, v213, v215, 0 op_sel:[1,1,0] op_sel_hi:[1,1,0]
    v_mfma_f32_16x16x32_f16 v[184:187], a[232:235], v[140:143], v[184:187]
    v_cvt_pk_bf16_f32 v247, v214, v213
    v_mfma_f32_16x16x32_f16 v[196:199], a[220:223], v[152:155], 0
    s_waitcnt lgkmcnt(13)
    ds_read_u16_d16_hi v0, v0
    v_mfma_f32_16x16x32_f16 v[204:207], a[220:223], v[156:159], 0
    s_waitcnt lgkmcnt(10)
    ds_read_u16 v210, v210
    v_or_b32 v240, v231, v230
    v_mfma_f32_16x16x32_f16 v[180:183], a[236:239], v[136:139], v[180:183]
    ds_read_u16_d16_hi v209, v209
    v_mfma_f32_16x16x32_f16 v[188:191], a[236:239], v[140:143], v[188:191]
    ds_read_u16 v212, v212
    v_mfma_f32_16x16x32_f16 v[192:195], a[232:235], v[160:163], v[192:195]
    v_mfma_f32_16x16x32_f16 v[200:203], a[232:235], v[164:167], v[200:203]
    ds_read_u16_d16_hi v211, v211
    v_mfma_f32_16x16x32_f16 v[176:179], a[240:243], v[144:147], v[176:179]
    s_add_u32 m0, s56, 11456
    v_mfma_f32_16x16x32_f16 v[184:187], a[240:243], v[148:151], v[184:187]
    s_waitcnt lgkmcnt(13)
    ds_read_b128 a[232:235], v23 offset:28672
    buffer_load_dwordx4 v6, s[20:23], 0 offen offset:64 lds
    v_mfma_f32_16x16x32_f16 v[196:199], a[236:239], v[160:163], v[196:199]
    s_waitcnt lgkmcnt(11)
    v_or_b32 v241, v249, v248
    v_mfma_f32_16x16x32_f16 v[204:207], a[236:239], v[164:167], v[204:207]
    ds_read_b128 a[236:239], v23 offset:29696
    v_cvt_pkrtz_f16_f32 v216, v176, v177
    v_pk_lshrrev_b16 v216, 3, v216 op_sel_hi:[0,1]
    v_mfma_f32_16x16x32_f16 v[180:183], a[244:247], v[144:147], v[180:183]
    s_waitcnt lgkmcnt(10)
    v_or_b32 v242, v251, v250
    v_mad_u32_u16 v217, v216, 2, s85
    v_mad_u32_u16 v216, v216, 2, s85 op_sel:[1,0,0,0]
    v_mfma_f32_16x16x32_f16 v[188:191], a[244:247], v[148:151], v[188:191]
    ds_read_u16 v217, v217
    v_cvt_pkrtz_f16_f32 v218, v178, v179
    v_pk_lshrrev_b16 v218, 3, v218 op_sel_hi:[0,1]
    v_mfma_f32_16x16x32_f16 v[192:195], a[240:243], v[168:171], v[192:195]
    ds_read_u16_d16_hi v216, v216
    v_mad_u32_u16 v219, v218, 2, s85
    v_mad_u32_u16 v218, v218, 2, s85 op_sel:[1,0,0,0]
    v_mfma_f32_16x16x32_f16 v[200:203], a[240:243], v[172:175], v[200:203]
    s_waitcnt lgkmcnt(10)
    ds_read_b128 a[240:243], v23 offset:20480
    v_or_b32 v243, v253, v252
    v_cvt_pkrtz_f16_f32 v220, v180, v181
    v_mfma_f32_16x16x32_f16 v[196:199], a[244:247], v[168:171], v[196:199]
    v_pk_lshrrev_b16 v220, 3, v220 op_sel_hi:[0,1]
    v_mad_u32_u16 v221, v220, 2, s85
    v_mad_u32_u16 v220, v220, 2, s85 op_sel:[1,0,0,0]
    v_mfma_f32_16x16x32_f16 v[204:207], a[244:247], v[172:175], v[204:207]
    ds_read_b128 a[244:247], v23 offset:21504
    v_cvt_pkrtz_f16_f32 v222, v182, v183
    v_pk_lshrrev_b16 v222, 3, v222 op_sel_hi:[0,1]
    v_mfma_f32_16x16x32_bf16 v[32:35], a[248:251], v[232:235], v[32:35]
    s_waitcnt lgkmcnt(10)
    ds_read_u16 v219, v219
    v_or_b32 v244, v208, v0
    v_mad_u32_u16 v223, v222, 2, s85
    v_mfma_f32_16x16x32_bf16 v[40:43], a[248:251], v[236:239], v[40:43]
    v_mad_u32_u16 v222, v222, 2, s85 op_sel:[1,0,0,0]
    v_cvt_pkrtz_f16_f32 v224, v184, v185
    v_pk_lshrrev_b16 v224, 3, v224 op_sel_hi:[0,1]
    v_mfma_f32_16x16x32_bf16 v[36:39], a[252:255], v[232:235], v[36:39]
    ds_read_u16_d16_hi v218, v218
    v_mad_u32_u16 v225, v224, 2, s85
    v_mad_u32_u16 v224, v224, 2, s85 op_sel:[1,0,0,0]
    v_mfma_f32_16x16x32_bf16 v[44:47], a[252:255], v[236:239], v[44:47]
    s_waitcnt lgkmcnt(10)
    ds_read_u16 v221, v221
    v_or_b32 v245, v210, v209
    v_cvt_pkrtz_f16_f32 v226, v186, v187
    v_mfma_f32_16x16x32_bf16 v[80:83], a[248:251], v[240:243], v[80:83]
    s_waitcnt lgkmcnt(10)
    ds_read_u16_d16_hi v220, v220
    v_pk_lshrrev_b16 v226, 3, v226 op_sel_hi:[0,1]
    v_mad_u32_u16 v227, v226, 2, s85
    v_mad_u32_u16 v226, v226, 2, s85 op_sel:[1,0,0,0]
    v_cvt_pkrtz_f16_f32 v230, v188, v189
    v_cvt_pkrtz_f16_f32 v249, v190, v191
    v_pk_fma_f16 v228, v230, v230, s53
    s_waitcnt lgkmcnt(10)
    v_or_b32 v246, v212, v211
    v_pk_fma_f16 v231, v249, v249, s53
    v_pk_mul_f16 v228, v228, v230 neg_lo:[1,0] neg_hi:[1,0]
    v_mfma_f32_16x16x32_bf16 v[88:91], a[248:251], v[244:247], v[88:91]
    s_waitcnt lgkmcnt(9)
    ds_read_u16 v223, v223
    ds_read_u16_d16_hi v222, v222
    v_pk_mul_f16 v231, v231, v249 neg_lo:[1,0] neg_hi:[1,0]
    v_mfma_f32_16x16x32_bf16 v[48:51], a[232:235], v[232:235], v[48:51]
    ds_read_u16 v225, v225
    v_exp_f16 v229, v228
    v_mfma_f32_16x16x32_bf16 v[56:59], a[232:235], v[236:239], v[56:59]
    v_exp_f16 v248, v231
    v_exp_f16_sdwa v229, v228 dst_sel:WORD_1 dst_unused:UNUSED_PRESERVE src0_sel:WORD_1
    v_mfma_f32_16x16x32_bf16 v[84:87], a[252:255], v[240:243], v[84:87]
    ds_read_u16_d16_hi v224, v224
    v_exp_f16_sdwa v248, v231 dst_sel:WORD_1 dst_unused:UNUSED_PRESERVE src0_sel:WORD_1
    v_mfma_f32_16x16x32_bf16 v[92:95], a[252:255], v[244:247], v[92:95]
    s_waitcnt lgkmcnt(12)
    ds_read_u16 v227, v227
    ds_read_u16_d16_hi v226, v226
    v_pk_fma_f16 v229, v229, s86, s86
    v_mfma_f32_16x16x32_bf16 v[52:55], a[236:239], v[232:235], v[52:55]
    s_waitcnt lgkmcnt(13)
    ds_read_b128 a[248:251], v24 offset:0
    v_pk_fma_f16 v248, v248, s86, s86
    v_rcp_f16 v228, v229
    v_mfma_f32_16x16x32_bf16 v[60:63], a[236:239], v[236:239], v[60:63]
    v_rcp_f16 v231, v248
    v_rcp_f16_sdwa v228, v229 dst_sel:WORD_1 dst_unused:UNUSED_PRESERVE src0_sel:WORD_1
    v_mfma_f32_16x16x32_bf16 v[96:99], a[232:235], v[240:243], v[96:99]
    s_waitcnt lgkmcnt(13)
    ds_read_b128 a[252:255], v24 offset:1024
    v_rcp_f16_sdwa v231, v248 dst_sel:WORD_1 dst_unused:UNUSED_PRESERVE src0_sel:WORD_1
    v_mfma_f32_16x16x32_bf16 v[104:107], a[232:235], v[244:247], v[104:107]
    s_waitcnt lgkmcnt(13)
    ds_read_b128 a[232:235], v24 offset:2048
    v_fma_mix_f32 v229, v228, v230, 0 op_sel_hi:[1,1,0]
    v_fma_mix_f32 v248, v231, v249, 0 op_sel_hi:[1,1,0]
    v_mfma_f32_16x16x32_bf16 v[64:67], a[240:243], v[232:235], v[64:67]
    v_fma_mix_f32 v228, v228, v230, 0 op_sel:[1,1,0] op_sel_hi:[1,1,0]
    v_fma_mix_f32 v231, v231, v249, 0 op_sel:[1,1,0] op_sel_hi:[1,1,0]
    v_cvt_pkrtz_f16_f32 v250, v192, v193
    v_mfma_f32_16x16x32_bf16 v[72:75], a[240:243], v[236:239], v[72:75]
    v_pk_lshrrev_b16 v250, 3, v250 op_sel_hi:[0,1]
    v_cvt_pkrtz_f16_f32 v252, v194, v195
    v_cvt_pkrtz_f16_f32 v0, v196, v197
    v_mfma_f32_16x16x32_bf16 v[100:103], a[236:239], v[240:243], v[100:103]
    v_cvt_pkrtz_f16_f32 v209, v198, v199
    v_cvt_pkrtz_f16_f32 v211, v200, v201
    v_cvt_pkrtz_f16_f32 v213, v202, v203
    v_mfma_f32_16x16x32_bf16 v[108:111], a[236:239], v[244:247], v[108:111]
    s_waitcnt lgkmcnt(13)
    ds_read_b128 a[236:239], v24 offset:3072
    v_mad_u32_u16 v251, v250, 2, s85
    v_mad_u32_u16 v250, v250, 2, s85 op_sel:[1,0,0,0]
    v_mfma_f32_16x16x32_bf16 v[68:71], a[244:247], v[232:235], v[68:71]
    s_waitcnt lgkmcnt(12)
    ds_read_u16 v251, v251
    ds_read_u16_d16_hi v250, v250
    v_or_b32 v232, v217, v216
    v_mfma_f32_16x16x32_bf16 v[76:79], a[244:247], v[236:239], v[76:79]
    s_waitcnt lgkmcnt(10)
    v_or_b32 v233, v219, v218
    v_or_b32 v234, v221, v220
    v_or_b32 v235, v223, v222
    v_mfma_f32_16x16x32_bf16 v[112:115], a[240:243], v[240:243], v[112:115]
    s_add_u32 m0, s56, 12480
    v_cvt_pk_bf16_f32 v238, v229, v228
    v_cvt_pk_bf16_f32 v239, v248, v231
    v_cvt_pkrtz_f16_f32 v217, v204, v205
    v_mfma_f32_16x16x32_bf16 v[120:123], a[240:243], v[244:247], v[120:123]
    buffer_load_dword v7, s[20:23], 0 offen offset:64 lds
    ds_read_b128 a[240:243], v24 offset:4096
    v_mfma_f32_16x16x32_bf16 v[116:119], a[244:247], v[240:243], v[116:119]
    s_waitcnt lgkmcnt(9)
    v_or_b32 v236, v225, v224
    v_cvt_pkrtz_f16_f32 v220, v206, v207
    v_pk_lshrrev_b16 v252, 3, v252 op_sel_hi:[0,1]
    v_mfma_f32_16x16x32_bf16 v[124:127], a[244:247], v[244:247], v[124:127]
    s_waitcnt lgkmcnt(8)
    ds_read_b128 a[244:247], v24 offset:5120
    v_mad_u32_u16 v253, v252, 2, s85
    v_mad_u32_u16 v252, v252, 2, s85 op_sel:[1,0,0,0]
    v_pk_lshrrev_b16 v0, 3, v0 op_sel_hi:[0,1]
    v_mad_u32_u16 v208, v0, 2, s85
    s_waitcnt lgkmcnt(8)
    v_or_b32 v237, v227, v226
    v_mad_u32_u16 v0, v0, 2, s85 op_sel:[1,0,0,0]
    v_pk_lshrrev_b16 v209, 3, v209 op_sel_hi:[0,1]
    v_mad_u32_u16 v210, v209, 2, s85
    s_waitcnt lgkmcnt(7)
    v_mfma_f32_16x16x32_f16 v[176:179], a[248:251], v[128:131], 0
    ds_read_u16 v253, v253
    ds_read_u16_d16_hi v252, v252
    v_mad_u32_u16 v209, v209, 2, s85 op_sel:[1,0,0,0]
    v_mfma_f32_16x16x32_f16 v[184:187], a[248:251], v[132:135], 0
    s_waitcnt lgkmcnt(8)
    ds_read_u16 v208, v208
    ds_read_u16_d16_hi v0, v0
    v_pk_lshrrev_b16 v211, 3, v211 op_sel_hi:[0,1]
    v_mfma_f32_16x16x32_f16 v[180:183], a[252:255], v[128:131], 0
    ds_read_u16 v210, v210
    ds_read_u16_d16_hi v209, v209
    v_mad_u32_u16 v212, v211, 2, s85
    v_mfma_f32_16x16x32_f16 v[188:191], a[252:255], v[132:135], 0
    ds_read_u16 v212, v212
    v_mad_u32_u16 v211, v211, 2, s85 op_sel:[1,0,0,0]
    v_pk_lshrrev_b16 v213, 3, v213 op_sel_hi:[0,1]
    v_mfma_f32_16x16x32_f16 v[192:195], a[248:251], v[152:155], 0
    ds_read_u16_d16_hi v211, v211
    v_mad_u32_u16 v214, v213, 2, s85
    v_mad_u32_u16 v213, v213, 2, s85 op_sel:[1,0,0,0]
    v_mfma_f32_16x16x32_f16 v[200:203], a[248:251], v[156:159], 0
    s_waitcnt lgkmcnt(13)
    ds_read_u16 v214, v214
    v_pk_fma_f16 v215, v217, v217, s53
    v_pk_fma_f16 v218, v220, v220, s53
    v_mfma_f32_16x16x32_f16 v[176:179], a[232:235], v[136:139], v[176:179]
    s_waitcnt lgkmcnt(13)
    ds_read_u16_d16_hi v213, v213
    v_pk_mul_f16 v215, v215, v217 neg_lo:[1,0] neg_hi:[1,0]
    v_pk_mul_f16 v218, v218, v220 neg_lo:[1,0] neg_hi:[1,0]
    v_mfma_f32_16x16x32_f16 v[184:187], a[232:235], v[140:143], v[184:187]
    s_waitcnt lgkmcnt(13)
    ds_read_b128 a[248:251], v23 offset:36864
    v_exp_f16 v216, v215
    v_mfma_f32_16x16x32_f16 v[196:199], a[252:255], v[152:155], 0
    v_exp_f16 v219, v218
    v_exp_f16_sdwa v216, v215 dst_sel:WORD_1 dst_unused:UNUSED_PRESERVE src0_sel:WORD_1
    v_mfma_f32_16x16x32_f16 v[204:207], a[252:255], v[156:159], 0
    s_waitcnt lgkmcnt(13)
    ds_read_b128 a[252:255], v23 offset:37888
    v_exp_f16_sdwa v219, v218 dst_sel:WORD_1 dst_unused:UNUSED_PRESERVE src0_sel:WORD_1
    v_mfma_f32_16x16x32_f16 v[180:183], a[236:239], v[136:139], v[180:183]
    v_pk_fma_f16 v216, v216, s86, s86
    v_pk_fma_f16 v219, v219, s86, s86
    v_rcp_f16 v215, v216
    v_mfma_f32_16x16x32_f16 v[188:191], a[236:239], v[140:143], v[188:191]
    v_rcp_f16 v218, v219
    v_rcp_f16_sdwa v215, v216 dst_sel:WORD_1 dst_unused:UNUSED_PRESERVE src0_sel:WORD_1
    v_mfma_f32_16x16x32_f16 v[192:195], a[232:235], v[160:163], v[192:195]
    v_rcp_f16_sdwa v218, v219 dst_sel:WORD_1 dst_unused:UNUSED_PRESERVE src0_sel:WORD_1
    v_fma_mix_f32 v216, v215, v217, 0 op_sel_hi:[1,1,0]
    v_mfma_f32_16x16x32_f16 v[200:203], a[232:235], v[164:167], v[200:203]
    s_waitcnt lgkmcnt(13)
    ds_read_b128 a[232:235], v23 offset:38912
    v_fma_mix_f32 v219, v218, v220, 0 op_sel_hi:[1,1,0]
    v_fma_mix_f32 v215, v215, v217, 0 op_sel:[1,1,0] op_sel_hi:[1,1,0]
    v_mfma_f32_16x16x32_f16 v[176:179], a[240:243], v[144:147], v[176:179]
    s_waitcnt lgkmcnt(11)
    v_fma_mix_f32 v218, v218, v220, 0 op_sel:[1,1,0] op_sel_hi:[1,1,0]
    v_or_b32 v240, v251, v250
    v_or_b32 v241, v253, v252
    v_mfma_f32_16x16x32_f16 v[184:187], a[240:243], v[148:151], v[184:187]
    s_waitcnt lgkmcnt(7)
    v_or_b32 v242, v208, v0
    v_or_b32 v243, v210, v209
    v_cvt_pk_bf16_f32 v246, v216, v215
    v_mfma_f32_16x16x32_f16 v[196:199], a[236:239], v[160:163], v[196:199]
    v_cvt_pk_bf16_f32 v247, v219, v218
    v_cvt_pkrtz_f16_f32 v221, v176, v177
    v_pk_lshrrev_b16 v221, 3, v221 op_sel_hi:[0,1]
    v_mfma_f32_16x16x32_f16 v[204:207], a[236:239], v[164:167], v[204:207]
    ds_read_b128 a[236:239], v23 offset:39936
    v_mad_u32_u16 v222, v221, 2, s85
    v_mad_u32_u16 v221, v221, 2, s85 op_sel:[1,0,0,0]
    v_mfma_f32_16x16x32_f16 v[180:183], a[244:247], v[144:147], v[180:183]
    s_add_u32 m0, s56, 0
    ds_read_u16 v222, v222
    buffer_load_dwordx4 v1, s[20:23], 0 offen offset:0 lds
    v_mfma_f32_16x16x32_f16 v[188:191], a[244:247], v[148:151], v[188:191]
    s_waitcnt lgkmcnt(7)
    ds_read_u16_d16_hi v221, v221
    v_or_b32 v244, v212, v211
    v_cvt_pkrtz_f16_f32 v223, v178, v179
    v_mfma_f32_16x16x32_f16 v[192:195], a[240:243], v[168:171], v[192:195]
    s_waitcnt lgkmcnt(6)
    v_pk_lshrrev_b16 v223, 3, v223 op_sel_hi:[0,1]
    v_mad_u32_u16 v224, v223, 2, s85
    v_or_b32 v245, v214, v213
    v_mfma_f32_16x16x32_f16 v[200:203], a[240:243], v[172:175], v[200:203]
    ds_read_b128 a[240:243], v23 offset:30720
    ds_read_u16 v224, v224
    v_mad_u32_u16 v223, v223, 2, s85 op_sel:[1,0,0,0]
    v_mfma_f32_16x16x32_f16 v[196:199], a[244:247], v[168:171], v[196:199]
    ds_read_u16_d16_hi v223, v223
    v_cvt_pkrtz_f16_f32 v225, v180, v181
    v_pk_lshrrev_b16 v225, 3, v225 op_sel_hi:[0,1]
    v_mfma_f32_16x16x32_f16 v[204:207], a[244:247], v[172:175], v[204:207]
    s_waitcnt lgkmcnt(8)
    ds_read_b128 a[244:247], v23 offset:31744
    v_mad_u32_u16 v226, v225, 2, s85
    v_mad_u32_u16 v225, v225, 2, s85 op_sel:[1,0,0,0]
    v_mfma_f32_16x16x32_bf16 v[32:35], a[248:251], v[232:235], v[32:35]
    ds_read_u16 v226, v226
    ds_read_u16_d16_hi v225, v225
    v_cvt_pkrtz_f16_f32 v227, v182, v183
    v_mfma_f32_16x16x32_bf16 v[40:43], a[248:251], v[236:239], v[40:43]
    s_waitcnt lgkmcnt(10)
    v_pk_lshrrev_b16 v227, 3, v227 op_sel_hi:[0,1]
    v_mad_u32_u16 v228, v227, 2, s85
    v_mad_u32_u16 v227, v227, 2, s85 op_sel:[1,0,0,0]
    v_mfma_f32_16x16x32_bf16 v[36:39], a[252:255], v[232:235], v[36:39]
    ds_read_u16 v228, v228
    ds_read_u16_d16_hi v227, v227
    v_cvt_pkrtz_f16_f32 v229, v184, v185
    v_mfma_f32_16x16x32_bf16 v[44:47], a[252:255], v[236:239], v[44:47]
    v_pk_lshrrev_b16 v229, 3, v229 op_sel_hi:[0,1]
    v_mad_u32_u16 v230, v229, 2, s85
    v_mad_u32_u16 v229, v229, 2, s85 op_sel:[1,0,0,0]
    v_mfma_f32_16x16x32_bf16 v[80:83], a[248:251], v[240:243], v[80:83]
    ds_read_u16 v230, v230
    ds_read_u16_d16_hi v229, v229
    v_cvt_pkrtz_f16_f32 v231, v186, v187
    v_mfma_f32_16x16x32_bf16 v[88:91], a[248:251], v[244:247], v[88:91]
    s_waitcnt lgkmcnt(13)
    ds_read_b128 a[248:251], v24 offset:12288
    v_pk_lshrrev_b16 v231, 3, v231 op_sel_hi:[0,1]
    v_mad_u32_u16 v248, v231, 2, s85
    v_mfma_f32_16x16x32_bf16 v[48:51], a[232:235], v[232:235], v[48:51]
    s_waitcnt lgkmcnt(13)
    ds_read_u16 v248, v248
    v_mad_u32_u16 v231, v231, 2, s85 op_sel:[1,0,0,0]
    v_cvt_pkrtz_f16_f32 v249, v188, v189
    v_mfma_f32_16x16x32_bf16 v[56:59], a[232:235], v[236:239], v[56:59]
    s_waitcnt lgkmcnt(13)
    ds_read_u16_d16_hi v231, v231
    v_pk_lshrrev_b16 v249, 3, v249 op_sel_hi:[0,1]
    v_mad_u32_u16 v250, v249, 2, s85
    v_mfma_f32_16x16x32_bf16 v[84:87], a[252:255], v[240:243], v[84:87]
    s_waitcnt lgkmcnt(13)
    ds_read_u16 v250, v250
    v_mad_u32_u16 v249, v249, 2, s85 op_sel:[1,0,0,0]
    v_cvt_pkrtz_f16_f32 v253, v190, v191
    v_mfma_f32_16x16x32_bf16 v[92:95], a[252:255], v[244:247], v[92:95]
    s_waitcnt lgkmcnt(12)
    ds_read_u16_d16_hi v249, v249
    ds_read_b128 a[252:255], v24 offset:13312
    v_pk_fma_f16 v251, v253, v253, s53
    v_mfma_f32_16x16x32_bf16 v[52:55], a[236:239], v[232:235], v[52:55]
    v_pk_mul_f16 v251, v251, v253 neg_lo:[1,0] neg_hi:[1,0]
    v_exp_f16 v252, v251
    v_mfma_f32_16x16x32_bf16 v[60:63], a[236:239], v[236:239], v[60:63]
    v_exp_f16_sdwa v252, v251 dst_sel:WORD_1 dst_unused:UNUSED_PRESERVE src0_sel:WORD_1
    v_cvt_pkrtz_f16_f32 v0, v192, v193
    v_mfma_f32_16x16x32_bf16 v[96:99], a[232:235], v[240:243], v[96:99]
    s_waitcnt lgkmcnt(13)
    v_pk_fma_f16 v252, v252, s86, s86
    v_rcp_f16 v251, v252
    v_mfma_f32_16x16x32_bf16 v[104:107], a[232:235], v[244:247], v[104:107]
    s_add_u32 m0, s56, 1024
    ds_read_b128 a[232:235], v24 offset:14336
    buffer_load_dwordx4 v2, s[20:23], 0 offen offset:0 lds
    v_mfma_f32_16x16x32_bf16 v[64:67], a[240:243], v[232:235], v[64:67]
    v_rcp_f16_sdwa v251, v252 dst_sel:WORD_1 dst_unused:UNUSED_PRESERVE src0_sel:WORD_1
    v_pk_lshrrev_b16 v0, 3, v0 op_sel_hi:[0,1]
    v_mfma_f32_16x16x32_bf16 v[72:75], a[240:243], v[236:239], v[72:75]
    v_fma_mix_f32 v252, v251, v253, 0 op_sel_hi:[1,1,0]
    v_fma_mix_f32 v251, v251, v253, 0 op_sel:[1,1,0] op_sel_hi:[1,1,0]
    v_cvt_pkrtz_f16_f32 v209, v194, v195
    v_mfma_f32_16x16x32_bf16 v[100:103], a[236:239], v[240:243], v[100:103]
    v_cvt_pkrtz_f16_f32 v211, v196, v197
    v_cvt_pkrtz_f16_f32 v213, v198, v199
    v_cvt_pkrtz_f16_f32 v215, v200, v201
    v_mfma_f32_16x16x32_bf16 v[108:111], a[236:239], v[244:247], v[108:111]
    s_waitcnt lgkmcnt(13)
    ds_read_b128 a[236:239], v24 offset:15360
    v_cvt_pkrtz_f16_f32 v217, v202, v203
    v_cvt_pkrtz_f16_f32 v219, v204, v205
    v_mfma_f32_16x16x32_bf16 v[68:71], a[244:247], v[232:235], v[68:71]
    s_waitcnt lgkmcnt(12)
    v_or_b32 v232, v222, v221
    v_or_b32 v233, v224, v223
    v_or_b32 v234, v226, v225
    v_mfma_f32_16x16x32_bf16 v[76:79], a[244:247], v[236:239], v[76:79]
    s_waitcnt lgkmcnt(5)
    v_or_b32 v235, v228, v227
    v_or_b32 v236, v230, v229
    v_or_b32 v237, v248, v231
    v_mfma_f32_16x16x32_bf16 v[112:115], a[240:243], v[240:243], v[112:115]
    v_cvt_pk_bf16_f32 v239, v252, v251
    v_cvt_pkrtz_f16_f32 v223, v206, v207
    v_mad_u32_u16 v208, v0, 2, s85
    v_mfma_f32_16x16x32_bf16 v[120:123], a[240:243], v[244:247], v[120:123]
    ds_read_b128 a[240:243], v24 offset:16384
    ds_read_u16 v208, v208
    v_mad_u32_u16 v0, v0, 2, s85 op_sel:[1,0,0,0]
    v_mfma_f32_16x16x32_bf16 v[116:119], a[244:247], v[240:243], v[116:119]
    s_waitcnt lgkmcnt(5)
    ds_read_u16_d16_hi v0, v0
    v_pk_lshrrev_b16 v209, 3, v209 op_sel_hi:[0,1]
    v_or_b32 v238, v250, v249
    v_mfma_f32_16x16x32_bf16 v[124:127], a[244:247], v[244:247], v[124:127]
    ds_read_b128 a[244:247], v24 offset:17408
    v_mad_u32_u16 v210, v209, 2, s85
    v_mad_u32_u16 v209, v209, 2, s85 op_sel:[1,0,0,0]
    v_mfma_f32_16x16x32_f16 v[176:179], a[248:251], v[128:131], 0
    ds_read_u16 v210, v210
    ds_read_u16_d16_hi v209, v209
    v_pk_lshrrev_b16 v211, 3, v211 op_sel_hi:[0,1]
    v_mfma_f32_16x16x32_f16 v[184:187], a[248:251], v[132:135], 0
    s_waitcnt lgkmcnt(8)
    v_mad_u32_u16 v212, v211, 2, s85
    v_mad_u32_u16 v211, v211, 2, s85 op_sel:[1,0,0,0]
    v_pk_lshrrev_b16 v213, 3, v213 op_sel_hi:[0,1]
    v_mfma_f32_16x16x32_f16 v[180:183], a[252:255], v[128:131], 0
    ds_read_u16 v212, v212
    ds_read_u16_d16_hi v211, v211
    v_mad_u32_u16 v214, v213, 2, s85
    v_mfma_f32_16x16x32_f16 v[188:191], a[252:255], v[132:135], 0
    ds_read_u16 v214, v214
    v_mad_u32_u16 v213, v213, 2, s85 op_sel:[1,0,0,0]
    v_pk_lshrrev_b16 v215, 3, v215 op_sel_hi:[0,1]
    v_mfma_f32_16x16x32_f16 v[192:195], a[248:251], v[152:155], 0
    ds_read_u16_d16_hi v213, v213
    v_mad_u32_u16 v216, v215, 2, s85
    v_mad_u32_u16 v215, v215, 2, s85 op_sel:[1,0,0,0]
    v_mfma_f32_16x16x32_f16 v[200:203], a[248:251], v[156:159], 0
    s_waitcnt lgkmcnt(11)
    ds_read_u16 v216, v216
    ds_read_u16_d16_hi v215, v215
    v_pk_lshrrev_b16 v217, 3, v217 op_sel_hi:[0,1]
    v_mfma_f32_16x16x32_f16 v[176:179], a[232:235], v[136:139], v[176:179]
    ds_read_b128 a[248:251], v24 offset:6144
    v_mad_u32_u16 v218, v217, 2, s85
    v_mad_u32_u16 v217, v217, 2, s85 op_sel:[1,0,0,0]
    v_mfma_f32_16x16x32_f16 v[184:187], a[232:235], v[140:143], v[184:187]
    s_waitcnt lgkmcnt(12)
    ds_read_u16 v218, v218
    ds_read_u16_d16_hi v217, v217
    v_pk_lshrrev_b16 v219, 3, v219 op_sel_hi:[0,1]
    v_mfma_f32_16x16x32_f16 v[196:199], a[252:255], v[152:155], 0
    v_mad_u32_u16 v220, v219, 2, s85
    v_mad_u32_u16 v219, v219, 2, s85 op_sel:[1,0,0,0]
    v_pk_fma_f16 v221, v223, v223, s53
    v_mfma_f32_16x16x32_f16 v[204:207], a[252:255], v[156:159], 0
    s_waitcnt lgkmcnt(12)
    ds_read_u16 v220, v220
    ds_read_u16_d16_hi v219, v219
    v_pk_mul_f16 v221, v221, v223 neg_lo:[1,0] neg_hi:[1,0]
    v_mfma_f32_16x16x32_f16 v[180:183], a[236:239], v[136:139], v[180:183]
    s_waitcnt lgkmcnt(13)
    ds_read_b128 a[252:255], v24 offset:7168
    v_exp_f16 v222, v221
    v_mfma_f32_16x16x32_f16 v[188:191], a[236:239], v[140:143], v[188:191]
    s_add_u32 m0, s56, 2048
    v_exp_f16_sdwa v222, v221 dst_sel:WORD_1 dst_unused:UNUSED_PRESERVE src0_sel:WORD_1
    v_or_b32 v240, v208, v0
    v_mfma_f32_16x16x32_f16 v[192:195], a[232:235], v[160:163], v[192:195]
    buffer_load_dwordx4 v3, s[20:23], 0 offen offset:0 lds
    v_pk_fma_f16 v222, v222, s86, s86
    v_mfma_f32_16x16x32_f16 v[200:203], a[232:235], v[164:167], v[200:203]
    s_waitcnt lgkmcnt(13)
    ds_read_b128 a[232:235], v24 offset:8192
    v_rcp_f16 v221, v222
    v_mfma_f32_16x16x32_f16 v[176:179], a[240:243], v[144:147], v[176:179]
    s_waitcnt lgkmcnt(13)
    v_rcp_f16_sdwa v221, v222 dst_sel:WORD_1 dst_unused:UNUSED_PRESERVE src0_sel:WORD_1
    v_or_b32 v241, v210, v209
    v_mfma_f32_16x16x32_f16 v[184:187], a[240:243], v[148:151], v[184:187]
    s_waitcnt lgkmcnt(11)
    v_fma_mix_f32 v222, v221, v223, 0 op_sel_hi:[1,1,0]
    v_fma_mix_f32 v221, v221, v223, 0 op_sel:[1,1,0] op_sel_hi:[1,1,0]
    v_or_b32 v242, v212, v211
    v_mfma_f32_16x16x32_f16 v[196:199], a[236:239], v[160:163], v[196:199]
    s_waitcnt lgkmcnt(9)
    v_or_b32 v243, v214, v213
    v_cvt_pk_bf16_f32 v247, v222, v221
    v_cvt_pkrtz_f16_f32 v224, v176, v177
    v_mfma_f32_16x16x32_f16 v[204:207], a[236:239], v[164:167], v[204:207]
    s_waitcnt lgkmcnt(7)
    ds_read_b128 a[236:239], v24 offset:9216
    v_or_b32 v244, v216, v215
    v_pk_lshrrev_b16 v224, 3, v224 op_sel_hi:[0,1]
    v_mfma_f32_16x16x32_f16 v[180:183], a[244:247], v[144:147], v[180:183]
    v_mad_u32_u16 v225, v224, 2, s85
    v_mad_u32_u16 v224, v224, 2, s85 op_sel:[1,0,0,0]
    v_cvt_pkrtz_f16_f32 v226, v178, v179
    v_mfma_f32_16x16x32_f16 v[188:191], a[244:247], v[148:151], v[188:191]
    ds_read_u16 v225, v225
    ds_read_u16_d16_hi v224, v224
    v_pk_lshrrev_b16 v226, 3, v226 op_sel_hi:[0,1]
    v_mfma_f32_16x16x32_f16 v[192:195], a[240:243], v[168:171], v[192:195]
    v_mad_u32_u16 v227, v226, 2, s85
    v_mad_u32_u16 v226, v226, 2, s85 op_sel:[1,0,0,0]
    v_cvt_pkrtz_f16_f32 v228, v180, v181
    v_mfma_f32_16x16x32_f16 v[200:203], a[240:243], v[172:175], v[200:203]
    s_waitcnt lgkmcnt(7)
    ds_read_b128 a[240:243], v24 offset:10240
    ds_read_u16 v227, v227
    v_or_b32 v245, v218, v217
    v_mfma_f32_16x16x32_f16 v[196:199], a[244:247], v[168:171], v[196:199]
    ds_read_u16_d16_hi v226, v226
    v_pk_lshrrev_b16 v228, 3, v228 op_sel_hi:[0,1]
    v_mad_u32_u16 v229, v228, 2, s85
    v_mfma_f32_16x16x32_f16 v[204:207], a[244:247], v[172:175], v[204:207]
    s_waitcnt lgkmcnt(8)
    ds_read_b128 a[244:247], v24 offset:11264
    ds_read_u16 v229, v229
    v_or_b32 v246, v220, v219
    v_mfma_f32_16x16x32_bf16 v[32:35], a[248:251], v[232:235], v[32:35]
    v_mad_u32_u16 v228, v228, 2, s85 op_sel:[1,0,0,0]
    v_cvt_pkrtz_f16_f32 v230, v182, v183
    v_pk_lshrrev_b16 v230, 3, v230 op_sel_hi:[0,1]
    v_mfma_f32_16x16x32_bf16 v[40:43], a[248:251], v[236:239], v[40:43]
    s_waitcnt lgkmcnt(9)
    ds_read_u16_d16_hi v228, v228
    v_mad_u32_u16 v231, v230, 2, s85
    v_mad_u32_u16 v230, v230, 2, s85 op_sel:[1,0,0,0]
    v_mfma_f32_16x16x32_bf16 v[36:39], a[252:255], v[232:235], v[36:39]
    ds_read_u16 v231, v231
    ds_read_u16_d16_hi v230, v230
    v_cvt_pkrtz_f16_f32 v248, v184, v185
    v_mfma_f32_16x16x32_bf16 v[44:47], a[252:255], v[236:239], v[44:47]
    v_pk_lshrrev_b16 v248, 3, v248 op_sel_hi:[0,1]
    v_mad_u32_u16 v249, v248, 2, s85
    v_mad_u32_u16 v248, v248, 2, s85 op_sel:[1,0,0,0]
    v_mfma_f32_16x16x32_bf16 v[80:83], a[248:251], v[240:243], v[80:83]
    ds_read_u16 v249, v249
    ds_read_u16_d16_hi v248, v248
    v_cvt_pkrtz_f16_f32 v250, v186, v187
    v_mfma_f32_16x16x32_bf16 v[88:91], a[248:251], v[244:247], v[88:91]
    s_waitcnt lgkmcnt(13)
    ds_read_b128 a[248:251], v24 offset:24576
    v_pk_lshrrev_b16 v250, 3, v250 op_sel_hi:[0,1]
    v_mad_u32_u16 v251, v250, 2, s85
    v_mfma_f32_16x16x32_bf16 v[48:51], a[232:235], v[232:235], v[48:51]
    s_waitcnt lgkmcnt(13)
    ds_read_u16 v251, v251
    v_mad_u32_u16 v250, v250, 2, s85 op_sel:[1,0,0,0]
    v_cvt_pkrtz_f16_f32 v0, v188, v189
    v_mfma_f32_16x16x32_bf16 v[56:59], a[232:235], v[236:239], v[56:59]
    s_waitcnt lgkmcnt(13)
    ds_read_u16_d16_hi v250, v250
    v_cvt_pkrtz_f16_f32 v210, v190, v191
    v_pk_fma_f16 v252, v0, v0, s53
    v_mfma_f32_16x16x32_bf16 v[84:87], a[252:255], v[240:243], v[84:87]
    v_pk_fma_f16 v208, v210, v210, s53
    v_pk_mul_f16 v252, v252, v0 neg_lo:[1,0] neg_hi:[1,0]
    v_pk_mul_f16 v208, v208, v210 neg_lo:[1,0] neg_hi:[1,0]
    v_mfma_f32_16x16x32_bf16 v[92:95], a[252:255], v[244:247], v[92:95]
    s_waitcnt lgkmcnt(13)
    ds_read_b128 a[252:255], v24 offset:25600
    v_exp_f16 v253, v252
    v_mfma_f32_16x16x32_bf16 v[52:55], a[236:239], v[232:235], v[52:55]
    v_exp_f16 v209, v208
    v_exp_f16_sdwa v253, v252 dst_sel:WORD_1 dst_unused:UNUSED_PRESERVE src0_sel:WORD_1
    v_mfma_f32_16x16x32_bf16 v[60:63], a[236:239], v[236:239], v[60:63]
    v_exp_f16_sdwa v209, v208 dst_sel:WORD_1 dst_unused:UNUSED_PRESERVE src0_sel:WORD_1
    v_pk_fma_f16 v253, v253, s86, s86
    v_mfma_f32_16x16x32_bf16 v[96:99], a[232:235], v[240:243], v[96:99]
    s_add_u32 m0, s56, 3072
    v_pk_fma_f16 v209, v209, s86, s86
    v_rcp_f16 v252, v253
    v_mfma_f32_16x16x32_bf16 v[104:107], a[232:235], v[244:247], v[104:107]
    s_waitcnt lgkmcnt(13)
    buffer_load_dwordx4 v4, s[20:23], 0 offen offset:0 lds
    ds_read_b128 a[232:235], v24 offset:26624
    v_mfma_f32_16x16x32_bf16 v[64:67], a[240:243], v[232:235], v[64:67]
    v_rcp_f16 v208, v209
    v_rcp_f16_sdwa v252, v253 dst_sel:WORD_1 dst_unused:UNUSED_PRESERVE src0_sel:WORD_1
    v_mfma_f32_16x16x32_bf16 v[72:75], a[240:243], v[236:239], v[72:75]
    v_rcp_f16_sdwa v208, v209 dst_sel:WORD_1 dst_unused:UNUSED_PRESERVE src0_sel:WORD_1
    v_fma_mix_f32 v253, v252, v0, 0 op_sel_hi:[1,1,0]
    v_mfma_f32_16x16x32_bf16 v[100:103], a[236:239], v[240:243], v[100:103]
    v_fma_mix_f32 v209, v208, v210, 0 op_sel_hi:[1,1,0]
    v_fma_mix_f32 v252, v252, v0, 0 op_sel:[1,1,0] op_sel_hi:[1,1,0]
    v_fma_mix_f32 v208, v208, v210, 0 op_sel:[1,1,0] op_sel_hi:[1,1,0]
    v_mfma_f32_16x16x32_bf16 v[108:111], a[236:239], v[244:247], v[108:111]
    s_waitcnt lgkmcnt(11)
    ds_read_b128 a[236:239], v24 offset:27648
    v_cvt_pkrtz_f16_f32 v211, v192, v193
    v_pk_lshrrev_b16 v211, 3, v211 op_sel_hi:[0,1]
    v_mfma_f32_16x16x32_bf16 v[68:71], a[244:247], v[232:235], v[68:71]
    s_waitcnt lgkmcnt(10)
    v_or_b32 v232, v225, v224
    v_or_b32 v233, v227, v226
    v_or_b32 v234, v229, v228
    v_mfma_f32_16x16x32_bf16 v[76:79], a[244:247], v[236:239], v[76:79]
    s_waitcnt lgkmcnt(6)
    v_or_b32 v235, v231, v230
    v_or_b32 v236, v249, v248
    v_cvt_pk_bf16_f32 v238, v253, v252
    v_mfma_f32_16x16x32_bf16 v[112:115], a[240:243], v[240:243], v[112:115]
    v_cvt_pk_bf16_f32 v239, v209, v208
    v_cvt_pkrtz_f16_f32 v213, v194, v195
    v_cvt_pkrtz_f16_f32 v215, v196, v197
    v_mfma_f32_16x16x32_bf16 v[120:123], a[240:243], v[244:247], v[120:123]
    s_waitcnt lgkmcnt(3)
    ds_read_b128 a[240:243], v24 offset:28672
    v_or_b32 v237, v251, v250
    v_cvt_pkrtz_f16_f32 v217, v198, v199
    v_mfma_f32_16x16x32_bf16 v[116:119], a[244:247], v[240:243], v[116:119]
    v_cvt_pkrtz_f16_f32 v219, v200, v201
    v_cvt_pkrtz_f16_f32 v221, v202, v203
    v_cvt_pkrtz_f16_f32 v223, v204, v205
    v_mfma_f32_16x16x32_bf16 v[124:127], a[244:247], v[244:247], v[124:127]
    ds_read_b128 a[244:247], v24 offset:29696
    v_cvt_pkrtz_f16_f32 v225, v206, v207
    v_mad_u32_u16 v212, v211, 2, s85
    v_mfma_f32_16x16x32_f16 v[176:179], a[248:251], v[128:131], 0
    ds_read_u16 v212, v212
    v_mad_u32_u16 v211, v211, 2, s85 op_sel:[1,0,0,0]
    v_pk_lshrrev_b16 v213, 3, v213 op_sel_hi:[0,1]
    v_mfma_f32_16x16x32_f16 v[184:187], a[248:251], v[132:135], 0
    s_waitcnt lgkmcnt(5)
    ds_read_u16_d16_hi v211, v211
    v_mad_u32_u16 v214, v213, 2, s85
    v_mad_u32_u16 v213, v213, 2, s85 op_sel:[1,0,0,0]
    v_mfma_f32_16x16x32_f16 v[180:183], a[252:255], v[128:131], 0
    ds_read_u16 v214, v214
    ds_read_u16_d16_hi v213, v213
    v_pk_lshrrev_b16 v215, 3, v215 op_sel_hi:[0,1]
    v_mfma_f32_16x16x32_f16 v[188:191], a[252:255], v[132:135], 0
    v_mad_u32_u16 v216, v215, 2, s85
    v_mad_u32_u16 v215, v215, 2, s85 op_sel:[1,0,0,0]
    v_pk_lshrrev_b16 v217, 3, v217 op_sel_hi:[0,1]
    v_mfma_f32_16x16x32_f16 v[192:195], a[248:251], v[152:155], 0
    ds_read_u16 v216, v216
    ds_read_u16_d16_hi v215, v215
    v_mad_u32_u16 v218, v217, 2, s85
    v_mfma_f32_16x16x32_f16 v[200:203], a[248:251], v[156:159], 0
    s_waitcnt lgkmcnt(9)
    ds_read_u16 v218, v218
    ds_read_b128 a[248:251], v24 offset:18432
    v_mad_u32_u16 v217, v217, 2, s85 op_sel:[1,0,0,0]
    v_mfma_f32_16x16x32_f16 v[176:179], a[232:235], v[136:139], v[176:179]
    s_add_u32 m0, s56, 4096
    ds_read_u16_d16_hi v217, v217
    buffer_load_dwordx4 v5, s[20:23], 0 offen offset:0 lds
    v_mfma_f32_16x16x32_f16 v[184:187], a[232:235], v[140:143], v[184:187]
    v_pk_lshrrev_b16 v219, 3, v219 op_sel_hi:[0,1]
    v_mad_u32_u16 v220, v219, 2, s85
    v_mad_u32_u16 v219, v219, 2, s85 op_sel:[1,0,0,0]
    v_mfma_f32_16x16x32_f16 v[196:199], a[252:255], v[152:155], 0
    ds_read_u16 v220, v220
    ds_read_u16_d16_hi v219, v219
    v_pk_lshrrev_b16 v221, 3, v221 op_sel_hi:[0,1]
    v_mfma_f32_16x16x32_f16 v[204:207], a[252:255], v[156:159], 0
    s_waitcnt lgkmcnt(13)
    ds_read_b128 a[252:255], v24 offset:19456
    v_mad_u32_u16 v222, v221, 2, s85
    v_mad_u32_u16 v221, v221, 2, s85 op_sel:[1,0,0,0]
    v_mfma_f32_16x16x32_f16 v[180:183], a[236:239], v[136:139], v[180:183]
    s_waitcnt lgkmcnt(12)
    ds_read_u16 v222, v222
    ds_read_u16_d16_hi v221, v221
    v_pk_lshrrev_b16 v223, 3, v223 op_sel_hi:[0,1]
    v_mfma_f32_16x16x32_f16 v[188:191], a[236:239], v[140:143], v[188:191]
    v_mad_u32_u16 v224, v223, 2, s85
    v_mad_u32_u16 v223, v223, 2, s85 op_sel:[1,0,0,0]
    v_pk_lshrrev_b16 v225, 3, v225 op_sel_hi:[0,1]
    v_mfma_f32_16x16x32_f16 v[192:195], a[232:235], v[160:163], v[192:195]
    s_waitcnt lgkmcnt(12)
    ds_read_u16 v224, v224
    ds_read_u16_d16_hi v223, v223
    v_mad_u32_u16 v226, v225, 2, s85
    v_mfma_f32_16x16x32_f16 v[200:203], a[232:235], v[164:167], v[200:203]
    s_waitcnt lgkmcnt(12)
    ds_read_u16 v226, v226
    ds_read_b128 a[232:235], v24 offset:20480
    v_mad_u32_u16 v225, v225, 2, s85 op_sel:[1,0,0,0]
    v_mfma_f32_16x16x32_f16 v[176:179], a[240:243], v[144:147], v[176:179]
    s_waitcnt lgkmcnt(13)
    ds_read_u16_d16_hi v225, v225
    v_or_b32 v240, v212, v211
    v_or_b32 v241, v214, v213
    v_mfma_f32_16x16x32_f16 v[184:187], a[240:243], v[148:151], v[184:187]
    s_waitcnt lgkmcnt(10)
    v_or_b32 v242, v216, v215
    v_or_b32 v243, v218, v217
    v_mfma_f32_16x16x32_f16 v[196:199], a[236:239], v[160:163], v[196:199]
    v_cvt_pkrtz_f16_f32 v227, v176, v177
    v_pk_lshrrev_b16 v227, 3, v227 op_sel_hi:[0,1]
    v_mad_u32_u16 v228, v227, 2, s85
    v_mfma_f32_16x16x32_f16 v[204:207], a[236:239], v[164:167], v[204:207]
    ds_read_b128 a[236:239], v24 offset:21504
    ds_read_u16 v228, v228
    v_mad_u32_u16 v227, v227, 2, s85 op_sel:[1,0,0,0]
    v_mfma_f32_16x16x32_f16 v[180:183], a[244:247], v[144:147], v[180:183]
    s_waitcnt lgkmcnt(10)
    ds_read_u16_d16_hi v227, v227
    v_or_b32 v244, v220, v219
    v_cvt_pkrtz_f16_f32 v229, v178, v179
    v_mfma_f32_16x16x32_f16 v[188:191], a[244:247], v[148:151], v[188:191]
    v_pk_lshrrev_b16 v229, 3, v229 op_sel_hi:[0,1]
    v_mad_u32_u16 v230, v229, 2, s85
    v_mad_u32_u16 v229, v229, 2, s85 op_sel:[1,0,0,0]
    v_mfma_f32_16x16x32_f16 v[192:195], a[240:243], v[168:171], v[192:195]
    ds_read_u16 v230, v230
    ds_read_u16_d16_hi v229, v229
    v_cvt_pkrtz_f16_f32 v231, v180, v181
    v_mfma_f32_16x16x32_f16 v[200:203], a[240:243], v[172:175], v[200:203]
    s_waitcnt lgkmcnt(10)
    v_pk_lshrrev_b16 v231, 3, v231 op_sel_hi:[0,1]
    v_or_b32 v245, v222, v221
    v_mad_u32_u16 v248, v231, 2, s85
    v_mfma_f32_16x16x32_f16 v[196:199], a[244:247], v[168:171], v[196:199]
    ds_read_b128 a[240:243], v24 offset:22528
    v_mad_u32_u16 v231, v231, 2, s85 op_sel:[1,0,0,0]
    v_cvt_pkrtz_f16_f32 v249, v182, v183
    v_mfma_f32_16x16x32_f16 v[204:207], a[244:247], v[172:175], v[204:207]
    ds_read_b128 a[244:247], v24 offset:23552
    v_pk_lshrrev_b16 v249, 3, v249 op_sel_hi:[0,1]
    v_mad_u32_u16 v250, v249, 2, s85
    v_mfma_f32_16x16x32_bf16 v[32:35], a[248:251], v[232:235], v[32:35]
    s_waitcnt lgkmcnt(10)
    v_mad_u32_u16 v249, v249, 2, s85 op_sel:[1,0,0,0]
    v_or_b32 v246, v224, v223
    v_cvt_pkrtz_f16_f32 v251, v184, v185
    v_mfma_f32_16x16x32_bf16 v[40:43], a[248:251], v[236:239], v[40:43]
    ds_read_u16 v248, v248
    v_pk_lshrrev_b16 v251, 3, v251 op_sel_hi:[0,1]
    v_mad_u32_u16 v252, v251, 2, s85
    v_mfma_f32_16x16x32_bf16 v[36:39], a[252:255], v[232:235], v[36:39]
    ds_read_u16_d16_hi v231, v231
    v_mad_u32_u16 v251, v251, 2, s85 op_sel:[1,0,0,0]
    v_cvt_pkrtz_f16_f32 v253, v186, v187
    v_mfma_f32_16x16x32_bf16 v[44:47], a[252:255], v[236:239], v[44:47]
    ds_read_u16 v250, v250
    v_pk_lshrrev_b16 v253, 3, v253 op_sel_hi:[0,1]
    v_mad_u32_u16 v0, v253, 2, s85
    v_mfma_f32_16x16x32_bf16 v[80:83], a[248:251], v[240:243], v[80:83]
    s_waitcnt lgkmcnt(10)
    ds_read_u16_d16_hi v249, v249
    v_or_b32 v247, v226, v225
    v_mad_u32_u16 v253, v253, 2, s85 op_sel:[1,0,0,0]
    v_cvt_pkrtz_f16_f32 v210, v188, v189
    v_mfma_f32_16x16x32_bf16 v[88:91], a[248:251], v[244:247], v[88:91]
    ds_read_u16 v252, v252
    v_cvt_pkrtz_f16_f32 v213, v190, v191
    v_pk_fma_f16 v208, v210, v210, s53
    v_mfma_f32_16x16x32_bf16 v[48:51], a[232:235], v[232:235], v[48:51]
    ds_read_u16_d16_hi v251, v251
    v_pk_fma_f16 v211, v213, v213, s53
    v_pk_mul_f16 v208, v208, v210 neg_lo:[1,0] neg_hi:[1,0]
    v_mfma_f32_16x16x32_bf16 v[56:59], a[232:235], v[236:239], v[56:59]
    v_pk_mul_f16 v211, v211, v213 neg_lo:[1,0] neg_hi:[1,0]
    v_exp_f16 v209, v208
    v_mfma_f32_16x16x32_bf16 v[84:87], a[252:255], v[240:243], v[84:87]
    s_waitcnt lgkmcnt(12)
    ds_read_u16 v0, v0
    v_exp_f16 v212, v211
    v_mfma_f32_16x16x32_bf16 v[92:95], a[252:255], v[244:247], v[92:95]
    s_add_u32 m0, s56, 5120
    ds_read_u16_d16_hi v253, v253
    buffer_load_dwordx4 v6, s[20:23], 0 offen offset:0 lds
    v_mfma_f32_16x16x32_bf16 v[52:55], a[236:239], v[232:235], v[52:55]
    v_exp_f16_sdwa v209, v208 dst_sel:WORD_1 dst_unused:UNUSED_PRESERVE src0_sel:WORD_1
    v_exp_f16_sdwa v212, v211 dst_sel:WORD_1 dst_unused:UNUSED_PRESERVE src0_sel:WORD_1
    v_mfma_f32_16x16x32_bf16 v[60:63], a[236:239], v[236:239], v[60:63]
    s_waitcnt lgkmcnt(12)
    ds_read_b128 a[248:251], v24 offset:36864
    ds_read_b128 a[252:255], v24 offset:37888
    v_pk_fma_f16 v209, v209, s86, s86
    v_mfma_f32_16x16x32_bf16 v[96:99], a[232:235], v[240:243], v[96:99]
    v_pk_fma_f16 v212, v212, s86, s86
    v_rcp_f16 v208, v209
    v_mfma_f32_16x16x32_bf16 v[104:107], a[232:235], v[244:247], v[104:107]
    s_waitcnt lgkmcnt(11)
    ds_read_b128 a[232:235], v24 offset:38912
    v_rcp_f16 v211, v212
    v_mfma_f32_16x16x32_bf16 v[64:67], a[240:243], v[232:235], v[64:67]
    v_rcp_f16_sdwa v208, v209 dst_sel:WORD_1 dst_unused:UNUSED_PRESERVE src0_sel:WORD_1
    v_rcp_f16_sdwa v211, v212 dst_sel:WORD_1 dst_unused:UNUSED_PRESERVE src0_sel:WORD_1
    v_mfma_f32_16x16x32_bf16 v[72:75], a[240:243], v[236:239], v[72:75]
    v_fma_mix_f32 v209, v208, v210, 0 op_sel_hi:[1,1,0]
    v_fma_mix_f32 v212, v211, v213, 0 op_sel_hi:[1,1,0]
    v_fma_mix_f32 v208, v208, v210, 0 op_sel:[1,1,0] op_sel_hi:[1,1,0]
    v_mfma_f32_16x16x32_bf16 v[100:103], a[236:239], v[240:243], v[100:103]
    v_fma_mix_f32 v211, v211, v213, 0 op_sel:[1,1,0] op_sel_hi:[1,1,0]
    v_cvt_pkrtz_f16_f32 v214, v192, v193
    v_pk_lshrrev_b16 v214, 3, v214 op_sel_hi:[0,1]
    v_mfma_f32_16x16x32_bf16 v[108:111], a[236:239], v[244:247], v[108:111]
    s_waitcnt lgkmcnt(11)
    ds_read_b128 a[236:239], v24 offset:39936
    v_cvt_pkrtz_f16_f32 v216, v194, v195
    v_cvt_pkrtz_f16_f32 v218, v196, v197
    v_mfma_f32_16x16x32_bf16 v[68:71], a[244:247], v[232:235], v[68:71]
    s_waitcnt lgkmcnt(10)
    v_or_b32 v232, v228, v227
    v_or_b32 v233, v230, v229
    v_or_b32 v234, v248, v231
    v_mfma_f32_16x16x32_bf16 v[76:79], a[244:247], v[236:239], v[76:79]
    s_waitcnt lgkmcnt(8)
    v_or_b32 v235, v250, v249
    v_cvt_pk_bf16_f32 v238, v209, v208
    v_cvt_pk_bf16_f32 v239, v212, v211
    v_mfma_f32_16x16x32_bf16 v[112:115], a[240:243], v[240:243], v[112:115]
    s_waitcnt lgkmcnt(6)
    v_cvt_pkrtz_f16_f32 v220, v198, v199
    v_or_b32 v236, v252, v251
    v_cvt_pkrtz_f16_f32 v222, v200, v201
    v_mfma_f32_16x16x32_bf16 v[120:123], a[240:243], v[244:247], v[120:123]
    ds_read_b128 a[240:243], v24 offset:40960
    v_cvt_pkrtz_f16_f32 v224, v202, v203
    v_cvt_pkrtz_f16_f32 v226, v204, v205
    v_mfma_f32_16x16x32_bf16 v[116:119], a[244:247], v[240:243], v[116:119]
    v_cvt_pkrtz_f16_f32 v230, v206, v207
    v_mad_u32_u16 v215, v214, 2, s85
    v_mad_u32_u16 v214, v214, 2, s85 op_sel:[1,0,0,0]
    v_mfma_f32_16x16x32_bf16 v[124:127], a[244:247], v[244:247], v[124:127]
    s_waitcnt lgkmcnt(5)
    ds_read_b128 a[244:247], v24 offset:41984
    ds_read_u16 v215, v215
    v_or_b32 v237, v0, v253
    v_pk_lshrrev_b16 v216, 3, v216 op_sel_hi:[0,1]
    s_waitcnt lgkmcnt(6)
    v_mfma_f32_16x16x32_f16 v[176:179], a[248:251], v[128:131], 0
    ds_read_u16_d16_hi v214, v214
    v_mad_u32_u16 v217, v216, 2, s85
    v_mad_u32_u16 v216, v216, 2, s85 op_sel:[1,0,0,0]
    v_mfma_f32_16x16x32_f16 v[184:187], a[248:251], v[132:135], 0
    s_waitcnt lgkmcnt(6)
    ds_read_u16 v217, v217
    ds_read_u16_d16_hi v216, v216
    v_pk_lshrrev_b16 v218, 3, v218 op_sel_hi:[0,1]
    v_mfma_f32_16x16x32_f16 v[180:183], a[252:255], v[128:131], 0
    v_mad_u32_u16 v219, v218, 2, s85
    v_mad_u32_u16 v218, v218, 2, s85 op_sel:[1,0,0,0]
    v_pk_lshrrev_b16 v220, 3, v220 op_sel_hi:[0,1]
    v_mfma_f32_16x16x32_f16 v[188:191], a[252:255], v[132:135], 0
    ds_read_u16 v219, v219
    ds_read_u16_d16_hi v218, v218
    v_mad_u32_u16 v221, v220, 2, s85
    v_mfma_f32_16x16x32_f16 v[192:195], a[248:251], v[152:155], 0
    ds_read_u16 v221, v221
    v_mad_u32_u16 v220, v220, 2, s85 op_sel:[1,0,0,0]
    v_pk_lshrrev_b16 v222, 3, v222 op_sel_hi:[0,1]
    v_mfma_f32_16x16x32_f16 v[200:203], a[248:251], v[156:159], 0
    s_waitcnt lgkmcnt(10)
    ds_read_u16_d16_hi v220, v220
    ds_read_b128 a[248:251], v24 offset:30720
    v_mad_u32_u16 v223, v222, 2, s85
    v_mfma_f32_16x16x32_f16 v[176:179], a[232:235], v[136:139], v[176:179]
    ds_read_u16 v223, v223
    v_mad_u32_u16 v222, v222, 2, s85 op_sel:[1,0,0,0]
    v_pk_lshrrev_b16 v224, 3, v224 op_sel_hi:[0,1]
    v_mfma_f32_16x16x32_f16 v[184:187], a[232:235], v[140:143], v[184:187]
    ds_read_u16_d16_hi v222, v222
    v_mad_u32_u16 v225, v224, 2, s85
    v_mad_u32_u16 v224, v224, 2, s85 op_sel:[1,0,0,0]
    v_mfma_f32_16x16x32_f16 v[196:199], a[252:255], v[152:155], 0
    s_waitcnt lgkmcnt(12)
    ds_read_u16 v225, v225
    ds_read_u16_d16_hi v224, v224
    v_pk_lshrrev_b16 v226, 3, v226 op_sel_hi:[0,1]
    v_mfma_f32_16x16x32_f16 v[204:207], a[252:255], v[156:159], 0
    s_waitcnt lgkmcnt(13)
    ds_read_b128 a[252:255], v24 offset:31744
    v_mad_u32_u16 v227, v226, 2, s85
    v_mad_u32_u16 v226, v226, 2, s85 op_sel:[1,0,0,0]
    v_mfma_f32_16x16x32_f16 v[180:183], a[236:239], v[136:139], v[180:183]
    s_waitcnt lgkmcnt(13)
    ds_read_u16 v227, v227
    v_pk_fma_f16 v228, v230, v230, s53
    v_pk_mul_f16 v228, v228, v230 neg_lo:[1,0] neg_hi:[1,0]
    v_mfma_f32_16x16x32_f16 v[188:191], a[236:239], v[140:143], v[188:191]
    s_waitcnt lgkmcnt(13)
    ds_read_u16_d16_hi v226, v226
    v_exp_f16 v229, v228
    v_mfma_f32_16x16x32_f16 v[192:195], a[232:235], v[160:163], v[192:195]
    v_exp_f16_sdwa v229, v228 dst_sel:WORD_1 dst_unused:UNUSED_PRESERVE src0_sel:WORD_1
    v_or_b32 v240, v215, v214
    v_mfma_f32_16x16x32_f16 v[200:203], a[232:235], v[164:167], v[200:203]
    s_waitcnt lgkmcnt(13)
    ds_read_b128 a[232:235], v24 offset:32768
    v_pk_fma_f16 v229, v229, s86, s86
    v_rcp_f16 v228, v229
    v_mfma_f32_16x16x32_f16 v[176:179], a[240:243], v[144:147], v[176:179]
    s_waitcnt lgkmcnt(11)
    v_rcp_f16_sdwa v228, v229 dst_sel:WORD_1 dst_unused:UNUSED_PRESERVE src0_sel:WORD_1
    v_or_b32 v241, v217, v216
    v_mfma_f32_16x16x32_f16 v[184:187], a[240:243], v[148:151], v[184:187]
    s_add_u32 m0, s56, 6144
    v_fma_mix_f32 v229, v228, v230, 0 op_sel_hi:[1,1,0]
    v_fma_mix_f32 v228, v228, v230, 0 op_sel:[1,1,0] op_sel_hi:[1,1,0]
    v_or_b32 v242, v219, v218
    v_mfma_f32_16x16x32_f16 v[196:199], a[236:239], v[160:163], v[196:199]
    s_waitcnt lgkmcnt(9)
    buffer_load_dword v7, s[20:23], 0 offen offset:0 lds
    v_or_b32 v243, v221, v220
    v_mfma_f32_16x16x32_f16 v[204:207], a[236:239], v[164:167], v[204:207]
    ds_read_b128 a[236:239], v24 offset:33792
    v_cvt_pk_bf16_f32 v247, v229, v228
    v_cvt_pkrtz_f16_f32 v231, v176, v177
    v_mfma_f32_16x16x32_f16 v[180:183], a[244:247], v[144:147], v[180:183]
    v_pk_lshrrev_b16 v231, 3, v231 op_sel_hi:[0,1]
    v_mad_u32_u16 v248, v231, 2, s85
    v_mad_u32_u16 v231, v231, 2, s85 op_sel:[1,0,0,0]
    v_mfma_f32_16x16x32_f16 v[188:191], a[244:247], v[148:151], v[188:191]
    s_waitcnt lgkmcnt(7)
    ds_read_u16 v248, v248
    ds_read_u16_d16_hi v231, v231
    v_or_b32 v244, v223, v222
    v_mfma_f32_16x16x32_f16 v[192:195], a[240:243], v[168:171], v[192:195]
    v_cvt_pkrtz_f16_f32 v249, v178, v179
    v_pk_lshrrev_b16 v249, 3, v249 op_sel_hi:[0,1]
    v_mad_u32_u16 v250, v249, 2, s85
    v_mfma_f32_16x16x32_f16 v[200:203], a[240:243], v[172:175], v[200:203]
    ds_read_b128 a[240:243], v24 offset:34816
    ds_read_u16 v250, v250
    v_mad_u32_u16 v249, v249, 2, s85 op_sel:[1,0,0,0]
    v_mfma_f32_16x16x32_f16 v[196:199], a[244:247], v[168:171], v[196:199]
    s_waitcnt lgkmcnt(9)
    ds_read_u16_d16_hi v249, v249
    v_or_b32 v245, v225, v224
    v_cvt_pkrtz_f16_f32 v251, v180, v181
    v_mfma_f32_16x16x32_f16 v[204:207], a[244:247], v[172:175], v[204:207]
    ds_read_b128 a[244:247], v24 offset:35840
    v_pk_lshrrev_b16 v251, 3, v251 op_sel_hi:[0,1]
    v_mad_u32_u16 v252, v251, 2, s85
    v_mfma_f32_16x16x32_bf16 v[32:35], a[248:251], v[232:235], v[32:35]
    ds_read_u16 v252, v252
    v_mad_u32_u16 v251, v251, 2, s85 op_sel:[1,0,0,0]
    v_cvt_pkrtz_f16_f32 v253, v182, v183
    v_mfma_f32_16x16x32_bf16 v[40:43], a[248:251], v[236:239], v[40:43]
    s_waitcnt lgkmcnt(9)
    ds_read_u16_d16_hi v251, v251
    v_pk_lshrrev_b16 v253, 3, v253 op_sel_hi:[0,1]
    v_or_b32 v246, v227, v226
    v_mfma_f32_16x16x32_bf16 v[36:39], a[252:255], v[232:235], v[36:39]
    v_mad_u32_u16 v0, v253, 2, s85
    v_mad_u32_u16 v253, v253, 2, s85 op_sel:[1,0,0,0]
    v_cvt_pkrtz_f16_f32 v208, v184, v185
    v_mfma_f32_16x16x32_bf16 v[44:47], a[252:255], v[236:239], v[44:47]
    ds_read_u16 v0, v0
    ds_read_u16_d16_hi v253, v253
    v_pk_lshrrev_b16 v208, 3, v208 op_sel_hi:[0,1]
    v_mfma_f32_16x16x32_bf16 v[80:83], a[248:251], v[240:243], v[80:83]
    v_mad_u32_u16 v209, v208, 2, s85
    v_mad_u32_u16 v208, v208, 2, s85 op_sel:[1,0,0,0]
    v_cvt_pkrtz_f16_f32 v210, v186, v187
    v_mfma_f32_16x16x32_bf16 v[88:91], a[248:251], v[244:247], v[88:91]
    s_waitcnt lgkmcnt(11)
    ds_read_u16 v209, v209
    ds_read_u16_d16_hi v208, v208
    v_pk_lshrrev_b16 v210, 3, v210 op_sel_hi:[0,1]
    v_mfma_f32_16x16x32_bf16 v[48:51], a[232:235], v[232:235], v[48:51]
    ds_read_b128 a[248:251], v24 offset:43008
    buffer_load_dword v254, v31, s[20:23], 0 offen
    v_mad_u32_u16 v211, v210, 2, s85
    v_mfma_f32_16x16x32_bf16 v[56:59], a[232:235], v[236:239], v[56:59]
    s_waitcnt lgkmcnt(13)
    ds_read_u16 v211, v211
    v_mad_u32_u16 v210, v210, 2, s85 op_sel:[1,0,0,0]
    v_cvt_pkrtz_f16_f32 v212, v188, v189
    v_mfma_f32_16x16x32_bf16 v[84:87], a[252:255], v[240:243], v[84:87]
    v_pk_lshrrev_b16 v212, 3, v212 op_sel_hi:[0,1]
    v_mad_u32_u16 v213, v212, 2, s85
    v_mad_u32_u16 v212, v212, 2, s85 op_sel:[1,0,0,0]
    v_mfma_f32_16x16x32_bf16 v[92:95], a[252:255], v[244:247], v[92:95]
    s_waitcnt lgkmcnt(13)
    ds_read_u16_d16_hi v210, v210
    v_cvt_pkrtz_f16_f32 v216, v190, v191
    v_pk_fma_f16 v214, v216, v216, s53
    v_mfma_f32_16x16x32_bf16 v[52:55], a[236:239], v[232:235], v[52:55]
    s_waitcnt lgkmcnt(13)
    ds_read_u16 v213, v213
    v_pk_mul_f16 v214, v214, v216 neg_lo:[1,0] neg_hi:[1,0]
    v_exp_f16 v215, v214
    v_mfma_f32_16x16x32_bf16 v[60:63], a[236:239], v[236:239], v[60:63]
    s_waitcnt lgkmcnt(13)
    ds_read_u16_d16_hi v212, v212
    v_exp_f16_sdwa v215, v214 dst_sel:WORD_1 dst_unused:UNUSED_PRESERVE src0_sel:WORD_1
    v_mfma_f32_16x16x32_bf16 v[96:99], a[232:235], v[240:243], v[96:99]
    s_waitcnt lgkmcnt(13)
    ds_read_b128 a[252:255], v24 offset:44032
    v_pk_fma_f16 v215, v215, s86, s86
    v_rcp_f16 v214, v215
    v_mfma_f32_16x16x32_bf16 v[104:107], a[232:235], v[244:247], v[104:107]
    s_waitcnt lgkmcnt(13)
    ds_read_b128 a[232:235], v24 offset:45056
    v_rcp_f16_sdwa v214, v215 dst_sel:WORD_1 dst_unused:UNUSED_PRESERVE src0_sel:WORD_1
    v_mfma_f32_16x16x32_bf16 v[64:67], a[240:243], v[232:235], v[64:67]
    v_fma_mix_f32 v215, v214, v216, 0 op_sel_hi:[1,1,0]
    v_fma_mix_f32 v214, v214, v216, 0 op_sel:[1,1,0] op_sel_hi:[1,1,0]
    v_cvt_pkrtz_f16_f32 v217, v192, v193
    v_mfma_f32_16x16x32_bf16 v[72:75], a[240:243], v[236:239], v[72:75]
    v_pk_lshrrev_b16 v217, 3, v217 op_sel_hi:[0,1]
    v_cvt_pkrtz_f16_f32 v219, v194, v195
    v_cvt_pkrtz_f16_f32 v221, v196, v197
    v_mfma_f32_16x16x32_bf16 v[100:103], a[236:239], v[240:243], v[100:103]
    v_cvt_pkrtz_f16_f32 v223, v198, v199
    v_cvt_pkrtz_f16_f32 v225, v200, v201
    v_cvt_pkrtz_f16_f32 v227, v202, v203
    v_mfma_f32_16x16x32_bf16 v[108:111], a[236:239], v[244:247], v[108:111]
    s_waitcnt lgkmcnt(13)
    ds_read_b128 a[236:239], v24 offset:46080
    v_cvt_pkrtz_f16_f32 v229, v204, v205
    v_mad_u32_u16 v218, v217, 2, s85
    v_mfma_f32_16x16x32_bf16 v[68:71], a[244:247], v[232:235], v[68:71]
    s_waitcnt lgkmcnt(13)
    ds_read_u16 v218, v218
    v_or_b32 v232, v248, v231
    v_or_b32 v233, v250, v249
    v_mfma_f32_16x16x32_bf16 v[76:79], a[244:247], v[236:239], v[76:79]
    s_waitcnt lgkmcnt(9)
    v_or_b32 v234, v252, v251
    v_or_b32 v235, v0, v253
    v_or_b32 v236, v209, v208
    v_mfma_f32_16x16x32_bf16 v[112:115], a[240:243], v[240:243], v[112:115]
    v_cvt_pk_bf16_f32 v239, v215, v214
    v_cvt_pkrtz_f16_f32 v249, v206, v207
    v_mad_u32_u16 v217, v217, 2, s85 op_sel:[1,0,0,0]
    v_mfma_f32_16x16x32_bf16 v[120:123], a[240:243], v[244:247], v[120:123]
    ds_read_b128 a[240:243], v24 offset:47104
    ds_read_u16_d16_hi v217, v217
    v_pk_lshrrev_b16 v219, 3, v219 op_sel_hi:[0,1]
    v_mfma_f32_16x16x32_bf16 v[116:119], a[244:247], v[240:243], v[116:119]
    s_waitcnt lgkmcnt(8)
    v_mad_u32_u16 v220, v219, 2, s85
    v_mad_u32_u16 v219, v219, 2, s85 op_sel:[1,0,0,0]
    v_or_b32 v237, v211, v210
    v_mfma_f32_16x16x32_bf16 v[124:127], a[244:247], v[244:247], v[124:127]
    ds_read_b128 a[244:247], v24 offset:48128
    ds_read_u16 v220, v220
    v_pk_lshrrev_b16 v221, 3, v221 op_sel_hi:[0,1]
    v_mfma_f32_16x16x32_f16 v[176:179], a[0:3], v[128:131], 0
    ds_read_u16_d16_hi v219, v219
    v_mad_u32_u16 v222, v221, 2, s85
    v_mad_u32_u16 v221, v221, 2, s85 op_sel:[1,0,0,0]
    v_mfma_f32_16x16x32_bf16 v[32:35], a[248:251], v[232:235], v[32:35]
    s_waitcnt lgkmcnt(9)
    ds_read_u16 v222, v222
    ds_read_u16_d16_hi v221, v221
    v_or_b32 v238, v213, v212
    v_mfma_f32_16x16x32_f16 v[180:183], a[4:7], v[128:131], 0
    s_waitcnt lgkmcnt(10)
    v_pk_lshrrev_b16 v223, 3, v223 op_sel_hi:[0,1]
    v_mad_u32_u16 v224, v223, 2, s85
    v_mad_u32_u16 v223, v223, 2, s85 op_sel:[1,0,0,0]
    v_mfma_f32_16x16x32_bf16 v[36:39], a[252:255], v[232:235], v[36:39]
    ds_read_u16 v224, v224
    ds_read_u16_d16_hi v223, v223
    v_pk_lshrrev_b16 v225, 3, v225 op_sel_hi:[0,1]
    v_mfma_f32_16x16x32_f16 v[176:179], a[8:11], v[136:139], v[176:179]
    s_waitcnt lgkmcnt(11)
    v_mad_u32_u16 v226, v225, 2, s85
    v_mad_u32_u16 v225, v225, 2, s85 op_sel:[1,0,0,0]
    v_pk_lshrrev_b16 v227, 3, v227 op_sel_hi:[0,1]
    v_mfma_f32_16x16x32_bf16 v[48:51], a[232:235], v[232:235], v[48:51]
    ds_read_u16 v226, v226
    ds_read_u16_d16_hi v225, v225
    v_mad_u32_u16 v228, v227, 2, s85
    v_mfma_f32_16x16x32_f16 v[180:183], a[12:15], v[136:139], v[180:183]
    s_waitcnt lgkmcnt(12)
    ds_read_u16 v228, v228
    v_mad_u32_u16 v227, v227, 2, s85 op_sel:[1,0,0,0]
    v_pk_lshrrev_b16 v229, 3, v229 op_sel_hi:[0,1]
    v_mfma_f32_16x16x32_bf16 v[52:55], a[236:239], v[232:235], v[52:55]
    v_mad_u32_u16 v230, v229, 2, s85
    v_mad_u32_u16 v229, v229, 2, s85 op_sel:[1,0,0,0]
    v_pk_fma_f16 v231, v249, v249, s53
    v_mfma_f32_16x16x32_f16 v[176:179], a[16:19], v[144:147], v[176:179]
    s_waitcnt lgkmcnt(11)
    ds_read_u16_d16_hi v227, v227
    ds_read_u16 v230, v230
    v_pk_mul_f16 v231, v231, v249 neg_lo:[1,0] neg_hi:[1,0]
    v_mfma_f32_16x16x32_bf16 v[64:67], a[240:243], v[232:235], v[64:67]
    s_waitcnt lgkmcnt(12)
    v_exp_f16 v248, v231
    v_or_b32 v240, v218, v217
    v_mfma_f32_16x16x32_f16 v[180:183], a[20:23], v[144:147], v[180:183]
    s_waitcnt lgkmcnt(11)
    ds_read_u16_d16_hi v229, v229
    v_exp_f16_sdwa v248, v231 dst_sel:WORD_1 dst_unused:UNUSED_PRESERVE src0_sel:WORD_1
    v_mfma_f32_16x16x32_bf16 v[68:71], a[244:247], v[232:235], v[68:71]
    v_pk_fma_f16 v248, v248, s86, s86
    v_rcp_f16 v231, v248
    v_mfma_f32_16x16x32_f16 v[184:187], a[0:3], v[132:135], 0
    s_waitcnt lgkmcnt(10)
    v_rcp_f16_sdwa v231, v248 dst_sel:WORD_1 dst_unused:UNUSED_PRESERVE src0_sel:WORD_1
    v_or_b32 v241, v220, v219
    v_mfma_f32_16x16x32_bf16 v[40:43], a[248:251], v[236:239], v[40:43]
    v_fma_mix_f32 v248, v231, v249, 0 op_sel_hi:[1,1,0]
    v_fma_mix_f32 v231, v231, v249, 0 op_sel:[1,1,0] op_sel_hi:[1,1,0]
    v_cvt_pk_bf16_f32 v247, v248, v231
    v_mfma_f32_16x16x32_f16 v[188:191], a[4:7], v[132:135], 0
    s_waitcnt lgkmcnt(8)
    v_or_b32 v242, v222, v221
    v_cvt_pkrtz_f16_f32 v250, v176, v177
    v_pk_lshrrev_b16 v250, 3, v250 op_sel_hi:[0,1]
    v_mfma_f32_16x16x32_bf16 v[44:47], a[252:255], v[236:239], v[44:47]
    v_mad_u32_u16 v251, v250, 2, s85
    v_mad_u32_u16 v250, v250, 2, s85 op_sel:[1,0,0,0]
    v_cvt_pkrtz_f16_f32 v252, v178, v179
    v_mfma_f32_16x16x32_f16 v[184:187], a[8:11], v[140:143], v[184:187]
    ds_read_u16 v251, v251
    ds_read_u16_d16_hi v250, v250
    v_pk_lshrrev_b16 v252, 3, v252 op_sel_hi:[0,1]
    v_mfma_f32_16x16x32_bf16 v[56:59], a[232:235], v[236:239], v[56:59]
    s_waitcnt lgkmcnt(8)
    v_or_b32 v243, v224, v223
    v_mad_u32_u16 v253, v252, 2, s85
    v_mad_u32_u16 v252, v252, 2, s85 op_sel:[1,0,0,0]
    v_mfma_f32_16x16x32_f16 v[188:191], a[12:15], v[140:143], v[188:191]
    ds_read_u16 v253, v253
    ds_read_u16_d16_hi v252, v252
    v_cvt_pkrtz_f16_f32 v0, v180, v181
    v_mfma_f32_16x16x32_bf16 v[60:63], a[236:239], v[236:239], v[60:63]
    v_pk_lshrrev_b16 v0, 3, v0 op_sel_hi:[0,1]
    v_mad_u32_u16 v208, v0, 2, s85
    v_mad_u32_u16 v0, v0, 2, s85 op_sel:[1,0,0,0]
    v_mfma_f32_16x16x32_f16 v[184:187], a[16:19], v[148:151], v[184:187]
    s_waitcnt lgkmcnt(8)
    ds_read_u16 v208, v208
    ds_read_u16_d16_hi v0, v0
    v_or_b32 v244, v226, v225
    v_mfma_f32_16x16x32_f16 v[188:191], a[20:23], v[148:151], v[188:191]
    v_cvt_pkrtz_f16_f32 v209, v182, v183
    v_pk_lshrrev_b16 v209, 3, v209 op_sel_hi:[0,1]
    v_mad_u32_u16 v210, v209, 2, s85
    v_mfma_f32_16x16x32_bf16 v[72:75], a[240:243], v[236:239], v[72:75]
    ds_read_u16 v210, v210
    v_mad_u32_u16 v209, v209, 2, s85 op_sel:[1,0,0,0]
    v_cvt_pkrtz_f16_f32 v211, v184, v185
    v_mfma_f32_16x16x32_bf16 v[76:79], a[244:247], v[236:239], v[76:79]
    s_waitcnt lgkmcnt(9)
    ds_read_u16_d16_hi v209, v209
    v_or_b32 v245, v228, v227
    v_pk_lshrrev_b16 v211, 3, v211 op_sel_hi:[0,1]
    v_mfma_f32_16x16x32_f16 v[176:179], a[48:51], v[128:131], 0
    v_mad_u32_u16 v212, v211, 2, s85
    v_mad_u32_u16 v211, v211, 2, s85 op_sel:[1,0,0,0]
    v_cvt_pkrtz_f16_f32 v213, v186, v187
    v_mfma_f32_16x16x32_bf16 v[80:83], a[248:251], v[240:243], v[80:83]
    ds_read_u16 v212, v212
    ds_read_u16_d16_hi v211, v211
    v_pk_lshrrev_b16 v213, 3, v213 op_sel_hi:[0,1]
    v_mfma_f32_16x16x32_f16 v[180:183], a[52:55], v[128:131], 0
    s_waitcnt lgkmcnt(10)
    v_or_b32 v246, v230, v229
    v_mad_u32_u16 v214, v213, 2, s85
    v_mad_u32_u16 v213, v213, 2, s85 op_sel:[1,0,0,0]
    v_mfma_f32_16x16x32_bf16 v[84:87], a[252:255], v[240:243], v[84:87]
    ds_read_u16 v214, v214
    ds_read_u16_d16_hi v213, v213
    v_cvt_pkrtz_f16_f32 v215, v188, v189
    v_mfma_f32_16x16x32_f16 v[176:179], a[56:59], v[136:139], v[176:179]
    v_pk_lshrrev_b16 v215, 3, v215 op_sel_hi:[0,1]
    v_mad_u32_u16 v216, v215, 2, s85
    v_mad_u32_u16 v215, v215, 2, s85 op_sel:[1,0,0,0]
    v_mfma_f32_16x16x32_bf16 v[96:99], a[232:235], v[240:243], v[96:99]
    ds_read_u16 v216, v216
    v_cvt_pkrtz_f16_f32 v219, v190, v191
    v_pk_fma_f16 v217, v219, v219, s53
    v_mfma_f32_16x16x32_f16 v[180:183], a[60:63], v[136:139], v[180:183]
    ds_read_u16_d16_hi v215, v215
    v_pk_mul_f16 v217, v217, v219 neg_lo:[1,0] neg_hi:[1,0]
    v_exp_f16 v218, v217
    v_mfma_f32_16x16x32_bf16 v[100:103], a[236:239], v[240:243], v[100:103]
    s_waitcnt lgkmcnt(12)
    v_exp_f16_sdwa v218, v217 dst_sel:WORD_1 dst_unused:UNUSED_PRESERVE src0_sel:WORD_1
    v_or_b32 v232, v251, v250
    v_mfma_f32_16x16x32_f16 v[176:179], a[64:67], v[144:147], v[176:179]
    v_pk_fma_f16 v218, v218, s86, s86
    v_rcp_f16 v217, v218
    v_mfma_f32_16x16x32_bf16 v[112:115], a[240:243], v[240:243], v[112:115]
    s_waitcnt lgkmcnt(10)
    v_rcp_f16_sdwa v217, v218 dst_sel:WORD_1 dst_unused:UNUSED_PRESERVE src0_sel:WORD_1
    v_or_b32 v233, v253, v252
    v_mfma_f32_16x16x32_f16 v[180:183], a[68:71], v[144:147], v[180:183]
    s_waitcnt lgkmcnt(8)
    v_fma_mix_f32 v218, v217, v219, 0 op_sel_hi:[1,1,0]
    v_fma_mix_f32 v217, v217, v219, 0 op_sel:[1,1,0] op_sel_hi:[1,1,0]
    v_or_b32 v234, v208, v0
    v_mfma_f32_16x16x32_bf16 v[116:119], a[244:247], v[240:243], v[116:119]
    v_cvt_pk_bf16_f32 v239, v218, v217
    v_cvt_pkrtz_f16_f32 v220, v176, v177
    v_pk_lshrrev_b16 v220, 3, v220 op_sel_hi:[0,1]
    v_mfma_f32_16x16x32_f16 v[184:187], a[48:51], v[132:135], 0
    v_mad_u32_u16 v221, v220, 2, s85
    v_mad_u32_u16 v220, v220, 2, s85 op_sel:[1,0,0,0]
    v_cvt_pkrtz_f16_f32 v222, v178, v179
    v_mfma_f32_16x16x32_bf16 v[88:91], a[248:251], v[244:247], v[88:91]
    s_waitcnt lgkmcnt(6)
    ds_read_u16 v221, v221
    ds_read_u16_d16_hi v220, v220
    v_or_b32 v235, v210, v209
    v_mfma_f32_16x16x32_f16 v[188:191], a[52:55], v[132:135], 0
    v_pk_lshrrev_b16 v222, 3, v222 op_sel_hi:[0,1]
    v_mad_u32_u16 v223, v222, 2, s85
    v_mad_u32_u16 v222, v222, 2, s85 op_sel:[1,0,0,0]
    v_mfma_f32_16x16x32_bf16 v[92:95], a[252:255], v[244:247], v[92:95]
    ds_read_u16 v223, v223
    ds_read_u16_d16_hi v222, v222
    v_cvt_pkrtz_f16_f32 v224, v180, v181
    v_mfma_f32_16x16x32_f16 v[184:187], a[56:59], v[140:143], v[184:187]
    s_waitcnt lgkmcnt(8)
    v_or_b32 v236, v212, v211
    v_pk_lshrrev_b16 v224, 3, v224 op_sel_hi:[0,1]
    v_mad_u32_u16 v225, v224, 2, s85
    v_mfma_f32_16x16x32_bf16 v[104:107], a[232:235], v[244:247], v[104:107]
    ds_read_u16 v225, v225
    v_mad_u32_u16 v224, v224, 2, s85 op_sel:[1,0,0,0]
    v_cvt_pkrtz_f16_f32 v226, v182, v183
    v_mfma_f32_16x16x32_f16 v[188:191], a[60:63], v[140:143], v[188:191]
    ds_read_u16_d16_hi v224, v224
    v_pk_lshrrev_b16 v226, 3, v226 op_sel_hi:[0,1]
    v_mad_u32_u16 v227, v226, 2, s85
    v_mfma_f32_16x16x32_bf16 v[108:111], a[236:239], v[244:247], v[108:111]
    s_waitcnt lgkmcnt(8)
    ds_read_u16 v227, v227
    v_or_b32 v237, v214, v213
    v_mad_u32_u16 v226, v226, 2, s85 op_sel:[1,0,0,0]
    v_mfma_f32_16x16x32_f16 v[184:187], a[64:67], v[148:151], v[184:187]
    ds_read_u16_d16_hi v226, v226
    v_mfma_f32_16x16x32_f16 v[188:191], a[68:71], v[148:151], v[188:191]
    v_mfma_f32_16x16x32_bf16 v[120:123], a[240:243], v[244:247], v[120:123]
    s_waitcnt lgkmcnt(8)
    v_or_b32 v238, v216, v215
    v_mfma_f32_16x16x32_bf16 v[124:127], a[244:247], v[244:247], v[124:127]
    v_mfma_f32_16x16x32_f16 v[176:179], a[96:99], v[128:131], 0
    s_nop 0
    v_cvt_pkrtz_f16_f32 v228, v184, v185
    v_pk_lshrrev_b16 v228, 3, v228 op_sel_hi:[0,1]
    v_mfma_f32_16x16x32_bf16 v[32:35], a[24:27], v[232:235], v[32:35]
    v_mad_u32_u16 v229, v228, 2, s85
    v_mad_u32_u16 v228, v228, 2, s85 op_sel:[1,0,0,0]
    v_cvt_pkrtz_f16_f32 v230, v186, v187
    v_mfma_f32_16x16x32_f16 v[180:183], a[100:103], v[128:131], 0
    ds_read_u16 v229, v229
    ds_read_u16_d16_hi v228, v228
    v_pk_lshrrev_b16 v230, 3, v230 op_sel_hi:[0,1]
    v_mfma_f32_16x16x32_bf16 v[36:39], a[28:31], v[232:235], v[36:39]
    v_mad_u32_u16 v231, v230, 2, s85
    v_mad_u32_u16 v230, v230, 2, s85 op_sel:[1,0,0,0]
    v_cvt_pkrtz_f16_f32 v248, v188, v189
    v_mfma_f32_16x16x32_f16 v[176:179], a[104:107], v[136:139], v[176:179]
    ds_read_u16 v231, v231
    ds_read_u16_d16_hi v230, v230
    v_pk_lshrrev_b16 v248, 3, v248 op_sel_hi:[0,1]
    v_mfma_f32_16x16x32_bf16 v[48:51], a[32:35], v[232:235], v[48:51]
    v_mad_u32_u16 v249, v248, 2, s85
    v_mad_u32_u16 v248, v248, 2, s85 op_sel:[1,0,0,0]
    v_cvt_pkrtz_f16_f32 v250, v190, v191
    v_mfma_f32_16x16x32_f16 v[180:183], a[108:111], v[136:139], v[180:183]
    ds_read_u16 v249, v249
    ds_read_u16_d16_hi v248, v248
    v_pk_lshrrev_b16 v250, 3, v250 op_sel_hi:[0,1]
    v_mfma_f32_16x16x32_bf16 v[52:55], a[36:39], v[232:235], v[52:55]
    v_mad_u32_u16 v251, v250, 2, s85
    v_mad_u32_u16 v250, v250, 2, s85 op_sel:[1,0,0,0]
    v_mfma_f32_16x16x32_f16 v[176:179], a[112:115], v[144:147], v[176:179]
    s_waitcnt lgkmcnt(12)
    ds_read_u16 v251, v251
    ds_read_u16_d16_hi v250, v250
    v_mfma_f32_16x16x32_bf16 v[64:67], a[40:43], v[232:235], v[64:67]
    v_mfma_f32_16x16x32_f16 v[180:183], a[116:119], v[144:147], v[180:183]
    v_mfma_f32_16x16x32_bf16 v[68:71], a[44:47], v[232:235], v[68:71]
    s_waitcnt lgkmcnt(10)
    v_or_b32 v232, v221, v220
    v_or_b32 v233, v223, v222
    v_or_b32 v234, v225, v224
    v_mfma_f32_16x16x32_f16 v[184:187], a[96:99], v[132:135], 0
    s_waitcnt lgkmcnt(8)
    v_or_b32 v235, v227, v226
    v_cvt_pkrtz_f16_f32 v252, v176, v177
    v_pk_lshrrev_b16 v252, 3, v252 op_sel_hi:[0,1]
    v_mfma_f32_16x16x32_bf16 v[40:43], a[24:27], v[236:239], v[40:43]
    v_mad_u32_u16 v253, v252, 2, s85
    v_mad_u32_u16 v252, v252, 2, s85 op_sel:[1,0,0,0]
    v_cvt_pkrtz_f16_f32 v0, v178, v179
    v_mfma_f32_16x16x32_f16 v[188:191], a[100:103], v[132:135], 0
    ds_read_u16 v253, v253
    ds_read_u16_d16_hi v252, v252
    v_pk_lshrrev_b16 v0, 3, v0 op_sel_hi:[0,1]
    v_mfma_f32_16x16x32_bf16 v[44:47], a[28:31], v[236:239], v[44:47]
    v_mad_u32_u16 v208, v0, 2, s85
    v_mad_u32_u16 v0, v0, 2, s85 op_sel:[1,0,0,0]
    v_cvt_pkrtz_f16_f32 v209, v180, v181
    v_mfma_f32_16x16x32_f16 v[184:187], a[104:107], v[140:143], v[184:187]
    ds_read_u16 v208, v208
    ds_read_u16_d16_hi v0, v0
    v_pk_lshrrev_b16 v209, 3, v209 op_sel_hi:[0,1]
    v_mfma_f32_16x16x32_bf16 v[56:59], a[32:35], v[236:239], v[56:59]
    v_mad_u32_u16 v210, v209, 2, s85
    v_mad_u32_u16 v209, v209, 2, s85 op_sel:[1,0,0,0]
    v_cvt_pkrtz_f16_f32 v211, v182, v183
    v_mfma_f32_16x16x32_f16 v[188:191], a[108:111], v[140:143], v[188:191]
    ds_read_u16 v210, v210
    ds_read_u16_d16_hi v209, v209
    v_pk_lshrrev_b16 v211, 3, v211 op_sel_hi:[0,1]
    v_mfma_f32_16x16x32_bf16 v[60:63], a[36:39], v[236:239], v[60:63]
    v_mad_u32_u16 v212, v211, 2, s85
    v_mad_u32_u16 v211, v211, 2, s85 op_sel:[1,0,0,0]
    v_mfma_f32_16x16x32_f16 v[184:187], a[112:115], v[148:151], v[184:187]
    s_waitcnt lgkmcnt(12)
    ds_read_u16 v212, v212
    ds_read_u16_d16_hi v211, v211
    v_mfma_f32_16x16x32_f16 v[188:191], a[116:119], v[148:151], v[188:191]
    v_mfma_f32_16x16x32_bf16 v[72:75], a[40:43], v[236:239], v[72:75]
    v_mfma_f32_16x16x32_bf16 v[76:79], a[44:47], v[236:239], v[76:79]
    s_waitcnt lgkmcnt(10)
    v_or_b32 v236, v229, v228
    v_or_b32 v237, v231, v230
    v_or_b32 v238, v249, v248
    v_mfma_f32_16x16x32_f16 v[176:179], a[144:147], v[128:131], 0
    s_waitcnt lgkmcnt(8)
    v_or_b32 v239, v251, v250
    v_cvt_pkrtz_f16_f32 v213, v184, v185
    v_pk_lshrrev_b16 v213, 3, v213 op_sel_hi:[0,1]
    v_mfma_f32_16x16x32_bf16 v[32:35], a[72:75], v[232:235], v[32:35]
    v_mad_u32_u16 v214, v213, 2, s85
    v_mad_u32_u16 v213, v213, 2, s85 op_sel:[1,0,0,0]
    v_cvt_pkrtz_f16_f32 v215, v186, v187
    v_mfma_f32_16x16x32_f16 v[180:183], a[148:151], v[128:131], 0
    ds_read_u16 v214, v214
    ds_read_u16_d16_hi v213, v213
    v_pk_lshrrev_b16 v215, 3, v215 op_sel_hi:[0,1]
    v_mfma_f32_16x16x32_bf16 v[36:39], a[76:79], v[232:235], v[36:39]
    v_mad_u32_u16 v216, v215, 2, s85
    v_mad_u32_u16 v215, v215, 2, s85 op_sel:[1,0,0,0]
    v_cvt_pkrtz_f16_f32 v217, v188, v189
    v_mfma_f32_16x16x32_f16 v[176:179], a[152:155], v[136:139], v[176:179]
    ds_read_u16 v216, v216
    ds_read_u16_d16_hi v215, v215
    v_pk_lshrrev_b16 v217, 3, v217 op_sel_hi:[0,1]
    v_mfma_f32_16x16x32_bf16 v[48:51], a[80:83], v[232:235], v[48:51]
    v_mad_u32_u16 v218, v217, 2, s85
    v_mad_u32_u16 v217, v217, 2, s85 op_sel:[1,0,0,0]
    v_cvt_pkrtz_f16_f32 v221, v190, v191
    v_mfma_f32_16x16x32_f16 v[180:183], a[156:159], v[136:139], v[180:183]
    ds_read_u16 v218, v218
    ds_read_u16_d16_hi v217, v217
    v_pk_fma_f16 v219, v221, v221, s53
    v_mfma_f32_16x16x32_bf16 v[52:55], a[84:87], v[232:235], v[52:55]
    v_pk_mul_f16 v219, v219, v221 neg_lo:[1,0] neg_hi:[1,0]
    v_exp_f16 v220, v219
    v_mfma_f32_16x16x32_f16 v[176:179], a[160:163], v[144:147], v[176:179]
    v_exp_f16_sdwa v220, v219 dst_sel:WORD_1 dst_unused:UNUSED_PRESERVE src0_sel:WORD_1
    v_mfma_f32_16x16x32_bf16 v[64:67], a[88:91], v[232:235], v[64:67]
    v_pk_fma_f16 v220, v220, s86, s86
    v_rcp_f16 v219, v220
    v_mfma_f32_16x16x32_f16 v[180:183], a[164:167], v[144:147], v[180:183]
    v_rcp_f16_sdwa v219, v220 dst_sel:WORD_1 dst_unused:UNUSED_PRESERVE src0_sel:WORD_1
    v_mfma_f32_16x16x32_bf16 v[68:71], a[92:95], v[232:235], v[68:71]
    s_waitcnt lgkmcnt(12)
    v_fma_mix_f32 v220, v219, v221, 0 op_sel_hi:[1,1,0]
    v_fma_mix_f32 v219, v219, v221, 0 op_sel:[1,1,0] op_sel_hi:[1,1,0]
    v_or_b32 v232, v253, v252
    v_mfma_f32_16x16x32_f16 v[184:187], a[144:147], v[132:135], 0
    s_waitcnt lgkmcnt(6)
    v_or_b32 v233, v208, v0
    v_or_b32 v234, v210, v209
    v_or_b32 v235, v212, v211
    v_mfma_f32_16x16x32_bf16 v[40:43], a[72:75], v[236:239], v[40:43]
    v_cvt_pkrtz_f16_f32 v222, v176, v177
    v_pk_lshrrev_b16 v222, 3, v222 op_sel_hi:[0,1]
    v_mad_u32_u16 v223, v222, 2, s85
    v_mfma_f32_16x16x32_f16 v[188:191], a[148:151], v[132:135], 0
    ds_read_u16 v223, v223
    v_mad_u32_u16 v222, v222, 2, s85 op_sel:[1,0,0,0]
    v_cvt_pkrtz_f16_f32 v224, v178, v179
    v_mfma_f32_16x16x32_bf16 v[44:47], a[76:79], v[236:239], v[44:47]
    ds_read_u16_d16_hi v222, v222
    v_pk_lshrrev_b16 v224, 3, v224 op_sel_hi:[0,1]
    v_mad_u32_u16 v225, v224, 2, s85
    v_mfma_f32_16x16x32_f16 v[184:187], a[152:155], v[140:143], v[184:187]
    ds_read_u16 v225, v225
    v_mad_u32_u16 v224, v224, 2, s85 op_sel:[1,0,0,0]
    v_cvt_pkrtz_f16_f32 v226, v180, v181
    v_mfma_f32_16x16x32_bf16 v[56:59], a[80:83], v[236:239], v[56:59]
    ds_read_u16_d16_hi v224, v224
    v_pk_lshrrev_b16 v226, 3, v226 op_sel_hi:[0,1]
    v_mad_u32_u16 v227, v226, 2, s85
    v_mfma_f32_16x16x32_f16 v[188:191], a[156:159], v[140:143], v[188:191]
    ds_read_u16 v227, v227
    v_mad_u32_u16 v226, v226, 2, s85 op_sel:[1,0,0,0]
    v_cvt_pkrtz_f16_f32 v228, v182, v183
    v_mfma_f32_16x16x32_bf16 v[60:63], a[84:87], v[236:239], v[60:63]
    ds_read_u16_d16_hi v226, v226
    v_pk_lshrrev_b16 v228, 3, v228 op_sel_hi:[0,1]
    v_mad_u32_u16 v229, v228, 2, s85
    v_mfma_f32_16x16x32_f16 v[184:187], a[160:163], v[148:151], v[184:187]
    ds_read_u16 v229, v229
    v_mad_u32_u16 v228, v228, 2, s85 op_sel:[1,0,0,0]
    v_mfma_f32_16x16x32_f16 v[188:191], a[164:167], v[148:151], v[188:191]
    ds_read_u16_d16_hi v228, v228
    v_mfma_f32_16x16x32_bf16 v[72:75], a[88:91], v[236:239], v[72:75]
    v_mfma_f32_16x16x32_bf16 v[76:79], a[92:95], v[236:239], v[76:79]
    s_waitcnt lgkmcnt(8)
    v_or_b32 v236, v214, v213
    v_or_b32 v237, v216, v215
    v_or_b32 v238, v218, v217
    v_mfma_f32_16x16x32_f16 v[192:195], a[0:3], v[152:155], 0
    s_waitcnt vmcnt(1)
    ds_read_b128 a[232:235], v8 offset:0
    v_cvt_pk_bf16_f32 v239, v220, v219
    v_cvt_pkrtz_f16_f32 v230, v184, v185
    v_mfma_f32_16x16x32_bf16 v[32:35], a[120:123], v[232:235], v[32:35]
    v_pk_lshrrev_b16 v230, 3, v230 op_sel_hi:[0,1]
    v_mad_u32_u16 v231, v230, 2, s85
    v_mad_u32_u16 v230, v230, 2, s85 op_sel:[1,0,0,0]
    v_mfma_f32_16x16x32_f16 v[196:199], a[4:7], v[152:155], 0
    ds_read_u16 v231, v231
    ds_read_u16_d16_hi v230, v230
    v_cvt_pkrtz_f16_f32 v248, v186, v187
    v_mfma_f32_16x16x32_bf16 v[36:39], a[124:127], v[232:235], v[36:39]
    v_pk_lshrrev_b16 v248, 3, v248 op_sel_hi:[0,1]
    v_mad_u32_u16 v249, v248, 2, s85
    v_mad_u32_u16 v248, v248, 2, s85 op_sel:[1,0,0,0]
    v_mfma_f32_16x16x32_f16 v[192:195], a[8:11], v[160:163], v[192:195]
    ds_read_u16 v249, v249
    ds_read_u16_d16_hi v248, v248
    v_cvt_pkrtz_f16_f32 v250, v188, v189
    v_mfma_f32_16x16x32_bf16 v[48:51], a[128:131], v[232:235], v[48:51]
    ds_read_b128 a[240:243], v14 offset:1280
    v_pk_lshrrev_b16 v250, 3, v250 op_sel_hi:[0,1]
    v_mad_u32_u16 v251, v250, 2, s85
    v_mfma_f32_16x16x32_f16 v[196:199], a[12:15], v[160:163], v[196:199]
    s_waitcnt lgkmcnt(12)
    ds_read_u16 v251, v251
    ds_read_b128 a[248:251], v12 offset:2560
    v_mad_u32_u16 v250, v250, 2, s85 op_sel:[1,0,0,0]
    v_mfma_f32_16x16x32_bf16 v[52:55], a[132:135], v[232:235], v[52:55]
    s_waitcnt lgkmcnt(13)
    ds_read_u16_d16_hi v250, v250
    v_cvt_pkrtz_f16_f32 v252, v190, v191
    v_pk_lshrrev_b16 v252, 3, v252 op_sel_hi:[0,1]
    v_mfma_f32_16x16x32_f16 v[192:195], a[16:19], v[168:171], v[192:195]
    v_mad_u32_u16 v253, v252, 2, s85
    v_mad_u32_u16 v252, v252, 2, s85 op_sel:[1,0,0,0]
    v_mfma_f32_16x16x32_bf16 v[64:67], a[136:139], v[232:235], v[64:67]
    s_waitcnt lgkmcnt(12)
    ds_read_u16 v253, v253
    ds_read_u16_d16_hi v252, v252
    v_mfma_f32_16x16x32_f16 v[196:199], a[20:23], v[168:171], v[196:199]
    s_waitcnt lgkmcnt(13)
    ds_read_b128 a[244:247], v8 offset:2560
    v_mfma_f32_16x16x32_bf16 v[68:71], a[140:143], v[232:235], v[68:71]
    v_or_b32 v232, v223, v222
    v_or_b32 v233, v225, v224
    v_or_b32 v234, v227, v226
    v_mfma_f32_16x16x32_f16 v[200:203], a[0:3], v[156:159], 0
    s_waitcnt lgkmcnt(12)
    ds_read_b128 a[236:239], v12 offset:0
    v_or_b32 v235, v229, v228
    v_cvt_pkrtz_f16_f32 v0, v192, v193
    v_mfma_f32_16x16x32_bf16 v[40:43], a[120:123], v[236:239], v[40:43]
    v_pk_lshrrev_b16 v0, 3, v0 op_sel_hi:[0,1]
    v_cvt_pkrtz_f16_f32 v209, v194, v195
    v_cvt_pkrtz_f16_f32 v211, v196, v197
    v_mfma_f32_16x16x32_f16 v[204:207], a[4:7], v[156:159], 0
    ds_read_b128 a[252:255], v14 offset:3840
    v_cvt_pkrtz_f16_f32 v213, v198, v199
    v_mad_u32_u16 v208, v0, 2, s85
    v_mfma_f32_16x16x32_bf16 v[44:47], a[124:127], v[236:239], v[44:47]
    s_waitcnt lgkmcnt(13)
    ds_read_u16 v208, v208
    v_mad_u32_u16 v0, v0, 2, s85 op_sel:[1,0,0,0]
    v_pk_lshrrev_b16 v209, 3, v209 op_sel_hi:[0,1]
    v_mfma_f32_16x16x32_f16 v[200:203], a[8:11], v[164:167], v[200:203]
    s_waitcnt lgkmcnt(13)
    ds_read_u16_d16_hi v0, v0
    v_mad_u32_u16 v210, v209, 2, s85
    v_mad_u32_u16 v209, v209, 2, s85 op_sel:[1,0,0,0]
    v_mfma_f32_16x16x32_bf16 v[56:59], a[128:131], v[236:239], v[56:59]
    s_waitcnt lgkmcnt(13)
    ds_read_u16 v210, v210
    v_pk_lshrrev_b16 v211, 3, v211 op_sel_hi:[0,1]
    v_mad_u32_u16 v212, v211, 2, s85
    v_mfma_f32_16x16x32_f16 v[204:207], a[12:15], v[164:167], v[204:207]
    s_waitcnt lgkmcnt(13)
    ds_read_u16_d16_hi v209, v209
    v_mad_u32_u16 v211, v211, 2, s85 op_sel:[1,0,0,0]
    v_pk_lshrrev_b16 v213, 3, v213 op_sel_hi:[0,1]
    v_mfma_f32_16x16x32_bf16 v[60:63], a[132:135], v[236:239], v[60:63]
    s_waitcnt lgkmcnt(13)
    ds_read_u16 v212, v212
    v_mad_u32_u16 v214, v213, 2, s85
    v_mad_u32_u16 v213, v213, 2, s85 op_sel:[1,0,0,0]
    v_mfma_f32_16x16x32_f16 v[200:203], a[16:19], v[172:175], v[200:203]
    s_waitcnt lgkmcnt(13)
    ds_read_u16_d16_hi v211, v211
    v_mfma_f32_16x16x32_f16 v[204:207], a[20:23], v[172:175], v[204:207]
    v_mfma_f32_16x16x32_bf16 v[72:75], a[136:139], v[236:239], v[72:75]
    s_waitcnt lgkmcnt(13)
    ds_read_u16 v214, v214
    v_mfma_f32_16x16x32_bf16 v[76:79], a[140:143], v[236:239], v[76:79]
    s_waitcnt lgkmcnt(12)
    v_or_b32 v236, v231, v230
    v_or_b32 v237, v249, v248
    v_or_b32 v238, v251, v250
    v_mfma_f32_16x16x32_f16 v[192:195], a[48:51], v[152:155], 0
    s_waitcnt lgkmcnt(10)
    ds_read_u16_d16_hi v213, v213
    v_or_b32 v239, v253, v252
    v_cvt_pkrtz_f16_f32 v215, v200, v201
    v_mfma_f32_16x16x32_bf16 v[32:35], a[168:171], v[232:235], v[32:35]
    v_cvt_pkrtz_f16_f32 v217, v202, v203
    v_cvt_pkrtz_f16_f32 v219, v204, v205
    v_cvt_pkrtz_f16_f32 v221, v206, v207
    v_mfma_f32_16x16x32_f16 v[196:199], a[52:55], v[152:155], 0
    v_pk_lshrrev_b16 v215, 3, v215 op_sel_hi:[0,1]
    v_mad_u32_u16 v216, v215, 2, s85
    v_mad_u32_u16 v215, v215, 2, s85 op_sel:[1,0,0,0]
    v_mfma_f32_16x16x32_bf16 v[36:39], a[172:175], v[232:235], v[36:39]
    ds_read_u16 v216, v216
    ds_read_u16_d16_hi v215, v215
    v_pk_lshrrev_b16 v217, 3, v217 op_sel_hi:[0,1]
    v_mfma_f32_16x16x32_f16 v[192:195], a[56:59], v[160:163], v[192:195]
    v_mad_u32_u16 v218, v217, 2, s85
    v_mad_u32_u16 v217, v217, 2, s85 op_sel:[1,0,0,0]
    v_pk_lshrrev_b16 v219, 3, v219 op_sel_hi:[0,1]
    v_mfma_f32_16x16x32_bf16 v[48:51], a[176:179], v[232:235], v[48:51]
    s_waitcnt lgkmcnt(12)
    ds_read_u16 v218, v218
    ds_read_u16_d16_hi v217, v217
    v_mad_u32_u16 v220, v219, 2, s85
    v_mfma_f32_16x16x32_f16 v[196:199], a[60:63], v[160:163], v[196:199]
    s_waitcnt lgkmcnt(13)
    ds_read_u16 v220, v220
    v_mad_u32_u16 v219, v219, 2, s85 op_sel:[1,0,0,0]
    v_pk_lshrrev_b16 v221, 3, v221 op_sel_hi:[0,1]
    v_mfma_f32_16x16x32_bf16 v[52:55], a[180:183], v[232:235], v[52:55]
    s_waitcnt lgkmcnt(13)
    ds_read_u16_d16_hi v219, v219
    v_mad_u32_u16 v222, v221, 2, s85
    v_mad_u32_u16 v221, v221, 2, s85 op_sel:[1,0,0,0]
    v_mfma_f32_16x16x32_f16 v[192:195], a[64:67], v[168:171], v[192:195]
    s_waitcnt lgkmcnt(10)
    ds_read_u16 v222, v222
    v_or_b32 v240, v208, v0
    v_or_b32 v241, v210, v209
    v_mfma_f32_16x16x32_bf16 v[64:67], a[184:187], v[232:235], v[64:67]
    ds_read_u16_d16_hi v221, v221
    v_cvt_pk_bf16_f32 v32, v32, v33
    v_cvt_pk_bf16_f32 v33, v34, v35
    v_mfma_f32_16x16x32_f16 v[196:199], a[68:71], v[168:171], v[196:199]
    s_waitcnt lgkmcnt(10)
    v_cvt_pkrtz_f16_f32 v223, v192, v193
    v_pk_lshrrev_b16 v223, 3, v223 op_sel_hi:[0,1]
    v_or_b32 v242, v212, v211
    v_mfma_f32_16x16x32_bf16 v[68:71], a[188:191], v[232:235], v[68:71]
    v_cvt_pkrtz_f16_f32 v225, v194, v195
    v_mad_u32_u16 v224, v223, 2, s85
    v_mad_u32_u16 v223, v223, 2, s85 op_sel:[1,0,0,0]
    v_mfma_f32_16x16x32_f16 v[200:203], a[48:51], v[156:159], 0
    ds_read_u16 v224, v224
    ds_read_u16_d16_hi v223, v223
    v_cvt_pkrtz_f16_f32 v227, v196, v197
    v_mfma_f32_16x16x32_bf16 v[40:43], a[168:171], v[236:239], v[40:43]
    s_waitcnt lgkmcnt(10)
    v_cvt_pkrtz_f16_f32 v229, v198, v199
    v_pk_lshrrev_b16 v225, 3, v225 op_sel_hi:[0,1]
    v_or_b32 v243, v214, v213
    v_mfma_f32_16x16x32_f16 v[204:207], a[52:55], v[156:159], 0
    v_mad_u32_u16 v226, v225, 2, s85
    v_mad_u32_u16 v225, v225, 2, s85 op_sel:[1,0,0,0]
    v_pk_lshrrev_b16 v227, 3, v227 op_sel_hi:[0,1]
    v_mfma_f32_16x16x32_bf16 v[44:47], a[172:175], v[236:239], v[44:47]
    ds_read_u16 v226, v226
    ds_read_u16_d16_hi v225, v225
    v_mad_u32_u16 v228, v227, 2, s85
    v_mfma_f32_16x16x32_f16 v[200:203], a[56:59], v[164:167], v[200:203]
    s_waitcnt lgkmcnt(10)
    v_mad_u32_u16 v227, v227, 2, s85 op_sel:[1,0,0,0]
    v_or_b32 v244, v216, v215
    v_pk_lshrrev_b16 v229, 3, v229 op_sel_hi:[0,1]
    v_mfma_f32_16x16x32_bf16 v[56:59], a[176:179], v[236:239], v[56:59]
    ds_read_u16 v228, v228
    v_mad_u32_u16 v230, v229, 2, s85
    v_mad_u32_u16 v229, v229, 2, s85 op_sel:[1,0,0,0]
    v_mfma_f32_16x16x32_f16 v[204:207], a[60:63], v[164:167], v[204:207]
    ds_read_u16_d16_hi v227, v227
    v_cvt_pk_bf16_f32 v34, v36, v37
    v_cvt_pk_bf16_f32 v35, v38, v39
    v_mfma_f32_16x16x32_bf16 v[60:63], a[180:183], v[236:239], v[60:63]
    s_waitcnt lgkmcnt(10)
    v_cvt_pk_bf16_f32 v40, v40, v41
    v_or_b32 v245, v218, v217
    v_cvt_pk_bf16_f32 v41, v42, v43
    v_mfma_f32_16x16x32_f16 v[200:203], a[64:67], v[172:175], v[200:203]
    ds_read_b128 v[188:191], v9 offset:2560
    v_cvt_pk_bf16_f32 v42, v44, v45
    v_cvt_pk_bf16_f32 v43, v46, v47
    v_mfma_f32_16x16x32_f16 v[204:207], a[68:71], v[172:175], v[204:207]
    ds_read_u16 v230, v230
    v_cvt_pk_bf16_f32 v48, v48, v49
    v_cvt_pk_bf16_f32 v49, v50, v51
    v_mfma_f32_16x16x32_bf16 v[72:75], a[184:187], v[236:239], v[72:75]
    s_waitcnt lgkmcnt(10)
    ds_read_u16_d16_hi v229, v229
    v_or_b32 v246, v220, v219
    v_cvt_pkrtz_f16_f32 v231, v200, v201
    v_mfma_f32_16x16x32_bf16 v[76:79], a[188:191], v[236:239], v[76:79]
    v_cvt_pkrtz_f16_f32 v249, v202, v203
    v_cvt_pkrtz_f16_f32 v253, v204, v205
    v_cvt_pkrtz_f16_f32 v209, v206, v207
    v_mfma_f32_16x16x32_f16 v[192:195], a[96:99], v[152:155], 0
    v_pk_lshrrev_b16 v231, 3, v231 op_sel_hi:[0,1]
    v_mad_u32_u16 v248, v231, 2, s85
    v_mad_u32_u16 v231, v231, 2, s85 op_sel:[1,0,0,0]
    v_mfma_f32_16x16x32_bf16 v[80:83], a[24:27], v[240:243], v[80:83]
    s_waitcnt lgkmcnt(9)
    ds_read_u16 v248, v248
    ds_read_u16_d16_hi v231, v231
    v_or_b32 v247, v222, v221
    v_mfma_f32_16x16x32_f16 v[196:199], a[100:103], v[152:155], 0
    v_pk_lshrrev_b16 v249, 3, v249 op_sel_hi:[0,1]
    v_mad_u32_u16 v250, v249, 2, s85
    v_mad_u32_u16 v249, v249, 2, s85 op_sel:[1,0,0,0]
    v_mfma_f32_16x16x32_bf16 v[84:87], a[28:31], v[240:243], v[84:87]
    ds_read_u16 v250, v250
    v_cvt_pk_bf16_f32 v50, v52, v53
    v_cvt_pk_bf16_f32 v51, v54, v55
    v_mfma_f32_16x16x32_f16 v[192:195], a[104:107], v[160:163], v[192:195]
    ds_read_u16_d16_hi v249, v249
    v_pk_fma_f16 v251, v253, v253, s53
    v_pk_fma_f16 v0, v209, v209, s53
    v_mfma_f32_16x16x32_bf16 v[96:99], a[32:35], v[240:243], v[96:99]
    v_pk_mul_f16 v251, v251, v253 neg_lo:[1,0] neg_hi:[1,0]
    v_pk_mul_f16 v0, v0, v209 neg_lo:[1,0] neg_hi:[1,0]
    v_exp_f16 v252, v251
    v_mfma_f32_16x16x32_f16 v[196:199], a[108:111], v[160:163], v[196:199]
    ds_read_b128 v[180:183], v13 offset:0
    v_exp_f16 v208, v0
    v_mfma_f32_16x16x32_bf16 v[100:103], a[36:39], v[240:243], v[100:103]
    v_exp_f16_sdwa v252, v251 dst_sel:WORD_1 dst_unused:UNUSED_PRESERVE src0_sel:WORD_1
    v_exp_f16_sdwa v208, v0 dst_sel:WORD_1 dst_unused:UNUSED_PRESERVE src0_sel:WORD_1
    v_mfma_f32_16x16x32_f16 v[192:195], a[112:115], v[168:171], v[192:195]
    v_pk_fma_f16 v252, v252, s86, s86
    v_pk_fma_f16 v208, v208, s86, s86
    v_rcp_f16 v251, v252
    v_mfma_f32_16x16x32_bf16 v[112:115], a[40:43], v[240:243], v[112:115]
    v_rcp_f16 v0, v208
    v_rcp_f16_sdwa v251, v252 dst_sel:WORD_1 dst_unused:UNUSED_PRESERVE src0_sel:WORD_1
    v_mfma_f32_16x16x32_f16 v[196:199], a[116:119], v[168:171], v[196:199]
    v_rcp_f16_sdwa v0, v208 dst_sel:WORD_1 dst_unused:UNUSED_PRESERVE src0_sel:WORD_1
    v_fma_mix_f32 v252, v251, v253, 0 op_sel_hi:[1,1,0]
    v_mfma_f32_16x16x32_bf16 v[116:119], a[44:47], v[240:243], v[116:119]
    v_fma_mix_f32 v208, v0, v209, 0 op_sel_hi:[1,1,0]
    v_fma_mix_f32 v251, v251, v253, 0 op_sel:[1,1,0] op_sel_hi:[1,1,0]
    v_fma_mix_f32 v0, v0, v209, 0 op_sel:[1,1,0] op_sel_hi:[1,1,0]
    v_mfma_f32_16x16x32_f16 v[200:203], a[96:99], v[156:159], 0
    s_waitcnt lgkmcnt(8)
    v_or_b32 v240, v224, v223
    v_or_b32 v241, v226, v225
    v_or_b32 v242, v228, v227
    v_mfma_f32_16x16x32_bf16 v[88:91], a[24:27], v[244:247], v[88:91]
    s_waitcnt lgkmcnt(5)
    buffer_store_dwordx4 v[40:43], v26, s[24:27], s81 offen offset:0 sc0 sc1
    buffer_store_dwordx4 v[48:51], v26, s[24:27], s80 offen offset:64 sc0 sc1
    v_or_b32 v243, v230, v229
    v_mfma_f32_16x16x32_f16 v[204:207], a[100:103], v[156:159], 0
    v_cvt_pkrtz_f16_f32 v210, v192, v193
    v_pk_lshrrev_b16 v210, 3, v210 op_sel_hi:[0,1]
    v_cvt_pkrtz_f16_f32 v212, v194, v195
    v_mfma_f32_16x16x32_bf16 v[92:95], a[28:31], v[244:247], v[92:95]
    v_cvt_pkrtz_f16_f32 v214, v196, v197
    v_cvt_pkrtz_f16_f32 v216, v198, v199
    v_mad_u32_u16 v211, v210, 2, s85
    v_mfma_f32_16x16x32_f16 v[200:203], a[104:107], v[164:167], v[200:203]
    ds_read_b128 v[176:179], v9 offset:0
    ds_read_u16 v211, v211
    v_mad_u32_u16 v210, v210, 2, s85 op_sel:[1,0,0,0]
    v_mfma_f32_16x16x32_bf16 v[104:107], a[32:35], v[244:247], v[104:107]
    ds_read_b128 v[232:235], v13 offset:2560
    ds_read_u16_d16_hi v210, v210
    v_pk_lshrrev_b16 v212, 3, v212 op_sel_hi:[0,1]
    v_mfma_f32_16x16x32_f16 v[204:207], a[108:111], v[164:167], v[204:207]
    v_mad_u32_u16 v213, v212, 2, s85
    v_mad_u32_u16 v212, v212, 2, s85 op_sel:[1,0,0,0]
    v_pk_lshrrev_b16 v214, 3, v214 op_sel_hi:[0,1]
    v_mfma_f32_16x16x32_bf16 v[108:111], a[36:39], v[244:247], v[108:111]
    ds_read_u16 v213, v213
    ds_read_u16_d16_hi v212, v212
    v_mad_u32_u16 v215, v214, 2, s85
    v_mfma_f32_16x16x32_f16 v[200:203], a[112:115], v[172:175], v[200:203]
    ds_read_u16 v215, v215
    v_mad_u32_u16 v214, v214, 2, s85 op_sel:[1,0,0,0]
    v_pk_lshrrev_b16 v216, 3, v216 op_sel_hi:[0,1]
    v_mfma_f32_16x16x32_f16 v[204:207], a[116:119], v[172:175], v[204:207]
    ds_read_u16_d16_hi v214, v214
    v_mad_u32_u16 v217, v216, 2, s85
    v_mad_u32_u16 v216, v216, 2, s85 op_sel:[1,0,0,0]
    v_mfma_f32_16x16x32_bf16 v[120:123], a[40:43], v[244:247], v[120:123]
    s_waitcnt lgkmcnt(12)
    ds_read_u16 v217, v217
    ds_read_u16_d16_hi v216, v216
    v_cvt_pkrtz_f16_f32 v218, v200, v201
    v_mfma_f32_16x16x32_bf16 v[124:127], a[44:47], v[244:247], v[124:127]
    s_waitcnt lgkmcnt(11)
    v_or_b32 v244, v248, v231
    v_or_b32 v245, v250, v249
    v_cvt_pk_bf16_f32 v246, v252, v251
    v_mfma_f32_16x16x32_f16 v[192:195], a[144:147], v[152:155], 0
    ds_read_b128 v[184:187], v15 offset:1280
    v_cvt_pk_bf16_f32 v247, v208, v0
    v_cvt_pkrtz_f16_f32 v220, v202, v203
    v_mfma_f32_16x16x32_bf16 v[80:83], a[72:75], v[240:243], v[80:83]
    ds_read_b128 v[236:239], v15 offset:3840
    v_cvt_pkrtz_f16_f32 v222, v204, v205
    v_cvt_pkrtz_f16_f32 v224, v206, v207
    v_mfma_f32_16x16x32_f16 v[196:199], a[148:151], v[152:155], 0
    v_pk_lshrrev_b16 v218, 3, v218 op_sel_hi:[0,1]
    v_mad_u32_u16 v219, v218, 2, s85
    v_mad_u32_u16 v218, v218, 2, s85 op_sel:[1,0,0,0]
    v_mfma_f32_16x16x32_bf16 v[84:87], a[76:79], v[240:243], v[84:87]
    s_waitcnt lgkmcnt(12)
    ds_read_u16 v219, v219
    ds_read_u16_d16_hi v218, v218
    v_pk_lshrrev_b16 v220, 3, v220 op_sel_hi:[0,1]
    v_mfma_f32_16x16x32_f16 v[192:195], a[152:155], v[160:163], v[192:195]
    v_mad_u32_u16 v221, v220, 2, s85
    v_mad_u32_u16 v220, v220, 2, s85 op_sel:[1,0,0,0]
    v_pk_lshrrev_b16 v222, 3, v222 op_sel_hi:[0,1]
    v_mfma_f32_16x16x32_bf16 v[96:99], a[80:83], v[240:243], v[96:99]
    s_waitcnt lgkmcnt(12)
    ds_read_u16 v221, v221
    ds_read_u16_d16_hi v220, v220
    v_mad_u32_u16 v223, v222, 2, s85
    v_mfma_f32_16x16x32_f16 v[196:199], a[156:159], v[160:163], v[196:199]
    s_waitcnt lgkmcnt(13)
    ds_read_u16 v223, v223
    v_mad_u32_u16 v222, v222, 2, s85 op_sel:[1,0,0,0]
    v_pk_lshrrev_b16 v224, 3, v224 op_sel_hi:[0,1]
    v_mfma_f32_16x16x32_bf16 v[100:103], a[84:87], v[240:243], v[100:103]
    s_waitcnt lgkmcnt(13)
    ds_read_u16_d16_hi v222, v222
    v_mad_u32_u16 v225, v224, 2, s85
    v_mad_u32_u16 v224, v224, 2, s85 op_sel:[1,0,0,0]
    v_mfma_f32_16x16x32_f16 v[192:195], a[160:163], v[168:171], v[192:195]
    s_waitcnt lgkmcnt(12)
    ds_read_u16 v225, v225
    ds_read_u16_d16_hi v224, v224
    v_cvt_pk_bf16_f32 v56, v56, v57
    v_mfma_f32_16x16x32_bf16 v[112:115], a[88:91], v[240:243], v[112:115]
    v_cvt_pk_bf16_f32 v57, v58, v59
    v_cvt_pk_bf16_f32 v58, v60, v61
    v_cvt_pk_bf16_f32 v59, v62, v63
    v_mfma_f32_16x16x32_f16 v[196:199], a[164:167], v[168:171], v[196:199]
    v_cvt_pk_bf16_f32 v64, v64, v65
    v_cvt_pk_bf16_f32 v65, v66, v67
    v_cvt_pk_bf16_f32 v66, v68, v69
    v_mfma_f32_16x16x32_bf16 v[116:119], a[92:95], v[240:243], v[116:119]
    v_cvt_pk_bf16_f32 v67, v70, v71
    v_cvt_pk_bf16_f32 v72, v72, v73
    v_cvt_pk_bf16_f32 v73, v74, v75
    v_mfma_f32_16x16x32_f16 v[200:203], a[144:147], v[156:159], 0
    buffer_store_dwordx4 v[64:67], v26, s[24:27], s80 offen offset:128 sc0 sc1
    buffer_store_dwordx4 v[56:59], v26, s[24:27], s81 offen offset:64 sc0 sc1
    v_cvt_pk_bf16_f32 v74, v76, v77
    v_mfma_f32_16x16x32_bf16 v[88:91], a[72:75], v[244:247], v[88:91]
    v_cvt_pk_bf16_f32 v75, v78, v79
    v_or_b32 v240, v211, v210
    v_or_b32 v241, v213, v212
    v_mfma_f32_16x16x32_f16 v[204:207], a[148:151], v[156:159], 0
    s_waitcnt lgkmcnt(10)
    v_or_b32 v242, v215, v214
    v_or_b32 v243, v217, v216
    v_cvt_pkrtz_f16_f32 v226, v192, v193
    v_mfma_f32_16x16x32_bf16 v[92:95], a[76:79], v[244:247], v[92:95]
    v_pk_lshrrev_b16 v226, 3, v226 op_sel_hi:[0,1]
    v_cvt_pkrtz_f16_f32 v228, v194, v195
    v_cvt_pkrtz_f16_f32 v230, v196, v197
    v_mfma_f32_16x16x32_f16 v[200:203], a[152:155], v[164:167], v[200:203]
    buffer_store_dwordx4 v[72:75], v26, s[24:27], s81 offen offset:128 sc0 sc1
    v_cvt_pkrtz_f16_f32 v248, v198, v199
    v_mad_u32_u16 v227, v226, 2, s85
    v_mfma_f32_16x16x32_bf16 v[104:107], a[80:83], v[244:247], v[104:107]
    ds_read_u16 v227, v227
    v_mad_u32_u16 v226, v226, 2, s85 op_sel:[1,0,0,0]
    v_pk_lshrrev_b16 v228, 3, v228 op_sel_hi:[0,1]
    v_mfma_f32_16x16x32_f16 v[204:207], a[156:159], v[164:167], v[204:207]
    ds_read_u16_d16_hi v226, v226
    v_mad_u32_u16 v229, v228, 2, s85
    v_mad_u32_u16 v228, v228, 2, s85 op_sel:[1,0,0,0]
    v_mfma_f32_16x16x32_bf16 v[108:111], a[84:87], v[244:247], v[108:111]
    ds_read_u16 v229, v229
    ds_read_u16_d16_hi v228, v228
    v_pk_lshrrev_b16 v230, 3, v230 op_sel_hi:[0,1]
    v_mfma_f32_16x16x32_f16 v[200:203], a[160:163], v[172:175], v[200:203]
    v_mad_u32_u16 v231, v230, 2, s85
    v_mad_u32_u16 v230, v230, 2, s85 op_sel:[1,0,0,0]
    v_pk_lshrrev_b16 v248, 3, v248 op_sel_hi:[0,1]
    v_mfma_f32_16x16x32_f16 v[204:207], a[164:167], v[172:175], v[204:207]
    s_waitcnt lgkmcnt(12)
    ds_read_u16 v231, v231
    ds_read_u16_d16_hi v230, v230
    v_mad_u32_u16 v249, v248, 2, s85
    v_mfma_f32_16x16x32_bf16 v[120:123], a[88:91], v[244:247], v[120:123]
    s_waitcnt lgkmcnt(13)
    ds_read_u16 v249, v249
    v_cvt_pkrtz_f16_f32 v250, v200, v201
    v_cvt_pkrtz_f16_f32 v252, v202, v203
    v_mfma_f32_16x16x32_bf16 v[124:127], a[92:95], v[244:247], v[124:127]
    s_waitcnt lgkmcnt(11)
    ds_read_b128 v[52:55], v21 offset:0
    v_or_b32 v244, v219, v218
    v_or_b32 v245, v221, v220
    v_mfma_f32_16x16x32_bf16 v[80:83], a[120:123], v[240:243], v[80:83]
    s_waitcnt lgkmcnt(8)
    v_or_b32 v246, v223, v222
    v_or_b32 v247, v225, v224
    v_cvt_pkrtz_f16_f32 v209, v204, v205
    v_mfma_f32_16x16x32_bf16 v[84:87], a[124:127], v[240:243], v[84:87]
    v_cvt_pkrtz_f16_f32 v212, v206, v207
    v_mad_u32_u16 v248, v248, 2, s85 op_sel:[1,0,0,0]
    v_pk_lshrrev_b16 v250, 3, v250 op_sel_hi:[0,1]
    v_mfma_f32_16x16x32_bf16 v[96:99], a[128:131], v[240:243], v[96:99]
    ds_read_u16_d16_hi v248, v248
    ds_read_b128 v[192:195], v22 offset:0
    v_mad_u32_u16 v251, v250, 2, s85
    v_mfma_f32_16x16x32_bf16 v[100:103], a[132:135], v[240:243], v[100:103]
    ds_read_u16 v251, v251
    v_mad_u32_u16 v250, v250, 2, s85 op_sel:[1,0,0,0]
    v_pk_lshrrev_b16 v252, 3, v252 op_sel_hi:[0,1]
    v_mfma_f32_16x16x32_bf16 v[112:115], a[136:139], v[240:243], v[112:115]
    ds_read_u16_d16_hi v250, v250
    v_mad_u32_u16 v253, v252, 2, s85
    v_mad_u32_u16 v252, v252, 2, s85 op_sel:[1,0,0,0]
    v_mfma_f32_16x16x32_bf16 v[116:119], a[140:143], v[240:243], v[116:119]
    s_waitcnt lgkmcnt(10)
    ds_read_u16 v253, v253
    ds_read_u16_d16_hi v252, v252
    v_or_b32 v240, v227, v226
    v_mfma_f32_16x16x32_bf16 v[88:91], a[120:123], v[244:247], v[88:91]
    s_waitcnt lgkmcnt(10)
    ds_read_b128 v[196:199], v22 offset:256
    ds_read_b128 v[60:63], v21 offset:2560
    v_or_b32 v241, v229, v228
    v_mfma_f32_16x16x32_bf16 v[92:95], a[124:127], v[244:247], v[92:95]
    s_waitcnt lgkmcnt(10)
    ds_read_b128 v[204:207], v22 offset:272
    v_or_b32 v242, v231, v230
    v_pk_fma_f16 v0, v209, v209, s53
    v_mfma_f32_16x16x32_bf16 v[104:107], a[128:131], v[244:247], v[104:107]
    ds_read_b128 v[56:59], v20 offset:2560
    v_pk_fma_f16 v210, v212, v212, s53
    v_pk_mul_f16 v0, v0, v209 neg_lo:[1,0] neg_hi:[1,0]
    v_mfma_f32_16x16x32_bf16 v[108:111], a[132:135], v[244:247], v[108:111]
    v_pk_mul_f16 v210, v210, v212 neg_lo:[1,0] neg_hi:[1,0]
    v_exp_f16 v208, v0
    v_mfma_f32_16x16x32_bf16 v[120:123], a[136:139], v[244:247], v[120:123]
    s_waitcnt lgkmcnt(9)
    buffer_store_dwordx4 v[32:35], v26, s[24:27], s80 offen offset:0 sc0 sc1
    v_or_b32 v243, v249, v248
    v_exp_f16 v211, v210
    v_mfma_f32_16x16x32_bf16 v[124:127], a[140:143], v[244:247], v[124:127]
    v_exp_f16_sdwa v208, v0 dst_sel:WORD_1 dst_unused:UNUSED_PRESERVE src0_sel:WORD_1
    v_exp_f16_sdwa v211, v210 dst_sel:WORD_1 dst_unused:UNUSED_PRESERVE src0_sel:WORD_1
    v_mfma_f32_16x16x32_bf16 v[80:83], a[168:171], v[240:243], v[80:83]
    ds_read_b128 v[200:203], v22 offset:16
    v_pk_fma_f16 v208, v208, s86, s86
    v_pk_fma_f16 v211, v211, s86, s86
    v_mfma_f32_16x16x32_bf16 v[84:87], a[172:175], v[240:243], v[84:87]
    ds_read_b128 v[48:51], v20 offset:0
    v_rcp_f16 v0, v208
    v_mfma_f32_16x16x32_bf16 v[96:99], a[176:179], v[240:243], v[96:99]
    s_add_u32 s52, s52, 1
    v_rcp_f16 v210, v211
    v_rcp_f16_sdwa v0, v208 dst_sel:WORD_1 dst_unused:UNUSED_PRESERVE src0_sel:WORD_1
    v_mfma_f32_16x16x32_bf16 v[100:103], a[180:183], v[240:243], v[100:103]
    s_cmp_eq_u32 s52, 4
    v_rcp_f16_sdwa v210, v211 dst_sel:WORD_1 dst_unused:UNUSED_PRESERVE src0_sel:WORD_1
    v_fma_mix_f32 v208, v0, v209, 0 op_sel_hi:[1,1,0]
    v_mfma_f32_16x16x32_bf16 v[112:115], a[184:187], v[240:243], v[112:115]
    v_fma_mix_f32 v211, v210, v212, 0 op_sel_hi:[1,1,0]
    v_fma_mix_f32 v0, v0, v209, 0 op_sel:[1,1,0] op_sel_hi:[1,1,0]
    v_fma_mix_f32 v210, v210, v212, 0 op_sel:[1,1,0] op_sel_hi:[1,1,0]
    v_mfma_f32_16x16x32_bf16 v[116:119], a[188:191], v[240:243], v[116:119]
    s_waitcnt lgkmcnt(6)
    v_or_b32 v244, v251, v250
    v_or_b32 v245, v253, v252
    v_cvt_pk_bf16_f32 v246, v208, v0
    v_cvt_pk_bf16_f32 v247, v211, v210
    s_cbranch_scc0 L_conv
L_final:
    s_nop 0
    v_mfma_f32_16x16x32_bf16 v[88:91], a[168:171], v[244:247], v[88:91]
    v_cvt_pk_bf16_f32 v80, v80, v81
    v_cvt_pk_bf16_f32 v81, v82, v83
    v_cvt_pk_bf16_f32 v82, v84, v85
    v_mfma_f32_16x16x32_bf16 v[92:95], a[172:175], v[244:247], v[92:95]
    v_cvt_pk_bf16_f32 v83, v86, v87
    v_cvt_pk_bf16_f32 v96, v96, v97
    v_cvt_pk_bf16_f32 v97, v98, v99
    v_mfma_f32_16x16x32_bf16 v[104:107], a[176:179], v[244:247], v[104:107]
    buffer_store_dwordx4 v[80:83], v26, s[24:27], s82 offen offset:0 sc0 sc1
    v_cvt_pk_bf16_f32 v98, v100, v101
    v_cvt_pk_bf16_f32 v99, v102, v103
    v_mfma_f32_16x16x32_bf16 v[108:111], a[180:183], v[244:247], v[108:111]
    buffer_store_dwordx4 v[96:99], v26, s[24:27], s82 offen offset:64 sc0 sc1
    v_cvt_pk_bf16_f32 v112, v112, v113
    v_cvt_pk_bf16_f32 v113, v114, v115
    v_mfma_f32_16x16x32_bf16 v[120:123], a[184:187], v[244:247], v[120:123]
    v_cvt_pk_bf16_f32 v114, v116, v117
    v_cvt_pk_bf16_f32 v115, v118, v119
    v_cvt_pk_bf16_f32 v88, v88, v89
    v_mfma_f32_16x16x32_bf16 v[124:127], a[188:191], v[244:247], v[124:127]
    v_cvt_pk_bf16_f32 v89, v90, v91
    v_cvt_pk_bf16_f32 v90, v92, v93
    v_cvt_pk_bf16_f32 v91, v94, v95
    v_cvt_pk_bf16_f32 v104, v104, v105
    v_cvt_pk_bf16_f32 v105, v106, v107
    v_cvt_pk_bf16_f32 v106, v108, v109
    v_cvt_pk_bf16_f32 v107, v110, v111
    v_cvt_pk_bf16_f32 v120, v120, v121
    v_cvt_pk_bf16_f32 v121, v122, v123
    v_cvt_pk_bf16_f32 v122, v124, v125
    v_cvt_pk_bf16_f32 v123, v126, v127
    buffer_store_dwordx4 v[112:115], v26, s[24:27], s82 offen offset:128 sc0 sc1
    buffer_store_dwordx4 v[88:91], v26, s[24:27], s83 offen offset:0 sc0 sc1
    buffer_store_dwordx4 v[104:107], v26, s[24:27], s83 offen offset:64 sc0 sc1
    buffer_store_dwordx4 v[120:123], v26, s[24:27], s83 offen offset:128 sc0 sc1
L_end:
    s_endpgm
.section .rodata,"a"
.p2align 6
.amdhsa_kernel standalone__modern_conv_block_convnext__vision_kernel
  .amdhsa_next_free_vgpr 512
  .amdhsa_next_free_sgpr 102
  .amdhsa_accum_offset 256
  .amdhsa_group_segment_fixed_size 0
  .amdhsa_kernarg_size 80
  .amdhsa_user_sgpr_count 2
  .amdhsa_user_sgpr_kernarg_segment_ptr 1
  .amdhsa_system_sgpr_workgroup_id_x 1
.end_amdhsa_kernel
```

```asm
; @launch grid=(256,1,1) block=(256,1,1) lds=163840
.amdgcn_target "amdgcn-amd-amdhsa--gfx950"
.text
.globl standalone__modern_conv_block_convnext__vision_kernel
.p2align 8
.type standalone__modern_conv_block_convnext__vision_kernel,@function
standalone__modern_conv_block_convnext__vision_kernel:
    s_cmp_ge_u32 s2, 256
    s_cbranch_scc1 L_end
    s_load_dwordx16 s[4:19], s[0:1], 0
    v_readfirstlane_b32 s3, v0
    v_and_b32 v129, 63, v0
    s_and_b32 s60, s2, 7
    s_lshr_b32 s61, s2, 7
    s_lshl1_add_u32 s60, s60, s61
    s_lshr_b32 s3, s3, 6
    s_getpc_b64 s[62:63]
L_pc:
    v_min_u32 v18, 2, v129
    s_lshr_b32 s71, s2, 3
    s_lshl2_add_u32 s71, s71, s3
    v_mad_u32_u24 v18, s71, 3, v18
    v_min_u32 v18, (L_last-L_pc)/128, v18
    v_lshlrev_b32 v18, 1, v18
    v_mad_u64_u32 v[18:19], vcc, v18, 64, s[62:63]
    global_load_dword v251, v[18:19], off
    s_bfe_u32 s61, s2, 0x40003
    s_lshl2_add_u32 s55, s61, s3
    s_mul_i32 s60, s60, 3145728
    s_mul_i32 s61, s55, 1536
    s_add_u32 s63, s60, s61
    s_sub_u32 s64, s63, 98496
    s_movk_i32 s65, 0
    s_movk_i32 s66, 2048
    s_cmp_eq_u32 s55, 0
    s_cmovk_i32 s65, 100
    s_cmovk_i32 s66, 1948
    s_cmp_eq_u32 s55, 63
    s_cmovk_i32 s66, 1800
    s_mul_i32 s56, s3, 12800
    s_add_u32 s56, s56, 90112
    s_mov_b32 s68, 96384
    v_lshrrev_b32 v131, 2, v129
    v_mul_u32_u24 v130, 205, v131
    v_mul_u32_u24 v131, 192, v131
    v_add_u32 v131, s64, v131
    v_lshlrev_b32 v132, 4, v0
    v_and_b32 v133, 16, v0
    v_bitop3_b32 v132, v132, v133, 48 bitop3:0x28
    v_bfrev_b32 v136, 1
    s_waitcnt lgkmcnt(0)
    s_mov_b32 s20, s4
    s_mov_b32 s21, s5
    s_mov_b32 s22, 50331648
    s_mov_b32 s23, 0x20000
    s_mulk_i32 s71, 640
    v_lshlrev_b32 v141, 7, v129
    v_cmp_gt_u32 vcc, 5, v129
    s_nop 1
    v_cndmask_b32 v141, v136, v141, vcc
    s_mov_b32 s44, s8
    s_mov_b32 s45, s9
    s_mov_b32 s46, 73728
    s_mov_b32 s47, 0x20000
    s_mov_b32 s48, s12
    s_mov_b32 s49, s13
    s_mov_b32 s50, 73728
    s_mov_b32 s51, 0x20000
    buffer_load_dword v142, v141, s[44:47], s71 offen
    buffer_load_dword v143, v141, s[48:51], s71 offen
    v_lshrrev_b32 v138, 5, v129
    s_movk_i32 s69, 192
    v_mul_u32_u24 v139, 1366, v0
    v_lshrrev_b32 v139, 16, v139
    v_mul_u32_u24 v139, 384, v139
    v_lshl_add_u32 v139, v0, 2, v139
    v_lshlrev_b32 v140, 3, v0
    s_mov_b32 s28, s6
    s_mov_b32 s29, s7
    s_mov_b32 s30, 1728
    s_mov_b32 s31, 0x20000
    s_mov_b32 s36, s14
    s_mov_b32 s37, s15
    s_mov_b32 s38, 192
    s_mov_b32 s39, 0x20000
    s_mov_b32 s40, s16
    s_mov_b32 s41, s17
    s_mov_b32 s42, 192
    s_mov_b32 s43, 0x20000
    s_mov_b32 s32, s10
    s_mov_b32 s33, s11
    s_mov_b32 s34, 768
    s_mov_b32 s35, 0x20000
    buffer_load_dword v144, v139, s[28:31], 0 offen
    buffer_load_dword v145, v139, s[28:31], 0 offen offset:192
    buffer_load_dword v146, v139, s[28:31], 0 offen offset:384
    buffer_load_dwordx2 v[148:149], v140, s[36:39], 0 offen
    buffer_load_dwordx2 v[150:151], v140, s[40:43], 0 offen
    s_cmp_ge_u32 s3, 2
    s_cbranch_scc1 L_prep1
L_prep0:
    v_bfe_u32 v158, v129, 2, 1
    v_bfe_u32 v159, v129, 3, 2
    v_lshl_add_u32 v159, v158, 2, v159
    v_and_b32 v160, 3, v129
    v_lshl_add_u32 v236, v138, 2, v160
    s_lshl_b32 s60, s3, 7
    v_lshl_add_u32 v236, v236, 4, s60
    v_mul_u32_u24 v159, 768, v159
    v_add_u32 v232, v159, v236
    v_add_u32 v233, 6144, v232
    v_and_b32 v159, 0x1c, v129
    v_cmp_eq_u32 vcc, 0x1c, v159
    s_mov_b32 s72, 72960
    s_mul_i32 s60, s3, 24576
    s_add_u32 s60, s60, 40960
    v_cndmask_b32 v237, v136, v236, vcc
    v_lshl_add_u32 v234, v129, 4, s60
    s_lshl_b32 s60, s3, 12
    s_add_u32 s60, s60, 40960
    v_mov_b32 v238, s60
    buffer_load_dwordx4 v[176:179], v236, s[44:47], s72 offen offset:0
    buffer_load_dwordx4 a[232:235], v237, s[32:35], 0 offen offset:0
    buffer_load_dwordx4 v[180:183], v236, s[44:47], s72 offen offset:256
    buffer_load_dwordx4 a[236:239], v237, s[32:35], 0 offen offset:256
    buffer_load_dwordx4 v[184:187], v236, s[44:47], s72 offen offset:512
    buffer_load_dwordx4 a[240:243], v237, s[32:35], 0 offen offset:512
    s_mov_b32 m0, s56
    s_movk_i32 s70, 5
L_xl0:
    v_lshrrev_b32 v134, 11, v130
    v_subrev_u32 v135, s65, v130
    v_mad_u32_u24 v134, v134, s68, v131
    v_and_b32 v135, 0x7ff, v135
    v_cmp_gt_u32 vcc, s66, v135
    v_lshrrev_b32 v135, 7, v130
    v_and_b32 v135, 32, v135
    v_xad_u32 v134, v132, v135, v134
    v_cndmask_b32 v134, v136, v134, vcc
    v_add_u32 v130, 3280, v130
    v_add_u32 v131, 3072, v131
    buffer_load_dwordx4 v134, s[20:23], 0 offen lds
    s_add_u32 m0, m0, 1024
    s_sub_u32 s70, s70, 1
    s_cbranch_scc0 L_xl0
    s_branch L_prb0
L_prep1:
    v_bfe_u32 v158, v129, 2, 1
    v_bfe_u32 v159, v129, 3, 2
    v_lshl_add_u32 v159, v158, 2, v159
    v_and_b32 v160, 3, v129
    v_lshl_add_u32 v159, v138, 4, v159
    s_lshl_b32 s60, s3, 6
    s_sub_u32 s60, s60, 128
    v_add_u32 v159, s60, v159
    v_xor_b32 v236, v138, v160
    v_lshlrev_b32 v236, 4, v236
    v_mad_u32_u24 v232, v159, s69, v236
    s_lshl_b32 s60, s3, 1
    s_sub_u32 s60, s60, 4
    v_add_u32 v159, s60, v158
    v_lshlrev_b32 v238, 11, v159
    v_add_u32 v238, 40960, v238
    v_mul_u32_u24 v159, 768, v159
    v_lshl_add_u32 v159, v158, 2, v159
    v_add_u32 v159, v160, v159
    v_bfe_u32 v160, v129, 3, 1
    v_lshl_add_u32 v159, v160, 6, v159
    v_lshrrev_b32 v160, 4, v129
    v_lshl_add_u32 v159, v160, 4, v159
    v_lshlrev_b32 v159, 4, v159
    v_add_u32 v234, 40960, v159
    v_xor_b32 v235, 64, v234
    buffer_load_dwordx4 v[208:211], v236, s[40:43], 0 offen offset:0
    buffer_load_dwordx4 v[212:215], v236, s[40:43], 0 offen offset:64
    buffer_load_dwordx4 v[216:219], v236, s[40:43], 0 offen offset:128
    s_mov_b32 m0, s56
    s_movk_i32 s70, 5
L_xl1:
    v_lshrrev_b32 v134, 11, v130
    v_subrev_u32 v135, s65, v130
    v_mad_u32_u24 v134, v134, s68, v131
    v_and_b32 v135, 0x7ff, v135
    v_cmp_gt_u32 vcc, s66, v135
    v_lshrrev_b32 v135, 7, v130
    v_and_b32 v135, 32, v135
    v_xad_u32 v134, v132, v135, v134
    v_cndmask_b32 v134, v136, v134, vcc
    v_add_u32 v130, 3280, v130
    v_add_u32 v131, 3072, v131
    buffer_load_dwordx4 v134, s[20:23], 0 offen lds
    s_add_u32 m0, m0, 1024
    s_sub_u32 s70, s70, 1
    s_cbranch_scc0 L_xl1
L_prb1:
    v_lshrrev_b32 v131, 4, v129
    v_add_u32 v131, 96, v131
    v_mul_u32_u24 v130, 205, v131
    v_mul_u32_u24 v131, 192, v131
    v_add_u32 v131, s64, v131
    v_lshlrev_b32 v133, 2, v129
    v_and_b32 v133, 63, v133
    v_lshrrev_b32 v134, 11, v130
    v_subrev_u32 v135, s65, v130
    v_mad_u32_u24 v134, v134, s68, v131
    v_and_b32 v135, 0x7ff, v135
    v_cmp_gt_u32 vcc, s66, v135
    v_lshrrev_b32 v135, 7, v130
    v_and_b32 v135, 32, v135
    v_xad_u32 v134, v133, v135, v134
    v_cndmask_b32 v7, v136, v134, vcc
    s_add_u32 m0, s56, 6144
    s_nop 0
    buffer_load_dword v7, s[20:23], 0 offen offset:0 lds
    v_lshrrev_b32 v131, 2, v129
    v_mul_u32_u24 v130, 205, v131
    v_mul_u32_u24 v131, 192, v131
    v_add_u32 v131, s64, v131
    v_lshrrev_b32 v134, 11, v130
    v_subrev_u32 v135, s65, v130
    v_mad_u32_u24 v134, v134, s68, v131
    v_and_b32 v135, 0x7ff, v135
    v_cmp_gt_u32 vcc, s66, v135
    v_lshrrev_b32 v135, 7, v130
    v_and_b32 v135, 32, v135
    v_xad_u32 v134, v132, v135, v134
    v_cndmask_b32 v1, v136, v134, vcc
    v_add_u32 v130, 3280, v130
    v_add_u32 v131, 3072, v131
    v_lshrrev_b32 v134, 11, v130
    v_subrev_u32 v135, s65, v130
    v_mad_u32_u24 v134, v134, s68, v131
    v_and_b32 v135, 0x7ff, v135
    v_cmp_gt_u32 vcc, s66, v135
    v_lshrrev_b32 v135, 7, v130
    v_and_b32 v135, 32, v135
    v_xad_u32 v134, v132, v135, v134
    v_cndmask_b32 v2, v136, v134, vcc
    v_add_u32 v130, 3280, v130
    v_add_u32 v131, 3072, v131
    v_lshrrev_b32 v134, 11, v130
    v_subrev_u32 v135, s65, v130
    v_mad_u32_u24 v134, v134, s68, v131
    v_and_b32 v135, 0x7ff, v135
    v_cmp_gt_u32 vcc, s66, v135
    v_lshrrev_b32 v135, 7, v130
    v_and_b32 v135, 32, v135
    v_xad_u32 v134, v132, v135, v134
    v_cndmask_b32 v3, v136, v134, vcc
    v_add_u32 v130, 3280, v130
    v_add_u32 v131, 3072, v131
    v_lshrrev_b32 v134, 11, v130
    v_subrev_u32 v135, s65, v130
    v_mad_u32_u24 v134, v134, s68, v131
    v_and_b32 v135, 0x7ff, v135
    v_cmp_gt_u32 vcc, s66, v135
    v_lshrrev_b32 v135, 7, v130
    v_and_b32 v135, 32, v135
    v_xad_u32 v134, v132, v135, v134
    v_cndmask_b32 v4, v136, v134, vcc
    v_add_u32 v130, 3280, v130
    v_add_u32 v131, 3072, v131
    v_lshrrev_b32 v134, 11, v130
    v_subrev_u32 v135, s65, v130
    v_mad_u32_u24 v134, v134, s68, v131
    v_and_b32 v135, 0x7ff, v135
    v_cmp_gt_u32 vcc, s66, v135
    v_lshrrev_b32 v135, 7, v130
    v_and_b32 v135, 32, v135
    v_xad_u32 v134, v132, v135, v134
    v_cndmask_b32 v5, v136, v134, vcc
    v_add_u32 v130, 3280, v130
    v_add_u32 v131, 3072, v131
    v_lshrrev_b32 v134, 11, v130
    v_subrev_u32 v135, s65, v130
    v_mad_u32_u24 v134, v134, s68, v131
    v_and_b32 v135, 0x7ff, v135
    v_cmp_gt_u32 vcc, s66, v135
    v_lshrrev_b32 v135, 7, v130
    v_and_b32 v135, 32, v135
    v_xad_u32 v134, v132, v135, v134
    v_cndmask_b32 v6, v136, v134, vcc
    s_cmp_lt_u32 s55, 63
    s_cselect_b32 s66, 10, 0
    s_add_u32 s64, s64, 1856
    v_mul_u32_u24 v134, 98304, v129
    v_add_u32 v134, s64, v134
    v_cmp_gt_u32 vcc, s66, v129
    s_nop 1
    v_cndmask_b32 v31, v136, v134, vcc
    v_mov_b32 v157, 268435456
    v_and_b32 v152, 15, v129
    v_lshrrev_b32 v153, 4, v129
    v_add_u32 v154, 4, v152
    v_lshrrev_b32 v154, 3, v154
    v_mad_i32_i24 v155, v154, -4, v152
    v_and_b32 v154, 1, v154
    v_and_b32 v156, 1, v153
    v_lshlrev_b32 v158, 1, v154
    v_mul_u32_u24 v159, 98304, v158
    v_mad_u32_u24 v159, v155, s69, v159
    v_lshl_add_u32 v159, v153, 4, v159
    v_add_u32 v26, s63, v159
    v_xor_b32 v161, v154, v138
    v_add_u32 v159, v153, v158
    v_add_u32 v160, 0, v155
    v_mad_u32_u24 v159, v159, 10, v160
    v_bfe_u32 v160, v159, 2, 1
    v_lshl_or_b32 v160, v161, 1, v160
    v_lshl_add_u32 v160, v159, 2, v160
    v_lshl_add_u32 v8, v160, 4, s56
    v_add_u32 v162, 1, v156
    v_add_u32 v159, v138, v158
    v_add_u32 v160, v162, v155
    v_mad_u32_u24 v159, v159, 10, v160
    v_bfe_u32 v160, v159, 2, 1
    v_lshl_or_b32 v160, v154, 1, v160
    v_lshl_add_u32 v160, v159, 2, v160
    v_lshl_add_u32 v12, v160, 4, s56
    v_xor_b32 v9, 16, v8
    v_xor_b32 v10, 32, v8
    v_xor_b32 v11, 48, v8
    v_xor_b32 v13, 16, v12
    v_xor_b32 v14, 32, v12
    v_xor_b32 v15, 48, v12
    v_add_u32 v159, 1, v158
    v_add_u32 v160, 1, v155
    v_mad_u32_u24 v159, v159, 10, v160
    v_bfe_u32 v160, v159, 2, 1
    v_lshl_or_b32 v160, v154, 1, v160
    v_xor_b32 v160, v153, v160
    v_lshl_add_u32 v160, v159, 2, v160
    v_lshl_add_u32 v20, v160, 4, s56
    v_xor_b32 v161, 1, v154
    v_add_u32 v159, 2, v158
    v_add_u32 v160, 1, v155
    v_mad_u32_u24 v159, v159, 10, v160
    v_bfe_u32 v160, v159, 2, 1
    v_lshl_or_b32 v160, v161, 1, v160
    v_xor_b32 v160, v153, v160
    v_lshl_add_u32 v160, v159, 2, v160
    v_lshl_add_u32 v21, v160, 4, s56
    v_bfe_u32 v158, v152, 2, 1
    v_sub_u32 v158, v153, v158
    v_and_b32 v159, 3, v152
    v_mul_u32_u24 v16, 0x1111, v159
    v_lshrrev_b32 v160, 3, v152
    v_lshl_add_u32 v159, v160, 2, v159
    v_lshlrev_b32 v159, 5, v159
    v_add_u32 v159, 141312, v159
    s_movk_i32 s70, 3072
    v_cmp_gt_u32 vcc, 3, v158
    v_mad_u32_u24 v159, v158, s70, v159
    s_nop 0
    v_cndmask_b32 v22, v157, v159, vcc
    v_lshlrev_b32 v23, 4, v129
    v_add_u32 v24, 40960, v23
    v_lshlrev_b32 v25, 5, v153
    v_add_u32 v25, 150528, v25
    v_and_b32 v160, 1, v129
    v_lshlrev_b32 v160, 4, v160
    v_mov_b32 v161, 0x3f80
    v_lshlrev_b32 v160, v160, v161
    v_bfe_u32 v158, v129, 1, 1
    v_bfe_u32 v159, v129, 3, 2
    v_lshl_add_u32 v159, v159, 1, v158
    v_bfe_u32 v161, v129, 2, 1
    v_xor_b32 v161, v161, v138
    v_lshl_add_u32 v159, v161, 3, v159
    v_lshlrev_b32 v159, v159, 1
    v_lshrrev_b32 v161, 2, v152
    v_xor_b32 v161, v161, v153
    v_lshl_add_u32 v158, v161, 1, v158
    v_lshlrev_b32 v158, v158, 1
    v_bfe_i32 v240, v159, 0, 1
    v_bfe_i32 v241, v159, 1, 1
    v_bfe_i32 v242, v159, 2, 1
    v_bfe_i32 v243, v159, 3, 1
    v_bfe_i32 v244, v159, 4, 1
    v_bfe_i32 v245, v159, 5, 1
    v_bfe_i32 v246, v159, 6, 1
    v_bfe_i32 v247, v159, 7, 1
    v_bfe_i32 v18, v158, 0, 1
    v_bfe_i32 v19, v158, 1, 1
    v_and_b32 v240, v160, v240
    v_and_b32 v241, v160, v241
    v_and_b32 v242, v160, v242
    v_and_b32 v243, v160, v243
    v_and_b32 v244, v160, v244
    v_and_b32 v245, v160, v245
    v_and_b32 v246, v160, v246
    v_and_b32 v247, v160, v247
    v_and_b32 v18, v160, v18
    v_and_b32 v19, v160, v19
    s_mov_b32 s24, s18
    s_mov_b32 s25, s19
    s_mov_b32 s26, 50331648
    s_mov_b32 s27, 0x20000
    s_mov_b32 s52, 0
    s_mov_b32 s80, 0
    s_mov_b32 s81, 98304
    s_mov_b32 s82, 393216
    s_mov_b32 s83, 491520
    s_mov_b32 s53, 1156138217
    s_mov_b32 s58, 0x3c003c00
    s_mov_b32 s85, 150912
    s_mov_b32 s86, 0x37803780
    s_mov_b32 s87, 0xffffffff
    s_mov_b32 s84, 0x37800000
    v_lshrrev_b32 v158, 2, v152
    v_xor_b32 v158, v158, v153
    v_bfe_i32 v158, v158, 0, 1
    v_bfi_b32 v158, v158, 0, s58
    v_accvgpr_write_b32 a228, v158
    v_accvgpr_write_b32 a229, v158
    v_accvgpr_write_b32 a230, v158
    v_accvgpr_write_b32 a231, v158
    v_and_b32 v17, v138, v153
    v_lshlrev_b32 v17, 4, v17
    v_lshrrev_b32 v17, v17, -1
    s_mov_b32 s73, 0x409d2a01
    s_mov_b32 s59, 0x3ef00000
    v_mul_u32_u24 v252, 0x100010, v0
    v_add_u32 v252, 0xc0004, v252
    v_lshlrev_b32 v253, 2, v0
    v_add_u32 v253, 150912, v253
    v_add_u32 v160, 0x0, v252
    v_add_u32 v168, 0x10001000, v252
    v_cvt_f32_f16 v161, v160
    v_cvt_f32_f16 v169, v168
    v_cvt_f32_f16_sdwa v162, v160 dst_sel:DWORD dst_unused:UNUSED_PAD src0_sel:WORD_1
    v_cvt_f32_f16_sdwa v170, v168 dst_sel:DWORD dst_unused:UNUSED_PAD src0_sel:WORD_1
    v_mul_f32 v163, 0x3f7fdde7, v161
    v_mul_f32 v171, 0x3f7fdde7, v169
    v_mul_f32 v164, 0x3f7fdde7, v162
    v_mul_f32 v172, 0x3f7fdde7, v170
    v_fma_f32 v163, v163, v161, s73
    v_fma_f32 v171, v171, v169, s73
    v_fma_f32 v164, v164, v162, s73
    v_fma_f32 v172, v172, v170, s73
    v_mul_f32 v163, -v161, v163
    v_mul_f32 v171, -v169, v171
    v_mul_f32 v164, -v162, v164
    v_mul_f32 v172, -v170, v172
    v_exp_f32 v165, v163
    v_exp_f32 v173, v171
    v_exp_f32 v166, v164
    v_exp_f32 v174, v172
    v_fma_f32 v163, v165, s59, s59
    v_fma_f32 v171, v173, s59, s59
    v_fma_f32 v164, v166, s59, s59
    v_fma_f32 v172, v174, s59, s59
    v_rcp_f32 v163, v163
    v_rcp_f32 v171, v171
    v_rcp_f32 v164, v164
    v_rcp_f32 v172, v172
    v_mul_f32 v163, v161, v163
    v_mul_f32 v171, v169, v171
    v_mul_f32 v164, v162, v164
    v_mul_f32 v172, v170, v172
    v_mul_f32 v165, -v165, v163
    v_mul_f32 v173, -v173, v171
    v_mul_f32 v166, -v166, v164
    v_mul_f32 v174, -v174, v172
    v_cvt_pk_bf16_f32 v167, v165, v166
    v_cvt_pk_bf16_f32 v175, v173, v174
    v_cvt_pk_bf16_f32 v160, v163, v164
    v_cvt_pk_bf16_f32 v168, v171, v172
    ds_write_b32 v253, v167 offset:8192
    ds_write_b32 v253, v160 offset:0
    ds_write_b32 v253, v175 offset:9216
    ds_write_b32 v253, v168 offset:1024
    v_add_u32 v160, 0x20002000, v252
    s_nop 0
    v_add_u32 v168, 0x30003000, v252
    v_cvt_f32_f16 v161, v160
    v_cvt_f32_f16 v169, v168
    v_cvt_f32_f16_sdwa v162, v160 dst_sel:DWORD dst_unused:UNUSED_PAD src0_sel:WORD_1
    v_cvt_f32_f16_sdwa v170, v168 dst_sel:DWORD dst_unused:UNUSED_PAD src0_sel:WORD_1
    v_mul_f32 v163, 0x3f7fdde7, v161
    v_mul_f32 v171, 0x3f7fdde7, v169
    v_mul_f32 v164, 0x3f7fdde7, v162
    v_mul_f32 v172, 0x3f7fdde7, v170
    v_fma_f32 v163, v163, v161, s73
    v_fma_f32 v171, v171, v169, s73
    v_fma_f32 v164, v164, v162, s73
    v_fma_f32 v172, v172, v170, s73
    v_mul_f32 v163, -v161, v163
    v_mul_f32 v171, -v169, v171
    v_mul_f32 v164, -v162, v164
    v_mul_f32 v172, -v170, v172
    v_exp_f32 v165, v163
    v_exp_f32 v173, v171
    v_exp_f32 v166, v164
    v_exp_f32 v174, v172
    v_fma_f32 v163, v165, s59, s59
    v_fma_f32 v171, v173, s59, s59
    v_fma_f32 v164, v166, s59, s59
    v_fma_f32 v172, v174, s59, s59
    v_rcp_f32 v163, v163
    v_rcp_f32 v171, v171
    v_rcp_f32 v164, v164
    v_rcp_f32 v172, v172
    v_mul_f32 v163, v161, v163
    v_mul_f32 v171, v169, v171
    v_mul_f32 v164, v162, v164
    v_mul_f32 v172, v170, v172
    v_mul_f32 v165, -v165, v163
    v_mul_f32 v173, -v173, v171
    v_mul_f32 v166, -v166, v164
    v_mul_f32 v174, -v174, v172
    v_cvt_pk_bf16_f32 v167, v165, v166
    v_cvt_pk_bf16_f32 v175, v173, v174
    v_cvt_pk_bf16_f32 v160, v163, v164
    v_cvt_pk_bf16_f32 v168, v171, v172
    ds_write_b32 v253, v167 offset:10240
    ds_write_b32 v253, v160 offset:2048
    ds_write_b32 v253, v175 offset:11264
    ds_write_b32 v253, v168 offset:3072
    v_add_u32 v160, 0x40004000, v252
    s_nop 0
    v_add_u32 v168, 0x50005000, v252
    v_cvt_f32_f16 v161, v160
    v_cvt_f32_f16 v169, v168
    v_cvt_f32_f16_sdwa v162, v160 dst_sel:DWORD dst_unused:UNUSED_PAD src0_sel:WORD_1
    v_cvt_f32_f16_sdwa v170, v168 dst_sel:DWORD dst_unused:UNUSED_PAD src0_sel:WORD_1
    v_mul_f32 v163, 0x3f7fdde7, v161
    v_mul_f32 v171, 0x40088889, v169
    v_mul_f32 v164, 0x3f7fdde7, v162
    v_mul_f32 v172, 0x40088889, v170
    v_fma_f32 v163, v163, v161, s73
    v_cvt_pk_bf16_f32 v168, v171, v172
    v_fma_f32 v164, v164, v162, s73
    v_mul_f32 v163, -v161, v163
    v_mul_f32 v164, -v162, v164
    v_exp_f32 v165, v163
    v_exp_f32 v166, v164
    v_fma_f32 v163, v165, s59, s59
    v_fma_f32 v164, v166, s59, s59
    v_rcp_f32 v163, v163
    v_rcp_f32 v164, v164
    v_mul_f32 v163, v161, v163
    v_mul_f32 v164, v162, v164
    v_mul_f32 v165, -v165, v163
    v_mul_f32 v166, -v166, v164
    v_cvt_pk_bf16_f32 v167, v165, v166
    v_cvt_pk_bf16_f32 v160, v163, v164
    ds_write_b32 v253, v167 offset:12288
    ds_write_b32 v253, v160 offset:4096
    ds_write_b32 v253, v168 offset:5120
    s_nop 0
    v_add_u32 v160, 0x60006000, v252
    v_add_u32 v168, 0x70007000, v252
    v_cvt_f32_f16 v161, v160
    v_cvt_f32_f16 v169, v168
    v_cvt_f32_f16_sdwa v162, v160 dst_sel:DWORD dst_unused:UNUSED_PAD src0_sel:WORD_1
    v_cvt_f32_f16_sdwa v170, v168 dst_sel:DWORD dst_unused:UNUSED_PAD src0_sel:WORD_1
    v_mul_f32 v163, 0x40088889, v161
    v_mul_f32 v171, 0x40088889, v169
    v_mul_f32 v164, 0x40088889, v162
    v_mul_f32 v172, 0x40088889, v170
    v_cvt_pk_bf16_f32 v160, v163, v164
    v_cvt_pk_bf16_f32 v168, v171, v172
    ds_write_b32 v253, v160 offset:6144
    ds_write_b32 v253, v168 offset:7168
    v_lshlrev_b32 v158, 6, v0
    v_add_u32 v158, 141312, v158
    v_cmp_gt_u32 vcc, 144, v0
    s_nop 1
    v_cndmask_b32 v158, v157, v158, vcc
    v_and_b32 v159, 3, v0
    v_lshl_add_u32 v160, v159, 2, v158
    v_lshrrev_b32 v159, 1, v159
    v_lshl_add_u32 v159, v159, 2, v158
    v_lshlrev_b32 v161, 4, v0
    v_add_u32 v161, 150528, v161
    v_cmp_gt_u32 vcc, 24, v0
    s_nop 1
    v_cndmask_b32 v161, v157, v161, vcc
    v_mov_b32 v164, 0
    v_mov_b32 v165, 0
    v_mov_b32 v166, 0
    v_mov_b32 v167, 0
    ds_write_b128 v158, v[164:167]
    ds_write_b128 v158, v[164:167] offset:16
    s_waitcnt lgkmcnt(9)
    ds_write_b128 v158, v[164:167] offset:32
    ds_write_b128 v158, v[164:167] offset:48
    s_waitcnt vmcnt(14)
    ds_write_b16 v160, v144
    ds_write_b16_d16_hi v160, v144 offset:34
    s_waitcnt vmcnt(13)
    ds_write_b16 v159, v145 offset:16
    ds_write_b16_d16_hi v159, v145 offset:48
    s_waitcnt vmcnt(12) lgkmcnt(13)
    ds_write_b16 v159, v146 offset:24
    ds_write_b16_d16_hi v159, v146 offset:56
    s_waitcnt vmcnt(11)
    v_lshlrev_b32 v168, 16, v148
    v_and_b32 v169, 0xffff0000, v148
    v_lshlrev_b32 v170, 16, v149
    v_and_b32 v171, 0xffff0000, v149
    s_waitcnt vmcnt(10)
    v_lshlrev_b32 v172, 16, v150
    v_and_b32 v173, 0xffff0000, v150
    v_lshlrev_b32 v174, 16, v151
    v_and_b32 v175, 0xffff0000, v151
    v_mul_f32 v168, v168, v172
    v_mul_f32 v169, v169, v173
    v_mul_f32 v170, v170, v174
    v_mul_f32 v171, v171, v175
    s_waitcnt lgkmcnt(14)
    ds_write_b128 v161, v[168:171]
    s_waitcnt vmcnt(9)
    v_mfma_f32_32x32x16_bf16 v[176:191], v[208:211], v[240:243], 0
    v_mfma_f32_32x32x16_bf16 v[176:191], v[208:211], v[244:247], v[176:191]
    s_waitcnt vmcnt(8)
    s_nop 10
    v_mfma_f32_32x32x16_bf16 v[180:195], v[212:215], v[240:243], 0
    v_mfma_f32_32x32x16_bf16 v[180:195], v[212:215], v[244:247], v[180:195]
    s_waitcnt vmcnt(7)
    s_nop 10
    v_mfma_f32_32x32x16_bf16 v[184:199], v[216:219], v[240:243], 0
    v_mfma_f32_32x32x16_bf16 v[184:199], v[216:219], v[244:247], v[184:199]
    s_mov_b32 s74, 0
    s_mov_b32 s75, 6144
    buffer_load_dwordx4 a[0:3], v232, s[48:51], s74 offen offset:0
    buffer_load_dwordx4 a[4:7], v232, s[48:51], s75 offen offset:0
    buffer_load_dwordx4 a[8:11], v232, s[48:51], s74 offen offset:1536
    buffer_load_dwordx4 a[12:15], v232, s[48:51], s75 offen offset:1536
    buffer_load_dwordx4 a[16:19], v232, s[48:51], s74 offen offset:64
    buffer_load_dwordx4 a[20:23], v232, s[48:51], s75 offen offset:64
    buffer_load_dwordx4 a[24:27], v232, s[48:51], s74 offen offset:1600
    buffer_load_dwordx4 a[28:31], v232, s[48:51], s75 offen offset:1600
    buffer_load_dwordx4 a[32:35], v232, s[48:51], s74 offen offset:128
    buffer_load_dwordx4 a[36:39], v232, s[48:51], s75 offen offset:128
    buffer_load_dwordx4 a[40:43], v232, s[48:51], s74 offen offset:1664
    buffer_load_dwordx4 a[44:47], v232, s[48:51], s75 offen offset:1664
    s_mov_b32 s74, 24576
    s_mov_b32 s75, 30720
    buffer_load_dwordx4 a[48:51], v232, s[48:51], s74 offen offset:0
    buffer_load_dwordx4 a[52:55], v232, s[48:51], s75 offen offset:0
    buffer_load_dwordx4 a[56:59], v232, s[48:51], s74 offen offset:1536
    buffer_load_dwordx4 a[60:63], v232, s[48:51], s75 offen offset:1536
    buffer_load_dwordx4 a[64:67], v232, s[48:51], s74 offen offset:64
    buffer_load_dwordx4 a[68:71], v232, s[48:51], s75 offen offset:64
    buffer_load_dwordx4 a[72:75], v232, s[48:51], s74 offen offset:1600
    buffer_load_dwordx4 a[76:79], v232, s[48:51], s75 offen offset:1600
    buffer_load_dwordx4 a[80:83], v232, s[48:51], s74 offen offset:128
    buffer_load_dwordx4 a[84:87], v232, s[48:51], s75 offen offset:128
    buffer_load_dwordx4 a[88:91], v232, s[48:51], s74 offen offset:1664
    buffer_load_dwordx4 a[92:95], v232, s[48:51], s75 offen offset:1664
    s_waitcnt vmcnt(23)
    v_mfma_f32_32x32x16_bf16 v[80:95], a[0:3], v[240:243], 0
    s_waitcnt vmcnt(21)
    v_mfma_f32_32x32x16_bf16 v[96:111], a[8:11], v[240:243], 0
    v_mfma_f32_32x32x16_bf16 v[80:95], a[4:7], v[244:247], v[80:95]
    s_waitcnt vmcnt(20)
    v_mfma_f32_32x32x16_bf16 v[96:111], a[12:15], v[244:247], v[96:111]
    s_waitcnt vmcnt(19)
    v_mfma_f32_32x32x16_bf16 v[112:127], a[16:19], v[240:243], 0
    s_waitcnt vmcnt(17)
    v_mfma_f32_32x32x16_bf16 v[128:143], a[24:27], v[240:243], 0
    v_mfma_f32_32x32x16_bf16 v[112:127], a[20:23], v[244:247], v[112:127]
    s_waitcnt vmcnt(16)
    v_mfma_f32_32x32x16_bf16 v[128:143], a[28:31], v[244:247], v[128:143]
    s_nop 2
    v_pk_mul_f32 v[80:81], v[80:81], v[176:177]
    v_pk_mul_f32 v[84:85], v[84:85], v[176:177]
    v_pk_mul_f32 v[88:89], v[88:89], v[176:177]
    v_pk_mul_f32 v[92:93], v[92:93], v[176:177]
    v_pk_mul_f32 v[96:97], v[96:97], v[176:177]
    v_pk_mul_f32 v[100:101], v[100:101], v[176:177]
    v_pk_mul_f32 v[104:105], v[104:105], v[176:177]
    v_pk_mul_f32 v[108:109], v[108:109], v[176:177]
    v_cvt_pk_bf16_f32 v224, v80, v84
    v_cvt_pk_bf16_f32 v225, v88, v92
    v_cvt_pk_bf16_f32 v226, v96, v100
    v_cvt_pk_bf16_f32 v227, v104, v108
    s_waitcnt vmcnt(15)
    v_mfma_f32_32x32x16_bf16 v[144:159], a[32:35], v[240:243], 0
    s_waitcnt lgkmcnt(14)
    ds_write_b128 v234, v[224:227] offset:6144
    s_mov_b32 s74, 49152
    v_cvt_pk_bf16_f32 v228, v81, v85
    v_cvt_pk_bf16_f32 v229, v89, v93
    v_cvt_pk_bf16_f32 v230, v97, v101
    v_cvt_pk_bf16_f32 v231, v105, v109
    s_waitcnt vmcnt(13)
    v_mfma_f32_32x32x16_bf16 v[160:175], a[40:43], v[240:243], 0
    s_waitcnt lgkmcnt(14)
    ds_write_b128 v235, v[228:231] offset:6144
    s_mov_b32 s75, 55296
    buffer_load_dwordx4 v[32:35], v232, s[48:51], s74 offen offset:0
    v_pk_mul_f32 v[82:83], v[82:83], v[178:179]
    v_pk_mul_f32 v[86:87], v[86:87], v[178:179]
    v_pk_mul_f32 v[90:91], v[90:91], v[178:179]
    v_pk_mul_f32 v[94:95], v[94:95], v[178:179]
    v_pk_mul_f32 v[98:99], v[98:99], v[178:179]
    v_pk_mul_f32 v[102:103], v[102:103], v[178:179]
    v_pk_mul_f32 v[106:107], v[106:107], v[178:179]
    v_pk_mul_f32 v[110:111], v[110:111], v[178:179]
    v_cvt_pk_bf16_f32 v224, v82, v86
    v_cvt_pk_bf16_f32 v225, v90, v94
    v_cvt_pk_bf16_f32 v226, v98, v102
    v_cvt_pk_bf16_f32 v227, v106, v110
    v_mfma_f32_32x32x16_bf16 v[144:159], a[36:39], v[244:247], v[144:159]
    s_waitcnt lgkmcnt(14)
    ds_write_b128 v234, v[224:227] offset:6272
    buffer_load_dwordx4 v[36:39], v232, s[48:51], s75 offen offset:0
    v_cvt_pk_bf16_f32 v228, v83, v87
    v_cvt_pk_bf16_f32 v229, v91, v95
    v_cvt_pk_bf16_f32 v230, v99, v103
    v_cvt_pk_bf16_f32 v231, v107, v111
    s_waitcnt vmcnt(14)
    v_mfma_f32_32x32x16_bf16 v[160:175], a[44:47], v[244:247], v[160:175]
    s_waitcnt vmcnt(10)
    s_waitcnt lgkmcnt(14)
    ds_write_b128 v235, v[228:231] offset:6272
    buffer_load_dwordx4 v[40:43], v232, s[48:51], s74 offen offset:1536
    buffer_load_dwordx4 v[44:47], v232, s[48:51], s75 offen offset:1536
    v_pk_mul_f32 v[112:113], v[112:113], v[180:181]
    v_pk_mul_f32 v[116:117], v[116:117], v[180:181]
    v_pk_mul_f32 v[120:121], v[120:121], v[180:181]
    v_pk_mul_f32 v[124:125], v[124:125], v[180:181]
    v_pk_mul_f32 v[128:129], v[128:129], v[180:181]
    v_pk_mul_f32 v[132:133], v[132:133], v[180:181]
    v_pk_mul_f32 v[136:137], v[136:137], v[180:181]
    v_pk_mul_f32 v[140:141], v[140:141], v[180:181]
    v_cvt_pk_bf16_f32 v224, v112, v116
    v_cvt_pk_bf16_f32 v225, v120, v124
    v_cvt_pk_bf16_f32 v226, v128, v132
    v_cvt_pk_bf16_f32 v227, v136, v140
    v_mfma_f32_32x32x16_bf16 v[80:95], a[48:51], v[240:243], 0
    s_waitcnt lgkmcnt(14)
    ds_write_b128 v234, v[224:227] offset:8192
    buffer_load_dwordx4 v[48:51], v232, s[48:51], s74 offen offset:64
    v_cvt_pk_bf16_f32 v228, v113, v117
    v_cvt_pk_bf16_f32 v229, v121, v125
    v_cvt_pk_bf16_f32 v230, v129, v133
    v_cvt_pk_bf16_f32 v231, v137, v141
    v_mfma_f32_32x32x16_bf16 v[96:111], a[56:59], v[240:243], 0
    s_waitcnt lgkmcnt(14)
    ds_write_b128 v235, v[228:231] offset:8192
    buffer_load_dwordx4 v[52:55], v232, s[48:51], s75 offen offset:64
    v_pk_mul_f32 v[114:115], v[114:115], v[182:183]
    v_pk_mul_f32 v[118:119], v[118:119], v[182:183]
    v_pk_mul_f32 v[122:123], v[122:123], v[182:183]
    v_pk_mul_f32 v[126:127], v[126:127], v[182:183]
    v_pk_mul_f32 v[130:131], v[130:131], v[182:183]
    v_pk_mul_f32 v[134:135], v[134:135], v[182:183]
    v_pk_mul_f32 v[138:139], v[138:139], v[182:183]
    v_pk_mul_f32 v[142:143], v[142:143], v[182:183]
    v_cvt_pk_bf16_f32 v224, v114, v118
    v_cvt_pk_bf16_f32 v225, v122, v126
    v_cvt_pk_bf16_f32 v226, v130, v134
    v_cvt_pk_bf16_f32 v227, v138, v142
    v_mfma_f32_32x32x16_bf16 v[80:95], a[52:55], v[244:247], v[80:95]
    s_waitcnt lgkmcnt(14)
    ds_write_b128 v234, v[224:227] offset:8320
    buffer_load_dwordx4 v[56:59], v232, s[48:51], s74 offen offset:1600
    v_cvt_pk_bf16_f32 v228, v115, v119
    v_cvt_pk_bf16_f32 v229, v123, v127
    v_cvt_pk_bf16_f32 v230, v131, v135
    v_cvt_pk_bf16_f32 v231, v139, v143
    v_mfma_f32_32x32x16_bf16 v[96:111], a[60:63], v[244:247], v[96:111]
    s_waitcnt vmcnt(11)
    s_waitcnt lgkmcnt(14)
    ds_write_b128 v235, v[228:231] offset:8320
    buffer_load_dwordx4 v[60:63], v232, s[48:51], s75 offen offset:1600
    v_pk_mul_f32 v[144:145], v[144:145], v[184:185]
    v_pk_mul_f32 v[148:149], v[148:149], v[184:185]
    v_pk_mul_f32 v[152:153], v[152:153], v[184:185]
    v_pk_mul_f32 v[156:157], v[156:157], v[184:185]
    v_pk_mul_f32 v[160:161], v[160:161], v[184:185]
    v_pk_mul_f32 v[164:165], v[164:165], v[184:185]
    v_pk_mul_f32 v[168:169], v[168:169], v[184:185]
    v_pk_mul_f32 v[172:173], v[172:173], v[184:185]
    v_cvt_pk_bf16_f32 v224, v144, v148
    v_cvt_pk_bf16_f32 v225, v152, v156
    v_cvt_pk_bf16_f32 v226, v160, v164
    v_cvt_pk_bf16_f32 v227, v168, v172
    v_mfma_f32_32x32x16_bf16 v[112:127], a[64:67], v[240:243], 0
    s_waitcnt lgkmcnt(14)
    ds_write_b128 v234, v[224:227] offset:10240
    buffer_load_dwordx4 v[64:67], v232, s[48:51], s74 offen offset:128
    v_cvt_pk_bf16_f32 v228, v145, v149
    v_cvt_pk_bf16_f32 v229, v153, v157
    v_cvt_pk_bf16_f32 v230, v161, v165
    v_cvt_pk_bf16_f32 v231, v169, v173
    v_mfma_f32_32x32x16_bf16 v[128:143], a[72:75], v[240:243], 0
    s_waitcnt lgkmcnt(14)
    ds_write_b128 v235, v[228:231] offset:10240
    buffer_load_dwordx4 v[68:71], v232, s[48:51], s75 offen offset:128
    v_pk_mul_f32 v[146:147], v[146:147], v[186:187]
    v_pk_mul_f32 v[150:151], v[150:151], v[186:187]
    v_pk_mul_f32 v[154:155], v[154:155], v[186:187]
    v_pk_mul_f32 v[158:159], v[158:159], v[186:187]
    v_pk_mul_f32 v[162:163], v[162:163], v[186:187]
    v_pk_mul_f32 v[166:167], v[166:167], v[186:187]
    v_pk_mul_f32 v[170:171], v[170:171], v[186:187]
    v_pk_mul_f32 v[174:175], v[174:175], v[186:187]
    v_cvt_pk_bf16_f32 v224, v146, v150
    v_cvt_pk_bf16_f32 v225, v154, v158
    v_cvt_pk_bf16_f32 v226, v162, v166
    v_cvt_pk_bf16_f32 v227, v170, v174
    v_mfma_f32_32x32x16_bf16 v[112:127], a[68:71], v[244:247], v[112:127]
    s_waitcnt lgkmcnt(14)
    ds_write_b128 v234, v[224:227] offset:10368
    buffer_load_dwordx4 v[72:75], v232, s[48:51], s74 offen offset:1664
    v_cvt_pk_bf16_f32 v228, v147, v151
    v_cvt_pk_bf16_f32 v229, v155, v159
    v_cvt_pk_bf16_f32 v230, v163, v167
    v_cvt_pk_bf16_f32 v231, v171, v175
    v_mfma_f32_32x32x16_bf16 v[128:143], a[76:79], v[244:247], v[128:143]
    s_waitcnt vmcnt(11)
    s_waitcnt lgkmcnt(14)
    ds_write_b128 v235, v[228:231] offset:10368
    buffer_load_dwordx4 v[76:79], v232, s[48:51], s75 offen offset:1664
    v_sub_u32 v234, v234, v238
    v_sub_u32 v235, v235, v238
    v_pk_mul_f32 v[80:81], v[80:81], v[176:177]
    v_pk_mul_f32 v[84:85], v[84:85], v[176:177]
    v_pk_mul_f32 v[88:89], v[88:89], v[176:177]
    v_pk_mul_f32 v[92:93], v[92:93], v[176:177]
    v_pk_mul_f32 v[96:97], v[96:97], v[176:177]
    v_pk_mul_f32 v[100:101], v[100:101], v[176:177]
    v_pk_mul_f32 v[104:105], v[104:105], v[176:177]
    v_pk_mul_f32 v[108:109], v[108:109], v[176:177]
    v_cvt_pk_bf16_f32 v224, v80, v84
    v_cvt_pk_bf16_f32 v225, v88, v92
    v_cvt_pk_bf16_f32 v226, v96, v100
    v_cvt_pk_bf16_f32 v227, v104, v108
    v_mfma_f32_32x32x16_bf16 v[144:159], a[80:83], v[240:243], 0
    s_waitcnt lgkmcnt(0)
    s_barrier
    ds_write_b128 v234, v[224:227] offset:6144
    ds_read_b128 a[192:195], v23 offset:0
    ds_read_b128 a[196:199], v23 offset:1024
    ds_read_b128 a[200:203], v23 offset:10240
    ds_read_b128 a[204:207], v23 offset:11264
    ds_read_b128 a[208:211], v23 offset:20480
    ds_read_b128 a[212:215], v23 offset:21504
    ds_read_b128 a[216:219], v23 offset:30720
    s_add_u32 m0, s56, 6336
    s_nop 0
    buffer_load_dwordx4 v1, s[20:23], 0 offen offset:64 lds
    v_cvt_pk_bf16_f32 v228, v81, v85
    v_cvt_pk_bf16_f32 v229, v89, v93
    v_cvt_pk_bf16_f32 v230, v97, v101
    v_cvt_pk_bf16_f32 v231, v105, v109
    v_mfma_f32_32x32x16_bf16 v[160:175], a[88:91], v[240:243], 0
    ds_write_b128 v235, v[228:231] offset:6144
    ds_read_b128 a[220:223], v23 offset:31744
    ds_read_b128 a[0:3], v24 offset:0
    ds_read_b128 a[4:7], v24 offset:1024
    ds_read_b128 a[24:27], v24 offset:6144
    ds_read_b128 a[28:31], v24 offset:7168
    ds_read_b128 a[96:99], v24 offset:24576
    s_waitcnt lgkmcnt(14)
    ds_read_b128 a[100:103], v24 offset:25600
    s_add_u32 m0, s56, 7360
    s_nop 0
    buffer_load_dwordx4 v2, s[20:23], 0 offen offset:64 lds
    v_pk_mul_f32 v[82:83], v[82:83], v[178:179]
    v_pk_mul_f32 v[86:87], v[86:87], v[178:179]
    v_pk_mul_f32 v[90:91], v[90:91], v[178:179]
    v_pk_mul_f32 v[94:95], v[94:95], v[178:179]
    v_pk_mul_f32 v[98:99], v[98:99], v[178:179]
    v_pk_mul_f32 v[102:103], v[102:103], v[178:179]
    v_pk_mul_f32 v[106:107], v[106:107], v[178:179]
    v_pk_mul_f32 v[110:111], v[110:111], v[178:179]
    v_cvt_pk_bf16_f32 v224, v82, v86
    v_cvt_pk_bf16_f32 v225, v90, v94
    v_cvt_pk_bf16_f32 v226, v98, v102
    v_cvt_pk_bf16_f32 v227, v106, v110
    v_mfma_f32_32x32x16_bf16 v[144:159], a[84:87], v[244:247], v[144:159]
    s_waitcnt lgkmcnt(9)
    ds_write_b128 v234, v[224:227] offset:6272
    ds_read_b128 a[120:123], v24 offset:30720
    ds_read_b128 a[124:127], v24 offset:31744
    ds_read_b128 a[144:147], v24 offset:36864
    ds_read_b128 a[148:151], v24 offset:37888
    ds_read_b128 a[168:171], v24 offset:43008
    s_waitcnt lgkmcnt(13)
    ds_read_b128 a[172:175], v24 offset:44032
    ds_read_b128 a[48:51], v24 offset:12288
    s_add_u32 m0, s56, 8384
    s_nop 0
    buffer_load_dwordx4 v3, s[20:23], 0 offen offset:64 lds
    v_cvt_pk_bf16_f32 v228, v83, v87
    v_cvt_pk_bf16_f32 v229, v91, v95
    v_cvt_pk_bf16_f32 v230, v99, v103
    v_cvt_pk_bf16_f32 v231, v107, v111
    v_mfma_f32_32x32x16_bf16 v[160:175], a[92:95], v[244:247], v[160:175]
    s_waitcnt vmcnt(11)
    s_waitcnt lgkmcnt(9)
    ds_write_b128 v235, v[228:231] offset:6272
    ds_read_b128 a[52:55], v24 offset:13312
    ds_read_b128 a[72:75], v24 offset:18432
    ds_read_b128 a[76:79], v24 offset:19456
    ds_read_b128 a[8:11], v24 offset:2048
    ds_read_b128 a[12:15], v24 offset:3072
    s_waitcnt lgkmcnt(13)
    ds_read_b128 a[32:35], v24 offset:8192
    ds_read_b128 a[36:39], v24 offset:9216
    s_add_u32 m0, s56, 9408
    s_nop 0
    buffer_load_dwordx4 v4, s[20:23], 0 offen offset:64 lds
    v_pk_mul_f32 v[112:113], v[112:113], v[180:181]
    v_pk_mul_f32 v[116:117], v[116:117], v[180:181]
    v_pk_mul_f32 v[120:121], v[120:121], v[180:181]
    v_pk_mul_f32 v[124:125], v[124:125], v[180:181]
    v_pk_mul_f32 v[128:129], v[128:129], v[180:181]
    v_pk_mul_f32 v[132:133], v[132:133], v[180:181]
    v_pk_mul_f32 v[136:137], v[136:137], v[180:181]
    v_pk_mul_f32 v[140:141], v[140:141], v[180:181]
    v_cvt_pk_bf16_f32 v224, v112, v116
    v_cvt_pk_bf16_f32 v225, v120, v124
    v_cvt_pk_bf16_f32 v226, v128, v132
    v_cvt_pk_bf16_f32 v227, v136, v140
    v_mfma_f32_32x32x16_bf16 v[80:95], v[32:35], v[240:243], 0
    s_waitcnt lgkmcnt(9)
    ds_write_b128 v234, v[224:227] offset:8192
    ds_read_b128 a[104:107], v24 offset:26624
    ds_read_b128 a[108:111], v24 offset:27648
    ds_read_b128 a[128:131], v24 offset:32768
    ds_read_b128 a[132:135], v24 offset:33792
    ds_read_b128 a[152:155], v24 offset:38912
    s_waitcnt lgkmcnt(13)
    ds_read_b128 a[156:159], v24 offset:39936
    ds_read_b128 a[176:179], v24 offset:45056
    s_add_u32 m0, s56, 10432
    v_cvt_pk_bf16_f32 v228, v113, v117
    v_cvt_pk_bf16_f32 v229, v121, v125
    v_cvt_pk_bf16_f32 v230, v129, v133
    v_cvt_pk_bf16_f32 v231, v137, v141
    v_mfma_f32_32x32x16_bf16 v[96:111], v[40:43], v[240:243], 0
    s_waitcnt lgkmcnt(9)
    ds_write_b128 v235, v[228:231] offset:8192
    ds_read_b128 a[180:183], v24 offset:46080
    ds_read_b128 a[56:59], v24 offset:14336
    ds_read_b128 a[60:63], v24 offset:15360
    ds_read_b128 a[80:83], v24 offset:20480
    ds_read_b128 a[84:87], v24 offset:21504
    s_waitcnt lgkmcnt(13)
    ds_read_b128 a[16:19], v24 offset:4096
    ds_read_b128 a[20:23], v24 offset:5120
    buffer_load_dwordx4 v5, s[20:23], 0 offen offset:64 lds
    s_add_u32 m0, s56, 11456
    v_pk_mul_f32 v[114:115], v[114:115], v[182:183]
    v_pk_mul_f32 v[118:119], v[118:119], v[182:183]
    v_pk_mul_f32 v[122:123], v[122:123], v[182:183]
    v_pk_mul_f32 v[126:127], v[126:127], v[182:183]
    v_pk_mul_f32 v[130:131], v[130:131], v[182:183]
    v_pk_mul_f32 v[134:135], v[134:135], v[182:183]
    v_pk_mul_f32 v[138:139], v[138:139], v[182:183]
    v_pk_mul_f32 v[142:143], v[142:143], v[182:183]
    v_cvt_pk_bf16_f32 v224, v114, v118
    v_cvt_pk_bf16_f32 v225, v122, v126
    v_cvt_pk_bf16_f32 v226, v130, v134
    v_cvt_pk_bf16_f32 v227, v138, v142
    v_mfma_f32_32x32x16_bf16 v[80:95], v[36:39], v[244:247], v[80:95]
    s_waitcnt lgkmcnt(9)
    ds_write_b128 v234, v[224:227] offset:8320
    ds_read_b128 a[40:43], v24 offset:10240
    ds_read_b128 a[44:47], v24 offset:11264
    ds_read_b128 a[112:115], v24 offset:28672
    ds_read_b128 a[116:119], v24 offset:29696
    ds_read_b128 a[136:139], v24 offset:34816
    s_waitcnt lgkmcnt(13)
    ds_read_b128 a[140:143], v24 offset:35840
    ds_read_b128 a[160:163], v24 offset:40960
    buffer_load_dwordx4 v6, s[20:23], 0 offen offset:64 lds
    s_add_u32 m0, s56, 12480
    v_cvt_pk_bf16_f32 v228, v115, v119
    v_cvt_pk_bf16_f32 v229, v123, v127
    v_cvt_pk_bf16_f32 v230, v131, v135
    v_cvt_pk_bf16_f32 v231, v139, v143
    v_mfma_f32_32x32x16_bf16 v[96:111], v[44:47], v[244:247], v[96:111]
    s_waitcnt vmcnt(10)
    s_waitcnt lgkmcnt(9)
    ds_write_b128 v235, v[228:231] offset:8320
    ds_read_b128 a[164:167], v24 offset:41984
    ds_read_b128 a[184:187], v24 offset:47104
    ds_read_b128 a[188:191], v24 offset:48128
    ds_read_b128 a[64:67], v24 offset:16384
    ds_read_b128 a[68:71], v24 offset:17408
    s_waitcnt lgkmcnt(13)
    ds_read_b128 a[88:91], v24 offset:22528
    ds_read_b128 a[92:95], v24 offset:23552
    buffer_load_dword v7, s[20:23], 0 offen offset:64 lds
    buffer_load_dword v254, v31, s[20:23], 0 offen
    v_pk_mul_f32 v[144:145], v[144:145], v[184:185]
    v_pk_mul_f32 v[148:149], v[148:149], v[184:185]
    v_pk_mul_f32 v[152:153], v[152:153], v[184:185]
    v_pk_mul_f32 v[156:157], v[156:157], v[184:185]
    v_pk_mul_f32 v[160:161], v[160:161], v[184:185]
    v_pk_mul_f32 v[164:165], v[164:165], v[184:185]
    v_pk_mul_f32 v[168:169], v[168:169], v[184:185]
    v_pk_mul_f32 v[172:173], v[172:173], v[184:185]
    v_cvt_pk_bf16_f32 v224, v144, v148
    v_cvt_pk_bf16_f32 v225, v152, v156
    v_cvt_pk_bf16_f32 v226, v160, v164
    v_cvt_pk_bf16_f32 v227, v168, v172
    v_mfma_f32_32x32x16_bf16 v[112:127], v[48:51], v[240:243], 0
    s_waitcnt lgkmcnt(0)
    s_barrier
    ds_write_b128 v234, v[224:227] offset:0
    v_cvt_pk_bf16_f32 v228, v145, v149
    v_cvt_pk_bf16_f32 v229, v153, v157
    v_cvt_pk_bf16_f32 v230, v161, v165
    v_cvt_pk_bf16_f32 v231, v169, v173
    v_mfma_f32_32x32x16_bf16 v[128:143], v[56:59], v[240:243], 0
    ds_write_b128 v235, v[228:231] offset:0
    v_pk_mul_f32 v[146:147], v[146:147], v[186:187]
    v_pk_mul_f32 v[150:151], v[150:151], v[186:187]
    v_pk_mul_f32 v[154:155], v[154:155], v[186:187]
    v_pk_mul_f32 v[158:159], v[158:159], v[186:187]
    v_pk_mul_f32 v[162:163], v[162:163], v[186:187]
    v_pk_mul_f32 v[166:167], v[166:167], v[186:187]
    v_pk_mul_f32 v[170:171], v[170:171], v[186:187]
    v_pk_mul_f32 v[174:175], v[174:175], v[186:187]
    v_cvt_pk_bf16_f32 v224, v146, v150
    v_cvt_pk_bf16_f32 v225, v154, v158
    v_cvt_pk_bf16_f32 v226, v162, v166
    v_cvt_pk_bf16_f32 v227, v170, v174
    v_mfma_f32_32x32x16_bf16 v[112:127], v[52:55], v[244:247], v[112:127]
    ds_write_b128 v234, v[224:227] offset:128
    v_cvt_pk_bf16_f32 v228, v147, v151
    v_cvt_pk_bf16_f32 v229, v155, v159
    v_cvt_pk_bf16_f32 v230, v163, v167
    v_cvt_pk_bf16_f32 v231, v171, v175
    v_mfma_f32_32x32x16_bf16 v[128:143], v[60:63], v[244:247], v[128:143]
    s_waitcnt vmcnt(8)
    ds_write_b128 v235, v[228:231] offset:128
    v_add_u32 v234, v234, v238
    v_add_u32 v235, v235, v238
    v_pk_mul_f32 v[80:81], v[80:81], v[176:177]
    v_pk_mul_f32 v[84:85], v[84:85], v[176:177]
    v_pk_mul_f32 v[88:89], v[88:89], v[176:177]
    v_pk_mul_f32 v[92:93], v[92:93], v[176:177]
    v_pk_mul_f32 v[96:97], v[96:97], v[176:177]
    v_pk_mul_f32 v[100:101], v[100:101], v[176:177]
    v_pk_mul_f32 v[104:105], v[104:105], v[176:177]
    v_pk_mul_f32 v[108:109], v[108:109], v[176:177]
    v_cvt_pk_bf16_f32 v224, v80, v84
    v_cvt_pk_bf16_f32 v225, v88, v92
    v_cvt_pk_bf16_f32 v226, v96, v100
    v_cvt_pk_bf16_f32 v227, v104, v108
    v_mfma_f32_32x32x16_bf16 v[144:159], v[64:67], v[240:243], 0
    ds_write_b128 v234, v[224:227] offset:6144
    v_cvt_pk_bf16_f32 v228, v81, v85
    v_cvt_pk_bf16_f32 v229, v89, v93
    v_cvt_pk_bf16_f32 v230, v97, v101
    v_cvt_pk_bf16_f32 v231, v105, v109
    v_mfma_f32_32x32x16_bf16 v[160:175], v[72:75], v[240:243], 0
    ds_write_b128 v235, v[228:231] offset:6144
    v_pk_mul_f32 v[82:83], v[82:83], v[178:179]
    v_pk_mul_f32 v[86:87], v[86:87], v[178:179]
    v_pk_mul_f32 v[90:91], v[90:91], v[178:179]
    v_pk_mul_f32 v[94:95], v[94:95], v[178:179]
    v_pk_mul_f32 v[98:99], v[98:99], v[178:179]
    v_pk_mul_f32 v[102:103], v[102:103], v[178:179]
    v_pk_mul_f32 v[106:107], v[106:107], v[178:179]
    v_pk_mul_f32 v[110:111], v[110:111], v[178:179]
    v_cvt_pk_bf16_f32 v224, v82, v86
    v_cvt_pk_bf16_f32 v225, v90, v94
    v_cvt_pk_bf16_f32 v226, v98, v102
    v_cvt_pk_bf16_f32 v227, v106, v110
    v_mfma_f32_32x32x16_bf16 v[144:159], v[68:71], v[244:247], v[144:159]
    ds_write_b128 v234, v[224:227] offset:6272
    v_cvt_pk_bf16_f32 v228, v83, v87
    v_cvt_pk_bf16_f32 v229, v91, v95
    v_cvt_pk_bf16_f32 v230, v99, v103
    v_cvt_pk_bf16_f32 v231, v107, v111
    v_mfma_f32_32x32x16_bf16 v[160:175], v[76:79], v[244:247], v[160:175]
    ds_write_b128 v235, v[228:231] offset:6272
    v_pk_mul_f32 v[112:113], v[112:113], v[180:181]
    v_pk_mul_f32 v[116:117], v[116:117], v[180:181]
    v_pk_mul_f32 v[120:121], v[120:121], v[180:181]
    v_pk_mul_f32 v[124:125], v[124:125], v[180:181]
    v_pk_mul_f32 v[128:129], v[128:129], v[180:181]
    v_pk_mul_f32 v[132:133], v[132:133], v[180:181]
    v_pk_mul_f32 v[136:137], v[136:137], v[180:181]
    v_pk_mul_f32 v[140:141], v[140:141], v[180:181]
    v_cvt_pk_bf16_f32 v224, v112, v116
    v_cvt_pk_bf16_f32 v225, v120, v124
    v_cvt_pk_bf16_f32 v226, v128, v132
    v_cvt_pk_bf16_f32 v227, v136, v140
    ds_write_b128 v234, v[224:227] offset:8192
    v_cvt_pk_bf16_f32 v228, v113, v117
    v_cvt_pk_bf16_f32 v229, v121, v125
    v_cvt_pk_bf16_f32 v230, v129, v133
    v_cvt_pk_bf16_f32 v231, v137, v141
    ds_write_b128 v235, v[228:231] offset:8192
    v_pk_mul_f32 v[114:115], v[114:115], v[182:183]
    v_pk_mul_f32 v[118:119], v[118:119], v[182:183]
    v_pk_mul_f32 v[122:123], v[122:123], v[182:183]
    v_pk_mul_f32 v[126:127], v[126:127], v[182:183]
    v_pk_mul_f32 v[130:131], v[130:131], v[182:183]
    v_pk_mul_f32 v[134:135], v[134:135], v[182:183]
    v_pk_mul_f32 v[138:139], v[138:139], v[182:183]
    v_pk_mul_f32 v[142:143], v[142:143], v[182:183]
    v_cvt_pk_bf16_f32 v224, v114, v118
    v_cvt_pk_bf16_f32 v225, v122, v126
    v_cvt_pk_bf16_f32 v226, v130, v134
    v_cvt_pk_bf16_f32 v227, v138, v142
    ds_write_b128 v234, v[224:227] offset:8320
    v_cvt_pk_bf16_f32 v228, v115, v119
    v_cvt_pk_bf16_f32 v229, v123, v127
    v_cvt_pk_bf16_f32 v230, v131, v135
    v_cvt_pk_bf16_f32 v231, v139, v143
    ds_write_b128 v235, v[228:231] offset:8320
    v_pk_mul_f32 v[144:145], v[144:145], v[184:185]
    v_pk_mul_f32 v[148:149], v[148:149], v[184:185]
    v_pk_mul_f32 v[152:153], v[152:153], v[184:185]
    v_pk_mul_f32 v[156:157], v[156:157], v[184:185]
    v_pk_mul_f32 v[160:161], v[160:161], v[184:185]
    v_pk_mul_f32 v[164:165], v[164:165], v[184:185]
    v_pk_mul_f32 v[168:169], v[168:169], v[184:185]
    v_pk_mul_f32 v[172:173], v[172:173], v[184:185]
    v_cvt_pk_bf16_f32 v224, v144, v148
    v_cvt_pk_bf16_f32 v225, v152, v156
    v_cvt_pk_bf16_f32 v226, v160, v164
    v_cvt_pk_bf16_f32 v227, v168, v172
    ds_write_b128 v234, v[224:227] offset:10240
    v_cvt_pk_bf16_f32 v228, v145, v149
    v_cvt_pk_bf16_f32 v229, v153, v157
    v_cvt_pk_bf16_f32 v230, v161, v165
    v_cvt_pk_bf16_f32 v231, v169, v173
    ds_write_b128 v235, v[228:231] offset:10240
    v_pk_mul_f32 v[146:147], v[146:147], v[186:187]
    v_pk_mul_f32 v[150:151], v[150:151], v[186:187]
    v_pk_mul_f32 v[154:155], v[154:155], v[186:187]
    v_pk_mul_f32 v[158:159], v[158:159], v[186:187]
    v_pk_mul_f32 v[162:163], v[162:163], v[186:187]
    v_pk_mul_f32 v[166:167], v[166:167], v[186:187]
    v_pk_mul_f32 v[170:171], v[170:171], v[186:187]
    v_pk_mul_f32 v[174:175], v[174:175], v[186:187]
    v_cvt_pk_bf16_f32 v224, v146, v150
    v_cvt_pk_bf16_f32 v225, v154, v158
    v_cvt_pk_bf16_f32 v226, v162, v166
    v_cvt_pk_bf16_f32 v227, v170, v174
    ds_write_b128 v234, v[224:227] offset:10368
    v_cvt_pk_bf16_f32 v228, v147, v151
    v_cvt_pk_bf16_f32 v229, v155, v159
    v_cvt_pk_bf16_f32 v230, v163, v167
    v_cvt_pk_bf16_f32 v231, v171, v175
    s_waitcnt lgkmcnt(14)
    ds_write_b128 v235, v[228:231] offset:10368
    s_branch L_conv0
L_prb0:
    v_lshrrev_b32 v131, 4, v129
    v_add_u32 v131, 96, v131
    v_mul_u32_u24 v130, 205, v131
    v_mul_u32_u24 v131, 192, v131
    v_add_u32 v131, s64, v131
    v_lshlrev_b32 v133, 2, v129
    v_and_b32 v133, 63, v133
    v_lshrrev_b32 v134, 11, v130
    v_subrev_u32 v135, s65, v130
    v_mad_u32_u24 v134, v134, s68, v131
    v_and_b32 v135, 0x7ff, v135
    v_cmp_gt_u32 vcc, s66, v135
    v_lshrrev_b32 v135, 7, v130
    v_and_b32 v135, 32, v135
    v_xad_u32 v134, v133, v135, v134
    v_cndmask_b32 v7, v136, v134, vcc
    s_add_u32 m0, s56, 6144
    s_nop 0
    buffer_load_dword v7, s[20:23], 0 offen offset:0 lds
    v_lshrrev_b32 v131, 2, v129
    v_mul_u32_u24 v130, 205, v131
    v_mul_u32_u24 v131, 192, v131
    v_add_u32 v131, s64, v131
    v_lshrrev_b32 v134, 11, v130
    v_subrev_u32 v135, s65, v130
    v_mad_u32_u24 v134, v134, s68, v131
    v_and_b32 v135, 0x7ff, v135
    v_cmp_gt_u32 vcc, s66, v135
    v_lshrrev_b32 v135, 7, v130
    v_and_b32 v135, 32, v135
    v_xad_u32 v134, v132, v135, v134
    v_cndmask_b32 v1, v136, v134, vcc
    v_add_u32 v130, 3280, v130
    v_add_u32 v131, 3072, v131
    v_lshrrev_b32 v134, 11, v130
    v_subrev_u32 v135, s65, v130
    v_mad_u32_u24 v134, v134, s68, v131
    v_and_b32 v135, 0x7ff, v135
    v_cmp_gt_u32 vcc, s66, v135
    v_lshrrev_b32 v135, 7, v130
    v_and_b32 v135, 32, v135
    v_xad_u32 v134, v132, v135, v134
    v_cndmask_b32 v2, v136, v134, vcc
    v_add_u32 v130, 3280, v130
    v_add_u32 v131, 3072, v131
    v_lshrrev_b32 v134, 11, v130
    v_subrev_u32 v135, s65, v130
    v_mad_u32_u24 v134, v134, s68, v131
    v_and_b32 v135, 0x7ff, v135
    v_cmp_gt_u32 vcc, s66, v135
    v_lshrrev_b32 v135, 7, v130
    v_and_b32 v135, 32, v135
    v_xad_u32 v134, v132, v135, v134
    v_cndmask_b32 v3, v136, v134, vcc
    v_add_u32 v130, 3280, v130
    v_add_u32 v131, 3072, v131
    v_lshrrev_b32 v134, 11, v130
    v_subrev_u32 v135, s65, v130
    v_mad_u32_u24 v134, v134, s68, v131
    v_and_b32 v135, 0x7ff, v135
    v_cmp_gt_u32 vcc, s66, v135
    v_lshrrev_b32 v135, 7, v130
    v_and_b32 v135, 32, v135
    v_xad_u32 v134, v132, v135, v134
    v_cndmask_b32 v4, v136, v134, vcc
    v_add_u32 v130, 3280, v130
    v_add_u32 v131, 3072, v131
    v_lshrrev_b32 v134, 11, v130
    v_subrev_u32 v135, s65, v130
    v_mad_u32_u24 v134, v134, s68, v131
    v_and_b32 v135, 0x7ff, v135
    v_cmp_gt_u32 vcc, s66, v135
    v_lshrrev_b32 v135, 7, v130
    v_and_b32 v135, 32, v135
    v_xad_u32 v134, v132, v135, v134
    v_cndmask_b32 v5, v136, v134, vcc
    v_add_u32 v130, 3280, v130
    v_add_u32 v131, 3072, v131
    v_lshrrev_b32 v134, 11, v130
    v_subrev_u32 v135, s65, v130
    v_mad_u32_u24 v134, v134, s68, v131
    v_and_b32 v135, 0x7ff, v135
    v_cmp_gt_u32 vcc, s66, v135
    v_lshrrev_b32 v135, 7, v130
    v_and_b32 v135, 32, v135
    v_xad_u32 v134, v132, v135, v134
    v_cndmask_b32 v6, v136, v134, vcc
    s_cmp_lt_u32 s55, 63
    s_cselect_b32 s66, 10, 0
    s_add_u32 s64, s64, 1856
    v_mul_u32_u24 v134, 98304, v129
    v_add_u32 v134, s64, v134
    v_cmp_gt_u32 vcc, s66, v129
    s_nop 1
    v_cndmask_b32 v31, v136, v134, vcc
    v_mov_b32 v157, 268435456
    v_and_b32 v152, 15, v129
    v_lshrrev_b32 v153, 4, v129
    v_add_u32 v154, 4, v152
    v_lshrrev_b32 v154, 3, v154
    v_mad_i32_i24 v155, v154, -4, v152
    v_and_b32 v154, 1, v154
    v_and_b32 v156, 1, v153
    v_lshlrev_b32 v158, 1, v154
    v_mul_u32_u24 v159, 98304, v158
    v_mad_u32_u24 v159, v155, s69, v159
    v_lshl_add_u32 v159, v153, 4, v159
    v_add_u32 v26, s63, v159
    v_xor_b32 v161, v154, v138
    v_add_u32 v159, v153, v158
    v_add_u32 v160, 0, v155
    v_mad_u32_u24 v159, v159, 10, v160
    v_bfe_u32 v160, v159, 2, 1
    v_lshl_or_b32 v160, v161, 1, v160
    v_lshl_add_u32 v160, v159, 2, v160
    v_lshl_add_u32 v8, v160, 4, s56
    v_add_u32 v162, 1, v156
    v_add_u32 v159, v138, v158
    v_add_u32 v160, v162, v155
    v_mad_u32_u24 v159, v159, 10, v160
    v_bfe_u32 v160, v159, 2, 1
    v_lshl_or_b32 v160, v154, 1, v160
    v_lshl_add_u32 v160, v159, 2, v160
    v_lshl_add_u32 v12, v160, 4, s56
    v_xor_b32 v9, 16, v8
    v_xor_b32 v10, 32, v8
    v_xor_b32 v11, 48, v8
    v_xor_b32 v13, 16, v12
    v_xor_b32 v14, 32, v12
    v_xor_b32 v15, 48, v12
    v_add_u32 v159, 1, v158
    v_add_u32 v160, 1, v155
    v_mad_u32_u24 v159, v159, 10, v160
    v_bfe_u32 v160, v159, 2, 1
    v_lshl_or_b32 v160, v154, 1, v160
    v_xor_b32 v160, v153, v160
    v_lshl_add_u32 v160, v159, 2, v160
    v_lshl_add_u32 v20, v160, 4, s56
    v_xor_b32 v161, 1, v154
    v_add_u32 v159, 2, v158
    v_add_u32 v160, 1, v155
    v_mad_u32_u24 v159, v159, 10, v160
    v_bfe_u32 v160, v159, 2, 1
    v_lshl_or_b32 v160, v161, 1, v160
    v_xor_b32 v160, v153, v160
    v_lshl_add_u32 v160, v159, 2, v160
    v_lshl_add_u32 v21, v160, 4, s56
    v_bfe_u32 v158, v152, 2, 1
    v_sub_u32 v158, v153, v158
    v_and_b32 v159, 3, v152
    v_mul_u32_u24 v16, 0x1111, v159
    v_lshrrev_b32 v160, 3, v152
    v_lshl_add_u32 v159, v160, 2, v159
    v_lshlrev_b32 v159, 5, v159
    v_add_u32 v159, 141312, v159
    s_movk_i32 s70, 3072
    v_cmp_gt_u32 vcc, 3, v158
    v_mad_u32_u24 v159, v158, s70, v159
    s_nop 0
    v_cndmask_b32 v22, v157, v159, vcc
    v_lshlrev_b32 v23, 4, v129
    v_add_u32 v24, 40960, v23
    v_lshlrev_b32 v25, 5, v153
    v_add_u32 v25, 150528, v25
    v_and_b32 v160, 1, v129
    v_lshlrev_b32 v160, 4, v160
    v_mov_b32 v161, 0x3f80
    v_lshlrev_b32 v160, v160, v161
    v_bfe_u32 v158, v129, 1, 1
    v_bfe_u32 v159, v129, 3, 2
    v_lshl_add_u32 v159, v159, 1, v158
    v_bfe_u32 v161, v129, 2, 1
    v_xor_b32 v161, v161, v138
    v_lshl_add_u32 v159, v161, 3, v159
    v_lshlrev_b32 v159, v159, 1
    v_lshrrev_b32 v161, 2, v152
    v_xor_b32 v161, v161, v153
    v_lshl_add_u32 v158, v161, 1, v158
    v_lshlrev_b32 v158, v158, 1
    v_bfe_i32 v240, v159, 0, 1
    v_bfe_i32 v241, v159, 1, 1
    v_bfe_i32 v242, v159, 2, 1
    v_bfe_i32 v243, v159, 3, 1
    v_bfe_i32 v244, v159, 4, 1
    v_bfe_i32 v245, v159, 5, 1
    v_bfe_i32 v246, v159, 6, 1
    v_bfe_i32 v247, v159, 7, 1
    v_bfe_i32 v18, v158, 0, 1
    v_bfe_i32 v19, v158, 1, 1
    v_and_b32 v240, v160, v240
    v_and_b32 v241, v160, v241
    v_and_b32 v242, v160, v242
    v_and_b32 v243, v160, v243
    v_and_b32 v244, v160, v244
    v_and_b32 v245, v160, v245
    v_and_b32 v246, v160, v246
    v_and_b32 v247, v160, v247
    v_and_b32 v18, v160, v18
    v_and_b32 v19, v160, v19
    s_mov_b32 s24, s18
    s_mov_b32 s25, s19
    s_mov_b32 s26, 50331648
    s_mov_b32 s27, 0x20000
    s_mov_b32 s52, 0
    s_mov_b32 s80, 0
    s_mov_b32 s81, 98304
    s_mov_b32 s82, 393216
    s_mov_b32 s83, 491520
    s_mov_b32 s53, 1156138217
    s_mov_b32 s58, 0x3c003c00
    s_mov_b32 s85, 150912
    s_mov_b32 s86, 0x37803780
    s_mov_b32 s87, 0xffffffff
    s_mov_b32 s84, 0x37800000
    v_lshrrev_b32 v158, 2, v152
    v_xor_b32 v158, v158, v153
    v_bfe_i32 v158, v158, 0, 1
    v_bfi_b32 v158, v158, 0, s58
    v_accvgpr_write_b32 a228, v158
    v_accvgpr_write_b32 a229, v158
    v_accvgpr_write_b32 a230, v158
    v_accvgpr_write_b32 a231, v158
    v_and_b32 v17, v138, v153
    v_lshlrev_b32 v17, 4, v17
    v_lshrrev_b32 v17, v17, -1
    s_mov_b32 s73, 0x409d2a01
    s_mov_b32 s59, 0x3ef00000
    v_mul_u32_u24 v252, 0x100010, v0
    v_add_u32 v252, 0xc0004, v252
    v_lshlrev_b32 v253, 2, v0
    v_add_u32 v253, 150912, v253
    v_add_u32 v160, 0x0, v252
    v_add_u32 v168, 0x10001000, v252
    v_cvt_f32_f16 v161, v160
    v_cvt_f32_f16 v169, v168
    v_cvt_f32_f16_sdwa v162, v160 dst_sel:DWORD dst_unused:UNUSED_PAD src0_sel:WORD_1
    v_cvt_f32_f16_sdwa v170, v168 dst_sel:DWORD dst_unused:UNUSED_PAD src0_sel:WORD_1
    v_mul_f32 v163, 0x3f7fdde7, v161
    v_mul_f32 v171, 0x3f7fdde7, v169
    v_mul_f32 v164, 0x3f7fdde7, v162
    v_mul_f32 v172, 0x3f7fdde7, v170
    v_fma_f32 v163, v163, v161, s73
    v_fma_f32 v171, v171, v169, s73
    v_fma_f32 v164, v164, v162, s73
    v_fma_f32 v172, v172, v170, s73
    v_mul_f32 v163, -v161, v163
    v_mul_f32 v171, -v169, v171
    v_mul_f32 v164, -v162, v164
    v_mul_f32 v172, -v170, v172
    v_exp_f32 v165, v163
    v_exp_f32 v173, v171
    v_exp_f32 v166, v164
    v_exp_f32 v174, v172
    v_fma_f32 v163, v165, s59, s59
    v_fma_f32 v171, v173, s59, s59
    v_fma_f32 v164, v166, s59, s59
    v_fma_f32 v172, v174, s59, s59
    v_rcp_f32 v163, v163
    v_rcp_f32 v171, v171
    v_rcp_f32 v164, v164
    v_rcp_f32 v172, v172
    v_mul_f32 v163, v161, v163
    v_mul_f32 v171, v169, v171
    v_mul_f32 v164, v162, v164
    v_mul_f32 v172, v170, v172
    v_mul_f32 v165, -v165, v163
    v_mul_f32 v173, -v173, v171
    v_mul_f32 v166, -v166, v164
    v_mul_f32 v174, -v174, v172
    v_cvt_pk_bf16_f32 v167, v165, v166
    v_cvt_pk_bf16_f32 v175, v173, v174
    v_cvt_pk_bf16_f32 v160, v163, v164
    v_cvt_pk_bf16_f32 v168, v171, v172
    ds_write_b32 v253, v167 offset:8192
    ds_write_b32 v253, v160 offset:0
    ds_write_b32 v253, v175 offset:9216
    ds_write_b32 v253, v168 offset:1024
    v_add_u32 v160, 0x20002000, v252
    s_nop 0
    v_add_u32 v168, 0x30003000, v252
    v_cvt_f32_f16 v161, v160
    v_cvt_f32_f16 v169, v168
    v_cvt_f32_f16_sdwa v162, v160 dst_sel:DWORD dst_unused:UNUSED_PAD src0_sel:WORD_1
    v_cvt_f32_f16_sdwa v170, v168 dst_sel:DWORD dst_unused:UNUSED_PAD src0_sel:WORD_1
    v_mul_f32 v163, 0x3f7fdde7, v161
    v_mul_f32 v171, 0x3f7fdde7, v169
    v_mul_f32 v164, 0x3f7fdde7, v162
    v_mul_f32 v172, 0x3f7fdde7, v170
    v_fma_f32 v163, v163, v161, s73
    v_fma_f32 v171, v171, v169, s73
    v_fma_f32 v164, v164, v162, s73
    v_fma_f32 v172, v172, v170, s73
    v_mul_f32 v163, -v161, v163
    v_mul_f32 v171, -v169, v171
    v_mul_f32 v164, -v162, v164
    v_mul_f32 v172, -v170, v172
    v_exp_f32 v165, v163
    v_exp_f32 v173, v171
    v_exp_f32 v166, v164
    v_exp_f32 v174, v172
    v_fma_f32 v163, v165, s59, s59
    v_fma_f32 v171, v173, s59, s59
    v_fma_f32 v164, v166, s59, s59
    v_fma_f32 v172, v174, s59, s59
    v_rcp_f32 v163, v163
    v_rcp_f32 v171, v171
    v_rcp_f32 v164, v164
    v_rcp_f32 v172, v172
    v_mul_f32 v163, v161, v163
    v_mul_f32 v171, v169, v171
    v_mul_f32 v164, v162, v164
    v_mul_f32 v172, v170, v172
    v_mul_f32 v165, -v165, v163
    v_mul_f32 v173, -v173, v171
    v_mul_f32 v166, -v166, v164
    v_mul_f32 v174, -v174, v172
    v_cvt_pk_bf16_f32 v167, v165, v166
    v_cvt_pk_bf16_f32 v175, v173, v174
    v_cvt_pk_bf16_f32 v160, v163, v164
    v_cvt_pk_bf16_f32 v168, v171, v172
    ds_write_b32 v253, v167 offset:10240
    ds_write_b32 v253, v160 offset:2048
    ds_write_b32 v253, v175 offset:11264
    ds_write_b32 v253, v168 offset:3072
    v_add_u32 v160, 0x40004000, v252
    s_nop 0
    v_add_u32 v168, 0x50005000, v252
    v_cvt_f32_f16 v161, v160
    v_cvt_f32_f16 v169, v168
    v_cvt_f32_f16_sdwa v162, v160 dst_sel:DWORD dst_unused:UNUSED_PAD src0_sel:WORD_1
    v_cvt_f32_f16_sdwa v170, v168 dst_sel:DWORD dst_unused:UNUSED_PAD src0_sel:WORD_1
    v_mul_f32 v163, 0x3f7fdde7, v161
    v_mul_f32 v171, 0x40088889, v169
    v_mul_f32 v164, 0x3f7fdde7, v162
    v_mul_f32 v172, 0x40088889, v170
    v_fma_f32 v163, v163, v161, s73
    v_cvt_pk_bf16_f32 v168, v171, v172
    v_fma_f32 v164, v164, v162, s73
    v_mul_f32 v163, -v161, v163
    v_mul_f32 v164, -v162, v164
    v_exp_f32 v165, v163
    v_exp_f32 v166, v164
    v_fma_f32 v163, v165, s59, s59
    v_fma_f32 v164, v166, s59, s59
    v_rcp_f32 v163, v163
    v_rcp_f32 v164, v164
    v_mul_f32 v163, v161, v163
    v_mul_f32 v164, v162, v164
    v_mul_f32 v165, -v165, v163
    v_mul_f32 v166, -v166, v164
    v_cvt_pk_bf16_f32 v167, v165, v166
    v_cvt_pk_bf16_f32 v160, v163, v164
    ds_write_b32 v253, v167 offset:12288
    ds_write_b32 v253, v160 offset:4096
    ds_write_b32 v253, v168 offset:5120
    s_nop 0
    v_add_u32 v160, 0x60006000, v252
    v_add_u32 v168, 0x70007000, v252
    v_cvt_f32_f16 v161, v160
    v_cvt_f32_f16 v169, v168
    v_cvt_f32_f16_sdwa v162, v160 dst_sel:DWORD dst_unused:UNUSED_PAD src0_sel:WORD_1
    v_cvt_f32_f16_sdwa v170, v168 dst_sel:DWORD dst_unused:UNUSED_PAD src0_sel:WORD_1
    v_mul_f32 v163, 0x40088889, v161
    v_mul_f32 v171, 0x40088889, v169
    v_mul_f32 v164, 0x40088889, v162
    v_mul_f32 v172, 0x40088889, v170
    v_cvt_pk_bf16_f32 v160, v163, v164
    v_cvt_pk_bf16_f32 v168, v171, v172
    ds_write_b32 v253, v160 offset:6144
    ds_write_b32 v253, v168 offset:7168
    v_lshlrev_b32 v158, 6, v0
    v_add_u32 v158, 141312, v158
    v_cmp_gt_u32 vcc, 144, v0
    s_nop 1
    v_cndmask_b32 v158, v157, v158, vcc
    v_and_b32 v159, 3, v0
    v_lshl_add_u32 v160, v159, 2, v158
    v_lshrrev_b32 v159, 1, v159
    v_lshl_add_u32 v159, v159, 2, v158
    v_lshlrev_b32 v161, 4, v0
    v_add_u32 v161, 150528, v161
    v_cmp_gt_u32 vcc, 24, v0
    s_nop 1
    v_cndmask_b32 v161, v157, v161, vcc
    v_mov_b32 v164, 0
    v_mov_b32 v165, 0
    v_mov_b32 v166, 0
    v_mov_b32 v167, 0
    ds_write_b128 v158, v[164:167]
    ds_write_b128 v158, v[164:167] offset:16
    s_waitcnt lgkmcnt(9)
    ds_write_b128 v158, v[164:167] offset:32
    ds_write_b128 v158, v[164:167] offset:48
    s_waitcnt vmcnt(17)
    ds_write_b16 v160, v144
    ds_write_b16_d16_hi v160, v144 offset:34
    s_waitcnt vmcnt(16)
    ds_write_b16 v159, v145 offset:16
    ds_write_b16_d16_hi v159, v145 offset:48
    s_waitcnt vmcnt(15) lgkmcnt(13)
    ds_write_b16 v159, v146 offset:24
    ds_write_b16_d16_hi v159, v146 offset:56
    s_waitcnt vmcnt(14)
    v_lshlrev_b32 v168, 16, v148
    v_and_b32 v169, 0xffff0000, v148
    v_lshlrev_b32 v170, 16, v149
    v_and_b32 v171, 0xffff0000, v149
    s_waitcnt vmcnt(13)
    v_lshlrev_b32 v172, 16, v150
    v_and_b32 v173, 0xffff0000, v150
    v_lshlrev_b32 v174, 16, v151
    v_and_b32 v175, 0xffff0000, v151
    v_mul_f32 v168, v168, v172
    v_mul_f32 v169, v169, v173
    v_mul_f32 v170, v170, v174
    v_mul_f32 v171, v171, v175
    s_waitcnt lgkmcnt(14)
    ds_write_b128 v161, v[168:171]
    s_waitcnt vmcnt(12)
    v_xor_b32 v176, 0x80008000, v176
    v_xor_b32 v177, 0x80008000, v177
    v_xor_b32 v178, 0x80008000, v178
    v_xor_b32 v179, 0x80008000, v179
    s_nop 1
    v_mfma_f32_32x32x16_bf16 v[208:223], v[176:179], v[240:243], 0
    v_mfma_f32_32x32x16_bf16 v[208:223], v[176:179], v[244:247], v[208:223]
    s_waitcnt vmcnt(10)
    v_xor_b32 v180, 0x80008000, v180
    v_xor_b32 v181, 0x80008000, v181
    v_xor_b32 v182, 0x80008000, v182
    v_xor_b32 v183, 0x80008000, v183
    s_nop 1
    v_mfma_f32_32x32x16_bf16 v[192:207], v[180:183], v[240:243], 0
    v_mfma_f32_32x32x16_bf16 v[192:207], v[180:183], v[244:247], v[192:207]
    s_mov_b32 s74, 0
    s_mov_b32 s75, 12288
    buffer_load_dwordx4 a[0:3], v232, s[44:47], s74 offen offset:0
    buffer_load_dwordx4 a[4:7], v232, s[44:47], s75 offen offset:0
    buffer_load_dwordx4 a[8:11], v233, s[44:47], s74 offen offset:0
    buffer_load_dwordx4 a[12:15], v233, s[44:47], s75 offen offset:0
    s_mov_b32 s74, 24576
    s_mov_b32 s75, 36864
    buffer_load_dwordx4 a[16:19], v232, s[44:47], s74 offen offset:0
    buffer_load_dwordx4 a[20:23], v232, s[44:47], s75 offen offset:0
    buffer_load_dwordx4 a[24:27], v233, s[44:47], s74 offen offset:0
    buffer_load_dwordx4 a[28:31], v233, s[44:47], s75 offen offset:0
    s_mov_b32 s74, 49152
    s_mov_b32 s75, 61440
    buffer_load_dwordx4 a[32:35], v232, s[44:47], s74 offen offset:0
    buffer_load_dwordx4 a[36:39], v232, s[44:47], s75 offen offset:0
    buffer_load_dwordx4 a[40:43], v233, s[44:47], s74 offen offset:0
    buffer_load_dwordx4 a[44:47], v233, s[44:47], s75 offen offset:0
    s_mov_b32 s74, 0
    s_mov_b32 s75, 12288
    buffer_load_dwordx4 a[48:51], v232, s[44:47], s74 offen offset:256
    buffer_load_dwordx4 a[52:55], v232, s[44:47], s75 offen offset:256
    buffer_load_dwordx4 a[56:59], v233, s[44:47], s74 offen offset:256
    buffer_load_dwordx4 a[60:63], v233, s[44:47], s75 offen offset:256
    s_mov_b32 s74, 24576
    s_mov_b32 s75, 36864
    buffer_load_dwordx4 a[64:67], v232, s[44:47], s74 offen offset:256
    buffer_load_dwordx4 a[68:71], v232, s[44:47], s75 offen offset:256
    buffer_load_dwordx4 a[72:75], v233, s[44:47], s74 offen offset:256
    buffer_load_dwordx4 a[76:79], v233, s[44:47], s75 offen offset:256
    s_mov_b32 s74, 49152
    s_mov_b32 s75, 61440
    buffer_load_dwordx4 a[80:83], v232, s[44:47], s74 offen offset:256
    buffer_load_dwordx4 a[84:87], v232, s[44:47], s75 offen offset:256
    buffer_load_dwordx4 a[88:91], v233, s[44:47], s74 offen offset:256
    buffer_load_dwordx4 a[92:95], v233, s[44:47], s75 offen offset:256
    s_waitcnt vmcnt(23)
    v_mfma_f32_32x32x16_bf16 v[80:95], a[0:3], v[240:243], v[208:223]
    s_waitcnt vmcnt(21)
    v_mfma_f32_32x32x16_bf16 v[96:111], a[8:11], v[240:243], v[208:223]
    v_mfma_f32_32x32x16_bf16 v[80:95], a[4:7], v[244:247], v[80:95]
    s_waitcnt vmcnt(20)
    v_mfma_f32_32x32x16_bf16 v[96:111], a[12:15], v[244:247], v[96:111]
    s_waitcnt vmcnt(19)
    v_mfma_f32_32x32x16_bf16 v[112:127], a[16:19], v[240:243], v[208:223]
    s_waitcnt vmcnt(17)
    v_mfma_f32_32x32x16_bf16 v[128:143], a[24:27], v[240:243], v[208:223]
    v_mfma_f32_32x32x16_bf16 v[112:127], a[20:23], v[244:247], v[112:127]
    s_waitcnt vmcnt(16)
    v_mfma_f32_32x32x16_bf16 v[128:143], a[28:31], v[244:247], v[128:143]
    s_nop 2
    v_cvt_pk_f16_f32 v224, v80, v84
    v_cvt_pk_f16_f32 v225, v88, v92
    v_cvt_pk_f16_f32 v226, v96, v100
    v_cvt_pk_f16_f32 v227, v104, v108
    s_waitcnt vmcnt(15)
    v_mfma_f32_32x32x16_bf16 v[144:159], a[32:35], v[240:243], v[208:223]
    s_waitcnt lgkmcnt(14)
    ds_write_b128 v234, v[224:227] offset:0
    s_mov_b32 s74, 0
    v_cvt_pk_f16_f32 v228, v81, v85
    v_cvt_pk_f16_f32 v229, v89, v93
    v_cvt_pk_f16_f32 v230, v97, v101
    v_cvt_pk_f16_f32 v231, v105, v109
    s_waitcnt vmcnt(13)
    v_mfma_f32_32x32x16_bf16 v[160:175], a[40:43], v[240:243], v[208:223]
    s_waitcnt lgkmcnt(14)
    ds_write_b128 v234, v[228:231] offset:1024
    s_mov_b32 s75, 12288
    buffer_load_dwordx4 v[32:35], v232, s[44:47], s74 offen offset:512
    v_cvt_pk_f16_f32 v224, v82, v86
    v_cvt_pk_f16_f32 v225, v90, v94
    v_cvt_pk_f16_f32 v226, v98, v102
    v_cvt_pk_f16_f32 v227, v106, v110
    v_mfma_f32_32x32x16_bf16 v[144:159], a[36:39], v[244:247], v[144:159]
    s_waitcnt lgkmcnt(14)
    ds_write_b128 v234, v[224:227] offset:12288
    buffer_load_dwordx4 v[36:39], v232, s[44:47], s75 offen offset:512
    v_cvt_pk_f16_f32 v228, v83, v87
    v_cvt_pk_f16_f32 v229, v91, v95
    v_cvt_pk_f16_f32 v230, v99, v103
    v_cvt_pk_f16_f32 v231, v107, v111
    s_waitcnt vmcnt(14)
    v_mfma_f32_32x32x16_bf16 v[160:175], a[44:47], v[244:247], v[160:175]
    s_waitcnt vmcnt(10)
    s_waitcnt lgkmcnt(14)
    ds_write_b128 v234, v[228:231] offset:13312
    buffer_load_dwordx4 v[40:43], v233, s[44:47], s74 offen offset:512
    buffer_load_dwordx4 v[44:47], v233, s[44:47], s75 offen offset:512
    v_mfma_f32_32x32x16_bf16 v[160:175], a[232:235], v[244:247], v[160:175]
    v_cvt_pk_f16_f32 v224, v112, v116
    v_cvt_pk_f16_f32 v225, v120, v124
    v_cvt_pk_f16_f32 v226, v128, v132
    v_cvt_pk_f16_f32 v227, v136, v140
    v_mfma_f32_32x32x16_bf16 v[80:95], a[48:51], v[240:243], v[192:207]
    s_waitcnt lgkmcnt(14)
    ds_write_b128 v234, v[224:227] offset:2048
    s_mov_b32 s74, 24576
    v_cvt_pk_f16_f32 v228, v113, v117
    v_cvt_pk_f16_f32 v229, v121, v125
    v_cvt_pk_f16_f32 v230, v129, v133
    v_cvt_pk_f16_f32 v231, v137, v141
    v_mfma_f32_32x32x16_bf16 v[96:111], a[56:59], v[240:243], v[192:207]
    s_waitcnt lgkmcnt(14)
    ds_write_b128 v234, v[228:231] offset:3072
    s_mov_b32 s75, 36864
    buffer_load_dwordx4 v[48:51], v232, s[44:47], s74 offen offset:512
    v_cvt_pk_f16_f32 v224, v114, v118
    v_cvt_pk_f16_f32 v225, v122, v126
    v_cvt_pk_f16_f32 v226, v130, v134
    v_cvt_pk_f16_f32 v227, v138, v142
    v_mfma_f32_32x32x16_bf16 v[80:95], a[52:55], v[244:247], v[80:95]
    s_waitcnt lgkmcnt(14)
    ds_write_b128 v234, v[224:227] offset:14336
    buffer_load_dwordx4 v[52:55], v232, s[44:47], s75 offen offset:512
    v_cvt_pk_f16_f32 v228, v115, v119
    v_cvt_pk_f16_f32 v229, v123, v127
    v_cvt_pk_f16_f32 v230, v131, v135
    v_cvt_pk_f16_f32 v231, v139, v143
    v_mfma_f32_32x32x16_bf16 v[96:111], a[60:63], v[244:247], v[96:111]
    s_waitcnt vmcnt(10)
    s_waitcnt lgkmcnt(14)
    ds_write_b128 v234, v[228:231] offset:15360
    buffer_load_dwordx4 v[56:59], v233, s[44:47], s74 offen offset:512
    buffer_load_dwordx4 v[60:63], v233, s[44:47], s75 offen offset:512
    v_xor_b32 v184, 0x80008000, v184
    v_xor_b32 v185, 0x80008000, v185
    v_xor_b32 v186, 0x80008000, v186
    v_xor_b32 v187, 0x80008000, v187
    v_cvt_pk_f16_f32 v224, v144, v148
    v_cvt_pk_f16_f32 v225, v152, v156
    v_cvt_pk_f16_f32 v226, v160, v164
    v_cvt_pk_f16_f32 v227, v168, v172
    v_mfma_f32_32x32x16_bf16 v[112:127], a[64:67], v[240:243], v[192:207]
    s_waitcnt lgkmcnt(14)
    ds_write_b128 v234, v[224:227] offset:4096
    s_mov_b32 s74, 49152
    v_cvt_pk_f16_f32 v228, v145, v149
    v_cvt_pk_f16_f32 v229, v153, v157
    v_cvt_pk_f16_f32 v230, v161, v165
    v_cvt_pk_f16_f32 v231, v169, v173
    v_mfma_f32_32x32x16_bf16 v[128:143], a[72:75], v[240:243], v[192:207]
    s_waitcnt lgkmcnt(14)
    ds_write_b128 v234, v[228:231] offset:5120
    s_mov_b32 s75, 61440
    buffer_load_dwordx4 v[64:67], v232, s[44:47], s74 offen offset:512
    v_cvt_pk_f16_f32 v224, v146, v150
    v_cvt_pk_f16_f32 v225, v154, v158
    v_cvt_pk_f16_f32 v226, v162, v166
    v_cvt_pk_f16_f32 v227, v170, v174
    v_mfma_f32_32x32x16_bf16 v[112:127], a[68:71], v[244:247], v[112:127]
    s_waitcnt lgkmcnt(14)
    ds_write_b128 v234, v[224:227] offset:16384
    buffer_load_dwordx4 v[68:71], v232, s[44:47], s75 offen offset:512
    v_cvt_pk_f16_f32 v228, v147, v151
    v_cvt_pk_f16_f32 v229, v155, v159
    v_cvt_pk_f16_f32 v230, v163, v167
    v_cvt_pk_f16_f32 v231, v171, v175
    v_mfma_f32_32x32x16_bf16 v[128:143], a[76:79], v[244:247], v[128:143]
    s_waitcnt vmcnt(10)
    s_waitcnt lgkmcnt(14)
    ds_write_b128 v234, v[228:231] offset:17408
    buffer_load_dwordx4 v[72:75], v233, s[44:47], s74 offen offset:512
    buffer_load_dwordx4 v[76:79], v233, s[44:47], s75 offen offset:512
    v_sub_u32 v234, v234, v238
    v_mfma_f32_32x32x16_bf16 v[208:223], v[184:187], v[240:243], 0
    v_mfma_f32_32x32x16_bf16 v[208:223], v[184:187], v[244:247], v[208:223]
    v_cvt_pk_f16_f32 v224, v80, v84
    v_cvt_pk_f16_f32 v225, v88, v92
    v_cvt_pk_f16_f32 v226, v96, v100
    v_cvt_pk_f16_f32 v227, v104, v108
    v_mfma_f32_32x32x16_bf16 v[144:159], a[80:83], v[240:243], v[192:207]
    s_waitcnt lgkmcnt(14)
    ds_write_b128 v234, v[224:227] offset:0
    s_add_u32 m0, s56, 6336
    s_nop 0
    buffer_load_dwordx4 v1, s[20:23], 0 offen offset:64 lds
    v_cvt_pk_f16_f32 v228, v81, v85
    v_cvt_pk_f16_f32 v229, v89, v93
    v_cvt_pk_f16_f32 v230, v97, v101
    v_cvt_pk_f16_f32 v231, v105, v109
    v_mfma_f32_32x32x16_bf16 v[160:175], a[88:91], v[240:243], v[192:207]
    s_waitcnt lgkmcnt(14)
    ds_write_b128 v234, v[228:231] offset:1024
    s_add_u32 m0, s56, 7360
    s_nop 0
    buffer_load_dwordx4 v2, s[20:23], 0 offen offset:64 lds
    v_cvt_pk_f16_f32 v224, v82, v86
    v_cvt_pk_f16_f32 v225, v90, v94
    v_cvt_pk_f16_f32 v226, v98, v102
    v_cvt_pk_f16_f32 v227, v106, v110
    v_mfma_f32_32x32x16_bf16 v[144:159], a[84:87], v[244:247], v[144:159]
    s_waitcnt lgkmcnt(14)
    ds_write_b128 v234, v[224:227] offset:10240
    s_add_u32 m0, s56, 8384
    s_nop 0
    buffer_load_dwordx4 v3, s[20:23], 0 offen offset:64 lds
    v_cvt_pk_f16_f32 v228, v83, v87
    v_cvt_pk_f16_f32 v229, v91, v95
    v_cvt_pk_f16_f32 v230, v99, v103
    v_cvt_pk_f16_f32 v231, v107, v111
    v_mfma_f32_32x32x16_bf16 v[160:175], a[92:95], v[244:247], v[160:175]
    s_waitcnt vmcnt(11)
    s_waitcnt lgkmcnt(14)
    ds_write_b128 v234, v[228:231] offset:11264
    s_add_u32 m0, s56, 9408
    s_nop 0
    buffer_load_dwordx4 v4, s[20:23], 0 offen offset:64 lds
    v_mfma_f32_32x32x16_bf16 v[160:175], a[236:239], v[244:247], v[160:175]
    v_cvt_pk_f16_f32 v224, v112, v116
    v_cvt_pk_f16_f32 v225, v120, v124
    v_cvt_pk_f16_f32 v226, v128, v132
    v_cvt_pk_f16_f32 v227, v136, v140
    v_mfma_f32_32x32x16_bf16 v[80:95], v[32:35], v[240:243], v[208:223]
    s_waitcnt lgkmcnt(0)
    s_barrier
    ds_write_b128 v234, v[224:227] offset:2048
    ds_read_b128 a[192:195], v23 offset:0
    ds_read_b128 a[196:199], v23 offset:1024
    ds_read_b128 a[200:203], v23 offset:10240
    ds_read_b128 a[204:207], v23 offset:11264
    ds_read_b128 a[208:211], v23 offset:20480
    ds_read_b128 a[212:215], v23 offset:21504
    ds_read_b128 a[216:219], v23 offset:30720
    s_add_u32 m0, s56, 10432
    v_cvt_pk_f16_f32 v228, v113, v117
    v_cvt_pk_f16_f32 v229, v121, v125
    v_cvt_pk_f16_f32 v230, v129, v133
    v_cvt_pk_f16_f32 v231, v137, v141
    v_mfma_f32_32x32x16_bf16 v[96:111], v[40:43], v[240:243], v[208:223]
    ds_write_b128 v234, v[228:231] offset:3072
    ds_read_b128 a[220:223], v23 offset:31744
    ds_read_b128 a[0:3], v24 offset:0
    ds_read_b128 a[4:7], v24 offset:1024
    ds_read_b128 a[24:27], v24 offset:6144
    ds_read_b128 a[28:31], v24 offset:7168
    ds_read_b128 a[96:99], v24 offset:24576
    s_waitcnt lgkmcnt(14)
    ds_read_b128 a[100:103], v24 offset:25600
    buffer_load_dwordx4 v5, s[20:23], 0 offen offset:64 lds
    s_add_u32 m0, s56, 11456
    v_cvt_pk_f16_f32 v224, v114, v118
    v_cvt_pk_f16_f32 v225, v122, v126
    v_cvt_pk_f16_f32 v226, v130, v134
    v_cvt_pk_f16_f32 v227, v138, v142
    v_mfma_f32_32x32x16_bf16 v[80:95], v[36:39], v[244:247], v[80:95]
    s_waitcnt lgkmcnt(9)
    ds_write_b128 v234, v[224:227] offset:12288
    ds_read_b128 a[120:123], v24 offset:30720
    ds_read_b128 a[124:127], v24 offset:31744
    ds_read_b128 a[144:147], v24 offset:36864
    ds_read_b128 a[148:151], v24 offset:37888
    ds_read_b128 a[168:171], v24 offset:43008
    s_waitcnt lgkmcnt(13)
    ds_read_b128 a[172:175], v24 offset:44032
    ds_read_b128 a[48:51], v24 offset:12288
    buffer_load_dwordx4 v6, s[20:23], 0 offen offset:64 lds
    s_add_u32 m0, s56, 12480
    v_cvt_pk_f16_f32 v228, v115, v119
    v_cvt_pk_f16_f32 v229, v123, v127
    v_cvt_pk_f16_f32 v230, v131, v135
    v_cvt_pk_f16_f32 v231, v139, v143
    v_mfma_f32_32x32x16_bf16 v[96:111], v[44:47], v[244:247], v[96:111]
    s_waitcnt vmcnt(10)
    s_waitcnt lgkmcnt(9)
    ds_write_b128 v234, v[228:231] offset:13312
    ds_read_b128 a[52:55], v24 offset:13312
    ds_read_b128 a[72:75], v24 offset:18432
    ds_read_b128 a[76:79], v24 offset:19456
    ds_read_b128 a[8:11], v24 offset:2048
    ds_read_b128 a[12:15], v24 offset:3072
    s_waitcnt lgkmcnt(13)
    ds_read_b128 a[32:35], v24 offset:8192
    ds_read_b128 a[36:39], v24 offset:9216
    buffer_load_dword v7, s[20:23], 0 offen offset:64 lds
    buffer_load_dword v254, v31, s[20:23], 0 offen
    v_cvt_pk_f16_f32 v224, v144, v148
    v_cvt_pk_f16_f32 v225, v152, v156
    v_cvt_pk_f16_f32 v226, v160, v164
    v_cvt_pk_f16_f32 v227, v168, v172
    v_mfma_f32_32x32x16_bf16 v[112:127], v[48:51], v[240:243], v[208:223]
    s_waitcnt lgkmcnt(9)
    ds_write_b128 v234, v[224:227] offset:4096
    ds_read_b128 a[104:107], v24 offset:26624
    ds_read_b128 a[108:111], v24 offset:27648
    ds_read_b128 a[128:131], v24 offset:32768
    ds_read_b128 a[132:135], v24 offset:33792
    ds_read_b128 a[152:155], v24 offset:38912
    s_waitcnt lgkmcnt(13)
    ds_read_b128 a[156:159], v24 offset:39936
    ds_read_b128 a[176:179], v24 offset:45056
    v_cvt_pk_f16_f32 v228, v145, v149
    v_cvt_pk_f16_f32 v229, v153, v157
    v_cvt_pk_f16_f32 v230, v161, v165
    v_cvt_pk_f16_f32 v231, v169, v173
    v_mfma_f32_32x32x16_bf16 v[128:143], v[56:59], v[240:243], v[208:223]
    s_waitcnt lgkmcnt(9)
    ds_write_b128 v234, v[228:231] offset:5120
    ds_read_b128 a[180:183], v24 offset:46080
    ds_read_b128 a[56:59], v24 offset:14336
    ds_read_b128 a[60:63], v24 offset:15360
    ds_read_b128 a[80:83], v24 offset:20480
    ds_read_b128 a[84:87], v24 offset:21504
    s_waitcnt lgkmcnt(13)
    ds_read_b128 a[16:19], v24 offset:4096
    ds_read_b128 a[20:23], v24 offset:5120
    v_cvt_pk_f16_f32 v224, v146, v150
    v_cvt_pk_f16_f32 v225, v154, v158
    v_cvt_pk_f16_f32 v226, v162, v166
    v_cvt_pk_f16_f32 v227, v170, v174
    v_mfma_f32_32x32x16_bf16 v[112:127], v[52:55], v[244:247], v[112:127]
    s_waitcnt lgkmcnt(9)
    ds_write_b128 v234, v[224:227] offset:14336
    ds_read_b128 a[40:43], v24 offset:10240
    ds_read_b128 a[44:47], v24 offset:11264
    ds_read_b128 a[112:115], v24 offset:28672
    ds_read_b128 a[116:119], v24 offset:29696
    ds_read_b128 a[136:139], v24 offset:34816
    s_waitcnt lgkmcnt(13)
    ds_read_b128 a[140:143], v24 offset:35840
    ds_read_b128 a[160:163], v24 offset:40960
    v_cvt_pk_f16_f32 v228, v147, v151
    v_cvt_pk_f16_f32 v229, v155, v159
    v_cvt_pk_f16_f32 v230, v163, v167
    v_cvt_pk_f16_f32 v231, v171, v175
    v_mfma_f32_32x32x16_bf16 v[128:143], v[60:63], v[244:247], v[128:143]
    s_waitcnt vmcnt(8)
    s_waitcnt lgkmcnt(9)
    ds_write_b128 v234, v[228:231] offset:15360
    ds_read_b128 a[164:167], v24 offset:41984
    ds_read_b128 a[184:187], v24 offset:47104
    ds_read_b128 a[188:191], v24 offset:48128
    ds_read_b128 a[64:67], v24 offset:16384
    ds_read_b128 a[68:71], v24 offset:17408
    s_waitcnt lgkmcnt(13)
    ds_read_b128 a[88:91], v24 offset:22528
    ds_read_b128 a[92:95], v24 offset:23552
    v_add_u32 v234, v234, v238
    v_cvt_pk_f16_f32 v224, v80, v84
    v_cvt_pk_f16_f32 v225, v88, v92
    v_cvt_pk_f16_f32 v226, v96, v100
    v_cvt_pk_f16_f32 v227, v104, v108
    v_mfma_f32_32x32x16_bf16 v[144:159], v[64:67], v[240:243], v[208:223]
    s_waitcnt lgkmcnt(0)
    s_barrier
    ds_write_b128 v234, v[224:227] offset:0
    v_cvt_pk_f16_f32 v228, v81, v85
    v_cvt_pk_f16_f32 v229, v89, v93
    v_cvt_pk_f16_f32 v230, v97, v101
    v_cvt_pk_f16_f32 v231, v105, v109
    v_mfma_f32_32x32x16_bf16 v[160:175], v[72:75], v[240:243], v[208:223]
    ds_write_b128 v234, v[228:231] offset:1024
    v_cvt_pk_f16_f32 v224, v82, v86
    v_cvt_pk_f16_f32 v225, v90, v94
    v_cvt_pk_f16_f32 v226, v98, v102
    v_cvt_pk_f16_f32 v227, v106, v110
    v_mfma_f32_32x32x16_bf16 v[144:159], v[68:71], v[244:247], v[144:159]
    ds_write_b128 v234, v[224:227] offset:12288
    v_cvt_pk_f16_f32 v228, v83, v87
    v_cvt_pk_f16_f32 v229, v91, v95
    v_cvt_pk_f16_f32 v230, v99, v103
    v_cvt_pk_f16_f32 v231, v107, v111
    v_mfma_f32_32x32x16_bf16 v[160:175], v[76:79], v[244:247], v[160:175]
    ds_write_b128 v234, v[228:231] offset:13312
    v_mfma_f32_32x32x16_bf16 v[160:175], a[240:243], v[244:247], v[160:175]
    v_cvt_pk_f16_f32 v224, v112, v116
    v_cvt_pk_f16_f32 v225, v120, v124
    v_cvt_pk_f16_f32 v226, v128, v132
    v_cvt_pk_f16_f32 v227, v136, v140
    ds_write_b128 v234, v[224:227] offset:2048
    v_cvt_pk_f16_f32 v228, v113, v117
    v_cvt_pk_f16_f32 v229, v121, v125
    v_cvt_pk_f16_f32 v230, v129, v133
    v_cvt_pk_f16_f32 v231, v137, v141
    ds_write_b128 v234, v[228:231] offset:3072
    v_cvt_pk_f16_f32 v224, v114, v118
    v_cvt_pk_f16_f32 v225, v122, v126
    v_cvt_pk_f16_f32 v226, v130, v134
    v_cvt_pk_f16_f32 v227, v138, v142
    ds_write_b128 v234, v[224:227] offset:14336
    v_cvt_pk_f16_f32 v228, v115, v119
    v_cvt_pk_f16_f32 v229, v123, v127
    v_cvt_pk_f16_f32 v230, v131, v135
    v_cvt_pk_f16_f32 v231, v139, v143
    ds_write_b128 v234, v[228:231] offset:15360
    v_cvt_pk_f16_f32 v224, v144, v148
    v_cvt_pk_f16_f32 v225, v152, v156
    v_cvt_pk_f16_f32 v226, v160, v164
    v_cvt_pk_f16_f32 v227, v168, v172
    ds_write_b128 v234, v[224:227] offset:4096
    v_cvt_pk_f16_f32 v228, v145, v149
    v_cvt_pk_f16_f32 v229, v153, v157
    v_cvt_pk_f16_f32 v230, v161, v165
    v_cvt_pk_f16_f32 v231, v169, v173
    ds_write_b128 v234, v[228:231] offset:5120
    v_cvt_pk_f16_f32 v224, v146, v150
    v_cvt_pk_f16_f32 v225, v154, v158
    v_cvt_pk_f16_f32 v226, v162, v166
    v_cvt_pk_f16_f32 v227, v170, v174
    ds_write_b128 v234, v[224:227] offset:16384
    v_cvt_pk_f16_f32 v228, v147, v151
    v_cvt_pk_f16_f32 v229, v155, v159
    v_cvt_pk_f16_f32 v230, v163, v167
    v_cvt_pk_f16_f32 v231, v171, v175
    ds_write_b128 v234, v[228:231] offset:17408
L_conv0:
    s_getpc_b64 s[94:95]
L_pd:
    s_lshl_b32 s60, s3, 10
    s_add_u32 s60, s60, L_final-L_pd
    s_add_u32 s94, s94, s60
    s_addc_u32 s95, s95, 0
    s_waitcnt lgkmcnt(9)
    ds_read_b128 v[192:195], v22 offset:0
    ds_read_b128 a[232:235], v8 offset:0
    ds_read_b128 a[244:247], v8 offset:2560
    s_waitcnt lgkmcnt(9)
    ds_read_b128 v[200:203], v22 offset:16
    ds_read_b128 a[236:239], v12 offset:0
    ds_read_b128 a[248:251], v12 offset:2560
    ds_read_b128 a[240:243], v15 offset:1280
    ds_read_b128 a[252:255], v15 offset:3840
    ds_read_b128 v[196:199], v22 offset:256
    s_waitcnt lgkmcnt(11)
    ds_read_b128 v[204:207], v22 offset:272
    ds_read_b128 v[176:179], v9 offset:0
    ds_read_b128 v[188:191], v9 offset:2560
    ds_read_b128 v[180:183], v13 offset:0
    s_waitcnt lgkmcnt(11)
    v_mfma_f32_16x16x32_bf16 v[128:131], v[192:195], a[232:235], 0
    ds_read_b128 v[232:235], v13 offset:2560
    ds_read_b128 v[184:187], v14 offset:1280
    ds_read_b128 v[236:239], v14 offset:3840
    s_waitcnt lgkmcnt(13)
    v_mfma_f32_16x16x32_bf16 v[152:155], v[192:195], a[244:247], 0
    s_waitcnt lgkmcnt(12)
    ds_read_b128 a[232:235], v10 offset:0
    ds_read_b128 a[244:247], v10 offset:2560
    s_waitcnt lgkmcnt(11)
    v_smfmac_f32_16x16x64_bf16 v[128:131], v[200:203], a[236:243], v16
    ds_read_b128 v[192:195], v22 offset:512
    ds_read_b128 v[56:59], v20 offset:2560
    ds_read_b128 a[236:239], v14 offset:0
    s_waitcnt lgkmcnt(13)
    v_smfmac_f32_16x16x64_bf16 v[152:155], v[200:203], a[248:255], v16
    s_waitcnt lgkmcnt(12)
    ds_read_b128 a[240:243], v13 offset:1280
    ds_read_b128 a[248:251], v14 offset:2560
    v_cvt_pkrtz_f16_f32 v128, v128, v129
    s_waitcnt lgkmcnt(12)
    v_mfma_f32_16x16x32_bf16 v[224:227], v[196:199], v[176:179], 0
    ds_read_b128 a[252:255], v13 offset:3840
    v_cvt_pkrtz_f16_f32 v129, v130, v131
    v_cvt_pkrtz_f16_f32 v152, v152, v153
    v_cvt_pkrtz_f16_f32 v153, v154, v155
    s_waitcnt lgkmcnt(12)
    v_mfma_f32_16x16x32_bf16 v[228:231], v[196:199], v[188:191], 0
    s_waitcnt lgkmcnt(11)
    ds_read_b128 v[200:203], v22 offset:528
    ds_read_b128 v[176:179], v11 offset:0
    ds_read_b128 v[188:191], v11 offset:2560
    v_dot2_f32_f16 v28, v128, v128, 0
    v_dot2_f32_f16 v30, v152, v152, 0
    v_dot2_f32_f16 v28, v129, v129, v28
    s_waitcnt lgkmcnt(12)
    v_smfmac_f32_16x16x64_bf16 v[224:227], v[204:207], v[180:187], v16
    s_waitcnt lgkmcnt(10)
    ds_read_b128 v[196:199], v22 offset:768
    v_smfmac_f32_16x16x64_bf16 v[228:231], v[204:207], v[232:239], v16
    s_add_u32 m0, s56, -128
    ds_read_b128 v[180:183], v15 offset:0
    ds_read_b128 v[184:187], v12 offset:1280
    v_dot2_f32_f16 v30, v153, v153, v30
    ds_read_b128 v[60:63], v21 offset:2560
    s_waitcnt lgkmcnt(12)
    v_mfma_f32_16x16x32_bf16 v[132:135], v[192:195], a[232:235], 0
    ds_read_b128 v[232:235], v15 offset:2560
    v_cvt_pkrtz_f16_f32 v130, v224, v225
    v_cvt_pkrtz_f16_f32 v154, v228, v229
    v_cvt_pkrtz_f16_f32 v131, v226, v227
    v_mfma_f32_16x16x32_bf16 v[156:159], v[192:195], a[244:247], 0
    s_waitcnt lgkmcnt(11)
    ds_read_b128 v[236:239], v12 offset:3840
    ds_read_b128 v[204:207], v22 offset:784
    v_cvt_pkrtz_f16_f32 v155, v230, v231
    ds_read_b128 v[52:55], v21 offset:0
    v_dot2_f32_f16 v28, v130, v130, v28
    v_dot2_f32_f16 v30, v154, v154, v30
    v_dot2_f32_f16 v28, v131, v131, v28
    v_dot2_f32_f16 v30, v155, v155, v30
    s_waitcnt lgkmcnt(10)
    v_smfmac_f32_16x16x64_bf16 v[132:135], v[200:203], a[236:243], v16
    ds_read_b128 v[48:51], v20 offset:0
    ds_read_b128 v[32:35], v25 offset:0
    s_waitcnt vmcnt(1)
    ds_read_b128 a[232:235], v8 offset:6400
    v_smfmac_f32_16x16x64_bf16 v[156:159], v[200:203], a[248:255], v16
    s_waitcnt lgkmcnt(12)
    ds_read_b128 a[244:247], v8 offset:8960
    ds_read_b128 v[192:195], v22 offset:1024
    v_mfma_f32_16x16x32_f16 v[248:251], a[228:231], v[128:131], 0
    v_cvt_pkrtz_f16_f32 v132, v132, v133
    v_cvt_pkrtz_f16_f32 v133, v134, v135
    s_waitcnt vmcnt(0)
    v_mfma_f32_16x16x32_f16 v[252:255], a[228:231], v[152:155], 0
    s_waitcnt lgkmcnt(12)
    ds_read_b128 a[236:239], v12 offset:6400
    ds_read_b128 a[240:243], v15 offset:7680
    v_cvt_pkrtz_f16_f32 v156, v156, v157
    v_cvt_pkrtz_f16_f32 v157, v158, v159
    v_mfma_f32_16x16x32_bf16 v[224:227], v[196:199], v[176:179], 0
    s_waitcnt lgkmcnt(13)
    ds_read_b128 a[248:251], v12 offset:8960
    v_mfma_f32_16x16x32_bf16 v[228:231], v[196:199], v[188:191], 0
    s_waitcnt lgkmcnt(12)
    ds_read_b128 a[252:255], v15 offset:10240
    ds_read_b128 v[200:203], v22 offset:1040
    v_dot2_f32_f16 v28, v132, v132, v28
    v_dot2_f32_f16 v30, v156, v156, v30
    v_dot2_f32_f16 v28, v133, v133, v28
    v_dot2_f32_f16 v30, v157, v157, v30
    s_waitcnt lgkmcnt(11)
    v_smfmac_f32_16x16x64_bf16 v[224:227], v[204:207], v[180:187], v16
    ds_read_b128 v[176:179], v9 offset:6400
    ds_read_b128 v[188:191], v9 offset:8960
    ds_read_b128 v[196:199], v22 offset:1280
    v_smfmac_f32_16x16x64_bf16 v[228:231], v[204:207], v[232:239], v16
    s_waitcnt lgkmcnt(12)
    buffer_load_dwordx4 v1, s[20:23], 0 offen offset:128 lds
    ds_read_b128 v[180:183], v13 offset:6400
    ds_read_b128 v[184:187], v14 offset:7680
    s_waitcnt lgkmcnt(13)
    v_mfma_f32_16x16x16_bf16 v[80:83], v[18:19], v[56:57], v[32:35]
    s_add_u32 m0, s56, 896
    v_cvt_pkrtz_f16_f32 v134, v224, v225
    v_cvt_pkrtz_f16_f32 v135, v226, v227
    v_cvt_pkrtz_f16_f32 v158, v228, v229
    v_cvt_pkrtz_f16_f32 v159, v230, v231
    v_dot2_f32_f16 v28, v134, v134, v28
    v_dot2_f32_f16 v30, v158, v158, v30
    v_dot2_f32_f16 v28, v135, v135, v28
    s_waitcnt lgkmcnt(10)
    v_mfma_f32_16x16x32_bf16 v[136:139], v[192:195], a[232:235], 0
    s_waitcnt lgkmcnt(9)
    buffer_load_dwordx4 v2, s[20:23], 0 offen offset:128 lds
    ds_read_b128 v[36:39], v25 offset:16
    ds_read_b128 v[232:235], v13 offset:8960
    s_add_u32 m0, s56, 1920
    ds_read_b128 v[236:239], v14 offset:10240
    buffer_load_dwordx4 v3, s[20:23], 0 offen offset:128 lds
    s_add_u32 m0, s56, 2944
    ds_read_b128 v[204:207], v22 offset:1296
    buffer_load_dwordx4 v4, s[20:23], 0 offen offset:128 lds
    s_add_u32 m0, s56, 3968
    ds_read_b128 a[232:235], v10 offset:6400
    buffer_load_dwordx4 v5, s[20:23], 0 offen offset:128 lds
    s_add_u32 m0, s56, 4992
    s_nop 0
    buffer_load_dwordx4 v6, s[20:23], 0 offen offset:128 lds
    s_add_u32 m0, s56, 6016
    s_nop 0
    buffer_load_dword v7, s[20:23], 0 offen offset:128 lds
    s_waitcnt lgkmcnt(4)
    v_mfma_f32_16x16x16_bf16 v[84:87], v[18:19], v[58:59], v[36:39]
    v_mfma_f32_16x16x16_bf16 v[88:91], v[18:19], v[60:61], v[32:35]
    v_mfma_f32_16x16x32_bf16 v[160:163], v[192:195], a[244:247], 0
    ds_read_b128 a[244:247], v10 offset:8960
    ds_read_b128 v[192:195], v22 offset:1536
    v_mfma_f32_16x16x16_bf16 v[92:95], v[18:19], v[62:63], v[36:39]
    v_smfmac_f32_16x16x64_bf16 v[136:139], v[200:203], a[236:243], v16
    ds_read_b128 a[236:239], v14 offset:6400
    ds_read_b128 a[240:243], v13 offset:7680
    ds_read_b128 v[216:219], v20 offset:8960
    v_smfmac_f32_16x16x64_bf16 v[160:163], v[200:203], a[248:255], v16
    ds_read_b128 a[248:251], v14 offset:8960
    ds_read_b128 a[252:255], v13 offset:10240
    ds_read_b128 v[200:203], v22 offset:1552
    v_mfma_f32_16x16x16_bf16 v[40:43], v[18:19], v[52:53], v[32:35]
    v_cvt_pkrtz_f16_f32 v136, v136, v137
    v_cvt_pkrtz_f16_f32 v137, v138, v139
    v_mfma_f32_16x16x16_bf16 v[44:47], v[18:19], v[54:55], v[36:39]
    s_nop 0
    v_cvt_pkrtz_f16_f32 v160, v160, v161
    v_cvt_pkrtz_f16_f32 v161, v162, v163
    v_mfma_f32_16x16x32_f16 v[248:251], a[228:231], v[132:135], v[248:251]
    v_permlane16_swap_b32 v128, v132
    v_permlane16_swap_b32 v129, v133
    v_mfma_f32_16x16x32_f16 v[252:255], a[228:231], v[156:159], v[252:255]
    v_permlane16_swap_b32 v152, v156
    v_permlane16_swap_b32 v153, v157
    v_permlane16_swap_b32 v130, v134
    v_dot2_f32_f16 v30, v159, v159, v30
    v_permlane16_swap_b32 v154, v158
    v_permlane16_swap_b32 v131, v135
    v_permlane16_swap_b32 v155, v159
    v_mfma_f32_16x16x32_bf16 v[224:227], v[196:199], v[176:179], 0
    ds_read_b128 v[176:179], v11 offset:6400
    v_mfma_f32_16x16x32_bf16 v[228:231], v[196:199], v[188:191], 0
    s_waitcnt lgkmcnt(10)
    ds_read_b128 v[188:191], v11 offset:8960
    ds_read_b128 v[196:199], v22 offset:1792
    s_nop 0
    v_smfmac_f32_16x16x64_bf16 v[224:227], v[204:207], v[180:187], v16
    ds_read_b128 v[180:183], v15 offset:6400
    ds_read_b128 v[184:187], v12 offset:7680
    v_mfma_f32_16x16x16_bf16 v[32:35], v[18:19], v[48:49], v[32:35]
    s_waitcnt lgkmcnt(13)
    ds_read_b128 v[220:223], v21 offset:8960
    v_smfmac_f32_16x16x64_bf16 v[228:231], v[204:207], v[232:239], v16
    s_waitcnt lgkmcnt(11)
    ds_read_b128 v[232:235], v15 offset:8960
    ds_read_b128 v[236:239], v12 offset:10240
    ds_read_b128 v[204:207], v22 offset:1808
    v_cvt_pkrtz_f16_f32 v138, v224, v225
    v_mfma_f32_16x16x32_bf16 v[140:143], v[192:195], a[232:235], 0
    s_waitcnt lgkmcnt(13)
    ds_read_b128 v[212:215], v21 offset:6400
    v_cvt_pkrtz_f16_f32 v139, v226, v227
    v_mfma_f32_16x16x32_bf16 v[164:167], v[192:195], a[244:247], 0
    s_waitcnt lgkmcnt(10)
    ds_read_b128 v[192:195], v22 offset:2048
    v_cvt_pkrtz_f16_f32 v162, v228, v229
    v_cvt_pkrtz_f16_f32 v163, v230, v231
    v_smfmac_f32_16x16x64_bf16 v[140:143], v[200:203], a[236:243], v16
    v_mfma_f32_16x16x16_bf16 v[36:39], v[18:19], v[50:51], v[36:39]
    v_smfmac_f32_16x16x64_bf16 v[164:167], v[200:203], a[248:255], v16
    ds_read_b128 v[200:203], v22 offset:2064
    v_mfma_f32_16x16x32_f16 v[248:251], a[228:231], v[136:139], v[248:251]
    v_mfma_f32_16x16x32_f16 v[252:255], a[228:231], v[160:163], v[252:255]
    s_waitcnt lgkmcnt(9)
    s_nop 1
    v_cvt_pkrtz_f16_f32 v140, v140, v141
    v_cvt_pkrtz_f16_f32 v141, v142, v143
    v_mfma_f32_16x16x32_bf16 v[224:227], v[196:199], v[176:179], 0
    ds_read_b128 v[208:211], v20 offset:6400
    v_cvt_pkrtz_f16_f32 v164, v164, v165
    v_cvt_pkrtz_f16_f32 v165, v166, v167
    v_mfma_f32_16x16x32_bf16 v[228:231], v[196:199], v[188:191], 0
    s_waitcnt lgkmcnt(4)
    ds_read_b128 v[196:199], v22 offset:2304
    v_smfmac_f32_16x16x64_bf16 v[224:227], v[204:207], v[180:187], v16
    s_nop 2
    v_smfmac_f32_16x16x64_bf16 v[228:231], v[204:207], v[232:239], v16
    s_waitcnt lgkmcnt(1)
    ds_read_b128 v[204:207], v22 offset:2320
    s_nop 1
    v_cvt_pkrtz_f16_f32 v142, v224, v225
    v_cvt_pkrtz_f16_f32 v143, v226, v227
    v_dot2_f32_f16 v28, v136, v136, v28
    v_dot2_f32_f16 v30, v160, v160, v30
    v_cvt_pkrtz_f16_f32 v166, v228, v229
    v_cvt_pkrtz_f16_f32 v167, v230, v231
    v_dot2_f32_f16 v28, v137, v137, v28
    v_dot2_f32_f16 v30, v161, v161, v30
    v_dot2_f32_f16 v28, v138, v138, v28
    v_dot2_f32_f16 v30, v162, v162, v30
    v_dot2_f32_f16 v28, v139, v139, v28
    v_dot2_f32_f16 v30, v163, v163, v30
    v_dot2_f32_f16 v28, v140, v140, v28
    v_dot2_f32_f16 v30, v164, v164, v30
    v_dot2_f32_f16 v28, v141, v141, v28
    v_dot2_f32_f16 v30, v165, v165, v30
    v_dot2_f32_f16 v28, v142, v142, v28
    v_dot2_f32_f16 v30, v166, v166, v30
    v_dot2_f32_f16 v28, v143, v143, v28
    v_dot2_f32_f16 v30, v167, v167, v30
    s_waitcnt vmcnt(0)
    ds_read_b128 a[232:235], v8 offset:0
    ds_read_b128 a[244:247], v8 offset:2560
    ds_read_b128 a[236:239], v12 offset:0
    ds_read_b128 a[240:243], v15 offset:1280
    ds_read_b128 a[248:251], v12 offset:2560
    ds_read_b128 a[252:255], v15 offset:3840
    ds_read_b128 v[176:179], v9 offset:0
    ds_read_b128 v[188:191], v9 offset:2560
    ds_read_b128 v[180:183], v13 offset:0
    ds_read_b128 v[184:187], v14 offset:1280
    ds_read_b128 v[232:235], v13 offset:2560
    ds_read_b128 v[236:239], v14 offset:3840
    s_waitcnt lgkmcnt(11)
    v_mfma_f32_16x16x32_bf16 v[144:147], v[192:195], a[232:235], 0
    s_waitcnt lgkmcnt(10)
    ds_read_b128 a[232:235], v10 offset:0
    v_mfma_f32_16x16x32_bf16 v[168:171], v[192:195], a[244:247], 0
    s_waitcnt lgkmcnt(10)
    ds_read_b128 a[244:247], v10 offset:2560
    ds_read_b128 v[192:195], v22 offset:2560
    s_waitcnt lgkmcnt(11)
    v_smfmac_f32_16x16x64_bf16 v[144:147], v[200:203], a[236:243], v16
    ds_read_b128 a[236:239], v14 offset:0
    ds_read_b128 a[240:243], v13 offset:1280
    s_waitcnt lgkmcnt(11)
    v_smfmac_f32_16x16x64_bf16 v[168:171], v[200:203], a[248:255], v16
    ds_read_b128 a[248:251], v14 offset:2560
    ds_read_b128 a[252:255], v13 offset:3840
    ds_read_b128 v[200:203], v22 offset:2576
    v_mfma_f32_16x16x32_f16 v[248:251], a[228:231], v[140:143], v[248:251]
    v_cvt_pkrtz_f16_f32 v144, v144, v145
    v_cvt_pkrtz_f16_f32 v145, v146, v147
    v_permlane16_swap_b32 v136, v140
    v_mfma_f32_16x16x32_f16 v[252:255], a[228:231], v[164:167], v[252:255]
    s_waitcnt lgkmcnt(13)
    ds_read_b128 v[48:51], v25 offset:128
    v_cvt_pkrtz_f16_f32 v168, v168, v169
    v_cvt_pkrtz_f16_f32 v169, v170, v171
    v_permlane16_swap_b32 v160, v164
    v_mfma_f32_16x16x32_bf16 v[224:227], v[196:199], v[176:179], 0
    s_waitcnt lgkmcnt(13)
    ds_read_b128 v[176:179], v11 offset:0
    v_permlane16_swap_b32 v137, v141
    v_permlane16_swap_b32 v161, v165
    v_mfma_f32_16x16x32_bf16 v[228:231], v[196:199], v[188:191], 0
    s_waitcnt lgkmcnt(12)
    ds_read_b128 v[188:191], v11 offset:2560
    ds_read_b128 v[196:199], v22 offset:2816
    v_permlane16_swap_b32 v138, v142
    v_smfmac_f32_16x16x64_bf16 v[224:227], v[204:207], v[180:187], v16
    s_waitcnt lgkmcnt(11)
    ds_read_b128 v[180:183], v15 offset:0
    ds_read_b128 v[184:187], v12 offset:1280
    ds_read_b128 v[52:55], v25 offset:144
    v_permlane16_swap_b32 v162, v166
    v_smfmac_f32_16x16x64_bf16 v[228:231], v[204:207], v[232:239], v16
    s_waitcnt lgkmcnt(12)
    ds_read_b128 v[232:235], v15 offset:2560
    ds_read_b128 v[236:239], v12 offset:3840
    v_permlane16_swap_b32 v139, v143
    v_mfma_f32_16x16x32_bf16 v[148:151], v[192:195], a[232:235], 0
    s_waitcnt lgkmcnt(13)
    ds_read_b128 v[204:207], v22 offset:2832
    v_cvt_pkrtz_f16_f32 v146, v224, v225
    v_cvt_pkrtz_f16_f32 v147, v226, v227
    v_permlane16_swap_b32 v163, v167
    v_mfma_f32_16x16x32_bf16 v[172:175], v[192:195], a[244:247], 0
    s_waitcnt lgkmcnt(13)
    v_cvt_pkrtz_f16_f32 v170, v228, v229
    v_cvt_pkrtz_f16_f32 v171, v230, v231
    s_waitcnt lgkmcnt(10)
    v_smfmac_f32_16x16x64_bf16 v[148:151], v[200:203], a[236:243], v16
    s_nop 0
    v_smfmac_f32_16x16x64_bf16 v[172:175], v[200:203], a[248:255], v16
    ds_read_b128 a[232:235], v23 offset:2048
    ds_read_b128 a[236:239], v23 offset:3072
    ds_read_b128 a[240:243], v23 offset:4096
    v_mfma_f32_16x16x32_f16 v[248:251], a[228:231], v[144:147], v[248:251]
    s_waitcnt lgkmcnt(11)
    ds_read_b128 a[244:247], v23 offset:5120
    ds_read_b128 a[248:251], v23 offset:12288
    ds_read_b128 a[252:255], v23 offset:13312
    v_cvt_pkrtz_f16_f32 v148, v148, v149
    v_mfma_f32_16x16x32_f16 v[252:255], a[228:231], v[168:171], v[252:255]
    s_waitcnt lgkmcnt(12)
    v_cvt_pkrtz_f16_f32 v172, v172, v173
    v_cvt_pkrtz_f16_f32 v149, v150, v151
    v_cvt_pkrtz_f16_f32 v173, v174, v175
    v_mfma_f32_16x16x32_bf16 v[224:227], v[196:199], v[176:179], 0
    v_mfma_f32_16x16x32_bf16 v[228:231], v[196:199], v[188:191], 0
    s_waitcnt lgkmcnt(10)
    ds_read_b128 v[64:67], v25 offset:256
    v_dot2_f32_f16 v28, v144, v144, v28
    v_dot2_f32_f16 v30, v168, v168, v30
    v_dot2_f32_f16 v28, v145, v145, v28
    v_dot2_f32_f16 v30, v169, v169, v30
    v_dot2_f32_f16 v28, v146, v146, v28
    v_dot2_f32_f16 v30, v170, v170, v30
    v_dot2_f32_f16 v28, v147, v147, v28
    v_dot2_f32_f16 v30, v171, v171, v30
    v_dot2_f32_f16 v28, v148, v148, v28
    s_waitcnt lgkmcnt(7)
    v_smfmac_f32_16x16x64_bf16 v[224:227], v[204:207], v[180:187], v16
    v_smfmac_f32_16x16x64_bf16 v[228:231], v[204:207], v[232:239], v16
    ds_read_b128 v[68:71], v25 offset:272
    v_dot2_f32_f16 v30, v172, v172, v30
    v_dot2_f32_f16 v28, v149, v149, v28
    v_dot2_f32_f16 v30, v173, v173, v30
    s_waitcnt lgkmcnt(0)
    s_barrier
    s_branch L_mid
L_final:
    v_mfma_f32_16x16x32_bf16 v[88:91], a[168:171], v[244:247], v[88:91]
    v_cvt_pk_bf16_f32 v80, v80, v81
    v_cvt_pk_bf16_f32 v81, v82, v83
    v_cvt_pk_bf16_f32 v82, v84, v85
    v_mfma_f32_16x16x32_bf16 v[92:95], a[172:175], v[244:247], v[92:95]
    v_cvt_pk_bf16_f32 v83, v86, v87
    v_cvt_pk_bf16_f32 v96, v96, v97
    v_cvt_pk_bf16_f32 v97, v98, v99
    v_mfma_f32_16x16x32_bf16 v[104:107], a[176:179], v[244:247], v[104:107]
    buffer_store_dwordx4 v[80:83], v26, s[24:27], s82 offen offset:0 sc0 sc1
    v_mfma_f32_16x16x32_bf16 v[108:111], a[180:183], v[244:247], v[108:111]
    v_cvt_pk_bf16_f32 v98, v100, v101
    v_cvt_pk_bf16_f32 v99, v102, v103
    v_cvt_pk_bf16_f32 v112, v112, v113
    v_mfma_f32_16x16x32_bf16 v[120:123], a[184:187], v[244:247], v[120:123]
    buffer_store_dwordx4 v[96:99], v26, s[24:27], s82 offen offset:64 sc0 sc1
    v_mfma_f32_16x16x32_bf16 v[124:127], a[188:191], v[244:247], v[124:127]
    v_cvt_pk_bf16_f32 v113, v114, v115
    v_cvt_pk_bf16_f32 v114, v116, v117
    v_cvt_pk_bf16_f32 v115, v118, v119
    v_cvt_pk_bf16_f32 v88, v88, v89
    v_cvt_pk_bf16_f32 v89, v90, v91
    v_cvt_pk_bf16_f32 v90, v92, v93
    v_cvt_pk_bf16_f32 v91, v94, v95
    v_cvt_pk_bf16_f32 v104, v104, v105
    v_cvt_pk_bf16_f32 v105, v106, v107
    v_cvt_pk_bf16_f32 v106, v108, v109
    v_cvt_pk_bf16_f32 v107, v110, v111
    v_cvt_pk_bf16_f32 v120, v120, v121
    v_cvt_pk_bf16_f32 v121, v122, v123
    v_cvt_pk_bf16_f32 v122, v124, v125
    v_cvt_pk_bf16_f32 v123, v126, v127
    buffer_store_dwordx4 v[112:115], v26, s[24:27], s82 offen offset:128 sc0 sc1
    buffer_store_dwordx4 v[88:91], v26, s[24:27], s83 offen offset:0 sc0 sc1
    buffer_store_dwordx4 v[104:107], v26, s[24:27], s83 offen offset:64 sc0 sc1
    buffer_store_dwordx4 v[120:123], v26, s[24:27], s83 offen offset:128 sc0 sc1
L_end:
    s_endpgm
L_conv:
    v_mfma_f32_16x16x32_bf16 v[128:131], v[192:195], a[232:235], 0
    ds_read_b128 a[232:235], v8 offset:6400
    v_cvt_pk_bf16_f32 v80, v80, v81
    v_cvt_pk_bf16_f32 v81, v82, v83
    v_mfma_f32_16x16x32_bf16 v[152:155], v[192:195], a[244:247], 0
    ds_read_b128 a[244:247], v8 offset:8960
    ds_read_b128 v[192:195], v22 offset:512
    v_cvt_pk_bf16_f32 v82, v84, v85
    v_mfma_f32_16x16x32_bf16 v[88:91], a[168:171], v[244:247], v[88:91]
    v_cvt_pk_bf16_f32 v83, v86, v87
    v_cvt_pk_bf16_f32 v96, v96, v97
    v_cvt_pk_bf16_f32 v97, v98, v99
    v_mfma_f32_16x16x32_bf16 v[92:95], a[172:175], v[244:247], v[92:95]
    s_waitcnt lgkmcnt(3)
    v_cvt_pk_bf16_f32 v98, v100, v101
    v_cvt_pk_bf16_f32 v99, v102, v103
    v_cvt_pk_bf16_f32 v112, v112, v113
    v_smfmac_f32_16x16x64_bf16 v[128:131], v[200:203], a[236:243], v16
    ds_read_b128 a[236:239], v12 offset:6400
    ds_read_b128 a[240:243], v15 offset:7680
    v_cvt_pk_bf16_f32 v88, v88, v89
    v_smfmac_f32_16x16x64_bf16 v[152:155], v[200:203], a[248:255], v16
    ds_read_b128 a[248:251], v12 offset:8960
    ds_read_b128 a[252:255], v15 offset:10240
    ds_read_b128 v[200:203], v22 offset:528
    v_mfma_f32_16x16x32_bf16 v[224:227], v[196:199], v[176:179], 0
    ds_read_b128 v[176:179], v9 offset:6400
    v_cvt_pkrtz_f16_f32 v128, v128, v129
    v_cvt_pkrtz_f16_f32 v129, v130, v131
    v_mfma_f32_16x16x32_bf16 v[228:231], v[196:199], v[188:191], 0
    ds_read_b128 v[188:191], v9 offset:8960
    ds_read_b128 v[196:199], v22 offset:768
    v_cvt_pkrtz_f16_f32 v152, v152, v153
    v_smfmac_f32_16x16x64_bf16 v[224:227], v[204:207], v[180:187], v16
    ds_read_b128 v[180:183], v13 offset:6400
    ds_read_b128 v[184:187], v14 offset:7680
    v_cvt_pkrtz_f16_f32 v153, v154, v155
    v_smfmac_f32_16x16x64_bf16 v[228:231], v[204:207], v[232:239], v16
    s_waitcnt lgkmcnt(10)
    ds_read_b128 v[232:235], v13 offset:8960
    ds_read_b128 v[236:239], v14 offset:10240
    ds_read_b128 v[204:207], v22 offset:784
    v_mfma_f32_16x16x32_bf16 v[132:135], v[192:195], v[32:35], 0
    v_cvt_pkrtz_f16_f32 v130, v224, v225
    v_cvt_pkrtz_f16_f32 v131, v226, v227
    v_cvt_pk_bf16_f32 v89, v90, v91
    v_mfma_f32_16x16x32_bf16 v[104:107], a[176:179], v[244:247], v[104:107]
    v_cvt_pkrtz_f16_f32 v154, v228, v229
    v_cvt_pkrtz_f16_f32 v155, v230, v231
    v_cvt_pk_bf16_f32 v90, v92, v93
    v_mfma_f32_16x16x32_bf16 v[156:159], v[192:195], v[44:47], 0
    ds_read_b128 v[192:195], v22 offset:1024
    v_cvt_pk_bf16_f32 v91, v94, v95
    v_cvt_pk_bf16_f32 v113, v114, v115
    v_mfma_f32_16x16x32_bf16 v[108:111], a[180:183], v[244:247], v[108:111]
    s_waitcnt lgkmcnt(9)
    ds_read_b128 v[32:35], v25 offset:0
    v_cvt_pk_bf16_f32 v104, v104, v105
    v_cvt_pk_bf16_f32 v105, v106, v107
    v_smfmac_f32_16x16x64_bf16 v[132:135], v[200:203], v[36:43], v16
    v_cvt_pk_bf16_f32 v114, v116, v117
    v_cvt_pk_bf16_f32 v115, v118, v119
    v_smfmac_f32_16x16x64_bf16 v[156:159], v[200:203], v[64:71], v16
    ds_read_b128 v[200:203], v22 offset:1040
    ds_read_b128 v[36:39], v25 offset:16
    v_cvt_pk_bf16_f32 v106, v108, v109
    v_mfma_f32_16x16x32_f16 v[248:251], a[228:231], v[128:131], 0
    s_nop 0
    v_cvt_pkrtz_f16_f32 v132, v132, v133
    v_cvt_pkrtz_f16_f32 v133, v134, v135
    v_cvt_pk_bf16_f32 v107, v110, v111
    s_waitcnt vmcnt(13)
    v_mfma_f32_16x16x32_f16 v[252:255], a[228:231], v[152:155], 0
    s_waitcnt lgkmcnt(9)
    v_cvt_pkrtz_f16_f32 v156, v156, v157
    v_cvt_pkrtz_f16_f32 v157, v158, v159
    v_dot2_f32_f16 v28, v128, v128, 0
    v_dot2_f32_f16 v30, v152, v152, 0
    v_dot2_f32_f16 v28, v129, v129, v28
    v_dot2_f32_f16 v30, v153, v153, v30
    v_dot2_f32_f16 v28, v130, v130, v28
    v_dot2_f32_f16 v30, v154, v154, v30
    v_dot2_f32_f16 v28, v131, v131, v28
    v_dot2_f32_f16 v30, v155, v155, v30
    v_dot2_f32_f16 v28, v132, v132, v28
    v_dot2_f32_f16 v30, v156, v156, v30
    v_dot2_f32_f16 v28, v133, v133, v28
    v_mfma_f32_16x16x32_bf16 v[224:227], v[196:199], v[136:139], 0
    ds_read_b128 v[216:219], v20 offset:8960
    v_mfma_f32_16x16x32_bf16 v[228:231], v[196:199], v[148:151], 0
    s_waitcnt lgkmcnt(5)
    ds_read_b128 v[196:199], v22 offset:1280
    s_nop 1
    v_smfmac_f32_16x16x64_bf16 v[224:227], v[204:207], v[140:147], v16
    buffer_store_dwordx4 v[80:83], v26, s[24:27], s82 offen offset:0 sc0 sc1
    v_smfmac_f32_16x16x64_bf16 v[228:231], v[204:207], v[72:79], v16
    s_waitcnt lgkmcnt(5)
    ds_read_b128 v[204:207], v22 offset:1296
    v_mfma_f32_16x16x32_bf16 v[136:139], v[192:195], a[232:235], 0
    ds_read_b128 a[232:235], v10 offset:6400
    v_mfma_f32_16x16x32_bf16 v[120:123], a[184:187], v[244:247], v[120:123]
    s_nop 0
    v_cvt_pkrtz_f16_f32 v134, v224, v225
    v_cvt_pkrtz_f16_f32 v135, v226, v227
    v_mfma_f32_16x16x32_bf16 v[160:163], v[192:195], a[244:247], 0
    s_waitcnt lgkmcnt(5)
    ds_read_b128 a[244:247], v10 offset:8960
    ds_read_b128 v[192:195], v22 offset:1536
    v_cvt_pkrtz_f16_f32 v158, v228, v229
    v_smfmac_f32_16x16x64_bf16 v[136:139], v[200:203], a[236:243], v16
    ds_read_b128 a[236:239], v14 offset:6400
    ds_read_b128 a[240:243], v13 offset:7680
    v_cvt_pkrtz_f16_f32 v159, v230, v231
    v_mfma_f32_16x16x32_bf16 v[124:127], a[188:191], v[244:247], v[124:127]
    buffer_store_dwordx4 v[88:91], v26, s[24:27], s83 offen offset:0 sc0 sc1
    v_smfmac_f32_16x16x64_bf16 v[160:163], v[200:203], a[248:255], v16
    ds_read_b128 a[248:251], v14 offset:8960
    ds_read_b128 a[252:255], v13 offset:10240
    ds_read_b128 v[200:203], v22 offset:1552
    v_mfma_f32_16x16x32_f16 v[248:251], a[228:231], v[132:135], v[248:251]
    v_cvt_pkrtz_f16_f32 v136, v136, v137
    v_cvt_pkrtz_f16_f32 v137, v138, v139
    v_cvt_pk_bf16_f32 v120, v120, v121
    v_mfma_f32_16x16x32_f16 v[252:255], a[228:231], v[156:159], v[252:255]
    s_waitcnt lgkmcnt(9)
    v_cvt_pkrtz_f16_f32 v160, v160, v161
    v_cvt_pkrtz_f16_f32 v161, v162, v163
    v_cvt_pk_bf16_f32 v121, v122, v123
    v_mfma_f32_16x16x32_bf16 v[224:227], v[196:199], v[176:179], 0
    ds_read_b128 v[176:179], v11 offset:6400
    v_cvt_pk_bf16_f32 v122, v124, v125
    v_cvt_pk_bf16_f32 v123, v126, v127
    v_mfma_f32_16x16x16_bf16 v[80:83], v[18:19], v[56:57], v[32:35]
    v_permlane16_swap_b32 v128, v132
    v_permlane16_swap_b32 v152, v156
    v_mfma_f32_16x16x16_bf16 v[84:87], v[18:19], v[58:59], v[36:39]
    v_permlane16_swap_b32 v129, v133
    v_mfma_f32_16x16x32_bf16 v[228:231], v[196:199], v[188:191], 0
    ds_read_b128 v[188:191], v11 offset:8960
    ds_read_b128 v[196:199], v22 offset:1792
    v_mfma_f32_16x16x16_bf16 v[88:91], v[18:19], v[60:61], v[32:35]
    s_waitcnt lgkmcnt(11)
    v_smfmac_f32_16x16x64_bf16 v[224:227], v[204:207], v[180:187], v16
    ds_read_b128 v[180:183], v15 offset:6400
    ds_read_b128 v[184:187], v12 offset:7680
    v_smfmac_f32_16x16x64_bf16 v[228:231], v[204:207], v[232:239], v16
    s_waitcnt lgkmcnt(11)
    ds_read_b128 v[232:235], v15 offset:8960
    ds_read_b128 v[236:239], v12 offset:10240
    ds_read_b128 v[204:207], v22 offset:1808
    v_mfma_f32_16x16x16_bf16 v[92:95], v[18:19], v[62:63], v[36:39]
    s_waitcnt lgkmcnt(13)
    v_cvt_pkrtz_f16_f32 v138, v224, v225
    v_cvt_pkrtz_f16_f32 v139, v226, v227
    v_mfma_f32_16x16x32_bf16 v[140:143], v[192:195], a[232:235], 0
    v_cvt_pkrtz_f16_f32 v162, v228, v229
    v_cvt_pkrtz_f16_f32 v163, v230, v231
    v_mfma_f32_16x16x16_bf16 v[40:43], v[18:19], v[52:53], v[32:35]
    s_waitcnt vmcnt(2) lgkmcnt(12)
    ds_read_b128 a[232:235], v8 offset:0
    ds_read_b128 v[220:223], v21 offset:8960
    v_mfma_f32_16x16x32_bf16 v[164:167], v[192:195], a[244:247], 0
    s_waitcnt lgkmcnt(10)
    ds_read_b128 a[244:247], v8 offset:2560
    ds_read_b128 v[192:195], v22 offset:2048
    v_smfmac_f32_16x16x64_bf16 v[140:143], v[200:203], a[236:243], v16
    ds_read_b128 a[236:239], v12 offset:0
    ds_read_b128 a[240:243], v15 offset:1280
    v_smfmac_f32_16x16x64_bf16 v[164:167], v[200:203], a[248:255], v16
    s_waitcnt lgkmcnt(11)
    buffer_store_dwordx4 v[96:99], v26, s[24:27], s82 offen offset:64 sc0 sc1
    ds_read_b128 a[248:251], v12 offset:2560
    ds_read_b128 a[252:255], v15 offset:3840
    ds_read_b128 v[200:203], v22 offset:2064
    v_mfma_f32_16x16x32_f16 v[248:251], a[228:231], v[136:139], v[248:251]
    v_cvt_pkrtz_f16_f32 v140, v140, v141
    v_cvt_pkrtz_f16_f32 v141, v142, v143
    v_mfma_f32_16x16x32_f16 v[252:255], a[228:231], v[160:163], v[252:255]
    v_cvt_pkrtz_f16_f32 v164, v164, v165
    v_cvt_pkrtz_f16_f32 v165, v166, v167
    v_mfma_f32_16x16x32_bf16 v[224:227], v[196:199], v[176:179], 0
    s_waitcnt lgkmcnt(13)
    buffer_store_dwordx4 v[104:107], v26, s[24:27], s83 offen offset:64 sc0 sc1
    ds_read_b128 v[176:179], v9 offset:0
    v_mfma_f32_16x16x16_bf16 v[44:47], v[18:19], v[54:55], v[36:39]
    s_waitcnt lgkmcnt(13)
    ds_read_b128 v[212:215], v21 offset:6400
    v_mfma_f32_16x16x32_bf16 v[228:231], v[196:199], v[188:191], 0
    s_waitcnt lgkmcnt(11)
    ds_read_b128 v[188:191], v9 offset:2560
    ds_read_b128 v[196:199], v22 offset:2304
    v_smfmac_f32_16x16x64_bf16 v[224:227], v[204:207], v[180:187], v16
    s_waitcnt lgkmcnt(12)
    buffer_store_dwordx4 v[112:115], v26, s[24:27], s82 offen offset:128 sc0 sc1
    ds_read_b128 v[180:183], v13 offset:0
    ds_read_b128 v[184:187], v14 offset:1280
    v_smfmac_f32_16x16x64_bf16 v[228:231], v[204:207], v[232:239], v16
    s_waitcnt lgkmcnt(11)
    ds_read_b128 v[232:235], v13 offset:2560
    ds_read_b128 v[236:239], v14 offset:3840
    ds_read_b128 v[204:207], v22 offset:2320
    v_mfma_f32_16x16x16_bf16 v[32:35], v[18:19], v[48:49], v[32:35]
    v_cvt_pkrtz_f16_f32 v142, v224, v225
    v_cvt_pkrtz_f16_f32 v143, v226, v227
    s_nop 0
    v_cvt_pkrtz_f16_f32 v166, v228, v229
    v_dot2_f32_f16 v30, v157, v157, v30
    v_dot2_f32_f16 v28, v134, v134, v28
    v_dot2_f32_f16 v30, v158, v158, v30
    v_dot2_f32_f16 v28, v135, v135, v28
    v_dot2_f32_f16 v30, v159, v159, v30
    v_dot2_f32_f16 v28, v136, v136, v28
    v_dot2_f32_f16 v30, v160, v160, v30
    v_dot2_f32_f16 v28, v137, v137, v28
    v_dot2_f32_f16 v30, v161, v161, v30
    v_dot2_f32_f16 v28, v138, v138, v28
    v_dot2_f32_f16 v30, v162, v162, v30
    v_dot2_f32_f16 v28, v139, v139, v28
    v_dot2_f32_f16 v30, v163, v163, v30
    v_dot2_f32_f16 v28, v140, v140, v28
    v_dot2_f32_f16 v30, v164, v164, v30
    v_dot2_f32_f16 v28, v141, v141, v28
    v_dot2_f32_f16 v30, v165, v165, v30
    v_permlane16_swap_b32 v153, v157
    v_permlane16_swap_b32 v130, v134
    v_permlane16_swap_b32 v154, v158
    v_mfma_f32_16x16x32_bf16 v[144:147], v[192:195], a[232:235], 0
    s_waitcnt lgkmcnt(13)
    ds_read_b128 a[232:235], v10 offset:0
    v_permlane16_swap_b32 v131, v135
    v_mfma_f32_16x16x32_bf16 v[168:171], v[192:195], a[244:247], 0
    s_waitcnt lgkmcnt(10)
    ds_read_b128 a[244:247], v10 offset:2560
    ds_read_b128 v[192:195], v22 offset:2560
    v_permlane16_swap_b32 v155, v159
    v_smfmac_f32_16x16x64_bf16 v[144:147], v[200:203], a[236:243], v16
    ds_read_b128 a[236:239], v14 offset:0
    ds_read_b128 a[240:243], v13 offset:1280
    v_cvt_pkrtz_f16_f32 v167, v230, v231
    v_smfmac_f32_16x16x64_bf16 v[168:171], v[200:203], a[248:255], v16
    s_waitcnt lgkmcnt(11)
    ds_read_b128 a[248:251], v14 offset:2560
    ds_read_b128 a[252:255], v13 offset:3840
    ds_read_b128 v[200:203], v22 offset:2576
    v_mfma_f32_16x16x32_f16 v[248:251], a[228:231], v[140:143], v[248:251]
    v_cvt_pkrtz_f16_f32 v144, v144, v145
    v_cvt_pkrtz_f16_f32 v145, v146, v147
    v_permlane16_swap_b32 v136, v140
    v_mfma_f32_16x16x32_f16 v[252:255], a[228:231], v[164:167], v[252:255]
    s_waitcnt lgkmcnt(13)
    v_cvt_pkrtz_f16_f32 v168, v168, v169
    v_cvt_pkrtz_f16_f32 v169, v170, v171
    v_permlane16_swap_b32 v160, v164
    v_mfma_f32_16x16x32_bf16 v[224:227], v[196:199], v[176:179], 0
    ds_read_b128 v[176:179], v11 offset:0
    v_permlane16_swap_b32 v137, v141
    v_mfma_f32_16x16x32_bf16 v[228:231], v[196:199], v[188:191], 0
    s_waitcnt lgkmcnt(9)
    ds_read_b128 v[188:191], v11 offset:2560
    ds_read_b128 v[196:199], v22 offset:2816
    v_permlane16_swap_b32 v161, v165
    v_smfmac_f32_16x16x64_bf16 v[224:227], v[204:207], v[180:187], v16
    ds_read_b128 v[180:183], v15 offset:0
    ds_read_b128 v[184:187], v12 offset:1280
    v_mfma_f32_16x16x16_bf16 v[36:39], v[18:19], v[50:51], v[36:39]
    s_waitcnt lgkmcnt(12)
    ds_read_b128 v[48:51], v25 offset:128
    ds_read_b128 v[52:55], v25 offset:144
    v_smfmac_f32_16x16x64_bf16 v[228:231], v[204:207], v[232:239], v16
    s_waitcnt lgkmcnt(10)
    ds_read_b128 v[232:235], v15 offset:2560
    ds_read_b128 v[236:239], v12 offset:3840
    ds_read_b128 v[204:207], v22 offset:2832
    ds_read_b128 v[64:67], v25 offset:256
    v_mfma_f32_16x16x32_bf16 v[148:151], v[192:195], a[232:235], 0
    v_cvt_pkrtz_f16_f32 v146, v224, v225
    v_cvt_pkrtz_f16_f32 v147, v226, v227
    v_mfma_f32_16x16x32_bf16 v[172:175], v[192:195], a[244:247], 0
    s_waitcnt lgkmcnt(11)
    ds_read_b128 v[68:71], v25 offset:272
    v_cvt_pkrtz_f16_f32 v170, v228, v229
    v_cvt_pkrtz_f16_f32 v171, v230, v231
    v_smfmac_f32_16x16x64_bf16 v[148:151], v[200:203], a[236:243], v16
    buffer_store_dwordx4 v[120:123], v26, s[24:27], s83 offen offset:128 sc0 sc1
    v_smfmac_f32_16x16x64_bf16 v[172:175], v[200:203], a[248:255], v16
    s_waitcnt lgkmcnt(11)
    ds_read_b128 v[208:211], v20 offset:6400
    ds_read_b128 a[232:235], v23 offset:2048
    ds_read_b128 a[236:239], v23 offset:3072
    v_mfma_f32_16x16x32_f16 v[248:251], a[228:231], v[144:147], v[248:251]
    s_nop 0
    v_cvt_pkrtz_f16_f32 v148, v148, v149
    v_cvt_pkrtz_f16_f32 v149, v150, v151
    v_mfma_f32_16x16x32_f16 v[252:255], a[228:231], v[168:171], v[252:255]
    s_waitcnt lgkmcnt(12)
    v_cvt_pkrtz_f16_f32 v172, v172, v173
    v_cvt_pkrtz_f16_f32 v173, v174, v175
    v_dot2_f32_f16 v28, v142, v142, v28
    v_dot2_f32_f16 v30, v166, v166, v30
    v_dot2_f32_f16 v28, v143, v143, v28
    v_dot2_f32_f16 v30, v167, v167, v30
    v_dot2_f32_f16 v28, v144, v144, v28
    v_dot2_f32_f16 v30, v168, v168, v30
    v_dot2_f32_f16 v28, v145, v145, v28
    v_dot2_f32_f16 v30, v169, v169, v30
    v_dot2_f32_f16 v28, v146, v146, v28
    v_dot2_f32_f16 v30, v170, v170, v30
    v_dot2_f32_f16 v28, v147, v147, v28
    v_dot2_f32_f16 v30, v171, v171, v30
    v_permlane16_swap_b32 v138, v142
    v_permlane16_swap_b32 v162, v166
    v_permlane16_swap_b32 v139, v143
    v_mfma_f32_16x16x32_bf16 v[224:227], v[196:199], v[176:179], 0
    s_waitcnt lgkmcnt(5)
    v_permlane16_swap_b32 v163, v167
    v_mfma_f32_16x16x32_bf16 v[228:231], v[196:199], v[188:191], 0
    s_add_u32 s80, s80, 786432
    ds_read_b128 a[240:243], v23 offset:4096
    ds_read_b128 a[244:247], v23 offset:5120
    v_smfmac_f32_16x16x64_bf16 v[224:227], v[204:207], v[180:187], v16
    s_add_u32 s81, s81, 786432
    s_add_u32 s82, s82, 786432
    v_smfmac_f32_16x16x64_bf16 v[228:231], v[204:207], v[232:239], v16
    s_add_u32 s83, s83, 786432
    ds_read_b128 a[248:251], v23 offset:12288
    ds_read_b128 a[252:255], v23 offset:13312
    v_dot2_f32_f16 v28, v148, v148, v28
    v_dot2_f32_f16 v30, v172, v172, v30
    v_dot2_f32_f16 v28, v149, v149, v28
    v_dot2_f32_f16 v30, v173, v173, v30
L_mid:
    v_cvt_pkrtz_f16_f32 v150, v224, v225
    v_cvt_pkrtz_f16_f32 v174, v228, v229
    v_cvt_pkrtz_f16_f32 v151, v226, v227
    v_cvt_pkrtz_f16_f32 v175, v230, v231
    v_dot2_f32_f16 v28, v150, v150, v28
    v_mfma_f32_16x16x32_f16 v[248:251], a[228:231], v[148:151], v[248:251]
    v_permlane16_swap_b32 v144, v148
    v_permlane16_swap_b32 v145, v149
    v_mfma_f32_16x16x32_f16 v[252:255], a[228:231], v[172:175], v[252:255]
    s_cmp_eq_u32 s52, 3
    v_permlane16_swap_b32 v168, v172
    v_permlane16_swap_b32 v169, v173
    v_permlane16_swap_b32 v146, v150
    v_dot2_f32_f16 v30, v174, v174, v30
    v_dot2_f32_f16 v28, v151, v151, v28
    v_dot2_f32_f16 v30, v175, v175, v30
    v_permlane16_swap_b32 v170, v174
    v_permlane16_swap_b32 v147, v151
    v_permlane16_swap_b32 v171, v175
    v_mfma_f32_16x16x16_bf16 v[96:99], v[18:19], v[216:217], v[48:51]
    s_cselect_b32 s57, 0x40000000, 786432
    ds_read_b128 v[240:243], v20 offset:2560
    ds_read_b128 v[244:247], v21 offset:2560
    v_add_u32 v1, s57, v1
    v_mfma_f32_16x16x16_bf16 v[100:103], v[18:19], v[218:219], v[52:55]
    ds_read_b128 v[236:239], v21 offset:0
    ds_read_b128 v[232:235], v20 offset:0
    v_add_u32 v2, s57, v2
    v_mfma_f32_16x16x16_bf16 v[104:107], v[18:19], v[220:221], v[48:51]
    v_add_u32 v3, s57, v3
    v_add_u32 v4, s57, v4
    v_add_u32 v5, s57, v5
    v_mfma_f32_16x16x16_bf16 v[108:111], v[18:19], v[222:223], v[52:55]
    v_add_u32 v6, s57, v6
    v_add_u32 v7, s57, v7
    v_add_u32 v31, s57, v31
    v_mfma_f32_16x16x16_bf16 v[56:59], v[18:19], v[212:213], v[48:51]
    v_mov_b32 v27, v28
    v_mov_b32 v29, v30
    v_mfma_f32_16x16x16_bf16 v[60:63], v[18:19], v[214:215], v[52:55]
    s_waitcnt lgkmcnt(10)
    v_permlane32_swap_b32 v27, v28
    v_permlane32_swap_b32 v29, v30
    v_mfma_f32_16x16x16_bf16 v[48:51], v[18:19], v[208:209], v[48:51]
    v_add_f32 v28, v27, v28
    v_add_f32 v30, v29, v30
    v_mul_f32 v27, 0x3c2aaaab, v248
    v_mfma_f32_16x16x16_bf16 v[52:55], v[18:19], v[210:211], v[52:55]
    v_mul_f32 v29, 0x3c2aaaab, v252
    v_mul_f32 v28, 0x3c2aaaab, v28
    v_mul_f32 v30, 0x3c2aaaab, v30
    v_fma_f32 v28, -v27, v27, v28
    v_fma_f32 v30, -v29, v29, v30
    v_max_f32 v28, 0, v28
    v_max_f32 v30, 0, v30
    v_add_f32 v28, 0x3727c5ac, v28
    v_add_f32 v30, 0x3727c5ac, v30
    v_rsq_f32 v28, v28
    v_rsq_f32 v30, v30
    v_fma_mixlo_f16 v28, v28, s59, 0
    v_fma_mixlo_f16 v30, v30, s59, 0
    v_fma_mixhi_f16 v28, -v27, v28, 0 op_sel_hi:[0,1,0]
    v_fma_mixhi_f16 v30, -v29, v30, 0 op_sel_hi:[0,1,0]
    v_mov_b32 v27, v28
    v_mov_b32 v29, v30
    s_nop 0
    v_permlane16_swap_b32 v28, v27
    v_permlane16_swap_b32 v30, v29
    v_pk_fma_f16 v128, v128, v28, v28 op_sel:[0,0,1] op_sel_hi:[1,0,1]
    v_pk_fma_f16 v129, v129, v28, v28 op_sel:[0,0,1] op_sel_hi:[1,0,1]
    v_pk_fma_f16 v130, v130, v28, v28 op_sel:[0,0,1] op_sel_hi:[1,0,1]
    v_pk_fma_f16 v131, v131, v28, v28 op_sel:[0,0,1] op_sel_hi:[1,0,1]
    v_pk_fma_f16 v132, v132, v27, v27 op_sel:[0,0,1] op_sel_hi:[1,0,1]
    v_pk_fma_f16 v133, v133, v27, v27 op_sel:[0,0,1] op_sel_hi:[1,0,1]
    v_mfma_f32_16x16x32_f16 v[176:179], a[192:195], v[128:131], 0
    v_pk_fma_f16 v134, v134, v27, v27 op_sel:[0,0,1] op_sel_hi:[1,0,1]
    v_pk_fma_f16 v135, v135, v27, v27 op_sel:[0,0,1] op_sel_hi:[1,0,1]
    v_pk_fma_f16 v136, v136, v28, v28 op_sel:[0,0,1] op_sel_hi:[1,0,1]
    v_pk_fma_f16 v137, v137, v28, v28 op_sel:[0,0,1] op_sel_hi:[1,0,1]
    v_mfma_f32_16x16x32_f16 v[184:187], a[192:195], v[132:135], 0
    v_pk_fma_f16 v138, v138, v28, v28 op_sel:[0,0,1] op_sel_hi:[1,0,1]
    v_pk_fma_f16 v139, v139, v28, v28 op_sel:[0,0,1] op_sel_hi:[1,0,1]
    v_pk_fma_f16 v140, v140, v27, v27 op_sel:[0,0,1] op_sel_hi:[1,0,1]
    v_mfma_f32_16x16x32_f16 v[180:183], a[196:199], v[128:131], 0
    v_pk_fma_f16 v141, v141, v27, v27 op_sel:[0,0,1] op_sel_hi:[1,0,1]
    v_pk_fma_f16 v142, v142, v27, v27 op_sel:[0,0,1] op_sel_hi:[1,0,1]
    v_pk_fma_f16 v143, v143, v27, v27 op_sel:[0,0,1] op_sel_hi:[1,0,1]
    v_mfma_f32_16x16x32_f16 v[188:191], a[196:199], v[132:135], 0
    s_waitcnt lgkmcnt(9)
    v_pk_fma_f16 v147, v147, v28, v28 op_sel:[0,0,1] op_sel_hi:[1,0,1]
    v_pk_fma_f16 v144, v144, v28, v28 op_sel:[0,0,1] op_sel_hi:[1,0,1]
    v_pk_fma_f16 v145, v145, v28, v28 op_sel:[0,0,1] op_sel_hi:[1,0,1]
    v_mfma_f32_16x16x32_f16 v[176:179], a[232:235], v[136:139], v[176:179]
    v_bfi_b32 v147, v17, v147, s84
    v_pk_fma_f16 v146, v146, v28, v28 op_sel:[0,0,1] op_sel_hi:[1,0,1]
    v_pk_fma_f16 v151, v151, v27, v27 op_sel:[0,0,1] op_sel_hi:[1,0,1]
    v_mfma_f32_16x16x32_f16 v[184:187], a[232:235], v[140:143], v[184:187]
    s_waitcnt lgkmcnt(8)
    v_pk_fma_f16 v148, v148, v27, v27 op_sel:[0,0,1] op_sel_hi:[1,0,1]
    v_pk_fma_f16 v149, v149, v27, v27 op_sel:[0,0,1] op_sel_hi:[1,0,1]
    v_bfi_b32 v151, v17, v151, s84
    v_mfma_f32_16x16x32_f16 v[180:183], a[236:239], v[136:139], v[180:183]
    v_pk_fma_f16 v150, v150, v27, v27 op_sel:[0,0,1] op_sel_hi:[1,0,1]
    v_pk_fma_f16 v152, v152, v30, v30 op_sel:[0,0,1] op_sel_hi:[1,0,1]
    v_pk_fma_f16 v153, v153, v30, v30 op_sel:[0,0,1] op_sel_hi:[1,0,1]
    v_mfma_f32_16x16x32_f16 v[188:191], a[236:239], v[140:143], v[188:191]
    s_waitcnt lgkmcnt(7)
    v_pk_fma_f16 v154, v154, v30, v30 op_sel:[0,0,1] op_sel_hi:[1,0,1]
    v_pk_fma_f16 v155, v155, v30, v30 op_sel:[0,0,1] op_sel_hi:[1,0,1]
    v_pk_fma_f16 v156, v156, v29, v29 op_sel:[0,0,1] op_sel_hi:[1,0,1]
    v_mfma_f32_16x16x32_f16 v[176:179], a[240:243], v[144:147], v[176:179]
    v_pk_fma_f16 v157, v157, v29, v29 op_sel:[0,0,1] op_sel_hi:[1,0,1]
    v_pk_fma_f16 v158, v158, v29, v29 op_sel:[0,0,1] op_sel_hi:[1,0,1]
    v_pk_fma_f16 v159, v159, v29, v29 op_sel:[0,0,1] op_sel_hi:[1,0,1]
    v_mfma_f32_16x16x32_f16 v[184:187], a[240:243], v[148:151], v[184:187]
    s_waitcnt lgkmcnt(6)
    v_pk_fma_f16 v160, v160, v30, v30 op_sel:[0,0,1] op_sel_hi:[1,0,1]
    v_pk_fma_f16 v161, v161, v30, v30 op_sel:[0,0,1] op_sel_hi:[1,0,1]
    v_pk_fma_f16 v162, v162, v30, v30 op_sel:[0,0,1] op_sel_hi:[1,0,1]
    v_mfma_f32_16x16x32_f16 v[180:183], a[244:247], v[144:147], v[180:183]
    v_pk_fma_f16 v163, v163, v30, v30 op_sel:[0,0,1] op_sel_hi:[1,0,1]
    v_pk_fma_f16 v164, v164, v29, v29 op_sel:[0,0,1] op_sel_hi:[1,0,1]
    v_pk_fma_f16 v165, v165, v29, v29 op_sel:[0,0,1] op_sel_hi:[1,0,1]
    v_mfma_f32_16x16x32_f16 v[188:191], a[244:247], v[148:151], v[188:191]
    v_pk_fma_f16 v166, v166, v29, v29 op_sel:[0,0,1] op_sel_hi:[1,0,1]
    v_pk_fma_f16 v167, v167, v29, v29 op_sel:[0,0,1] op_sel_hi:[1,0,1]
    v_pk_fma_f16 v171, v171, v30, v30 op_sel:[0,0,1] op_sel_hi:[1,0,1]
    v_mfma_f32_16x16x32_f16 v[192:195], a[192:195], v[152:155], 0
    v_pk_fma_f16 v168, v168, v30, v30 op_sel:[0,0,1] op_sel_hi:[1,0,1]
    v_pk_fma_f16 v169, v169, v30, v30 op_sel:[0,0,1] op_sel_hi:[1,0,1]
    v_bfi_b32 v171, v17, v171, s84
    v_mfma_f32_16x16x32_f16 v[200:203], a[192:195], v[156:159], 0
    v_pk_fma_f16 v170, v170, v30, v30 op_sel:[0,0,1] op_sel_hi:[1,0,1]
    v_pk_fma_f16 v175, v175, v29, v29 op_sel:[0,0,1] op_sel_hi:[1,0,1]
    v_pk_fma_f16 v172, v172, v29, v29 op_sel:[0,0,1] op_sel_hi:[1,0,1]
    v_mfma_f32_16x16x32_f16 v[196:199], a[196:199], v[152:155], 0
    v_pk_fma_f16 v173, v173, v29, v29 op_sel:[0,0,1] op_sel_hi:[1,0,1]
    v_bfi_b32 v175, v17, v175, s84
    v_pk_fma_f16 v174, v174, v29, v29 op_sel:[0,0,1] op_sel_hi:[1,0,1]
    v_mfma_f32_16x16x32_f16 v[204:207], a[196:199], v[156:159], 0
    v_cvt_pkrtz_f16_f32 v208, v176, v177
    v_pk_lshrrev_b16 v208, 3, v208 op_sel_hi:[0,1]
    v_mad_u32_u16 v209, v208, 2, s85
    v_mfma_f32_16x16x32_f16 v[192:195], a[232:235], v[160:163], v[192:195]
    ds_read_u16 v209, v209
    v_mad_u32_u16 v208, v208, 2, s85 op_sel:[1,0,0,0]
    v_cvt_pkrtz_f16_f32 v210, v178, v179
    v_mfma_f32_16x16x32_f16 v[200:203], a[232:235], v[164:167], v[200:203]
    ds_read_u16_d16_hi v208, v208
    ds_read_b128 a[232:235], v23 offset:14336
    v_pk_lshrrev_b16 v210, 3, v210 op_sel_hi:[0,1]
    v_mfma_f32_16x16x32_f16 v[196:199], a[236:239], v[160:163], v[196:199]
    v_mad_u32_u16 v211, v210, 2, s85
    v_mad_u32_u16 v210, v210, 2, s85 op_sel:[1,0,0,0]
    ds_read_u16 v211, v211
    ds_read_u16_d16_hi v210, v210
    v_mfma_f32_16x16x32_f16 v[204:207], a[236:239], v[164:167], v[204:207]
    ds_read_b128 a[236:239], v23 offset:15360
    v_cvt_pkrtz_f16_f32 v212, v180, v181
    v_pk_lshrrev_b16 v212, 3, v212 op_sel_hi:[0,1]
    v_mfma_f32_16x16x32_f16 v[192:195], a[240:243], v[168:171], v[192:195]
    v_mad_u32_u16 v213, v212, 2, s85
    v_mad_u32_u16 v212, v212, 2, s85 op_sel:[1,0,0,0]
    v_cvt_pkrtz_f16_f32 v214, v182, v183
    v_mfma_f32_16x16x32_f16 v[200:203], a[240:243], v[172:175], v[200:203]
    ds_read_u16 v213, v213
    ds_read_u16_d16_hi v212, v212
    v_pk_lshrrev_b16 v214, 3, v214 op_sel_hi:[0,1]
    v_mfma_f32_16x16x32_f16 v[196:199], a[244:247], v[168:171], v[196:199]
    s_add_u32 m0, s56, 6336
    ds_read_b128 a[240:243], v23 offset:6144
    buffer_load_dwordx4 v1, s[20:23], 0 offen offset:64 lds
    v_mfma_f32_16x16x32_f16 v[204:207], a[244:247], v[172:175], v[204:207]
    s_waitcnt lgkmcnt(12)
    ds_read_b128 a[244:247], v23 offset:7168
    v_mad_u32_u16 v215, v214, 2, s85
    v_mad_u32_u16 v214, v214, 2, s85 op_sel:[1,0,0,0]
    v_mfma_f32_16x16x16_bf16 v[112:115], v[18:19], v[240:241], v[64:67]
    s_waitcnt lgkmcnt(12)
    ds_read_u16 v215, v215
    ds_read_u16_d16_hi v214, v214
    v_cvt_pkrtz_f16_f32 v216, v184, v185
    v_mfma_f32_16x16x16_bf16 v[116:119], v[18:19], v[242:243], v[68:71]
    v_pk_lshrrev_b16 v216, 3, v216 op_sel_hi:[0,1]
    v_mad_u32_u16 v217, v216, 2, s85
    v_mad_u32_u16 v216, v216, 2, s85 op_sel:[1,0,0,0]
    v_mfma_f32_16x16x16_bf16 v[120:123], v[18:19], v[244:245], v[64:67]
    s_waitcnt lgkmcnt(12)
    ds_read_u16 v217, v217
    ds_read_u16_d16_hi v216, v216
    v_cvt_pkrtz_f16_f32 v218, v186, v187
    v_mfma_f32_16x16x16_bf16 v[124:127], v[18:19], v[246:247], v[68:71]
    v_pk_lshrrev_b16 v218, 3, v218 op_sel_hi:[0,1]
    v_mad_u32_u16 v219, v218, 2, s85
    v_mad_u32_u16 v218, v218, 2, s85 op_sel:[1,0,0,0]
    v_mfma_f32_16x16x16_bf16 v[72:75], v[18:19], v[236:237], v[64:67]
    s_waitcnt lgkmcnt(12)
    ds_read_u16 v219, v219
    ds_read_u16_d16_hi v218, v218
    v_cvt_pkrtz_f16_f32 v220, v188, v189
    v_mfma_f32_16x16x16_bf16 v[76:79], v[18:19], v[238:239], v[68:71]
    v_pk_lshrrev_b16 v220, 3, v220 op_sel_hi:[0,1]
    v_mad_u32_u16 v221, v220, 2, s85
    v_mad_u32_u16 v220, v220, 2, s85 op_sel:[1,0,0,0]
    v_mfma_f32_16x16x16_bf16 v[64:67], v[18:19], v[232:233], v[64:67]
    s_waitcnt lgkmcnt(12)
    ds_read_u16 v221, v221
    ds_read_u16_d16_hi v220, v220
    v_cvt_pkrtz_f16_f32 v224, v190, v191
    v_mfma_f32_16x16x16_bf16 v[68:71], v[18:19], v[234:235], v[68:71]
    v_pk_fma_f16 v222, v224, v224, s53
    v_pk_mul_f16 v222, v222, v224 neg_lo:[1,0] neg_hi:[1,0]
    v_exp_f16 v223, v222
    v_mfma_f32_16x16x32_f16 v[176:179], a[200:203], v[128:131], 0
    v_exp_f16_sdwa v223, v222 dst_sel:WORD_1 dst_unused:UNUSED_PRESERVE src0_sel:WORD_1
    v_or_b32 v232, v209, v208
    v_mfma_f32_16x16x32_f16 v[184:187], a[200:203], v[132:135], 0
    v_pk_fma_f16 v223, v223, s86, s86
    v_rcp_f16 v222, v223
    v_mfma_f32_16x16x32_f16 v[180:183], a[204:207], v[128:131], 0
    s_waitcnt lgkmcnt(13)
    v_rcp_f16_sdwa v222, v223 dst_sel:WORD_1 dst_unused:UNUSED_PRESERVE src0_sel:WORD_1
    v_or_b32 v233, v211, v210
    v_mfma_f32_16x16x32_f16 v[188:191], a[204:207], v[132:135], 0
    s_waitcnt lgkmcnt(10)
    v_fma_mix_f32 v223, v222, v224, 0 op_sel_hi:[1,1,0]
    v_fma_mix_f32 v222, v222, v224, 0 op_sel:[1,1,0] op_sel_hi:[1,1,0]
    v_or_b32 v234, v213, v212
    v_mfma_f32_16x16x32_f16 v[176:179], a[248:251], v[136:139], v[176:179]
    s_waitcnt lgkmcnt(4)
    v_or_b32 v235, v215, v214
    v_or_b32 v236, v217, v216
    v_cvt_pk_bf16_f32 v239, v223, v222
    v_mfma_f32_16x16x32_f16 v[184:187], a[248:251], v[140:143], v[184:187]
    v_cvt_pkrtz_f16_f32 v225, v192, v193
    v_pk_lshrrev_b16 v225, 3, v225 op_sel_hi:[0,1]
    v_cvt_pkrtz_f16_f32 v227, v194, v195
    v_mfma_f32_16x16x32_f16 v[192:195], a[200:203], v[152:155], 0
    s_waitcnt lgkmcnt(2)
    v_or_b32 v237, v219, v218
    v_cvt_pkrtz_f16_f32 v229, v196, v197
    v_cvt_pkrtz_f16_f32 v231, v198, v199
    v_cvt_pkrtz_f16_f32 v249, v200, v201
    v_cvt_pkrtz_f16_f32 v251, v202, v203
    v_mfma_f32_16x16x32_f16 v[200:203], a[200:203], v[156:159], 0
    v_cvt_pkrtz_f16_f32 v253, v204, v205
    v_cvt_pkrtz_f16_f32 v210, v206, v207
    v_mad_u32_u16 v226, v225, 2, s85
    v_mfma_f32_16x16x32_f16 v[180:183], a[252:255], v[136:139], v[180:183]
    s_waitcnt lgkmcnt(0)
    ds_read_u16 v226, v226
    v_or_b32 v238, v221, v220
    v_mad_u32_u16 v225, v225, 2, s85 op_sel:[1,0,0,0]
    v_mfma_f32_16x16x32_f16 v[188:191], a[252:255], v[140:143], v[188:191]
    ds_read_u16_d16_hi v225, v225
    v_pk_lshrrev_b16 v227, 3, v227 op_sel_hi:[0,1]
    v_mad_u32_u16 v228, v227, 2, s85
    v_mfma_f32_16x16x32_f16 v[196:199], a[204:207], v[152:155], 0
    ds_read_u16 v228, v228
    v_mad_u32_u16 v227, v227, 2, s85 op_sel:[1,0,0,0]
    v_pk_lshrrev_b16 v229, 3, v229 op_sel_hi:[0,1]
    v_mfma_f32_16x16x32_f16 v[204:207], a[204:207], v[156:159], 0
    ds_read_u16_d16_hi v227, v227
    v_mad_u32_u16 v230, v229, 2, s85
    v_mad_u32_u16 v229, v229, 2, s85 op_sel:[1,0,0,0]
    v_mfma_f32_16x16x32_f16 v[176:179], a[232:235], v[144:147], v[176:179]
    ds_read_u16 v230, v230
    ds_read_u16_d16_hi v229, v229
    v_pk_lshrrev_b16 v231, 3, v231 op_sel_hi:[0,1]
    v_mfma_f32_16x16x32_f16 v[184:187], a[232:235], v[148:151], v[184:187]
    v_mad_u32_u16 v248, v231, 2, s85
    v_mad_u32_u16 v231, v231, 2, s85 op_sel:[1,0,0,0]
    v_pk_lshrrev_b16 v249, 3, v249 op_sel_hi:[0,1]
    v_mfma_f32_16x16x32_f16 v[192:195], a[248:251], v[160:163], v[192:195]
    ds_read_u16 v248, v248
    ds_read_u16_d16_hi v231, v231
    v_mad_u32_u16 v250, v249, 2, s85
    v_mfma_f32_16x16x32_f16 v[200:203], a[248:251], v[164:167], v[200:203]
    ds_read_u16 v250, v250
    ds_read_b128 a[248:251], v23 offset:8192
    v_mad_u32_u16 v249, v249, 2, s85 op_sel:[1,0,0,0]
    v_mfma_f32_16x16x32_f16 v[180:183], a[236:239], v[144:147], v[180:183]
    ds_read_u16_d16_hi v249, v249
    v_pk_lshrrev_b16 v251, 3, v251 op_sel_hi:[0,1]
    v_mad_u32_u16 v252, v251, 2, s85
    v_mfma_f32_16x16x32_f16 v[188:191], a[236:239], v[148:151], v[188:191]
    ds_read_u16 v252, v252
    v_mad_u32_u16 v251, v251, 2, s85 op_sel:[1,0,0,0]
    v_pk_lshrrev_b16 v253, 3, v253 op_sel_hi:[0,1]
    v_mfma_f32_16x16x32_f16 v[196:199], a[252:255], v[160:163], v[196:199]
    s_add_u32 m0, s56, 7360
    ds_read_u16_d16_hi v251, v251
    buffer_load_dwordx4 v2, s[20:23], 0 offen offset:64 lds
    v_mfma_f32_16x16x32_f16 v[204:207], a[252:255], v[164:167], v[204:207]
    ds_read_b128 a[252:255], v23 offset:9216
    v_mad_u32_u16 v0, v253, 2, s85
    v_mad_u32_u16 v253, v253, 2, s85 op_sel:[1,0,0,0]
    v_mfma_f32_16x16x32_f16 v[192:195], a[232:235], v[168:171], v[192:195]
    s_waitcnt lgkmcnt(12)
    ds_read_u16 v0, v0
    ds_read_u16_d16_hi v253, v253
    v_pk_fma_f16 v208, v210, v210, s53
    v_mfma_f32_16x16x32_f16 v[200:203], a[232:235], v[172:175], v[200:203]
    s_waitcnt lgkmcnt(13)
    ds_read_b128 a[232:235], v23 offset:0
    v_pk_mul_f16 v208, v208, v210 neg_lo:[1,0] neg_hi:[1,0]
    v_exp_f16 v209, v208
    v_mfma_f32_16x16x32_f16 v[196:199], a[236:239], v[168:171], v[196:199]
    v_exp_f16_sdwa v209, v208 dst_sel:WORD_1 dst_unused:UNUSED_PRESERVE src0_sel:WORD_1
    v_or_b32 v240, v226, v225
    v_mfma_f32_16x16x32_f16 v[204:207], a[236:239], v[172:175], v[204:207]
    s_waitcnt lgkmcnt(13)
    ds_read_b128 a[236:239], v23 offset:1024
    v_pk_fma_f16 v209, v209, s86, s86
    v_rcp_f16 v208, v209
    v_mfma_f32_16x16x32_bf16 v[32:35], a[240:243], v[232:235], v[32:35]
    v_rcp_f16_sdwa v208, v209 dst_sel:WORD_1 dst_unused:UNUSED_PRESERVE src0_sel:WORD_1
    v_or_b32 v241, v228, v227
    v_mfma_f32_16x16x32_bf16 v[40:43], a[240:243], v[236:239], v[40:43]
    s_waitcnt lgkmcnt(12)
    v_fma_mix_f32 v209, v208, v210, 0 op_sel_hi:[1,1,0]
    v_fma_mix_f32 v208, v208, v210, 0 op_sel:[1,1,0] op_sel_hi:[1,1,0]
    v_or_b32 v242, v230, v229
    v_mfma_f32_16x16x32_bf16 v[36:39], a[244:247], v[232:235], v[36:39]
    s_waitcnt lgkmcnt(7)
    v_or_b32 v243, v248, v231
    v_or_b32 v244, v250, v249
    v_cvt_pk_bf16_f32 v247, v209, v208
    v_mfma_f32_16x16x32_bf16 v[44:47], a[244:247], v[236:239], v[44:47]
    v_cvt_pkrtz_f16_f32 v211, v176, v177
    v_pk_lshrrev_b16 v211, 3, v211 op_sel_hi:[0,1]
    v_mad_u32_u16 v212, v211, 2, s85
    v_mfma_f32_16x16x32_bf16 v[48:51], a[248:251], v[232:235], v[48:51]
    s_waitcnt lgkmcnt(5)
    ds_read_u16 v212, v212
    v_or_b32 v245, v252, v251
    v_mad_u32_u16 v211, v211, 2, s85 op_sel:[1,0,0,0]
    v_mfma_f32_16x16x32_bf16 v[56:59], a[248:251], v[236:239], v[56:59]
    ds_read_u16_d16_hi v211, v211
    v_cvt_pkrtz_f16_f32 v213, v178, v179
    v_pk_lshrrev_b16 v213, 3, v213 op_sel_hi:[0,1]
    v_mfma_f32_16x16x32_bf16 v[80:83], a[240:243], v[240:243], v[80:83]
    s_waitcnt lgkmcnt(5)
    v_mad_u32_u16 v214, v213, 2, s85
    v_mad_u32_u16 v213, v213, 2, s85 op_sel:[1,0,0,0]
    v_cvt_pkrtz_f16_f32 v215, v180, v181
    v_pk_lshrrev_b16 v215, 3, v215 op_sel_hi:[0,1]
    v_mad_u32_u16 v216, v215, 2, s85
    v_mad_u32_u16 v215, v215, 2, s85 op_sel:[1,0,0,0]
    v_cvt_pkrtz_f16_f32 v217, v182, v183
    s_waitcnt lgkmcnt(4)
    v_or_b32 v246, v0, v253
    v_pk_lshrrev_b16 v217, 3, v217 op_sel_hi:[0,1]
    v_mad_u32_u16 v218, v217, 2, s85
    v_mfma_f32_16x16x32_bf16 v[88:91], a[240:243], v[244:247], v[88:91]
    ds_read_u16 v214, v214
    ds_read_u16_d16_hi v213, v213
    v_mad_u32_u16 v217, v217, 2, s85 op_sel:[1,0,0,0]
    v_mfma_f32_16x16x32_bf16 v[52:55], a[252:255], v[232:235], v[52:55]
    ds_read_u16 v216, v216
    ds_read_u16_d16_hi v215, v215
    v_cvt_pkrtz_f16_f32 v219, v184, v185
    v_mfma_f32_16x16x32_bf16 v[60:63], a[252:255], v[236:239], v[60:63]
    ds_read_u16 v218, v218
    ds_read_u16_d16_hi v217, v217
    v_pk_lshrrev_b16 v219, 3, v219 op_sel_hi:[0,1]
    v_mfma_f32_16x16x32_bf16 v[84:87], a[244:247], v[240:243], v[84:87]
    ds_read_b128 a[240:243], v23 offset:22528
    v_mad_u32_u16 v220, v219, 2, s85
    v_mad_u32_u16 v219, v219, 2, s85 op_sel:[1,0,0,0]
    v_mfma_f32_16x16x32_bf16 v[92:95], a[244:247], v[244:247], v[92:95]
    s_waitcnt lgkmcnt(10)
    ds_read_u16 v220, v220
    ds_read_u16_d16_hi v219, v219
    v_cvt_pkrtz_f16_f32 v221, v186, v187
    v_mfma_f32_16x16x32_bf16 v[64:67], a[232:235], v[232:235], v[64:67]
    ds_read_b128 a[244:247], v23 offset:23552
    v_pk_lshrrev_b16 v221, 3, v221 op_sel_hi:[0,1]
    v_mad_u32_u16 v222, v221, 2, s85
    v_mfma_f32_16x16x32_bf16 v[72:75], a[232:235], v[236:239], v[72:75]
    ds_read_u16 v222, v222
    v_mad_u32_u16 v221, v221, 2, s85 op_sel:[1,0,0,0]
    v_cvt_pkrtz_f16_f32 v223, v188, v189
    v_mfma_f32_16x16x32_bf16 v[96:99], a[248:251], v[240:243], v[96:99]
    s_waitcnt lgkmcnt(11)
    ds_read_u16_d16_hi v221, v221
    v_pk_lshrrev_b16 v223, 3, v223 op_sel_hi:[0,1]
    v_mad_u32_u16 v224, v223, 2, s85
    v_mfma_f32_16x16x32_bf16 v[104:107], a[248:251], v[244:247], v[104:107]
    s_add_u32 m0, s56, 8384
    ds_read_u16 v224, v224
    ds_read_b128 a[248:251], v23 offset:24576
    v_mad_u32_u16 v223, v223, 2, s85 op_sel:[1,0,0,0]
    v_mfma_f32_16x16x32_bf16 v[68:71], a[236:239], v[232:235], v[68:71]
    s_waitcnt lgkmcnt(13)
    ds_read_u16_d16_hi v223, v223
    buffer_load_dwordx4 v3, s[20:23], 0 offen offset:64 lds
    v_mfma_f32_16x16x32_bf16 v[76:79], a[236:239], v[236:239], v[76:79]
    v_cvt_pkrtz_f16_f32 v227, v190, v191
    v_pk_fma_f16 v225, v227, v227, s53
    v_pk_mul_f16 v225, v225, v227 neg_lo:[1,0] neg_hi:[1,0]
    v_mfma_f32_16x16x32_bf16 v[100:103], a[252:255], v[240:243], v[100:103]
    v_exp_f16 v226, v225
    v_or_b32 v232, v212, v211
    v_mfma_f32_16x16x32_bf16 v[108:111], a[252:255], v[244:247], v[108:111]
    s_waitcnt lgkmcnt(13)
    ds_read_b128 a[252:255], v23 offset:25600
    v_exp_f16_sdwa v226, v225 dst_sel:WORD_1 dst_unused:UNUSED_PRESERVE src0_sel:WORD_1
    v_mfma_f32_16x16x32_bf16 v[112:115], a[232:235], v[240:243], v[112:115]
    v_pk_fma_f16 v226, v226, s86, s86
    v_rcp_f16 v225, v226
    v_mfma_f32_16x16x32_bf16 v[120:123], a[232:235], v[244:247], v[120:123]
    s_waitcnt lgkmcnt(13)
    ds_read_b128 a[232:235], v23 offset:16384
    v_rcp_f16_sdwa v225, v226 dst_sel:WORD_1 dst_unused:UNUSED_PRESERVE src0_sel:WORD_1
    v_mfma_f32_16x16x32_bf16 v[116:119], a[236:239], v[240:243], v[116:119]
    v_fma_mix_f32 v226, v225, v227, 0 op_sel_hi:[1,1,0]
    v_fma_mix_f32 v225, v225, v227, 0 op_sel:[1,1,0] op_sel_hi:[1,1,0]
    v_or_b32 v233, v214, v213
    v_mfma_f32_16x16x32_bf16 v[124:127], a[236:239], v[244:247], v[124:127]
    s_waitcnt lgkmcnt(11)
    ds_read_b128 a[236:239], v23 offset:17408
    v_or_b32 v234, v216, v215
    v_or_b32 v235, v218, v217
    v_mfma_f32_16x16x32_f16 v[176:179], a[208:211], v[128:131], 0
    s_waitcnt lgkmcnt(9)
    v_or_b32 v236, v220, v219
    v_cvt_pk_bf16_f32 v239, v226, v225
    v_cvt_pkrtz_f16_f32 v228, v192, v193
    v_mfma_f32_16x16x32_f16 v[184:187], a[208:211], v[132:135], 0
    v_pk_lshrrev_b16 v228, 3, v228 op_sel_hi:[0,1]
    v_cvt_pkrtz_f16_f32 v230, v194, v195
    v_cvt_pkrtz_f16_f32 v248, v196, v197
    v_mfma_f32_16x16x32_f16 v[180:183], a[212:215], v[128:131], 0
    s_waitcnt lgkmcnt(6)
    v_cvt_pkrtz_f16_f32 v250, v198, v199
    v_cvt_pkrtz_f16_f32 v252, v200, v201
    v_or_b32 v237, v222, v221
    v_mfma_f32_16x16x32_f16 v[188:191], a[212:215], v[132:135], 0
    v_cvt_pkrtz_f16_f32 v0, v202, v203
    v_cvt_pkrtz_f16_f32 v209, v204, v205
    v_cvt_pkrtz_f16_f32 v211, v206, v207
    v_mfma_f32_16x16x32_f16 v[176:179], a[240:243], v[136:139], v[176:179]
    v_mad_u32_u16 v229, v228, 2, s85
    v_mad_u32_u16 v228, v228, 2, s85 op_sel:[1,0,0,0]
    ds_read_u16 v229, v229
    ds_read_u16_d16_hi v228, v228
    v_mfma_f32_16x16x32_f16 v[184:187], a[240:243], v[140:143], v[184:187]
    s_waitcnt lgkmcnt(5)
    v_pk_lshrrev_b16 v230, 3, v230 op_sel_hi:[0,1]
    v_mad_u32_u16 v231, v230, 2, s85
    v_or_b32 v238, v224, v223
    v_mfma_f32_16x16x32_f16 v[192:195], a[208:211], v[152:155], 0
    ds_read_u16 v231, v231
    v_mad_u32_u16 v230, v230, 2, s85 op_sel:[1,0,0,0]
    v_pk_lshrrev_b16 v248, 3, v248 op_sel_hi:[0,1]
    v_mfma_f32_16x16x32_f16 v[200:203], a[208:211], v[156:159], 0
    ds_read_u16_d16_hi v230, v230
    v_mad_u32_u16 v249, v248, 2, s85
    v_mad_u32_u16 v248, v248, 2, s85 op_sel:[1,0,0,0]
    v_mfma_f32_16x16x32_f16 v[180:183], a[244:247], v[136:139], v[180:183]
    ds_read_u16 v249, v249
    ds_read_u16_d16_hi v248, v248
    v_pk_lshrrev_b16 v250, 3, v250 op_sel_hi:[0,1]
    v_mfma_f32_16x16x32_f16 v[188:191], a[244:247], v[140:143], v[188:191]
    v_mad_u32_u16 v251, v250, 2, s85
    v_mad_u32_u16 v250, v250, 2, s85 op_sel:[1,0,0,0]
    v_pk_lshrrev_b16 v252, 3, v252 op_sel_hi:[0,1]
    v_mfma_f32_16x16x32_f16 v[196:199], a[212:215], v[152:155], 0
    ds_read_u16 v251, v251
    ds_read_u16_d16_hi v250, v250
    v_mad_u32_u16 v253, v252, 2, s85
    v_mfma_f32_16x16x32_f16 v[204:207], a[212:215], v[156:159], 0
    ds_read_u16 v253, v253
    v_mad_u32_u16 v252, v252, 2, s85 op_sel:[1,0,0,0]
    v_pk_lshrrev_b16 v0, 3, v0 op_sel_hi:[0,1]
    v_mfma_f32_16x16x32_f16 v[176:179], a[248:251], v[144:147], v[176:179]
    s_waitcnt lgkmcnt(11)
    ds_read_u16_d16_hi v252, v252
    v_mad_u32_u16 v208, v0, 2, s85
    v_mad_u32_u16 v0, v0, 2, s85 op_sel:[1,0,0,0]
    v_mfma_f32_16x16x32_f16 v[184:187], a[248:251], v[148:151], v[184:187]
    s_add_u32 m0, s56, 9408
    ds_read_u16 v208, v208
    ds_read_u16_d16_hi v0, v0
    v_pk_lshrrev_b16 v209, 3, v209 op_sel_hi:[0,1]
    v_mfma_f32_16x16x32_f16 v[192:195], a[240:243], v[160:163], v[192:195]
    s_waitcnt lgkmcnt(13)
    buffer_load_dwordx4 v4, s[20:23], 0 offen offset:64 lds
    v_mfma_f32_16x16x32_f16 v[200:203], a[240:243], v[164:167], v[200:203]
    s_add_u32 m0, s56, 10432
    ds_read_b128 a[240:243], v23 offset:18432
    buffer_load_dwordx4 v5, s[20:23], 0 offen offset:64 lds
    v_mfma_f32_16x16x32_f16 v[180:183], a[252:255], v[144:147], v[180:183]
    v_mad_u32_u16 v210, v209, 2, s85
    v_mad_u32_u16 v209, v209, 2, s85 op_sel:[1,0,0,0]
    v_pk_lshrrev_b16 v211, 3, v211 op_sel_hi:[0,1]
    v_mfma_f32_16x16x32_f16 v[188:191], a[252:255], v[148:151], v[188:191]
    s_waitcnt lgkmcnt(12)
    ds_read_u16 v210, v210
    ds_read_u16_d16_hi v209, v209
    v_mad_u32_u16 v212, v211, 2, s85
    v_mfma_f32_16x16x32_f16 v[196:199], a[244:247], v[160:163], v[196:199]
    s_waitcnt lgkmcnt(13)
    ds_read_u16 v212, v212
    v_mad_u32_u16 v211, v211, 2, s85 op_sel:[1,0,0,0]
    v_or_b32 v240, v229, v228
    v_mfma_f32_16x16x32_f16 v[204:207], a[244:247], v[164:167], v[204:207]
    s_waitcnt lgkmcnt(12)
    ds_read_u16_d16_hi v211, v211
    ds_read_b128 a[244:247], v23 offset:19456
    v_or_b32 v241, v231, v230
    v_mfma_f32_16x16x32_f16 v[192:195], a[248:251], v[168:171], v[192:195]
    s_waitcnt lgkmcnt(10)
    v_or_b32 v242, v249, v248
    v_or_b32 v243, v251, v250
    v_cvt_pkrtz_f16_f32 v213, v176, v177
    v_mfma_f32_16x16x32_f16 v[200:203], a[248:251], v[172:175], v[200:203]
    ds_read_b128 a[248:251], v23 offset:10240
    v_pk_lshrrev_b16 v213, 3, v213 op_sel_hi:[0,1]
    v_mad_u32_u16 v214, v213, 2, s85
    v_mfma_f32_16x16x32_f16 v[196:199], a[252:255], v[168:171], v[196:199]
    s_waitcnt lgkmcnt(9)
    ds_read_u16 v214, v214
    v_or_b32 v244, v253, v252
    v_mad_u32_u16 v213, v213, 2, s85 op_sel:[1,0,0,0]
    v_mfma_f32_16x16x32_f16 v[204:207], a[252:255], v[172:175], v[204:207]
    ds_read_b128 a[252:255], v23 offset:11264
    ds_read_u16_d16_hi v213, v213
    v_cvt_pkrtz_f16_f32 v215, v178, v179
    v_mfma_f32_16x16x32_bf16 v[32:35], a[232:235], v[232:235], v[32:35]
    v_pk_lshrrev_b16 v215, 3, v215 op_sel_hi:[0,1]
    v_mad_u32_u16 v216, v215, 2, s85
    v_mad_u32_u16 v215, v215, 2, s85 op_sel:[1,0,0,0]
    v_mfma_f32_16x16x32_bf16 v[40:43], a[232:235], v[236:239], v[40:43]
    s_waitcnt lgkmcnt(10)
    ds_read_u16 v216, v216
    ds_read_u16_d16_hi v215, v215
    v_or_b32 v245, v208, v0
    v_mfma_f32_16x16x32_bf16 v[36:39], a[236:239], v[232:235], v[36:39]
    v_cvt_pkrtz_f16_f32 v217, v180, v181
    v_pk_lshrrev_b16 v217, 3, v217 op_sel_hi:[0,1]
    v_mad_u32_u16 v218, v217, 2, s85
    v_mfma_f32_16x16x32_bf16 v[44:47], a[236:239], v[236:239], v[44:47]
    s_waitcnt lgkmcnt(11)
    ds_read_u16 v218, v218
    v_mad_u32_u16 v217, v217, 2, s85 op_sel:[1,0,0,0]
    v_cvt_pkrtz_f16_f32 v219, v182, v183
    v_mfma_f32_16x16x32_bf16 v[48:51], a[240:243], v[232:235], v[48:51]
    ds_read_u16_d16_hi v217, v217
    v_pk_lshrrev_b16 v219, 3, v219 op_sel_hi:[0,1]
    v_mad_u32_u16 v220, v219, 2, s85
    v_mfma_f32_16x16x32_bf16 v[56:59], a[240:243], v[236:239], v[56:59]
    s_waitcnt lgkmcnt(11)
    ds_read_u16 v220, v220
    v_or_b32 v246, v210, v209
    v_mad_u32_u16 v219, v219, 2, s85 op_sel:[1,0,0,0]
    v_mfma_f32_16x16x32_bf16 v[80:83], a[232:235], v[240:243], v[80:83]
    s_waitcnt lgkmcnt(11)
    ds_read_u16_d16_hi v219, v219
    v_cvt_pkrtz_f16_f32 v221, v184, v185
    v_pk_lshrrev_b16 v221, 3, v221 op_sel_hi:[0,1]
    v_mad_u32_u16 v222, v221, 2, s85
    v_mad_u32_u16 v221, v221, 2, s85 op_sel:[1,0,0,0]
    v_cvt_pkrtz_f16_f32 v223, v186, v187
    v_pk_lshrrev_b16 v223, 3, v223 op_sel_hi:[0,1]
    v_mad_u32_u16 v224, v223, 2, s85
    s_waitcnt lgkmcnt(11)
    v_or_b32 v247, v212, v211
    v_mad_u32_u16 v223, v223, 2, s85 op_sel:[1,0,0,0]
    v_cvt_pkrtz_f16_f32 v225, v188, v189
    v_mfma_f32_16x16x32_bf16 v[88:91], a[232:235], v[244:247], v[88:91]
    s_waitcnt lgkmcnt(10)
    ds_read_u16 v222, v222
    ds_read_u16_d16_hi v221, v221
    v_pk_lshrrev_b16 v225, 3, v225 op_sel_hi:[0,1]
    v_mfma_f32_16x16x32_bf16 v[52:55], a[244:247], v[232:235], v[52:55]
    ds_read_u16 v224, v224
    ds_read_u16_d16_hi v223, v223
    v_mad_u32_u16 v226, v225, 2, s85
    v_mfma_f32_16x16x32_bf16 v[60:63], a[244:247], v[236:239], v[60:63]
    s_waitcnt lgkmcnt(12)
    ds_read_u16 v226, v226
    ds_read_b128 a[232:235], v23 offset:32768
    v_mad_u32_u16 v225, v225, 2, s85 op_sel:[1,0,0,0]
    v_mfma_f32_16x16x32_bf16 v[84:87], a[236:239], v[240:243], v[84:87]
    s_waitcnt lgkmcnt(13)
    ds_read_u16_d16_hi v225, v225
    v_cvt_pkrtz_f16_f32 v229, v190, v191
    v_pk_fma_f16 v227, v229, v229, s53
    v_mfma_f32_16x16x32_bf16 v[92:95], a[236:239], v[244:247], v[92:95]
    v_pk_mul_f16 v227, v227, v229 neg_lo:[1,0] neg_hi:[1,0]
    v_exp_f16 v228, v227
    v_mfma_f32_16x16x32_bf16 v[64:67], a[248:251], v[232:235], v[64:67]
    s_waitcnt lgkmcnt(13)
    ds_read_b128 a[236:239], v23 offset:33792
    v_exp_f16_sdwa v228, v227 dst_sel:WORD_1 dst_unused:UNUSED_PRESERVE src0_sel:WORD_1
    v_mfma_f32_16x16x32_bf16 v[72:75], a[248:251], v[236:239], v[72:75]
    v_pk_fma_f16 v228, v228, s86, s86
    v_rcp_f16 v227, v228
    v_mfma_f32_16x16x32_bf16 v[96:99], a[240:243], v[240:243], v[96:99]
    v_rcp_f16_sdwa v227, v228 dst_sel:WORD_1 dst_unused:UNUSED_PRESERVE src0_sel:WORD_1
    v_cvt_pkrtz_f16_f32 v230, v192, v193
    v_mfma_f32_16x16x32_bf16 v[104:107], a[240:243], v[244:247], v[104:107]
    s_waitcnt lgkmcnt(13)
    ds_read_b128 a[240:243], v23 offset:34816
    v_fma_mix_f32 v228, v227, v229, 0 op_sel_hi:[1,1,0]
    v_fma_mix_f32 v227, v227, v229, 0 op_sel:[1,1,0] op_sel_hi:[1,1,0]
    v_mfma_f32_16x16x32_bf16 v[68:71], a[252:255], v[232:235], v[68:71]
    s_waitcnt lgkmcnt(13)
    v_or_b32 v232, v214, v213
    v_or_b32 v233, v216, v215
    v_pk_lshrrev_b16 v230, 3, v230 op_sel_hi:[0,1]
    v_mfma_f32_16x16x32_bf16 v[76:79], a[252:255], v[236:239], v[76:79]
    s_waitcnt lgkmcnt(11)
    v_cvt_pk_bf16_f32 v239, v228, v227
    v_or_b32 v234, v218, v217
    v_cvt_pkrtz_f16_f32 v248, v194, v195
    v_mfma_f32_16x16x32_bf16 v[100:103], a[244:247], v[240:243], v[100:103]
    v_cvt_pkrtz_f16_f32 v250, v196, v197
    v_cvt_pkrtz_f16_f32 v252, v198, v199
    v_cvt_pkrtz_f16_f32 v0, v200, v201
    v_mfma_f32_16x16x32_bf16 v[108:111], a[244:247], v[244:247], v[108:111]
    ds_read_b128 a[244:247], v23 offset:35840
    v_cvt_pkrtz_f16_f32 v209, v202, v203
    v_cvt_pkrtz_f16_f32 v211, v204, v205
    v_mfma_f32_16x16x32_bf16 v[112:115], a[248:251], v[240:243], v[112:115]
    s_waitcnt lgkmcnt(10)
    v_or_b32 v235, v220, v219
    v_cvt_pkrtz_f16_f32 v215, v206, v207
    v_mad_u32_u16 v231, v230, 2, s85
    v_mfma_f32_16x16x32_bf16 v[120:123], a[248:251], v[244:247], v[120:123]
    ds_read_b128 a[248:251], v23 offset:26624
    ds_read_u16 v231, v231
    v_mad_u32_u16 v230, v230, 2, s85 op_sel:[1,0,0,0]
    v_mfma_f32_16x16x32_bf16 v[116:119], a[252:255], v[240:243], v[116:119]
    ds_read_u16_d16_hi v230, v230
    v_pk_lshrrev_b16 v248, 3, v248 op_sel_hi:[0,1]
    v_mad_u32_u16 v249, v248, 2, s85
    v_mfma_f32_16x16x32_bf16 v[124:127], a[252:255], v[244:247], v[124:127]
    s_waitcnt lgkmcnt(11)
    ds_read_b128 a[252:255], v23 offset:27648
    ds_read_u16 v249, v249
    v_or_b32 v236, v222, v221
    v_mfma_f32_16x16x32_f16 v[176:179], a[216:219], v[128:131], 0
    v_mad_u32_u16 v248, v248, 2, s85 op_sel:[1,0,0,0]
    v_pk_lshrrev_b16 v250, 3, v250 op_sel_hi:[0,1]
    v_mad_u32_u16 v251, v250, 2, s85
    v_mfma_f32_16x16x32_f16 v[184:187], a[216:219], v[132:135], 0
    s_waitcnt lgkmcnt(12)
    ds_read_u16_d16_hi v248, v248
    ds_read_u16 v251, v251
    v_mad_u32_u16 v250, v250, 2, s85 op_sel:[1,0,0,0]
    v_mfma_f32_16x16x32_f16 v[180:183], a[220:223], v[128:131], 0
    s_waitcnt lgkmcnt(13)
    ds_read_u16_d16_hi v250, v250
    v_or_b32 v237, v224, v223
    v_pk_lshrrev_b16 v252, 3, v252 op_sel_hi:[0,1]
    v_mfma_f32_16x16x32_f16 v[188:191], a[220:223], v[132:135], 0
    v_mad_u32_u16 v253, v252, 2, s85
    v_mad_u32_u16 v252, v252, 2, s85 op_sel:[1,0,0,0]
    v_pk_lshrrev_b16 v0, 3, v0 op_sel_hi:[0,1]
    v_mad_u32_u16 v208, v0, 2, s85
    v_mad_u32_u16 v0, v0, 2, s85 op_sel:[1,0,0,0]
    v_pk_lshrrev_b16 v209, 3, v209 op_sel_hi:[0,1]
    s_waitcnt lgkmcnt(12)
    v_mfma_f32_16x16x32_f16 v[176:179], a[232:235], v[136:139], v[176:179]
    ds_read_u16 v253, v253
    ds_read_u16_d16_hi v252, v252
    v_mad_u32_u16 v210, v209, 2, s85
    v_mfma_f32_16x16x32_f16 v[184:187], a[232:235], v[140:143], v[184:187]
    s_waitcnt lgkmcnt(13)
    ds_read_u16 v208, v208
    v_or_b32 v238, v226, v225
    v_mad_u32_u16 v209, v209, 2, s85 op_sel:[1,0,0,0]
    v_mfma_f32_16x16x32_f16 v[192:195], a[216:219], v[152:155], 0
    s_waitcnt lgkmcnt(13)
    ds_read_u16_d16_hi v0, v0
    v_pk_lshrrev_b16 v211, 3, v211 op_sel_hi:[0,1]
    v_mad_u32_u16 v212, v211, 2, s85
    v_mfma_f32_16x16x32_f16 v[200:203], a[216:219], v[156:159], 0
    s_waitcnt lgkmcnt(13)
    ds_read_u16 v210, v210
    v_mad_u32_u16 v211, v211, 2, s85 op_sel:[1,0,0,0]
    v_pk_fma_f16 v213, v215, v215, s53
    v_mfma_f32_16x16x32_f16 v[180:183], a[236:239], v[136:139], v[180:183]
    s_waitcnt lgkmcnt(12)
    ds_read_u16_d16_hi v209, v209
    ds_read_u16 v212, v212
    v_pk_mul_f16 v213, v213, v215 neg_lo:[1,0] neg_hi:[1,0]
    v_mfma_f32_16x16x32_f16 v[188:191], a[236:239], v[140:143], v[188:191]
    v_exp_f16 v214, v213
    v_mfma_f32_16x16x32_f16 v[196:199], a[220:223], v[152:155], 0
    s_waitcnt lgkmcnt(13)
    ds_read_u16_d16_hi v211, v211
    v_exp_f16_sdwa v214, v213 dst_sel:WORD_1 dst_unused:UNUSED_PRESERVE src0_sel:WORD_1
    v_mfma_f32_16x16x32_f16 v[204:207], a[220:223], v[156:159], 0
    v_pk_fma_f16 v214, v214, s86, s86
    v_rcp_f16 v213, v214
    v_mfma_f32_16x16x32_f16 v[176:179], a[240:243], v[144:147], v[176:179]
    s_waitcnt lgkmcnt(13)
    v_rcp_f16_sdwa v213, v214 dst_sel:WORD_1 dst_unused:UNUSED_PRESERVE src0_sel:WORD_1
    v_or_b32 v240, v231, v230
    v_mfma_f32_16x16x32_f16 v[184:187], a[240:243], v[148:151], v[184:187]
    v_fma_mix_f32 v214, v213, v215, 0 op_sel_hi:[1,1,0]
    v_fma_mix_f32 v213, v213, v215, 0 op_sel:[1,1,0] op_sel_hi:[1,1,0]
    v_cvt_pk_bf16_f32 v247, v214, v213
    v_mfma_f32_16x16x32_f16 v[192:195], a[232:235], v[160:163], v[192:195]
    s_add_u32 m0, s56, 11456
    v_cvt_pkrtz_f16_f32 v216, v176, v177
    v_pk_lshrrev_b16 v216, 3, v216 op_sel_hi:[0,1]
    v_mad_u32_u16 v217, v216, 2, s85
    v_mfma_f32_16x16x32_f16 v[200:203], a[232:235], v[164:167], v[200:203]
    buffer_load_dwordx4 v6, s[20:23], 0 offen offset:64 lds
    ds_read_b128 a[232:235], v23 offset:28672
    v_mfma_f32_16x16x32_f16 v[180:183], a[244:247], v[144:147], v[180:183]
    s_waitcnt lgkmcnt(11)
    ds_read_u16 v217, v217
    v_or_b32 v241, v249, v248
    v_mad_u32_u16 v216, v216, 2, s85 op_sel:[1,0,0,0]
    v_mfma_f32_16x16x32_f16 v[188:191], a[244:247], v[148:151], v[188:191]
    ds_read_u16_d16_hi v216, v216
    v_cvt_pkrtz_f16_f32 v218, v178, v179
    v_pk_lshrrev_b16 v218, 3, v218 op_sel_hi:[0,1]
    v_mfma_f32_16x16x32_f16 v[196:199], a[236:239], v[160:163], v[196:199]
    s_waitcnt lgkmcnt(11)
    v_or_b32 v242, v251, v250
    v_mad_u32_u16 v219, v218, 2, s85
    v_mad_u32_u16 v218, v218, 2, s85 op_sel:[1,0,0,0]
    v_mfma_f32_16x16x32_f16 v[204:207], a[236:239], v[164:167], v[204:207]
    ds_read_b128 a[236:239], v23 offset:29696
    ds_read_u16 v219, v219
    v_cvt_pkrtz_f16_f32 v220, v180, v181
    v_mfma_f32_16x16x32_f16 v[192:195], a[240:243], v[168:171], v[192:195]
    ds_read_u16_d16_hi v218, v218
    v_pk_lshrrev_b16 v220, 3, v220 op_sel_hi:[0,1]
    v_mad_u32_u16 v221, v220, 2, s85
    v_mfma_f32_16x16x32_f16 v[200:203], a[240:243], v[172:175], v[200:203]
    s_waitcnt lgkmcnt(12)
    ds_read_b128 a[240:243], v23 offset:20480
    ds_read_u16 v221, v221
    v_or_b32 v243, v253, v252
    v_mfma_f32_16x16x32_f16 v[196:199], a[244:247], v[168:171], v[196:199]
    v_mad_u32_u16 v220, v220, 2, s85 op_sel:[1,0,0,0]
    v_cvt_pkrtz_f16_f32 v222, v182, v183
    v_pk_lshrrev_b16 v222, 3, v222 op_sel_hi:[0,1]
    v_mfma_f32_16x16x32_f16 v[204:207], a[244:247], v[172:175], v[204:207]
    s_waitcnt lgkmcnt(12)
    ds_read_b128 a[244:247], v23 offset:21504
    v_mad_u32_u16 v223, v222, 2, s85
    v_or_b32 v244, v208, v0
    v_mfma_f32_16x16x32_bf16 v[32:35], a[248:251], v[232:235], v[32:35]
    ds_read_u16_d16_hi v220, v220
    v_mad_u32_u16 v222, v222, 2, s85 op_sel:[1,0,0,0]
    v_cvt_pkrtz_f16_f32 v224, v184, v185
    v_mfma_f32_16x16x32_bf16 v[40:43], a[248:251], v[236:239], v[40:43]
    s_waitcnt lgkmcnt(13)
    ds_read_u16 v223, v223
    v_pk_lshrrev_b16 v224, 3, v224 op_sel_hi:[0,1]
    v_mad_u32_u16 v225, v224, 2, s85
    v_mfma_f32_16x16x32_bf16 v[36:39], a[252:255], v[232:235], v[36:39]
    s_waitcnt lgkmcnt(13)
    v_mad_u32_u16 v224, v224, 2, s85 op_sel:[1,0,0,0]
    v_cvt_pkrtz_f16_f32 v226, v186, v187
    v_or_b32 v245, v210, v209
    v_mfma_f32_16x16x32_bf16 v[44:47], a[252:255], v[236:239], v[44:47]
    ds_read_u16_d16_hi v222, v222
    v_pk_lshrrev_b16 v226, 3, v226 op_sel_hi:[0,1]
    v_mad_u32_u16 v227, v226, 2, s85
    v_mad_u32_u16 v226, v226, 2, s85 op_sel:[1,0,0,0]
    v_cvt_pkrtz_f16_f32 v230, v188, v189
    v_cvt_pkrtz_f16_f32 v249, v190, v191
    v_pk_fma_f16 v228, v230, v230, s53
    v_pk_fma_f16 v231, v249, v249, s53
    v_pk_mul_f16 v228, v228, v230 neg_lo:[1,0] neg_hi:[1,0]
    v_pk_mul_f16 v231, v231, v249 neg_lo:[1,0] neg_hi:[1,0]
    v_exp_f16 v229, v228
    s_waitcnt lgkmcnt(12)
    v_or_b32 v246, v212, v211
    v_exp_f16 v248, v231
    s_waitcnt lgkmcnt(11)
    v_mfma_f32_16x16x32_bf16 v[48:51], a[232:235], v[232:235], v[48:51]
    ds_read_u16 v225, v225
    ds_read_u16_d16_hi v224, v224
    v_exp_f16_sdwa v229, v228 dst_sel:WORD_1 dst_unused:UNUSED_PRESERVE src0_sel:WORD_1
    v_mfma_f32_16x16x32_bf16 v[56:59], a[232:235], v[236:239], v[56:59]
    s_waitcnt lgkmcnt(12)
    ds_read_u16 v227, v227
    ds_read_u16_d16_hi v226, v226
    v_exp_f16_sdwa v248, v231 dst_sel:WORD_1 dst_unused:UNUSED_PRESERVE src0_sel:WORD_1
    v_mfma_f32_16x16x32_bf16 v[80:83], a[248:251], v[240:243], v[80:83]
    v_pk_fma_f16 v229, v229, s86, s86
    v_pk_fma_f16 v248, v248, s86, s86
    v_rcp_f16 v228, v229
    v_mfma_f32_16x16x32_bf16 v[88:91], a[248:251], v[244:247], v[88:91]
    s_waitcnt lgkmcnt(12)
    ds_read_b128 a[248:251], v24 offset:0
    v_rcp_f16 v231, v248
    v_mfma_f32_16x16x32_bf16 v[52:55], a[236:239], v[232:235], v[52:55]
    v_rcp_f16_sdwa v228, v229 dst_sel:WORD_1 dst_unused:UNUSED_PRESERVE src0_sel:WORD_1
    v_rcp_f16_sdwa v231, v248 dst_sel:WORD_1 dst_unused:UNUSED_PRESERVE src0_sel:WORD_1
    v_mfma_f32_16x16x32_bf16 v[60:63], a[236:239], v[236:239], v[60:63]
    v_fma_mix_f32 v229, v228, v230, 0 op_sel_hi:[1,1,0]
    v_fma_mix_f32 v248, v231, v249, 0 op_sel_hi:[1,1,0]
    v_fma_mix_f32 v228, v228, v230, 0 op_sel:[1,1,0] op_sel_hi:[1,1,0]
    v_mfma_f32_16x16x32_bf16 v[84:87], a[252:255], v[240:243], v[84:87]
    v_fma_mix_f32 v231, v231, v249, 0 op_sel:[1,1,0] op_sel_hi:[1,1,0]
    v_cvt_pkrtz_f16_f32 v250, v192, v193
    v_pk_lshrrev_b16 v250, 3, v250 op_sel_hi:[0,1]
    v_mfma_f32_16x16x32_bf16 v[92:95], a[252:255], v[244:247], v[92:95]
    s_waitcnt lgkmcnt(10)
    ds_read_b128 a[252:255], v24 offset:1024
    v_cvt_pkrtz_f16_f32 v252, v194, v195
    v_cvt_pkrtz_f16_f32 v0, v196, v197
    v_mfma_f32_16x16x32_bf16 v[64:67], a[240:243], v[232:235], v[64:67]
    v_cvt_pkrtz_f16_f32 v209, v198, v199
    v_cvt_pkrtz_f16_f32 v211, v200, v201
    v_cvt_pkrtz_f16_f32 v213, v202, v203
    v_mfma_f32_16x16x32_bf16 v[72:75], a[240:243], v[236:239], v[72:75]
    v_mad_u32_u16 v251, v250, 2, s85
    v_mad_u32_u16 v250, v250, 2, s85 op_sel:[1,0,0,0]
    v_pk_lshrrev_b16 v252, 3, v252 op_sel_hi:[0,1]
    v_mfma_f32_16x16x32_bf16 v[96:99], a[232:235], v[240:243], v[96:99]
    ds_read_u16 v251, v251
    ds_read_u16_d16_hi v250, v250
    v_mad_u32_u16 v253, v252, 2, s85
    v_mfma_f32_16x16x32_bf16 v[104:107], a[232:235], v[244:247], v[104:107]
    s_waitcnt lgkmcnt(11)
    ds_read_b128 a[232:235], v24 offset:2048
    ds_read_u16 v253, v253
    v_mad_u32_u16 v252, v252, 2, s85 op_sel:[1,0,0,0]
    v_mfma_f32_16x16x32_bf16 v[68:71], a[244:247], v[232:235], v[68:71]
    ds_read_u16_d16_hi v252, v252
    v_or_b32 v232, v217, v216
    v_or_b32 v233, v219, v218
    v_mfma_f32_16x16x32_bf16 v[76:79], a[244:247], v[236:239], v[76:79]
    s_waitcnt lgkmcnt(11)
    v_or_b32 v234, v221, v220
    v_or_b32 v235, v223, v222
    v_cvt_pk_bf16_f32 v238, v229, v228
    v_mfma_f32_16x16x32_bf16 v[100:103], a[236:239], v[240:243], v[100:103]
    v_cvt_pk_bf16_f32 v239, v248, v231
    v_cvt_pkrtz_f16_f32 v217, v204, v205
    v_cvt_pkrtz_f16_f32 v220, v206, v207
    v_mfma_f32_16x16x32_bf16 v[108:111], a[236:239], v[244:247], v[108:111]
    ds_read_b128 a[236:239], v24 offset:3072
    v_pk_lshrrev_b16 v0, 3, v0 op_sel_hi:[0,1]
    v_mad_u32_u16 v208, v0, 2, s85
    v_mfma_f32_16x16x32_bf16 v[112:115], a[240:243], v[240:243], v[112:115]
    s_waitcnt lgkmcnt(10)
    ds_read_u16 v208, v208
    v_or_b32 v236, v225, v224
    v_mad_u32_u16 v0, v0, 2, s85 op_sel:[1,0,0,0]
    v_mfma_f32_16x16x32_bf16 v[120:123], a[240:243], v[244:247], v[120:123]
    ds_read_b128 a[240:243], v24 offset:4096
    ds_read_u16_d16_hi v0, v0
    v_pk_lshrrev_b16 v209, 3, v209 op_sel_hi:[0,1]
    v_mfma_f32_16x16x32_bf16 v[116:119], a[244:247], v[240:243], v[116:119]
    v_mad_u32_u16 v210, v209, 2, s85
    v_mad_u32_u16 v209, v209, 2, s85 op_sel:[1,0,0,0]
    v_pk_lshrrev_b16 v211, 3, v211 op_sel_hi:[0,1]
    v_mfma_f32_16x16x32_bf16 v[124:127], a[244:247], v[244:247], v[124:127]
    s_waitcnt lgkmcnt(10)
    ds_read_b128 a[244:247], v24 offset:5120
    ds_read_u16 v210, v210
    v_or_b32 v237, v227, v226
    v_mfma_f32_16x16x32_f16 v[176:179], a[248:251], v[128:131], 0
    ds_read_u16_d16_hi v209, v209
    v_mad_u32_u16 v212, v211, 2, s85
    v_mad_u32_u16 v211, v211, 2, s85 op_sel:[1,0,0,0]
    v_mfma_f32_16x16x32_f16 v[184:187], a[248:251], v[132:135], 0
    s_waitcnt lgkmcnt(12)
    ds_read_u16 v212, v212
    ds_read_u16_d16_hi v211, v211
    v_pk_lshrrev_b16 v213, 3, v213 op_sel_hi:[0,1]
    v_mfma_f32_16x16x32_f16 v[180:183], a[252:255], v[128:131], 0
    v_mad_u32_u16 v214, v213, 2, s85
    v_mad_u32_u16 v213, v213, 2, s85 op_sel:[1,0,0,0]
    v_pk_fma_f16 v215, v217, v217, s53
    v_mfma_f32_16x16x32_f16 v[188:191], a[252:255], v[132:135], 0
    s_waitcnt lgkmcnt(12)
    ds_read_u16 v214, v214
    ds_read_u16_d16_hi v213, v213
    v_pk_fma_f16 v218, v220, v220, s53
    v_pk_mul_f16 v215, v215, v217 neg_lo:[1,0] neg_hi:[1,0]
    v_pk_mul_f16 v218, v218, v220 neg_lo:[1,0] neg_hi:[1,0]
    s_waitcnt lgkmcnt(13)
    v_mfma_f32_16x16x32_f16 v[176:179], a[232:235], v[136:139], v[176:179]
    v_exp_f16 v216, v215
    v_exp_f16 v219, v218
    v_mfma_f32_16x16x32_f16 v[184:187], a[232:235], v[140:143], v[184:187]
    s_add_u32 m0, s56, 12480
    v_exp_f16_sdwa v216, v215 dst_sel:WORD_1 dst_unused:UNUSED_PRESERVE src0_sel:WORD_1
    v_exp_f16_sdwa v219, v218 dst_sel:WORD_1 dst_unused:UNUSED_PRESERVE src0_sel:WORD_1
    v_mfma_f32_16x16x32_f16 v[192:195], a[248:251], v[152:155], 0
    buffer_load_dword v7, s[20:23], 0 offen offset:64 lds
    v_mfma_f32_16x16x32_f16 v[200:203], a[248:251], v[156:159], 0
    s_waitcnt lgkmcnt(10)
    ds_read_b128 a[248:251], v23 offset:36864
    v_pk_fma_f16 v216, v216, s86, s86
    v_pk_fma_f16 v219, v219, s86, s86
    v_mfma_f32_16x16x32_f16 v[180:183], a[236:239], v[136:139], v[180:183]
    v_rcp_f16 v215, v216
    v_rcp_f16 v218, v219
    v_mfma_f32_16x16x32_f16 v[188:191], a[236:239], v[140:143], v[188:191]
    v_rcp_f16_sdwa v215, v216 dst_sel:WORD_1 dst_unused:UNUSED_PRESERVE src0_sel:WORD_1
    v_rcp_f16_sdwa v218, v219 dst_sel:WORD_1 dst_unused:UNUSED_PRESERVE src0_sel:WORD_1
    v_mfma_f32_16x16x32_f16 v[196:199], a[252:255], v[152:155], 0
    v_fma_mix_f32 v216, v215, v217, 0 op_sel_hi:[1,1,0]
    v_fma_mix_f32 v219, v218, v220, 0 op_sel_hi:[1,1,0]
    v_fma_mix_f32 v215, v215, v217, 0 op_sel:[1,1,0] op_sel_hi:[1,1,0]
    v_mfma_f32_16x16x32_f16 v[204:207], a[252:255], v[156:159], 0
    s_waitcnt lgkmcnt(9)
    ds_read_b128 a[252:255], v23 offset:37888
    v_fma_mix_f32 v218, v218, v220, 0 op_sel:[1,1,0] op_sel_hi:[1,1,0]
    v_or_b32 v240, v251, v250
    v_mfma_f32_16x16x32_f16 v[176:179], a[240:243], v[144:147], v[176:179]
    s_waitcnt lgkmcnt(9)
    v_or_b32 v241, v253, v252
    v_or_b32 v242, v208, v0
    v_cvt_pk_bf16_f32 v246, v216, v215
    v_mfma_f32_16x16x32_f16 v[184:187], a[240:243], v[148:151], v[184:187]
    v_cvt_pk_bf16_f32 v247, v219, v218
    v_mfma_f32_16x16x32_f16 v[192:195], a[232:235], v[160:163], v[192:195]
    s_waitcnt lgkmcnt(6)
    v_or_b32 v243, v210, v209
    v_mfma_f32_16x16x32_f16 v[200:203], a[232:235], v[164:167], v[200:203]
    ds_read_b128 a[232:235], v23 offset:38912
    v_cvt_pkrtz_f16_f32 v221, v176, v177
    v_pk_lshrrev_b16 v221, 3, v221 op_sel_hi:[0,1]
    v_mfma_f32_16x16x32_f16 v[180:183], a[244:247], v[144:147], v[180:183]
    s_add_u32 m0, s56, 0
    v_mad_u32_u16 v222, v221, 2, s85
    v_mad_u32_u16 v221, v221, 2, s85 op_sel:[1,0,0,0]
    v_cvt_pkrtz_f16_f32 v223, v178, v179
    v_mfma_f32_16x16x32_f16 v[188:191], a[244:247], v[148:151], v[188:191]
    buffer_load_dwordx4 v1, s[20:23], 0 offen offset:0 lds
    ds_read_u16 v222, v222
    v_mfma_f32_16x16x32_f16 v[196:199], a[236:239], v[160:163], v[196:199]
    s_waitcnt lgkmcnt(6)
    ds_read_u16_d16_hi v221, v221
    v_or_b32 v244, v212, v211
    v_pk_lshrrev_b16 v223, 3, v223 op_sel_hi:[0,1]
    v_mfma_f32_16x16x32_f16 v[204:207], a[236:239], v[164:167], v[204:207]
    ds_read_b128 a[236:239], v23 offset:39936
    v_mad_u32_u16 v224, v223, 2, s85
    v_mad_u32_u16 v223, v223, 2, s85 op_sel:[1,0,0,0]
    v_mfma_f32_16x16x32_f16 v[192:195], a[240:243], v[168:171], v[192:195]
    s_waitcnt lgkmcnt(6)
    ds_read_u16 v224, v224
    ds_read_u16_d16_hi v223, v223
    v_or_b32 v245, v214, v213
    v_mfma_f32_16x16x32_f16 v[200:203], a[240:243], v[172:175], v[200:203]
    ds_read_b128 a[240:243], v23 offset:30720
    v_cvt_pkrtz_f16_f32 v225, v180, v181
    v_pk_lshrrev_b16 v225, 3, v225 op_sel_hi:[0,1]
    v_mfma_f32_16x16x32_f16 v[196:199], a[244:247], v[168:171], v[196:199]
    v_mad_u32_u16 v226, v225, 2, s85
    v_mad_u32_u16 v225, v225, 2, s85 op_sel:[1,0,0,0]
    v_cvt_pkrtz_f16_f32 v227, v182, v183
    v_mfma_f32_16x16x32_f16 v[204:207], a[244:247], v[172:175], v[204:207]
    s_waitcnt lgkmcnt(8)
    ds_read_b128 a[244:247], v23 offset:31744
    ds_read_u16 v226, v226
    v_pk_lshrrev_b16 v227, 3, v227 op_sel_hi:[0,1]
    v_mfma_f32_16x16x32_bf16 v[32:35], a[248:251], v[232:235], v[32:35]
    ds_read_u16_d16_hi v225, v225
    v_mad_u32_u16 v228, v227, 2, s85
    v_mad_u32_u16 v227, v227, 2, s85 op_sel:[1,0,0,0]
    v_mfma_f32_16x16x32_bf16 v[40:43], a[248:251], v[236:239], v[40:43]
    s_waitcnt lgkmcnt(10)
    ds_read_u16 v228, v228
    ds_read_u16_d16_hi v227, v227
    v_cvt_pkrtz_f16_f32 v229, v184, v185
    v_mfma_f32_16x16x32_bf16 v[36:39], a[252:255], v[232:235], v[36:39]
    v_pk_lshrrev_b16 v229, 3, v229 op_sel_hi:[0,1]
    v_mad_u32_u16 v230, v229, 2, s85
    v_mad_u32_u16 v229, v229, 2, s85 op_sel:[1,0,0,0]
    v_mfma_f32_16x16x32_bf16 v[44:47], a[252:255], v[236:239], v[44:47]
    s_waitcnt lgkmcnt(11)
    ds_read_u16 v230, v230
    ds_read_u16_d16_hi v229, v229
    v_cvt_pkrtz_f16_f32 v231, v186, v187
    v_mfma_f32_16x16x32_bf16 v[48:51], a[232:235], v[232:235], v[48:51]
    v_pk_lshrrev_b16 v231, 3, v231 op_sel_hi:[0,1]
    v_mad_u32_u16 v248, v231, 2, s85
    v_mad_u32_u16 v231, v231, 2, s85 op_sel:[1,0,0,0]
    v_mfma_f32_16x16x32_bf16 v[56:59], a[232:235], v[236:239], v[56:59]
    s_waitcnt lgkmcnt(12)
    ds_read_u16 v248, v248
    ds_read_u16_d16_hi v231, v231
    v_cvt_pkrtz_f16_f32 v249, v188, v189
    v_mfma_f32_16x16x32_bf16 v[80:83], a[248:251], v[240:243], v[80:83]
    v_pk_lshrrev_b16 v249, 3, v249 op_sel_hi:[0,1]
    v_mad_u32_u16 v250, v249, 2, s85
    v_mad_u32_u16 v249, v249, 2, s85 op_sel:[1,0,0,0]
    v_mfma_f32_16x16x32_bf16 v[88:91], a[248:251], v[244:247], v[88:91]
    s_waitcnt lgkmcnt(12)
    ds_read_u16 v250, v250
    ds_read_u16_d16_hi v249, v249
    v_cvt_pkrtz_f16_f32 v253, v190, v191
    v_mfma_f32_16x16x32_bf16 v[52:55], a[236:239], v[232:235], v[52:55]
    s_waitcnt lgkmcnt(13)
    ds_read_b128 a[248:251], v24 offset:12288
    v_pk_fma_f16 v251, v253, v253, s53
    v_pk_mul_f16 v251, v251, v253 neg_lo:[1,0] neg_hi:[1,0]
    v_mfma_f32_16x16x32_bf16 v[60:63], a[236:239], v[236:239], v[60:63]
    v_exp_f16 v252, v251
    v_cvt_pkrtz_f16_f32 v0, v192, v193
    v_mfma_f32_16x16x32_bf16 v[84:87], a[252:255], v[240:243], v[84:87]
    v_exp_f16_sdwa v252, v251 dst_sel:WORD_1 dst_unused:UNUSED_PRESERVE src0_sel:WORD_1
    v_pk_lshrrev_b16 v0, 3, v0 op_sel_hi:[0,1]
    v_mfma_f32_16x16x32_bf16 v[92:95], a[252:255], v[244:247], v[92:95]
    s_waitcnt lgkmcnt(12)
    ds_read_b128 a[252:255], v24 offset:13312
    v_pk_fma_f16 v252, v252, s86, s86
    v_rcp_f16 v251, v252
    v_mfma_f32_16x16x32_bf16 v[64:67], a[240:243], v[232:235], v[64:67]
    v_rcp_f16_sdwa v251, v252 dst_sel:WORD_1 dst_unused:UNUSED_PRESERVE src0_sel:WORD_1
    v_cvt_pkrtz_f16_f32 v209, v194, v195
    v_mfma_f32_16x16x32_bf16 v[72:75], a[240:243], v[236:239], v[72:75]
    s_add_u32 m0, s56, 1024
    v_fma_mix_f32 v252, v251, v253, 0 op_sel_hi:[1,1,0]
    v_fma_mix_f32 v251, v251, v253, 0 op_sel:[1,1,0] op_sel_hi:[1,1,0]
    v_cvt_pkrtz_f16_f32 v211, v196, v197
    v_mfma_f32_16x16x32_bf16 v[96:99], a[232:235], v[240:243], v[96:99]
    buffer_load_dwordx4 v2, s[20:23], 0 offen offset:0 lds
    v_mfma_f32_16x16x32_bf16 v[104:107], a[232:235], v[244:247], v[104:107]
    s_waitcnt lgkmcnt(12)
    ds_read_b128 a[232:235], v24 offset:14336
    v_cvt_pkrtz_f16_f32 v213, v198, v199
    v_cvt_pkrtz_f16_f32 v215, v200, v201
    v_mfma_f32_16x16x32_bf16 v[68:71], a[244:247], v[232:235], v[68:71]
    s_waitcnt lgkmcnt(11)
    v_or_b32 v232, v222, v221
    v_or_b32 v233, v224, v223
    v_or_b32 v234, v226, v225
    v_mfma_f32_16x16x32_bf16 v[76:79], a[244:247], v[236:239], v[76:79]
    s_waitcnt lgkmcnt(7)
    v_or_b32 v235, v228, v227
    v_or_b32 v236, v230, v229
    v_cvt_pk_bf16_f32 v239, v252, v251
    v_mfma_f32_16x16x32_bf16 v[100:103], a[236:239], v[240:243], v[100:103]
    s_waitcnt lgkmcnt(5)
    v_or_b32 v237, v248, v231
    v_cvt_pkrtz_f16_f32 v217, v202, v203
    v_cvt_pkrtz_f16_f32 v219, v204, v205
    v_mfma_f32_16x16x32_bf16 v[108:111], a[236:239], v[244:247], v[108:111]
    ds_read_b128 a[236:239], v24 offset:15360
    v_cvt_pkrtz_f16_f32 v223, v206, v207
    v_mad_u32_u16 v208, v0, 2, s85
    v_mfma_f32_16x16x32_bf16 v[112:115], a[240:243], v[240:243], v[112:115]
    ds_read_u16 v208, v208
    v_mad_u32_u16 v0, v0, 2, s85 op_sel:[1,0,0,0]
    v_pk_lshrrev_b16 v209, 3, v209 op_sel_hi:[0,1]
    v_mfma_f32_16x16x32_bf16 v[120:123], a[240:243], v[244:247], v[120:123]
    s_waitcnt lgkmcnt(5)
    ds_read_b128 a[240:243], v24 offset:16384
    ds_read_u16_d16_hi v0, v0
    v_or_b32 v238, v250, v249
    v_mfma_f32_16x16x32_bf16 v[116:119], a[244:247], v[240:243], v[116:119]
    v_mad_u32_u16 v210, v209, 2, s85
    v_mad_u32_u16 v209, v209, 2, s85 op_sel:[1,0,0,0]
    v_pk_lshrrev_b16 v211, 3, v211 op_sel_hi:[0,1]
    v_mfma_f32_16x16x32_bf16 v[124:127], a[244:247], v[244:247], v[124:127]
    s_waitcnt lgkmcnt(6)
    ds_read_b128 a[244:247], v24 offset:17408
    ds_read_u16 v210, v210
    v_mad_u32_u16 v212, v211, 2, s85
    v_mfma_f32_16x16x32_f16 v[176:179], a[248:251], v[128:131], 0
    ds_read_u16_d16_hi v209, v209
    ds_read_u16 v212, v212
    v_mad_u32_u16 v211, v211, 2, s85 op_sel:[1,0,0,0]
    v_mfma_f32_16x16x32_f16 v[184:187], a[248:251], v[132:135], 0
    s_waitcnt lgkmcnt(9)
    ds_read_u16_d16_hi v211, v211
    v_pk_lshrrev_b16 v213, 3, v213 op_sel_hi:[0,1]
    v_mad_u32_u16 v214, v213, 2, s85
    v_mfma_f32_16x16x32_f16 v[180:183], a[252:255], v[128:131], 0
    ds_read_u16 v214, v214
    v_mad_u32_u16 v213, v213, 2, s85 op_sel:[1,0,0,0]
    v_pk_lshrrev_b16 v215, 3, v215 op_sel_hi:[0,1]
    v_mfma_f32_16x16x32_f16 v[188:191], a[252:255], v[132:135], 0
    s_waitcnt lgkmcnt(10)
    ds_read_u16_d16_hi v213, v213
    v_mad_u32_u16 v216, v215, 2, s85
    v_mad_u32_u16 v215, v215, 2, s85 op_sel:[1,0,0,0]
    v_mfma_f32_16x16x32_f16 v[176:179], a[232:235], v[136:139], v[176:179]
    ds_read_u16 v216, v216
    ds_read_u16_d16_hi v215, v215
    v_pk_lshrrev_b16 v217, 3, v217 op_sel_hi:[0,1]
    v_mfma_f32_16x16x32_f16 v[184:187], a[232:235], v[140:143], v[184:187]
    v_mad_u32_u16 v218, v217, 2, s85
    v_mad_u32_u16 v217, v217, 2, s85 op_sel:[1,0,0,0]
    v_pk_lshrrev_b16 v219, 3, v219 op_sel_hi:[0,1]
    v_mfma_f32_16x16x32_f16 v[192:195], a[248:251], v[152:155], 0
    s_waitcnt lgkmcnt(12)
    ds_read_u16 v218, v218
    ds_read_u16_d16_hi v217, v217
    v_mad_u32_u16 v220, v219, 2, s85
    v_mfma_f32_16x16x32_f16 v[200:203], a[248:251], v[156:159], 0
    s_waitcnt lgkmcnt(12)
    ds_read_u16 v220, v220
    ds_read_b128 a[248:251], v24 offset:6144
    v_mad_u32_u16 v219, v219, 2, s85 op_sel:[1,0,0,0]
    v_mfma_f32_16x16x32_f16 v[180:183], a[236:239], v[136:139], v[180:183]
    s_waitcnt lgkmcnt(13)
    ds_read_u16_d16_hi v219, v219
    v_pk_fma_f16 v221, v223, v223, s53
    v_pk_mul_f16 v221, v221, v223 neg_lo:[1,0] neg_hi:[1,0]
    v_mfma_f32_16x16x32_f16 v[188:191], a[236:239], v[140:143], v[188:191]
    v_exp_f16 v222, v221
    v_or_b32 v240, v208, v0
    v_mfma_f32_16x16x32_f16 v[196:199], a[252:255], v[152:155], 0
    s_waitcnt lgkmcnt(11)
    v_exp_f16_sdwa v222, v221 dst_sel:WORD_1 dst_unused:UNUSED_PRESERVE src0_sel:WORD_1
    v_or_b32 v241, v210, v209
    v_mfma_f32_16x16x32_f16 v[204:207], a[252:255], v[156:159], 0
    s_add_u32 m0, s56, 2048
    ds_read_b128 a[252:255], v24 offset:7168
    buffer_load_dwordx4 v3, s[20:23], 0 offen offset:0 lds
    v_mfma_f32_16x16x32_f16 v[176:179], a[240:243], v[144:147], v[176:179]
    v_pk_fma_f16 v222, v222, s86, s86
    v_rcp_f16 v221, v222
    v_mfma_f32_16x16x32_f16 v[184:187], a[240:243], v[148:151], v[184:187]
    s_waitcnt lgkmcnt(10)
    v_rcp_f16_sdwa v221, v222 dst_sel:WORD_1 dst_unused:UNUSED_PRESERVE src0_sel:WORD_1
    v_or_b32 v242, v212, v211
    v_mfma_f32_16x16x32_f16 v[192:195], a[232:235], v[160:163], v[192:195]
    s_waitcnt lgkmcnt(8)
    v_fma_mix_f32 v222, v221, v223, 0 op_sel_hi:[1,1,0]
    v_fma_mix_f32 v221, v221, v223, 0 op_sel:[1,1,0] op_sel_hi:[1,1,0]
    v_or_b32 v243, v214, v213
    v_mfma_f32_16x16x32_f16 v[200:203], a[232:235], v[164:167], v[200:203]
    ds_read_b128 a[232:235], v24 offset:8192
    v_cvt_pk_bf16_f32 v247, v222, v221
    v_cvt_pkrtz_f16_f32 v224, v176, v177
    v_mfma_f32_16x16x32_f16 v[180:183], a[244:247], v[144:147], v[180:183]
    s_waitcnt lgkmcnt(7)
    v_or_b32 v244, v216, v215
    v_pk_lshrrev_b16 v224, 3, v224 op_sel_hi:[0,1]
    v_mad_u32_u16 v225, v224, 2, s85
    v_mfma_f32_16x16x32_f16 v[188:191], a[244:247], v[148:151], v[188:191]
    ds_read_u16 v225, v225
    v_mad_u32_u16 v224, v224, 2, s85 op_sel:[1,0,0,0]
    v_cvt_pkrtz_f16_f32 v226, v178, v179
    v_mfma_f32_16x16x32_f16 v[196:199], a[236:239], v[160:163], v[196:199]
    ds_read_u16_d16_hi v224, v224
    v_pk_lshrrev_b16 v226, 3, v226 op_sel_hi:[0,1]
    v_mad_u32_u16 v227, v226, 2, s85
    v_mfma_f32_16x16x32_f16 v[204:207], a[236:239], v[164:167], v[204:207]
    s_waitcnt lgkmcnt(7)
    ds_read_b128 a[236:239], v24 offset:9216
    ds_read_u16 v227, v227
    v_or_b32 v245, v218, v217
    v_mfma_f32_16x16x32_f16 v[192:195], a[240:243], v[168:171], v[192:195]
    v_mad_u32_u16 v226, v226, 2, s85 op_sel:[1,0,0,0]
    v_cvt_pkrtz_f16_f32 v228, v180, v181
    v_pk_lshrrev_b16 v228, 3, v228 op_sel_hi:[0,1]
    v_mfma_f32_16x16x32_f16 v[200:203], a[240:243], v[172:175], v[200:203]
    ds_read_b128 a[240:243], v24 offset:10240
    ds_read_u16_d16_hi v226, v226
    v_mad_u32_u16 v229, v228, 2, s85
    v_mfma_f32_16x16x32_f16 v[196:199], a[244:247], v[168:171], v[196:199]
    s_waitcnt lgkmcnt(8)
    ds_read_u16 v229, v229
    v_mad_u32_u16 v228, v228, 2, s85 op_sel:[1,0,0,0]
    v_or_b32 v246, v220, v219
    v_mfma_f32_16x16x32_f16 v[204:207], a[244:247], v[172:175], v[204:207]
    ds_read_b128 a[244:247], v24 offset:11264
    ds_read_u16_d16_hi v228, v228
    v_cvt_pkrtz_f16_f32 v230, v182, v183
    v_mfma_f32_16x16x32_bf16 v[32:35], a[248:251], v[232:235], v[32:35]
    v_pk_lshrrev_b16 v230, 3, v230 op_sel_hi:[0,1]
    v_mad_u32_u16 v231, v230, 2, s85
    v_mad_u32_u16 v230, v230, 2, s85 op_sel:[1,0,0,0]
    v_mfma_f32_16x16x32_bf16 v[40:43], a[248:251], v[236:239], v[40:43]
    s_waitcnt lgkmcnt(10)
    ds_read_u16 v231, v231
    ds_read_u16_d16_hi v230, v230
    v_cvt_pkrtz_f16_f32 v248, v184, v185
    v_mfma_f32_16x16x32_bf16 v[36:39], a[252:255], v[232:235], v[36:39]
    v_pk_lshrrev_b16 v248, 3, v248 op_sel_hi:[0,1]
    v_mad_u32_u16 v249, v248, 2, s85
    v_mad_u32_u16 v248, v248, 2, s85 op_sel:[1,0,0,0]
    v_mfma_f32_16x16x32_bf16 v[44:47], a[252:255], v[236:239], v[44:47]
    s_waitcnt lgkmcnt(11)
    ds_read_u16 v249, v249
    ds_read_u16_d16_hi v248, v248
    v_cvt_pkrtz_f16_f32 v250, v186, v187
    v_mfma_f32_16x16x32_bf16 v[48:51], a[232:235], v[232:235], v[48:51]
    v_pk_lshrrev_b16 v250, 3, v250 op_sel_hi:[0,1]
    v_mad_u32_u16 v251, v250, 2, s85
    v_mad_u32_u16 v250, v250, 2, s85 op_sel:[1,0,0,0]
    v_mfma_f32_16x16x32_bf16 v[56:59], a[232:235], v[236:239], v[56:59]
    s_waitcnt lgkmcnt(12)
    ds_read_u16 v251, v251
    ds_read_u16_d16_hi v250, v250
    v_cvt_pkrtz_f16_f32 v0, v188, v189
    v_mfma_f32_16x16x32_bf16 v[80:83], a[248:251], v[240:243], v[80:83]
    v_cvt_pkrtz_f16_f32 v210, v190, v191
    v_pk_fma_f16 v252, v0, v0, s53
    v_pk_fma_f16 v208, v210, v210, s53
    v_mfma_f32_16x16x32_bf16 v[88:91], a[248:251], v[244:247], v[88:91]
    s_waitcnt lgkmcnt(12)
    ds_read_b128 a[248:251], v24 offset:24576
    v_pk_mul_f16 v252, v252, v0 neg_lo:[1,0] neg_hi:[1,0]
    v_pk_mul_f16 v208, v208, v210 neg_lo:[1,0] neg_hi:[1,0]
    v_mfma_f32_16x16x32_bf16 v[52:55], a[236:239], v[232:235], v[52:55]
    v_exp_f16 v253, v252
    v_exp_f16 v209, v208
    v_mfma_f32_16x16x32_bf16 v[60:63], a[236:239], v[236:239], v[60:63]
    v_exp_f16_sdwa v253, v252 dst_sel:WORD_1 dst_unused:UNUSED_PRESERVE src0_sel:WORD_1
    v_exp_f16_sdwa v209, v208 dst_sel:WORD_1 dst_unused:UNUSED_PRESERVE src0_sel:WORD_1
    v_mfma_f32_16x16x32_bf16 v[84:87], a[252:255], v[240:243], v[84:87]
    v_pk_fma_f16 v253, v253, s86, s86
    v_pk_fma_f16 v209, v209, s86, s86
    v_rcp_f16 v252, v253
    v_mfma_f32_16x16x32_bf16 v[92:95], a[252:255], v[244:247], v[92:95]
    s_waitcnt lgkmcnt(11)
    ds_read_b128 a[252:255], v24 offset:25600
    v_rcp_f16 v208, v209
    v_mfma_f32_16x16x32_bf16 v[64:67], a[240:243], v[232:235], v[64:67]
    v_rcp_f16_sdwa v252, v253 dst_sel:WORD_1 dst_unused:UNUSED_PRESERVE src0_sel:WORD_1
    v_rcp_f16_sdwa v208, v209 dst_sel:WORD_1 dst_unused:UNUSED_PRESERVE src0_sel:WORD_1
    v_mfma_f32_16x16x32_bf16 v[72:75], a[240:243], v[236:239], v[72:75]
    v_fma_mix_f32 v253, v252, v0, 0 op_sel_hi:[1,1,0]
    v_fma_mix_f32 v209, v208, v210, 0 op_sel_hi:[1,1,0]
    v_fma_mix_f32 v252, v252, v0, 0 op_sel:[1,1,0] op_sel_hi:[1,1,0]
    v_mfma_f32_16x16x32_bf16 v[96:99], a[232:235], v[240:243], v[96:99]
    v_fma_mix_f32 v208, v208, v210, 0 op_sel:[1,1,0] op_sel_hi:[1,1,0]
    v_cvt_pkrtz_f16_f32 v211, v192, v193
    v_pk_lshrrev_b16 v211, 3, v211 op_sel_hi:[0,1]
    v_mfma_f32_16x16x32_bf16 v[104:107], a[232:235], v[244:247], v[104:107]
    s_waitcnt lgkmcnt(9)
    ds_read_b128 a[232:235], v24 offset:26624
    v_cvt_pkrtz_f16_f32 v213, v194, v195
    v_cvt_pkrtz_f16_f32 v215, v196, v197
    v_mfma_f32_16x16x32_bf16 v[68:71], a[244:247], v[232:235], v[68:71]
    s_waitcnt lgkmcnt(9)
    v_or_b32 v232, v225, v224
    v_or_b32 v233, v227, v226
    v_or_b32 v234, v229, v228
    v_mfma_f32_16x16x32_bf16 v[76:79], a[244:247], v[236:239], v[76:79]
    s_waitcnt lgkmcnt(5)
    v_or_b32 v235, v231, v230
    v_or_b32 v236, v249, v248
    v_cvt_pk_bf16_f32 v238, v253, v252
    v_mfma_f32_16x16x32_bf16 v[100:103], a[236:239], v[240:243], v[100:103]
    v_cvt_pk_bf16_f32 v239, v209, v208
    v_cvt_pkrtz_f16_f32 v217, v198, v199
    v_cvt_pkrtz_f16_f32 v219, v200, v201
    v_mfma_f32_16x16x32_bf16 v[108:111], a[236:239], v[244:247], v[108:111]
    s_waitcnt lgkmcnt(3)
    ds_read_b128 a[236:239], v24 offset:27648
    v_or_b32 v237, v251, v250
    v_cvt_pkrtz_f16_f32 v221, v202, v203
    v_mfma_f32_16x16x32_bf16 v[112:115], a[240:243], v[240:243], v[112:115]
    s_add_u32 m0, s56, 3072
    v_cvt_pkrtz_f16_f32 v223, v204, v205
    v_cvt_pkrtz_f16_f32 v225, v206, v207
    v_mad_u32_u16 v212, v211, 2, s85
    v_mfma_f32_16x16x32_bf16 v[120:123], a[240:243], v[244:247], v[120:123]
    buffer_load_dwordx4 v4, s[20:23], 0 offen offset:0 lds
    ds_read_b128 a[240:243], v24 offset:28672
    v_mfma_f32_16x16x32_bf16 v[116:119], a[244:247], v[240:243], v[116:119]
    ds_read_u16 v212, v212
    v_mad_u32_u16 v211, v211, 2, s85 op_sel:[1,0,0,0]
    v_pk_lshrrev_b16 v213, 3, v213 op_sel_hi:[0,1]
    v_mfma_f32_16x16x32_bf16 v[124:127], a[244:247], v[244:247], v[124:127]
    s_waitcnt lgkmcnt(5)
    ds_read_b128 a[244:247], v24 offset:29696
    ds_read_u16_d16_hi v211, v211
    v_mad_u32_u16 v214, v213, 2, s85
    v_mfma_f32_16x16x32_f16 v[176:179], a[248:251], v[128:131], 0
    ds_read_u16 v214, v214
    v_mad_u32_u16 v213, v213, 2, s85 op_sel:[1,0,0,0]
    v_pk_lshrrev_b16 v215, 3, v215 op_sel_hi:[0,1]
    v_mfma_f32_16x16x32_f16 v[184:187], a[248:251], v[132:135], 0
    s_waitcnt lgkmcnt(7)
    ds_read_u16_d16_hi v213, v213
    v_mad_u32_u16 v216, v215, 2, s85
    v_mad_u32_u16 v215, v215, 2, s85 op_sel:[1,0,0,0]
    v_mfma_f32_16x16x32_f16 v[180:183], a[252:255], v[128:131], 0
    ds_read_u16 v216, v216
    ds_read_u16_d16_hi v215, v215
    v_pk_lshrrev_b16 v217, 3, v217 op_sel_hi:[0,1]
    v_mfma_f32_16x16x32_f16 v[188:191], a[252:255], v[132:135], 0
    s_waitcnt lgkmcnt(9)
    v_mad_u32_u16 v218, v217, 2, s85
    v_mad_u32_u16 v217, v217, 2, s85 op_sel:[1,0,0,0]
    v_pk_lshrrev_b16 v219, 3, v219 op_sel_hi:[0,1]
    v_mfma_f32_16x16x32_f16 v[176:179], a[232:235], v[136:139], v[176:179]
    ds_read_u16 v218, v218
    ds_read_u16_d16_hi v217, v217
    v_mad_u32_u16 v220, v219, 2, s85
    v_mfma_f32_16x16x32_f16 v[184:187], a[232:235], v[140:143], v[184:187]
    ds_read_u16 v220, v220
    v_mad_u32_u16 v219, v219, 2, s85 op_sel:[1,0,0,0]
    v_pk_lshrrev_b16 v221, 3, v221 op_sel_hi:[0,1]
    v_mfma_f32_16x16x32_f16 v[192:195], a[248:251], v[152:155], 0
    s_add_u32 m0, s56, 4096
    ds_read_u16_d16_hi v219, v219
    buffer_load_dwordx4 v5, s[20:23], 0 offen offset:0 lds
    v_mfma_f32_16x16x32_f16 v[200:203], a[248:251], v[156:159], 0
    s_waitcnt lgkmcnt(12)
    ds_read_b128 a[248:251], v24 offset:18432
    v_mad_u32_u16 v222, v221, 2, s85
    v_mad_u32_u16 v221, v221, 2, s85 op_sel:[1,0,0,0]
    v_mfma_f32_16x16x32_f16 v[180:183], a[236:239], v[136:139], v[180:183]
    s_waitcnt lgkmcnt(12)
    ds_read_u16 v222, v222
    ds_read_u16_d16_hi v221, v221
    v_pk_lshrrev_b16 v223, 3, v223 op_sel_hi:[0,1]
    v_mfma_f32_16x16x32_f16 v[188:191], a[236:239], v[140:143], v[188:191]
    v_mad_u32_u16 v224, v223, 2, s85
    v_mad_u32_u16 v223, v223, 2, s85 op_sel:[1,0,0,0]
    v_pk_lshrrev_b16 v225, 3, v225 op_sel_hi:[0,1]
    v_mfma_f32_16x16x32_f16 v[196:199], a[252:255], v[152:155], 0
    s_waitcnt lgkmcnt(12)
    ds_read_u16 v224, v224
    ds_read_u16_d16_hi v223, v223
    v_mad_u32_u16 v226, v225, 2, s85
    v_mfma_f32_16x16x32_f16 v[204:207], a[252:255], v[156:159], 0
    s_waitcnt lgkmcnt(12)
    ds_read_u16 v226, v226
    ds_read_b128 a[252:255], v24 offset:19456
    v_mad_u32_u16 v225, v225, 2, s85 op_sel:[1,0,0,0]
    v_mfma_f32_16x16x32_f16 v[176:179], a[240:243], v[144:147], v[176:179]
    s_waitcnt lgkmcnt(13)
    ds_read_u16_d16_hi v225, v225
    v_or_b32 v240, v212, v211
    v_or_b32 v241, v214, v213
    v_mfma_f32_16x16x32_f16 v[184:187], a[240:243], v[148:151], v[184:187]
    s_waitcnt lgkmcnt(10)
    v_or_b32 v242, v216, v215
    v_or_b32 v243, v218, v217
    v_and_b32 v254, 0x70, v23
    v_mfma_f32_16x16x32_f16 v[192:195], a[232:235], v[160:163], v[192:195]
    v_cvt_pkrtz_f16_f32 v227, v176, v177
    v_pk_lshrrev_b16 v227, 3, v227 op_sel_hi:[0,1]
    v_mad_u32_u16 v228, v227, 2, s85
    v_mfma_f32_16x16x32_f16 v[200:203], a[232:235], v[164:167], v[200:203]
    s_waitcnt lgkmcnt(8)
    ds_read_b128 a[232:235], v24 offset:20480
    ds_read_u16 v228, v228
    v_or_b32 v244, v220, v219
    v_mfma_f32_16x16x32_f16 v[180:183], a[244:247], v[144:147], v[180:183]
    v_mad_u32_u16 v227, v227, 2, s85 op_sel:[1,0,0,0]
    v_cvt_pkrtz_f16_f32 v229, v178, v179
    v_pk_lshrrev_b16 v229, 3, v229 op_sel_hi:[0,1]
    v_mfma_f32_16x16x32_f16 v[188:191], a[244:247], v[148:151], v[188:191]
    ds_read_u16_d16_hi v227, v227
    v_mad_u32_u16 v230, v229, 2, s85
    v_mad_u32_u16 v229, v229, 2, s85 op_sel:[1,0,0,0]
    v_mfma_f32_16x16x32_f16 v[196:199], a[236:239], v[160:163], v[196:199]
    ds_read_u16 v230, v230
    ds_read_u16_d16_hi v229, v229
    v_cvt_pkrtz_f16_f32 v231, v180, v181
    v_mfma_f32_16x16x32_f16 v[204:207], a[236:239], v[164:167], v[204:207]
    s_waitcnt lgkmcnt(10)
    ds_read_b128 a[236:239], v24 offset:21504
    v_or_b32 v245, v222, v221
    v_pk_lshrrev_b16 v231, 3, v231 op_sel_hi:[0,1]
    v_mfma_f32_16x16x32_f16 v[192:195], a[240:243], v[168:171], v[192:195]
    v_mad_u32_u16 v248, v231, 2, s85
    v_mad_u32_u16 v231, v231, 2, s85 op_sel:[1,0,0,0]
    v_cvt_pkrtz_f16_f32 v249, v182, v183
    v_mfma_f32_16x16x32_f16 v[200:203], a[240:243], v[172:175], v[200:203]
    ds_read_b128 a[240:243], v24 offset:22528
    ds_read_u16 v248, v248
    v_pk_lshrrev_b16 v249, 3, v249 op_sel_hi:[0,1]
    v_mfma_f32_16x16x32_f16 v[196:199], a[244:247], v[168:171], v[196:199]
    s_waitcnt lgkmcnt(11)
    ds_read_u16_d16_hi v231, v231
    v_or_b32 v246, v224, v223
    v_mad_u32_u16 v250, v249, 2, s85
    v_mfma_f32_16x16x32_f16 v[204:207], a[244:247], v[172:175], v[204:207]
    s_waitcnt lgkmcnt(11)
    ds_read_b128 a[244:247], v24 offset:23552
    ds_read_u16 v250, v250
    v_mad_u32_u16 v249, v249, 2, s85 op_sel:[1,0,0,0]
    v_mfma_f32_16x16x32_bf16 v[32:35], a[248:251], v[232:235], v[32:35]
    s_add_u32 m0, s56, 5120
    ds_read_u16_d16_hi v249, v249
    buffer_load_dwordx4 v6, s[20:23], 0 offen offset:0 lds
    v_mfma_f32_16x16x32_bf16 v[40:43], a[248:251], v[236:239], v[40:43]
    s_waitcnt lgkmcnt(12)
    v_cvt_pkrtz_f16_f32 v251, v184, v185
    v_pk_lshrrev_b16 v251, 3, v251 op_sel_hi:[0,1]
    v_or_b32 v247, v226, v225
    v_mfma_f32_16x16x32_bf16 v[36:39], a[252:255], v[232:235], v[36:39]
    v_mad_u32_u16 v252, v251, 2, s85
    v_mad_u32_u16 v251, v251, 2, s85 op_sel:[1,0,0,0]
    v_cvt_pkrtz_f16_f32 v253, v186, v187
    v_mfma_f32_16x16x32_bf16 v[44:47], a[252:255], v[236:239], v[44:47]
    s_waitcnt lgkmcnt(11)
    ds_read_u16 v252, v252
    ds_read_u16_d16_hi v251, v251
    v_pk_lshrrev_b16 v253, 3, v253 op_sel_hi:[0,1]
    v_mfma_f32_16x16x32_bf16 v[48:51], a[232:235], v[232:235], v[48:51]
    v_mad_u32_u16 v0, v253, 2, s85
    v_mad_u32_u16 v253, v253, 2, s85 op_sel:[1,0,0,0]
    v_cvt_pkrtz_f16_f32 v210, v188, v189
    v_mfma_f32_16x16x32_bf16 v[56:59], a[232:235], v[236:239], v[56:59]
    s_waitcnt lgkmcnt(12)
    ds_read_u16 v0, v0
    ds_read_u16_d16_hi v253, v253
    v_cvt_pkrtz_f16_f32 v213, v190, v191
    v_mfma_f32_16x16x32_bf16 v[80:83], a[248:251], v[240:243], v[80:83]
    v_mad_u64_u32 v[254:255], vcc, v254, 8, s[94:95]
    v_pk_fma_f16 v208, v210, v210, s53
    v_pk_fma_f16 v211, v213, v213, s53
    v_mfma_f32_16x16x32_bf16 v[88:91], a[248:251], v[244:247], v[88:91]
    s_waitcnt lgkmcnt(13)
    global_load_dword v254, v[254:255], off
    ds_read_b128 a[248:251], v24 offset:36864
    v_pk_mul_f16 v208, v208, v210 neg_lo:[1,0] neg_hi:[1,0]
    v_pk_mul_f16 v211, v211, v213 neg_lo:[1,0] neg_hi:[1,0]
    v_exp_f16 v209, v208
    v_exp_f16 v212, v211
    v_exp_f16_sdwa v209, v208 dst_sel:WORD_1 dst_unused:UNUSED_PRESERVE src0_sel:WORD_1
    s_waitcnt lgkmcnt(11)
    v_mfma_f32_16x16x32_bf16 v[52:55], a[236:239], v[232:235], v[52:55]
    v_exp_f16_sdwa v212, v211 dst_sel:WORD_1 dst_unused:UNUSED_PRESERVE src0_sel:WORD_1
    v_pk_fma_f16 v209, v209, s86, s86
    v_mfma_f32_16x16x32_bf16 v[60:63], a[236:239], v[236:239], v[60:63]
    v_pk_fma_f16 v212, v212, s86, s86
    v_rcp_f16 v208, v209
    v_mfma_f32_16x16x32_bf16 v[84:87], a[252:255], v[240:243], v[84:87]
    v_rcp_f16 v211, v212
    v_rcp_f16_sdwa v208, v209 dst_sel:WORD_1 dst_unused:UNUSED_PRESERVE src0_sel:WORD_1
    v_mfma_f32_16x16x32_bf16 v[92:95], a[252:255], v[244:247], v[92:95]
    s_waitcnt lgkmcnt(10)
    ds_read_b128 a[252:255], v24 offset:37888
    v_rcp_f16_sdwa v211, v212 dst_sel:WORD_1 dst_unused:UNUSED_PRESERVE src0_sel:WORD_1
    v_mfma_f32_16x16x32_bf16 v[64:67], a[240:243], v[232:235], v[64:67]
    v_fma_mix_f32 v209, v208, v210, 0 op_sel_hi:[1,1,0]
    v_fma_mix_f32 v212, v211, v213, 0 op_sel_hi:[1,1,0]
    v_fma_mix_f32 v208, v208, v210, 0 op_sel:[1,1,0] op_sel_hi:[1,1,0]
    v_mfma_f32_16x16x32_bf16 v[72:75], a[240:243], v[236:239], v[72:75]
    v_fma_mix_f32 v211, v211, v213, 0 op_sel:[1,1,0] op_sel_hi:[1,1,0]
    v_cvt_pkrtz_f16_f32 v214, v192, v193
    v_pk_lshrrev_b16 v214, 3, v214 op_sel_hi:[0,1]
    v_mfma_f32_16x16x32_bf16 v[96:99], a[232:235], v[240:243], v[96:99]
    v_cvt_pkrtz_f16_f32 v216, v194, v195
    v_cvt_pkrtz_f16_f32 v218, v196, v197
    v_cvt_pkrtz_f16_f32 v220, v198, v199
    v_mfma_f32_16x16x32_bf16 v[104:107], a[232:235], v[244:247], v[104:107]
    s_waitcnt lgkmcnt(8)
    ds_read_b128 a[232:235], v24 offset:38912
    v_cvt_pkrtz_f16_f32 v222, v200, v201
    v_cvt_pkrtz_f16_f32 v224, v202, v203
    v_mfma_f32_16x16x32_bf16 v[68:71], a[244:247], v[232:235], v[68:71]
    v_or_b32 v232, v228, v227
    v_or_b32 v233, v230, v229
    v_or_b32 v234, v248, v231
    v_mfma_f32_16x16x32_bf16 v[76:79], a[244:247], v[236:239], v[76:79]
    s_waitcnt lgkmcnt(7)
    v_or_b32 v235, v250, v249
    v_cvt_pk_bf16_f32 v238, v209, v208
    v_cvt_pk_bf16_f32 v239, v212, v211
    v_mfma_f32_16x16x32_bf16 v[100:103], a[236:239], v[240:243], v[100:103]
    s_waitcnt lgkmcnt(5)
    v_or_b32 v236, v252, v251
    v_cvt_pkrtz_f16_f32 v226, v204, v205
    v_cvt_pkrtz_f16_f32 v230, v206, v207
    v_mfma_f32_16x16x32_bf16 v[108:111], a[236:239], v[244:247], v[108:111]
    ds_read_b128 a[236:239], v24 offset:39936
    v_mad_u32_u16 v215, v214, 2, s85
    v_mad_u32_u16 v214, v214, 2, s85 op_sel:[1,0,0,0]
    v_mfma_f32_16x16x32_bf16 v[112:115], a[240:243], v[240:243], v[112:115]
    s_waitcnt lgkmcnt(4)
    ds_read_u16 v215, v215
    ds_read_u16_d16_hi v214, v214
    v_or_b32 v237, v0, v253
    v_mfma_f32_16x16x32_bf16 v[120:123], a[240:243], v[244:247], v[120:123]
    ds_read_b128 a[240:243], v24 offset:40960
    v_pk_lshrrev_b16 v216, 3, v216 op_sel_hi:[0,1]
    v_mad_u32_u16 v217, v216, 2, s85
    v_mfma_f32_16x16x32_bf16 v[116:119], a[244:247], v[240:243], v[116:119]
    ds_read_u16 v217, v217
    v_mad_u32_u16 v216, v216, 2, s85 op_sel:[1,0,0,0]
    v_pk_lshrrev_b16 v218, 3, v218 op_sel_hi:[0,1]
    v_mfma_f32_16x16x32_bf16 v[124:127], a[244:247], v[244:247], v[124:127]
    s_waitcnt lgkmcnt(7)
    ds_read_b128 a[244:247], v24 offset:41984
    ds_read_u16_d16_hi v216, v216
    v_mad_u32_u16 v219, v218, 2, s85
    v_mfma_f32_16x16x32_f16 v[176:179], a[248:251], v[128:131], 0
    ds_read_u16 v219, v219
    v_mad_u32_u16 v218, v218, 2, s85 op_sel:[1,0,0,0]
    v_pk_lshrrev_b16 v220, 3, v220 op_sel_hi:[0,1]
    v_mfma_f32_16x16x32_f16 v[184:187], a[248:251], v[132:135], 0
    s_waitcnt lgkmcnt(9)
    ds_read_u16_d16_hi v218, v218
    v_mad_u32_u16 v221, v220, 2, s85
    v_mad_u32_u16 v220, v220, 2, s85 op_sel:[1,0,0,0]
    v_mfma_f32_16x16x32_f16 v[180:183], a[252:255], v[128:131], 0
    ds_read_u16 v221, v221
    ds_read_u16_d16_hi v220, v220
    v_pk_lshrrev_b16 v222, 3, v222 op_sel_hi:[0,1]
    v_mfma_f32_16x16x32_f16 v[188:191], a[252:255], v[132:135], 0
    s_waitcnt lgkmcnt(11)
    v_mad_u32_u16 v223, v222, 2, s85
    v_mad_u32_u16 v222, v222, 2, s85 op_sel:[1,0,0,0]
    v_pk_lshrrev_b16 v224, 3, v224 op_sel_hi:[0,1]
    v_mfma_f32_16x16x32_f16 v[176:179], a[232:235], v[136:139], v[176:179]
    ds_read_u16 v223, v223
    ds_read_u16_d16_hi v222, v222
    v_mad_u32_u16 v225, v224, 2, s85
    v_mfma_f32_16x16x32_f16 v[184:187], a[232:235], v[140:143], v[184:187]
    ds_read_u16 v225, v225
    v_mad_u32_u16 v224, v224, 2, s85 op_sel:[1,0,0,0]
    v_pk_lshrrev_b16 v226, 3, v226 op_sel_hi:[0,1]
    v_mfma_f32_16x16x32_f16 v[192:195], a[248:251], v[152:155], 0
    s_waitcnt lgkmcnt(13)
    ds_read_u16_d16_hi v224, v224
    v_mad_u32_u16 v227, v226, 2, s85
    v_mad_u32_u16 v226, v226, 2, s85 op_sel:[1,0,0,0]
    v_mfma_f32_16x16x32_f16 v[200:203], a[248:251], v[156:159], 0
    s_waitcnt lgkmcnt(12)
    ds_read_u16 v227, v227
    ds_read_u16_d16_hi v226, v226
    v_pk_fma_f16 v228, v230, v230, s53
    v_mfma_f32_16x16x32_f16 v[180:183], a[236:239], v[136:139], v[180:183]
    s_waitcnt lgkmcnt(13)
    ds_read_b128 a[248:251], v24 offset:30720
    v_pk_mul_f16 v228, v228, v230 neg_lo:[1,0] neg_hi:[1,0]
    v_exp_f16 v229, v228
    v_mfma_f32_16x16x32_f16 v[188:191], a[236:239], v[140:143], v[188:191]
    v_exp_f16_sdwa v229, v228 dst_sel:WORD_1 dst_unused:UNUSED_PRESERVE src0_sel:WORD_1
    v_or_b32 v240, v215, v214
    v_mfma_f32_16x16x32_f16 v[196:199], a[252:255], v[152:155], 0
    v_pk_fma_f16 v229, v229, s86, s86
    v_rcp_f16 v228, v229
    v_mfma_f32_16x16x32_f16 v[204:207], a[252:255], v[156:159], 0
    s_waitcnt lgkmcnt(13)
    ds_read_b128 a[252:255], v24 offset:31744
    v_rcp_f16_sdwa v228, v229 dst_sel:WORD_1 dst_unused:UNUSED_PRESERVE src0_sel:WORD_1
    v_mfma_f32_16x16x32_f16 v[176:179], a[240:243], v[144:147], v[176:179]
    s_waitcnt lgkmcnt(8)
    v_fma_mix_f32 v229, v228, v230, 0 op_sel_hi:[1,1,0]
    v_fma_mix_f32 v228, v228, v230, 0 op_sel:[1,1,0] op_sel_hi:[1,1,0]
    v_or_b32 v241, v217, v216
    v_mfma_f32_16x16x32_f16 v[184:187], a[240:243], v[148:151], v[184:187]
    s_add_u32 m0, s56, 6144
    v_or_b32 v242, v219, v218
    v_or_b32 v243, v221, v220
    v_cvt_pk_bf16_f32 v247, v229, v228
    v_mfma_f32_16x16x32_f16 v[192:195], a[232:235], v[160:163], v[192:195]
    buffer_load_dword v7, s[20:23], 0 offen offset:0 lds
    v_mfma_f32_16x16x32_f16 v[200:203], a[232:235], v[164:167], v[200:203]
    ds_read_b128 a[232:235], v24 offset:32768
    v_cvt_pkrtz_f16_f32 v231, v176, v177
    v_pk_lshrrev_b16 v231, 3, v231 op_sel_hi:[0,1]
    v_mfma_f32_16x16x32_f16 v[180:183], a[244:247], v[144:147], v[180:183]
    s_waitcnt lgkmcnt(7)
    v_or_b32 v244, v223, v222
    v_mad_u32_u16 v248, v231, 2, s85
    v_mad_u32_u16 v231, v231, 2, s85 op_sel:[1,0,0,0]
    v_mfma_f32_16x16x32_f16 v[188:191], a[244:247], v[148:151], v[188:191]
    ds_read_u16 v248, v248
    ds_read_u16_d16_hi v231, v231
    v_cvt_pkrtz_f16_f32 v249, v178, v179
    v_mfma_f32_16x16x32_f16 v[196:199], a[236:239], v[160:163], v[196:199]
    s_waitcnt lgkmcnt(7)
    v_pk_lshrrev_b16 v249, 3, v249 op_sel_hi:[0,1]
    v_mad_u32_u16 v250, v249, 2, s85
    v_or_b32 v245, v225, v224
    v_mfma_f32_16x16x32_f16 v[204:207], a[236:239], v[164:167], v[204:207]
    ds_read_b128 a[236:239], v24 offset:33792
    ds_read_u16 v250, v250
    v_mad_u32_u16 v249, v249, 2, s85 op_sel:[1,0,0,0]
    v_mfma_f32_16x16x32_f16 v[192:195], a[240:243], v[168:171], v[192:195]
    ds_read_u16_d16_hi v249, v249
    v_cvt_pkrtz_f16_f32 v251, v180, v181
    v_pk_lshrrev_b16 v251, 3, v251 op_sel_hi:[0,1]
    v_mfma_f32_16x16x32_f16 v[200:203], a[240:243], v[172:175], v[200:203]
    s_waitcnt lgkmcnt(8)
    ds_read_b128 a[240:243], v24 offset:34816
    v_mad_u32_u16 v252, v251, 2, s85
    v_or_b32 v246, v227, v226
    v_mfma_f32_16x16x32_f16 v[196:199], a[244:247], v[168:171], v[196:199]
    ds_read_u16 v252, v252
    v_mad_u32_u16 v251, v251, 2, s85 op_sel:[1,0,0,0]
    v_cvt_pkrtz_f16_f32 v253, v182, v183
    v_mfma_f32_16x16x32_f16 v[204:207], a[244:247], v[172:175], v[204:207]
    s_waitcnt lgkmcnt(9)
    ds_read_b128 a[244:247], v24 offset:35840
    ds_read_u16_d16_hi v251, v251
    v_pk_lshrrev_b16 v253, 3, v253 op_sel_hi:[0,1]
    v_mfma_f32_16x16x32_bf16 v[32:35], a[248:251], v[232:235], v[32:35]
    v_mad_u32_u16 v0, v253, 2, s85
    v_mad_u32_u16 v253, v253, 2, s85 op_sel:[1,0,0,0]
    v_cvt_pkrtz_f16_f32 v208, v184, v185
    v_mfma_f32_16x16x32_bf16 v[40:43], a[248:251], v[236:239], v[40:43]
    s_waitcnt lgkmcnt(10)
    ds_read_u16 v0, v0
    ds_read_u16_d16_hi v253, v253
    v_pk_lshrrev_b16 v208, 3, v208 op_sel_hi:[0,1]
    v_mfma_f32_16x16x32_bf16 v[36:39], a[252:255], v[232:235], v[36:39]
    v_mad_u32_u16 v209, v208, 2, s85
    v_mad_u32_u16 v208, v208, 2, s85 op_sel:[1,0,0,0]
    v_cvt_pkrtz_f16_f32 v210, v186, v187
    v_mfma_f32_16x16x32_bf16 v[44:47], a[252:255], v[236:239], v[44:47]
    s_waitcnt lgkmcnt(11)
    ds_read_u16 v209, v209
    ds_read_u16_d16_hi v208, v208
    v_pk_lshrrev_b16 v210, 3, v210 op_sel_hi:[0,1]
    v_mfma_f32_16x16x32_bf16 v[48:51], a[232:235], v[232:235], v[48:51]
    buffer_load_dword v254, v31, s[20:23], 0 offen
    v_mad_u32_u16 v211, v210, 2, s85
    v_mad_u32_u16 v210, v210, 2, s85 op_sel:[1,0,0,0]
    v_mfma_f32_16x16x32_bf16 v[56:59], a[232:235], v[236:239], v[56:59]
    s_waitcnt lgkmcnt(12)
    ds_read_u16 v211, v211
    ds_read_u16_d16_hi v210, v210
    v_cvt_pkrtz_f16_f32 v212, v188, v189
    v_mfma_f32_16x16x32_bf16 v[80:83], a[248:251], v[240:243], v[80:83]
    v_pk_lshrrev_b16 v212, 3, v212 op_sel_hi:[0,1]
    v_mad_u32_u16 v213, v212, 2, s85
    v_mad_u32_u16 v212, v212, 2, s85 op_sel:[1,0,0,0]
    v_mfma_f32_16x16x32_bf16 v[88:91], a[248:251], v[244:247], v[88:91]
    s_waitcnt lgkmcnt(12)
    ds_read_u16 v213, v213
    ds_read_u16_d16_hi v212, v212
    v_cvt_pkrtz_f16_f32 v216, v190, v191
    v_mfma_f32_16x16x32_bf16 v[52:55], a[236:239], v[232:235], v[52:55]
    s_waitcnt lgkmcnt(13)
    ds_read_b128 a[248:251], v24 offset:43008
    v_pk_fma_f16 v214, v216, v216, s53
    v_pk_mul_f16 v214, v214, v216 neg_lo:[1,0] neg_hi:[1,0]
    v_mfma_f32_16x16x32_bf16 v[60:63], a[236:239], v[236:239], v[60:63]
    v_exp_f16 v215, v214
    v_cvt_pkrtz_f16_f32 v217, v192, v193
    v_mfma_f32_16x16x32_bf16 v[84:87], a[252:255], v[240:243], v[84:87]
    v_exp_f16_sdwa v215, v214 dst_sel:WORD_1 dst_unused:UNUSED_PRESERVE src0_sel:WORD_1
    v_pk_lshrrev_b16 v217, 3, v217 op_sel_hi:[0,1]
    v_mfma_f32_16x16x32_bf16 v[92:95], a[252:255], v[244:247], v[92:95]
    s_waitcnt lgkmcnt(12)
    ds_read_b128 a[252:255], v24 offset:44032
    v_pk_fma_f16 v215, v215, s86, s86
    v_rcp_f16 v214, v215
    v_mfma_f32_16x16x32_bf16 v[64:67], a[240:243], v[232:235], v[64:67]
    v_rcp_f16_sdwa v214, v215 dst_sel:WORD_1 dst_unused:UNUSED_PRESERVE src0_sel:WORD_1
    v_cvt_pkrtz_f16_f32 v219, v194, v195
    v_mfma_f32_16x16x32_bf16 v[72:75], a[240:243], v[236:239], v[72:75]
    v_fma_mix_f32 v215, v214, v216, 0 op_sel_hi:[1,1,0]
    v_fma_mix_f32 v214, v214, v216, 0 op_sel:[1,1,0] op_sel_hi:[1,1,0]
    v_cvt_pkrtz_f16_f32 v221, v196, v197
    v_mfma_f32_16x16x32_bf16 v[96:99], a[232:235], v[240:243], v[96:99]
    v_cvt_pkrtz_f16_f32 v223, v198, v199
    v_cvt_pkrtz_f16_f32 v225, v200, v201
    v_cvt_pkrtz_f16_f32 v227, v202, v203
    v_mfma_f32_16x16x32_bf16 v[104:107], a[232:235], v[244:247], v[104:107]
    s_waitcnt lgkmcnt(11)
    ds_read_b128 a[232:235], v24 offset:45056
    v_cvt_pkrtz_f16_f32 v229, v204, v205
    v_mad_u32_u16 v218, v217, 2, s85
    v_mfma_f32_16x16x32_bf16 v[68:71], a[244:247], v[232:235], v[68:71]
    ds_read_u16 v218, v218
    v_or_b32 v232, v248, v231
    v_or_b32 v233, v250, v249
    v_mfma_f32_16x16x32_bf16 v[76:79], a[244:247], v[236:239], v[76:79]
    s_waitcnt lgkmcnt(8)
    v_or_b32 v234, v252, v251
    v_or_b32 v235, v0, v253
    v_or_b32 v236, v209, v208
    v_mfma_f32_16x16x32_bf16 v[100:103], a[236:239], v[240:243], v[100:103]
    v_cvt_pk_bf16_f32 v239, v215, v214
    v_cvt_pkrtz_f16_f32 v249, v206, v207
    v_mad_u32_u16 v217, v217, 2, s85 op_sel:[1,0,0,0]
    v_mfma_f32_16x16x32_bf16 v[108:111], a[236:239], v[244:247], v[108:111]
    s_waitcnt lgkmcnt(6)
    ds_read_b128 a[236:239], v24 offset:46080
    ds_read_u16_d16_hi v217, v217
    v_or_b32 v237, v211, v210
    v_mfma_f32_16x16x32_bf16 v[112:115], a[240:243], v[240:243], v[112:115]
    v_pk_lshrrev_b16 v219, 3, v219 op_sel_hi:[0,1]
    v_mad_u32_u16 v220, v219, 2, s85
    v_mad_u32_u16 v219, v219, 2, s85 op_sel:[1,0,0,0]
    v_mfma_f32_16x16x32_bf16 v[120:123], a[240:243], v[244:247], v[120:123]
    ds_read_b128 a[240:243], v24 offset:47104
    ds_read_u16 v220, v220
    v_pk_lshrrev_b16 v221, 3, v221 op_sel_hi:[0,1]
    v_mfma_f32_16x16x32_bf16 v[116:119], a[244:247], v[240:243], v[116:119]
    s_waitcnt lgkmcnt(8)
    ds_read_u16_d16_hi v219, v219
    v_or_b32 v238, v213, v212
    v_mad_u32_u16 v222, v221, 2, s85
    v_mfma_f32_16x16x32_bf16 v[124:127], a[244:247], v[244:247], v[124:127]
    s_waitcnt lgkmcnt(8)
    ds_read_b128 a[244:247], v24 offset:48128
    ds_read_u16 v222, v222
    v_mad_u32_u16 v221, v221, 2, s85 op_sel:[1,0,0,0]
    v_mfma_f32_16x16x32_bf16 v[32:35], a[248:251], v[232:235], v[32:35]
    ds_read_u16_d16_hi v221, v221
    v_pk_lshrrev_b16 v223, 3, v223 op_sel_hi:[0,1]
    v_mad_u32_u16 v224, v223, 2, s85
    v_mfma_f32_16x16x32_f16 v[176:179], a[0:3], v[128:131], 0
    s_waitcnt lgkmcnt(10)
    ds_read_u16 v224, v224
    v_mad_u32_u16 v223, v223, 2, s85 op_sel:[1,0,0,0]
    v_pk_lshrrev_b16 v225, 3, v225 op_sel_hi:[0,1]
    v_mfma_f32_16x16x32_bf16 v[36:39], a[252:255], v[232:235], v[36:39]
    ds_read_u16_d16_hi v223, v223
    v_mad_u32_u16 v226, v225, 2, s85
    v_mad_u32_u16 v225, v225, 2, s85 op_sel:[1,0,0,0]
    v_mfma_f32_16x16x32_f16 v[180:183], a[4:7], v[128:131], 0
    s_waitcnt lgkmcnt(11)
    ds_read_u16 v226, v226
    ds_read_u16_d16_hi v225, v225
    v_pk_lshrrev_b16 v227, 3, v227 op_sel_hi:[0,1]
    v_mfma_f32_16x16x32_bf16 v[48:51], a[232:235], v[232:235], v[48:51]
    v_mad_u32_u16 v228, v227, 2, s85
    v_mad_u32_u16 v227, v227, 2, s85 op_sel:[1,0,0,0]
    v_pk_lshrrev_b16 v229, 3, v229 op_sel_hi:[0,1]
    v_mfma_f32_16x16x32_f16 v[176:179], a[8:11], v[136:139], v[176:179]
    s_waitcnt lgkmcnt(11)
    ds_read_u16 v228, v228
    ds_read_u16_d16_hi v227, v227
    v_mad_u32_u16 v230, v229, 2, s85
    v_mfma_f32_16x16x32_bf16 v[52:55], a[236:239], v[232:235], v[52:55]
    ds_read_u16 v230, v230
    v_mad_u32_u16 v229, v229, 2, s85 op_sel:[1,0,0,0]
    v_pk_fma_f16 v231, v249, v249, s53
    v_mfma_f32_16x16x32_f16 v[180:183], a[12:15], v[136:139], v[180:183]
    s_waitcnt lgkmcnt(12)
    ds_read_u16_d16_hi v229, v229
    v_pk_mul_f16 v231, v231, v249 neg_lo:[1,0] neg_hi:[1,0]
    v_exp_f16 v248, v231
    v_mfma_f32_16x16x32_bf16 v[64:67], a[240:243], v[232:235], v[64:67]
    v_exp_f16_sdwa v248, v231 dst_sel:WORD_1 dst_unused:UNUSED_PRESERVE src0_sel:WORD_1
    v_or_b32 v240, v218, v217
    v_mfma_f32_16x16x32_f16 v[176:179], a[16:19], v[144:147], v[176:179]
    s_waitcnt lgkmcnt(10)
    v_pk_fma_f16 v248, v248, s86, s86
    v_rcp_f16 v231, v248
    v_mfma_f32_16x16x32_bf16 v[68:71], a[244:247], v[232:235], v[68:71]
    v_rcp_f16_sdwa v231, v248 dst_sel:WORD_1 dst_unused:UNUSED_PRESERVE src0_sel:WORD_1
    v_or_b32 v241, v220, v219
    v_mfma_f32_16x16x32_f16 v[180:183], a[20:23], v[144:147], v[180:183]
    v_fma_mix_f32 v248, v231, v249, 0 op_sel_hi:[1,1,0]
    v_fma_mix_f32 v231, v231, v249, 0 op_sel:[1,1,0] op_sel_hi:[1,1,0]
    v_cvt_pk_bf16_f32 v247, v248, v231
    v_mfma_f32_16x16x32_bf16 v[40:43], a[248:251], v[236:239], v[40:43]
    s_waitcnt lgkmcnt(8)
    v_or_b32 v242, v222, v221
    v_cvt_pkrtz_f16_f32 v250, v176, v177
    v_pk_lshrrev_b16 v250, 3, v250 op_sel_hi:[0,1]
    v_mfma_f32_16x16x32_f16 v[184:187], a[0:3], v[132:135], 0
    v_mad_u32_u16 v251, v250, 2, s85
    v_mad_u32_u16 v250, v250, 2, s85 op_sel:[1,0,0,0]
    v_cvt_pkrtz_f16_f32 v252, v178, v179
    v_mfma_f32_16x16x32_bf16 v[44:47], a[252:255], v[236:239], v[44:47]
    s_waitcnt lgkmcnt(6)
    ds_read_u16 v251, v251
    ds_read_u16_d16_hi v250, v250
    v_or_b32 v243, v224, v223
    v_mfma_f32_16x16x32_f16 v[188:191], a[4:7], v[132:135], 0
    v_pk_lshrrev_b16 v252, 3, v252 op_sel_hi:[0,1]
    v_mad_u32_u16 v253, v252, 2, s85
    v_mad_u32_u16 v252, v252, 2, s85 op_sel:[1,0,0,0]
    v_mfma_f32_16x16x32_bf16 v[56:59], a[232:235], v[236:239], v[56:59]
    ds_read_u16 v253, v253
    ds_read_u16_d16_hi v252, v252
    v_cvt_pkrtz_f16_f32 v0, v180, v181
    v_mfma_f32_16x16x32_f16 v[184:187], a[8:11], v[140:143], v[184:187]
    s_waitcnt lgkmcnt(8)
    v_pk_lshrrev_b16 v0, 3, v0 op_sel_hi:[0,1]
    v_mad_u32_u16 v208, v0, 2, s85
    v_or_b32 v244, v226, v225
    v_mfma_f32_16x16x32_f16 v[188:191], a[12:15], v[140:143], v[188:191]
    ds_read_u16 v208, v208
    v_mad_u32_u16 v0, v0, 2, s85 op_sel:[1,0,0,0]
    v_cvt_pkrtz_f16_f32 v209, v182, v183
    v_mfma_f32_16x16x32_f16 v[184:187], a[16:19], v[148:151], v[184:187]
    ds_read_u16_d16_hi v0, v0
    v_pk_lshrrev_b16 v209, 3, v209 op_sel_hi:[0,1]
    v_mad_u32_u16 v210, v209, 2, s85
    v_mfma_f32_16x16x32_f16 v[188:191], a[20:23], v[148:151], v[188:191]
    s_waitcnt lgkmcnt(8)
    ds_read_u16 v210, v210
    v_or_b32 v245, v228, v227
    v_mad_u32_u16 v209, v209, 2, s85 op_sel:[1,0,0,0]
    v_mfma_f32_16x16x32_bf16 v[60:63], a[236:239], v[236:239], v[60:63]
    ds_read_u16_d16_hi v209, v209
    v_cvt_pkrtz_f16_f32 v211, v184, v185
    v_pk_lshrrev_b16 v211, 3, v211 op_sel_hi:[0,1]
    v_mfma_f32_16x16x32_bf16 v[72:75], a[240:243], v[236:239], v[72:75]
    v_mad_u32_u16 v212, v211, 2, s85
    v_mad_u32_u16 v211, v211, 2, s85 op_sel:[1,0,0,0]
    v_cvt_pkrtz_f16_f32 v213, v186, v187
    v_mfma_f32_16x16x32_bf16 v[76:79], a[244:247], v[236:239], v[76:79]
    s_waitcnt lgkmcnt(8)
    ds_read_u16 v212, v212
    ds_read_u16_d16_hi v211, v211
    v_or_b32 v246, v230, v229
    v_mfma_f32_16x16x32_bf16 v[80:83], a[248:251], v[240:243], v[80:83]
    v_pk_lshrrev_b16 v213, 3, v213 op_sel_hi:[0,1]
    v_mad_u32_u16 v214, v213, 2, s85
    v_mad_u32_u16 v213, v213, 2, s85 op_sel:[1,0,0,0]
    v_mfma_f32_16x16x32_f16 v[176:179], a[48:51], v[128:131], 0
    ds_read_u16 v214, v214
    ds_read_u16_d16_hi v213, v213
    v_cvt_pkrtz_f16_f32 v215, v188, v189
    v_mfma_f32_16x16x32_bf16 v[84:87], a[252:255], v[240:243], v[84:87]
    v_pk_lshrrev_b16 v215, 3, v215 op_sel_hi:[0,1]
    v_mad_u32_u16 v216, v215, 2, s85
    v_mad_u32_u16 v215, v215, 2, s85 op_sel:[1,0,0,0]
    v_mfma_f32_16x16x32_f16 v[180:183], a[52:55], v[128:131], 0
    ds_read_u16 v216, v216
    ds_read_u16_d16_hi v215, v215
    v_cvt_pkrtz_f16_f32 v219, v190, v191
    v_mfma_f32_16x16x32_bf16 v[96:99], a[232:235], v[240:243], v[96:99]
    v_pk_fma_f16 v217, v219, v219, s53
    v_pk_mul_f16 v217, v217, v219 neg_lo:[1,0] neg_hi:[1,0]
    v_exp_f16 v218, v217
    v_mfma_f32_16x16x32_f16 v[176:179], a[56:59], v[136:139], v[176:179]
    s_waitcnt lgkmcnt(12)
    v_exp_f16_sdwa v218, v217 dst_sel:WORD_1 dst_unused:UNUSED_PRESERVE src0_sel:WORD_1
    v_or_b32 v232, v251, v250
    v_mfma_f32_16x16x32_bf16 v[100:103], a[236:239], v[240:243], v[100:103]
    v_pk_fma_f16 v218, v218, s86, s86
    v_rcp_f16 v217, v218
    v_mfma_f32_16x16x32_f16 v[180:183], a[60:63], v[136:139], v[180:183]
    s_waitcnt lgkmcnt(10)
    v_rcp_f16_sdwa v217, v218 dst_sel:WORD_1 dst_unused:UNUSED_PRESERVE src0_sel:WORD_1
    v_or_b32 v233, v253, v252
    v_mfma_f32_16x16x32_bf16 v[112:115], a[240:243], v[240:243], v[112:115]
    s_waitcnt lgkmcnt(8)
    v_fma_mix_f32 v218, v217, v219, 0 op_sel_hi:[1,1,0]
    v_fma_mix_f32 v217, v217, v219, 0 op_sel:[1,1,0] op_sel_hi:[1,1,0]
    v_or_b32 v234, v208, v0
    v_mfma_f32_16x16x32_f16 v[176:179], a[64:67], v[144:147], v[176:179]
    v_cvt_pk_bf16_f32 v239, v218, v217
    v_mfma_f32_16x16x32_bf16 v[116:119], a[244:247], v[240:243], v[116:119]
    v_mfma_f32_16x16x32_f16 v[180:183], a[68:71], v[144:147], v[180:183]
    s_waitcnt lgkmcnt(6)
    v_or_b32 v235, v210, v209
    v_mfma_f32_16x16x32_bf16 v[88:91], a[248:251], v[244:247], v[88:91]
    v_mfma_f32_16x16x32_f16 v[184:187], a[48:51], v[132:135], 0
    s_nop 0
    v_cvt_pkrtz_f16_f32 v220, v176, v177
    v_pk_lshrrev_b16 v220, 3, v220 op_sel_hi:[0,1]
    v_mfma_f32_16x16x32_bf16 v[92:95], a[252:255], v[244:247], v[92:95]
    s_waitcnt lgkmcnt(4)
    v_mad_u32_u16 v221, v220, 2, s85
    v_or_b32 v236, v212, v211
    v_mad_u32_u16 v220, v220, 2, s85 op_sel:[1,0,0,0]
    v_mfma_f32_16x16x32_f16 v[188:191], a[52:55], v[132:135], 0
    ds_read_u16 v221, v221
    ds_read_u16_d16_hi v220, v220
    v_cvt_pkrtz_f16_f32 v222, v178, v179
    v_mfma_f32_16x16x32_bf16 v[104:107], a[232:235], v[244:247], v[104:107]
    v_pk_lshrrev_b16 v222, 3, v222 op_sel_hi:[0,1]
    v_mad_u32_u16 v223, v222, 2, s85
    v_mad_u32_u16 v222, v222, 2, s85 op_sel:[1,0,0,0]
    v_mfma_f32_16x16x32_f16 v[184:187], a[56:59], v[140:143], v[184:187]
    s_waitcnt lgkmcnt(4)
    ds_read_u16 v223, v223
    ds_read_u16_d16_hi v222, v222
    v_or_b32 v237, v214, v213
    v_mfma_f32_16x16x32_f16 v[188:191], a[60:63], v[140:143], v[188:191]
    v_cvt_pkrtz_f16_f32 v224, v180, v181
    v_pk_lshrrev_b16 v224, 3, v224 op_sel_hi:[0,1]
    v_mad_u32_u16 v225, v224, 2, s85
    v_mfma_f32_16x16x32_f16 v[184:187], a[64:67], v[148:151], v[184:187]
    ds_read_u16 v225, v225
    v_mad_u32_u16 v224, v224, 2, s85 op_sel:[1,0,0,0]
    v_cvt_pkrtz_f16_f32 v226, v182, v183
    v_mfma_f32_16x16x32_f16 v[188:191], a[68:71], v[148:151], v[188:191]
    s_waitcnt lgkmcnt(5)
    ds_read_u16_d16_hi v224, v224
    v_or_b32 v238, v216, v215
    v_pk_lshrrev_b16 v226, 3, v226 op_sel_hi:[0,1]
    v_mfma_f32_16x16x32_bf16 v[108:111], a[236:239], v[244:247], v[108:111]
    v_mad_u32_u16 v227, v226, 2, s85
    v_mad_u32_u16 v226, v226, 2, s85 op_sel:[1,0,0,0]
    v_cvt_pkrtz_f16_f32 v228, v184, v185
    v_mfma_f32_16x16x32_bf16 v[120:123], a[240:243], v[244:247], v[120:123]
    ds_read_u16 v227, v227
    ds_read_u16_d16_hi v226, v226
    v_pk_lshrrev_b16 v228, 3, v228 op_sel_hi:[0,1]
    v_mfma_f32_16x16x32_bf16 v[124:127], a[244:247], v[244:247], v[124:127]
    v_mad_u32_u16 v229, v228, 2, s85
    v_mad_u32_u16 v228, v228, 2, s85 op_sel:[1,0,0,0]
    v_cvt_pkrtz_f16_f32 v230, v186, v187
    v_mfma_f32_16x16x32_bf16 v[32:35], a[24:27], v[232:235], v[32:35]
    ds_read_u16 v229, v229
    ds_read_u16_d16_hi v228, v228
    v_pk_lshrrev_b16 v230, 3, v230 op_sel_hi:[0,1]
    v_mfma_f32_16x16x32_f16 v[176:179], a[96:99], v[128:131], 0
    v_mad_u32_u16 v231, v230, 2, s85
    v_mad_u32_u16 v230, v230, 2, s85 op_sel:[1,0,0,0]
    v_cvt_pkrtz_f16_f32 v248, v188, v189
    v_mfma_f32_16x16x32_bf16 v[36:39], a[28:31], v[232:235], v[36:39]
    ds_read_u16 v231, v231
    ds_read_u16_d16_hi v230, v230
    v_pk_lshrrev_b16 v248, 3, v248 op_sel_hi:[0,1]
    v_mfma_f32_16x16x32_f16 v[180:183], a[100:103], v[128:131], 0
    v_mad_u32_u16 v249, v248, 2, s85
    v_mad_u32_u16 v248, v248, 2, s85 op_sel:[1,0,0,0]
    v_cvt_pkrtz_f16_f32 v250, v190, v191
    v_mfma_f32_16x16x32_bf16 v[48:51], a[32:35], v[232:235], v[48:51]
    ds_read_u16 v249, v249
    ds_read_u16_d16_hi v248, v248
    v_pk_lshrrev_b16 v250, 3, v250 op_sel_hi:[0,1]
    v_mfma_f32_16x16x32_f16 v[176:179], a[104:107], v[136:139], v[176:179]
    v_mad_u32_u16 v251, v250, 2, s85
    v_mad_u32_u16 v250, v250, 2, s85 op_sel:[1,0,0,0]
    v_mfma_f32_16x16x32_bf16 v[52:55], a[36:39], v[232:235], v[52:55]
    s_waitcnt lgkmcnt(12)
    ds_read_u16 v251, v251
    ds_read_u16_d16_hi v250, v250
    v_mfma_f32_16x16x32_f16 v[180:183], a[108:111], v[136:139], v[180:183]
    v_mfma_f32_16x16x32_bf16 v[64:67], a[40:43], v[232:235], v[64:67]
    v_mfma_f32_16x16x32_f16 v[176:179], a[112:115], v[144:147], v[176:179]
    v_mfma_f32_16x16x32_bf16 v[68:71], a[44:47], v[232:235], v[68:71]
    s_waitcnt lgkmcnt(10)
    v_or_b32 v232, v221, v220
    v_or_b32 v233, v223, v222
    v_or_b32 v234, v225, v224
    v_mfma_f32_16x16x32_f16 v[180:183], a[116:119], v[144:147], v[180:183]
    s_waitcnt lgkmcnt(8)
    v_or_b32 v235, v227, v226
    v_mfma_f32_16x16x32_bf16 v[40:43], a[24:27], v[236:239], v[40:43]
    v_cvt_pkrtz_f16_f32 v252, v176, v177
    v_pk_lshrrev_b16 v252, 3, v252 op_sel_hi:[0,1]
    v_mad_u32_u16 v253, v252, 2, s85
    v_mfma_f32_16x16x32_f16 v[184:187], a[96:99], v[132:135], 0
    ds_read_u16 v253, v253
    v_mad_u32_u16 v252, v252, 2, s85 op_sel:[1,0,0,0]
    v_cvt_pkrtz_f16_f32 v0, v178, v179
    v_mfma_f32_16x16x32_bf16 v[44:47], a[28:31], v[236:239], v[44:47]
    ds_read_u16_d16_hi v252, v252
    v_pk_lshrrev_b16 v0, 3, v0 op_sel_hi:[0,1]
    v_mad_u32_u16 v208, v0, 2, s85
    v_mfma_f32_16x16x32_f16 v[188:191], a[100:103], v[132:135], 0
    ds_read_u16 v208, v208
    v_mad_u32_u16 v0, v0, 2, s85 op_sel:[1,0,0,0]
    v_cvt_pkrtz_f16_f32 v209, v180, v181
    v_mfma_f32_16x16x32_bf16 v[56:59], a[32:35], v[236:239], v[56:59]
    ds_read_u16_d16_hi v0, v0
    v_pk_lshrrev_b16 v209, 3, v209 op_sel_hi:[0,1]
    v_mad_u32_u16 v210, v209, 2, s85
    v_mfma_f32_16x16x32_f16 v[184:187], a[104:107], v[140:143], v[184:187]
    ds_read_u16 v210, v210
    v_mad_u32_u16 v209, v209, 2, s85 op_sel:[1,0,0,0]
    v_cvt_pkrtz_f16_f32 v211, v182, v183
    v_mfma_f32_16x16x32_f16 v[188:191], a[108:111], v[140:143], v[188:191]
    ds_read_u16_d16_hi v209, v209
    v_pk_lshrrev_b16 v211, 3, v211 op_sel_hi:[0,1]
    v_mad_u32_u16 v212, v211, 2, s85
    v_mfma_f32_16x16x32_f16 v[184:187], a[112:115], v[148:151], v[184:187]
    s_waitcnt lgkmcnt(13)
    ds_read_u16 v212, v212
    v_mad_u32_u16 v211, v211, 2, s85 op_sel:[1,0,0,0]
    v_mfma_f32_16x16x32_f16 v[188:191], a[116:119], v[148:151], v[188:191]
    s_waitcnt lgkmcnt(13)
    ds_read_u16_d16_hi v211, v211
    v_mfma_f32_16x16x32_bf16 v[60:63], a[36:39], v[236:239], v[60:63]
    v_mfma_f32_16x16x32_bf16 v[72:75], a[40:43], v[236:239], v[72:75]
    v_cvt_pkrtz_f16_f32 v213, v184, v185
    v_pk_lshrrev_b16 v213, 3, v213 op_sel_hi:[0,1]
    v_mfma_f32_16x16x32_bf16 v[76:79], a[44:47], v[236:239], v[76:79]
    s_waitcnt lgkmcnt(10)
    v_or_b32 v236, v229, v228
    v_or_b32 v237, v231, v230
    v_or_b32 v238, v249, v248
    v_mfma_f32_16x16x32_bf16 v[32:35], a[72:75], v[232:235], v[32:35]
    s_waitcnt lgkmcnt(8)
    v_or_b32 v239, v251, v250
    v_mad_u32_u16 v214, v213, 2, s85
    v_mad_u32_u16 v213, v213, 2, s85 op_sel:[1,0,0,0]
    v_mfma_f32_16x16x32_f16 v[176:179], a[144:147], v[128:131], 0
    ds_read_u16 v214, v214
    ds_read_u16_d16_hi v213, v213
    v_cvt_pkrtz_f16_f32 v215, v186, v187
    v_mfma_f32_16x16x32_bf16 v[36:39], a[76:79], v[232:235], v[36:39]
    v_pk_lshrrev_b16 v215, 3, v215 op_sel_hi:[0,1]
    v_mad_u32_u16 v216, v215, 2, s85
    v_mad_u32_u16 v215, v215, 2, s85 op_sel:[1,0,0,0]
    v_mfma_f32_16x16x32_f16 v[180:183], a[148:151], v[128:131], 0
    ds_read_u16 v216, v216
    ds_read_u16_d16_hi v215, v215
    v_cvt_pkrtz_f16_f32 v217, v188, v189
    v_mfma_f32_16x16x32_bf16 v[48:51], a[80:83], v[232:235], v[48:51]
    v_pk_lshrrev_b16 v217, 3, v217 op_sel_hi:[0,1]
    v_mad_u32_u16 v218, v217, 2, s85
    v_mad_u32_u16 v217, v217, 2, s85 op_sel:[1,0,0,0]
    v_mfma_f32_16x16x32_f16 v[176:179], a[152:155], v[136:139], v[176:179]
    ds_read_u16 v218, v218
    ds_read_u16_d16_hi v217, v217
    v_cvt_pkrtz_f16_f32 v219, v190, v191
    v_mfma_f32_16x16x32_bf16 v[52:55], a[84:87], v[232:235], v[52:55]
    v_pk_lshrrev_b16 v219, 3, v219 op_sel_hi:[0,1]
    v_mad_u32_u16 v220, v219, 2, s85
    v_mad_u32_u16 v219, v219, 2, s85 op_sel:[1,0,0,0]
    v_mfma_f32_16x16x32_f16 v[180:183], a[156:159], v[136:139], v[180:183]
    s_waitcnt lgkmcnt(12)
    ds_read_u16 v220, v220
    ds_read_u16_d16_hi v219, v219
    v_mfma_f32_16x16x32_bf16 v[64:67], a[88:91], v[232:235], v[64:67]
    v_mfma_f32_16x16x32_f16 v[176:179], a[160:163], v[144:147], v[176:179]
    v_mfma_f32_16x16x32_bf16 v[68:71], a[92:95], v[232:235], v[68:71]
    s_waitcnt lgkmcnt(10)
    v_or_b32 v232, v253, v252
    v_or_b32 v233, v208, v0
    v_or_b32 v234, v210, v209
    v_mfma_f32_16x16x32_f16 v[180:183], a[164:167], v[144:147], v[180:183]
    s_waitcnt lgkmcnt(8)
    v_or_b32 v235, v212, v211
    v_mfma_f32_16x16x32_bf16 v[40:43], a[72:75], v[236:239], v[40:43]
    v_cvt_pkrtz_f16_f32 v221, v176, v177
    v_pk_lshrrev_b16 v221, 3, v221 op_sel_hi:[0,1]
    v_mad_u32_u16 v222, v221, 2, s85
    v_mfma_f32_16x16x32_f16 v[184:187], a[144:147], v[132:135], 0
    ds_read_u16 v222, v222
    v_mad_u32_u16 v221, v221, 2, s85 op_sel:[1,0,0,0]
    v_cvt_pkrtz_f16_f32 v223, v178, v179
    v_mfma_f32_16x16x32_bf16 v[44:47], a[76:79], v[236:239], v[44:47]
    ds_read_u16_d16_hi v221, v221
    v_pk_lshrrev_b16 v223, 3, v223 op_sel_hi:[0,1]
    v_mad_u32_u16 v224, v223, 2, s85
    v_mfma_f32_16x16x32_f16 v[188:191], a[148:151], v[132:135], 0
    ds_read_u16 v224, v224
    v_mad_u32_u16 v223, v223, 2, s85 op_sel:[1,0,0,0]
    v_cvt_pkrtz_f16_f32 v225, v180, v181
    v_mfma_f32_16x16x32_bf16 v[56:59], a[80:83], v[236:239], v[56:59]
    ds_read_u16_d16_hi v223, v223
    v_pk_lshrrev_b16 v225, 3, v225 op_sel_hi:[0,1]
    v_mad_u32_u16 v226, v225, 2, s85
    v_mfma_f32_16x16x32_f16 v[184:187], a[152:155], v[140:143], v[184:187]
    ds_read_u16 v226, v226
    v_mad_u32_u16 v225, v225, 2, s85 op_sel:[1,0,0,0]
    v_cvt_pkrtz_f16_f32 v227, v182, v183
    v_mfma_f32_16x16x32_f16 v[188:191], a[156:159], v[140:143], v[188:191]
    ds_read_u16_d16_hi v225, v225
    v_pk_lshrrev_b16 v227, 3, v227 op_sel_hi:[0,1]
    v_mad_u32_u16 v228, v227, 2, s85
    v_mfma_f32_16x16x32_f16 v[184:187], a[160:163], v[148:151], v[184:187]
    s_waitcnt lgkmcnt(13)
    ds_read_u16 v228, v228
    v_mad_u32_u16 v227, v227, 2, s85 op_sel:[1,0,0,0]
    v_mfma_f32_16x16x32_f16 v[188:191], a[164:167], v[148:151], v[188:191]
    s_waitcnt lgkmcnt(13)
    ds_read_u16_d16_hi v227, v227
    v_mfma_f32_16x16x32_bf16 v[60:63], a[84:87], v[236:239], v[60:63]
    v_mfma_f32_16x16x32_bf16 v[72:75], a[88:91], v[236:239], v[72:75]
    v_cvt_pkrtz_f16_f32 v229, v184, v185
    v_pk_lshrrev_b16 v229, 3, v229 op_sel_hi:[0,1]
    v_mfma_f32_16x16x32_bf16 v[76:79], a[92:95], v[236:239], v[76:79]
    s_waitcnt vmcnt(1) lgkmcnt(12)
    ds_read_b128 a[232:235], v8 offset:0
    v_or_b32 v236, v214, v213
    v_or_b32 v237, v216, v215
    v_mfma_f32_16x16x32_bf16 v[32:35], a[120:123], v[232:235], v[32:35]
    s_waitcnt lgkmcnt(9)
    v_or_b32 v238, v218, v217
    v_or_b32 v239, v220, v219
    v_mad_u32_u16 v230, v229, 2, s85
    v_mfma_f32_16x16x32_f16 v[192:195], a[0:3], v[152:155], 0
    ds_read_u16 v230, v230
    v_mad_u32_u16 v229, v229, 2, s85 op_sel:[1,0,0,0]
    v_cvt_pkrtz_f16_f32 v231, v186, v187
    v_mfma_f32_16x16x32_bf16 v[36:39], a[124:127], v[232:235], v[36:39]
    ds_read_u16_d16_hi v229, v229
    ds_read_b128 a[248:251], v12 offset:2560
    v_pk_lshrrev_b16 v231, 3, v231 op_sel_hi:[0,1]
    v_mfma_f32_16x16x32_f16 v[196:199], a[4:7], v[152:155], 0
    v_mad_u32_u16 v248, v231, 2, s85
    v_mad_u32_u16 v231, v231, 2, s85 op_sel:[1,0,0,0]
    v_cvt_pkrtz_f16_f32 v249, v188, v189
    v_mfma_f32_16x16x32_bf16 v[48:51], a[128:131], v[232:235], v[48:51]
    ds_read_u16 v248, v248
    ds_read_u16_d16_hi v231, v231
    v_pk_lshrrev_b16 v249, 3, v249 op_sel_hi:[0,1]
    v_mfma_f32_16x16x32_f16 v[192:195], a[8:11], v[160:163], v[192:195]
    s_waitcnt lgkmcnt(13)
    ds_read_b128 a[240:243], v15 offset:1280
    v_mad_u32_u16 v250, v249, 2, s85
    v_mad_u32_u16 v249, v249, 2, s85 op_sel:[1,0,0,0]
    v_mfma_f32_16x16x32_bf16 v[52:55], a[132:135], v[232:235], v[52:55]
    s_waitcnt lgkmcnt(12)
    ds_read_u16 v250, v250
    ds_read_u16_d16_hi v249, v249
    v_cvt_pkrtz_f16_f32 v251, v190, v191
    v_mfma_f32_16x16x32_f16 v[196:199], a[12:15], v[160:163], v[196:199]
    v_pk_lshrrev_b16 v251, 3, v251 op_sel_hi:[0,1]
    v_mad_u32_u16 v252, v251, 2, s85
    v_mad_u32_u16 v251, v251, 2, s85 op_sel:[1,0,0,0]
    v_mfma_f32_16x16x32_bf16 v[64:67], a[136:139], v[232:235], v[64:67]
    s_waitcnt lgkmcnt(12)
    ds_read_u16 v252, v252
    ds_read_u16_d16_hi v251, v251
    v_mfma_f32_16x16x32_f16 v[192:195], a[16:19], v[168:171], v[192:195]
    s_waitcnt lgkmcnt(13)
    ds_read_b128 a[244:247], v8 offset:2560
    v_mfma_f32_16x16x32_bf16 v[68:71], a[140:143], v[232:235], v[68:71]
    v_or_b32 v232, v222, v221
    v_or_b32 v233, v224, v223
    v_or_b32 v234, v226, v225
    v_mfma_f32_16x16x32_f16 v[196:199], a[20:23], v[168:171], v[196:199]
    s_waitcnt lgkmcnt(12)
    v_or_b32 v235, v228, v227
    v_mfma_f32_16x16x32_bf16 v[40:43], a[120:123], v[236:239], v[40:43]
    v_cvt_pkrtz_f16_f32 v253, v192, v193
    v_pk_lshrrev_b16 v253, 3, v253 op_sel_hi:[0,1]
    v_cvt_pkrtz_f16_f32 v208, v194, v195
    v_mfma_f32_16x16x32_f16 v[200:203], a[0:3], v[156:159], 0
    ds_read_b128 a[252:255], v15 offset:3840
    v_mad_u32_u16 v0, v253, 2, s85
    v_cvt_pkrtz_f16_f32 v210, v196, v197
    v_mfma_f32_16x16x32_bf16 v[44:47], a[124:127], v[236:239], v[44:47]
    ds_read_u16 v0, v0
    v_cvt_pkrtz_f16_f32 v212, v198, v199
    v_mad_u32_u16 v253, v253, 2, s85 op_sel:[1,0,0,0]
    v_mfma_f32_16x16x32_f16 v[204:207], a[4:7], v[156:159], 0
    s_waitcnt lgkmcnt(13)
    ds_read_u16_d16_hi v253, v253
    v_pk_lshrrev_b16 v208, 3, v208 op_sel_hi:[0,1]
    v_mad_u32_u16 v209, v208, 2, s85
    v_mfma_f32_16x16x32_bf16 v[56:59], a[128:131], v[236:239], v[56:59]
    s_waitcnt lgkmcnt(13)
    ds_read_u16 v209, v209
    v_mad_u32_u16 v208, v208, 2, s85 op_sel:[1,0,0,0]
    v_pk_lshrrev_b16 v210, 3, v210 op_sel_hi:[0,1]
    v_mfma_f32_16x16x32_f16 v[200:203], a[8:11], v[164:167], v[200:203]
    s_waitcnt lgkmcnt(13)
    ds_read_u16_d16_hi v208, v208
    v_mad_u32_u16 v211, v210, 2, s85
    v_mad_u32_u16 v210, v210, 2, s85 op_sel:[1,0,0,0]
    v_mfma_f32_16x16x32_f16 v[204:207], a[12:15], v[164:167], v[204:207]
    s_waitcnt lgkmcnt(12)
    ds_read_b128 v[136:139], v11 offset:0
    ds_read_u16 v211, v211
    v_pk_lshrrev_b16 v212, 3, v212 op_sel_hi:[0,1]
    v_mfma_f32_16x16x32_f16 v[200:203], a[16:19], v[172:175], v[200:203]
    s_waitcnt lgkmcnt(13)
    ds_read_u16_d16_hi v210, v210
    v_mad_u32_u16 v213, v212, 2, s85
    v_mad_u32_u16 v212, v212, 2, s85 op_sel:[1,0,0,0]
    v_mfma_f32_16x16x32_f16 v[204:207], a[20:23], v[172:175], v[204:207]
    s_waitcnt lgkmcnt(12)
    ds_read_u16 v213, v213
    ds_read_u16_d16_hi v212, v212
    v_mfma_f32_16x16x32_bf16 v[60:63], a[132:135], v[236:239], v[60:63]
    v_cvt_pkrtz_f16_f32 v214, v200, v201
    v_cvt_pkrtz_f16_f32 v216, v202, v203
    v_pk_lshrrev_b16 v214, 3, v214 op_sel_hi:[0,1]
    v_mfma_f32_16x16x32_bf16 v[72:75], a[136:139], v[236:239], v[72:75]
    v_cvt_pkrtz_f16_f32 v218, v204, v205
    v_cvt_pkrtz_f16_f32 v220, v206, v207
    v_mad_u32_u16 v215, v214, 2, s85
    v_mfma_f32_16x16x32_bf16 v[76:79], a[140:143], v[236:239], v[76:79]
    s_waitcnt lgkmcnt(13)
    ds_read_u16 v215, v215
    v_or_b32 v236, v230, v229
    v_or_b32 v237, v248, v231
    v_mfma_f32_16x16x32_bf16 v[32:35], a[168:171], v[232:235], v[32:35]
    s_waitcnt lgkmcnt(12)
    ds_read_b128 a[236:239], v12 offset:0
    v_or_b32 v238, v250, v249
    v_or_b32 v239, v252, v251
    v_mfma_f32_16x16x32_f16 v[192:195], a[48:51], v[152:155], 0
    v_mad_u32_u16 v214, v214, 2, s85 op_sel:[1,0,0,0]
    v_pk_lshrrev_b16 v216, 3, v216 op_sel_hi:[0,1]
    v_mad_u32_u16 v217, v216, 2, s85
    v_mfma_f32_16x16x32_bf16 v[36:39], a[172:175], v[232:235], v[36:39]
    s_waitcnt lgkmcnt(12)
    ds_read_u16_d16_hi v214, v214
    ds_read_u16 v217, v217
    v_mad_u32_u16 v216, v216, 2, s85 op_sel:[1,0,0,0]
    v_mfma_f32_16x16x32_f16 v[196:199], a[52:55], v[152:155], 0
    s_waitcnt lgkmcnt(12)
    ds_read_u16_d16_hi v216, v216
    ds_read_b128 v[140:143], v15 offset:0
    v_pk_lshrrev_b16 v218, 3, v218 op_sel_hi:[0,1]
    v_mfma_f32_16x16x32_bf16 v[48:51], a[176:179], v[232:235], v[48:51]
    v_mad_u32_u16 v219, v218, 2, s85
    v_mad_u32_u16 v218, v218, 2, s85 op_sel:[1,0,0,0]
    v_pk_lshrrev_b16 v220, 3, v220 op_sel_hi:[0,1]
    v_mfma_f32_16x16x32_f16 v[192:195], a[56:59], v[160:163], v[192:195]
    s_waitcnt lgkmcnt(13)
    ds_read_u16 v219, v219
    v_mad_u32_u16 v221, v220, 2, s85
    v_mad_u32_u16 v220, v220, 2, s85 op_sel:[1,0,0,0]
    v_mfma_f32_16x16x32_bf16 v[52:55], a[180:183], v[232:235], v[52:55]
    s_waitcnt lgkmcnt(13)
    ds_read_u16_d16_hi v218, v218
    v_or_b32 v240, v0, v253
    v_cvt_pk_bf16_f32 v32, v32, v33
    v_mfma_f32_16x16x32_f16 v[196:199], a[60:63], v[160:163], v[196:199]
    s_waitcnt lgkmcnt(13)
    v_cvt_pk_bf16_f32 v33, v34, v35
    v_cvt_pk_bf16_f32 v34, v36, v37
    v_or_b32 v241, v209, v208
    v_mfma_f32_16x16x32_bf16 v[64:67], a[184:187], v[232:235], v[64:67]
    s_waitcnt lgkmcnt(12)
    ds_read_u16 v221, v221
    ds_read_u16_d16_hi v220, v220
    v_cvt_pk_bf16_f32 v35, v38, v39
    v_mfma_f32_16x16x32_f16 v[192:195], a[64:67], v[168:171], v[192:195]
    v_cvt_pk_bf16_f32 v48, v48, v49
    v_cvt_pk_bf16_f32 v49, v50, v51
    v_cvt_pk_bf16_f32 v50, v52, v53
    v_mfma_f32_16x16x32_bf16 v[68:71], a[188:191], v[232:235], v[68:71]
    s_waitcnt lgkmcnt(13)
    ds_read_b128 v[148:151], v11 offset:2560
    v_cvt_pk_bf16_f32 v51, v54, v55
    v_mfma_f32_16x16x32_f16 v[196:199], a[68:71], v[168:171], v[196:199]
    s_waitcnt lgkmcnt(13)
    v_cvt_pkrtz_f16_f32 v222, v192, v193
    v_pk_lshrrev_b16 v222, 3, v222 op_sel_hi:[0,1]
    v_or_b32 v242, v211, v210
    v_mfma_f32_16x16x32_bf16 v[40:43], a[168:171], v[236:239], v[40:43]
    v_cvt_pkrtz_f16_f32 v224, v194, v195
    v_mad_u32_u16 v223, v222, 2, s85
    v_mad_u32_u16 v222, v222, 2, s85 op_sel:[1,0,0,0]
    v_mfma_f32_16x16x32_f16 v[200:203], a[48:51], v[156:159], 0
    v_cvt_pkrtz_f16_f32 v226, v196, v197
    v_cvt_pkrtz_f16_f32 v228, v198, v199
    v_pk_lshrrev_b16 v224, 3, v224 op_sel_hi:[0,1]
    v_mfma_f32_16x16x32_bf16 v[44:47], a[172:175], v[236:239], v[44:47]
    s_waitcnt lgkmcnt(11)
    ds_read_b128 v[144:147], v12 offset:1280
    v_or_b32 v243, v213, v212
    v_mad_u32_u16 v225, v224, 2, s85
    v_mfma_f32_16x16x32_f16 v[204:207], a[52:55], v[156:159], 0
    v_mad_u32_u16 v224, v224, 2, s85 op_sel:[1,0,0,0]
    v_pk_lshrrev_b16 v226, 3, v226 op_sel_hi:[0,1]
    v_mad_u32_u16 v227, v226, 2, s85
    v_mfma_f32_16x16x32_bf16 v[56:59], a[176:179], v[236:239], v[56:59]
    ds_read_b128 v[180:183], v13 offset:0
    ds_read_u16 v223, v223
    v_mad_u32_u16 v226, v226, 2, s85 op_sel:[1,0,0,0]
    v_mfma_f32_16x16x32_f16 v[200:203], a[56:59], v[164:167], v[200:203]
    s_waitcnt lgkmcnt(12)
    ds_read_u16_d16_hi v222, v222
    ds_read_u16 v225, v225
    v_pk_lshrrev_b16 v228, 3, v228 op_sel_hi:[0,1]
    v_mfma_f32_16x16x32_f16 v[204:207], a[60:63], v[164:167], v[204:207]
    s_waitcnt lgkmcnt(13)
    ds_read_u16_d16_hi v224, v224
    v_or_b32 v244, v215, v214
    v_mad_u32_u16 v229, v228, 2, s85
    v_mfma_f32_16x16x32_f16 v[200:203], a[64:67], v[172:175], v[200:203]
    v_mad_u32_u16 v228, v228, 2, s85 op_sel:[1,0,0,0]
    v_cvt_pk_bf16_f32 v40, v40, v41
    v_cvt_pk_bf16_f32 v41, v42, v43
    v_mfma_f32_16x16x32_f16 v[204:207], a[68:71], v[172:175], v[204:207]
    s_waitcnt lgkmcnt(13)
    ds_read_b128 v[188:191], v9 offset:2560
    v_cvt_pk_bf16_f32 v42, v44, v45
    v_cvt_pk_bf16_f32 v43, v46, v47
    v_mfma_f32_16x16x32_bf16 v[60:63], a[180:183], v[236:239], v[60:63]
    s_waitcnt lgkmcnt(13)
    ds_read_u16 v227, v227
    v_or_b32 v245, v217, v216
    v_cvt_pkrtz_f16_f32 v230, v200, v201
    v_mfma_f32_16x16x32_bf16 v[72:75], a[184:187], v[236:239], v[72:75]
    s_waitcnt lgkmcnt(13)
    ds_read_u16_d16_hi v226, v226
    v_cvt_pkrtz_f16_f32 v248, v202, v203
    v_cvt_pkrtz_f16_f32 v250, v204, v205
    v_mfma_f32_16x16x32_bf16 v[76:79], a[188:191], v[236:239], v[76:79]
    v_cvt_pkrtz_f16_f32 v0, v206, v207
    v_pk_lshrrev_b16 v230, 3, v230 op_sel_hi:[0,1]
    v_mad_u32_u16 v231, v230, 2, s85
    v_mfma_f32_16x16x32_bf16 v[80:83], a[24:27], v[240:243], v[80:83]
    s_waitcnt lgkmcnt(13)
    ds_read_u16 v229, v229
    v_mad_u32_u16 v230, v230, 2, s85 op_sel:[1,0,0,0]
    v_pk_lshrrev_b16 v248, 3, v248 op_sel_hi:[0,1]
    v_mfma_f32_16x16x32_f16 v[192:195], a[96:99], v[152:155], 0
    s_waitcnt lgkmcnt(13)
    ds_read_u16_d16_hi v228, v228
    buffer_store_dwordx4 v[40:43], v26, s[24:27], s81 offen offset:0 sc0 sc1
    v_mfma_f32_16x16x32_bf16 v[84:87], a[28:31], v[240:243], v[84:87]
    s_waitcnt lgkmcnt(13)
    ds_read_u16 v231, v231
    v_or_b32 v246, v219, v218
    v_mad_u32_u16 v249, v248, 2, s85
    v_mfma_f32_16x16x32_f16 v[196:199], a[100:103], v[152:155], 0
    s_waitcnt lgkmcnt(13)
    ds_read_u16_d16_hi v230, v230
    v_or_b32 v247, v221, v220
    v_mad_u32_u16 v248, v248, 2, s85 op_sel:[1,0,0,0]
    v_mfma_f32_16x16x32_bf16 v[96:99], a[32:35], v[240:243], v[96:99]
    s_waitcnt lgkmcnt(13)
    ds_read_u16 v249, v249
    v_pk_lshrrev_b16 v250, 3, v250 op_sel_hi:[0,1]
    v_mad_u32_u16 v251, v250, 2, s85
    v_mfma_f32_16x16x32_f16 v[192:195], a[104:107], v[160:163], v[192:195]
    s_waitcnt lgkmcnt(13)
    ds_read_u16_d16_hi v248, v248
    buffer_store_dwordx4 v[32:35], v26, s[24:27], s80 offen offset:0 sc0 sc1
    v_mfma_f32_16x16x32_bf16 v[100:103], a[36:39], v[240:243], v[100:103]
    s_waitcnt lgkmcnt(13)
    ds_read_u16 v251, v251
    v_mad_u32_u16 v250, v250, 2, s85 op_sel:[1,0,0,0]
    v_cvt_pk_bf16_f32 v56, v56, v57
    v_mfma_f32_16x16x32_f16 v[196:199], a[108:111], v[160:163], v[196:199]
    s_waitcnt lgkmcnt(13)
    ds_read_u16_d16_hi v250, v250
    v_cvt_pk_bf16_f32 v57, v58, v59
    v_cvt_pk_bf16_f32 v58, v60, v61
    v_mfma_f32_16x16x32_bf16 v[112:115], a[40:43], v[240:243], v[112:115]
    buffer_store_dwordx4 v[48:51], v26, s[24:27], s80 offen offset:64 sc0 sc1
    v_mfma_f32_16x16x32_f16 v[192:195], a[112:115], v[168:171], v[192:195]
    s_waitcnt lgkmcnt(13)
    ds_read_b128 v[232:235], v13 offset:2560
    v_cvt_pk_bf16_f32 v59, v62, v63
    v_cvt_pk_bf16_f32 v64, v64, v65
    v_mfma_f32_16x16x32_bf16 v[116:119], a[44:47], v[240:243], v[116:119]
    v_cvt_pk_bf16_f32 v65, v66, v67
    v_cvt_pk_bf16_f32 v66, v68, v69
    v_cvt_pk_bf16_f32 v67, v70, v71
    v_mfma_f32_16x16x32_f16 v[196:199], a[116:119], v[168:171], v[196:199]
    s_waitcnt lgkmcnt(13)
    buffer_store_dwordx4 v[56:59], v26, s[24:27], s81 offen offset:64 sc0 sc1
    ds_read_b128 v[32:35], v10 offset:0
    v_mfma_f32_16x16x32_bf16 v[88:91], a[24:27], v[244:247], v[88:91]
    v_cvt_pk_bf16_f32 v72, v72, v73
    v_cvt_pk_bf16_f32 v73, v74, v75
    v_cvt_pk_bf16_f32 v74, v76, v77
    v_mfma_f32_16x16x32_f16 v[200:203], a[96:99], v[156:159], 0
    v_cvt_pk_bf16_f32 v75, v78, v79
    v_pk_fma_f16 v252, v0, v0, s53
    v_pk_mul_f16 v252, v252, v0 neg_lo:[1,0] neg_hi:[1,0]
    v_mfma_f32_16x16x32_bf16 v[92:95], a[28:31], v[244:247], v[92:95]
    v_exp_f16 v253, v252
    v_or_b32 v240, v223, v222
    v_mfma_f32_16x16x32_f16 v[204:207], a[100:103], v[156:159], 0
    s_waitcnt lgkmcnt(13)
    v_exp_f16_sdwa v253, v252 dst_sel:WORD_1 dst_unused:UNUSED_PRESERVE src0_sel:WORD_1
    v_or_b32 v241, v225, v224
    v_mfma_f32_16x16x32_bf16 v[104:107], a[32:35], v[244:247], v[104:107]
    s_waitcnt lgkmcnt(12)
    ds_read_b128 v[176:179], v9 offset:0
    ds_read_b128 v[184:187], v14 offset:1280
    v_pk_fma_f16 v253, v253, s86, s86
    v_mfma_f32_16x16x32_f16 v[200:203], a[104:107], v[164:167], v[200:203]
    s_waitcnt lgkmcnt(13)
    ds_read_b128 v[44:47], v10 offset:2560
    v_rcp_f16 v252, v253
    v_mfma_f32_16x16x32_f16 v[204:207], a[108:111], v[164:167], v[204:207]
    s_waitcnt lgkmcnt(13)
    v_rcp_f16_sdwa v252, v253 dst_sel:WORD_1 dst_unused:UNUSED_PRESERVE src0_sel:WORD_1
    v_or_b32 v242, v227, v226
    v_mfma_f32_16x16x32_f16 v[200:203], a[112:115], v[172:175], v[200:203]
    ds_read_b128 v[36:39], v14 offset:0
    v_fma_mix_f32 v253, v252, v0, 0 op_sel_hi:[1,1,0]
    v_fma_mix_f32 v252, v252, v0, 0 op_sel:[1,1,0] op_sel_hi:[1,1,0]
    v_mfma_f32_16x16x32_f16 v[204:207], a[116:119], v[172:175], v[204:207]
    s_waitcnt lgkmcnt(12)
    v_or_b32 v243, v229, v228
    v_cvt_pkrtz_f16_f32 v208, v192, v193
    v_pk_lshrrev_b16 v208, 3, v208 op_sel_hi:[0,1]
    v_mfma_f32_16x16x32_bf16 v[108:111], a[36:39], v[244:247], v[108:111]
    buffer_store_dwordx4 v[72:75], v26, s[24:27], s81 offen offset:128 sc0 sc1
    v_mfma_f32_16x16x32_bf16 v[120:123], a[40:43], v[244:247], v[120:123]
    ds_read_b128 v[40:43], v13 offset:1280
    v_cvt_pkrtz_f16_f32 v210, v194, v195
    v_cvt_pkrtz_f16_f32 v212, v196, v197
    v_mfma_f32_16x16x32_bf16 v[124:127], a[44:47], v[244:247], v[124:127]
    s_waitcnt lgkmcnt(9)
    v_or_b32 v244, v231, v230
    v_or_b32 v245, v249, v248
    v_cvt_pk_bf16_f32 v247, v253, v252
    v_mfma_f32_16x16x32_bf16 v[80:83], a[72:75], v[240:243], v[80:83]
    ds_read_b128 v[56:59], v20 offset:2560
    v_cvt_pkrtz_f16_f32 v214, v198, v199
    v_cvt_pkrtz_f16_f32 v216, v200, v201
    v_mfma_f32_16x16x32_f16 v[192:195], a[144:147], v[152:155], 0
    buffer_store_dwordx4 v[64:67], v26, s[24:27], s80 offen offset:128 sc0 sc1
    v_mfma_f32_16x16x32_bf16 v[84:87], a[76:79], v[240:243], v[84:87]
    s_waitcnt lgkmcnt(8)
    ds_read_b128 v[60:63], v21 offset:2560
    v_or_b32 v246, v251, v250
    v_cvt_pkrtz_f16_f32 v218, v202, v203
    v_mfma_f32_16x16x32_f16 v[196:199], a[148:151], v[152:155], 0
    v_cvt_pkrtz_f16_f32 v220, v204, v205
    v_cvt_pkrtz_f16_f32 v222, v206, v207
    v_mad_u32_u16 v209, v208, 2, s85
    v_mfma_f32_16x16x32_bf16 v[96:99], a[80:83], v[240:243], v[96:99]
    ds_read_u16 v209, v209
    ds_read_b128 v[236:239], v14 offset:3840
    v_mad_u32_u16 v208, v208, 2, s85 op_sel:[1,0,0,0]
    v_mfma_f32_16x16x32_f16 v[192:195], a[152:155], v[160:163], v[192:195]
    ds_read_u16_d16_hi v208, v208
    ds_read_b128 v[52:55], v21 offset:0
    v_pk_lshrrev_b16 v210, 3, v210 op_sel_hi:[0,1]
    v_mfma_f32_16x16x32_bf16 v[100:103], a[84:87], v[240:243], v[100:103]
    s_waitcnt lgkmcnt(12)
    ds_read_b128 v[48:51], v20 offset:0
    ds_read_b128 v[64:67], v14 offset:2560
    v_mad_u32_u16 v211, v210, 2, s85
    v_mfma_f32_16x16x32_f16 v[196:199], a[156:159], v[160:163], v[196:199]
    s_waitcnt lgkmcnt(13)
    ds_read_u16 v211, v211
    v_mad_u32_u16 v210, v210, 2, s85 op_sel:[1,0,0,0]
    v_pk_lshrrev_b16 v212, 3, v212 op_sel_hi:[0,1]
    v_mfma_f32_16x16x32_bf16 v[112:115], a[88:91], v[240:243], v[112:115]
    s_waitcnt lgkmcnt(13)
    ds_read_u16_d16_hi v210, v210
    v_mad_u32_u16 v213, v212, 2, s85
    v_mad_u32_u16 v212, v212, 2, s85 op_sel:[1,0,0,0]
    v_mfma_f32_16x16x32_f16 v[192:195], a[160:163], v[168:171], v[192:195]
    s_waitcnt lgkmcnt(12)
    ds_read_u16 v213, v213
    ds_read_u16_d16_hi v212, v212
    v_pk_lshrrev_b16 v214, 3, v214 op_sel_hi:[0,1]
    v_mfma_f32_16x16x32_bf16 v[116:119], a[92:95], v[240:243], v[116:119]
    s_waitcnt lgkmcnt(13)
    ds_read_b128 v[68:71], v13 offset:3840
    v_mad_u32_u16 v215, v214, 2, s85
    v_mad_u32_u16 v214, v214, 2, s85 op_sel:[1,0,0,0]
    v_mfma_f32_16x16x32_f16 v[196:199], a[164:167], v[168:171], v[196:199]
    s_waitcnt lgkmcnt(12)
    ds_read_u16 v215, v215
    ds_read_u16_d16_hi v214, v214
    v_pk_lshrrev_b16 v216, 3, v216 op_sel_hi:[0,1]
    v_mfma_f32_16x16x32_bf16 v[88:91], a[72:75], v[244:247], v[88:91]
    s_waitcnt lgkmcnt(13)
    ds_read_b128 v[72:75], v15 offset:2560
    v_mad_u32_u16 v217, v216, 2, s85
    v_mad_u32_u16 v216, v216, 2, s85 op_sel:[1,0,0,0]
    v_mfma_f32_16x16x32_f16 v[200:203], a[144:147], v[156:159], 0
    s_waitcnt lgkmcnt(12)
    ds_read_u16 v217, v217
    ds_read_u16_d16_hi v216, v216
    v_pk_lshrrev_b16 v218, 3, v218 op_sel_hi:[0,1]
    v_mfma_f32_16x16x32_bf16 v[92:95], a[76:79], v[244:247], v[92:95]
    s_waitcnt lgkmcnt(13)
    ds_read_b128 v[76:79], v12 offset:3840
    v_mad_u32_u16 v219, v218, 2, s85
    v_mad_u32_u16 v218, v218, 2, s85 op_sel:[1,0,0,0]
    v_mfma_f32_16x16x32_f16 v[204:207], a[148:151], v[156:159], 0
    s_waitcnt lgkmcnt(12)
    ds_read_u16 v219, v219
    ds_read_u16_d16_hi v218, v218
    v_pk_lshrrev_b16 v220, 3, v220 op_sel_hi:[0,1]
    v_mfma_f32_16x16x32_bf16 v[104:107], a[80:83], v[244:247], v[104:107]
    v_mad_u32_u16 v221, v220, 2, s85
    v_mad_u32_u16 v220, v220, 2, s85 op_sel:[1,0,0,0]
    v_pk_lshrrev_b16 v222, 3, v222 op_sel_hi:[0,1]
    v_mfma_f32_16x16x32_f16 v[200:203], a[152:155], v[164:167], v[200:203]
    s_waitcnt lgkmcnt(12)
    ds_read_u16 v221, v221
    ds_read_u16_d16_hi v220, v220
    v_mad_u32_u16 v223, v222, 2, s85
    v_mfma_f32_16x16x32_f16 v[204:207], a[156:159], v[164:167], v[204:207]
    s_waitcnt lgkmcnt(13)
    ds_read_u16 v223, v223
    v_mad_u32_u16 v222, v222, 2, s85 op_sel:[1,0,0,0]
    v_or_b32 v240, v209, v208
    v_mfma_f32_16x16x32_f16 v[200:203], a[160:163], v[172:175], v[200:203]
    s_waitcnt lgkmcnt(13)
    ds_read_u16_d16_hi v222, v222
    v_or_b32 v241, v211, v210
    v_cvt_pkrtz_f16_f32 v224, v192, v193
    v_mfma_f32_16x16x32_f16 v[204:207], a[164:167], v[172:175], v[204:207]
    s_waitcnt lgkmcnt(13)
    v_pk_lshrrev_b16 v224, 3, v224 op_sel_hi:[0,1]
    v_or_b32 v242, v213, v212
    v_cvt_pkrtz_f16_f32 v226, v194, v195
    v_mfma_f32_16x16x32_bf16 v[108:111], a[84:87], v[244:247], v[108:111]
    v_cvt_pkrtz_f16_f32 v228, v196, v197
    v_cvt_pkrtz_f16_f32 v230, v198, v199
    v_cvt_pkrtz_f16_f32 v248, v200, v201
    v_mfma_f32_16x16x32_bf16 v[120:123], a[88:91], v[244:247], v[120:123]
    v_cvt_pkrtz_f16_f32 v250, v202, v203
    v_cvt_pkrtz_f16_f32 v0, v204, v205
    v_cvt_pkrtz_f16_f32 v210, v206, v207
    v_mfma_f32_16x16x32_bf16 v[124:127], a[92:95], v[244:247], v[124:127]
    s_waitcnt lgkmcnt(11)
    v_mad_u32_u16 v225, v224, 2, s85
    v_mad_u32_u16 v224, v224, 2, s85 op_sel:[1,0,0,0]
    v_pk_lshrrev_b16 v226, 3, v226 op_sel_hi:[0,1]
    v_mad_u32_u16 v227, v226, 2, s85
    v_mad_u32_u16 v226, v226, 2, s85 op_sel:[1,0,0,0]
    s_waitcnt lgkmcnt(10)
    v_or_b32 v243, v215, v214
    v_pk_lshrrev_b16 v228, 3, v228 op_sel_hi:[0,1]
    v_mad_u32_u16 v229, v228, 2, s85
    v_mfma_f32_16x16x32_bf16 v[80:83], a[120:123], v[240:243], v[80:83]
    ds_read_u16 v225, v225
    ds_read_u16_d16_hi v224, v224
    v_mad_u32_u16 v228, v228, 2, s85 op_sel:[1,0,0,0]
    v_mfma_f32_16x16x32_bf16 v[84:87], a[124:127], v[240:243], v[84:87]
    ds_read_u16 v227, v227
    ds_read_u16_d16_hi v226, v226
    v_pk_lshrrev_b16 v230, 3, v230 op_sel_hi:[0,1]
    v_mfma_f32_16x16x32_bf16 v[96:99], a[128:131], v[240:243], v[96:99]
    s_waitcnt lgkmcnt(12)
    ds_read_u16 v229, v229
    ds_read_u16_d16_hi v228, v228
    v_mad_u32_u16 v231, v230, 2, s85
    v_mfma_f32_16x16x32_bf16 v[100:103], a[132:135], v[240:243], v[100:103]
    s_waitcnt lgkmcnt(11)
    ds_read_u16 v231, v231
    v_or_b32 v244, v217, v216
    v_mad_u32_u16 v230, v230, 2, s85 op_sel:[1,0,0,0]
    v_mfma_f32_16x16x32_bf16 v[112:115], a[136:139], v[240:243], v[112:115]
    s_add_u32 m0, s56, -128
    ds_read_u16_d16_hi v230, v230
    buffer_load_dwordx4 v1, s[20:23], 0 offen offset:128 lds
    v_mfma_f32_16x16x32_bf16 v[116:119], a[140:143], v[240:243], v[116:119]
    s_add_u32 m0, s56, 896
    ds_read_b128 v[192:195], v22 offset:0
    buffer_load_dwordx4 v2, s[20:23], 0 offen offset:128 lds
    v_pk_lshrrev_b16 v248, 3, v248 op_sel_hi:[0,1]
    v_mad_u32_u16 v249, v248, 2, s85
    s_waitcnt lgkmcnt(13)
    v_or_b32 v245, v219, v218
    v_mad_u32_u16 v248, v248, 2, s85 op_sel:[1,0,0,0]
    v_pk_lshrrev_b16 v250, 3, v250 op_sel_hi:[0,1]
    v_mad_u32_u16 v251, v250, 2, s85
    v_mad_u32_u16 v250, v250, 2, s85 op_sel:[1,0,0,0]
    v_pk_fma_f16 v252, v0, v0, s53
    v_pk_fma_f16 v208, v210, v210, s53
    v_pk_mul_f16 v252, v252, v0 neg_lo:[1,0] neg_hi:[1,0]
    v_pk_mul_f16 v208, v208, v210 neg_lo:[1,0] neg_hi:[1,0]
    v_exp_f16 v253, v252
    v_exp_f16 v209, v208
    v_exp_f16_sdwa v253, v252 dst_sel:WORD_1 dst_unused:UNUSED_PRESERVE src0_sel:WORD_1
    s_waitcnt lgkmcnt(11)
    v_or_b32 v246, v221, v220
    v_exp_f16_sdwa v209, v208 dst_sel:WORD_1 dst_unused:UNUSED_PRESERVE src0_sel:WORD_1
    v_pk_fma_f16 v253, v253, s86, s86
    v_pk_fma_f16 v209, v209, s86, s86
    v_rcp_f16 v252, v253
    v_rcp_f16 v208, v209
    v_rcp_f16_sdwa v252, v253 dst_sel:WORD_1 dst_unused:UNUSED_PRESERVE src0_sel:WORD_1
    v_rcp_f16_sdwa v208, v209 dst_sel:WORD_1 dst_unused:UNUSED_PRESERVE src0_sel:WORD_1
    v_fma_mix_f32 v253, v252, v0, 0 op_sel_hi:[1,1,0]
    s_waitcnt lgkmcnt(9)
    v_or_b32 v247, v223, v222
    v_fma_mix_f32 v209, v208, v210, 0 op_sel_hi:[1,1,0]
    v_fma_mix_f32 v252, v252, v0, 0 op_sel:[1,1,0] op_sel_hi:[1,1,0]
    v_mfma_f32_16x16x32_bf16 v[88:91], a[120:123], v[244:247], v[88:91]
    ds_read_u16 v249, v249
    ds_read_u16_d16_hi v248, v248
    v_fma_mix_f32 v208, v208, v210, 0 op_sel:[1,1,0] op_sel_hi:[1,1,0]
    v_mfma_f32_16x16x32_bf16 v[92:95], a[124:127], v[244:247], v[92:95]
    s_add_u32 m0, s56, 1920
    ds_read_u16 v251, v251
    ds_read_u16_d16_hi v250, v250
    v_mfma_f32_16x16x32_bf16 v[104:107], a[128:131], v[244:247], v[104:107]
    s_waitcnt lgkmcnt(11)
    ds_read_b128 v[196:199], v22 offset:256
    ds_read_b128 v[204:207], v22 offset:272
    v_or_b32 v240, v225, v224
    v_mfma_f32_16x16x32_bf16 v[108:111], a[132:135], v[244:247], v[108:111]
    buffer_load_dwordx4 v3, s[20:23], 0 offen offset:128 lds
    s_add_u32 m0, s56, 2944
    v_mfma_f32_16x16x32_bf16 v[120:123], a[136:139], v[244:247], v[120:123]
    buffer_load_dwordx4 v4, s[20:23], 0 offen offset:128 lds
    s_add_u32 m0, s56, 3968
    v_mfma_f32_16x16x32_bf16 v[124:127], a[140:143], v[244:247], v[124:127]
    s_waitcnt lgkmcnt(11)
    buffer_load_dwordx4 v5, s[20:23], 0 offen offset:128 lds
    v_or_b32 v241, v227, v226
    v_cvt_pk_bf16_f32 v246, v253, v252
    v_cvt_pk_bf16_f32 v247, v209, v208
    s_waitcnt lgkmcnt(9)
    v_or_b32 v242, v229, v228
    s_waitcnt lgkmcnt(7)
    v_or_b32 v243, v231, v230
    s_nop 1
    v_mfma_f32_16x16x32_bf16 v[80:83], a[168:171], v[240:243], v[80:83]
    s_add_u32 m0, s56, 4992
    ds_read_b128 v[200:203], v22 offset:16
    buffer_load_dwordx4 v6, s[20:23], 0 offen offset:128 lds
    v_mfma_f32_16x16x32_bf16 v[84:87], a[172:175], v[240:243], v[84:87]
    v_mfma_f32_16x16x32_bf16 v[96:99], a[176:179], v[240:243], v[96:99]
    s_waitcnt lgkmcnt(6)
    v_mfma_f32_16x16x32_bf16 v[100:103], a[180:183], v[240:243], v[100:103]
    s_add_u32 m0, s56, 6016
    s_waitcnt lgkmcnt(5)
    v_or_b32 v244, v249, v248
    v_mfma_f32_16x16x32_bf16 v[112:115], a[184:187], v[240:243], v[112:115]
    s_waitcnt lgkmcnt(4)
    buffer_load_dword v7, s[20:23], 0 offen offset:128 lds
    v_mfma_f32_16x16x32_bf16 v[116:119], a[188:191], v[240:243], v[116:119]
    s_add_u32 s52, s52, 1
    s_cmp_eq_u32 s52, 4
    s_waitcnt lgkmcnt(3)
    v_or_b32 v245, v251, v250
    s_cbranch_scc0 L_conv
L_last:
    s_branch L_final
.section .rodata,"a"
.p2align 6
.amdhsa_kernel standalone__modern_conv_block_convnext__vision_kernel
  .amdhsa_next_free_vgpr 512
  .amdhsa_next_free_sgpr 102
  .amdhsa_accum_offset 256
  .amdhsa_group_segment_fixed_size 0
  .amdhsa_kernarg_size 80
  .amdhsa_user_sgpr_count 2
  .amdhsa_user_sgpr_kernarg_segment_ptr 1
  .amdhsa_system_sgpr_workgroup_id_x 1
.end_amdhsa_kernel
```

```asm
; @launch grid=(256,1,1) block=(256,1,1) lds=163840
.amdgcn_target "amdgcn-amd-amdhsa--gfx950"
.text
.globl standalone__modern_conv_block_convnext__vision_kernel
.p2align 8
.type standalone__modern_conv_block_convnext__vision_kernel,@function
standalone__modern_conv_block_convnext__vision_kernel:
    s_cmp_ge_u32 s2, 256
    s_cbranch_scc1 L_end
    s_load_dwordx16 s[4:19], s[0:1], 0
    v_readfirstlane_b32 s3, v0
    v_and_b32 v129, 63, v0
    s_and_b32 s60, s2, 7
    s_lshr_b32 s61, s2, 7
    s_lshl1_add_u32 s60, s60, s61
    s_lshr_b32 s3, s3, 6
    s_getpc_b64 s[62:63]
L_pc:
    v_min_u32 v18, 2, v129
    s_lshr_b32 s71, s2, 3
    s_lshl2_add_u32 s71, s71, s3
    v_mad_u32_u24 v18, s71, 3, v18
    v_min_u32 v18, (L_last-L_pc)/128, v18
    v_lshlrev_b32 v18, 1, v18
    v_mad_u64_u32 v[18:19], vcc, v18, 64, s[62:63]
    global_load_dword v251, v[18:19], off
    s_bfe_u32 s61, s2, 0x40003
    s_lshl2_add_u32 s55, s61, s3
    s_mul_i32 s60, s60, 3145728
    s_mul_i32 s61, s55, 1536
    s_add_u32 s63, s60, s61
    s_sub_u32 s64, s63, 98496
    s_movk_i32 s65, 0
    s_movk_i32 s66, 2048
    s_cmp_eq_u32 s55, 0
    s_cmovk_i32 s65, 100
    s_cmovk_i32 s66, 1948
    s_cmp_eq_u32 s55, 63
    s_cmovk_i32 s66, 1800
    s_mul_i32 s56, s3, 12800
    s_add_u32 s56, s56, 90112
    s_mov_b32 s68, 96384
    v_lshrrev_b32 v131, 2, v129
    v_mul_u32_u24 v130, 205, v131
    v_mul_u32_u24 v131, 192, v131
    v_add_u32 v131, s64, v131
    v_lshlrev_b32 v132, 4, v0
    v_and_b32 v133, 16, v0
    v_bitop3_b32 v132, v132, v133, 48 bitop3:0x28
    v_bfrev_b32 v136, 1
    s_waitcnt lgkmcnt(0)
    s_mov_b32 s20, s4
    s_mov_b32 s21, s5
    s_mov_b32 s22, 50331648
    s_mov_b32 s23, 0x20000
    s_mulk_i32 s71, 640
    v_lshlrev_b32 v141, 7, v129
    v_cmp_gt_u32 vcc, 5, v129
    s_nop 1
    v_cndmask_b32 v141, v136, v141, vcc
    s_mov_b32 s44, s8
    s_mov_b32 s45, s9
    s_mov_b32 s46, 73728
    s_mov_b32 s47, 0x20000
    s_mov_b32 s48, s12
    s_mov_b32 s49, s13
    s_mov_b32 s50, 73728
    s_mov_b32 s51, 0x20000
    buffer_load_dword v142, v141, s[44:47], s71 offen
    buffer_load_dword v143, v141, s[48:51], s71 offen
    v_lshrrev_b32 v138, 5, v129
    s_movk_i32 s69, 192
    v_mul_u32_u24 v139, 1366, v0
    v_lshrrev_b32 v139, 16, v139
    v_mul_u32_u24 v139, 384, v139
    v_lshl_add_u32 v139, v0, 2, v139
    v_lshlrev_b32 v140, 3, v0
    s_mov_b32 s28, s6
    s_mov_b32 s29, s7
    s_mov_b32 s30, 1728
    s_mov_b32 s31, 0x20000
    s_mov_b32 s36, s14
    s_mov_b32 s37, s15
    s_mov_b32 s38, 192
    s_mov_b32 s39, 0x20000
    s_mov_b32 s40, s16
    s_mov_b32 s41, s17
    s_mov_b32 s42, 192
    s_mov_b32 s43, 0x20000
    s_mov_b32 s32, s10
    s_mov_b32 s33, s11
    s_mov_b32 s34, 768
    s_mov_b32 s35, 0x20000
    buffer_load_dword v144, v139, s[28:31], 0 offen
    buffer_load_dword v145, v139, s[28:31], 0 offen offset:192
    buffer_load_dword v146, v139, s[28:31], 0 offen offset:384
    buffer_load_dwordx2 v[148:149], v140, s[36:39], 0 offen
    buffer_load_dwordx2 v[150:151], v140, s[40:43], 0 offen
    s_cmp_ge_u32 s3, 2
    s_cbranch_scc1 L_prep1
L_prep0:
    v_bfe_u32 v158, v129, 2, 1
    v_bfe_u32 v159, v129, 3, 2
    v_lshl_add_u32 v159, v158, 2, v159
    v_and_b32 v160, 3, v129
    v_lshl_add_u32 v236, v138, 2, v160
    s_lshl_b32 s60, s3, 7
    v_lshl_add_u32 v236, v236, 4, s60
    v_mul_u32_u24 v159, 768, v159
    v_add_u32 v232, v159, v236
    v_add_u32 v233, 6144, v232
    v_and_b32 v159, 0x1c, v129
    v_cmp_eq_u32 vcc, 0x1c, v159
    s_mov_b32 s72, 72960
    s_mul_i32 s60, s3, 24576
    s_add_u32 s60, s60, 40960
    v_cndmask_b32 v237, v136, v236, vcc
    v_lshl_add_u32 v234, v129, 4, s60
    s_lshl_b32 s60, s3, 12
    s_add_u32 s60, s60, 40960
    v_mov_b32 v238, s60
    buffer_load_dwordx4 v[176:179], v236, s[44:47], s72 offen offset:0
    buffer_load_dwordx4 a[232:235], v237, s[32:35], 0 offen offset:0
    buffer_load_dwordx4 v[180:183], v236, s[44:47], s72 offen offset:256
    buffer_load_dwordx4 a[236:239], v237, s[32:35], 0 offen offset:256
    buffer_load_dwordx4 v[184:187], v236, s[44:47], s72 offen offset:512
    buffer_load_dwordx4 a[240:243], v237, s[32:35], 0 offen offset:512
    s_mov_b32 m0, s56
    s_movk_i32 s70, 5
L_xl0:
    v_lshrrev_b32 v134, 11, v130
    v_subrev_u32 v135, s65, v130
    v_mad_u32_u24 v134, v134, s68, v131
    v_and_b32 v135, 0x7ff, v135
    v_cmp_gt_u32 vcc, s66, v135
    v_lshrrev_b32 v135, 7, v130
    v_and_b32 v135, 32, v135
    v_xad_u32 v134, v132, v135, v134
    v_cndmask_b32 v134, v136, v134, vcc
    v_add_u32 v130, 3280, v130
    v_add_u32 v131, 3072, v131
    buffer_load_dwordx4 v134, s[20:23], 0 offen lds
    s_add_u32 m0, m0, 1024
    s_sub_u32 s70, s70, 1
    s_cbranch_scc0 L_xl0
    s_branch L_prb0
L_prep1:
    v_bfe_u32 v158, v129, 2, 1
    v_bfe_u32 v159, v129, 3, 2
    v_lshl_add_u32 v159, v158, 2, v159
    v_and_b32 v160, 3, v129
    v_lshl_add_u32 v159, v138, 4, v159
    s_lshl_b32 s60, s3, 6
    s_sub_u32 s60, s60, 128
    v_add_u32 v159, s60, v159
    v_xor_b32 v236, v138, v160
    v_lshlrev_b32 v236, 4, v236
    v_mad_u32_u24 v232, v159, s69, v236
    s_lshl_b32 s60, s3, 1
    s_sub_u32 s60, s60, 4
    v_add_u32 v159, s60, v158
    v_lshlrev_b32 v238, 11, v159
    v_add_u32 v238, 43008, v238
    v_mul_u32_u24 v159, 768, v159
    v_lshl_add_u32 v159, v158, 2, v159
    v_add_u32 v159, v160, v159
    v_bfe_u32 v160, v129, 3, 1
    v_lshl_add_u32 v159, v160, 6, v159
    v_lshrrev_b32 v160, 4, v129
    v_lshl_add_u32 v159, v160, 4, v159
    v_lshlrev_b32 v159, 4, v159
    v_add_u32 v234, 40960, v159
    v_xor_b32 v235, 64, v234
    buffer_load_dwordx4 v[208:211], v236, s[40:43], 0 offen offset:0
    buffer_load_dwordx4 v[212:215], v236, s[40:43], 0 offen offset:64
    buffer_load_dwordx4 v[216:219], v236, s[40:43], 0 offen offset:128
    s_mov_b32 m0, s56
    s_movk_i32 s70, 5
L_xl1:
    v_lshrrev_b32 v134, 11, v130
    v_subrev_u32 v135, s65, v130
    v_mad_u32_u24 v134, v134, s68, v131
    v_and_b32 v135, 0x7ff, v135
    v_cmp_gt_u32 vcc, s66, v135
    v_lshrrev_b32 v135, 7, v130
    v_and_b32 v135, 32, v135
    v_xad_u32 v134, v132, v135, v134
    v_cndmask_b32 v134, v136, v134, vcc
    v_add_u32 v130, 3280, v130
    v_add_u32 v131, 3072, v131
    buffer_load_dwordx4 v134, s[20:23], 0 offen lds
    s_add_u32 m0, m0, 1024
    s_sub_u32 s70, s70, 1
    s_cbranch_scc0 L_xl1
L_prb1:
    v_lshrrev_b32 v131, 4, v129
    v_add_u32 v131, 96, v131
    v_mul_u32_u24 v130, 205, v131
    v_mul_u32_u24 v131, 192, v131
    v_add_u32 v131, s64, v131
    v_lshlrev_b32 v133, 2, v129
    v_and_b32 v133, 63, v133
    v_lshrrev_b32 v134, 11, v130
    v_subrev_u32 v135, s65, v130
    v_mad_u32_u24 v134, v134, s68, v131
    v_and_b32 v135, 0x7ff, v135
    v_cmp_gt_u32 vcc, s66, v135
    v_lshrrev_b32 v135, 7, v130
    v_and_b32 v135, 32, v135
    v_xad_u32 v134, v133, v135, v134
    v_cndmask_b32 v7, v136, v134, vcc
    s_add_u32 m0, s56, 6144
    s_nop 0
    buffer_load_dword v7, s[20:23], 0 offen offset:0 lds
    v_lshrrev_b32 v131, 2, v129
    v_mul_u32_u24 v130, 205, v131
    v_mul_u32_u24 v131, 192, v131
    v_add_u32 v131, s64, v131
    v_lshrrev_b32 v134, 11, v130
    v_subrev_u32 v135, s65, v130
    v_mad_u32_u24 v134, v134, s68, v131
    v_and_b32 v135, 0x7ff, v135
    v_cmp_gt_u32 vcc, s66, v135
    v_lshrrev_b32 v135, 7, v130
    v_and_b32 v135, 32, v135
    v_xad_u32 v134, v132, v135, v134
    v_cndmask_b32 v1, v136, v134, vcc
    v_add_u32 v130, 3280, v130
    v_add_u32 v131, 3072, v131
    v_lshrrev_b32 v134, 11, v130
    v_subrev_u32 v135, s65, v130
    v_mad_u32_u24 v134, v134, s68, v131
    v_and_b32 v135, 0x7ff, v135
    v_cmp_gt_u32 vcc, s66, v135
    v_lshrrev_b32 v135, 7, v130
    v_and_b32 v135, 32, v135
    v_xad_u32 v134, v132, v135, v134
    v_cndmask_b32 v2, v136, v134, vcc
    v_add_u32 v130, 3280, v130
    v_add_u32 v131, 3072, v131
    v_lshrrev_b32 v134, 11, v130
    v_subrev_u32 v135, s65, v130
    v_mad_u32_u24 v134, v134, s68, v131
    v_and_b32 v135, 0x7ff, v135
    v_cmp_gt_u32 vcc, s66, v135
    v_lshrrev_b32 v135, 7, v130
    v_and_b32 v135, 32, v135
    v_xad_u32 v134, v132, v135, v134
    v_cndmask_b32 v3, v136, v134, vcc
    v_add_u32 v130, 3280, v130
    v_add_u32 v131, 3072, v131
    v_lshrrev_b32 v134, 11, v130
    v_subrev_u32 v135, s65, v130
    v_mad_u32_u24 v134, v134, s68, v131
    v_and_b32 v135, 0x7ff, v135
    v_cmp_gt_u32 vcc, s66, v135
    v_lshrrev_b32 v135, 7, v130
    v_and_b32 v135, 32, v135
    v_xad_u32 v134, v132, v135, v134
    v_cndmask_b32 v4, v136, v134, vcc
    v_add_u32 v130, 3280, v130
    v_add_u32 v131, 3072, v131
    v_lshrrev_b32 v134, 11, v130
    v_subrev_u32 v135, s65, v130
    v_mad_u32_u24 v134, v134, s68, v131
    v_and_b32 v135, 0x7ff, v135
    v_cmp_gt_u32 vcc, s66, v135
    v_lshrrev_b32 v135, 7, v130
    v_and_b32 v135, 32, v135
    v_xad_u32 v134, v132, v135, v134
    v_cndmask_b32 v5, v136, v134, vcc
    v_add_u32 v130, 3280, v130
    v_add_u32 v131, 3072, v131
    v_lshrrev_b32 v134, 11, v130
    v_subrev_u32 v135, s65, v130
    v_mad_u32_u24 v134, v134, s68, v131
    v_and_b32 v135, 0x7ff, v135
    v_cmp_gt_u32 vcc, s66, v135
    v_lshrrev_b32 v135, 7, v130
    v_and_b32 v135, 32, v135
    v_xad_u32 v134, v132, v135, v134
    v_cndmask_b32 v6, v136, v134, vcc
    s_cmp_lt_u32 s55, 63
    s_cselect_b32 s66, 10, 0
    s_add_u32 s64, s64, 1856
    v_mul_u32_u24 v134, 98304, v129
    v_add_u32 v134, s64, v134
    v_cmp_gt_u32 vcc, s66, v129
    s_nop 1
    v_cndmask_b32 v31, v136, v134, vcc
    v_mov_b32 v157, 268435456
    v_and_b32 v152, 15, v129
    v_lshrrev_b32 v153, 4, v129
    v_add_u32 v154, 4, v152
    v_lshrrev_b32 v154, 3, v154
    v_mad_i32_i24 v155, v154, -4, v152
    v_and_b32 v154, 1, v154
    v_and_b32 v156, 1, v153
    v_lshlrev_b32 v158, 1, v154
    v_mul_u32_u24 v159, 98304, v158
    v_mad_u32_u24 v159, v155, s69, v159
    v_lshl_add_u32 v159, v153, 4, v159
    v_add_u32 v26, s63, v159
    v_xor_b32 v161, v154, v138
    v_add_u32 v159, v153, v158
    v_add_u32 v160, 0, v155
    v_mad_u32_u24 v159, v159, 10, v160
    v_bfe_u32 v160, v159, 2, 1
    v_lshl_or_b32 v160, v161, 1, v160
    v_lshl_add_u32 v160, v159, 2, v160
    v_lshl_add_u32 v8, v160, 4, s56
    v_add_u32 v162, 1, v156
    v_add_u32 v159, v138, v158
    v_add_u32 v160, v162, v155
    v_mad_u32_u24 v159, v159, 10, v160
    v_bfe_u32 v160, v159, 2, 1
    v_lshl_or_b32 v160, v154, 1, v160
    v_lshl_add_u32 v160, v159, 2, v160
    v_lshl_add_u32 v12, v160, 4, s56
    v_xor_b32 v9, 16, v8
    v_xor_b32 v10, 32, v8
    v_xor_b32 v11, 48, v8
    v_xor_b32 v13, 16, v12
    v_xor_b32 v14, 32, v12
    v_xor_b32 v15, 48, v12
    v_add_u32 v159, 1, v158
    v_add_u32 v160, 1, v155
    v_mad_u32_u24 v159, v159, 10, v160
    v_bfe_u32 v160, v159, 2, 1
    v_lshl_or_b32 v160, v154, 1, v160
    v_xor_b32 v160, v153, v160
    v_lshl_add_u32 v160, v159, 2, v160
    v_lshl_add_u32 v20, v160, 4, s56
    v_xor_b32 v161, 1, v154
    v_add_u32 v159, 2, v158
    v_add_u32 v160, 1, v155
    v_mad_u32_u24 v159, v159, 10, v160
    v_bfe_u32 v160, v159, 2, 1
    v_lshl_or_b32 v160, v161, 1, v160
    v_xor_b32 v160, v153, v160
    v_lshl_add_u32 v160, v159, 2, v160
    v_lshl_add_u32 v21, v160, 4, s56
    v_bfe_u32 v158, v152, 2, 1
    v_sub_u32 v158, v153, v158
    v_and_b32 v159, 3, v152
    v_mul_u32_u24 v16, 0x1111, v159
    v_lshrrev_b32 v160, 3, v152
    v_lshl_add_u32 v159, v160, 2, v159
    v_lshlrev_b32 v159, 5, v159
    v_add_u32 v159, 141312, v159
    s_movk_i32 s70, 3072
    v_cmp_gt_u32 vcc, 3, v158
    v_mad_u32_u24 v159, v158, s70, v159
    s_nop 0
    v_cndmask_b32 v22, v157, v159, vcc
    v_lshlrev_b32 v23, 4, v129
    v_add_u32 v24, 40960, v23
    v_lshlrev_b32 v25, 5, v153
    v_add_u32 v25, 150528, v25
    v_and_b32 v160, 1, v129
    v_lshlrev_b32 v160, 4, v160
    v_mov_b32 v161, 0x3f80
    v_lshlrev_b32 v160, v160, v161
    v_bfe_u32 v158, v129, 1, 1
    v_bfe_u32 v159, v129, 3, 2
    v_lshl_add_u32 v159, v159, 1, v158
    v_bfe_u32 v161, v129, 2, 1
    v_xor_b32 v161, v161, v138
    v_lshl_add_u32 v159, v161, 3, v159
    v_lshlrev_b32 v159, v159, 1
    v_lshrrev_b32 v161, 2, v152
    v_xor_b32 v161, v161, v153
    v_lshl_add_u32 v158, v161, 1, v158
    v_lshlrev_b32 v158, v158, 1
    v_bfe_i32 v240, v159, 0, 1
    v_bfe_i32 v241, v159, 1, 1
    v_bfe_i32 v242, v159, 2, 1
    v_bfe_i32 v243, v159, 3, 1
    v_bfe_i32 v244, v159, 4, 1
    v_bfe_i32 v245, v159, 5, 1
    v_bfe_i32 v246, v159, 6, 1
    v_bfe_i32 v247, v159, 7, 1
    v_bfe_i32 v18, v158, 0, 1
    v_bfe_i32 v19, v158, 1, 1
    v_and_b32 v240, v160, v240
    v_and_b32 v241, v160, v241
    v_and_b32 v242, v160, v242
    v_and_b32 v243, v160, v243
    v_and_b32 v244, v160, v244
    v_and_b32 v245, v160, v245
    v_and_b32 v246, v160, v246
    v_and_b32 v247, v160, v247
    v_and_b32 v18, v160, v18
    v_and_b32 v19, v160, v19
    s_mov_b32 s24, s18
    s_mov_b32 s25, s19
    s_mov_b32 s26, 50331648
    s_mov_b32 s27, 0x20000
    s_mov_b32 s52, 0
    s_mov_b32 s80, 0
    s_mov_b32 s81, 98304
    s_mov_b32 s82, 393216
    s_mov_b32 s83, 491520
    s_mov_b32 s53, 1156138217
    s_mov_b32 s58, 0x3c003c00
    s_mov_b32 s85, 150912
    s_mov_b32 s86, 0x37803780
    s_mov_b32 s87, 0xffffffff
    s_mov_b32 s84, 0x37800000
    v_lshrrev_b32 v158, 2, v152
    v_xor_b32 v158, v158, v153
    v_bfe_i32 v158, v158, 0, 1
    v_bfi_b32 v158, v158, 0, s58
    v_accvgpr_write_b32 a228, v158
    v_accvgpr_write_b32 a229, v158
    v_accvgpr_write_b32 a230, v158
    v_accvgpr_write_b32 a231, v158
    v_and_b32 v17, v138, v153
    v_lshlrev_b32 v17, 4, v17
    v_lshrrev_b32 v17, v17, -1
    s_mov_b32 s73, 0x409d2a01
    s_mov_b32 s59, 0x3ef00000
    v_mul_u32_u24 v252, 0x100010, v0
    v_add_u32 v252, 0xc0004, v252
    v_lshlrev_b32 v253, 2, v0
    v_add_u32 v253, 150912, v253
    v_add_u32 v160, 0x0, v252
    v_add_u32 v168, 0x10001000, v252
    v_cvt_f32_f16 v161, v160
    v_cvt_f32_f16 v169, v168
    v_cvt_f32_f16_sdwa v162, v160 dst_sel:DWORD dst_unused:UNUSED_PAD src0_sel:WORD_1
    v_cvt_f32_f16_sdwa v170, v168 dst_sel:DWORD dst_unused:UNUSED_PAD src0_sel:WORD_1
    v_mul_f32 v163, 0x3f7fdde7, v161
    v_mul_f32 v171, 0x3f7fdde7, v169
    v_mul_f32 v164, 0x3f7fdde7, v162
    v_mul_f32 v172, 0x3f7fdde7, v170
    v_fma_f32 v163, v163, v161, s73
    v_fma_f32 v171, v171, v169, s73
    v_fma_f32 v164, v164, v162, s73
    v_fma_f32 v172, v172, v170, s73
    v_mul_f32 v163, -v161, v163
    v_mul_f32 v171, -v169, v171
    v_mul_f32 v164, -v162, v164
    v_mul_f32 v172, -v170, v172
    v_exp_f32 v165, v163
    v_exp_f32 v173, v171
    v_exp_f32 v166, v164
    v_exp_f32 v174, v172
    v_fma_f32 v163, v165, s59, s59
    v_fma_f32 v171, v173, s59, s59
    v_fma_f32 v164, v166, s59, s59
    v_fma_f32 v172, v174, s59, s59
    v_rcp_f32 v163, v163
    v_rcp_f32 v171, v171
    v_rcp_f32 v164, v164
    v_rcp_f32 v172, v172
    v_mul_f32 v163, v161, v163
    v_mul_f32 v171, v169, v171
    v_mul_f32 v164, v162, v164
    v_mul_f32 v172, v170, v172
    v_mul_f32 v165, -v165, v163
    v_mul_f32 v173, -v173, v171
    v_mul_f32 v166, -v166, v164
    v_mul_f32 v174, -v174, v172
    v_cvt_pk_bf16_f32 v167, v165, v166
    v_cvt_pk_bf16_f32 v175, v173, v174
    v_cvt_pk_bf16_f32 v160, v163, v164
    v_cvt_pk_bf16_f32 v168, v171, v172
    ds_write_b32 v253, v167 offset:8192
    ds_write_b32 v253, v160 offset:0
    ds_write_b32 v253, v175 offset:9216
    ds_write_b32 v253, v168 offset:1024
    v_add_u32 v160, 0x20002000, v252
    s_nop 0
    v_add_u32 v168, 0x30003000, v252
    v_cvt_f32_f16 v161, v160
    v_cvt_f32_f16 v169, v168
    v_cvt_f32_f16_sdwa v162, v160 dst_sel:DWORD dst_unused:UNUSED_PAD src0_sel:WORD_1
    v_cvt_f32_f16_sdwa v170, v168 dst_sel:DWORD dst_unused:UNUSED_PAD src0_sel:WORD_1
    v_mul_f32 v163, 0x3f7fdde7, v161
    v_mul_f32 v171, 0x3f7fdde7, v169
    v_mul_f32 v164, 0x3f7fdde7, v162
    v_mul_f32 v172, 0x3f7fdde7, v170
    v_fma_f32 v163, v163, v161, s73
    v_fma_f32 v171, v171, v169, s73
    v_fma_f32 v164, v164, v162, s73
    v_fma_f32 v172, v172, v170, s73
    v_mul_f32 v163, -v161, v163
    v_mul_f32 v171, -v169, v171
    v_mul_f32 v164, -v162, v164
    v_mul_f32 v172, -v170, v172
    v_exp_f32 v165, v163
    v_exp_f32 v173, v171
    v_exp_f32 v166, v164
    v_exp_f32 v174, v172
    v_fma_f32 v163, v165, s59, s59
    v_fma_f32 v171, v173, s59, s59
    v_fma_f32 v164, v166, s59, s59
    v_fma_f32 v172, v174, s59, s59
    v_rcp_f32 v163, v163
    v_rcp_f32 v171, v171
    v_rcp_f32 v164, v164
    v_rcp_f32 v172, v172
    v_mul_f32 v163, v161, v163
    v_mul_f32 v171, v169, v171
    v_mul_f32 v164, v162, v164
    v_mul_f32 v172, v170, v172
    v_mul_f32 v165, -v165, v163
    v_mul_f32 v173, -v173, v171
    v_mul_f32 v166, -v166, v164
    v_mul_f32 v174, -v174, v172
    v_cvt_pk_bf16_f32 v167, v165, v166
    v_cvt_pk_bf16_f32 v175, v173, v174
    v_cvt_pk_bf16_f32 v160, v163, v164
    v_cvt_pk_bf16_f32 v168, v171, v172
    ds_write_b32 v253, v167 offset:10240
    ds_write_b32 v253, v160 offset:2048
    ds_write_b32 v253, v175 offset:11264
    ds_write_b32 v253, v168 offset:3072
    v_add_u32 v160, 0x40004000, v252
    s_nop 0
    v_add_u32 v168, 0x50005000, v252
    v_cvt_f32_f16 v161, v160
    v_cvt_f32_f16 v169, v168
    v_cvt_f32_f16_sdwa v162, v160 dst_sel:DWORD dst_unused:UNUSED_PAD src0_sel:WORD_1
    v_cvt_f32_f16_sdwa v170, v168 dst_sel:DWORD dst_unused:UNUSED_PAD src0_sel:WORD_1
    v_mul_f32 v163, 0x3f7fdde7, v161
    v_mul_f32 v171, 0x40088889, v169
    v_mul_f32 v164, 0x3f7fdde7, v162
    v_mul_f32 v172, 0x40088889, v170
    v_fma_f32 v163, v163, v161, s73
    v_cvt_pk_bf16_f32 v168, v171, v172
    v_fma_f32 v164, v164, v162, s73
    v_mul_f32 v163, -v161, v163
    v_mul_f32 v164, -v162, v164
    v_exp_f32 v165, v163
    v_exp_f32 v166, v164
    v_fma_f32 v163, v165, s59, s59
    v_fma_f32 v164, v166, s59, s59
    v_rcp_f32 v163, v163
    v_rcp_f32 v164, v164
    v_mul_f32 v163, v161, v163
    v_mul_f32 v164, v162, v164
    v_mul_f32 v165, -v165, v163
    v_mul_f32 v166, -v166, v164
    v_cvt_pk_bf16_f32 v167, v165, v166
    v_cvt_pk_bf16_f32 v160, v163, v164
    ds_write_b32 v253, v167 offset:12288
    ds_write_b32 v253, v160 offset:4096
    ds_write_b32 v253, v168 offset:5120
    s_nop 0
    v_add_u32 v160, 0x60006000, v252
    v_add_u32 v168, 0x70007000, v252
    v_cvt_f32_f16 v161, v160
    v_cvt_f32_f16 v169, v168
    v_cvt_f32_f16_sdwa v162, v160 dst_sel:DWORD dst_unused:UNUSED_PAD src0_sel:WORD_1
    v_cvt_f32_f16_sdwa v170, v168 dst_sel:DWORD dst_unused:UNUSED_PAD src0_sel:WORD_1
    v_mul_f32 v163, 0x40088889, v161
    v_mul_f32 v171, 0x40088889, v169
    v_mul_f32 v164, 0x40088889, v162
    v_mul_f32 v172, 0x40088889, v170
    v_cvt_pk_bf16_f32 v160, v163, v164
    v_cvt_pk_bf16_f32 v168, v171, v172
    ds_write_b32 v253, v160 offset:6144
    ds_write_b32 v253, v168 offset:7168
    v_lshlrev_b32 v158, 6, v0
    v_add_u32 v158, 141312, v158
    v_cmp_gt_u32 vcc, 144, v0
    s_nop 1
    v_cndmask_b32 v158, v157, v158, vcc
    v_and_b32 v159, 3, v0
    v_lshl_add_u32 v160, v159, 2, v158
    v_lshrrev_b32 v159, 1, v159
    v_lshl_add_u32 v159, v159, 2, v158
    v_lshlrev_b32 v161, 4, v0
    v_add_u32 v161, 150528, v161
    v_cmp_gt_u32 vcc, 24, v0
    s_nop 1
    v_cndmask_b32 v161, v157, v161, vcc
    v_mov_b32 v164, 0
    v_mov_b32 v165, 0
    v_mov_b32 v166, 0
    v_mov_b32 v167, 0
    ds_write_b128 v158, v[164:167]
    ds_write_b128 v158, v[164:167] offset:16
    s_waitcnt lgkmcnt(9)
    ds_write_b128 v158, v[164:167] offset:32
    ds_write_b128 v158, v[164:167] offset:48
    s_waitcnt vmcnt(14)
    ds_write_b16 v160, v144
    ds_write_b16_d16_hi v160, v144 offset:34
    s_waitcnt vmcnt(13)
    ds_write_b16 v159, v145 offset:16
    ds_write_b16_d16_hi v159, v145 offset:48
    s_waitcnt vmcnt(12) lgkmcnt(13)
    ds_write_b16 v159, v146 offset:24
    ds_write_b16_d16_hi v159, v146 offset:56
    s_waitcnt vmcnt(11)
    v_lshlrev_b32 v168, 16, v148
    v_and_b32 v169, 0xffff0000, v148
    v_lshlrev_b32 v170, 16, v149
    v_and_b32 v171, 0xffff0000, v149
    s_waitcnt vmcnt(10)
    v_lshlrev_b32 v172, 16, v150
    v_and_b32 v173, 0xffff0000, v150
    v_lshlrev_b32 v174, 16, v151
    v_and_b32 v175, 0xffff0000, v151
    v_mul_f32 v168, v168, v172
    v_mul_f32 v169, v169, v173
    v_mul_f32 v170, v170, v174
    v_mul_f32 v171, v171, v175
    s_waitcnt lgkmcnt(14)
    ds_write_b128 v161, v[168:171]
    s_waitcnt vmcnt(9)
    v_mfma_f32_32x32x16_bf16 v[176:191], v[208:211], v[240:243], 0
    v_mfma_f32_32x32x16_bf16 v[176:191], v[208:211], v[244:247], v[176:191]
    s_waitcnt vmcnt(8)
    s_nop 10
    v_mfma_f32_32x32x16_bf16 v[180:195], v[212:215], v[240:243], 0
    v_mfma_f32_32x32x16_bf16 v[180:195], v[212:215], v[244:247], v[180:195]
    s_waitcnt vmcnt(7)
    s_nop 10
    v_mfma_f32_32x32x16_bf16 v[184:199], v[216:219], v[240:243], 0
    v_mfma_f32_32x32x16_bf16 v[184:199], v[216:219], v[244:247], v[184:199]
    s_mov_b32 s74, 0
    s_mov_b32 s75, 6144
    buffer_load_dwordx4 a[0:3], v232, s[48:51], s74 offen offset:0
    buffer_load_dwordx4 a[4:7], v232, s[48:51], s75 offen offset:0
    buffer_load_dwordx4 a[8:11], v232, s[48:51], s74 offen offset:1536
    buffer_load_dwordx4 a[12:15], v232, s[48:51], s75 offen offset:1536
    buffer_load_dwordx4 a[16:19], v232, s[48:51], s74 offen offset:64
    buffer_load_dwordx4 a[20:23], v232, s[48:51], s75 offen offset:64
    buffer_load_dwordx4 a[24:27], v232, s[48:51], s74 offen offset:1600
    buffer_load_dwordx4 a[28:31], v232, s[48:51], s75 offen offset:1600
    buffer_load_dwordx4 a[32:35], v232, s[48:51], s74 offen offset:128
    buffer_load_dwordx4 a[36:39], v232, s[48:51], s75 offen offset:128
    buffer_load_dwordx4 a[40:43], v232, s[48:51], s74 offen offset:1664
    buffer_load_dwordx4 a[44:47], v232, s[48:51], s75 offen offset:1664
    s_mov_b32 s74, 24576
    s_mov_b32 s75, 30720
    buffer_load_dwordx4 a[48:51], v232, s[48:51], s74 offen offset:0
    buffer_load_dwordx4 a[52:55], v232, s[48:51], s75 offen offset:0
    buffer_load_dwordx4 a[56:59], v232, s[48:51], s74 offen offset:1536
    buffer_load_dwordx4 a[60:63], v232, s[48:51], s75 offen offset:1536
    buffer_load_dwordx4 a[64:67], v232, s[48:51], s74 offen offset:64
    buffer_load_dwordx4 a[68:71], v232, s[48:51], s75 offen offset:64
    buffer_load_dwordx4 a[72:75], v232, s[48:51], s74 offen offset:1600
    buffer_load_dwordx4 a[76:79], v232, s[48:51], s75 offen offset:1600
    buffer_load_dwordx4 a[80:83], v232, s[48:51], s74 offen offset:128
    buffer_load_dwordx4 a[84:87], v232, s[48:51], s75 offen offset:128
    buffer_load_dwordx4 a[88:91], v232, s[48:51], s74 offen offset:1664
    buffer_load_dwordx4 a[92:95], v232, s[48:51], s75 offen offset:1664
    s_waitcnt vmcnt(23)
    v_mfma_f32_32x32x16_bf16 v[80:95], a[0:3], v[240:243], 0
    s_waitcnt vmcnt(21)
    v_mfma_f32_32x32x16_bf16 v[96:111], a[8:11], v[240:243], 0
    v_mfma_f32_32x32x16_bf16 v[80:95], a[4:7], v[244:247], v[80:95]
    s_waitcnt vmcnt(20)
    v_mfma_f32_32x32x16_bf16 v[96:111], a[12:15], v[244:247], v[96:111]
    s_waitcnt vmcnt(19)
    v_mfma_f32_32x32x16_bf16 v[112:127], a[16:19], v[240:243], 0
    s_waitcnt vmcnt(17)
    v_mfma_f32_32x32x16_bf16 v[128:143], a[24:27], v[240:243], 0
    v_mfma_f32_32x32x16_bf16 v[112:127], a[20:23], v[244:247], v[112:127]
    s_waitcnt vmcnt(16)
    v_mfma_f32_32x32x16_bf16 v[128:143], a[28:31], v[244:247], v[128:143]
    s_nop 2
    v_pk_mul_f32 v[80:81], v[80:81], v[176:177]
    v_pk_mul_f32 v[84:85], v[84:85], v[176:177]
    v_pk_mul_f32 v[88:89], v[88:89], v[176:177]
    v_pk_mul_f32 v[92:93], v[92:93], v[176:177]
    v_pk_mul_f32 v[96:97], v[96:97], v[176:177]
    v_pk_mul_f32 v[100:101], v[100:101], v[176:177]
    v_pk_mul_f32 v[104:105], v[104:105], v[176:177]
    v_pk_mul_f32 v[108:109], v[108:109], v[176:177]
    v_cvt_pk_bf16_f32 v224, v80, v84
    v_cvt_pk_bf16_f32 v225, v88, v92
    v_cvt_pk_bf16_f32 v226, v96, v100
    v_cvt_pk_bf16_f32 v227, v104, v108
    s_waitcnt vmcnt(15)
    v_mfma_f32_32x32x16_bf16 v[144:159], a[32:35], v[240:243], 0
    s_waitcnt lgkmcnt(14)
    ds_write_b128 v234, v[224:227] offset:6144
    s_mov_b32 s74, 49152
    v_cvt_pk_bf16_f32 v228, v81, v85
    v_cvt_pk_bf16_f32 v229, v89, v93
    v_cvt_pk_bf16_f32 v230, v97, v101
    v_cvt_pk_bf16_f32 v231, v105, v109
    s_waitcnt vmcnt(13)
    v_mfma_f32_32x32x16_bf16 v[160:175], a[40:43], v[240:243], 0
    s_waitcnt lgkmcnt(14)
    ds_write_b128 v235, v[228:231] offset:6144
    s_mov_b32 s75, 55296
    buffer_load_dwordx4 v[32:35], v232, s[48:51], s74 offen offset:0
    v_pk_mul_f32 v[82:83], v[82:83], v[178:179]
    v_pk_mul_f32 v[86:87], v[86:87], v[178:179]
    v_pk_mul_f32 v[90:91], v[90:91], v[178:179]
    v_pk_mul_f32 v[94:95], v[94:95], v[178:179]
    v_pk_mul_f32 v[98:99], v[98:99], v[178:179]
    v_pk_mul_f32 v[102:103], v[102:103], v[178:179]
    v_pk_mul_f32 v[106:107], v[106:107], v[178:179]
    v_pk_mul_f32 v[110:111], v[110:111], v[178:179]
    v_cvt_pk_bf16_f32 v224, v82, v86
    v_cvt_pk_bf16_f32 v225, v90, v94
    v_cvt_pk_bf16_f32 v226, v98, v102
    v_cvt_pk_bf16_f32 v227, v106, v110
    v_mfma_f32_32x32x16_bf16 v[144:159], a[36:39], v[244:247], v[144:159]
    s_waitcnt lgkmcnt(14)
    ds_write_b128 v234, v[224:227] offset:6272
    buffer_load_dwordx4 v[36:39], v232, s[48:51], s75 offen offset:0
    v_cvt_pk_bf16_f32 v228, v83, v87
    v_cvt_pk_bf16_f32 v229, v91, v95
    v_cvt_pk_bf16_f32 v230, v99, v103
    v_cvt_pk_bf16_f32 v231, v107, v111
    s_waitcnt vmcnt(14)
    v_mfma_f32_32x32x16_bf16 v[160:175], a[44:47], v[244:247], v[160:175]
    s_waitcnt vmcnt(10)
    s_waitcnt lgkmcnt(14)
    ds_write_b128 v235, v[228:231] offset:6272
    buffer_load_dwordx4 v[40:43], v232, s[48:51], s74 offen offset:1536
    buffer_load_dwordx4 v[44:47], v232, s[48:51], s75 offen offset:1536
    v_pk_mul_f32 v[112:113], v[112:113], v[180:181]
    v_pk_mul_f32 v[116:117], v[116:117], v[180:181]
    v_pk_mul_f32 v[120:121], v[120:121], v[180:181]
    v_pk_mul_f32 v[124:125], v[124:125], v[180:181]
    v_pk_mul_f32 v[128:129], v[128:129], v[180:181]
    v_pk_mul_f32 v[132:133], v[132:133], v[180:181]
    v_pk_mul_f32 v[136:137], v[136:137], v[180:181]
    v_pk_mul_f32 v[140:141], v[140:141], v[180:181]
    v_cvt_pk_bf16_f32 v224, v112, v116
    v_cvt_pk_bf16_f32 v225, v120, v124
    v_cvt_pk_bf16_f32 v226, v128, v132
    v_cvt_pk_bf16_f32 v227, v136, v140
    v_mfma_f32_32x32x16_bf16 v[80:95], a[48:51], v[240:243], 0
    s_waitcnt lgkmcnt(14)
    ds_write_b128 v234, v[224:227] offset:8192
    buffer_load_dwordx4 v[48:51], v232, s[48:51], s74 offen offset:64
    v_cvt_pk_bf16_f32 v228, v113, v117
    v_cvt_pk_bf16_f32 v229, v121, v125
    v_cvt_pk_bf16_f32 v230, v129, v133
    v_cvt_pk_bf16_f32 v231, v137, v141
    v_mfma_f32_32x32x16_bf16 v[96:111], a[56:59], v[240:243], 0
    s_waitcnt lgkmcnt(14)
    ds_write_b128 v235, v[228:231] offset:8192
    buffer_load_dwordx4 v[52:55], v232, s[48:51], s75 offen offset:64
    v_pk_mul_f32 v[114:115], v[114:115], v[182:183]
    v_pk_mul_f32 v[118:119], v[118:119], v[182:183]
    v_pk_mul_f32 v[122:123], v[122:123], v[182:183]
    v_pk_mul_f32 v[126:127], v[126:127], v[182:183]
    v_pk_mul_f32 v[130:131], v[130:131], v[182:183]
    v_pk_mul_f32 v[134:135], v[134:135], v[182:183]
    v_pk_mul_f32 v[138:139], v[138:139], v[182:183]
    v_pk_mul_f32 v[142:143], v[142:143], v[182:183]
    v_cvt_pk_bf16_f32 v224, v114, v118
    v_cvt_pk_bf16_f32 v225, v122, v126
    v_cvt_pk_bf16_f32 v226, v130, v134
    v_cvt_pk_bf16_f32 v227, v138, v142
    v_mfma_f32_32x32x16_bf16 v[80:95], a[52:55], v[244:247], v[80:95]
    s_waitcnt lgkmcnt(14)
    ds_write_b128 v234, v[224:227] offset:8320
    buffer_load_dwordx4 v[56:59], v232, s[48:51], s74 offen offset:1600
    v_cvt_pk_bf16_f32 v228, v115, v119
    v_cvt_pk_bf16_f32 v229, v123, v127
    v_cvt_pk_bf16_f32 v230, v131, v135
    v_cvt_pk_bf16_f32 v231, v139, v143
    v_mfma_f32_32x32x16_bf16 v[96:111], a[60:63], v[244:247], v[96:111]
    s_waitcnt vmcnt(11)
    s_waitcnt lgkmcnt(14)
    ds_write_b128 v235, v[228:231] offset:8320
    buffer_load_dwordx4 v[60:63], v232, s[48:51], s75 offen offset:1600
    v_pk_mul_f32 v[144:145], v[144:145], v[184:185]
    v_pk_mul_f32 v[148:149], v[148:149], v[184:185]
    v_pk_mul_f32 v[152:153], v[152:153], v[184:185]
    v_pk_mul_f32 v[156:157], v[156:157], v[184:185]
    v_pk_mul_f32 v[160:161], v[160:161], v[184:185]
    v_pk_mul_f32 v[164:165], v[164:165], v[184:185]
    v_pk_mul_f32 v[168:169], v[168:169], v[184:185]
    v_pk_mul_f32 v[172:173], v[172:173], v[184:185]
    v_cvt_pk_bf16_f32 v224, v144, v148
    v_cvt_pk_bf16_f32 v225, v152, v156
    v_cvt_pk_bf16_f32 v226, v160, v164
    v_cvt_pk_bf16_f32 v227, v168, v172
    v_mfma_f32_32x32x16_bf16 v[112:127], a[64:67], v[240:243], 0
    s_waitcnt lgkmcnt(14)
    ds_write_b128 v234, v[224:227] offset:10240
    buffer_load_dwordx4 v[64:67], v232, s[48:51], s74 offen offset:128
    v_cvt_pk_bf16_f32 v228, v145, v149
    v_cvt_pk_bf16_f32 v229, v153, v157
    v_cvt_pk_bf16_f32 v230, v161, v165
    v_cvt_pk_bf16_f32 v231, v169, v173
    v_mfma_f32_32x32x16_bf16 v[128:143], a[72:75], v[240:243], 0
    s_waitcnt lgkmcnt(14)
    ds_write_b128 v235, v[228:231] offset:10240
    buffer_load_dwordx4 v[68:71], v232, s[48:51], s75 offen offset:128
    v_pk_mul_f32 v[146:147], v[146:147], v[186:187]
    v_pk_mul_f32 v[150:151], v[150:151], v[186:187]
    v_pk_mul_f32 v[154:155], v[154:155], v[186:187]
    v_pk_mul_f32 v[158:159], v[158:159], v[186:187]
    v_pk_mul_f32 v[162:163], v[162:163], v[186:187]
    v_pk_mul_f32 v[166:167], v[166:167], v[186:187]
    v_pk_mul_f32 v[170:171], v[170:171], v[186:187]
    v_pk_mul_f32 v[174:175], v[174:175], v[186:187]
    v_cvt_pk_bf16_f32 v224, v146, v150
    v_cvt_pk_bf16_f32 v225, v154, v158
    v_cvt_pk_bf16_f32 v226, v162, v166
    v_cvt_pk_bf16_f32 v227, v170, v174
    v_mfma_f32_32x32x16_bf16 v[112:127], a[68:71], v[244:247], v[112:127]
    s_waitcnt lgkmcnt(14)
    ds_write_b128 v234, v[224:227] offset:10368
    buffer_load_dwordx4 v[72:75], v232, s[48:51], s74 offen offset:1664
    v_cvt_pk_bf16_f32 v228, v147, v151
    v_cvt_pk_bf16_f32 v229, v155, v159
    v_cvt_pk_bf16_f32 v230, v163, v167
    v_cvt_pk_bf16_f32 v231, v171, v175
    v_mfma_f32_32x32x16_bf16 v[128:143], a[76:79], v[244:247], v[128:143]
    s_waitcnt vmcnt(11)
    s_waitcnt lgkmcnt(14)
    ds_write_b128 v235, v[228:231] offset:10368
    buffer_load_dwordx4 v[76:79], v232, s[48:51], s75 offen offset:1664
    v_sub_u32 v234, v234, v238
    v_sub_u32 v235, v235, v238
    v_pk_mul_f32 v[80:81], v[80:81], v[176:177]
    v_pk_mul_f32 v[84:85], v[84:85], v[176:177]
    v_pk_mul_f32 v[88:89], v[88:89], v[176:177]
    v_pk_mul_f32 v[92:93], v[92:93], v[176:177]
    v_pk_mul_f32 v[96:97], v[96:97], v[176:177]
    v_pk_mul_f32 v[100:101], v[100:101], v[176:177]
    v_pk_mul_f32 v[104:105], v[104:105], v[176:177]
    v_pk_mul_f32 v[108:109], v[108:109], v[176:177]
    v_cvt_pk_bf16_f32 v224, v80, v84
    v_cvt_pk_bf16_f32 v225, v88, v92
    v_cvt_pk_bf16_f32 v226, v96, v100
    v_cvt_pk_bf16_f32 v227, v104, v108
    v_mfma_f32_32x32x16_bf16 v[144:159], a[80:83], v[240:243], 0
    s_waitcnt lgkmcnt(14)
    ds_write_b128 v234, v[224:227] offset:6144
    s_add_u32 m0, s56, 6336
    s_nop 0
    buffer_load_dwordx4 v1, s[20:23], 0 offen offset:64 lds
    v_cvt_pk_bf16_f32 v228, v81, v85
    v_cvt_pk_bf16_f32 v229, v89, v93
    v_cvt_pk_bf16_f32 v230, v97, v101
    v_cvt_pk_bf16_f32 v231, v105, v109
    v_mfma_f32_32x32x16_bf16 v[160:175], a[88:91], v[240:243], 0
    s_waitcnt lgkmcnt(14)
    ds_write_b128 v235, v[228:231] offset:6144
    s_add_u32 m0, s56, 7360
    s_nop 0
    buffer_load_dwordx4 v2, s[20:23], 0 offen offset:64 lds
    v_pk_mul_f32 v[82:83], v[82:83], v[178:179]
    v_pk_mul_f32 v[86:87], v[86:87], v[178:179]
    v_pk_mul_f32 v[90:91], v[90:91], v[178:179]
    v_pk_mul_f32 v[94:95], v[94:95], v[178:179]
    v_pk_mul_f32 v[98:99], v[98:99], v[178:179]
    v_pk_mul_f32 v[102:103], v[102:103], v[178:179]
    v_pk_mul_f32 v[106:107], v[106:107], v[178:179]
    v_pk_mul_f32 v[110:111], v[110:111], v[178:179]
    v_cvt_pk_bf16_f32 v224, v82, v86
    v_cvt_pk_bf16_f32 v225, v90, v94
    v_cvt_pk_bf16_f32 v226, v98, v102
    v_cvt_pk_bf16_f32 v227, v106, v110
    v_mfma_f32_32x32x16_bf16 v[144:159], a[84:87], v[244:247], v[144:159]
    s_waitcnt lgkmcnt(14)
    ds_write_b128 v234, v[224:227] offset:6272
    s_add_u32 m0, s56, 8384
    s_nop 0
    buffer_load_dwordx4 v3, s[20:23], 0 offen offset:64 lds
    v_cvt_pk_bf16_f32 v228, v83, v87
    v_cvt_pk_bf16_f32 v229, v91, v95
    v_cvt_pk_bf16_f32 v230, v99, v103
    v_cvt_pk_bf16_f32 v231, v107, v111
    v_mfma_f32_32x32x16_bf16 v[160:175], a[92:95], v[244:247], v[160:175]
    s_waitcnt vmcnt(11)
    s_waitcnt lgkmcnt(14)
    ds_write_b128 v235, v[228:231] offset:6272
    s_add_u32 m0, s56, 9408
    s_nop 0
    buffer_load_dwordx4 v4, s[20:23], 0 offen offset:64 lds
    v_pk_mul_f32 v[112:113], v[112:113], v[180:181]
    v_pk_mul_f32 v[116:117], v[116:117], v[180:181]
    v_pk_mul_f32 v[120:121], v[120:121], v[180:181]
    v_pk_mul_f32 v[124:125], v[124:125], v[180:181]
    v_pk_mul_f32 v[128:129], v[128:129], v[180:181]
    v_pk_mul_f32 v[132:133], v[132:133], v[180:181]
    v_pk_mul_f32 v[136:137], v[136:137], v[180:181]
    v_pk_mul_f32 v[140:141], v[140:141], v[180:181]
    v_cvt_pk_bf16_f32 v224, v112, v116
    v_cvt_pk_bf16_f32 v225, v120, v124
    v_cvt_pk_bf16_f32 v226, v128, v132
    v_cvt_pk_bf16_f32 v227, v136, v140
    v_mfma_f32_32x32x16_bf16 v[80:95], v[32:35], v[240:243], 0
    s_waitcnt lgkmcnt(0)
    s_barrier
    ds_write_b128 v234, v[224:227] offset:8192
    ds_read_b128 a[192:195], v23 offset:4096
    ds_read_b128 a[196:199], v23 offset:5120
    ds_read_b128 a[200:203], v23 offset:14336
    ds_read_b128 a[204:207], v23 offset:15360
    ds_read_b128 a[208:211], v23 offset:24576
    ds_read_b128 a[212:215], v23 offset:25600
    ds_read_b128 a[216:219], v23 offset:34816
    s_add_u32 m0, s56, 10432
    v_cvt_pk_bf16_f32 v228, v113, v117
    v_cvt_pk_bf16_f32 v229, v121, v125
    v_cvt_pk_bf16_f32 v230, v129, v133
    v_cvt_pk_bf16_f32 v231, v137, v141
    v_mfma_f32_32x32x16_bf16 v[96:111], v[40:43], v[240:243], 0
    ds_write_b128 v235, v[228:231] offset:8192
    ds_read_b128 a[220:223], v23 offset:35840
    ds_read_b128 a[0:3], v24 offset:0
    ds_read_b128 a[4:7], v24 offset:1024
    ds_read_b128 a[24:27], v24 offset:6144
    ds_read_b128 a[28:31], v24 offset:7168
    ds_read_b128 a[96:99], v24 offset:24576
    s_waitcnt lgkmcnt(14)
    ds_read_b128 a[100:103], v24 offset:25600
    buffer_load_dwordx4 v5, s[20:23], 0 offen offset:64 lds
    s_add_u32 m0, s56, 11456
    v_pk_mul_f32 v[114:115], v[114:115], v[182:183]
    v_pk_mul_f32 v[118:119], v[118:119], v[182:183]
    v_pk_mul_f32 v[122:123], v[122:123], v[182:183]
    v_pk_mul_f32 v[126:127], v[126:127], v[182:183]
    v_pk_mul_f32 v[130:131], v[130:131], v[182:183]
    v_pk_mul_f32 v[134:135], v[134:135], v[182:183]
    v_pk_mul_f32 v[138:139], v[138:139], v[182:183]
    v_pk_mul_f32 v[142:143], v[142:143], v[182:183]
    v_cvt_pk_bf16_f32 v224, v114, v118
    v_cvt_pk_bf16_f32 v225, v122, v126
    v_cvt_pk_bf16_f32 v226, v130, v134
    v_cvt_pk_bf16_f32 v227, v138, v142
    v_mfma_f32_32x32x16_bf16 v[80:95], v[36:39], v[244:247], v[80:95]
    s_waitcnt lgkmcnt(9)
    ds_write_b128 v234, v[224:227] offset:8320
    ds_read_b128 a[120:123], v24 offset:30720
    ds_read_b128 a[124:127], v24 offset:31744
    ds_read_b128 a[144:147], v24 offset:36864
    ds_read_b128 a[148:151], v24 offset:37888
    ds_read_b128 a[168:171], v24 offset:43008
    s_waitcnt lgkmcnt(13)
    ds_read_b128 a[172:175], v24 offset:44032
    ds_read_b128 a[48:51], v24 offset:12288
    buffer_load_dwordx4 v6, s[20:23], 0 offen offset:64 lds
    s_add_u32 m0, s56, 12480
    v_cvt_pk_bf16_f32 v228, v115, v119
    v_cvt_pk_bf16_f32 v229, v123, v127
    v_cvt_pk_bf16_f32 v230, v131, v135
    v_cvt_pk_bf16_f32 v231, v139, v143
    v_mfma_f32_32x32x16_bf16 v[96:111], v[44:47], v[244:247], v[96:111]
    s_waitcnt vmcnt(10)
    s_waitcnt lgkmcnt(9)
    ds_write_b128 v235, v[228:231] offset:8320
    ds_read_b128 a[52:55], v24 offset:13312
    ds_read_b128 a[72:75], v24 offset:18432
    ds_read_b128 a[76:79], v24 offset:19456
    ds_read_b128 a[8:11], v24 offset:2048
    ds_read_b128 a[12:15], v24 offset:3072
    s_waitcnt lgkmcnt(13)
    ds_read_b128 a[32:35], v24 offset:8192
    ds_read_b128 a[36:39], v24 offset:9216
    buffer_load_dword v7, s[20:23], 0 offen offset:64 lds
    buffer_load_dword v254, v31, s[20:23], 0 offen
    v_pk_mul_f32 v[144:145], v[144:145], v[184:185]
    v_pk_mul_f32 v[148:149], v[148:149], v[184:185]
    v_pk_mul_f32 v[152:153], v[152:153], v[184:185]
    v_pk_mul_f32 v[156:157], v[156:157], v[184:185]
    v_pk_mul_f32 v[160:161], v[160:161], v[184:185]
    v_pk_mul_f32 v[164:165], v[164:165], v[184:185]
    v_pk_mul_f32 v[168:169], v[168:169], v[184:185]
    v_pk_mul_f32 v[172:173], v[172:173], v[184:185]
    v_cvt_pk_bf16_f32 v224, v144, v148
    v_cvt_pk_bf16_f32 v225, v152, v156
    v_cvt_pk_bf16_f32 v226, v160, v164
    v_cvt_pk_bf16_f32 v227, v168, v172
    v_mfma_f32_32x32x16_bf16 v[112:127], v[48:51], v[240:243], 0
    s_waitcnt lgkmcnt(9)
    ds_write_b128 v234, v[224:227] offset:10240
    ds_read_b128 a[104:107], v24 offset:26624
    ds_read_b128 a[108:111], v24 offset:27648
    ds_read_b128 a[128:131], v24 offset:32768
    ds_read_b128 a[132:135], v24 offset:33792
    ds_read_b128 a[152:155], v24 offset:38912
    s_waitcnt lgkmcnt(13)
    ds_read_b128 a[156:159], v24 offset:39936
    ds_read_b128 a[176:179], v24 offset:45056
    v_cvt_pk_bf16_f32 v228, v145, v149
    v_cvt_pk_bf16_f32 v229, v153, v157
    v_cvt_pk_bf16_f32 v230, v161, v165
    v_cvt_pk_bf16_f32 v231, v169, v173
    v_mfma_f32_32x32x16_bf16 v[128:143], v[56:59], v[240:243], 0
    s_waitcnt lgkmcnt(9)
    ds_write_b128 v235, v[228:231] offset:10240
    ds_read_b128 a[180:183], v24 offset:46080
    ds_read_b128 a[56:59], v24 offset:14336
    ds_read_b128 a[60:63], v24 offset:15360
    ds_read_b128 a[80:83], v24 offset:20480
    ds_read_b128 a[84:87], v24 offset:21504
    s_waitcnt lgkmcnt(13)
    ds_read_b128 a[16:19], v24 offset:4096
    ds_read_b128 a[20:23], v24 offset:5120
    v_pk_mul_f32 v[146:147], v[146:147], v[186:187]
    v_pk_mul_f32 v[150:151], v[150:151], v[186:187]
    v_pk_mul_f32 v[154:155], v[154:155], v[186:187]
    v_pk_mul_f32 v[158:159], v[158:159], v[186:187]
    v_pk_mul_f32 v[162:163], v[162:163], v[186:187]
    v_pk_mul_f32 v[166:167], v[166:167], v[186:187]
    v_pk_mul_f32 v[170:171], v[170:171], v[186:187]
    v_pk_mul_f32 v[174:175], v[174:175], v[186:187]
    v_cvt_pk_bf16_f32 v224, v146, v150
    v_cvt_pk_bf16_f32 v225, v154, v158
    v_cvt_pk_bf16_f32 v226, v162, v166
    v_cvt_pk_bf16_f32 v227, v170, v174
    v_mfma_f32_32x32x16_bf16 v[112:127], v[52:55], v[244:247], v[112:127]
    s_waitcnt lgkmcnt(9)
    ds_write_b128 v234, v[224:227] offset:10368
    ds_read_b128 a[40:43], v24 offset:10240
    ds_read_b128 a[44:47], v24 offset:11264
    ds_read_b128 a[112:115], v24 offset:28672
    ds_read_b128 a[116:119], v24 offset:29696
    ds_read_b128 a[136:139], v24 offset:34816
    s_waitcnt lgkmcnt(13)
    ds_read_b128 a[140:143], v24 offset:35840
    ds_read_b128 a[160:163], v24 offset:40960
    v_cvt_pk_bf16_f32 v228, v147, v151
    v_cvt_pk_bf16_f32 v229, v155, v159
    v_cvt_pk_bf16_f32 v230, v163, v167
    v_cvt_pk_bf16_f32 v231, v171, v175
    v_mfma_f32_32x32x16_bf16 v[128:143], v[60:63], v[244:247], v[128:143]
    s_waitcnt vmcnt(8)
    s_waitcnt lgkmcnt(9)
    ds_write_b128 v235, v[228:231] offset:10368
    ds_read_b128 a[164:167], v24 offset:41984
    ds_read_b128 a[184:187], v24 offset:47104
    ds_read_b128 a[188:191], v24 offset:48128
    ds_read_b128 a[64:67], v24 offset:16384
    ds_read_b128 a[68:71], v24 offset:17408
    s_waitcnt lgkmcnt(13)
    ds_read_b128 a[88:91], v24 offset:22528
    ds_read_b128 a[92:95], v24 offset:23552
    v_add_u32 v234, v234, v238
    v_add_u32 v235, v235, v238
    v_pk_mul_f32 v[80:81], v[80:81], v[176:177]
    v_pk_mul_f32 v[84:85], v[84:85], v[176:177]
    v_pk_mul_f32 v[88:89], v[88:89], v[176:177]
    v_pk_mul_f32 v[92:93], v[92:93], v[176:177]
    v_pk_mul_f32 v[96:97], v[96:97], v[176:177]
    v_pk_mul_f32 v[100:101], v[100:101], v[176:177]
    v_pk_mul_f32 v[104:105], v[104:105], v[176:177]
    v_pk_mul_f32 v[108:109], v[108:109], v[176:177]
    v_cvt_pk_bf16_f32 v224, v80, v84
    v_cvt_pk_bf16_f32 v225, v88, v92
    v_cvt_pk_bf16_f32 v226, v96, v100
    v_cvt_pk_bf16_f32 v227, v104, v108
    v_mfma_f32_32x32x16_bf16 v[144:159], v[64:67], v[240:243], 0
    s_waitcnt lgkmcnt(0)
    s_barrier
    ds_write_b128 v234, v[224:227] offset:6144
    v_cvt_pk_bf16_f32 v228, v81, v85
    v_cvt_pk_bf16_f32 v229, v89, v93
    v_cvt_pk_bf16_f32 v230, v97, v101
    v_cvt_pk_bf16_f32 v231, v105, v109
    v_mfma_f32_32x32x16_bf16 v[160:175], v[72:75], v[240:243], 0
    ds_write_b128 v235, v[228:231] offset:6144
    v_pk_mul_f32 v[82:83], v[82:83], v[178:179]
    v_pk_mul_f32 v[86:87], v[86:87], v[178:179]
    v_pk_mul_f32 v[90:91], v[90:91], v[178:179]
    v_pk_mul_f32 v[94:95], v[94:95], v[178:179]
    v_pk_mul_f32 v[98:99], v[98:99], v[178:179]
    v_pk_mul_f32 v[102:103], v[102:103], v[178:179]
    v_pk_mul_f32 v[106:107], v[106:107], v[178:179]
    v_pk_mul_f32 v[110:111], v[110:111], v[178:179]
    v_cvt_pk_bf16_f32 v224, v82, v86
    v_cvt_pk_bf16_f32 v225, v90, v94
    v_cvt_pk_bf16_f32 v226, v98, v102
    v_cvt_pk_bf16_f32 v227, v106, v110
    v_mfma_f32_32x32x16_bf16 v[144:159], v[68:71], v[244:247], v[144:159]
    ds_write_b128 v234, v[224:227] offset:6272
    v_cvt_pk_bf16_f32 v228, v83, v87
    v_cvt_pk_bf16_f32 v229, v91, v95
    v_cvt_pk_bf16_f32 v230, v99, v103
    v_cvt_pk_bf16_f32 v231, v107, v111
    v_mfma_f32_32x32x16_bf16 v[160:175], v[76:79], v[244:247], v[160:175]
    ds_write_b128 v235, v[228:231] offset:6272
    v_pk_mul_f32 v[112:113], v[112:113], v[180:181]
    v_pk_mul_f32 v[116:117], v[116:117], v[180:181]
    v_pk_mul_f32 v[120:121], v[120:121], v[180:181]
    v_pk_mul_f32 v[124:125], v[124:125], v[180:181]
    v_pk_mul_f32 v[128:129], v[128:129], v[180:181]
    v_pk_mul_f32 v[132:133], v[132:133], v[180:181]
    v_pk_mul_f32 v[136:137], v[136:137], v[180:181]
    v_pk_mul_f32 v[140:141], v[140:141], v[180:181]
    v_cvt_pk_bf16_f32 v224, v112, v116
    v_cvt_pk_bf16_f32 v225, v120, v124
    v_cvt_pk_bf16_f32 v226, v128, v132
    v_cvt_pk_bf16_f32 v227, v136, v140
    ds_write_b128 v234, v[224:227] offset:8192
    v_cvt_pk_bf16_f32 v228, v113, v117
    v_cvt_pk_bf16_f32 v229, v121, v125
    v_cvt_pk_bf16_f32 v230, v129, v133
    v_cvt_pk_bf16_f32 v231, v137, v141
    ds_write_b128 v235, v[228:231] offset:8192
    v_pk_mul_f32 v[114:115], v[114:115], v[182:183]
    v_pk_mul_f32 v[118:119], v[118:119], v[182:183]
    v_pk_mul_f32 v[122:123], v[122:123], v[182:183]
    v_pk_mul_f32 v[126:127], v[126:127], v[182:183]
    v_pk_mul_f32 v[130:131], v[130:131], v[182:183]
    v_pk_mul_f32 v[134:135], v[134:135], v[182:183]
    v_pk_mul_f32 v[138:139], v[138:139], v[182:183]
    v_pk_mul_f32 v[142:143], v[142:143], v[182:183]
    v_cvt_pk_bf16_f32 v224, v114, v118
    v_cvt_pk_bf16_f32 v225, v122, v126
    v_cvt_pk_bf16_f32 v226, v130, v134
    v_cvt_pk_bf16_f32 v227, v138, v142
    ds_write_b128 v234, v[224:227] offset:8320
    v_cvt_pk_bf16_f32 v228, v115, v119
    v_cvt_pk_bf16_f32 v229, v123, v127
    v_cvt_pk_bf16_f32 v230, v131, v135
    v_cvt_pk_bf16_f32 v231, v139, v143
    ds_write_b128 v235, v[228:231] offset:8320
    v_pk_mul_f32 v[144:145], v[144:145], v[184:185]
    v_pk_mul_f32 v[148:149], v[148:149], v[184:185]
    v_pk_mul_f32 v[152:153], v[152:153], v[184:185]
    v_pk_mul_f32 v[156:157], v[156:157], v[184:185]
    v_pk_mul_f32 v[160:161], v[160:161], v[184:185]
    v_pk_mul_f32 v[164:165], v[164:165], v[184:185]
    v_pk_mul_f32 v[168:169], v[168:169], v[184:185]
    v_pk_mul_f32 v[172:173], v[172:173], v[184:185]
    v_cvt_pk_bf16_f32 v224, v144, v148
    v_cvt_pk_bf16_f32 v225, v152, v156
    v_cvt_pk_bf16_f32 v226, v160, v164
    v_cvt_pk_bf16_f32 v227, v168, v172
    ds_write_b128 v234, v[224:227] offset:10240
    v_cvt_pk_bf16_f32 v228, v145, v149
    v_cvt_pk_bf16_f32 v229, v153, v157
    v_cvt_pk_bf16_f32 v230, v161, v165
    v_cvt_pk_bf16_f32 v231, v169, v173
    ds_write_b128 v235, v[228:231] offset:10240
    v_pk_mul_f32 v[146:147], v[146:147], v[186:187]
    v_pk_mul_f32 v[150:151], v[150:151], v[186:187]
    v_pk_mul_f32 v[154:155], v[154:155], v[186:187]
    v_pk_mul_f32 v[158:159], v[158:159], v[186:187]
    v_pk_mul_f32 v[162:163], v[162:163], v[186:187]
    v_pk_mul_f32 v[166:167], v[166:167], v[186:187]
    v_pk_mul_f32 v[170:171], v[170:171], v[186:187]
    v_pk_mul_f32 v[174:175], v[174:175], v[186:187]
    v_cvt_pk_bf16_f32 v224, v146, v150
    v_cvt_pk_bf16_f32 v225, v154, v158
    v_cvt_pk_bf16_f32 v226, v162, v166
    v_cvt_pk_bf16_f32 v227, v170, v174
    ds_write_b128 v234, v[224:227] offset:10368
    v_cvt_pk_bf16_f32 v228, v147, v151
    v_cvt_pk_bf16_f32 v229, v155, v159
    v_cvt_pk_bf16_f32 v230, v163, v167
    v_cvt_pk_bf16_f32 v231, v171, v175
    ds_write_b128 v235, v[228:231] offset:10368
    s_branch L_conv0
L_prb0:
    v_lshrrev_b32 v131, 4, v129
    v_add_u32 v131, 96, v131
    v_mul_u32_u24 v130, 205, v131
    v_mul_u32_u24 v131, 192, v131
    v_add_u32 v131, s64, v131
    v_lshlrev_b32 v133, 2, v129
    v_and_b32 v133, 63, v133
    v_lshrrev_b32 v134, 11, v130
    v_subrev_u32 v135, s65, v130
    v_mad_u32_u24 v134, v134, s68, v131
    v_and_b32 v135, 0x7ff, v135
    v_cmp_gt_u32 vcc, s66, v135
    v_lshrrev_b32 v135, 7, v130
    v_and_b32 v135, 32, v135
    v_xad_u32 v134, v133, v135, v134
    v_cndmask_b32 v7, v136, v134, vcc
    s_add_u32 m0, s56, 6144
    s_nop 0
    buffer_load_dword v7, s[20:23], 0 offen offset:0 lds
    v_lshrrev_b32 v131, 2, v129
    v_mul_u32_u24 v130, 205, v131
    v_mul_u32_u24 v131, 192, v131
    v_add_u32 v131, s64, v131
    v_lshrrev_b32 v134, 11, v130
    v_subrev_u32 v135, s65, v130
    v_mad_u32_u24 v134, v134, s68, v131
    v_and_b32 v135, 0x7ff, v135
    v_cmp_gt_u32 vcc, s66, v135
    v_lshrrev_b32 v135, 7, v130
    v_and_b32 v135, 32, v135
    v_xad_u32 v134, v132, v135, v134
    v_cndmask_b32 v1, v136, v134, vcc
    v_add_u32 v130, 3280, v130
    v_add_u32 v131, 3072, v131
    v_lshrrev_b32 v134, 11, v130
    v_subrev_u32 v135, s65, v130
    v_mad_u32_u24 v134, v134, s68, v131
    v_and_b32 v135, 0x7ff, v135
    v_cmp_gt_u32 vcc, s66, v135
    v_lshrrev_b32 v135, 7, v130
    v_and_b32 v135, 32, v135
    v_xad_u32 v134, v132, v135, v134
    v_cndmask_b32 v2, v136, v134, vcc
    v_add_u32 v130, 3280, v130
    v_add_u32 v131, 3072, v131
    v_lshrrev_b32 v134, 11, v130
    v_subrev_u32 v135, s65, v130
    v_mad_u32_u24 v134, v134, s68, v131
    v_and_b32 v135, 0x7ff, v135
    v_cmp_gt_u32 vcc, s66, v135
    v_lshrrev_b32 v135, 7, v130
    v_and_b32 v135, 32, v135
    v_xad_u32 v134, v132, v135, v134
    v_cndmask_b32 v3, v136, v134, vcc
    v_add_u32 v130, 3280, v130
    v_add_u32 v131, 3072, v131
    v_lshrrev_b32 v134, 11, v130
    v_subrev_u32 v135, s65, v130
    v_mad_u32_u24 v134, v134, s68, v131
    v_and_b32 v135, 0x7ff, v135
    v_cmp_gt_u32 vcc, s66, v135
    v_lshrrev_b32 v135, 7, v130
    v_and_b32 v135, 32, v135
    v_xad_u32 v134, v132, v135, v134
    v_cndmask_b32 v4, v136, v134, vcc
    v_add_u32 v130, 3280, v130
    v_add_u32 v131, 3072, v131
    v_lshrrev_b32 v134, 11, v130
    v_subrev_u32 v135, s65, v130
    v_mad_u32_u24 v134, v134, s68, v131
    v_and_b32 v135, 0x7ff, v135
    v_cmp_gt_u32 vcc, s66, v135
    v_lshrrev_b32 v135, 7, v130
    v_and_b32 v135, 32, v135
    v_xad_u32 v134, v132, v135, v134
    v_cndmask_b32 v5, v136, v134, vcc
    v_add_u32 v130, 3280, v130
    v_add_u32 v131, 3072, v131
    v_lshrrev_b32 v134, 11, v130
    v_subrev_u32 v135, s65, v130
    v_mad_u32_u24 v134, v134, s68, v131
    v_and_b32 v135, 0x7ff, v135
    v_cmp_gt_u32 vcc, s66, v135
    v_lshrrev_b32 v135, 7, v130
    v_and_b32 v135, 32, v135
    v_xad_u32 v134, v132, v135, v134
    v_cndmask_b32 v6, v136, v134, vcc
    s_cmp_lt_u32 s55, 63
    s_cselect_b32 s66, 10, 0
    s_add_u32 s64, s64, 1856
    v_mul_u32_u24 v134, 98304, v129
    v_add_u32 v134, s64, v134
    v_cmp_gt_u32 vcc, s66, v129
    s_nop 1
    v_cndmask_b32 v31, v136, v134, vcc
    v_mov_b32 v157, 268435456
    v_and_b32 v152, 15, v129
    v_lshrrev_b32 v153, 4, v129
    v_add_u32 v154, 4, v152
    v_lshrrev_b32 v154, 3, v154
    v_mad_i32_i24 v155, v154, -4, v152
    v_and_b32 v154, 1, v154
    v_and_b32 v156, 1, v153
    v_lshlrev_b32 v158, 1, v154
    v_mul_u32_u24 v159, 98304, v158
    v_mad_u32_u24 v159, v155, s69, v159
    v_lshl_add_u32 v159, v153, 4, v159
    v_add_u32 v26, s63, v159
    v_xor_b32 v161, v154, v138
    v_add_u32 v159, v153, v158
    v_add_u32 v160, 0, v155
    v_mad_u32_u24 v159, v159, 10, v160
    v_bfe_u32 v160, v159, 2, 1
    v_lshl_or_b32 v160, v161, 1, v160
    v_lshl_add_u32 v160, v159, 2, v160
    v_lshl_add_u32 v8, v160, 4, s56
    v_add_u32 v162, 1, v156
    v_add_u32 v159, v138, v158
    v_add_u32 v160, v162, v155
    v_mad_u32_u24 v159, v159, 10, v160
    v_bfe_u32 v160, v159, 2, 1
    v_lshl_or_b32 v160, v154, 1, v160
    v_lshl_add_u32 v160, v159, 2, v160
    v_lshl_add_u32 v12, v160, 4, s56
    v_xor_b32 v9, 16, v8
    v_xor_b32 v10, 32, v8
    v_xor_b32 v11, 48, v8
    v_xor_b32 v13, 16, v12
    v_xor_b32 v14, 32, v12
    v_xor_b32 v15, 48, v12
    v_add_u32 v159, 1, v158
    v_add_u32 v160, 1, v155
    v_mad_u32_u24 v159, v159, 10, v160
    v_bfe_u32 v160, v159, 2, 1
    v_lshl_or_b32 v160, v154, 1, v160
    v_xor_b32 v160, v153, v160
    v_lshl_add_u32 v160, v159, 2, v160
    v_lshl_add_u32 v20, v160, 4, s56
    v_xor_b32 v161, 1, v154
    v_add_u32 v159, 2, v158
    v_add_u32 v160, 1, v155
    v_mad_u32_u24 v159, v159, 10, v160
    v_bfe_u32 v160, v159, 2, 1
    v_lshl_or_b32 v160, v161, 1, v160
    v_xor_b32 v160, v153, v160
    v_lshl_add_u32 v160, v159, 2, v160
    v_lshl_add_u32 v21, v160, 4, s56
    v_bfe_u32 v158, v152, 2, 1
    v_sub_u32 v158, v153, v158
    v_and_b32 v159, 3, v152
    v_mul_u32_u24 v16, 0x1111, v159
    v_lshrrev_b32 v160, 3, v152
    v_lshl_add_u32 v159, v160, 2, v159
    v_lshlrev_b32 v159, 5, v159
    v_add_u32 v159, 141312, v159
    s_movk_i32 s70, 3072
    v_cmp_gt_u32 vcc, 3, v158
    v_mad_u32_u24 v159, v158, s70, v159
    s_nop 0
    v_cndmask_b32 v22, v157, v159, vcc
    v_lshlrev_b32 v23, 4, v129
    v_add_u32 v24, 40960, v23
    v_lshlrev_b32 v25, 5, v153
    v_add_u32 v25, 150528, v25
    v_and_b32 v160, 1, v129
    v_lshlrev_b32 v160, 4, v160
    v_mov_b32 v161, 0x3f80
    v_lshlrev_b32 v160, v160, v161
    v_bfe_u32 v158, v129, 1, 1
    v_bfe_u32 v159, v129, 3, 2
    v_lshl_add_u32 v159, v159, 1, v158
    v_bfe_u32 v161, v129, 2, 1
    v_xor_b32 v161, v161, v138
    v_lshl_add_u32 v159, v161, 3, v159
    v_lshlrev_b32 v159, v159, 1
    v_lshrrev_b32 v161, 2, v152
    v_xor_b32 v161, v161, v153
    v_lshl_add_u32 v158, v161, 1, v158
    v_lshlrev_b32 v158, v158, 1
    v_bfe_i32 v240, v159, 0, 1
    v_bfe_i32 v241, v159, 1, 1
    v_bfe_i32 v242, v159, 2, 1
    v_bfe_i32 v243, v159, 3, 1
    v_bfe_i32 v244, v159, 4, 1
    v_bfe_i32 v245, v159, 5, 1
    v_bfe_i32 v246, v159, 6, 1
    v_bfe_i32 v247, v159, 7, 1
    v_bfe_i32 v18, v158, 0, 1
    v_bfe_i32 v19, v158, 1, 1
    v_and_b32 v240, v160, v240
    v_and_b32 v241, v160, v241
    v_and_b32 v242, v160, v242
    v_and_b32 v243, v160, v243
    v_and_b32 v244, v160, v244
    v_and_b32 v245, v160, v245
    v_and_b32 v246, v160, v246
    v_and_b32 v247, v160, v247
    v_and_b32 v18, v160, v18
    v_and_b32 v19, v160, v19
    s_mov_b32 s24, s18
    s_mov_b32 s25, s19
    s_mov_b32 s26, 50331648
    s_mov_b32 s27, 0x20000
    s_mov_b32 s52, 0
    s_mov_b32 s80, 0
    s_mov_b32 s81, 98304
    s_mov_b32 s82, 393216
    s_mov_b32 s83, 491520
    s_mov_b32 s53, 1156138217
    s_mov_b32 s58, 0x3c003c00
    s_mov_b32 s85, 150912
    s_mov_b32 s86, 0x37803780
    s_mov_b32 s87, 0xffffffff
    s_mov_b32 s84, 0x37800000
    v_lshrrev_b32 v158, 2, v152
    v_xor_b32 v158, v158, v153
    v_bfe_i32 v158, v158, 0, 1
    v_bfi_b32 v158, v158, 0, s58
    v_accvgpr_write_b32 a228, v158
    v_accvgpr_write_b32 a229, v158
    v_accvgpr_write_b32 a230, v158
    v_accvgpr_write_b32 a231, v158
    v_and_b32 v17, v138, v153
    v_lshlrev_b32 v17, 4, v17
    v_lshrrev_b32 v17, v17, -1
    s_mov_b32 s73, 0x409d2a01
    s_mov_b32 s59, 0x3ef00000
    v_mul_u32_u24 v252, 0x100010, v0
    v_add_u32 v252, 0xc0004, v252
    v_lshlrev_b32 v253, 2, v0
    v_add_u32 v253, 150912, v253
    v_add_u32 v160, 0x0, v252
    v_add_u32 v168, 0x10001000, v252
    v_cvt_f32_f16 v161, v160
    v_cvt_f32_f16 v169, v168
    v_cvt_f32_f16_sdwa v162, v160 dst_sel:DWORD dst_unused:UNUSED_PAD src0_sel:WORD_1
    v_cvt_f32_f16_sdwa v170, v168 dst_sel:DWORD dst_unused:UNUSED_PAD src0_sel:WORD_1
    v_mul_f32 v163, 0x3f7fdde7, v161
    v_mul_f32 v171, 0x3f7fdde7, v169
    v_mul_f32 v164, 0x3f7fdde7, v162
    v_mul_f32 v172, 0x3f7fdde7, v170
    v_fma_f32 v163, v163, v161, s73
    v_fma_f32 v171, v171, v169, s73
    v_fma_f32 v164, v164, v162, s73
    v_fma_f32 v172, v172, v170, s73
    v_mul_f32 v163, -v161, v163
    v_mul_f32 v171, -v169, v171
    v_mul_f32 v164, -v162, v164
    v_mul_f32 v172, -v170, v172
    v_exp_f32 v165, v163
    v_exp_f32 v173, v171
    v_exp_f32 v166, v164
    v_exp_f32 v174, v172
    v_fma_f32 v163, v165, s59, s59
    v_fma_f32 v171, v173, s59, s59
    v_fma_f32 v164, v166, s59, s59
    v_fma_f32 v172, v174, s59, s59
    v_rcp_f32 v163, v163
    v_rcp_f32 v171, v171
    v_rcp_f32 v164, v164
    v_rcp_f32 v172, v172
    v_mul_f32 v163, v161, v163
    v_mul_f32 v171, v169, v171
    v_mul_f32 v164, v162, v164
    v_mul_f32 v172, v170, v172
    v_mul_f32 v165, -v165, v163
    v_mul_f32 v173, -v173, v171
    v_mul_f32 v166, -v166, v164
    v_mul_f32 v174, -v174, v172
    v_cvt_pk_bf16_f32 v167, v165, v166
    v_cvt_pk_bf16_f32 v175, v173, v174
    v_cvt_pk_bf16_f32 v160, v163, v164
    v_cvt_pk_bf16_f32 v168, v171, v172
    ds_write_b32 v253, v167 offset:8192
    ds_write_b32 v253, v160 offset:0
    ds_write_b32 v253, v175 offset:9216
    ds_write_b32 v253, v168 offset:1024
    v_add_u32 v160, 0x20002000, v252
    s_nop 0
    v_add_u32 v168, 0x30003000, v252
    v_cvt_f32_f16 v161, v160
    v_cvt_f32_f16 v169, v168
    v_cvt_f32_f16_sdwa v162, v160 dst_sel:DWORD dst_unused:UNUSED_PAD src0_sel:WORD_1
    v_cvt_f32_f16_sdwa v170, v168 dst_sel:DWORD dst_unused:UNUSED_PAD src0_sel:WORD_1
    v_mul_f32 v163, 0x3f7fdde7, v161
    v_mul_f32 v171, 0x3f7fdde7, v169
    v_mul_f32 v164, 0x3f7fdde7, v162
    v_mul_f32 v172, 0x3f7fdde7, v170
    v_fma_f32 v163, v163, v161, s73
    v_fma_f32 v171, v171, v169, s73
    v_fma_f32 v164, v164, v162, s73
    v_fma_f32 v172, v172, v170, s73
    v_mul_f32 v163, -v161, v163
    v_mul_f32 v171, -v169, v171
    v_mul_f32 v164, -v162, v164
    v_mul_f32 v172, -v170, v172
    v_exp_f32 v165, v163
    v_exp_f32 v173, v171
    v_exp_f32 v166, v164
    v_exp_f32 v174, v172
    v_fma_f32 v163, v165, s59, s59
    v_fma_f32 v171, v173, s59, s59
    v_fma_f32 v164, v166, s59, s59
    v_fma_f32 v172, v174, s59, s59
    v_rcp_f32 v163, v163
    v_rcp_f32 v171, v171
    v_rcp_f32 v164, v164
    v_rcp_f32 v172, v172
    v_mul_f32 v163, v161, v163
    v_mul_f32 v171, v169, v171
    v_mul_f32 v164, v162, v164
    v_mul_f32 v172, v170, v172
    v_mul_f32 v165, -v165, v163
    v_mul_f32 v173, -v173, v171
    v_mul_f32 v166, -v166, v164
    v_mul_f32 v174, -v174, v172
    v_cvt_pk_bf16_f32 v167, v165, v166
    v_cvt_pk_bf16_f32 v175, v173, v174
    v_cvt_pk_bf16_f32 v160, v163, v164
    v_cvt_pk_bf16_f32 v168, v171, v172
    ds_write_b32 v253, v167 offset:10240
    ds_write_b32 v253, v160 offset:2048
    ds_write_b32 v253, v175 offset:11264
    ds_write_b32 v253, v168 offset:3072
    v_add_u32 v160, 0x40004000, v252
    s_nop 0
    v_add_u32 v168, 0x50005000, v252
    v_cvt_f32_f16 v161, v160
    v_cvt_f32_f16 v169, v168
    v_cvt_f32_f16_sdwa v162, v160 dst_sel:DWORD dst_unused:UNUSED_PAD src0_sel:WORD_1
    v_cvt_f32_f16_sdwa v170, v168 dst_sel:DWORD dst_unused:UNUSED_PAD src0_sel:WORD_1
    v_mul_f32 v163, 0x3f7fdde7, v161
    v_mul_f32 v171, 0x40088889, v169
    v_mul_f32 v164, 0x3f7fdde7, v162
    v_mul_f32 v172, 0x40088889, v170
    v_fma_f32 v163, v163, v161, s73
    v_cvt_pk_bf16_f32 v168, v171, v172
    v_fma_f32 v164, v164, v162, s73
    v_mul_f32 v163, -v161, v163
    v_mul_f32 v164, -v162, v164
    v_exp_f32 v165, v163
    v_exp_f32 v166, v164
    v_fma_f32 v163, v165, s59, s59
    v_fma_f32 v164, v166, s59, s59
    v_rcp_f32 v163, v163
    v_rcp_f32 v164, v164
    v_mul_f32 v163, v161, v163
    v_mul_f32 v164, v162, v164
    v_mul_f32 v165, -v165, v163
    v_mul_f32 v166, -v166, v164
    v_cvt_pk_bf16_f32 v167, v165, v166
    v_cvt_pk_bf16_f32 v160, v163, v164
    ds_write_b32 v253, v167 offset:12288
    ds_write_b32 v253, v160 offset:4096
    ds_write_b32 v253, v168 offset:5120
    s_nop 0
    v_add_u32 v160, 0x60006000, v252
    v_add_u32 v168, 0x70007000, v252
    v_cvt_f32_f16 v161, v160
    v_cvt_f32_f16 v169, v168
    v_cvt_f32_f16_sdwa v162, v160 dst_sel:DWORD dst_unused:UNUSED_PAD src0_sel:WORD_1
    v_cvt_f32_f16_sdwa v170, v168 dst_sel:DWORD dst_unused:UNUSED_PAD src0_sel:WORD_1
    v_mul_f32 v163, 0x40088889, v161
    v_mul_f32 v171, 0x40088889, v169
    v_mul_f32 v164, 0x40088889, v162
    v_mul_f32 v172, 0x40088889, v170
    v_cvt_pk_bf16_f32 v160, v163, v164
    v_cvt_pk_bf16_f32 v168, v171, v172
    ds_write_b32 v253, v160 offset:6144
    ds_write_b32 v253, v168 offset:7168
    v_lshlrev_b32 v158, 6, v0
    v_add_u32 v158, 141312, v158
    v_cmp_gt_u32 vcc, 144, v0
    s_nop 1
    v_cndmask_b32 v158, v157, v158, vcc
    v_and_b32 v159, 3, v0
    v_lshl_add_u32 v160, v159, 2, v158
    v_lshrrev_b32 v159, 1, v159
    v_lshl_add_u32 v159, v159, 2, v158
    v_lshlrev_b32 v161, 4, v0
    v_add_u32 v161, 150528, v161
    v_cmp_gt_u32 vcc, 24, v0
    s_nop 1
    v_cndmask_b32 v161, v157, v161, vcc
    v_mov_b32 v164, 0
    v_mov_b32 v165, 0
    v_mov_b32 v166, 0
    v_mov_b32 v167, 0
    ds_write_b128 v158, v[164:167]
    ds_write_b128 v158, v[164:167] offset:16
    s_waitcnt lgkmcnt(9)
    ds_write_b128 v158, v[164:167] offset:32
    ds_write_b128 v158, v[164:167] offset:48
    s_waitcnt vmcnt(17)
    ds_write_b16 v160, v144
    ds_write_b16_d16_hi v160, v144 offset:34
    s_waitcnt vmcnt(16)
    ds_write_b16 v159, v145 offset:16
    ds_write_b16_d16_hi v159, v145 offset:48
    s_waitcnt vmcnt(15) lgkmcnt(13)
    ds_write_b16 v159, v146 offset:24
    ds_write_b16_d16_hi v159, v146 offset:56
    s_waitcnt vmcnt(14)
    v_lshlrev_b32 v168, 16, v148
    v_and_b32 v169, 0xffff0000, v148
    v_lshlrev_b32 v170, 16, v149
    v_and_b32 v171, 0xffff0000, v149
    s_waitcnt vmcnt(13)
    v_lshlrev_b32 v172, 16, v150
    v_and_b32 v173, 0xffff0000, v150
    v_lshlrev_b32 v174, 16, v151
    v_and_b32 v175, 0xffff0000, v151
    v_mul_f32 v168, v168, v172
    v_mul_f32 v169, v169, v173
    v_mul_f32 v170, v170, v174
    v_mul_f32 v171, v171, v175
    s_waitcnt lgkmcnt(14)
    ds_write_b128 v161, v[168:171]
    s_waitcnt vmcnt(12)
    v_xor_b32 v176, 0x80008000, v176
    v_xor_b32 v177, 0x80008000, v177
    v_xor_b32 v178, 0x80008000, v178
    v_xor_b32 v179, 0x80008000, v179
    s_nop 1
    v_mfma_f32_32x32x16_bf16 v[208:223], v[176:179], v[240:243], 0
    v_mfma_f32_32x32x16_bf16 v[208:223], v[176:179], v[244:247], v[208:223]
    s_waitcnt vmcnt(10)
    v_xor_b32 v180, 0x80008000, v180
    v_xor_b32 v181, 0x80008000, v181
    v_xor_b32 v182, 0x80008000, v182
    v_xor_b32 v183, 0x80008000, v183
    s_nop 1
    v_mfma_f32_32x32x16_bf16 v[192:207], v[180:183], v[240:243], 0
    v_mfma_f32_32x32x16_bf16 v[192:207], v[180:183], v[244:247], v[192:207]
    s_mov_b32 s74, 0
    s_mov_b32 s75, 12288
    buffer_load_dwordx4 a[0:3], v232, s[44:47], s74 offen offset:0
    buffer_load_dwordx4 a[4:7], v232, s[44:47], s75 offen offset:0
    buffer_load_dwordx4 a[8:11], v233, s[44:47], s74 offen offset:0
    buffer_load_dwordx4 a[12:15], v233, s[44:47], s75 offen offset:0
    s_mov_b32 s74, 24576
    s_mov_b32 s75, 36864
    buffer_load_dwordx4 a[16:19], v232, s[44:47], s74 offen offset:0
    buffer_load_dwordx4 a[20:23], v232, s[44:47], s75 offen offset:0
    buffer_load_dwordx4 a[24:27], v233, s[44:47], s74 offen offset:0
    buffer_load_dwordx4 a[28:31], v233, s[44:47], s75 offen offset:0
    s_mov_b32 s74, 49152
    s_mov_b32 s75, 61440
    buffer_load_dwordx4 a[32:35], v232, s[44:47], s74 offen offset:0
    buffer_load_dwordx4 a[36:39], v232, s[44:47], s75 offen offset:0
    buffer_load_dwordx4 a[40:43], v233, s[44:47], s74 offen offset:0
    buffer_load_dwordx4 a[44:47], v233, s[44:47], s75 offen offset:0
    s_mov_b32 s74, 0
    s_mov_b32 s75, 12288
    buffer_load_dwordx4 a[48:51], v232, s[44:47], s74 offen offset:256
    buffer_load_dwordx4 a[52:55], v232, s[44:47], s75 offen offset:256
    buffer_load_dwordx4 a[56:59], v233, s[44:47], s74 offen offset:256
    buffer_load_dwordx4 a[60:63], v233, s[44:47], s75 offen offset:256
    s_mov_b32 s74, 24576
    s_mov_b32 s75, 36864
    buffer_load_dwordx4 a[64:67], v232, s[44:47], s74 offen offset:256
    buffer_load_dwordx4 a[68:71], v232, s[44:47], s75 offen offset:256
    buffer_load_dwordx4 a[72:75], v233, s[44:47], s74 offen offset:256
    buffer_load_dwordx4 a[76:79], v233, s[44:47], s75 offen offset:256
    s_mov_b32 s74, 49152
    s_mov_b32 s75, 61440
    buffer_load_dwordx4 a[80:83], v232, s[44:47], s74 offen offset:256
    buffer_load_dwordx4 a[84:87], v232, s[44:47], s75 offen offset:256
    buffer_load_dwordx4 a[88:91], v233, s[44:47], s74 offen offset:256
    buffer_load_dwordx4 a[92:95], v233, s[44:47], s75 offen offset:256
    s_waitcnt vmcnt(23)
    v_mfma_f32_32x32x16_bf16 v[80:95], a[0:3], v[240:243], v[208:223]
    s_waitcnt vmcnt(21)
    v_mfma_f32_32x32x16_bf16 v[96:111], a[8:11], v[240:243], v[208:223]
    v_mfma_f32_32x32x16_bf16 v[80:95], a[4:7], v[244:247], v[80:95]
    s_waitcnt vmcnt(20)
    v_mfma_f32_32x32x16_bf16 v[96:111], a[12:15], v[244:247], v[96:111]
    s_waitcnt vmcnt(19)
    v_mfma_f32_32x32x16_bf16 v[112:127], a[16:19], v[240:243], v[208:223]
    s_waitcnt vmcnt(17)
    v_mfma_f32_32x32x16_bf16 v[128:143], a[24:27], v[240:243], v[208:223]
    v_mfma_f32_32x32x16_bf16 v[112:127], a[20:23], v[244:247], v[112:127]
    s_waitcnt vmcnt(16)
    v_mfma_f32_32x32x16_bf16 v[128:143], a[28:31], v[244:247], v[128:143]
    s_nop 2
    v_cvt_pk_f16_f32 v224, v80, v84
    v_cvt_pk_f16_f32 v225, v88, v92
    v_cvt_pk_f16_f32 v226, v96, v100
    v_cvt_pk_f16_f32 v227, v104, v108
    s_waitcnt vmcnt(15)
    v_mfma_f32_32x32x16_bf16 v[144:159], a[32:35], v[240:243], v[208:223]
    s_waitcnt lgkmcnt(14)
    ds_write_b128 v234, v[224:227] offset:0
    s_mov_b32 s74, 0
    v_cvt_pk_f16_f32 v228, v81, v85
    v_cvt_pk_f16_f32 v229, v89, v93
    v_cvt_pk_f16_f32 v230, v97, v101
    v_cvt_pk_f16_f32 v231, v105, v109
    s_waitcnt vmcnt(13)
    v_mfma_f32_32x32x16_bf16 v[160:175], a[40:43], v[240:243], v[208:223]
    s_waitcnt lgkmcnt(14)
    ds_write_b128 v234, v[228:231] offset:1024
    s_mov_b32 s75, 12288
    buffer_load_dwordx4 v[32:35], v232, s[44:47], s74 offen offset:512
    v_cvt_pk_f16_f32 v224, v82, v86
    v_cvt_pk_f16_f32 v225, v90, v94
    v_cvt_pk_f16_f32 v226, v98, v102
    v_cvt_pk_f16_f32 v227, v106, v110
    v_mfma_f32_32x32x16_bf16 v[144:159], a[36:39], v[244:247], v[144:159]
    s_waitcnt lgkmcnt(14)
    ds_write_b128 v234, v[224:227] offset:12288
    buffer_load_dwordx4 v[36:39], v232, s[44:47], s75 offen offset:512
    v_cvt_pk_f16_f32 v228, v83, v87
    v_cvt_pk_f16_f32 v229, v91, v95
    v_cvt_pk_f16_f32 v230, v99, v103
    v_cvt_pk_f16_f32 v231, v107, v111
    s_waitcnt vmcnt(14)
    v_mfma_f32_32x32x16_bf16 v[160:175], a[44:47], v[244:247], v[160:175]
    s_waitcnt vmcnt(10)
    s_waitcnt lgkmcnt(14)
    ds_write_b128 v234, v[228:231] offset:13312
    buffer_load_dwordx4 v[40:43], v233, s[44:47], s74 offen offset:512
    buffer_load_dwordx4 v[44:47], v233, s[44:47], s75 offen offset:512
    v_mfma_f32_32x32x16_bf16 v[160:175], a[232:235], v[244:247], v[160:175]
    v_cvt_pk_f16_f32 v224, v112, v116
    v_cvt_pk_f16_f32 v225, v120, v124
    v_cvt_pk_f16_f32 v226, v128, v132
    v_cvt_pk_f16_f32 v227, v136, v140
    v_mfma_f32_32x32x16_bf16 v[80:95], a[48:51], v[240:243], v[192:207]
    s_waitcnt lgkmcnt(14)
    ds_write_b128 v234, v[224:227] offset:2048
    s_mov_b32 s74, 24576
    v_cvt_pk_f16_f32 v228, v113, v117
    v_cvt_pk_f16_f32 v229, v121, v125
    v_cvt_pk_f16_f32 v230, v129, v133
    v_cvt_pk_f16_f32 v231, v137, v141
    v_mfma_f32_32x32x16_bf16 v[96:111], a[56:59], v[240:243], v[192:207]
    s_waitcnt lgkmcnt(14)
    ds_write_b128 v234, v[228:231] offset:3072
    s_mov_b32 s75, 36864
    buffer_load_dwordx4 v[48:51], v232, s[44:47], s74 offen offset:512
    v_cvt_pk_f16_f32 v224, v114, v118
    v_cvt_pk_f16_f32 v225, v122, v126
    v_cvt_pk_f16_f32 v226, v130, v134
    v_cvt_pk_f16_f32 v227, v138, v142
    v_mfma_f32_32x32x16_bf16 v[80:95], a[52:55], v[244:247], v[80:95]
    s_waitcnt lgkmcnt(14)
    ds_write_b128 v234, v[224:227] offset:14336
    buffer_load_dwordx4 v[52:55], v232, s[44:47], s75 offen offset:512
    v_cvt_pk_f16_f32 v228, v115, v119
    v_cvt_pk_f16_f32 v229, v123, v127
    v_cvt_pk_f16_f32 v230, v131, v135
    v_cvt_pk_f16_f32 v231, v139, v143
    v_mfma_f32_32x32x16_bf16 v[96:111], a[60:63], v[244:247], v[96:111]
    s_waitcnt vmcnt(10)
    s_waitcnt lgkmcnt(14)
    ds_write_b128 v234, v[228:231] offset:15360
    buffer_load_dwordx4 v[56:59], v233, s[44:47], s74 offen offset:512
    buffer_load_dwordx4 v[60:63], v233, s[44:47], s75 offen offset:512
    v_xor_b32 v184, 0x80008000, v184
    v_xor_b32 v185, 0x80008000, v185
    v_xor_b32 v186, 0x80008000, v186
    v_xor_b32 v187, 0x80008000, v187
    v_cvt_pk_f16_f32 v224, v144, v148
    v_cvt_pk_f16_f32 v225, v152, v156
    v_cvt_pk_f16_f32 v226, v160, v164
    v_cvt_pk_f16_f32 v227, v168, v172
    v_mfma_f32_32x32x16_bf16 v[112:127], a[64:67], v[240:243], v[192:207]
    s_waitcnt lgkmcnt(14)
    ds_write_b128 v234, v[224:227] offset:4096
    s_mov_b32 s74, 49152
    v_cvt_pk_f16_f32 v228, v145, v149
    v_cvt_pk_f16_f32 v229, v153, v157
    v_cvt_pk_f16_f32 v230, v161, v165
    v_cvt_pk_f16_f32 v231, v169, v173
    v_mfma_f32_32x32x16_bf16 v[128:143], a[72:75], v[240:243], v[192:207]
    s_waitcnt lgkmcnt(14)
    ds_write_b128 v234, v[228:231] offset:5120
    s_mov_b32 s75, 61440
    buffer_load_dwordx4 v[64:67], v232, s[44:47], s74 offen offset:512
    v_cvt_pk_f16_f32 v224, v146, v150
    v_cvt_pk_f16_f32 v225, v154, v158
    v_cvt_pk_f16_f32 v226, v162, v166
    v_cvt_pk_f16_f32 v227, v170, v174
    v_mfma_f32_32x32x16_bf16 v[112:127], a[68:71], v[244:247], v[112:127]
    s_waitcnt lgkmcnt(14)
    ds_write_b128 v234, v[224:227] offset:16384
    buffer_load_dwordx4 v[68:71], v232, s[44:47], s75 offen offset:512
    v_cvt_pk_f16_f32 v228, v147, v151
    v_cvt_pk_f16_f32 v229, v155, v159
    v_cvt_pk_f16_f32 v230, v163, v167
    v_cvt_pk_f16_f32 v231, v171, v175
    v_mfma_f32_32x32x16_bf16 v[128:143], a[76:79], v[244:247], v[128:143]
    s_waitcnt vmcnt(10)
    s_waitcnt lgkmcnt(14)
    ds_write_b128 v234, v[228:231] offset:17408
    buffer_load_dwordx4 v[72:75], v233, s[44:47], s74 offen offset:512
    buffer_load_dwordx4 v[76:79], v233, s[44:47], s75 offen offset:512
    v_sub_u32 v234, v234, v238
    v_mfma_f32_32x32x16_bf16 v[208:223], v[184:187], v[240:243], 0
    v_mfma_f32_32x32x16_bf16 v[208:223], v[184:187], v[244:247], v[208:223]
    v_cvt_pk_f16_f32 v224, v80, v84
    v_cvt_pk_f16_f32 v225, v88, v92
    v_cvt_pk_f16_f32 v226, v96, v100
    v_cvt_pk_f16_f32 v227, v104, v108
    v_mfma_f32_32x32x16_bf16 v[144:159], a[80:83], v[240:243], v[192:207]
    s_waitcnt lgkmcnt(0)
    s_barrier
    ds_write_b128 v234, v[224:227] offset:0
    ds_read_b128 a[192:195], v23 offset:4096
    ds_read_b128 a[196:199], v23 offset:5120
    ds_read_b128 a[200:203], v23 offset:14336
    ds_read_b128 a[204:207], v23 offset:15360
    ds_read_b128 a[208:211], v23 offset:24576
    ds_read_b128 a[212:215], v23 offset:25600
    ds_read_b128 a[216:219], v23 offset:34816
    s_add_u32 m0, s56, 6336
    s_nop 0
    buffer_load_dwordx4 v1, s[20:23], 0 offen offset:64 lds
    v_cvt_pk_f16_f32 v228, v81, v85
    v_cvt_pk_f16_f32 v229, v89, v93
    v_cvt_pk_f16_f32 v230, v97, v101
    v_cvt_pk_f16_f32 v231, v105, v109
    v_mfma_f32_32x32x16_bf16 v[160:175], a[88:91], v[240:243], v[192:207]
    ds_write_b128 v234, v[228:231] offset:1024
    ds_read_b128 a[220:223], v23 offset:35840
    ds_read_b128 a[0:3], v24 offset:0
    ds_read_b128 a[4:7], v24 offset:1024
    ds_read_b128 a[24:27], v24 offset:6144
    ds_read_b128 a[28:31], v24 offset:7168
    ds_read_b128 a[96:99], v24 offset:24576
    s_waitcnt lgkmcnt(14)
    ds_read_b128 a[100:103], v24 offset:25600
    s_add_u32 m0, s56, 7360
    s_nop 0
    buffer_load_dwordx4 v2, s[20:23], 0 offen offset:64 lds
    v_cvt_pk_f16_f32 v224, v82, v86
    v_cvt_pk_f16_f32 v225, v90, v94
    v_cvt_pk_f16_f32 v226, v98, v102
    v_cvt_pk_f16_f32 v227, v106, v110
    v_mfma_f32_32x32x16_bf16 v[144:159], a[84:87], v[244:247], v[144:159]
    s_waitcnt lgkmcnt(9)
    ds_write_b128 v234, v[224:227] offset:10240
    ds_read_b128 a[120:123], v24 offset:30720
    ds_read_b128 a[124:127], v24 offset:31744
    ds_read_b128 a[144:147], v24 offset:36864
    ds_read_b128 a[148:151], v24 offset:37888
    ds_read_b128 a[168:171], v24 offset:43008
    s_waitcnt lgkmcnt(13)
    ds_read_b128 a[172:175], v24 offset:44032
    ds_read_b128 a[48:51], v24 offset:12288
    s_add_u32 m0, s56, 8384
    s_nop 0
    buffer_load_dwordx4 v3, s[20:23], 0 offen offset:64 lds
    v_cvt_pk_f16_f32 v228, v83, v87
    v_cvt_pk_f16_f32 v229, v91, v95
    v_cvt_pk_f16_f32 v230, v99, v103
    v_cvt_pk_f16_f32 v231, v107, v111
    v_mfma_f32_32x32x16_bf16 v[160:175], a[92:95], v[244:247], v[160:175]
    s_waitcnt vmcnt(11)
    s_waitcnt lgkmcnt(9)
    ds_write_b128 v234, v[228:231] offset:11264
    ds_read_b128 a[52:55], v24 offset:13312
    ds_read_b128 a[72:75], v24 offset:18432
    ds_read_b128 a[76:79], v24 offset:19456
    ds_read_b128 a[8:11], v24 offset:2048
    ds_read_b128 a[12:15], v24 offset:3072
    s_waitcnt lgkmcnt(13)
    ds_read_b128 a[32:35], v24 offset:8192
    ds_read_b128 a[36:39], v24 offset:9216
    s_add_u32 m0, s56, 9408
    s_nop 0
    buffer_load_dwordx4 v4, s[20:23], 0 offen offset:64 lds
    v_mfma_f32_32x32x16_bf16 v[160:175], a[236:239], v[244:247], v[160:175]
    v_cvt_pk_f16_f32 v224, v112, v116
    v_cvt_pk_f16_f32 v225, v120, v124
    v_cvt_pk_f16_f32 v226, v128, v132
    v_cvt_pk_f16_f32 v227, v136, v140
    v_mfma_f32_32x32x16_bf16 v[80:95], v[32:35], v[240:243], v[208:223]
    s_waitcnt lgkmcnt(9)
    ds_write_b128 v234, v[224:227] offset:2048
    ds_read_b128 a[104:107], v24 offset:26624
    ds_read_b128 a[108:111], v24 offset:27648
    ds_read_b128 a[128:131], v24 offset:32768
    ds_read_b128 a[132:135], v24 offset:33792
    ds_read_b128 a[152:155], v24 offset:38912
    s_waitcnt lgkmcnt(13)
    ds_read_b128 a[156:159], v24 offset:39936
    ds_read_b128 a[176:179], v24 offset:45056
    s_add_u32 m0, s56, 10432
    v_cvt_pk_f16_f32 v228, v113, v117
    v_cvt_pk_f16_f32 v229, v121, v125
    v_cvt_pk_f16_f32 v230, v129, v133
    v_cvt_pk_f16_f32 v231, v137, v141
    v_mfma_f32_32x32x16_bf16 v[96:111], v[40:43], v[240:243], v[208:223]
    s_waitcnt lgkmcnt(9)
    ds_write_b128 v234, v[228:231] offset:3072
    ds_read_b128 a[180:183], v24 offset:46080
    ds_read_b128 a[56:59], v24 offset:14336
    ds_read_b128 a[60:63], v24 offset:15360
    ds_read_b128 a[80:83], v24 offset:20480
    ds_read_b128 a[84:87], v24 offset:21504
    s_waitcnt lgkmcnt(13)
    ds_read_b128 a[16:19], v24 offset:4096
    ds_read_b128 a[20:23], v24 offset:5120
    buffer_load_dwordx4 v5, s[20:23], 0 offen offset:64 lds
    s_add_u32 m0, s56, 11456
    v_cvt_pk_f16_f32 v224, v114, v118
    v_cvt_pk_f16_f32 v225, v122, v126
    v_cvt_pk_f16_f32 v226, v130, v134
    v_cvt_pk_f16_f32 v227, v138, v142
    v_mfma_f32_32x32x16_bf16 v[80:95], v[36:39], v[244:247], v[80:95]
    s_waitcnt lgkmcnt(9)
    ds_write_b128 v234, v[224:227] offset:12288
    ds_read_b128 a[40:43], v24 offset:10240
    ds_read_b128 a[44:47], v24 offset:11264
    ds_read_b128 a[112:115], v24 offset:28672
    ds_read_b128 a[116:119], v24 offset:29696
    ds_read_b128 a[136:139], v24 offset:34816
    s_waitcnt lgkmcnt(13)
    ds_read_b128 a[140:143], v24 offset:35840
    ds_read_b128 a[160:163], v24 offset:40960
    buffer_load_dwordx4 v6, s[20:23], 0 offen offset:64 lds
    s_add_u32 m0, s56, 12480
    v_cvt_pk_f16_f32 v228, v115, v119
    v_cvt_pk_f16_f32 v229, v123, v127
    v_cvt_pk_f16_f32 v230, v131, v135
    v_cvt_pk_f16_f32 v231, v139, v143
    v_mfma_f32_32x32x16_bf16 v[96:111], v[44:47], v[244:247], v[96:111]
    s_waitcnt vmcnt(10)
    s_waitcnt lgkmcnt(9)
    ds_write_b128 v234, v[228:231] offset:13312
    ds_read_b128 a[164:167], v24 offset:41984
    ds_read_b128 a[184:187], v24 offset:47104
    ds_read_b128 a[188:191], v24 offset:48128
    ds_read_b128 a[64:67], v24 offset:16384
    ds_read_b128 a[68:71], v24 offset:17408
    s_waitcnt lgkmcnt(13)
    ds_read_b128 a[88:91], v24 offset:22528
    ds_read_b128 a[92:95], v24 offset:23552
    buffer_load_dword v7, s[20:23], 0 offen offset:64 lds
    buffer_load_dword v254, v31, s[20:23], 0 offen
    v_cvt_pk_f16_f32 v224, v144, v148
    v_cvt_pk_f16_f32 v225, v152, v156
    v_cvt_pk_f16_f32 v226, v160, v164
    v_cvt_pk_f16_f32 v227, v168, v172
    v_mfma_f32_32x32x16_bf16 v[112:127], v[48:51], v[240:243], v[208:223]
    s_waitcnt lgkmcnt(0)
    s_barrier
    ds_write_b128 v234, v[224:227] offset:4096
    v_cvt_pk_f16_f32 v228, v145, v149
    v_cvt_pk_f16_f32 v229, v153, v157
    v_cvt_pk_f16_f32 v230, v161, v165
    v_cvt_pk_f16_f32 v231, v169, v173
    v_mfma_f32_32x32x16_bf16 v[128:143], v[56:59], v[240:243], v[208:223]
    ds_write_b128 v234, v[228:231] offset:5120
    v_cvt_pk_f16_f32 v224, v146, v150
    v_cvt_pk_f16_f32 v225, v154, v158
    v_cvt_pk_f16_f32 v226, v162, v166
    v_cvt_pk_f16_f32 v227, v170, v174
    v_mfma_f32_32x32x16_bf16 v[112:127], v[52:55], v[244:247], v[112:127]
    ds_write_b128 v234, v[224:227] offset:14336
    v_cvt_pk_f16_f32 v228, v147, v151
    v_cvt_pk_f16_f32 v229, v155, v159
    v_cvt_pk_f16_f32 v230, v163, v167
    v_cvt_pk_f16_f32 v231, v171, v175
    v_mfma_f32_32x32x16_bf16 v[128:143], v[60:63], v[244:247], v[128:143]
    s_waitcnt vmcnt(8)
    ds_write_b128 v234, v[228:231] offset:15360
    v_add_u32 v234, v234, v238
    v_cvt_pk_f16_f32 v224, v80, v84
    v_cvt_pk_f16_f32 v225, v88, v92
    v_cvt_pk_f16_f32 v226, v96, v100
    v_cvt_pk_f16_f32 v227, v104, v108
    v_mfma_f32_32x32x16_bf16 v[144:159], v[64:67], v[240:243], v[208:223]
    ds_write_b128 v234, v[224:227] offset:0
    v_cvt_pk_f16_f32 v228, v81, v85
    v_cvt_pk_f16_f32 v229, v89, v93
    v_cvt_pk_f16_f32 v230, v97, v101
    v_cvt_pk_f16_f32 v231, v105, v109
    v_mfma_f32_32x32x16_bf16 v[160:175], v[72:75], v[240:243], v[208:223]
    ds_write_b128 v234, v[228:231] offset:1024
    v_cvt_pk_f16_f32 v224, v82, v86
    v_cvt_pk_f16_f32 v225, v90, v94
    v_cvt_pk_f16_f32 v226, v98, v102
    v_cvt_pk_f16_f32 v227, v106, v110
    v_mfma_f32_32x32x16_bf16 v[144:159], v[68:71], v[244:247], v[144:159]
    ds_write_b128 v234, v[224:227] offset:12288
    v_cvt_pk_f16_f32 v228, v83, v87
    v_cvt_pk_f16_f32 v229, v91, v95
    v_cvt_pk_f16_f32 v230, v99, v103
    v_cvt_pk_f16_f32 v231, v107, v111
    v_mfma_f32_32x32x16_bf16 v[160:175], v[76:79], v[244:247], v[160:175]
    ds_write_b128 v234, v[228:231] offset:13312
    v_mfma_f32_32x32x16_bf16 v[160:175], a[240:243], v[244:247], v[160:175]
    v_cvt_pk_f16_f32 v224, v112, v116
    v_cvt_pk_f16_f32 v225, v120, v124
    v_cvt_pk_f16_f32 v226, v128, v132
    v_cvt_pk_f16_f32 v227, v136, v140
    ds_write_b128 v234, v[224:227] offset:2048
    v_cvt_pk_f16_f32 v228, v113, v117
    v_cvt_pk_f16_f32 v229, v121, v125
    v_cvt_pk_f16_f32 v230, v129, v133
    v_cvt_pk_f16_f32 v231, v137, v141
    ds_write_b128 v234, v[228:231] offset:3072
    v_cvt_pk_f16_f32 v224, v114, v118
    v_cvt_pk_f16_f32 v225, v122, v126
    v_cvt_pk_f16_f32 v226, v130, v134
    v_cvt_pk_f16_f32 v227, v138, v142
    ds_write_b128 v234, v[224:227] offset:14336
    v_cvt_pk_f16_f32 v228, v115, v119
    v_cvt_pk_f16_f32 v229, v123, v127
    v_cvt_pk_f16_f32 v230, v131, v135
    v_cvt_pk_f16_f32 v231, v139, v143
    ds_write_b128 v234, v[228:231] offset:15360
    v_cvt_pk_f16_f32 v224, v144, v148
    v_cvt_pk_f16_f32 v225, v152, v156
    v_cvt_pk_f16_f32 v226, v160, v164
    v_cvt_pk_f16_f32 v227, v168, v172
    ds_write_b128 v234, v[224:227] offset:4096
    v_cvt_pk_f16_f32 v228, v145, v149
    v_cvt_pk_f16_f32 v229, v153, v157
    v_cvt_pk_f16_f32 v230, v161, v165
    v_cvt_pk_f16_f32 v231, v169, v173
    ds_write_b128 v234, v[228:231] offset:5120
    v_cvt_pk_f16_f32 v224, v146, v150
    v_cvt_pk_f16_f32 v225, v154, v158
    v_cvt_pk_f16_f32 v226, v162, v166
    v_cvt_pk_f16_f32 v227, v170, v174
    ds_write_b128 v234, v[224:227] offset:16384
    v_cvt_pk_f16_f32 v228, v147, v151
    v_cvt_pk_f16_f32 v229, v155, v159
    v_cvt_pk_f16_f32 v230, v163, v167
    v_cvt_pk_f16_f32 v231, v171, v175
    s_waitcnt lgkmcnt(14)
    ds_write_b128 v234, v[228:231] offset:17408
L_conv0:
    s_getpc_b64 s[94:95]
L_pd:
    s_lshl_b32 s60, s3, 10
    s_add_u32 s60, s60, L_final-L_pd
    s_add_u32 s94, s94, s60
    s_addc_u32 s95, s95, 0
    s_waitcnt lgkmcnt(9)
    ds_read_b128 v[192:195], v22 offset:0
    ds_read_b128 a[232:235], v8 offset:0
    ds_read_b128 a[244:247], v8 offset:2560
    ds_read_b128 v[200:203], v22 offset:16
    ds_read_b128 a[236:239], v12 offset:0
    ds_read_b128 a[248:251], v12 offset:2560
    s_waitcnt lgkmcnt(9)
    ds_read_b128 a[240:243], v15 offset:1280
    ds_read_b128 a[252:255], v15 offset:3840
    ds_read_b128 v[196:199], v22 offset:256
    ds_read_b128 v[204:207], v22 offset:272
    ds_read_b128 v[176:179], v9 offset:0
    ds_read_b128 v[188:191], v9 offset:2560
    s_waitcnt lgkmcnt(14)
    ds_read_b128 v[180:183], v13 offset:0
    s_waitcnt lgkmcnt(11)
    v_mfma_f32_16x16x32_bf16 v[128:131], v[192:195], a[232:235], 0
    ds_read_b128 v[232:235], v13 offset:2560
    ds_read_b128 v[184:187], v14 offset:1280
    ds_read_b128 v[236:239], v14 offset:3840
    s_waitcnt lgkmcnt(13)
    v_mfma_f32_16x16x32_bf16 v[152:155], v[192:195], a[244:247], 0
    s_waitcnt lgkmcnt(12)
    ds_read_b128 a[232:235], v10 offset:0
    ds_read_b128 a[244:247], v10 offset:2560
    s_waitcnt lgkmcnt(11)
    v_smfmac_f32_16x16x64_bf16 v[128:131], v[200:203], a[236:243], v16
    ds_read_b128 v[192:195], v22 offset:512
    ds_read_b128 v[56:59], v20 offset:2560
    ds_read_b128 a[236:239], v14 offset:0
    s_waitcnt lgkmcnt(13)
    v_smfmac_f32_16x16x64_bf16 v[152:155], v[200:203], a[248:255], v16
    s_waitcnt lgkmcnt(12)
    ds_read_b128 a[240:243], v13 offset:1280
    ds_read_b128 a[248:251], v14 offset:2560
    v_cvt_pkrtz_f16_f32 v128, v128, v129
    s_waitcnt lgkmcnt(12)
    v_mfma_f32_16x16x32_bf16 v[224:227], v[196:199], v[176:179], 0
    ds_read_b128 a[252:255], v13 offset:3840
    v_cvt_pkrtz_f16_f32 v129, v130, v131
    v_cvt_pkrtz_f16_f32 v152, v152, v153
    v_cvt_pkrtz_f16_f32 v153, v154, v155
    s_waitcnt lgkmcnt(12)
    v_mfma_f32_16x16x32_bf16 v[228:231], v[196:199], v[188:191], 0
    s_waitcnt lgkmcnt(11)
    ds_read_b128 v[200:203], v22 offset:528
    ds_read_b128 v[176:179], v11 offset:0
    ds_read_b128 v[188:191], v11 offset:2560
    v_dot2_f32_f16 v28, v128, v128, 0
    v_dot2_f32_f16 v30, v152, v152, 0
    v_dot2_f32_f16 v28, v129, v129, v28
    s_waitcnt lgkmcnt(12)
    v_smfmac_f32_16x16x64_bf16 v[224:227], v[204:207], v[180:187], v16
    s_waitcnt lgkmcnt(10)
    ds_read_b128 v[196:199], v22 offset:768
    v_smfmac_f32_16x16x64_bf16 v[228:231], v[204:207], v[232:239], v16
    s_add_u32 m0, s56, -128
    ds_read_b128 v[180:183], v15 offset:0
    ds_read_b128 v[184:187], v12 offset:1280
    v_dot2_f32_f16 v30, v153, v153, v30
    ds_read_b128 v[60:63], v21 offset:2560
    s_waitcnt lgkmcnt(12)
    v_mfma_f32_16x16x32_bf16 v[132:135], v[192:195], a[232:235], 0
    ds_read_b128 v[232:235], v15 offset:2560
    v_cvt_pkrtz_f16_f32 v130, v224, v225
    v_cvt_pkrtz_f16_f32 v154, v228, v229
    v_cvt_pkrtz_f16_f32 v131, v226, v227
    v_mfma_f32_16x16x32_bf16 v[156:159], v[192:195], a[244:247], 0
    s_waitcnt lgkmcnt(11)
    ds_read_b128 v[236:239], v12 offset:3840
    ds_read_b128 v[204:207], v22 offset:784
    v_cvt_pkrtz_f16_f32 v155, v230, v231
    ds_read_b128 v[52:55], v21 offset:0
    v_dot2_f32_f16 v28, v130, v130, v28
    v_dot2_f32_f16 v30, v154, v154, v30
    v_dot2_f32_f16 v28, v131, v131, v28
    v_dot2_f32_f16 v30, v155, v155, v30
    s_waitcnt lgkmcnt(10)
    v_smfmac_f32_16x16x64_bf16 v[132:135], v[200:203], a[236:243], v16
    ds_read_b128 v[48:51], v20 offset:0
    ds_read_b128 v[32:35], v25 offset:0
    s_waitcnt vmcnt(1)
    ds_read_b128 a[232:235], v8 offset:6400
    v_smfmac_f32_16x16x64_bf16 v[156:159], v[200:203], a[248:255], v16
    s_waitcnt lgkmcnt(12)
    ds_read_b128 a[244:247], v8 offset:8960
    ds_read_b128 v[192:195], v22 offset:1024
    v_mfma_f32_16x16x32_f16 v[248:251], a[228:231], v[128:131], 0
    v_cvt_pkrtz_f16_f32 v132, v132, v133
    v_cvt_pkrtz_f16_f32 v133, v134, v135
    s_waitcnt vmcnt(0)
    v_mfma_f32_16x16x32_f16 v[252:255], a[228:231], v[152:155], 0
    s_waitcnt lgkmcnt(12)
    ds_read_b128 a[236:239], v12 offset:6400
    ds_read_b128 a[240:243], v15 offset:7680
    v_cvt_pkrtz_f16_f32 v156, v156, v157
    v_cvt_pkrtz_f16_f32 v157, v158, v159
    v_mfma_f32_16x16x32_bf16 v[224:227], v[196:199], v[176:179], 0
    s_waitcnt lgkmcnt(13)
    ds_read_b128 a[248:251], v12 offset:8960
    v_mfma_f32_16x16x32_bf16 v[228:231], v[196:199], v[188:191], 0
    s_waitcnt lgkmcnt(12)
    ds_read_b128 a[252:255], v15 offset:10240
    ds_read_b128 v[200:203], v22 offset:1040
    v_dot2_f32_f16 v28, v132, v132, v28
    v_dot2_f32_f16 v30, v156, v156, v30
    v_dot2_f32_f16 v28, v133, v133, v28
    v_dot2_f32_f16 v30, v157, v157, v30
    s_waitcnt lgkmcnt(11)
    v_smfmac_f32_16x16x64_bf16 v[224:227], v[204:207], v[180:187], v16
    ds_read_b128 v[176:179], v9 offset:6400
    ds_read_b128 v[188:191], v9 offset:8960
    ds_read_b128 v[196:199], v22 offset:1280
    v_smfmac_f32_16x16x64_bf16 v[228:231], v[204:207], v[232:239], v16
    s_waitcnt lgkmcnt(12)
    buffer_load_dwordx4 v1, s[20:23], 0 offen offset:128 lds
    ds_read_b128 v[180:183], v13 offset:6400
    ds_read_b128 v[184:187], v14 offset:7680
    s_waitcnt lgkmcnt(13)
    v_mfma_f32_16x16x16_bf16 v[80:83], v[18:19], v[56:57], v[32:35]
    s_add_u32 m0, s56, 896
    v_cvt_pkrtz_f16_f32 v134, v224, v225
    v_cvt_pkrtz_f16_f32 v135, v226, v227
    v_cvt_pkrtz_f16_f32 v158, v228, v229
    v_cvt_pkrtz_f16_f32 v159, v230, v231
    v_dot2_f32_f16 v28, v134, v134, v28
    v_dot2_f32_f16 v30, v158, v158, v30
    v_dot2_f32_f16 v28, v135, v135, v28
    s_waitcnt lgkmcnt(10)
    v_mfma_f32_16x16x32_bf16 v[136:139], v[192:195], a[232:235], 0
    s_waitcnt lgkmcnt(9)
    buffer_load_dwordx4 v2, s[20:23], 0 offen offset:128 lds
    ds_read_b128 v[36:39], v25 offset:16
    ds_read_b128 v[232:235], v13 offset:8960
    s_add_u32 m0, s56, 1920
    ds_read_b128 v[236:239], v14 offset:10240
    buffer_load_dwordx4 v3, s[20:23], 0 offen offset:128 lds
    s_add_u32 m0, s56, 2944
    ds_read_b128 v[204:207], v22 offset:1296
    buffer_load_dwordx4 v4, s[20:23], 0 offen offset:128 lds
    s_add_u32 m0, s56, 3968
    ds_read_b128 a[232:235], v10 offset:6400
    buffer_load_dwordx4 v5, s[20:23], 0 offen offset:128 lds
    s_add_u32 m0, s56, 4992
    s_nop 0
    buffer_load_dwordx4 v6, s[20:23], 0 offen offset:128 lds
    s_add_u32 m0, s56, 6016
    s_nop 0
    buffer_load_dword v7, s[20:23], 0 offen offset:128 lds
    s_waitcnt lgkmcnt(4)
    v_mfma_f32_16x16x16_bf16 v[84:87], v[18:19], v[58:59], v[36:39]
    v_mfma_f32_16x16x16_bf16 v[88:91], v[18:19], v[60:61], v[32:35]
    v_mfma_f32_16x16x32_bf16 v[160:163], v[192:195], a[244:247], 0
    ds_read_b128 a[244:247], v10 offset:8960
    ds_read_b128 v[192:195], v22 offset:1536
    v_mfma_f32_16x16x16_bf16 v[92:95], v[18:19], v[62:63], v[36:39]
    v_smfmac_f32_16x16x64_bf16 v[136:139], v[200:203], a[236:243], v16
    ds_read_b128 a[236:239], v14 offset:6400
    ds_read_b128 a[240:243], v13 offset:7680
    ds_read_b128 v[216:219], v20 offset:8960
    v_smfmac_f32_16x16x64_bf16 v[160:163], v[200:203], a[248:255], v16
    ds_read_b128 a[248:251], v14 offset:8960
    ds_read_b128 a[252:255], v13 offset:10240
    ds_read_b128 v[200:203], v22 offset:1552
    v_mfma_f32_16x16x16_bf16 v[40:43], v[18:19], v[52:53], v[32:35]
    v_cvt_pkrtz_f16_f32 v136, v136, v137
    v_cvt_pkrtz_f16_f32 v137, v138, v139
    v_mfma_f32_16x16x16_bf16 v[44:47], v[18:19], v[54:55], v[36:39]
    s_nop 0
    v_cvt_pkrtz_f16_f32 v160, v160, v161
    v_cvt_pkrtz_f16_f32 v161, v162, v163
    v_mfma_f32_16x16x32_f16 v[248:251], a[228:231], v[132:135], v[248:251]
    v_permlane16_swap_b32 v128, v132
    v_permlane16_swap_b32 v129, v133
    v_mfma_f32_16x16x32_f16 v[252:255], a[228:231], v[156:159], v[252:255]
    v_permlane16_swap_b32 v152, v156
    v_permlane16_swap_b32 v153, v157
    v_permlane16_swap_b32 v130, v134
    v_dot2_f32_f16 v30, v159, v159, v30
    v_permlane16_swap_b32 v154, v158
    v_permlane16_swap_b32 v131, v135
    v_permlane16_swap_b32 v155, v159
    v_mfma_f32_16x16x32_bf16 v[224:227], v[196:199], v[176:179], 0
    ds_read_b128 v[176:179], v11 offset:6400
    v_mfma_f32_16x16x32_bf16 v[228:231], v[196:199], v[188:191], 0
    s_waitcnt lgkmcnt(10)
    ds_read_b128 v[188:191], v11 offset:8960
    ds_read_b128 v[196:199], v22 offset:1792
    s_nop 0
    v_smfmac_f32_16x16x64_bf16 v[224:227], v[204:207], v[180:187], v16
    ds_read_b128 v[180:183], v15 offset:6400
    ds_read_b128 v[184:187], v12 offset:7680
    v_mfma_f32_16x16x16_bf16 v[32:35], v[18:19], v[48:49], v[32:35]
    s_waitcnt lgkmcnt(13)
    ds_read_b128 v[220:223], v21 offset:8960
    v_smfmac_f32_16x16x64_bf16 v[228:231], v[204:207], v[232:239], v16
    s_waitcnt lgkmcnt(11)
    ds_read_b128 v[232:235], v15 offset:8960
    ds_read_b128 v[236:239], v12 offset:10240
    ds_read_b128 v[204:207], v22 offset:1808
    v_cvt_pkrtz_f16_f32 v138, v224, v225
    v_mfma_f32_16x16x32_bf16 v[140:143], v[192:195], a[232:235], 0
    s_waitcnt lgkmcnt(13)
    ds_read_b128 v[212:215], v21 offset:6400
    v_cvt_pkrtz_f16_f32 v139, v226, v227
    v_mfma_f32_16x16x32_bf16 v[164:167], v[192:195], a[244:247], 0
    s_waitcnt lgkmcnt(10)
    ds_read_b128 v[192:195], v22 offset:2048
    v_cvt_pkrtz_f16_f32 v162, v228, v229
    v_cvt_pkrtz_f16_f32 v163, v230, v231
    v_smfmac_f32_16x16x64_bf16 v[140:143], v[200:203], a[236:243], v16
    v_mfma_f32_16x16x16_bf16 v[36:39], v[18:19], v[50:51], v[36:39]
    v_smfmac_f32_16x16x64_bf16 v[164:167], v[200:203], a[248:255], v16
    ds_read_b128 v[200:203], v22 offset:2064
    v_mfma_f32_16x16x32_f16 v[248:251], a[228:231], v[136:139], v[248:251]
    v_mfma_f32_16x16x32_f16 v[252:255], a[228:231], v[160:163], v[252:255]
    s_waitcnt lgkmcnt(9)
    s_nop 1
    v_cvt_pkrtz_f16_f32 v140, v140, v141
    v_cvt_pkrtz_f16_f32 v141, v142, v143
    v_mfma_f32_16x16x32_bf16 v[224:227], v[196:199], v[176:179], 0
    ds_read_b128 v[208:211], v20 offset:6400
    v_cvt_pkrtz_f16_f32 v164, v164, v165
    v_cvt_pkrtz_f16_f32 v165, v166, v167
    v_mfma_f32_16x16x32_bf16 v[228:231], v[196:199], v[188:191], 0
    s_waitcnt lgkmcnt(4)
    ds_read_b128 v[196:199], v22 offset:2304
    v_smfmac_f32_16x16x64_bf16 v[224:227], v[204:207], v[180:187], v16
    s_nop 2
    v_smfmac_f32_16x16x64_bf16 v[228:231], v[204:207], v[232:239], v16
    s_waitcnt lgkmcnt(1)
    ds_read_b128 v[204:207], v22 offset:2320
    s_nop 1
    v_cvt_pkrtz_f16_f32 v142, v224, v225
    v_dot2_f32_f16 v28, v136, v136, v28
    v_dot2_f32_f16 v30, v160, v160, v30
    v_dot2_f32_f16 v28, v137, v137, v28
    v_dot2_f32_f16 v30, v161, v161, v30
    v_dot2_f32_f16 v28, v138, v138, v28
    v_dot2_f32_f16 v30, v162, v162, v30
    v_dot2_f32_f16 v28, v139, v139, v28
    v_dot2_f32_f16 v30, v163, v163, v30
    v_dot2_f32_f16 v28, v140, v140, v28
    v_dot2_f32_f16 v30, v164, v164, v30
    v_dot2_f32_f16 v28, v141, v141, v28
    v_dot2_f32_f16 v30, v165, v165, v30
    v_cvt_pkrtz_f16_f32 v166, v228, v229
    v_cvt_pkrtz_f16_f32 v143, v226, v227
    v_cvt_pkrtz_f16_f32 v167, v230, v231
    s_waitcnt vmcnt(0)
    ds_read_b128 a[232:235], v8 offset:0
    ds_read_b128 a[244:247], v8 offset:2560
    ds_read_b128 a[236:239], v12 offset:0
    ds_read_b128 a[240:243], v15 offset:1280
    ds_read_b128 a[248:251], v12 offset:2560
    ds_read_b128 a[252:255], v15 offset:3840
    ds_read_b128 v[176:179], v9 offset:0
    ds_read_b128 v[188:191], v9 offset:2560
    ds_read_b128 v[180:183], v13 offset:0
    ds_read_b128 v[184:187], v14 offset:1280
    ds_read_b128 v[232:235], v13 offset:2560
    ds_read_b128 v[236:239], v14 offset:3840
    s_waitcnt lgkmcnt(11)
    v_mfma_f32_16x16x32_bf16 v[144:147], v[192:195], a[232:235], 0
    s_waitcnt lgkmcnt(10)
    ds_read_b128 a[232:235], v10 offset:0
    v_mfma_f32_16x16x32_bf16 v[168:171], v[192:195], a[244:247], 0
    s_waitcnt lgkmcnt(10)
    ds_read_b128 a[244:247], v10 offset:2560
    ds_read_b128 v[192:195], v22 offset:2560
    s_waitcnt lgkmcnt(11)
    v_smfmac_f32_16x16x64_bf16 v[144:147], v[200:203], a[236:243], v16
    ds_read_b128 a[236:239], v14 offset:0
    ds_read_b128 a[240:243], v13 offset:1280
    s_waitcnt lgkmcnt(11)
    v_smfmac_f32_16x16x64_bf16 v[168:171], v[200:203], a[248:255], v16
    ds_read_b128 a[248:251], v14 offset:2560
    ds_read_b128 a[252:255], v13 offset:3840
    ds_read_b128 v[200:203], v22 offset:2576
    v_mfma_f32_16x16x32_f16 v[248:251], a[228:231], v[140:143], v[248:251]
    v_cvt_pkrtz_f16_f32 v144, v144, v145
    v_cvt_pkrtz_f16_f32 v145, v146, v147
    v_mfma_f32_16x16x32_f16 v[252:255], a[228:231], v[164:167], v[252:255]
    s_waitcnt lgkmcnt(13)
    v_cvt_pkrtz_f16_f32 v168, v168, v169
    v_cvt_pkrtz_f16_f32 v169, v170, v171
    v_mfma_f32_16x16x32_bf16 v[224:227], v[196:199], v[176:179], 0
    s_waitcnt lgkmcnt(12)
    ds_read_b128 v[176:179], v11 offset:0
    v_mfma_f32_16x16x32_bf16 v[228:231], v[196:199], v[188:191], 0
    s_waitcnt lgkmcnt(11)
    ds_read_b128 v[188:191], v11 offset:2560
    ds_read_b128 v[196:199], v22 offset:2816
    v_smfmac_f32_16x16x64_bf16 v[224:227], v[204:207], v[180:187], v16
    s_waitcnt lgkmcnt(11)
    ds_read_b128 v[180:183], v15 offset:0
    ds_read_b128 v[184:187], v12 offset:1280
    v_smfmac_f32_16x16x64_bf16 v[228:231], v[204:207], v[232:239], v16
    s_waitcnt lgkmcnt(12)
    ds_read_b128 v[48:51], v25 offset:128
    ds_read_b128 v[232:235], v15 offset:2560
    s_waitcnt lgkmcnt(12)
    v_mfma_f32_16x16x32_bf16 v[148:151], v[192:195], a[232:235], 0
    ds_read_b128 v[236:239], v12 offset:3840
    v_mfma_f32_16x16x32_bf16 v[172:175], v[192:195], a[244:247], 0
    s_waitcnt lgkmcnt(12)
    ds_read_b128 v[204:207], v22 offset:2832
    v_cvt_pkrtz_f16_f32 v146, v224, v225
    v_cvt_pkrtz_f16_f32 v147, v226, v227
    v_cvt_pkrtz_f16_f32 v170, v228, v229
    v_cvt_pkrtz_f16_f32 v171, v230, v231
    s_waitcnt lgkmcnt(9)
    v_smfmac_f32_16x16x64_bf16 v[148:151], v[200:203], a[236:243], v16
    ds_read_b128 v[52:55], v25 offset:144
    v_smfmac_f32_16x16x64_bf16 v[172:175], v[200:203], a[248:255], v16
    ds_read_b128 a[232:235], v23 offset:0
    ds_read_b128 a[236:239], v23 offset:1024
    ds_read_b128 a[240:243], v23 offset:2048
    v_mfma_f32_16x16x32_f16 v[248:251], a[228:231], v[144:147], v[248:251]
    ds_read_b128 a[244:247], v23 offset:3072
    v_mfma_f32_16x16x32_f16 v[252:255], a[228:231], v[168:171], v[252:255]
    s_waitcnt lgkmcnt(11)
    v_cvt_pkrtz_f16_f32 v148, v148, v149
    v_cvt_pkrtz_f16_f32 v149, v150, v151
    v_cvt_pkrtz_f16_f32 v172, v172, v173
    v_cvt_pkrtz_f16_f32 v173, v174, v175
    v_mfma_f32_16x16x32_bf16 v[224:227], v[196:199], v[176:179], 0
    v_mfma_f32_16x16x32_bf16 v[228:231], v[196:199], v[188:191], 0
    s_waitcnt lgkmcnt(9)
    s_waitcnt lgkmcnt(5)
    s_nop 2
    v_smfmac_f32_16x16x64_bf16 v[224:227], v[204:207], v[180:187], v16
    ds_read_b128 v[64:67], v25 offset:256
    v_smfmac_f32_16x16x64_bf16 v[228:231], v[204:207], v[232:239], v16
    ds_read_b128 v[68:71], v25 offset:272
    s_waitcnt lgkmcnt(0)
    s_barrier
    ds_read_b128 a[248:251], v23 offset:4096
    ds_read_b128 a[252:255], v23 offset:5120
    s_branch L_mid
L_final:
    v_mfma_f32_16x16x32_bf16 v[88:91], a[168:171], v[244:247], v[88:91]
    v_cvt_pk_bf16_f32 v80, v80, v81
    v_cvt_pk_bf16_f32 v81, v82, v83
    v_cvt_pk_bf16_f32 v82, v84, v85
    v_mfma_f32_16x16x32_bf16 v[92:95], a[172:175], v[244:247], v[92:95]
    v_cvt_pk_bf16_f32 v83, v86, v87
    v_cvt_pk_bf16_f32 v96, v96, v97
    v_cvt_pk_bf16_f32 v97, v98, v99
    v_mfma_f32_16x16x32_bf16 v[104:107], a[176:179], v[244:247], v[104:107]
    buffer_store_dwordx4 v[80:83], v26, s[24:27], s82 offen offset:0 sc0 sc1
    v_mfma_f32_16x16x32_bf16 v[108:111], a[180:183], v[244:247], v[108:111]
    v_cvt_pk_bf16_f32 v98, v100, v101
    v_cvt_pk_bf16_f32 v99, v102, v103
    v_cvt_pk_bf16_f32 v112, v112, v113
    v_mfma_f32_16x16x32_bf16 v[120:123], a[184:187], v[244:247], v[120:123]
    buffer_store_dwordx4 v[96:99], v26, s[24:27], s82 offen offset:64 sc0 sc1
    v_mfma_f32_16x16x32_bf16 v[124:127], a[188:191], v[244:247], v[124:127]
    v_cvt_pk_bf16_f32 v113, v114, v115
    v_cvt_pk_bf16_f32 v114, v116, v117
    v_cvt_pk_bf16_f32 v115, v118, v119
    v_cvt_pk_bf16_f32 v88, v88, v89
    v_cvt_pk_bf16_f32 v89, v90, v91
    v_cvt_pk_bf16_f32 v90, v92, v93
    v_cvt_pk_bf16_f32 v91, v94, v95
    v_cvt_pk_bf16_f32 v104, v104, v105
    v_cvt_pk_bf16_f32 v105, v106, v107
    v_cvt_pk_bf16_f32 v106, v108, v109
    v_cvt_pk_bf16_f32 v107, v110, v111
    v_cvt_pk_bf16_f32 v120, v120, v121
    v_cvt_pk_bf16_f32 v121, v122, v123
    v_cvt_pk_bf16_f32 v122, v124, v125
    v_cvt_pk_bf16_f32 v123, v126, v127
    buffer_store_dwordx4 v[112:115], v26, s[24:27], s82 offen offset:128 sc0 sc1
    buffer_store_dwordx4 v[88:91], v26, s[24:27], s83 offen offset:0 sc0 sc1
    buffer_store_dwordx4 v[104:107], v26, s[24:27], s83 offen offset:64 sc0 sc1
    buffer_store_dwordx4 v[120:123], v26, s[24:27], s83 offen offset:128 sc0 sc1
L_end:
    s_endpgm
L_conv:
    v_cvt_pk_bf16_f32 v80, v80, v81
    v_cvt_pk_bf16_f32 v81, v82, v83
    v_cvt_pk_bf16_f32 v82, v84, v85
    s_waitcnt lgkmcnt(3)
    v_mfma_f32_16x16x32_bf16 v[128:131], v[192:195], a[232:235], 0
    ds_read_b128 a[232:235], v8 offset:6400
    v_cvt_pk_bf16_f32 v83, v86, v87
    v_cvt_pk_bf16_f32 v96, v96, v97
    v_mfma_f32_16x16x32_bf16 v[88:91], a[168:171], v[244:247], v[88:91]
    v_cvt_pk_bf16_f32 v97, v98, v99
    v_cvt_pk_bf16_f32 v98, v100, v101
    v_cvt_pk_bf16_f32 v99, v102, v103
    v_mfma_f32_16x16x32_bf16 v[152:155], v[192:195], a[244:247], 0
    ds_read_b128 a[244:247], v8 offset:8960
    ds_read_b128 v[192:195], v22 offset:512
    v_cvt_pk_bf16_f32 v112, v112, v113
    v_mfma_f32_16x16x32_bf16 v[92:95], a[172:175], v[244:247], v[92:95]
    s_waitcnt lgkmcnt(3)
    v_cvt_pk_bf16_f32 v88, v88, v89
    v_cvt_pk_bf16_f32 v89, v90, v91
    v_cvt_pk_bf16_f32 v113, v114, v115
    v_smfmac_f32_16x16x64_bf16 v[128:131], v[200:203], a[236:243], v16
    ds_read_b128 a[236:239], v12 offset:6400
    ds_read_b128 a[240:243], v15 offset:7680
    v_cvt_pk_bf16_f32 v114, v116, v117
    v_smfmac_f32_16x16x64_bf16 v[152:155], v[200:203], a[248:255], v16
    ds_read_b128 a[248:251], v12 offset:8960
    ds_read_b128 a[252:255], v15 offset:10240
    ds_read_b128 v[200:203], v22 offset:528
    v_mfma_f32_16x16x32_bf16 v[224:227], v[196:199], v[176:179], 0
    ds_read_b128 v[176:179], v9 offset:6400
    v_cvt_pkrtz_f16_f32 v128, v128, v129
    v_cvt_pkrtz_f16_f32 v129, v130, v131
    v_mfma_f32_16x16x32_bf16 v[228:231], v[196:199], v[188:191], 0
    ds_read_b128 v[188:191], v9 offset:8960
    ds_read_b128 v[196:199], v22 offset:768
    v_cvt_pkrtz_f16_f32 v152, v152, v153
    v_smfmac_f32_16x16x64_bf16 v[224:227], v[204:207], v[180:187], v16
    ds_read_b128 v[180:183], v13 offset:6400
    ds_read_b128 v[184:187], v14 offset:7680
    v_cvt_pkrtz_f16_f32 v153, v154, v155
    v_smfmac_f32_16x16x64_bf16 v[228:231], v[204:207], v[232:239], v16
    s_waitcnt lgkmcnt(10)
    ds_read_b128 v[232:235], v13 offset:8960
    ds_read_b128 v[236:239], v14 offset:10240
    ds_read_b128 v[204:207], v22 offset:784
    v_mfma_f32_16x16x32_bf16 v[132:135], v[192:195], v[32:35], 0
    v_cvt_pkrtz_f16_f32 v130, v224, v225
    v_cvt_pkrtz_f16_f32 v131, v226, v227
    v_cvt_pk_bf16_f32 v90, v92, v93
    v_mfma_f32_16x16x32_bf16 v[104:107], a[176:179], v[244:247], v[104:107]
    v_cvt_pkrtz_f16_f32 v154, v228, v229
    v_cvt_pkrtz_f16_f32 v155, v230, v231
    v_cvt_pk_bf16_f32 v91, v94, v95
    v_mfma_f32_16x16x32_bf16 v[156:159], v[192:195], v[44:47], 0
    ds_read_b128 v[192:195], v22 offset:1024
    v_cvt_pk_bf16_f32 v115, v118, v119
    v_mfma_f32_16x16x32_bf16 v[108:111], a[180:183], v[244:247], v[108:111]
    s_waitcnt lgkmcnt(9)
    ds_read_b128 v[32:35], v25 offset:0
    v_cvt_pk_bf16_f32 v104, v104, v105
    v_cvt_pk_bf16_f32 v105, v106, v107
    v_smfmac_f32_16x16x64_bf16 v[132:135], v[200:203], v[36:43], v16
    v_smfmac_f32_16x16x64_bf16 v[156:159], v[200:203], v[64:71], v16
    ds_read_b128 v[200:203], v22 offset:1040
    ds_read_b128 v[36:39], v25 offset:16
    v_mfma_f32_16x16x32_f16 v[248:251], a[228:231], v[128:131], 0
    v_cvt_pk_bf16_f32 v106, v108, v109
    v_cvt_pk_bf16_f32 v107, v110, v111
    s_waitcnt vmcnt(13)
    v_mfma_f32_16x16x32_f16 v[252:255], a[228:231], v[152:155], 0
    s_waitcnt lgkmcnt(9)
    v_cvt_pkrtz_f16_f32 v132, v132, v133
    v_cvt_pkrtz_f16_f32 v156, v156, v157
    v_cvt_pkrtz_f16_f32 v133, v134, v135
    v_cvt_pkrtz_f16_f32 v157, v158, v159
    v_dot2_f32_f16 v28, v128, v128, 0
    v_dot2_f32_f16 v30, v152, v152, 0
    v_dot2_f32_f16 v28, v129, v129, v28
    v_dot2_f32_f16 v30, v153, v153, v30
    v_dot2_f32_f16 v28, v130, v130, v28
    v_dot2_f32_f16 v30, v154, v154, v30
    v_dot2_f32_f16 v28, v131, v131, v28
    v_dot2_f32_f16 v30, v155, v155, v30
    v_dot2_f32_f16 v28, v132, v132, v28
    v_dot2_f32_f16 v30, v156, v156, v30
    v_dot2_f32_f16 v28, v133, v133, v28
    v_mfma_f32_16x16x32_bf16 v[224:227], v[196:199], v[136:139], 0
    ds_read_b128 v[216:219], v20 offset:8960
    v_mfma_f32_16x16x32_bf16 v[228:231], v[196:199], v[148:151], 0
    s_waitcnt lgkmcnt(5)
    ds_read_b128 v[196:199], v22 offset:1280
    s_nop 1
    v_smfmac_f32_16x16x64_bf16 v[224:227], v[204:207], v[140:147], v16
    buffer_store_dwordx4 v[80:83], v26, s[24:27], s82 offen offset:0 sc0 sc1
    v_smfmac_f32_16x16x64_bf16 v[228:231], v[204:207], v[72:79], v16
    s_waitcnt lgkmcnt(5)
    ds_read_b128 v[204:207], v22 offset:1296
    v_mfma_f32_16x16x32_bf16 v[136:139], v[192:195], a[232:235], 0
    ds_read_b128 a[232:235], v10 offset:6400
    v_mfma_f32_16x16x32_bf16 v[120:123], a[184:187], v[244:247], v[120:123]
    s_nop 0
    v_cvt_pkrtz_f16_f32 v134, v224, v225
    v_cvt_pkrtz_f16_f32 v135, v226, v227
    v_mfma_f32_16x16x32_bf16 v[160:163], v[192:195], a[244:247], 0
    s_waitcnt lgkmcnt(6)
    ds_read_b128 a[244:247], v10 offset:8960
    ds_read_b128 v[192:195], v22 offset:1536
    v_cvt_pkrtz_f16_f32 v158, v228, v229
    v_mfma_f32_16x16x16_bf16 v[80:83], v[18:19], v[56:57], v[32:35]
    s_waitcnt lgkmcnt(7)
    v_cvt_pkrtz_f16_f32 v159, v230, v231
    v_cvt_pk_bf16_f32 v120, v120, v121
    v_cvt_pk_bf16_f32 v121, v122, v123
    v_smfmac_f32_16x16x64_bf16 v[136:139], v[200:203], a[236:243], v16
    ds_read_b128 a[236:239], v14 offset:6400
    ds_read_b128 a[240:243], v13 offset:7680
    v_mfma_f32_16x16x32_bf16 v[124:127], a[188:191], v[244:247], v[124:127]
    buffer_store_dwordx4 v[88:91], v26, s[24:27], s83 offen offset:0 sc0 sc1
    v_smfmac_f32_16x16x64_bf16 v[160:163], v[200:203], a[248:255], v16
    ds_read_b128 a[248:251], v14 offset:8960
    ds_read_b128 a[252:255], v13 offset:10240
    ds_read_b128 v[200:203], v22 offset:1552
    v_mfma_f32_16x16x32_f16 v[248:251], a[228:231], v[132:135], v[248:251]
    v_cvt_pkrtz_f16_f32 v136, v136, v137
    v_cvt_pkrtz_f16_f32 v137, v138, v139
    v_cvt_pk_bf16_f32 v122, v124, v125
    v_mfma_f32_16x16x32_f16 v[252:255], a[228:231], v[156:159], v[252:255]
    s_waitcnt lgkmcnt(9)
    v_cvt_pkrtz_f16_f32 v160, v160, v161
    v_cvt_pkrtz_f16_f32 v161, v162, v163
    v_cvt_pk_bf16_f32 v123, v126, v127
    v_mfma_f32_16x16x32_bf16 v[224:227], v[196:199], v[176:179], 0
    ds_read_b128 v[176:179], v11 offset:6400
    v_permlane16_swap_b32 v128, v132
    v_mfma_f32_16x16x16_bf16 v[84:87], v[18:19], v[58:59], v[36:39]
    v_permlane16_swap_b32 v152, v156
    v_permlane16_swap_b32 v129, v133
    v_mfma_f32_16x16x32_bf16 v[228:231], v[196:199], v[188:191], 0
    ds_read_b128 v[188:191], v11 offset:8960
    ds_read_b128 v[196:199], v22 offset:1792
    v_mfma_f32_16x16x16_bf16 v[88:91], v[18:19], v[60:61], v[32:35]
    s_waitcnt lgkmcnt(11)
    v_smfmac_f32_16x16x64_bf16 v[224:227], v[204:207], v[180:187], v16
    ds_read_b128 v[180:183], v15 offset:6400
    ds_read_b128 v[184:187], v12 offset:7680
    v_smfmac_f32_16x16x64_bf16 v[228:231], v[204:207], v[232:239], v16
    s_waitcnt lgkmcnt(11)
    ds_read_b128 v[232:235], v15 offset:8960
    ds_read_b128 v[236:239], v12 offset:10240
    ds_read_b128 v[204:207], v22 offset:1808
    v_mfma_f32_16x16x16_bf16 v[92:95], v[18:19], v[62:63], v[36:39]
    s_waitcnt lgkmcnt(13)
    v_cvt_pkrtz_f16_f32 v138, v224, v225
    v_cvt_pkrtz_f16_f32 v139, v226, v227
    v_mfma_f32_16x16x32_bf16 v[140:143], v[192:195], a[232:235], 0
    s_waitcnt vmcnt(2)
    ds_read_b128 a[232:235], v8 offset:0
    buffer_store_dwordx4 v[96:99], v26, s[24:27], s82 offen offset:64 sc0 sc1
    v_mfma_f32_16x16x16_bf16 v[40:43], v[18:19], v[52:53], v[32:35]
    v_cvt_pkrtz_f16_f32 v162, v228, v229
    v_cvt_pkrtz_f16_f32 v163, v230, v231
    v_mfma_f32_16x16x32_bf16 v[164:167], v[192:195], a[244:247], 0
    s_waitcnt lgkmcnt(9)
    ds_read_b128 a[244:247], v8 offset:2560
    ds_read_b128 v[192:195], v22 offset:2048
    buffer_store_dwordx4 v[104:107], v26, s[24:27], s83 offen offset:64 sc0 sc1
    v_smfmac_f32_16x16x64_bf16 v[140:143], v[200:203], a[236:243], v16
    ds_read_b128 a[236:239], v12 offset:0
    ds_read_b128 a[240:243], v15 offset:1280
    v_smfmac_f32_16x16x64_bf16 v[164:167], v[200:203], a[248:255], v16
    s_waitcnt lgkmcnt(11)
    ds_read_b128 a[248:251], v12 offset:2560
    ds_read_b128 a[252:255], v15 offset:3840
    ds_read_b128 v[200:203], v22 offset:2064
    v_mfma_f32_16x16x32_f16 v[248:251], a[228:231], v[136:139], v[248:251]
    v_cvt_pkrtz_f16_f32 v140, v140, v141
    v_cvt_pkrtz_f16_f32 v141, v142, v143
    v_mfma_f32_16x16x32_f16 v[252:255], a[228:231], v[160:163], v[252:255]
    s_waitcnt lgkmcnt(13)
    v_cvt_pkrtz_f16_f32 v164, v164, v165
    v_cvt_pkrtz_f16_f32 v165, v166, v167
    v_mfma_f32_16x16x32_bf16 v[224:227], v[196:199], v[176:179], 0
    ds_read_b128 v[176:179], v9 offset:0
    buffer_store_dwordx4 v[112:115], v26, s[24:27], s82 offen offset:128 sc0 sc1
    v_mfma_f32_16x16x16_bf16 v[44:47], v[18:19], v[54:55], v[36:39]
    s_waitcnt lgkmcnt(13)
    ds_read_b128 v[220:223], v21 offset:8960
    v_mfma_f32_16x16x32_bf16 v[228:231], v[196:199], v[188:191], 0
    s_waitcnt lgkmcnt(10)
    ds_read_b128 v[188:191], v9 offset:2560
    ds_read_b128 v[196:199], v22 offset:2304
    v_smfmac_f32_16x16x64_bf16 v[224:227], v[204:207], v[180:187], v16
    ds_read_b128 v[180:183], v13 offset:0
    ds_read_b128 v[184:187], v14 offset:1280
    v_smfmac_f32_16x16x64_bf16 v[228:231], v[204:207], v[232:239], v16
    s_waitcnt lgkmcnt(11)
    ds_read_b128 v[232:235], v13 offset:2560
    ds_read_b128 v[236:239], v14 offset:3840
    ds_read_b128 v[204:207], v22 offset:2320
    v_mfma_f32_16x16x16_bf16 v[32:35], v[18:19], v[48:49], v[32:35]
    s_waitcnt lgkmcnt(13)
    ds_read_b128 v[212:215], v21 offset:6400
    v_cvt_pkrtz_f16_f32 v142, v224, v225
    v_cvt_pkrtz_f16_f32 v143, v226, v227
    v_cvt_pkrtz_f16_f32 v166, v228, v229
    v_dot2_f32_f16 v30, v157, v157, v30
    v_dot2_f32_f16 v28, v134, v134, v28
    v_dot2_f32_f16 v30, v158, v158, v30
    v_dot2_f32_f16 v28, v135, v135, v28
    v_dot2_f32_f16 v30, v159, v159, v30
    v_dot2_f32_f16 v28, v136, v136, v28
    v_dot2_f32_f16 v30, v160, v160, v30
    v_dot2_f32_f16 v28, v137, v137, v28
    v_dot2_f32_f16 v30, v161, v161, v30
    v_dot2_f32_f16 v28, v138, v138, v28
    v_dot2_f32_f16 v30, v162, v162, v30
    v_dot2_f32_f16 v28, v139, v139, v28
    v_dot2_f32_f16 v30, v163, v163, v30
    v_dot2_f32_f16 v28, v140, v140, v28
    v_dot2_f32_f16 v30, v164, v164, v30
    v_dot2_f32_f16 v28, v141, v141, v28
    v_dot2_f32_f16 v30, v165, v165, v30
    v_permlane16_swap_b32 v153, v157
    v_permlane16_swap_b32 v130, v134
    v_permlane16_swap_b32 v154, v158
    v_mfma_f32_16x16x32_bf16 v[144:147], v[192:195], a[232:235], 0
    s_waitcnt lgkmcnt(13)
    ds_read_b128 a[232:235], v10 offset:0
    v_permlane16_swap_b32 v131, v135
    v_mfma_f32_16x16x32_bf16 v[168:171], v[192:195], a[244:247], 0
    s_waitcnt lgkmcnt(11)
    ds_read_b128 a[244:247], v10 offset:2560
    ds_read_b128 v[192:195], v22 offset:2560
    v_permlane16_swap_b32 v155, v159
    v_smfmac_f32_16x16x64_bf16 v[144:147], v[200:203], a[236:243], v16
    s_waitcnt lgkmcnt(12)
    ds_read_b128 a[236:239], v14 offset:0
    ds_read_b128 a[240:243], v13 offset:1280
    v_cvt_pkrtz_f16_f32 v167, v230, v231
    v_smfmac_f32_16x16x64_bf16 v[168:171], v[200:203], a[248:255], v16
    s_waitcnt lgkmcnt(11)
    ds_read_b128 a[248:251], v14 offset:2560
    ds_read_b128 a[252:255], v13 offset:3840
    ds_read_b128 v[200:203], v22 offset:2576
    v_mfma_f32_16x16x32_f16 v[248:251], a[228:231], v[140:143], v[248:251]
    v_cvt_pkrtz_f16_f32 v144, v144, v145
    v_cvt_pkrtz_f16_f32 v145, v146, v147
    v_mfma_f32_16x16x32_f16 v[252:255], a[228:231], v[164:167], v[252:255]
    v_cvt_pkrtz_f16_f32 v168, v168, v169
    v_cvt_pkrtz_f16_f32 v169, v170, v171
    v_mfma_f32_16x16x32_bf16 v[224:227], v[196:199], v[176:179], 0
    s_waitcnt lgkmcnt(13)
    ds_read_b128 v[176:179], v11 offset:0
    v_mfma_f32_16x16x32_bf16 v[228:231], v[196:199], v[188:191], 0
    s_waitcnt lgkmcnt(10)
    ds_read_b128 v[188:191], v11 offset:2560
    ds_read_b128 v[196:199], v22 offset:2816
    v_smfmac_f32_16x16x64_bf16 v[224:227], v[204:207], v[180:187], v16
    ds_read_b128 v[180:183], v15 offset:0
    ds_read_b128 v[184:187], v12 offset:1280
    v_mfma_f32_16x16x16_bf16 v[36:39], v[18:19], v[50:51], v[36:39]
    s_waitcnt lgkmcnt(12)
    ds_read_b128 v[48:51], v25 offset:128
    ds_read_b128 v[52:55], v25 offset:144
    v_smfmac_f32_16x16x64_bf16 v[228:231], v[204:207], v[232:239], v16
    s_waitcnt lgkmcnt(11)
    ds_read_b128 v[232:235], v15 offset:2560
    ds_read_b128 v[236:239], v12 offset:3840
    ds_read_b128 v[204:207], v22 offset:2832
    v_mfma_f32_16x16x32_bf16 v[148:151], v[192:195], a[232:235], 0
    v_cvt_pkrtz_f16_f32 v146, v224, v225
    v_cvt_pkrtz_f16_f32 v147, v226, v227
    v_mfma_f32_16x16x32_bf16 v[172:175], v[192:195], a[244:247], 0
    s_waitcnt lgkmcnt(10)
    buffer_store_dwordx4 v[120:123], v26, s[24:27], s83 offen offset:128 sc0 sc1
    v_cvt_pkrtz_f16_f32 v170, v228, v229
    v_cvt_pkrtz_f16_f32 v171, v230, v231
    v_smfmac_f32_16x16x64_bf16 v[148:151], v[200:203], a[236:243], v16
    ds_read_b128 v[64:67], v25 offset:256
    v_smfmac_f32_16x16x64_bf16 v[172:175], v[200:203], a[248:255], v16
    ds_read_b128 v[68:71], v25 offset:272
    ds_read_b128 a[232:235], v23 offset:0
    ds_read_b128 a[236:239], v23 offset:1024
    v_mfma_f32_16x16x32_f16 v[248:251], a[228:231], v[144:147], v[248:251]
    s_nop 1
    v_cvt_pkrtz_f16_f32 v148, v148, v149
    v_cvt_pkrtz_f16_f32 v149, v150, v151
    v_mfma_f32_16x16x32_f16 v[252:255], a[228:231], v[168:171], v[252:255]
    s_waitcnt lgkmcnt(11)
    v_cvt_pkrtz_f16_f32 v172, v172, v173
    v_cvt_pkrtz_f16_f32 v173, v174, v175
    v_mfma_f32_16x16x32_bf16 v[224:227], v[196:199], v[176:179], 0
    s_waitcnt lgkmcnt(5)
    v_mfma_f32_16x16x32_bf16 v[228:231], v[196:199], v[188:191], 0
    s_add_u32 s80, s80, 786432
    ds_read_b128 a[240:243], v23 offset:2048
    ds_read_b128 a[244:247], v23 offset:3072
    s_waitcnt lgkmcnt(6)
    v_smfmac_f32_16x16x64_bf16 v[224:227], v[204:207], v[180:187], v16
    s_add_u32 s81, s81, 786432
    s_add_u32 s82, s82, 786432
    ds_read_b128 v[208:211], v20 offset:6400
    ds_read_b128 a[248:251], v23 offset:4096
    v_smfmac_f32_16x16x64_bf16 v[228:231], v[204:207], v[232:239], v16
    s_add_u32 s83, s83, 786432
    ds_read_b128 a[252:255], v23 offset:5120
L_mid:
    v_permlane16_swap_b32 v136, v140
    v_cvt_pkrtz_f16_f32 v150, v224, v225
    v_cvt_pkrtz_f16_f32 v151, v226, v227
    v_dot2_f32_f16 v28, v142, v142, v28
    v_dot2_f32_f16 v30, v166, v166, v30
    v_mfma_f32_16x16x32_f16 v[248:251], a[228:231], v[148:151], v[248:251]
    v_cvt_pkrtz_f16_f32 v174, v228, v229
    v_cvt_pkrtz_f16_f32 v175, v230, v231
    v_permlane16_swap_b32 v160, v164
    v_permlane16_swap_b32 v137, v141
    v_mfma_f32_16x16x32_f16 v[252:255], a[228:231], v[172:175], v[252:255]
    s_cmp_eq_u32 s52, 3
    v_permlane16_swap_b32 v161, v165
    v_permlane16_swap_b32 v138, v142
    v_permlane16_swap_b32 v162, v166
    v_dot2_f32_f16 v28, v143, v143, v28
    v_dot2_f32_f16 v30, v167, v167, v30
    v_dot2_f32_f16 v28, v144, v144, v28
    v_dot2_f32_f16 v30, v168, v168, v30
    v_dot2_f32_f16 v28, v145, v145, v28
    v_dot2_f32_f16 v30, v169, v169, v30
    v_dot2_f32_f16 v28, v146, v146, v28
    v_dot2_f32_f16 v30, v170, v170, v30
    v_dot2_f32_f16 v28, v147, v147, v28
    v_dot2_f32_f16 v30, v171, v171, v30
    v_dot2_f32_f16 v28, v148, v148, v28
    v_dot2_f32_f16 v30, v172, v172, v30
    v_dot2_f32_f16 v28, v149, v149, v28
    v_dot2_f32_f16 v30, v173, v173, v30
    v_dot2_f32_f16 v28, v150, v150, v28
    v_dot2_f32_f16 v30, v174, v174, v30
    v_dot2_f32_f16 v28, v151, v151, v28
    v_dot2_f32_f16 v30, v175, v175, v30
    v_permlane16_swap_b32 v139, v143
    v_permlane16_swap_b32 v163, v167
    v_permlane16_swap_b32 v144, v148
    v_mfma_f32_16x16x16_bf16 v[96:99], v[18:19], v[216:217], v[48:51]
    s_cselect_b32 s57, 0x40000000, 786432
    ds_read_b128 v[240:243], v20 offset:2560
    ds_read_b128 v[244:247], v21 offset:2560
    v_add_u32 v1, s57, v1
    v_mfma_f32_16x16x16_bf16 v[100:103], v[18:19], v[218:219], v[52:55]
    ds_read_b128 v[236:239], v21 offset:0
    ds_read_b128 v[232:235], v20 offset:0
    v_add_u32 v2, s57, v2
    v_mfma_f32_16x16x16_bf16 v[104:107], v[18:19], v[220:221], v[48:51]
    v_add_u32 v3, s57, v3
    v_add_u32 v4, s57, v4
    v_add_u32 v5, s57, v5
    v_mfma_f32_16x16x16_bf16 v[108:111], v[18:19], v[222:223], v[52:55]
    v_add_u32 v6, s57, v6
    v_add_u32 v7, s57, v7
    v_add_u32 v31, s57, v31
    v_mfma_f32_16x16x16_bf16 v[56:59], v[18:19], v[212:213], v[48:51]
    v_permlane16_swap_b32 v168, v172
    v_permlane16_swap_b32 v145, v149
    v_mfma_f32_16x16x16_bf16 v[60:63], v[18:19], v[214:215], v[52:55]
    s_waitcnt lgkmcnt(6)
    v_permlane16_swap_b32 v169, v173
    v_permlane16_swap_b32 v146, v150
    v_mfma_f32_16x16x16_bf16 v[48:51], v[18:19], v[208:209], v[48:51]
    v_permlane16_swap_b32 v170, v174
    v_permlane16_swap_b32 v147, v151
    v_mfma_f32_16x16x16_bf16 v[52:55], v[18:19], v[210:211], v[52:55]
    v_permlane16_swap_b32 v171, v175
    v_mov_b32 v27, v28
    v_mov_b32 v29, v30
    s_nop 0
    v_permlane32_swap_b32 v27, v28
    v_permlane32_swap_b32 v29, v30
    v_add_f32 v28, v27, v28
    v_add_f32 v30, v29, v30
    v_mul_f32 v27, 0x3c2aaaab, v248
    v_mul_f32 v29, 0x3c2aaaab, v252
    v_mul_f32 v28, 0x3c2aaaab, v28
    v_mul_f32 v30, 0x3c2aaaab, v30
    v_fma_f32 v28, -v27, v27, v28
    v_fma_f32 v30, -v29, v29, v30
    v_max_f32 v28, 0, v28
    v_max_f32 v30, 0, v30
    v_add_f32 v28, 0x3727c5ac, v28
    v_add_f32 v30, 0x3727c5ac, v30
    v_rsq_f32 v28, v28
    v_rsq_f32 v30, v30
    v_fma_mixlo_f16 v28, v28, s59, 0
    v_fma_mixlo_f16 v30, v30, s59, 0
    v_fma_mixhi_f16 v28, -v27, v28, 0 op_sel_hi:[0,1,0]
    v_fma_mixhi_f16 v30, -v29, v30, 0 op_sel_hi:[0,1,0]
    v_mov_b32 v27, v28
    v_mov_b32 v29, v30
    s_nop 0
    v_permlane16_swap_b32 v28, v27
    v_permlane16_swap_b32 v30, v29
    v_pk_fma_f16 v128, v128, v28, v28 op_sel:[0,0,1] op_sel_hi:[1,0,1]
    v_pk_fma_f16 v129, v129, v28, v28 op_sel:[0,0,1] op_sel_hi:[1,0,1]
    v_pk_fma_f16 v130, v130, v28, v28 op_sel:[0,0,1] op_sel_hi:[1,0,1]
    v_pk_fma_f16 v131, v131, v28, v28 op_sel:[0,0,1] op_sel_hi:[1,0,1]
    v_pk_fma_f16 v132, v132, v27, v27 op_sel:[0,0,1] op_sel_hi:[1,0,1]
    v_pk_fma_f16 v133, v133, v27, v27 op_sel:[0,0,1] op_sel_hi:[1,0,1]
    v_mfma_f32_16x16x32_f16 v[176:179], a[232:235], v[128:131], 0
    v_pk_fma_f16 v134, v134, v27, v27 op_sel:[0,0,1] op_sel_hi:[1,0,1]
    v_pk_fma_f16 v135, v135, v27, v27 op_sel:[0,0,1] op_sel_hi:[1,0,1]
    v_pk_fma_f16 v136, v136, v28, v28 op_sel:[0,0,1] op_sel_hi:[1,0,1]
    v_pk_fma_f16 v137, v137, v28, v28 op_sel:[0,0,1] op_sel_hi:[1,0,1]
    v_mfma_f32_16x16x32_f16 v[184:187], a[232:235], v[132:135], 0
    v_pk_fma_f16 v138, v138, v28, v28 op_sel:[0,0,1] op_sel_hi:[1,0,1]
    v_pk_fma_f16 v139, v139, v28, v28 op_sel:[0,0,1] op_sel_hi:[1,0,1]
    v_pk_fma_f16 v140, v140, v27, v27 op_sel:[0,0,1] op_sel_hi:[1,0,1]
    v_mfma_f32_16x16x32_f16 v[180:183], a[236:239], v[128:131], 0
    v_pk_fma_f16 v141, v141, v27, v27 op_sel:[0,0,1] op_sel_hi:[1,0,1]
    v_pk_fma_f16 v142, v142, v27, v27 op_sel:[0,0,1] op_sel_hi:[1,0,1]
    v_pk_fma_f16 v143, v143, v27, v27 op_sel:[0,0,1] op_sel_hi:[1,0,1]
    v_mfma_f32_16x16x32_f16 v[188:191], a[236:239], v[132:135], 0
    v_pk_fma_f16 v147, v147, v28, v28 op_sel:[0,0,1] op_sel_hi:[1,0,1]
    v_pk_fma_f16 v144, v144, v28, v28 op_sel:[0,0,1] op_sel_hi:[1,0,1]
    v_pk_fma_f16 v145, v145, v28, v28 op_sel:[0,0,1] op_sel_hi:[1,0,1]
    v_mfma_f32_16x16x32_f16 v[176:179], a[240:243], v[136:139], v[176:179]
    v_bfi_b32 v147, v17, v147, s84
    v_pk_fma_f16 v146, v146, v28, v28 op_sel:[0,0,1] op_sel_hi:[1,0,1]
    v_pk_fma_f16 v151, v151, v27, v27 op_sel:[0,0,1] op_sel_hi:[1,0,1]
    v_mfma_f32_16x16x32_f16 v[184:187], a[240:243], v[140:143], v[184:187]
    v_pk_fma_f16 v148, v148, v27, v27 op_sel:[0,0,1] op_sel_hi:[1,0,1]
    v_pk_fma_f16 v149, v149, v27, v27 op_sel:[0,0,1] op_sel_hi:[1,0,1]
    v_bfi_b32 v151, v17, v151, s84
    v_mfma_f32_16x16x32_f16 v[180:183], a[244:247], v[136:139], v[180:183]
    v_pk_fma_f16 v150, v150, v27, v27 op_sel:[0,0,1] op_sel_hi:[1,0,1]
    v_pk_fma_f16 v152, v152, v30, v30 op_sel:[0,0,1] op_sel_hi:[1,0,1]
    v_pk_fma_f16 v153, v153, v30, v30 op_sel:[0,0,1] op_sel_hi:[1,0,1]
    v_mfma_f32_16x16x32_f16 v[188:191], a[244:247], v[140:143], v[188:191]
    s_waitcnt lgkmcnt(5)
    v_pk_fma_f16 v154, v154, v30, v30 op_sel:[0,0,1] op_sel_hi:[1,0,1]
    v_pk_fma_f16 v155, v155, v30, v30 op_sel:[0,0,1] op_sel_hi:[1,0,1]
    v_pk_fma_f16 v156, v156, v29, v29 op_sel:[0,0,1] op_sel_hi:[1,0,1]
    v_mfma_f32_16x16x32_f16 v[176:179], a[248:251], v[144:147], v[176:179]
    v_pk_fma_f16 v157, v157, v29, v29 op_sel:[0,0,1] op_sel_hi:[1,0,1]
    v_pk_fma_f16 v158, v158, v29, v29 op_sel:[0,0,1] op_sel_hi:[1,0,1]
    v_pk_fma_f16 v159, v159, v29, v29 op_sel:[0,0,1] op_sel_hi:[1,0,1]
    v_mfma_f32_16x16x32_f16 v[184:187], a[248:251], v[148:151], v[184:187]
    s_waitcnt lgkmcnt(4)
    v_pk_fma_f16 v160, v160, v30, v30 op_sel:[0,0,1] op_sel_hi:[1,0,1]
    v_pk_fma_f16 v161, v161, v30, v30 op_sel:[0,0,1] op_sel_hi:[1,0,1]
    v_pk_fma_f16 v162, v162, v30, v30 op_sel:[0,0,1] op_sel_hi:[1,0,1]
    v_mfma_f32_16x16x32_f16 v[180:183], a[252:255], v[144:147], v[180:183]
    v_pk_fma_f16 v163, v163, v30, v30 op_sel:[0,0,1] op_sel_hi:[1,0,1]
    v_pk_fma_f16 v164, v164, v29, v29 op_sel:[0,0,1] op_sel_hi:[1,0,1]
    v_pk_fma_f16 v165, v165, v29, v29 op_sel:[0,0,1] op_sel_hi:[1,0,1]
    v_mfma_f32_16x16x32_f16 v[188:191], a[252:255], v[148:151], v[188:191]
    v_pk_fma_f16 v166, v166, v29, v29 op_sel:[0,0,1] op_sel_hi:[1,0,1]
    v_pk_fma_f16 v167, v167, v29, v29 op_sel:[0,0,1] op_sel_hi:[1,0,1]
    v_pk_fma_f16 v171, v171, v30, v30 op_sel:[0,0,1] op_sel_hi:[1,0,1]
    v_mfma_f32_16x16x32_f16 v[192:195], a[232:235], v[152:155], 0
    v_pk_fma_f16 v168, v168, v30, v30 op_sel:[0,0,1] op_sel_hi:[1,0,1]
    v_pk_fma_f16 v169, v169, v30, v30 op_sel:[0,0,1] op_sel_hi:[1,0,1]
    v_bfi_b32 v171, v17, v171, s84
    v_mfma_f32_16x16x32_f16 v[200:203], a[232:235], v[156:159], 0
    ds_read_b128 a[232:235], v23 offset:10240
    v_pk_fma_f16 v170, v170, v30, v30 op_sel:[0,0,1] op_sel_hi:[1,0,1]
    v_pk_fma_f16 v175, v175, v29, v29 op_sel:[0,0,1] op_sel_hi:[1,0,1]
    v_mfma_f32_16x16x32_f16 v[196:199], a[236:239], v[152:155], 0
    v_pk_fma_f16 v172, v172, v29, v29 op_sel:[0,0,1] op_sel_hi:[1,0,1]
    v_pk_fma_f16 v173, v173, v29, v29 op_sel:[0,0,1] op_sel_hi:[1,0,1]
    v_bfi_b32 v175, v17, v175, s84
    v_mfma_f32_16x16x32_f16 v[204:207], a[236:239], v[156:159], 0
    ds_read_b128 a[236:239], v23 offset:11264
    v_pk_fma_f16 v174, v174, v29, v29 op_sel:[0,0,1] op_sel_hi:[1,0,1]
    v_cvt_pkrtz_f16_f32 v208, v176, v177
    v_mfma_f32_16x16x32_f16 v[192:195], a[240:243], v[160:163], v[192:195]
    v_pk_lshrrev_b16 v208, 3, v208 op_sel_hi:[0,1]
    v_mad_u32_u16 v209, v208, 2, s85
    v_mad_u32_u16 v208, v208, 2, s85 op_sel:[1,0,0,0]
    v_mfma_f32_16x16x32_f16 v[200:203], a[240:243], v[164:167], v[200:203]
    ds_read_u16 v209, v209
    ds_read_u16_d16_hi v208, v208
    ds_read_b128 a[240:243], v23 offset:12288
    v_mfma_f32_16x16x32_f16 v[196:199], a[244:247], v[160:163], v[196:199]
    v_cvt_pkrtz_f16_f32 v210, v178, v179
    v_pk_lshrrev_b16 v210, 3, v210 op_sel_hi:[0,1]
    v_mad_u32_u16 v211, v210, 2, s85
    v_mfma_f32_16x16x32_f16 v[204:207], a[244:247], v[164:167], v[204:207]
    ds_read_u16 v211, v211
    ds_read_b128 a[244:247], v23 offset:13312
    v_mad_u32_u16 v210, v210, 2, s85 op_sel:[1,0,0,0]
    v_mfma_f32_16x16x32_f16 v[192:195], a[248:251], v[168:171], v[192:195]
    ds_read_u16_d16_hi v210, v210
    v_cvt_pkrtz_f16_f32 v212, v180, v181
    v_pk_lshrrev_b16 v212, 3, v212 op_sel_hi:[0,1]
    v_mfma_f32_16x16x32_f16 v[200:203], a[248:251], v[172:175], v[200:203]
    s_waitcnt lgkmcnt(11)
    ds_read_b128 a[248:251], v23 offset:14336
    v_mad_u32_u16 v213, v212, 2, s85
    v_mad_u32_u16 v212, v212, 2, s85 op_sel:[1,0,0,0]
    v_mfma_f32_16x16x32_f16 v[196:199], a[252:255], v[168:171], v[196:199]
    s_add_u32 m0, s56, 6336
    ds_read_u16 v213, v213
    ds_read_u16_d16_hi v212, v212
    buffer_load_dwordx4 v1, s[20:23], 0 offen offset:64 lds
    v_mfma_f32_16x16x32_f16 v[204:207], a[252:255], v[172:175], v[204:207]
    s_waitcnt lgkmcnt(13)
    ds_read_b128 a[252:255], v23 offset:15360
    v_cvt_pkrtz_f16_f32 v214, v182, v183
    v_pk_lshrrev_b16 v214, 3, v214 op_sel_hi:[0,1]
    v_mfma_f32_16x16x16_bf16 v[112:115], v[18:19], v[240:241], v[64:67]
    v_mad_u32_u16 v215, v214, 2, s85
    v_mad_u32_u16 v214, v214, 2, s85 op_sel:[1,0,0,0]
    v_cvt_pkrtz_f16_f32 v216, v184, v185
    v_mfma_f32_16x16x16_bf16 v[116:119], v[18:19], v[242:243], v[68:71]
    s_waitcnt lgkmcnt(12)
    ds_read_u16 v215, v215
    ds_read_u16_d16_hi v214, v214
    v_pk_lshrrev_b16 v216, 3, v216 op_sel_hi:[0,1]
    v_mfma_f32_16x16x16_bf16 v[120:123], v[18:19], v[244:245], v[64:67]
    v_mad_u32_u16 v217, v216, 2, s85
    v_mad_u32_u16 v216, v216, 2, s85 op_sel:[1,0,0,0]
    v_cvt_pkrtz_f16_f32 v218, v186, v187
    v_mfma_f32_16x16x16_bf16 v[124:127], v[18:19], v[246:247], v[68:71]
    s_waitcnt lgkmcnt(12)
    ds_read_u16 v217, v217
    ds_read_u16_d16_hi v216, v216
    v_pk_lshrrev_b16 v218, 3, v218 op_sel_hi:[0,1]
    v_mfma_f32_16x16x16_bf16 v[72:75], v[18:19], v[236:237], v[64:67]
    v_mad_u32_u16 v219, v218, 2, s85
    v_mad_u32_u16 v218, v218, 2, s85 op_sel:[1,0,0,0]
    v_cvt_pkrtz_f16_f32 v220, v188, v189
    v_mfma_f32_16x16x16_bf16 v[76:79], v[18:19], v[238:239], v[68:71]
    s_waitcnt lgkmcnt(12)
    ds_read_u16 v219, v219
    ds_read_u16_d16_hi v218, v218
    v_pk_lshrrev_b16 v220, 3, v220 op_sel_hi:[0,1]
    v_mfma_f32_16x16x16_bf16 v[64:67], v[18:19], v[232:233], v[64:67]
    v_mad_u32_u16 v221, v220, 2, s85
    v_mad_u32_u16 v220, v220, 2, s85 op_sel:[1,0,0,0]
    v_cvt_pkrtz_f16_f32 v222, v190, v191
    v_mfma_f32_16x16x16_bf16 v[68:71], v[18:19], v[234:235], v[68:71]
    s_waitcnt lgkmcnt(12)
    ds_read_u16 v221, v221
    ds_read_u16_d16_hi v220, v220
    v_pk_lshrrev_b16 v222, 3, v222 op_sel_hi:[0,1]
    v_mfma_f32_16x16x32_f16 v[176:179], a[232:235], v[128:131], 0
    v_mad_u32_u16 v223, v222, 2, s85
    v_mad_u32_u16 v222, v222, 2, s85 op_sel:[1,0,0,0]
    v_or_b32 v232, v209, v208
    v_mfma_f32_16x16x32_f16 v[184:187], a[232:235], v[132:135], 0
    s_waitcnt lgkmcnt(12)
    ds_read_u16 v223, v223
    ds_read_u16_d16_hi v222, v222
    v_or_b32 v233, v211, v210
    v_mfma_f32_16x16x32_f16 v[180:183], a[236:239], v[128:131], 0
    s_waitcnt lgkmcnt(8)
    v_or_b32 v234, v213, v212
    v_or_b32 v235, v215, v214
    v_cvt_pkrtz_f16_f32 v224, v192, v193
    v_mfma_f32_16x16x32_f16 v[188:191], a[236:239], v[132:135], 0
    s_waitcnt lgkmcnt(7)
    v_pk_lshrrev_b16 v224, 3, v224 op_sel_hi:[0,1]
    v_cvt_pkrtz_f16_f32 v226, v194, v195
    s_waitcnt lgkmcnt(6)
    v_or_b32 v236, v217, v216
    v_mfma_f32_16x16x32_f16 v[192:195], a[232:235], v[152:155], 0
    v_cvt_pkrtz_f16_f32 v228, v196, v197
    v_cvt_pkrtz_f16_f32 v230, v198, v199
    v_cvt_pkrtz_f16_f32 v248, v200, v201
    v_cvt_pkrtz_f16_f32 v250, v202, v203
    v_mfma_f32_16x16x32_f16 v[200:203], a[232:235], v[156:159], 0
    ds_read_b128 a[232:235], v23 offset:6144
    v_cvt_pkrtz_f16_f32 v252, v204, v205
    v_cvt_pkrtz_f16_f32 v0, v206, v207
    v_mfma_f32_16x16x32_f16 v[176:179], a[240:243], v[136:139], v[176:179]
    s_waitcnt lgkmcnt(5)
    v_or_b32 v237, v219, v218
    v_mad_u32_u16 v225, v224, 2, s85
    v_mad_u32_u16 v224, v224, 2, s85 op_sel:[1,0,0,0]
    v_mfma_f32_16x16x32_f16 v[184:187], a[240:243], v[140:143], v[184:187]
    ds_read_u16 v225, v225
    ds_read_u16_d16_hi v224, v224
    v_pk_lshrrev_b16 v226, 3, v226 op_sel_hi:[0,1]
    v_mfma_f32_16x16x32_f16 v[196:199], a[236:239], v[152:155], 0
    v_mad_u32_u16 v227, v226, 2, s85
    v_mad_u32_u16 v226, v226, 2, s85 op_sel:[1,0,0,0]
    v_pk_lshrrev_b16 v228, 3, v228 op_sel_hi:[0,1]
    v_mfma_f32_16x16x32_f16 v[204:207], a[236:239], v[156:159], 0
    ds_read_u16 v227, v227
    ds_read_u16_d16_hi v226, v226
    ds_read_b128 a[236:239], v23 offset:7168
    v_mfma_f32_16x16x32_f16 v[180:183], a[244:247], v[136:139], v[180:183]
    s_waitcnt lgkmcnt(8)
    v_or_b32 v238, v221, v220
    v_mad_u32_u16 v229, v228, 2, s85
    v_mad_u32_u16 v228, v228, 2, s85 op_sel:[1,0,0,0]
    v_mfma_f32_16x16x32_f16 v[188:191], a[244:247], v[140:143], v[188:191]
    s_waitcnt lgkmcnt(6)
    ds_read_u16 v229, v229
    ds_read_u16_d16_hi v228, v228
    v_or_b32 v239, v223, v222
    v_mfma_f32_16x16x32_f16 v[192:195], a[240:243], v[160:163], v[192:195]
    v_pk_lshrrev_b16 v230, 3, v230 op_sel_hi:[0,1]
    v_mad_u32_u16 v231, v230, 2, s85
    v_mad_u32_u16 v230, v230, 2, s85 op_sel:[1,0,0,0]
    v_mfma_f32_16x16x32_f16 v[200:203], a[240:243], v[164:167], v[200:203]
    ds_read_u16 v231, v231
    ds_read_u16_d16_hi v230, v230
    ds_read_b128 a[240:243], v23 offset:8192
    v_mfma_f32_16x16x32_f16 v[176:179], a[248:251], v[144:147], v[176:179]
    v_pk_lshrrev_b16 v248, 3, v248 op_sel_hi:[0,1]
    v_mad_u32_u16 v249, v248, 2, s85
    v_mad_u32_u16 v248, v248, 2, s85 op_sel:[1,0,0,0]
    v_mfma_f32_16x16x32_f16 v[184:187], a[248:251], v[148:151], v[184:187]
    ds_read_u16 v249, v249
    ds_read_u16_d16_hi v248, v248
    v_pk_lshrrev_b16 v250, 3, v250 op_sel_hi:[0,1]
    v_mfma_f32_16x16x32_f16 v[196:199], a[244:247], v[160:163], v[196:199]
    v_mad_u32_u16 v251, v250, 2, s85
    v_mad_u32_u16 v250, v250, 2, s85 op_sel:[1,0,0,0]
    v_pk_lshrrev_b16 v252, 3, v252 op_sel_hi:[0,1]
    v_mfma_f32_16x16x32_f16 v[204:207], a[244:247], v[164:167], v[204:207]
    s_waitcnt lgkmcnt(11)
    ds_read_u16 v251, v251
    ds_read_u16_d16_hi v250, v250
    ds_read_b128 a[244:247], v23 offset:9216
    v_mfma_f32_16x16x32_f16 v[180:183], a[252:255], v[144:147], v[180:183]
    s_add_u32 m0, s56, 7360
    v_mad_u32_u16 v253, v252, 2, s85
    v_mad_u32_u16 v252, v252, 2, s85 op_sel:[1,0,0,0]
    v_pk_lshrrev_b16 v0, 3, v0 op_sel_hi:[0,1]
    v_mfma_f32_16x16x32_f16 v[188:191], a[252:255], v[148:151], v[188:191]
    s_waitcnt lgkmcnt(12)
    ds_read_u16 v253, v253
    ds_read_u16_d16_hi v252, v252
    buffer_load_dwordx4 v2, s[20:23], 0 offen offset:64 lds
    v_mfma_f32_16x16x32_f16 v[192:195], a[248:251], v[168:171], v[192:195]
    v_mad_u32_u16 v208, v0, 2, s85
    v_mad_u32_u16 v0, v0, 2, s85 op_sel:[1,0,0,0]
    v_or_b32 v240, v225, v224
    v_mfma_f32_16x16x32_f16 v[200:203], a[248:251], v[172:175], v[200:203]
    s_waitcnt lgkmcnt(12)
    ds_read_u16 v208, v208
    ds_read_u16_d16_hi v0, v0
    v_or_b32 v241, v227, v226
    v_mfma_f32_16x16x32_f16 v[196:199], a[252:255], v[168:171], v[196:199]
    s_waitcnt lgkmcnt(12)
    ds_read_b128 a[248:251], v23 offset:20480
    v_or_b32 v242, v229, v228
    v_cvt_pkrtz_f16_f32 v209, v176, v177
    v_mfma_f32_16x16x32_f16 v[204:207], a[252:255], v[172:175], v[204:207]
    s_waitcnt lgkmcnt(11)
    v_pk_lshrrev_b16 v209, 3, v209 op_sel_hi:[0,1]
    v_or_b32 v243, v231, v230
    v_mad_u32_u16 v210, v209, 2, s85
    v_mfma_f32_16x16x32_bf16 v[32:35], a[192:195], v[232:235], v[32:35]
    ds_read_b128 a[252:255], v23 offset:21504
    ds_read_u16 v210, v210
    v_mad_u32_u16 v209, v209, 2, s85 op_sel:[1,0,0,0]
    v_mfma_f32_16x16x32_bf16 v[40:43], a[192:195], v[236:239], v[40:43]
    v_cvt_pkrtz_f16_f32 v211, v178, v179
    v_pk_lshrrev_b16 v211, 3, v211 op_sel_hi:[0,1]
    v_mad_u32_u16 v212, v211, 2, s85
    v_mfma_f32_16x16x32_bf16 v[36:39], a[196:199], v[232:235], v[36:39]
    ds_read_u16_d16_hi v209, v209
    v_mad_u32_u16 v211, v211, 2, s85 op_sel:[1,0,0,0]
    v_cvt_pkrtz_f16_f32 v213, v180, v181
    v_mfma_f32_16x16x32_bf16 v[44:47], a[196:199], v[236:239], v[44:47]
    s_waitcnt lgkmcnt(11)
    ds_read_u16 v212, v212
    v_or_b32 v244, v249, v248
    v_pk_lshrrev_b16 v213, 3, v213 op_sel_hi:[0,1]
    v_mfma_f32_16x16x32_bf16 v[80:83], a[192:195], v[240:243], v[80:83]
    s_waitcnt lgkmcnt(11)
    v_mad_u32_u16 v214, v213, 2, s85
    v_mad_u32_u16 v213, v213, 2, s85 op_sel:[1,0,0,0]
    v_cvt_pkrtz_f16_f32 v215, v182, v183
    v_pk_lshrrev_b16 v215, 3, v215 op_sel_hi:[0,1]
    v_mad_u32_u16 v216, v215, 2, s85
    v_mad_u32_u16 v215, v215, 2, s85 op_sel:[1,0,0,0]
    v_cvt_pkrtz_f16_f32 v217, v184, v185
    s_waitcnt lgkmcnt(10)
    v_or_b32 v245, v251, v250
    v_pk_lshrrev_b16 v217, 3, v217 op_sel_hi:[0,1]
    v_mad_u32_u16 v218, v217, 2, s85
    v_mad_u32_u16 v217, v217, 2, s85 op_sel:[1,0,0,0]
    v_cvt_pkrtz_f16_f32 v219, v186, v187
    v_pk_lshrrev_b16 v219, 3, v219 op_sel_hi:[0,1]
    v_mad_u32_u16 v220, v219, 2, s85
    v_mad_u32_u16 v219, v219, 2, s85 op_sel:[1,0,0,0]
    v_cvt_pkrtz_f16_f32 v221, v188, v189
    v_pk_lshrrev_b16 v221, 3, v221 op_sel_hi:[0,1]
    v_mad_u32_u16 v222, v221, 2, s85
    v_mad_u32_u16 v221, v221, 2, s85 op_sel:[1,0,0,0]
    v_cvt_pkrtz_f16_f32 v223, v190, v191
    v_pk_lshrrev_b16 v223, 3, v223 op_sel_hi:[0,1]
    v_mad_u32_u16 v224, v223, 2, s85
    v_mad_u32_u16 v223, v223, 2, s85 op_sel:[1,0,0,0]
    v_cvt_pkrtz_f16_f32 v225, v192, v193
    v_pk_lshrrev_b16 v225, 3, v225 op_sel_hi:[0,1]
    s_waitcnt lgkmcnt(7)
    v_or_b32 v246, v253, v252
    v_cvt_pkrtz_f16_f32 v227, v194, v195
    v_cvt_pkrtz_f16_f32 v229, v196, v197
    v_cvt_pkrtz_f16_f32 v231, v198, v199
    v_cvt_pkrtz_f16_f32 v249, v200, v201
    v_cvt_pkrtz_f16_f32 v251, v202, v203
    v_mad_u32_u16 v226, v225, 2, s85
    v_mad_u32_u16 v225, v225, 2, s85 op_sel:[1,0,0,0]
    v_pk_lshrrev_b16 v227, 3, v227 op_sel_hi:[0,1]
    v_mad_u32_u16 v228, v227, 2, s85
    v_mad_u32_u16 v227, v227, 2, s85 op_sel:[1,0,0,0]
    v_pk_lshrrev_b16 v229, 3, v229 op_sel_hi:[0,1]
    v_mad_u32_u16 v230, v229, 2, s85
    s_waitcnt lgkmcnt(5)
    v_or_b32 v247, v208, v0
    v_cvt_pkrtz_f16_f32 v208, v204, v205
    v_mad_u32_u16 v229, v229, 2, s85 op_sel:[1,0,0,0]
    v_mfma_f32_16x16x32_bf16 v[88:91], a[192:195], v[244:247], v[88:91]
    ds_read_u16_d16_hi v211, v211
    ds_read_u16 v214, v214
    ds_read_u16_d16_hi v213, v213
    ds_read_u16 v216, v216
    v_mfma_f32_16x16x32_bf16 v[48:51], a[232:235], v[232:235], v[48:51]
    ds_read_u16_d16_hi v215, v215
    ds_read_u16 v218, v218
    ds_read_u16_d16_hi v217, v217
    ds_read_u16 v220, v220
    v_mfma_f32_16x16x32_bf16 v[56:59], a[232:235], v[236:239], v[56:59]
    s_waitcnt lgkmcnt(12)
    ds_read_u16_d16_hi v219, v219
    ds_read_u16 v222, v222
    v_pk_lshrrev_b16 v231, 3, v231 op_sel_hi:[0,1]
    v_mfma_f32_16x16x32_bf16 v[84:87], a[196:199], v[240:243], v[84:87]
    s_waitcnt lgkmcnt(13)
    ds_read_u16_d16_hi v221, v221
    v_mad_u32_u16 v248, v231, 2, s85
    v_mad_u32_u16 v231, v231, 2, s85 op_sel:[1,0,0,0]
    v_mfma_f32_16x16x32_bf16 v[92:95], a[196:199], v[244:247], v[92:95]
    v_pk_lshrrev_b16 v249, 3, v249 op_sel_hi:[0,1]
    v_mad_u32_u16 v250, v249, 2, s85
    v_mad_u32_u16 v249, v249, 2, s85 op_sel:[1,0,0,0]
    v_mfma_f32_16x16x32_bf16 v[52:55], a[236:239], v[232:235], v[52:55]
    s_waitcnt lgkmcnt(13)
    ds_read_u16 v224, v224
    v_pk_lshrrev_b16 v251, 3, v251 op_sel_hi:[0,1]
    v_mad_u32_u16 v252, v251, 2, s85
    v_mfma_f32_16x16x32_bf16 v[60:63], a[236:239], v[236:239], v[60:63]
    s_waitcnt lgkmcnt(13)
    ds_read_u16_d16_hi v223, v223
    v_mad_u32_u16 v251, v251, 2, s85 op_sel:[1,0,0,0]
    v_pk_fma_f16 v253, v208, v208, s53
    v_mfma_f32_16x16x32_bf16 v[96:99], a[232:235], v[240:243], v[96:99]
    s_waitcnt lgkmcnt(13)
    ds_read_u16 v226, v226
    v_pk_mul_f16 v253, v253, v208 neg_lo:[1,0] neg_hi:[1,0]
    v_exp_f16 v0, v253
    v_mfma_f32_16x16x32_bf16 v[104:107], a[232:235], v[244:247], v[104:107]
    s_add_u32 m0, s56, 8384
    v_exp_f16_sdwa v0, v253 dst_sel:WORD_1 dst_unused:UNUSED_PRESERVE src0_sel:WORD_1
    v_mfma_f32_16x16x32_bf16 v[64:67], a[240:243], v[232:235], v[64:67]
    s_waitcnt lgkmcnt(12)
    ds_read_b128 a[232:235], v23 offset:22528
    buffer_load_dwordx4 v3, s[20:23], 0 offen offset:64 lds
    ds_read_u16_d16_hi v225, v225
    v_mfma_f32_16x16x32_bf16 v[72:75], a[240:243], v[236:239], v[72:75]
    v_pk_fma_f16 v0, v0, s86, s86
    v_rcp_f16 v253, v0
    v_mfma_f32_16x16x32_bf16 v[100:103], a[236:239], v[240:243], v[100:103]
    s_waitcnt lgkmcnt(13)
    ds_read_u16 v228, v228
    v_rcp_f16_sdwa v253, v0 dst_sel:WORD_1 dst_unused:UNUSED_PRESERVE src0_sel:WORD_1
    v_mfma_f32_16x16x32_bf16 v[108:111], a[236:239], v[244:247], v[108:111]
    s_waitcnt lgkmcnt(13)
    ds_read_b128 a[236:239], v23 offset:23552
    v_fma_mix_f32 v0, v253, v208, 0 op_sel_hi:[1,1,0]
    v_fma_mix_f32 v253, v253, v208, 0 op_sel:[1,1,0] op_sel_hi:[1,1,0]
    v_mfma_f32_16x16x32_bf16 v[68:71], a[244:247], v[232:235], v[68:71]
    v_or_b32 v232, v210, v209
    v_or_b32 v233, v212, v211
    v_or_b32 v234, v214, v213
    v_mfma_f32_16x16x32_bf16 v[76:79], a[244:247], v[236:239], v[76:79]
    s_waitcnt lgkmcnt(11)
    ds_read_u16_d16_hi v227, v227
    v_or_b32 v235, v216, v215
    v_or_b32 v236, v218, v217
    v_mfma_f32_16x16x32_bf16 v[112:115], a[240:243], v[240:243], v[112:115]
    ds_read_u16 v230, v230
    v_cvt_pkrtz_f16_f32 v211, v206, v207
    v_pk_fma_f16 v209, v211, v211, s53
    v_mfma_f32_16x16x32_bf16 v[120:123], a[240:243], v[244:247], v[120:123]
    s_waitcnt lgkmcnt(11)
    ds_read_b128 a[240:243], v23 offset:24576
    v_or_b32 v237, v220, v219
    v_pk_mul_f16 v209, v209, v211 neg_lo:[1,0] neg_hi:[1,0]
    v_mfma_f32_16x16x32_bf16 v[116:119], a[244:247], v[240:243], v[116:119]
    v_exp_f16 v210, v209
    v_mfma_f32_16x16x32_bf16 v[124:127], a[244:247], v[244:247], v[124:127]
    ds_read_b128 a[244:247], v23 offset:25600
    v_exp_f16_sdwa v210, v209 dst_sel:WORD_1 dst_unused:UNUSED_PRESERVE src0_sel:WORD_1
    v_mfma_f32_16x16x32_f16 v[176:179], a[248:251], v[128:131], 0
    s_waitcnt lgkmcnt(11)
    ds_read_u16_d16_hi v229, v229
    v_or_b32 v238, v222, v221
    v_pk_fma_f16 v210, v210, s86, s86
    v_mfma_f32_16x16x32_f16 v[184:187], a[248:251], v[132:135], 0
    v_rcp_f16 v209, v210
    v_cvt_pk_bf16_f32 v246, v0, v253
    v_mfma_f32_16x16x32_f16 v[180:183], a[252:255], v[128:131], 0
    ds_read_u16 v248, v248
    v_rcp_f16_sdwa v209, v210 dst_sel:WORD_1 dst_unused:UNUSED_PRESERVE src0_sel:WORD_1
    v_mfma_f32_16x16x32_f16 v[188:191], a[252:255], v[132:135], 0
    s_waitcnt lgkmcnt(11)
    ds_read_u16_d16_hi v231, v231
    v_or_b32 v239, v224, v223
    v_fma_mix_f32 v210, v209, v211, 0 op_sel_hi:[1,1,0]
    v_mfma_f32_16x16x32_f16 v[192:195], a[248:251], v[152:155], 0
    ds_read_u16 v250, v250
    v_fma_mix_f32 v209, v209, v211, 0 op_sel:[1,1,0] op_sel_hi:[1,1,0]
    v_cvt_pk_bf16_f32 v247, v210, v209
    v_mfma_f32_16x16x32_f16 v[200:203], a[248:251], v[156:159], 0
    s_waitcnt lgkmcnt(11)
    ds_read_u16_d16_hi v249, v249
    v_mfma_f32_16x16x32_f16 v[176:179], a[232:235], v[136:139], v[176:179]
    ds_read_u16 v252, v252
    v_mfma_f32_16x16x32_f16 v[184:187], a[232:235], v[140:143], v[184:187]
    s_waitcnt lgkmcnt(12)
    v_or_b32 v240, v226, v225
    v_mfma_f32_16x16x32_f16 v[196:199], a[252:255], v[152:155], 0
    ds_read_u16_d16_hi v251, v251
    v_mfma_f32_16x16x32_f16 v[204:207], a[252:255], v[156:159], 0
    s_waitcnt lgkmcnt(11)
    ds_read_b128 a[248:251], v23 offset:16384
    v_mfma_f32_16x16x32_f16 v[180:183], a[236:239], v[136:139], v[180:183]
    v_mfma_f32_16x16x32_f16 v[188:191], a[236:239], v[140:143], v[188:191]
    s_waitcnt lgkmcnt(11)
    ds_read_b128 a[252:255], v23 offset:17408
    v_or_b32 v241, v228, v227
    v_mfma_f32_16x16x32_f16 v[192:195], a[232:235], v[160:163], v[192:195]
    v_mfma_f32_16x16x32_f16 v[200:203], a[232:235], v[164:167], v[200:203]
    ds_read_b128 a[232:235], v23 offset:18432
    s_waitcnt lgkmcnt(11)
    v_mfma_f32_16x16x32_f16 v[176:179], a[240:243], v[144:147], v[176:179]
    s_add_u32 m0, s56, 10432
    v_mfma_f32_16x16x32_f16 v[184:187], a[240:243], v[148:151], v[184:187]
    buffer_load_dwordx4 v5, s[20:23], 0 offen offset:64 lds
    s_add_u32 m0, s56, 9408
    v_mfma_f32_16x16x32_f16 v[196:199], a[236:239], v[160:163], v[196:199]
    buffer_load_dwordx4 v4, s[20:23], 0 offen offset:64 lds
    v_mfma_f32_16x16x32_f16 v[204:207], a[236:239], v[164:167], v[204:207]
    s_waitcnt lgkmcnt(9)
    ds_read_b128 a[236:239], v23 offset:19456
    v_or_b32 v242, v230, v229
    v_cvt_pkrtz_f16_f32 v212, v176, v177
    v_mfma_f32_16x16x32_f16 v[180:183], a[244:247], v[144:147], v[180:183]
    s_waitcnt lgkmcnt(9)
    v_pk_lshrrev_b16 v212, 3, v212 op_sel_hi:[0,1]
    v_mad_u32_u16 v213, v212, 2, s85
    s_waitcnt lgkmcnt(8)
    v_or_b32 v243, v248, v231
    v_mfma_f32_16x16x32_f16 v[188:191], a[244:247], v[148:151], v[188:191]
    ds_read_u16 v213, v213
    v_mad_u32_u16 v212, v212, 2, s85 op_sel:[1,0,0,0]
    v_cvt_pkrtz_f16_f32 v214, v178, v179
    v_mfma_f32_16x16x32_f16 v[192:195], a[240:243], v[168:171], v[192:195]
    ds_read_u16_d16_hi v212, v212
    v_pk_lshrrev_b16 v214, 3, v214 op_sel_hi:[0,1]
    v_mad_u32_u16 v215, v214, 2, s85
    v_mfma_f32_16x16x32_f16 v[200:203], a[240:243], v[172:175], v[200:203]
    s_waitcnt lgkmcnt(8)
    ds_read_b128 a[240:243], v23 offset:30720
    ds_read_u16 v215, v215
    v_or_b32 v244, v250, v249
    v_mfma_f32_16x16x32_f16 v[196:199], a[244:247], v[168:171], v[196:199]
    v_mad_u32_u16 v214, v214, 2, s85 op_sel:[1,0,0,0]
    v_cvt_pkrtz_f16_f32 v216, v180, v181
    v_pk_lshrrev_b16 v216, 3, v216 op_sel_hi:[0,1]
    v_mfma_f32_16x16x32_f16 v[204:207], a[244:247], v[172:175], v[204:207]
    ds_read_b128 a[244:247], v23 offset:31744
    ds_read_u16_d16_hi v214, v214
    v_mad_u32_u16 v217, v216, 2, s85
    v_mfma_f32_16x16x32_bf16 v[32:35], a[200:203], v[232:235], v[32:35]
    s_waitcnt lgkmcnt(10)
    ds_read_u16 v217, v217
    v_or_b32 v245, v252, v251
    v_mad_u32_u16 v216, v216, 2, s85 op_sel:[1,0,0,0]
    v_mfma_f32_16x16x32_bf16 v[40:43], a[200:203], v[236:239], v[40:43]
    ds_read_u16_d16_hi v216, v216
    v_cvt_pkrtz_f16_f32 v218, v182, v183
    v_pk_lshrrev_b16 v218, 3, v218 op_sel_hi:[0,1]
    v_mfma_f32_16x16x32_bf16 v[36:39], a[204:207], v[232:235], v[36:39]
    v_mad_u32_u16 v219, v218, 2, s85
    v_mad_u32_u16 v218, v218, 2, s85 op_sel:[1,0,0,0]
    v_cvt_pkrtz_f16_f32 v220, v184, v185
    v_mfma_f32_16x16x32_bf16 v[44:47], a[204:207], v[236:239], v[44:47]
    ds_read_u16 v219, v219
    ds_read_u16_d16_hi v218, v218
    v_pk_lshrrev_b16 v220, 3, v220 op_sel_hi:[0,1]
    v_mfma_f32_16x16x32_bf16 v[80:83], a[200:203], v[240:243], v[80:83]
    v_mad_u32_u16 v221, v220, 2, s85
    v_mad_u32_u16 v220, v220, 2, s85 op_sel:[1,0,0,0]
    v_cvt_pkrtz_f16_f32 v222, v186, v187
    v_mfma_f32_16x16x32_bf16 v[88:91], a[200:203], v[244:247], v[88:91]
    s_waitcnt lgkmcnt(12)
    ds_read_u16 v221, v221
    ds_read_u16_d16_hi v220, v220
    v_pk_lshrrev_b16 v222, 3, v222 op_sel_hi:[0,1]
    v_mfma_f32_16x16x32_bf16 v[48:51], a[248:251], v[232:235], v[48:51]
    v_mad_u32_u16 v223, v222, 2, s85
    v_mad_u32_u16 v222, v222, 2, s85 op_sel:[1,0,0,0]
    v_cvt_pkrtz_f16_f32 v224, v188, v189
    v_mfma_f32_16x16x32_bf16 v[56:59], a[248:251], v[236:239], v[56:59]
    s_waitcnt lgkmcnt(12)
    ds_read_u16 v223, v223
    ds_read_u16_d16_hi v222, v222
    v_pk_lshrrev_b16 v224, 3, v224 op_sel_hi:[0,1]
    v_mfma_f32_16x16x32_bf16 v[84:87], a[204:207], v[240:243], v[84:87]
    v_mad_u32_u16 v225, v224, 2, s85
    v_mad_u32_u16 v224, v224, 2, s85 op_sel:[1,0,0,0]
    v_cvt_pkrtz_f16_f32 v226, v190, v191
    v_mfma_f32_16x16x32_bf16 v[92:95], a[204:207], v[244:247], v[92:95]
    s_waitcnt lgkmcnt(12)
    ds_read_u16 v225, v225
    ds_read_u16_d16_hi v224, v224
    v_pk_lshrrev_b16 v226, 3, v226 op_sel_hi:[0,1]
    v_mfma_f32_16x16x32_bf16 v[52:55], a[252:255], v[232:235], v[52:55]
    v_mad_u32_u16 v227, v226, 2, s85
    v_mad_u32_u16 v226, v226, 2, s85 op_sel:[1,0,0,0]
    v_cvt_pkrtz_f16_f32 v228, v192, v193
    v_mfma_f32_16x16x32_bf16 v[60:63], a[252:255], v[236:239], v[60:63]
    s_waitcnt lgkmcnt(12)
    ds_read_u16 v227, v227
    ds_read_u16_d16_hi v226, v226
    v_pk_lshrrev_b16 v228, 3, v228 op_sel_hi:[0,1]
    v_mfma_f32_16x16x32_bf16 v[96:99], a[248:251], v[240:243], v[96:99]
    v_cvt_pkrtz_f16_f32 v230, v194, v195
    v_cvt_pkrtz_f16_f32 v248, v196, v197
    v_cvt_pkrtz_f16_f32 v250, v198, v199
    v_mfma_f32_16x16x32_bf16 v[104:107], a[248:251], v[244:247], v[104:107]
    s_waitcnt lgkmcnt(13)
    ds_read_b128 a[248:251], v23 offset:32768
    v_cvt_pkrtz_f16_f32 v252, v200, v201
    v_cvt_pkrtz_f16_f32 v0, v202, v203
    v_mfma_f32_16x16x32_bf16 v[64:67], a[232:235], v[232:235], v[64:67]
    v_cvt_pkrtz_f16_f32 v209, v204, v205
    v_cvt_pkrtz_f16_f32 v211, v206, v207
    v_mad_u32_u16 v229, v228, 2, s85
    v_mfma_f32_16x16x32_bf16 v[72:75], a[232:235], v[236:239], v[72:75]
    s_waitcnt lgkmcnt(13)
    ds_read_u16 v229, v229
    v_mad_u32_u16 v228, v228, 2, s85 op_sel:[1,0,0,0]
    v_pk_lshrrev_b16 v230, 3, v230 op_sel_hi:[0,1]
    v_mfma_f32_16x16x32_bf16 v[100:103], a[252:255], v[240:243], v[100:103]
    s_waitcnt lgkmcnt(13)
    ds_read_u16_d16_hi v228, v228
    v_mad_u32_u16 v231, v230, 2, s85
    v_mad_u32_u16 v230, v230, 2, s85 op_sel:[1,0,0,0]
    v_mfma_f32_16x16x32_bf16 v[108:111], a[252:255], v[244:247], v[108:111]
    s_waitcnt lgkmcnt(12)
    ds_read_b128 a[252:255], v23 offset:33792
    ds_read_u16 v231, v231
    v_pk_lshrrev_b16 v248, 3, v248 op_sel_hi:[0,1]
    v_mfma_f32_16x16x32_bf16 v[68:71], a[236:239], v[232:235], v[68:71]
    s_waitcnt lgkmcnt(13)
    ds_read_u16_d16_hi v230, v230
    v_or_b32 v232, v213, v212
    v_or_b32 v233, v215, v214
    v_mfma_f32_16x16x32_bf16 v[76:79], a[236:239], v[236:239], v[76:79]
    s_waitcnt lgkmcnt(12)
    v_or_b32 v234, v217, v216
    v_or_b32 v235, v219, v218
    v_or_b32 v236, v221, v220
    v_mfma_f32_16x16x32_bf16 v[112:115], a[232:235], v[240:243], v[112:115]
    v_mad_u32_u16 v249, v248, 2, s85
    v_mad_u32_u16 v248, v248, 2, s85 op_sel:[1,0,0,0]
    v_pk_lshrrev_b16 v250, 3, v250 op_sel_hi:[0,1]
    v_mfma_f32_16x16x32_bf16 v[120:123], a[232:235], v[244:247], v[120:123]
    s_waitcnt lgkmcnt(10)
    ds_read_b128 a[232:235], v23 offset:34816
    ds_read_u16 v249, v249
    v_or_b32 v237, v223, v222
    v_mfma_f32_16x16x32_bf16 v[116:119], a[236:239], v[240:243], v[116:119]
    v_mad_u32_u16 v251, v250, 2, s85
    v_mad_u32_u16 v250, v250, 2, s85 op_sel:[1,0,0,0]
    v_pk_lshrrev_b16 v252, 3, v252 op_sel_hi:[0,1]
    v_mfma_f32_16x16x32_bf16 v[124:127], a[236:239], v[244:247], v[124:127]
    s_waitcnt lgkmcnt(11)
    ds_read_b128 a[236:239], v23 offset:35840
    v_mad_u32_u16 v253, v252, 2, s85
    s_waitcnt lgkmcnt(11)
    v_or_b32 v238, v225, v224
    v_mfma_f32_16x16x32_f16 v[176:179], a[240:243], v[128:131], 0
    ds_read_u16_d16_hi v248, v248
    v_mad_u32_u16 v252, v252, 2, s85 op_sel:[1,0,0,0]
    v_pk_lshrrev_b16 v0, 3, v0 op_sel_hi:[0,1]
    v_mfma_f32_16x16x32_f16 v[184:187], a[240:243], v[132:135], 0
    ds_read_u16 v251, v251
    v_mad_u32_u16 v208, v0, 2, s85
    v_mad_u32_u16 v0, v0, 2, s85 op_sel:[1,0,0,0]
    v_mfma_f32_16x16x32_f16 v[180:183], a[244:247], v[128:131], 0
    s_waitcnt lgkmcnt(11)
    v_pk_lshrrev_b16 v209, 3, v209 op_sel_hi:[0,1]
    v_or_b32 v239, v227, v226
    v_mad_u32_u16 v210, v209, 2, s85
    v_mfma_f32_16x16x32_f16 v[188:191], a[244:247], v[132:135], 0
    ds_read_u16_d16_hi v250, v250
    ds_read_u16 v253, v253
    v_mad_u32_u16 v209, v209, 2, s85 op_sel:[1,0,0,0]
    v_mfma_f32_16x16x32_f16 v[192:195], a[240:243], v[152:155], 0
    v_pk_lshrrev_b16 v211, 3, v211 op_sel_hi:[0,1]
    v_mad_u32_u16 v212, v211, 2, s85
    v_mad_u32_u16 v211, v211, 2, s85 op_sel:[1,0,0,0]
    v_mfma_f32_16x16x32_f16 v[200:203], a[240:243], v[156:159], 0
    s_waitcnt lgkmcnt(12)
    ds_read_u16_d16_hi v252, v252
    v_mfma_f32_16x16x32_f16 v[176:179], a[248:251], v[136:139], v[176:179]
    s_waitcnt lgkmcnt(11)
    ds_read_u16 v208, v208
    v_or_b32 v240, v229, v228
    v_mfma_f32_16x16x32_f16 v[184:187], a[248:251], v[140:143], v[184:187]
    ds_read_u16_d16_hi v0, v0
    v_mfma_f32_16x16x32_f16 v[196:199], a[244:247], v[152:155], 0
    v_mfma_f32_16x16x32_f16 v[204:207], a[244:247], v[156:159], 0
    s_waitcnt lgkmcnt(12)
    ds_read_u16 v210, v210
    v_mfma_f32_16x16x32_f16 v[180:183], a[252:255], v[136:139], v[180:183]
    s_waitcnt lgkmcnt(11)
    ds_read_u16_d16_hi v209, v209
    v_or_b32 v241, v231, v230
    v_mfma_f32_16x16x32_f16 v[188:191], a[252:255], v[140:143], v[188:191]
    ds_read_u16 v212, v212
    v_mfma_f32_16x16x32_f16 v[192:195], a[248:251], v[160:163], v[192:195]
    v_mfma_f32_16x16x32_f16 v[200:203], a[248:251], v[164:167], v[200:203]
    s_waitcnt lgkmcnt(12)
    ds_read_u16_d16_hi v211, v211
    v_mfma_f32_16x16x32_f16 v[176:179], a[232:235], v[144:147], v[176:179]
    s_add_u32 m0, s56, 11456
    ds_read_b128 a[240:243], v23 offset:26624
    buffer_load_dwordx4 v6, s[20:23], 0 offen offset:64 lds
    v_mfma_f32_16x16x32_f16 v[184:187], a[232:235], v[148:151], v[184:187]
    s_waitcnt lgkmcnt(11)
    ds_read_b128 a[244:247], v23 offset:27648
    v_or_b32 v242, v249, v248
    v_mfma_f32_16x16x32_f16 v[196:199], a[252:255], v[160:163], v[196:199]
    v_cvt_pkrtz_f16_f32 v213, v176, v177
    v_pk_lshrrev_b16 v213, 3, v213 op_sel_hi:[0,1]
    v_mad_u32_u16 v214, v213, 2, s85
    v_mfma_f32_16x16x32_f16 v[204:207], a[252:255], v[164:167], v[204:207]
    ds_read_b128 a[248:251], v23 offset:28672
    v_mad_u32_u16 v213, v213, 2, s85 op_sel:[1,0,0,0]
    v_cvt_pkrtz_f16_f32 v215, v178, v179
    v_mfma_f32_16x16x32_f16 v[180:183], a[236:239], v[144:147], v[180:183]
    s_waitcnt lgkmcnt(11)
    ds_read_b128 a[252:255], v23 offset:29696
    v_or_b32 v243, v251, v250
    v_pk_lshrrev_b16 v215, 3, v215 op_sel_hi:[0,1]
    v_mfma_f32_16x16x32_f16 v[188:191], a[236:239], v[148:151], v[188:191]
    v_mad_u32_u16 v216, v215, 2, s85
    v_mad_u32_u16 v215, v215, 2, s85 op_sel:[1,0,0,0]
    v_cvt_pkrtz_f16_f32 v221, v184, v185
    v_mfma_f32_16x16x32_f16 v[192:195], a[232:235], v[168:171], v[192:195]
    ds_read_u16 v214, v214
    v_cvt_pkrtz_f16_f32 v217, v180, v181
    v_pk_lshrrev_b16 v217, 3, v217 op_sel_hi:[0,1]
    v_mfma_f32_16x16x32_f16 v[200:203], a[232:235], v[172:175], v[200:203]
    s_waitcnt lgkmcnt(11)
    ds_read_b128 a[232:235], v24 offset:0
    v_or_b32 v244, v253, v252
    v_mad_u32_u16 v218, v217, 2, s85
    v_mfma_f32_16x16x32_f16 v[196:199], a[236:239], v[168:171], v[196:199]
    ds_read_u16_d16_hi v213, v213
    v_mad_u32_u16 v217, v217, 2, s85 op_sel:[1,0,0,0]
    v_cvt_pkrtz_f16_f32 v219, v182, v183
    v_mfma_f32_16x16x32_f16 v[204:207], a[236:239], v[172:175], v[204:207]
    s_waitcnt lgkmcnt(11)
    v_pk_lshrrev_b16 v219, 3, v219 op_sel_hi:[0,1]
    v_or_b32 v245, v208, v0
    v_mad_u32_u16 v220, v219, 2, s85
    v_mfma_f32_16x16x32_bf16 v[32:35], a[208:211], v[232:235], v[32:35]
    ds_read_b128 a[236:239], v24 offset:1024
    v_mad_u32_u16 v219, v219, 2, s85 op_sel:[1,0,0,0]
    v_pk_lshrrev_b16 v221, 3, v221 op_sel_hi:[0,1]
    v_mfma_f32_16x16x32_bf16 v[40:43], a[208:211], v[236:239], v[40:43]
    ds_read_u16 v216, v216
    v_mad_u32_u16 v222, v221, 2, s85
    v_mad_u32_u16 v221, v221, 2, s85 op_sel:[1,0,0,0]
    v_mfma_f32_16x16x32_bf16 v[36:39], a[212:215], v[232:235], v[36:39]
    s_waitcnt lgkmcnt(11)
    ds_read_u16_d16_hi v215, v215
    v_or_b32 v246, v210, v209
    v_cvt_pkrtz_f16_f32 v223, v186, v187
    v_mfma_f32_16x16x32_bf16 v[44:47], a[212:215], v[236:239], v[44:47]
    v_pk_lshrrev_b16 v223, 3, v223 op_sel_hi:[0,1]
    v_mad_u32_u16 v224, v223, 2, s85
    v_mad_u32_u16 v223, v223, 2, s85 op_sel:[1,0,0,0]
    v_mfma_f32_16x16x32_bf16 v[80:83], a[208:211], v[240:243], v[80:83]
    s_waitcnt lgkmcnt(11)
    ds_read_u16 v218, v218
    v_cvt_pkrtz_f16_f32 v225, v188, v189
    v_pk_lshrrev_b16 v225, 3, v225 op_sel_hi:[0,1]
    s_waitcnt lgkmcnt(11)
    v_or_b32 v247, v212, v211
    v_mad_u32_u16 v226, v225, 2, s85
    v_mad_u32_u16 v225, v225, 2, s85 op_sel:[1,0,0,0]
    v_mfma_f32_16x16x32_bf16 v[88:91], a[208:211], v[244:247], v[88:91]
    s_waitcnt lgkmcnt(10)
    ds_read_u16_d16_hi v217, v217
    ds_read_u16 v220, v220
    v_cvt_pkrtz_f16_f32 v227, v190, v191
    v_mfma_f32_16x16x32_bf16 v[48:51], a[240:243], v[232:235], v[48:51]
    ds_read_u16_d16_hi v219, v219
    v_pk_lshrrev_b16 v227, 3, v227 op_sel_hi:[0,1]
    v_mad_u32_u16 v228, v227, 2, s85
    v_mfma_f32_16x16x32_bf16 v[56:59], a[240:243], v[236:239], v[56:59]
    s_waitcnt lgkmcnt(12)
    ds_read_u16 v222, v222
    ds_read_u16_d16_hi v221, v221
    v_mad_u32_u16 v227, v227, 2, s85 op_sel:[1,0,0,0]
    v_mfma_f32_16x16x32_bf16 v[84:87], a[212:215], v[240:243], v[84:87]
    v_cvt_pkrtz_f16_f32 v229, v192, v193
    v_pk_lshrrev_b16 v229, 3, v229 op_sel_hi:[0,1]
    v_cvt_pkrtz_f16_f32 v231, v194, v195
    v_mfma_f32_16x16x32_bf16 v[92:95], a[212:215], v[244:247], v[92:95]
    s_waitcnt lgkmcnt(13)
    ds_read_u16 v224, v224
    v_cvt_pkrtz_f16_f32 v249, v196, v197
    v_cvt_pkrtz_f16_f32 v251, v198, v199
    v_mfma_f32_16x16x32_bf16 v[52:55], a[244:247], v[232:235], v[52:55]
    s_waitcnt lgkmcnt(13)
    ds_read_u16_d16_hi v223, v223
    v_cvt_pkrtz_f16_f32 v253, v200, v201
    v_cvt_pkrtz_f16_f32 v208, v202, v203
    v_mfma_f32_16x16x32_bf16 v[60:63], a[244:247], v[236:239], v[60:63]
    s_waitcnt lgkmcnt(13)
    ds_read_u16 v226, v226
    v_cvt_pkrtz_f16_f32 v210, v204, v205
    v_cvt_pkrtz_f16_f32 v212, v206, v207
    v_mfma_f32_16x16x32_bf16 v[96:99], a[240:243], v[240:243], v[96:99]
    s_waitcnt lgkmcnt(13)
    ds_read_u16_d16_hi v225, v225
    v_mad_u32_u16 v230, v229, 2, s85
    v_mad_u32_u16 v229, v229, 2, s85 op_sel:[1,0,0,0]
    v_mfma_f32_16x16x32_bf16 v[104:107], a[240:243], v[244:247], v[104:107]
    s_waitcnt lgkmcnt(13)
    ds_read_u16 v228, v228
    v_pk_lshrrev_b16 v231, 3, v231 op_sel_hi:[0,1]
    v_mad_u32_u16 v248, v231, 2, s85
    v_mfma_f32_16x16x32_bf16 v[64:67], a[248:251], v[232:235], v[64:67]
    v_mad_u32_u16 v231, v231, 2, s85 op_sel:[1,0,0,0]
    v_pk_lshrrev_b16 v249, 3, v249 op_sel_hi:[0,1]
    v_mad_u32_u16 v250, v249, 2, s85
    v_mfma_f32_16x16x32_bf16 v[72:75], a[248:251], v[236:239], v[72:75]
    s_waitcnt lgkmcnt(13)
    ds_read_u16_d16_hi v227, v227
    v_mad_u32_u16 v249, v249, 2, s85 op_sel:[1,0,0,0]
    v_pk_lshrrev_b16 v251, 3, v251 op_sel_hi:[0,1]
    v_mfma_f32_16x16x32_bf16 v[100:103], a[244:247], v[240:243], v[100:103]
    s_waitcnt lgkmcnt(13)
    ds_read_b128 a[240:243], v24 offset:2048
    v_mad_u32_u16 v252, v251, 2, s85
    v_mad_u32_u16 v251, v251, 2, s85 op_sel:[1,0,0,0]
    v_mfma_f32_16x16x32_bf16 v[108:111], a[244:247], v[244:247], v[108:111]
    s_waitcnt lgkmcnt(13)
    ds_read_b128 a[244:247], v24 offset:3072
    v_pk_lshrrev_b16 v253, 3, v253 op_sel_hi:[0,1]
    v_mad_u32_u16 v0, v253, 2, s85
    v_mfma_f32_16x16x32_bf16 v[68:71], a[252:255], v[232:235], v[68:71]
    s_waitcnt lgkmcnt(12)
    v_or_b32 v232, v214, v213
    v_or_b32 v233, v216, v215
    v_or_b32 v234, v218, v217
    v_mfma_f32_16x16x32_bf16 v[76:79], a[252:255], v[236:239], v[76:79]
    ds_read_u16 v230, v230
    v_mad_u32_u16 v253, v253, 2, s85 op_sel:[1,0,0,0]
    v_pk_lshrrev_b16 v208, 3, v208 op_sel_hi:[0,1]
    v_mfma_f32_16x16x32_bf16 v[112:115], a[248:251], v[240:243], v[112:115]
    s_waitcnt lgkmcnt(11)
    ds_read_u16_d16_hi v229, v229
    v_or_b32 v235, v220, v219
    v_mad_u32_u16 v209, v208, 2, s85
    v_mfma_f32_16x16x32_bf16 v[120:123], a[248:251], v[244:247], v[120:123]
    ds_read_b128 a[248:251], v24 offset:4096
    v_mad_u32_u16 v208, v208, 2, s85 op_sel:[1,0,0,0]
    v_pk_lshrrev_b16 v210, 3, v210 op_sel_hi:[0,1]
    v_mfma_f32_16x16x32_bf16 v[116:119], a[252:255], v[240:243], v[116:119]
    s_waitcnt lgkmcnt(12)
    v_mad_u32_u16 v211, v210, 2, s85
    v_mad_u32_u16 v210, v210, 2, s85 op_sel:[1,0,0,0]
    s_waitcnt lgkmcnt(11)
    v_or_b32 v236, v222, v221
    v_mfma_f32_16x16x32_bf16 v[124:127], a[252:255], v[244:247], v[124:127]
    ds_read_b128 a[252:255], v24 offset:5120
    v_pk_lshrrev_b16 v212, 3, v212 op_sel_hi:[0,1]
    v_mad_u32_u16 v213, v212, 2, s85
    v_mfma_f32_16x16x32_f16 v[176:179], a[232:235], v[128:131], 0
    ds_read_u16 v248, v248
    v_mad_u32_u16 v212, v212, 2, s85 op_sel:[1,0,0,0]
    v_mfma_f32_16x16x32_f16 v[184:187], a[232:235], v[132:135], 0
    s_waitcnt lgkmcnt(11)
    v_or_b32 v237, v224, v223
    v_mfma_f32_16x16x32_f16 v[180:183], a[236:239], v[128:131], 0
    ds_read_u16_d16_hi v231, v231
    v_mfma_f32_16x16x32_f16 v[188:191], a[236:239], v[132:135], 0
    ds_read_u16 v250, v250
    v_mfma_f32_16x16x32_f16 v[192:195], a[232:235], v[152:155], 0
    v_mfma_f32_16x16x32_f16 v[200:203], a[232:235], v[156:159], 0
    s_waitcnt lgkmcnt(11)
    ds_read_u16_d16_hi v249, v249
    v_or_b32 v238, v226, v225
    ds_read_u16 v252, v252
    s_waitcnt lgkmcnt(11)
    v_or_b32 v239, v228, v227
    s_waitcnt lgkmcnt(10)
    v_mfma_f32_16x16x32_f16 v[176:179], a[240:243], v[136:139], v[176:179]
    ds_read_u16_d16_hi v251, v251
    ds_read_u16 v0, v0
    ds_read_u16_d16_hi v253, v253
    v_mfma_f32_16x16x32_f16 v[184:187], a[240:243], v[140:143], v[184:187]
    v_mfma_f32_16x16x32_f16 v[196:199], a[236:239], v[152:155], 0
    s_waitcnt lgkmcnt(12)
    ds_read_u16 v209, v209
    v_mfma_f32_16x16x32_f16 v[204:207], a[236:239], v[156:159], 0
    s_add_u32 m0, s56, 12480
    v_mfma_f32_16x16x32_f16 v[180:183], a[244:247], v[136:139], v[180:183]
    s_waitcnt lgkmcnt(12)
    ds_read_u16_d16_hi v208, v208
    buffer_load_dword v7, s[20:23], 0 offen offset:64 lds
    ds_read_u16 v211, v211
    v_mfma_f32_16x16x32_f16 v[188:191], a[244:247], v[140:143], v[188:191]
    s_waitcnt lgkmcnt(13)
    ds_read_u16_d16_hi v210, v210
    v_or_b32 v240, v230, v229
    v_mfma_f32_16x16x32_f16 v[192:195], a[240:243], v[160:163], v[192:195]
    s_add_u32 m0, s56, 0
    v_mfma_f32_16x16x32_f16 v[200:203], a[240:243], v[164:167], v[200:203]
    s_waitcnt lgkmcnt(13)
    ds_read_u16 v213, v213
    buffer_load_dwordx4 v1, s[20:23], 0 offen offset:0 lds
    v_mfma_f32_16x16x32_f16 v[176:179], a[248:251], v[144:147], v[176:179]
    s_waitcnt lgkmcnt(11)
    ds_read_u16_d16_hi v212, v212
    v_or_b32 v241, v248, v231
    v_mfma_f32_16x16x32_f16 v[184:187], a[248:251], v[148:151], v[184:187]
    v_mfma_f32_16x16x32_f16 v[196:199], a[244:247], v[160:163], v[196:199]
    ds_read_b128 a[232:235], v23 offset:36864
    v_mfma_f32_16x16x32_f16 v[204:207], a[244:247], v[164:167], v[204:207]
    s_waitcnt lgkmcnt(11)
    ds_read_b128 a[236:239], v23 offset:37888
    v_or_b32 v242, v250, v249
    v_mfma_f32_16x16x32_f16 v[180:183], a[252:255], v[144:147], v[180:183]
    v_cvt_pkrtz_f16_f32 v214, v176, v177
    v_pk_lshrrev_b16 v214, 3, v214 op_sel_hi:[0,1]
    v_mad_u32_u16 v215, v214, 2, s85
    v_mfma_f32_16x16x32_f16 v[188:191], a[252:255], v[148:151], v[188:191]
    ds_read_b128 a[240:243], v23 offset:38912
    v_mad_u32_u16 v214, v214, 2, s85 op_sel:[1,0,0,0]
    v_cvt_pkrtz_f16_f32 v216, v178, v179
    v_mfma_f32_16x16x32_f16 v[192:195], a[248:251], v[168:171], v[192:195]
    s_waitcnt lgkmcnt(11)
    ds_read_b128 a[244:247], v23 offset:39936
    v_or_b32 v243, v252, v251
    v_pk_lshrrev_b16 v216, 3, v216 op_sel_hi:[0,1]
    v_mfma_f32_16x16x32_f16 v[200:203], a[248:251], v[172:175], v[200:203]
    v_mad_u32_u16 v217, v216, 2, s85
    v_mad_u32_u16 v216, v216, 2, s85 op_sel:[1,0,0,0]
    v_cvt_pkrtz_f16_f32 v218, v180, v181
    v_mfma_f32_16x16x32_f16 v[196:199], a[252:255], v[168:171], v[196:199]
    ds_read_b128 a[248:251], v24 offset:12288
    v_pk_lshrrev_b16 v218, 3, v218 op_sel_hi:[0,1]
    v_mad_u32_u16 v219, v218, 2, s85
    v_mfma_f32_16x16x32_f16 v[204:207], a[252:255], v[172:175], v[204:207]
    s_waitcnt lgkmcnt(11)
    ds_read_b128 a[252:255], v24 offset:13312
    v_or_b32 v244, v0, v253
    v_mad_u32_u16 v218, v218, 2, s85 op_sel:[1,0,0,0]
    v_mfma_f32_16x16x32_bf16 v[32:35], a[216:219], v[232:235], v[32:35]
    ds_read_u16 v215, v215
    v_cvt_pkrtz_f16_f32 v220, v182, v183
    v_pk_lshrrev_b16 v220, 3, v220 op_sel_hi:[0,1]
    v_mfma_f32_16x16x32_bf16 v[40:43], a[216:219], v[236:239], v[40:43]
    s_waitcnt lgkmcnt(12)
    v_mad_u32_u16 v221, v220, 2, s85
    v_mad_u32_u16 v220, v220, 2, s85 op_sel:[1,0,0,0]
    s_waitcnt lgkmcnt(11)
    v_or_b32 v245, v209, v208
    v_mfma_f32_16x16x32_bf16 v[36:39], a[220:223], v[232:235], v[36:39]
    ds_read_u16_d16_hi v214, v214
    v_cvt_pkrtz_f16_f32 v222, v184, v185
    v_pk_lshrrev_b16 v222, 3, v222 op_sel_hi:[0,1]
    v_mfma_f32_16x16x32_bf16 v[44:47], a[220:223], v[236:239], v[44:47]
    ds_read_u16 v217, v217
    v_mad_u32_u16 v223, v222, 2, s85
    v_mad_u32_u16 v222, v222, 2, s85 op_sel:[1,0,0,0]
    v_mfma_f32_16x16x32_bf16 v[80:83], a[216:219], v[240:243], v[80:83]
    s_waitcnt lgkmcnt(11)
    ds_read_u16_d16_hi v216, v216
    v_or_b32 v246, v211, v210
    v_cvt_pkrtz_f16_f32 v224, v186, v187
    v_pk_lshrrev_b16 v224, 3, v224 op_sel_hi:[0,1]
    v_mad_u32_u16 v225, v224, 2, s85
    v_mad_u32_u16 v224, v224, 2, s85 op_sel:[1,0,0,0]
    v_cvt_pkrtz_f16_f32 v228, v188, v189
    v_cvt_pkrtz_f16_f32 v231, v190, v191
    v_pk_fma_f16 v226, v228, v228, s53
    v_pk_fma_f16 v229, v231, v231, s53
    v_pk_mul_f16 v226, v226, v228 neg_lo:[1,0] neg_hi:[1,0]
    v_pk_mul_f16 v229, v229, v231 neg_lo:[1,0] neg_hi:[1,0]
    v_exp_f16 v227, v226
    s_waitcnt lgkmcnt(10)
    v_or_b32 v247, v213, v212
    v_exp_f16 v230, v229
    v_exp_f16_sdwa v227, v226 dst_sel:WORD_1 dst_unused:UNUSED_PRESERVE src0_sel:WORD_1
    v_mfma_f32_16x16x32_bf16 v[88:91], a[216:219], v[244:247], v[88:91]
    s_waitcnt lgkmcnt(9)
    ds_read_u16 v219, v219
    ds_read_u16_d16_hi v218, v218
    ds_read_u16 v221, v221
    ds_read_u16_d16_hi v220, v220
    v_mfma_f32_16x16x32_bf16 v[48:51], a[232:235], v[232:235], v[48:51]
    ds_read_u16 v223, v223
    v_exp_f16_sdwa v230, v229 dst_sel:WORD_1 dst_unused:UNUSED_PRESERVE src0_sel:WORD_1
    v_mfma_f32_16x16x32_bf16 v[56:59], a[232:235], v[236:239], v[56:59]
    s_waitcnt lgkmcnt(13)
    ds_read_u16_d16_hi v222, v222
    v_pk_fma_f16 v227, v227, s86, s86
    v_pk_fma_f16 v230, v230, s86, s86
    v_mfma_f32_16x16x32_bf16 v[84:87], a[220:223], v[240:243], v[84:87]
    s_waitcnt lgkmcnt(12)
    ds_read_u16 v225, v225
    ds_read_u16_d16_hi v224, v224
    v_rcp_f16 v226, v227
    v_mfma_f32_16x16x32_bf16 v[92:95], a[220:223], v[244:247], v[92:95]
    v_rcp_f16 v229, v230
    v_rcp_f16_sdwa v226, v227 dst_sel:WORD_1 dst_unused:UNUSED_PRESERVE src0_sel:WORD_1
    v_mfma_f32_16x16x32_bf16 v[52:55], a[236:239], v[232:235], v[52:55]
    v_rcp_f16_sdwa v229, v230 dst_sel:WORD_1 dst_unused:UNUSED_PRESERVE src0_sel:WORD_1
    v_fma_mix_f32 v227, v226, v228, 0 op_sel_hi:[1,1,0]
    v_mfma_f32_16x16x32_bf16 v[60:63], a[236:239], v[236:239], v[60:63]
    v_fma_mix_f32 v230, v229, v231, 0 op_sel_hi:[1,1,0]
    v_fma_mix_f32 v226, v226, v228, 0 op_sel:[1,1,0] op_sel_hi:[1,1,0]
    v_fma_mix_f32 v229, v229, v231, 0 op_sel:[1,1,0] op_sel_hi:[1,1,0]
    v_mfma_f32_16x16x32_bf16 v[96:99], a[232:235], v[240:243], v[96:99]
    v_cvt_pkrtz_f16_f32 v248, v192, v193
    v_pk_lshrrev_b16 v248, 3, v248 op_sel_hi:[0,1]
    v_cvt_pkrtz_f16_f32 v250, v194, v195
    v_mfma_f32_16x16x32_bf16 v[104:107], a[232:235], v[244:247], v[104:107]
    s_waitcnt lgkmcnt(13)
    ds_read_b128 a[232:235], v24 offset:14336
    v_cvt_pkrtz_f16_f32 v252, v196, v197
    v_cvt_pkrtz_f16_f32 v0, v198, v199
    v_mfma_f32_16x16x32_bf16 v[64:67], a[240:243], v[232:235], v[64:67]
    v_cvt_pkrtz_f16_f32 v209, v200, v201
    v_cvt_pkrtz_f16_f32 v211, v202, v203
    v_mad_u32_u16 v249, v248, 2, s85
    v_mfma_f32_16x16x32_bf16 v[72:75], a[240:243], v[236:239], v[72:75]
    s_waitcnt lgkmcnt(13)
    ds_read_u16 v249, v249
    v_mad_u32_u16 v248, v248, 2, s85 op_sel:[1,0,0,0]
    v_pk_lshrrev_b16 v250, 3, v250 op_sel_hi:[0,1]
    v_mfma_f32_16x16x32_bf16 v[100:103], a[236:239], v[240:243], v[100:103]
    s_waitcnt lgkmcnt(13)
    ds_read_u16_d16_hi v248, v248
    v_mad_u32_u16 v251, v250, 2, s85
    v_mad_u32_u16 v250, v250, 2, s85 op_sel:[1,0,0,0]
    v_mfma_f32_16x16x32_bf16 v[108:111], a[236:239], v[244:247], v[108:111]
    s_waitcnt lgkmcnt(11)
    ds_read_b128 a[236:239], v24 offset:15360
    ds_read_u16 v251, v251
    ds_read_u16_d16_hi v250, v250
    v_mfma_f32_16x16x32_bf16 v[68:71], a[244:247], v[232:235], v[68:71]
    s_waitcnt lgkmcnt(12)
    v_or_b32 v232, v215, v214
    v_or_b32 v233, v217, v216
    v_or_b32 v234, v219, v218
    v_mfma_f32_16x16x32_bf16 v[76:79], a[244:247], v[236:239], v[76:79]
    s_waitcnt lgkmcnt(10)
    v_or_b32 v235, v221, v220
    v_cvt_pk_bf16_f32 v238, v227, v226
    v_cvt_pk_bf16_f32 v239, v230, v229
    v_mfma_f32_16x16x32_bf16 v[112:115], a[240:243], v[240:243], v[112:115]
    v_cvt_pkrtz_f16_f32 v215, v204, v205
    v_cvt_pkrtz_f16_f32 v218, v206, v207
    v_pk_lshrrev_b16 v252, 3, v252 op_sel_hi:[0,1]
    v_mfma_f32_16x16x32_bf16 v[120:123], a[240:243], v[244:247], v[120:123]
    s_waitcnt lgkmcnt(8)
    ds_read_b128 a[240:243], v24 offset:16384
    v_or_b32 v236, v223, v222
    v_mad_u32_u16 v253, v252, 2, s85
    v_mfma_f32_16x16x32_bf16 v[116:119], a[244:247], v[240:243], v[116:119]
    ds_read_u16 v253, v253
    v_mad_u32_u16 v252, v252, 2, s85 op_sel:[1,0,0,0]
    v_pk_lshrrev_b16 v0, 3, v0 op_sel_hi:[0,1]
    v_mfma_f32_16x16x32_bf16 v[124:127], a[244:247], v[244:247], v[124:127]
    s_add_u32 m0, s56, 1024
    ds_read_b128 a[244:247], v24 offset:17408
    buffer_load_dwordx4 v2, s[20:23], 0 offen offset:0 lds
    ds_read_u16_d16_hi v252, v252
    v_mfma_f32_16x16x32_f16 v[176:179], a[248:251], v[128:131], 0
    s_waitcnt lgkmcnt(10)
    v_or_b32 v237, v225, v224
    v_mad_u32_u16 v208, v0, 2, s85
    v_mad_u32_u16 v0, v0, 2, s85 op_sel:[1,0,0,0]
    v_mfma_f32_16x16x32_f16 v[184:187], a[248:251], v[132:135], 0
    ds_read_u16 v208, v208
    ds_read_u16_d16_hi v0, v0
    v_pk_lshrrev_b16 v209, 3, v209 op_sel_hi:[0,1]
    v_mfma_f32_16x16x32_f16 v[180:183], a[252:255], v[128:131], 0
    v_mad_u32_u16 v210, v209, 2, s85
    v_mad_u32_u16 v209, v209, 2, s85 op_sel:[1,0,0,0]
    v_pk_lshrrev_b16 v211, 3, v211 op_sel_hi:[0,1]
    v_mfma_f32_16x16x32_f16 v[188:191], a[252:255], v[132:135], 0
    ds_read_u16 v210, v210
    ds_read_u16_d16_hi v209, v209
    v_mad_u32_u16 v212, v211, 2, s85
    v_mfma_f32_16x16x32_f16 v[192:195], a[248:251], v[152:155], 0
    s_waitcnt lgkmcnt(13)
    ds_read_u16 v212, v212
    v_mad_u32_u16 v211, v211, 2, s85 op_sel:[1,0,0,0]
    v_pk_fma_f16 v213, v215, v215, s53
    v_mfma_f32_16x16x32_f16 v[200:203], a[248:251], v[156:159], 0
    s_waitcnt lgkmcnt(12)
    ds_read_u16_d16_hi v211, v211
    ds_read_b128 a[248:251], v24 offset:6144
    v_pk_fma_f16 v216, v218, v218, s53
    v_mfma_f32_16x16x32_f16 v[176:179], a[232:235], v[136:139], v[176:179]
    v_pk_mul_f16 v213, v213, v215 neg_lo:[1,0] neg_hi:[1,0]
    v_pk_mul_f16 v216, v216, v218 neg_lo:[1,0] neg_hi:[1,0]
    v_exp_f16 v214, v213
    v_mfma_f32_16x16x32_f16 v[184:187], a[232:235], v[140:143], v[184:187]
    v_exp_f16 v217, v216
    v_exp_f16_sdwa v214, v213 dst_sel:WORD_1 dst_unused:UNUSED_PRESERVE src0_sel:WORD_1
    v_mfma_f32_16x16x32_f16 v[196:199], a[252:255], v[152:155], 0
    v_exp_f16_sdwa v217, v216 dst_sel:WORD_1 dst_unused:UNUSED_PRESERVE src0_sel:WORD_1
    v_pk_fma_f16 v214, v214, s86, s86
    v_mfma_f32_16x16x32_f16 v[204:207], a[252:255], v[156:159], 0
    s_waitcnt lgkmcnt(13)
    ds_read_b128 a[252:255], v24 offset:7168
    v_pk_fma_f16 v217, v217, s86, s86
    v_rcp_f16 v213, v214
    v_mfma_f32_16x16x32_f16 v[180:183], a[236:239], v[136:139], v[180:183]
    v_rcp_f16 v216, v217
    v_rcp_f16_sdwa v213, v214 dst_sel:WORD_1 dst_unused:UNUSED_PRESERVE src0_sel:WORD_1
    v_mfma_f32_16x16x32_f16 v[188:191], a[236:239], v[140:143], v[188:191]
    s_add_u32 m0, s56, 2048
    v_rcp_f16_sdwa v216, v217 dst_sel:WORD_1 dst_unused:UNUSED_PRESERVE src0_sel:WORD_1
    v_fma_mix_f32 v214, v213, v215, 0 op_sel_hi:[1,1,0]
    v_mfma_f32_16x16x32_f16 v[192:195], a[232:235], v[160:163], v[192:195]
    buffer_load_dwordx4 v3, s[20:23], 0 offen offset:0 lds
    v_mfma_f32_16x16x32_f16 v[200:203], a[232:235], v[164:167], v[200:203]
    s_waitcnt lgkmcnt(11)
    ds_read_b128 a[232:235], v24 offset:8192
    v_fma_mix_f32 v217, v216, v218, 0 op_sel_hi:[1,1,0]
    v_fma_mix_f32 v213, v213, v215, 0 op_sel:[1,1,0] op_sel_hi:[1,1,0]
    v_mfma_f32_16x16x32_f16 v[176:179], a[240:243], v[144:147], v[176:179]
    v_fma_mix_f32 v216, v216, v218, 0 op_sel:[1,1,0] op_sel_hi:[1,1,0]
    v_or_b32 v240, v249, v248
    v_or_b32 v241, v251, v250
    v_mfma_f32_16x16x32_f16 v[184:187], a[240:243], v[148:151], v[184:187]
    s_waitcnt lgkmcnt(6)
    v_or_b32 v242, v253, v252
    v_or_b32 v243, v208, v0
    s_waitcnt lgkmcnt(5)
    v_or_b32 v244, v210, v209
    v_mfma_f32_16x16x32_f16 v[196:199], a[236:239], v[160:163], v[196:199]
    v_cvt_pk_bf16_f32 v246, v214, v213
    v_cvt_pk_bf16_f32 v247, v217, v216
    v_cvt_pkrtz_f16_f32 v219, v176, v177
    v_mfma_f32_16x16x32_f16 v[204:207], a[236:239], v[164:167], v[204:207]
    ds_read_b128 a[236:239], v24 offset:9216
    v_pk_lshrrev_b16 v219, 3, v219 op_sel_hi:[0,1]
    v_mad_u32_u16 v220, v219, 2, s85
    v_mfma_f32_16x16x32_f16 v[180:183], a[244:247], v[144:147], v[180:183]
    s_waitcnt lgkmcnt(4)
    ds_read_u16 v220, v220
    v_or_b32 v245, v212, v211
    v_mad_u32_u16 v219, v219, 2, s85 op_sel:[1,0,0,0]
    v_mfma_f32_16x16x32_f16 v[188:191], a[244:247], v[148:151], v[188:191]
    ds_read_u16_d16_hi v219, v219
    v_cvt_pkrtz_f16_f32 v221, v178, v179
    v_pk_lshrrev_b16 v221, 3, v221 op_sel_hi:[0,1]
    v_mfma_f32_16x16x32_f16 v[192:195], a[240:243], v[168:171], v[192:195]
    v_mad_u32_u16 v222, v221, 2, s85
    v_mad_u32_u16 v221, v221, 2, s85 op_sel:[1,0,0,0]
    v_cvt_pkrtz_f16_f32 v223, v180, v181
    v_mfma_f32_16x16x32_f16 v[200:203], a[240:243], v[172:175], v[200:203]
    ds_read_b128 a[240:243], v24 offset:10240
    ds_read_u16 v222, v222
    ds_read_u16_d16_hi v221, v221
    v_mfma_f32_16x16x32_f16 v[196:199], a[244:247], v[168:171], v[196:199]
    v_pk_lshrrev_b16 v223, 3, v223 op_sel_hi:[0,1]
    v_mad_u32_u16 v224, v223, 2, s85
    v_mad_u32_u16 v223, v223, 2, s85 op_sel:[1,0,0,0]
    v_mfma_f32_16x16x32_f16 v[204:207], a[244:247], v[172:175], v[204:207]
    s_waitcnt lgkmcnt(8)
    ds_read_b128 a[244:247], v24 offset:11264
    ds_read_u16 v224, v224
    ds_read_u16_d16_hi v223, v223
    v_mfma_f32_16x16x32_bf16 v[32:35], a[248:251], v[232:235], v[32:35]
    v_cvt_pkrtz_f16_f32 v225, v182, v183
    v_pk_lshrrev_b16 v225, 3, v225 op_sel_hi:[0,1]
    v_mad_u32_u16 v226, v225, 2, s85
    v_mfma_f32_16x16x32_bf16 v[40:43], a[248:251], v[236:239], v[40:43]
    s_waitcnt lgkmcnt(10)
    ds_read_u16 v226, v226
    v_mad_u32_u16 v225, v225, 2, s85 op_sel:[1,0,0,0]
    v_cvt_pkrtz_f16_f32 v227, v184, v185
    v_mfma_f32_16x16x32_bf16 v[36:39], a[252:255], v[232:235], v[36:39]
    ds_read_u16_d16_hi v225, v225
    v_pk_lshrrev_b16 v227, 3, v227 op_sel_hi:[0,1]
    v_mad_u32_u16 v228, v227, 2, s85
    v_mfma_f32_16x16x32_bf16 v[44:47], a[252:255], v[236:239], v[44:47]
    ds_read_u16 v228, v228
    v_mad_u32_u16 v227, v227, 2, s85 op_sel:[1,0,0,0]
    v_cvt_pkrtz_f16_f32 v229, v186, v187
    v_mfma_f32_16x16x32_bf16 v[80:83], a[248:251], v[240:243], v[80:83]
    ds_read_u16_d16_hi v227, v227
    v_pk_lshrrev_b16 v229, 3, v229 op_sel_hi:[0,1]
    v_mad_u32_u16 v230, v229, 2, s85
    v_mfma_f32_16x16x32_bf16 v[88:91], a[248:251], v[244:247], v[88:91]
    s_waitcnt lgkmcnt(12)
    ds_read_u16 v230, v230
    ds_read_b128 a[248:251], v24 offset:24576
    v_mad_u32_u16 v229, v229, 2, s85 op_sel:[1,0,0,0]
    v_mfma_f32_16x16x32_bf16 v[48:51], a[232:235], v[232:235], v[48:51]
    s_waitcnt lgkmcnt(13)
    ds_read_u16_d16_hi v229, v229
    v_cvt_pkrtz_f16_f32 v231, v188, v189
    v_pk_lshrrev_b16 v231, 3, v231 op_sel_hi:[0,1]
    v_mfma_f32_16x16x32_bf16 v[56:59], a[232:235], v[236:239], v[56:59]
    v_mad_u32_u16 v248, v231, 2, s85
    v_mad_u32_u16 v231, v231, 2, s85 op_sel:[1,0,0,0]
    v_cvt_pkrtz_f16_f32 v249, v190, v191
    v_mfma_f32_16x16x32_bf16 v[84:87], a[252:255], v[240:243], v[84:87]
    s_waitcnt lgkmcnt(12)
    ds_read_u16 v248, v248
    ds_read_u16_d16_hi v231, v231
    v_pk_lshrrev_b16 v249, 3, v249 op_sel_hi:[0,1]
    v_mfma_f32_16x16x32_bf16 v[92:95], a[252:255], v[244:247], v[92:95]
    s_waitcnt lgkmcnt(13)
    ds_read_b128 a[252:255], v24 offset:25600
    v_mad_u32_u16 v250, v249, 2, s85
    v_mad_u32_u16 v249, v249, 2, s85 op_sel:[1,0,0,0]
    v_mfma_f32_16x16x32_bf16 v[52:55], a[236:239], v[232:235], v[52:55]
    s_waitcnt lgkmcnt(12)
    ds_read_u16 v250, v250
    ds_read_u16_d16_hi v249, v249
    v_cvt_pkrtz_f16_f32 v251, v192, v193
    v_mfma_f32_16x16x32_bf16 v[60:63], a[236:239], v[236:239], v[60:63]
    v_pk_lshrrev_b16 v251, 3, v251 op_sel_hi:[0,1]
    v_cvt_pkrtz_f16_f32 v253, v194, v195
    v_cvt_pkrtz_f16_f32 v208, v196, v197
    v_mfma_f32_16x16x32_bf16 v[96:99], a[232:235], v[240:243], v[96:99]
    v_cvt_pkrtz_f16_f32 v210, v198, v199
    v_cvt_pkrtz_f16_f32 v212, v200, v201
    v_cvt_pkrtz_f16_f32 v214, v202, v203
    v_mfma_f32_16x16x32_bf16 v[104:107], a[232:235], v[244:247], v[104:107]
    s_waitcnt lgkmcnt(13)
    ds_read_b128 a[232:235], v24 offset:26624
    v_cvt_pkrtz_f16_f32 v216, v204, v205
    v_cvt_pkrtz_f16_f32 v218, v206, v207
    v_mfma_f32_16x16x32_bf16 v[64:67], a[240:243], v[232:235], v[64:67]
    v_mad_u32_u16 v252, v251, 2, s85
    v_mad_u32_u16 v251, v251, 2, s85 op_sel:[1,0,0,0]
    v_pk_lshrrev_b16 v253, 3, v253 op_sel_hi:[0,1]
    v_mfma_f32_16x16x32_bf16 v[72:75], a[240:243], v[236:239], v[72:75]
    s_waitcnt lgkmcnt(12)
    ds_read_u16 v252, v252
    ds_read_u16_d16_hi v251, v251
    v_mad_u32_u16 v0, v253, 2, s85
    v_mfma_f32_16x16x32_bf16 v[100:103], a[236:239], v[240:243], v[100:103]
    s_waitcnt lgkmcnt(13)
    ds_read_u16 v0, v0
    v_mad_u32_u16 v253, v253, 2, s85 op_sel:[1,0,0,0]
    v_pk_lshrrev_b16 v208, 3, v208 op_sel_hi:[0,1]
    v_mfma_f32_16x16x32_bf16 v[108:111], a[236:239], v[244:247], v[108:111]
    s_waitcnt lgkmcnt(12)
    ds_read_b128 a[236:239], v24 offset:27648
    ds_read_u16_d16_hi v253, v253
    v_mad_u32_u16 v209, v208, 2, s85
    v_mfma_f32_16x16x32_bf16 v[68:71], a[244:247], v[232:235], v[68:71]
    s_waitcnt lgkmcnt(13)
    ds_read_u16 v209, v209
    v_or_b32 v232, v220, v219
    v_or_b32 v233, v222, v221
    v_mfma_f32_16x16x32_bf16 v[76:79], a[244:247], v[236:239], v[76:79]
    v_or_b32 v234, v224, v223
    v_or_b32 v235, v226, v225
    v_or_b32 v236, v228, v227
    v_mfma_f32_16x16x32_bf16 v[112:115], a[240:243], v[240:243], v[112:115]
    s_waitcnt lgkmcnt(10)
    v_or_b32 v237, v230, v229
    v_or_b32 v238, v248, v231
    v_mad_u32_u16 v208, v208, 2, s85 op_sel:[1,0,0,0]
    v_mfma_f32_16x16x32_bf16 v[120:123], a[240:243], v[244:247], v[120:123]
    ds_read_b128 a[240:243], v24 offset:28672
    ds_read_u16_d16_hi v208, v208
    v_pk_lshrrev_b16 v210, 3, v210 op_sel_hi:[0,1]
    v_mfma_f32_16x16x32_bf16 v[116:119], a[244:247], v[240:243], v[116:119]
    s_waitcnt lgkmcnt(9)
    v_mad_u32_u16 v211, v210, 2, s85
    v_or_b32 v239, v250, v249
    v_mad_u32_u16 v210, v210, 2, s85 op_sel:[1,0,0,0]
    v_mfma_f32_16x16x32_bf16 v[124:127], a[244:247], v[244:247], v[124:127]
    ds_read_b128 a[244:247], v24 offset:29696
    ds_read_u16 v211, v211
    ds_read_u16_d16_hi v210, v210
    v_mfma_f32_16x16x32_f16 v[176:179], a[248:251], v[128:131], 0
    v_pk_lshrrev_b16 v212, 3, v212 op_sel_hi:[0,1]
    v_mad_u32_u16 v213, v212, 2, s85
    v_mad_u32_u16 v212, v212, 2, s85 op_sel:[1,0,0,0]
    v_mfma_f32_16x16x32_f16 v[184:187], a[248:251], v[132:135], 0
    ds_read_u16 v213, v213
    ds_read_u16_d16_hi v212, v212
    v_pk_lshrrev_b16 v214, 3, v214 op_sel_hi:[0,1]
    v_mfma_f32_16x16x32_f16 v[180:183], a[252:255], v[128:131], 0
    s_waitcnt lgkmcnt(12)
    v_mad_u32_u16 v215, v214, 2, s85
    v_mad_u32_u16 v214, v214, 2, s85 op_sel:[1,0,0,0]
    v_pk_lshrrev_b16 v216, 3, v216 op_sel_hi:[0,1]
    v_mfma_f32_16x16x32_f16 v[188:191], a[252:255], v[132:135], 0
    s_add_u32 m0, s56, 3072
    ds_read_u16 v215, v215
    ds_read_u16_d16_hi v214, v214
    buffer_load_dwordx4 v4, s[20:23], 0 offen offset:0 lds
    v_mfma_f32_16x16x32_f16 v[192:195], a[248:251], v[152:155], 0
    v_mad_u32_u16 v217, v216, 2, s85
    v_mad_u32_u16 v216, v216, 2, s85 op_sel:[1,0,0,0]
    v_pk_lshrrev_b16 v218, 3, v218 op_sel_hi:[0,1]
    v_mfma_f32_16x16x32_f16 v[200:203], a[248:251], v[156:159], 0
    s_waitcnt lgkmcnt(12)
    ds_read_u16 v217, v217
    ds_read_u16_d16_hi v216, v216
    v_mad_u32_u16 v219, v218, 2, s85
    v_mfma_f32_16x16x32_f16 v[176:179], a[232:235], v[136:139], v[176:179]
    s_waitcnt lgkmcnt(12)
    v_mad_u32_u16 v218, v218, 2, s85 op_sel:[1,0,0,0]
    v_or_b32 v240, v252, v251
    v_or_b32 v241, v0, v253
    v_mfma_f32_16x16x32_f16 v[184:187], a[232:235], v[140:143], v[184:187]
    ds_read_u16 v219, v219
    ds_read_u16_d16_hi v218, v218
    v_and_b32 v254, 0x70, v23
    v_mfma_f32_16x16x32_f16 v[196:199], a[252:255], v[152:155], 0
    s_waitcnt lgkmcnt(11)
    v_mad_u64_u32 v[254:255], vcc, v254, 8, s[94:95]
    v_or_b32 v242, v209, v208
    v_mfma_f32_16x16x32_f16 v[204:207], a[252:255], v[156:159], 0
    ds_read_b128 a[248:251], v24 offset:18432
    ds_read_b128 a[252:255], v24 offset:19456
    v_mfma_f32_16x16x32_f16 v[180:183], a[236:239], v[136:139], v[180:183]
    v_mfma_f32_16x16x32_f16 v[188:191], a[236:239], v[140:143], v[188:191]
    v_mfma_f32_16x16x32_f16 v[192:195], a[232:235], v[160:163], v[192:195]
    v_mfma_f32_16x16x32_f16 v[200:203], a[232:235], v[164:167], v[200:203]
    s_waitcnt lgkmcnt(10)
    ds_read_b128 a[232:235], v24 offset:20480
    v_or_b32 v243, v211, v210
    v_mfma_f32_16x16x32_f16 v[176:179], a[240:243], v[144:147], v[176:179]
    v_mfma_f32_16x16x32_f16 v[184:187], a[240:243], v[148:151], v[184:187]
    s_add_u32 m0, s56, 4096
    v_mfma_f32_16x16x32_f16 v[196:199], a[236:239], v[160:163], v[196:199]
    buffer_load_dwordx4 v5, s[20:23], 0 offen offset:0 lds
    v_mfma_f32_16x16x32_f16 v[204:207], a[236:239], v[164:167], v[204:207]
    s_waitcnt lgkmcnt(9)
    ds_read_b128 a[236:239], v24 offset:21504
    v_or_b32 v244, v213, v212
    v_mfma_f32_16x16x32_f16 v[180:183], a[244:247], v[144:147], v[180:183]
    v_cvt_pkrtz_f16_f32 v220, v176, v177
    v_pk_lshrrev_b16 v220, 3, v220 op_sel_hi:[0,1]
    v_mad_u32_u16 v221, v220, 2, s85
    v_mfma_f32_16x16x32_f16 v[188:191], a[244:247], v[148:151], v[188:191]
    s_waitcnt lgkmcnt(8)
    ds_read_u16 v221, v221
    v_or_b32 v245, v215, v214
    v_mad_u32_u16 v220, v220, 2, s85 op_sel:[1,0,0,0]
    v_mfma_f32_16x16x32_f16 v[192:195], a[240:243], v[168:171], v[192:195]
    ds_read_u16_d16_hi v220, v220
    v_cvt_pkrtz_f16_f32 v222, v178, v179
    v_pk_lshrrev_b16 v222, 3, v222 op_sel_hi:[0,1]
    v_mfma_f32_16x16x32_f16 v[200:203], a[240:243], v[172:175], v[200:203]
    ds_read_b128 a[240:243], v24 offset:22528
    v_mad_u32_u16 v223, v222, 2, s85
    v_mad_u32_u16 v222, v222, 2, s85 op_sel:[1,0,0,0]
    v_mfma_f32_16x16x32_f16 v[196:199], a[244:247], v[168:171], v[196:199]
    s_waitcnt lgkmcnt(9)
    ds_read_u16 v223, v223
    ds_read_u16_d16_hi v222, v222
    v_or_b32 v246, v217, v216
    v_mfma_f32_16x16x32_f16 v[204:207], a[244:247], v[172:175], v[204:207]
    s_waitcnt lgkmcnt(9)
    ds_read_b128 a[244:247], v24 offset:23552
    v_cvt_pkrtz_f16_f32 v224, v180, v181
    v_pk_lshrrev_b16 v224, 3, v224 op_sel_hi:[0,1]
    v_mad_u32_u16 v225, v224, 2, s85
    v_mad_u32_u16 v224, v224, 2, s85 op_sel:[1,0,0,0]
    v_cvt_pkrtz_f16_f32 v226, v182, v183
    v_pk_lshrrev_b16 v226, 3, v226 op_sel_hi:[0,1]
    v_or_b32 v247, v219, v218
    v_mad_u32_u16 v227, v226, 2, s85
    v_mad_u32_u16 v226, v226, 2, s85 op_sel:[1,0,0,0]
    v_cvt_pkrtz_f16_f32 v228, v184, v185
    s_waitcnt lgkmcnt(9)
    v_mfma_f32_16x16x32_bf16 v[32:35], a[248:251], v[232:235], v[32:35]
    s_add_u32 m0, s56, 5120
    ds_read_u16 v225, v225
    ds_read_u16_d16_hi v224, v224
    ds_read_u16 v227, v227
    ds_read_u16_d16_hi v226, v226
    v_mfma_f32_16x16x32_bf16 v[40:43], a[248:251], v[236:239], v[40:43]
    s_waitcnt lgkmcnt(12)
    buffer_load_dwordx4 v6, s[20:23], 0 offen offset:0 lds
    v_mfma_f32_16x16x32_bf16 v[36:39], a[252:255], v[232:235], v[36:39]
    v_pk_lshrrev_b16 v228, 3, v228 op_sel_hi:[0,1]
    v_mad_u32_u16 v229, v228, 2, s85
    v_mad_u32_u16 v228, v228, 2, s85 op_sel:[1,0,0,0]
    v_mfma_f32_16x16x32_bf16 v[44:47], a[252:255], v[236:239], v[44:47]
    ds_read_u16 v229, v229
    ds_read_u16_d16_hi v228, v228
    global_load_dword v254, v[254:255], off
    v_mfma_f32_16x16x32_bf16 v[80:83], a[248:251], v[240:243], v[80:83]
    v_cvt_pkrtz_f16_f32 v230, v186, v187
    v_pk_lshrrev_b16 v230, 3, v230 op_sel_hi:[0,1]
    v_mad_u32_u16 v231, v230, 2, s85
    v_mfma_f32_16x16x32_bf16 v[88:91], a[248:251], v[244:247], v[88:91]
    s_waitcnt lgkmcnt(12)
    ds_read_u16 v231, v231
    ds_read_b128 a[248:251], v24 offset:36864
    v_mad_u32_u16 v230, v230, 2, s85 op_sel:[1,0,0,0]
    v_mfma_f32_16x16x32_bf16 v[48:51], a[232:235], v[232:235], v[48:51]
    s_waitcnt lgkmcnt(13)
    ds_read_u16_d16_hi v230, v230
    v_cvt_pkrtz_f16_f32 v248, v188, v189
    v_pk_lshrrev_b16 v248, 3, v248 op_sel_hi:[0,1]
    v_mfma_f32_16x16x32_bf16 v[56:59], a[232:235], v[236:239], v[56:59]
    v_mad_u32_u16 v249, v248, 2, s85
    v_mad_u32_u16 v248, v248, 2, s85 op_sel:[1,0,0,0]
    v_cvt_pkrtz_f16_f32 v252, v190, v191
    v_mfma_f32_16x16x32_bf16 v[84:87], a[252:255], v[240:243], v[84:87]
    s_waitcnt lgkmcnt(12)
    ds_read_u16 v249, v249
    ds_read_u16_d16_hi v248, v248
    v_pk_fma_f16 v250, v252, v252, s53
    v_mfma_f32_16x16x32_bf16 v[92:95], a[252:255], v[244:247], v[92:95]
    s_waitcnt lgkmcnt(13)
    ds_read_b128 a[252:255], v24 offset:37888
    v_pk_mul_f16 v250, v250, v252 neg_lo:[1,0] neg_hi:[1,0]
    v_exp_f16 v251, v250
    v_mfma_f32_16x16x32_bf16 v[52:55], a[236:239], v[232:235], v[52:55]
    v_exp_f16_sdwa v251, v250 dst_sel:WORD_1 dst_unused:UNUSED_PRESERVE src0_sel:WORD_1
    v_cvt_pkrtz_f16_f32 v253, v192, v193
    v_mfma_f32_16x16x32_bf16 v[60:63], a[236:239], v[236:239], v[60:63]
    v_pk_fma_f16 v251, v251, s86, s86
    v_rcp_f16 v250, v251
    v_mfma_f32_16x16x32_bf16 v[96:99], a[232:235], v[240:243], v[96:99]
    v_rcp_f16_sdwa v250, v251 dst_sel:WORD_1 dst_unused:UNUSED_PRESERVE src0_sel:WORD_1
    v_pk_lshrrev_b16 v253, 3, v253 op_sel_hi:[0,1]
    v_mfma_f32_16x16x32_bf16 v[104:107], a[232:235], v[244:247], v[104:107]
    s_waitcnt lgkmcnt(13)
    ds_read_b128 a[232:235], v24 offset:38912
    v_fma_mix_f32 v251, v250, v252, 0 op_sel_hi:[1,1,0]
    v_fma_mix_f32 v250, v250, v252, 0 op_sel:[1,1,0] op_sel_hi:[1,1,0]
    v_mfma_f32_16x16x32_bf16 v[64:67], a[240:243], v[232:235], v[64:67]
    v_cvt_pkrtz_f16_f32 v208, v194, v195
    v_cvt_pkrtz_f16_f32 v210, v196, v197
    v_cvt_pkrtz_f16_f32 v212, v198, v199
    v_mfma_f32_16x16x32_bf16 v[72:75], a[240:243], v[236:239], v[72:75]
    v_cvt_pkrtz_f16_f32 v214, v200, v201
    v_cvt_pkrtz_f16_f32 v216, v202, v203
    v_cvt_pkrtz_f16_f32 v218, v204, v205
    v_mfma_f32_16x16x32_bf16 v[100:103], a[236:239], v[240:243], v[100:103]
    v_mad_u32_u16 v0, v253, 2, s85
    v_mad_u32_u16 v253, v253, 2, s85 op_sel:[1,0,0,0]
    v_pk_lshrrev_b16 v208, 3, v208 op_sel_hi:[0,1]
    v_mfma_f32_16x16x32_bf16 v[108:111], a[236:239], v[244:247], v[108:111]
    s_waitcnt lgkmcnt(11)
    ds_read_b128 a[236:239], v24 offset:39936
    ds_read_u16 v0, v0
    ds_read_u16_d16_hi v253, v253
    v_mfma_f32_16x16x32_bf16 v[68:71], a[244:247], v[232:235], v[68:71]
    v_or_b32 v232, v221, v220
    v_or_b32 v233, v223, v222
    v_or_b32 v234, v225, v224
    v_mfma_f32_16x16x32_bf16 v[76:79], a[244:247], v[236:239], v[76:79]
    s_waitcnt lgkmcnt(10)
    v_or_b32 v235, v227, v226
    v_or_b32 v236, v229, v228
    v_cvt_pk_bf16_f32 v239, v251, v250
    v_mfma_f32_16x16x32_bf16 v[112:115], a[240:243], v[240:243], v[112:115]
    s_waitcnt lgkmcnt(7)
    v_cvt_pkrtz_f16_f32 v220, v206, v207
    v_or_b32 v237, v231, v230
    v_mad_u32_u16 v209, v208, 2, s85
    v_mfma_f32_16x16x32_bf16 v[120:123], a[240:243], v[244:247], v[120:123]
    ds_read_b128 a[240:243], v24 offset:40960
    ds_read_u16 v209, v209
    v_mad_u32_u16 v208, v208, 2, s85 op_sel:[1,0,0,0]
    v_mfma_f32_16x16x32_bf16 v[116:119], a[244:247], v[240:243], v[116:119]
    ds_read_u16_d16_hi v208, v208
    v_pk_lshrrev_b16 v210, 3, v210 op_sel_hi:[0,1]
    v_mad_u32_u16 v211, v210, 2, s85
    v_mfma_f32_16x16x32_bf16 v[124:127], a[244:247], v[244:247], v[124:127]
    s_waitcnt lgkmcnt(8)
    ds_read_b128 a[244:247], v24 offset:41984
    ds_read_u16 v211, v211
    v_or_b32 v238, v249, v248
    v_mfma_f32_16x16x32_f16 v[176:179], a[248:251], v[128:131], 0
    v_mad_u32_u16 v210, v210, 2, s85 op_sel:[1,0,0,0]
    v_pk_lshrrev_b16 v212, 3, v212 op_sel_hi:[0,1]
    v_mad_u32_u16 v213, v212, 2, s85
    v_mfma_f32_16x16x32_f16 v[184:187], a[248:251], v[132:135], 0
    s_waitcnt lgkmcnt(9)
    ds_read_u16_d16_hi v210, v210
    ds_read_u16 v213, v213
    v_mad_u32_u16 v212, v212, 2, s85 op_sel:[1,0,0,0]
    v_mfma_f32_16x16x32_f16 v[180:183], a[252:255], v[128:131], 0
    ds_read_u16_d16_hi v212, v212
    v_pk_lshrrev_b16 v214, 3, v214 op_sel_hi:[0,1]
    v_mad_u32_u16 v215, v214, 2, s85
    v_mfma_f32_16x16x32_f16 v[188:191], a[252:255], v[132:135], 0
    s_add_u32 m0, s56, 6144
    ds_read_u16 v215, v215
    buffer_load_dword v7, s[20:23], 0 offen offset:0 lds
    v_mfma_f32_16x16x32_f16 v[192:195], a[248:251], v[152:155], 0
    v_mad_u32_u16 v214, v214, 2, s85 op_sel:[1,0,0,0]
    v_pk_lshrrev_b16 v216, 3, v216 op_sel_hi:[0,1]
    v_mad_u32_u16 v217, v216, 2, s85
    v_mfma_f32_16x16x32_f16 v[200:203], a[248:251], v[156:159], 0
    s_waitcnt lgkmcnt(11)
    ds_read_u16_d16_hi v214, v214
    ds_read_u16 v217, v217
    ds_read_b128 a[248:251], v24 offset:30720
    v_mfma_f32_16x16x32_f16 v[176:179], a[232:235], v[136:139], v[176:179]
    v_mad_u32_u16 v216, v216, 2, s85 op_sel:[1,0,0,0]
    v_pk_lshrrev_b16 v218, 3, v218 op_sel_hi:[0,1]
    v_mad_u32_u16 v219, v218, 2, s85
    v_mfma_f32_16x16x32_f16 v[184:187], a[232:235], v[140:143], v[184:187]
    s_waitcnt lgkmcnt(12)
    ds_read_u16_d16_hi v216, v216
    ds_read_u16 v219, v219
    v_mad_u32_u16 v218, v218, 2, s85 op_sel:[1,0,0,0]
    v_mfma_f32_16x16x32_f16 v[196:199], a[252:255], v[152:155], 0
    s_waitcnt lgkmcnt(13)
    ds_read_u16_d16_hi v218, v218
    v_pk_lshrrev_b16 v220, 3, v220 op_sel_hi:[0,1]
    v_mad_u32_u16 v221, v220, 2, s85
    v_mfma_f32_16x16x32_f16 v[204:207], a[252:255], v[156:159], 0
    s_waitcnt lgkmcnt(13)
    ds_read_u16 v221, v221
    v_mad_u32_u16 v220, v220, 2, s85 op_sel:[1,0,0,0]
    v_or_b32 v240, v0, v253
    v_mfma_f32_16x16x32_f16 v[180:183], a[236:239], v[136:139], v[180:183]
    s_waitcnt lgkmcnt(13)
    ds_read_u16_d16_hi v220, v220
    v_or_b32 v241, v209, v208
    v_mfma_f32_16x16x32_f16 v[188:191], a[236:239], v[140:143], v[188:191]
    s_waitcnt lgkmcnt(11)
    ds_read_b128 a[252:255], v24 offset:31744
    v_or_b32 v242, v211, v210
    v_mfma_f32_16x16x32_f16 v[192:195], a[232:235], v[160:163], v[192:195]
    v_mfma_f32_16x16x32_f16 v[200:203], a[232:235], v[164:167], v[200:203]
    ds_read_b128 a[232:235], v24 offset:32768
    v_mfma_f32_16x16x32_f16 v[176:179], a[240:243], v[144:147], v[176:179]
    s_waitcnt lgkmcnt(11)
    v_or_b32 v243, v213, v212
    v_mfma_f32_16x16x32_f16 v[184:187], a[240:243], v[148:151], v[184:187]
    v_mfma_f32_16x16x32_f16 v[196:199], a[236:239], v[160:163], v[196:199]
    v_mfma_f32_16x16x32_f16 v[204:207], a[236:239], v[164:167], v[204:207]
    ds_read_b128 a[236:239], v24 offset:33792
    v_mfma_f32_16x16x32_f16 v[180:183], a[244:247], v[144:147], v[180:183]
    s_waitcnt lgkmcnt(10)
    v_or_b32 v244, v215, v214
    v_mfma_f32_16x16x32_f16 v[188:191], a[244:247], v[148:151], v[188:191]
    v_cvt_pkrtz_f16_f32 v222, v176, v177
    v_pk_lshrrev_b16 v222, 3, v222 op_sel_hi:[0,1]
    v_mad_u32_u16 v223, v222, 2, s85
    v_mfma_f32_16x16x32_f16 v[192:195], a[240:243], v[168:171], v[192:195]
    ds_read_u16 v223, v223
    v_mad_u32_u16 v222, v222, 2, s85 op_sel:[1,0,0,0]
    v_cvt_pkrtz_f16_f32 v224, v178, v179
    v_mfma_f32_16x16x32_f16 v[200:203], a[240:243], v[172:175], v[200:203]
    s_waitcnt lgkmcnt(10)
    ds_read_b128 a[240:243], v24 offset:34816
    ds_read_u16_d16_hi v222, v222
    s_waitcnt lgkmcnt(10)
    v_or_b32 v245, v217, v216
    v_mfma_f32_16x16x32_f16 v[196:199], a[244:247], v[168:171], v[196:199]
    v_pk_lshrrev_b16 v224, 3, v224 op_sel_hi:[0,1]
    v_mad_u32_u16 v225, v224, 2, s85
    v_mad_u32_u16 v224, v224, 2, s85 op_sel:[1,0,0,0]
    v_mfma_f32_16x16x32_f16 v[204:207], a[244:247], v[172:175], v[204:207]
    ds_read_b128 a[244:247], v24 offset:35840
    ds_read_u16 v225, v225
    ds_read_u16_d16_hi v224, v224
    v_mfma_f32_16x16x32_bf16 v[32:35], a[248:251], v[232:235], v[32:35]
    s_waitcnt lgkmcnt(11)
    v_cvt_pkrtz_f16_f32 v226, v180, v181
    v_or_b32 v246, v219, v218
    v_pk_lshrrev_b16 v226, 3, v226 op_sel_hi:[0,1]
    v_mfma_f32_16x16x32_bf16 v[40:43], a[248:251], v[236:239], v[40:43]
    v_mad_u32_u16 v227, v226, 2, s85
    v_mad_u32_u16 v226, v226, 2, s85 op_sel:[1,0,0,0]
    v_cvt_pkrtz_f16_f32 v228, v182, v183
    v_pk_lshrrev_b16 v228, 3, v228 op_sel_hi:[0,1]
    v_mad_u32_u16 v229, v228, 2, s85
    v_mad_u32_u16 v228, v228, 2, s85 op_sel:[1,0,0,0]
    v_cvt_pkrtz_f16_f32 v230, v184, v185
    v_pk_lshrrev_b16 v230, 3, v230 op_sel_hi:[0,1]
    v_mad_u32_u16 v231, v230, 2, s85
    s_waitcnt lgkmcnt(9)
    v_or_b32 v247, v221, v220
    v_mad_u32_u16 v230, v230, 2, s85 op_sel:[1,0,0,0]
    v_cvt_pkrtz_f16_f32 v248, v186, v187
    v_pk_lshrrev_b16 v248, 3, v248 op_sel_hi:[0,1]
    s_waitcnt lgkmcnt(8)
    v_mfma_f32_16x16x32_bf16 v[36:39], a[252:255], v[232:235], v[36:39]
    ds_read_u16 v227, v227
    ds_read_u16_d16_hi v226, v226
    ds_read_u16 v229, v229
    ds_read_u16_d16_hi v228, v228
    v_mfma_f32_16x16x32_bf16 v[44:47], a[252:255], v[236:239], v[44:47]
    ds_read_u16 v231, v231
    ds_read_u16_d16_hi v230, v230
    v_mad_u32_u16 v249, v248, 2, s85
    v_mfma_f32_16x16x32_bf16 v[80:83], a[248:251], v[240:243], v[80:83]
    v_mad_u32_u16 v248, v248, 2, s85 op_sel:[1,0,0,0]
    v_cvt_pkrtz_f16_f32 v250, v188, v189
    v_pk_lshrrev_b16 v250, 3, v250 op_sel_hi:[0,1]
    v_mfma_f32_16x16x32_bf16 v[88:91], a[248:251], v[244:247], v[88:91]
    s_waitcnt lgkmcnt(12)
    ds_read_u16 v249, v249
    ds_read_u16_d16_hi v248, v248
    v_mad_u32_u16 v251, v250, 2, s85
    v_mfma_f32_16x16x32_bf16 v[48:51], a[232:235], v[232:235], v[48:51]
    v_mad_u32_u16 v250, v250, 2, s85 op_sel:[1,0,0,0]
    v_cvt_pkrtz_f16_f32 v252, v190, v191
    v_pk_lshrrev_b16 v252, 3, v252 op_sel_hi:[0,1]
    v_mfma_f32_16x16x32_bf16 v[56:59], a[232:235], v[236:239], v[56:59]
    s_waitcnt lgkmcnt(13)
    ds_read_u16 v251, v251
    v_mad_u32_u16 v253, v252, 2, s85
    v_mad_u32_u16 v252, v252, 2, s85 op_sel:[1,0,0,0]
    v_mfma_f32_16x16x32_bf16 v[84:87], a[252:255], v[240:243], v[84:87]
    s_waitcnt lgkmcnt(13)
    ds_read_u16_d16_hi v250, v250
    v_cvt_pkrtz_f16_f32 v0, v192, v193
    v_pk_lshrrev_b16 v0, 3, v0 op_sel_hi:[0,1]
    v_mfma_f32_16x16x32_bf16 v[92:95], a[252:255], v[244:247], v[92:95]
    s_waitcnt lgkmcnt(13)
    ds_read_u16 v253, v253
    v_cvt_pkrtz_f16_f32 v209, v194, v195
    v_cvt_pkrtz_f16_f32 v211, v196, v197
    v_mfma_f32_16x16x32_bf16 v[52:55], a[236:239], v[232:235], v[52:55]
    s_waitcnt lgkmcnt(13)
    ds_read_u16_d16_hi v252, v252
    v_cvt_pkrtz_f16_f32 v213, v198, v199
    v_cvt_pkrtz_f16_f32 v215, v200, v201
    v_mfma_f32_16x16x32_bf16 v[60:63], a[236:239], v[236:239], v[60:63]
    v_cvt_pkrtz_f16_f32 v217, v202, v203
    v_cvt_pkrtz_f16_f32 v219, v204, v205
    v_cvt_pkrtz_f16_f32 v221, v206, v207
    v_mfma_f32_16x16x32_bf16 v[96:99], a[232:235], v[240:243], v[96:99]
    s_waitcnt lgkmcnt(13)
    ds_read_b128 a[248:251], v24 offset:43008
    v_mad_u32_u16 v208, v0, 2, s85
    v_mad_u32_u16 v0, v0, 2, s85 op_sel:[1,0,0,0]
    v_mfma_f32_16x16x32_bf16 v[104:107], a[232:235], v[244:247], v[104:107]
    s_waitcnt lgkmcnt(13)
    ds_read_b128 a[252:255], v24 offset:44032
    buffer_load_dword v254, v31, s[20:23], 0 offen
    v_pk_lshrrev_b16 v209, 3, v209 op_sel_hi:[0,1]
    v_mfma_f32_16x16x32_bf16 v[64:67], a[240:243], v[232:235], v[64:67]
    v_mad_u32_u16 v210, v209, 2, s85
    v_mad_u32_u16 v209, v209, 2, s85 op_sel:[1,0,0,0]
    v_pk_lshrrev_b16 v211, 3, v211 op_sel_hi:[0,1]
    v_mfma_f32_16x16x32_bf16 v[72:75], a[240:243], v[236:239], v[72:75]
    s_waitcnt lgkmcnt(13)
    ds_read_b128 a[232:235], v24 offset:45056
    v_mad_u32_u16 v212, v211, 2, s85
    v_mad_u32_u16 v211, v211, 2, s85 op_sel:[1,0,0,0]
    v_mfma_f32_16x16x32_bf16 v[100:103], a[236:239], v[240:243], v[100:103]
    s_waitcnt lgkmcnt(13)
    ds_read_u16 v208, v208
    v_pk_lshrrev_b16 v213, 3, v213 op_sel_hi:[0,1]
    v_mad_u32_u16 v214, v213, 2, s85
    v_mfma_f32_16x16x32_bf16 v[108:111], a[236:239], v[244:247], v[108:111]
    s_waitcnt lgkmcnt(13)
    ds_read_b128 a[236:239], v24 offset:46080
    v_mad_u32_u16 v213, v213, 2, s85 op_sel:[1,0,0,0]
    v_pk_lshrrev_b16 v215, 3, v215 op_sel_hi:[0,1]
    v_mfma_f32_16x16x32_bf16 v[68:71], a[244:247], v[232:235], v[68:71]
    v_or_b32 v232, v223, v222
    v_or_b32 v233, v225, v224
    v_or_b32 v234, v227, v226
    v_mfma_f32_16x16x32_bf16 v[76:79], a[244:247], v[236:239], v[76:79]
    s_waitcnt lgkmcnt(11)
    ds_read_u16_d16_hi v0, v0
    v_or_b32 v235, v229, v228
    v_or_b32 v236, v231, v230
    v_mfma_f32_16x16x32_bf16 v[112:115], a[240:243], v[240:243], v[112:115]
    ds_read_u16 v210, v210
    v_mad_u32_u16 v216, v215, 2, s85
    v_mad_u32_u16 v215, v215, 2, s85 op_sel:[1,0,0,0]
    v_mfma_f32_16x16x32_bf16 v[120:123], a[240:243], v[244:247], v[120:123]
    s_waitcnt lgkmcnt(11)
    ds_read_b128 a[240:243], v24 offset:47104
    v_or_b32 v237, v249, v248
    v_pk_lshrrev_b16 v217, 3, v217 op_sel_hi:[0,1]
    v_mfma_f32_16x16x32_bf16 v[116:119], a[244:247], v[240:243], v[116:119]
    v_mad_u32_u16 v218, v217, 2, s85
    v_mad_u32_u16 v217, v217, 2, s85 op_sel:[1,0,0,0]
    v_pk_lshrrev_b16 v219, 3, v219 op_sel_hi:[0,1]
    v_mfma_f32_16x16x32_bf16 v[124:127], a[244:247], v[244:247], v[124:127]
    ds_read_b128 a[244:247], v24 offset:48128
    v_mad_u32_u16 v220, v219, 2, s85
    v_mad_u32_u16 v219, v219, 2, s85 op_sel:[1,0,0,0]
    v_mfma_f32_16x16x32_f16 v[176:179], a[0:3], v[128:131], 0
    s_waitcnt lgkmcnt(11)
    ds_read_u16_d16_hi v209, v209
    v_or_b32 v238, v251, v250
    v_pk_lshrrev_b16 v221, 3, v221 op_sel_hi:[0,1]
    v_mad_u32_u16 v222, v221, 2, s85
    v_mad_u32_u16 v221, v221, 2, s85 op_sel:[1,0,0,0]
    ds_read_u16 v212, v212
    s_waitcnt lgkmcnt(11)
    v_or_b32 v239, v253, v252
    s_waitcnt lgkmcnt(10)
    v_mfma_f32_16x16x32_bf16 v[32:35], a[248:251], v[232:235], v[32:35]
    ds_read_u16_d16_hi v211, v211
    ds_read_u16 v214, v214
    ds_read_u16_d16_hi v213, v213
    v_mfma_f32_16x16x32_f16 v[180:183], a[4:7], v[128:131], 0
    s_waitcnt lgkmcnt(12)
    v_mfma_f32_16x16x32_bf16 v[36:39], a[252:255], v[232:235], v[36:39]
    ds_read_u16 v216, v216
    v_mfma_f32_16x16x32_f16 v[176:179], a[8:11], v[136:139], v[176:179]
    s_waitcnt lgkmcnt(12)
    ds_read_u16_d16_hi v215, v215
    v_mfma_f32_16x16x32_bf16 v[48:51], a[232:235], v[232:235], v[48:51]
    ds_read_u16 v218, v218
    v_mfma_f32_16x16x32_f16 v[180:183], a[12:15], v[136:139], v[180:183]
    s_waitcnt lgkmcnt(12)
    v_mfma_f32_16x16x32_bf16 v[52:55], a[236:239], v[232:235], v[52:55]
    s_waitcnt lgkmcnt(11)
    ds_read_u16_d16_hi v217, v217
    v_or_b32 v240, v208, v0
    v_mfma_f32_16x16x32_f16 v[176:179], a[16:19], v[144:147], v[176:179]
    ds_read_u16 v220, v220
    s_waitcnt lgkmcnt(11)
    v_mfma_f32_16x16x32_bf16 v[64:67], a[240:243], v[232:235], v[64:67]
    ds_read_u16_d16_hi v219, v219
    v_mfma_f32_16x16x32_f16 v[180:183], a[20:23], v[144:147], v[180:183]
    s_waitcnt lgkmcnt(11)
    ds_read_u16 v222, v222
    v_mfma_f32_16x16x32_bf16 v[68:71], a[244:247], v[232:235], v[68:71]
    s_waitcnt lgkmcnt(11)
    ds_read_u16_d16_hi v221, v221
    v_or_b32 v241, v210, v209
    v_mfma_f32_16x16x32_f16 v[184:187], a[0:3], v[132:135], 0
    v_cvt_pkrtz_f16_f32 v223, v176, v177
    v_pk_lshrrev_b16 v223, 3, v223 op_sel_hi:[0,1]
    v_mad_u32_u16 v224, v223, 2, s85
    v_mfma_f32_16x16x32_bf16 v[40:43], a[248:251], v[236:239], v[40:43]
    ds_read_u16 v224, v224
    v_mad_u32_u16 v223, v223, 2, s85 op_sel:[1,0,0,0]
    v_cvt_pkrtz_f16_f32 v225, v178, v179
    v_mfma_f32_16x16x32_f16 v[188:191], a[4:7], v[132:135], 0
    s_waitcnt lgkmcnt(11)
    ds_read_u16_d16_hi v223, v223
    v_or_b32 v242, v212, v211
    v_pk_lshrrev_b16 v225, 3, v225 op_sel_hi:[0,1]
    v_mfma_f32_16x16x32_bf16 v[44:47], a[252:255], v[236:239], v[44:47]
    v_mad_u32_u16 v226, v225, 2, s85
    v_mad_u32_u16 v225, v225, 2, s85 op_sel:[1,0,0,0]
    v_cvt_pkrtz_f16_f32 v227, v180, v181
    v_mfma_f32_16x16x32_f16 v[184:187], a[8:11], v[140:143], v[184:187]
    ds_read_u16 v226, v226
    v_pk_lshrrev_b16 v227, 3, v227 op_sel_hi:[0,1]
    v_mad_u32_u16 v228, v227, 2, s85
    v_mfma_f32_16x16x32_bf16 v[56:59], a[232:235], v[236:239], v[56:59]
    s_waitcnt lgkmcnt(11)
    ds_read_u16_d16_hi v225, v225
    v_or_b32 v243, v214, v213
    v_mad_u32_u16 v227, v227, 2, s85 op_sel:[1,0,0,0]
    v_mfma_f32_16x16x32_f16 v[188:191], a[12:15], v[140:143], v[188:191]
    ds_read_u16 v228, v228
    v_cvt_pkrtz_f16_f32 v229, v182, v183
    v_pk_lshrrev_b16 v229, 3, v229 op_sel_hi:[0,1]
    v_mfma_f32_16x16x32_bf16 v[60:63], a[236:239], v[236:239], v[60:63]
    s_waitcnt lgkmcnt(12)
    v_mad_u32_u16 v230, v229, 2, s85
    v_mad_u32_u16 v229, v229, 2, s85 op_sel:[1,0,0,0]
    s_waitcnt lgkmcnt(11)
    v_or_b32 v244, v216, v215
    v_mfma_f32_16x16x32_f16 v[184:187], a[16:19], v[148:151], v[184:187]
    ds_read_u16_d16_hi v227, v227
    v_mfma_f32_16x16x32_f16 v[188:191], a[20:23], v[148:151], v[188:191]
    ds_read_u16 v230, v230
    v_mfma_f32_16x16x32_bf16 v[72:75], a[240:243], v[236:239], v[72:75]
    v_mfma_f32_16x16x32_bf16 v[76:79], a[244:247], v[236:239], v[76:79]
    s_waitcnt lgkmcnt(11)
    ds_read_u16_d16_hi v229, v229
    v_or_b32 v245, v218, v217
    v_mfma_f32_16x16x32_f16 v[176:179], a[48:51], v[128:131], 0
    v_cvt_pkrtz_f16_f32 v231, v184, v185
    v_pk_lshrrev_b16 v231, 3, v231 op_sel_hi:[0,1]
    v_mad_u32_u16 v248, v231, 2, s85
    v_mfma_f32_16x16x32_bf16 v[80:83], a[248:251], v[240:243], v[80:83]
    ds_read_u16 v248, v248
    v_mad_u32_u16 v231, v231, 2, s85 op_sel:[1,0,0,0]
    v_cvt_pkrtz_f16_f32 v249, v186, v187
    v_mfma_f32_16x16x32_f16 v[180:183], a[52:55], v[128:131], 0
    s_waitcnt lgkmcnt(11)
    ds_read_u16_d16_hi v231, v231
    v_or_b32 v246, v220, v219
    v_pk_lshrrev_b16 v249, 3, v249 op_sel_hi:[0,1]
    v_mfma_f32_16x16x32_bf16 v[84:87], a[252:255], v[240:243], v[84:87]
    v_mad_u32_u16 v250, v249, 2, s85
    v_mad_u32_u16 v249, v249, 2, s85 op_sel:[1,0,0,0]
    v_cvt_pkrtz_f16_f32 v251, v188, v189
    v_mfma_f32_16x16x32_f16 v[176:179], a[56:59], v[136:139], v[176:179]
    s_waitcnt lgkmcnt(10)
    ds_read_u16 v250, v250
    ds_read_u16_d16_hi v249, v249
    v_or_b32 v247, v222, v221
    v_mfma_f32_16x16x32_bf16 v[96:99], a[232:235], v[240:243], v[96:99]
    v_pk_lshrrev_b16 v251, 3, v251 op_sel_hi:[0,1]
    v_mad_u32_u16 v252, v251, 2, s85
    v_mad_u32_u16 v251, v251, 2, s85 op_sel:[1,0,0,0]
    v_mfma_f32_16x16x32_f16 v[180:183], a[60:63], v[136:139], v[180:183]
    ds_read_u16 v252, v252
    v_cvt_pkrtz_f16_f32 v253, v190, v191
    v_pk_lshrrev_b16 v253, 3, v253 op_sel_hi:[0,1]
    v_mfma_f32_16x16x32_bf16 v[100:103], a[236:239], v[240:243], v[100:103]
    ds_read_u16_d16_hi v251, v251
    v_mad_u32_u16 v0, v253, 2, s85
    v_mad_u32_u16 v253, v253, 2, s85 op_sel:[1,0,0,0]
    v_mfma_f32_16x16x32_f16 v[176:179], a[64:67], v[144:147], v[176:179]
    s_waitcnt lgkmcnt(12)
    v_or_b32 v232, v224, v223
    v_mfma_f32_16x16x32_bf16 v[112:115], a[240:243], v[240:243], v[112:115]
    ds_read_u16 v0, v0
    v_mfma_f32_16x16x32_f16 v[180:183], a[68:71], v[144:147], v[180:183]
    s_waitcnt lgkmcnt(11)
    ds_read_u16_d16_hi v253, v253
    v_or_b32 v233, v226, v225
    v_mfma_f32_16x16x32_bf16 v[116:119], a[244:247], v[240:243], v[116:119]
    v_cvt_pkrtz_f16_f32 v208, v176, v177
    v_pk_lshrrev_b16 v208, 3, v208 op_sel_hi:[0,1]
    v_mad_u32_u16 v209, v208, 2, s85
    v_mfma_f32_16x16x32_f16 v[184:187], a[48:51], v[132:135], 0
    ds_read_u16 v209, v209
    v_mad_u32_u16 v208, v208, 2, s85 op_sel:[1,0,0,0]
    v_cvt_pkrtz_f16_f32 v210, v178, v179
    v_mfma_f32_16x16x32_bf16 v[88:91], a[248:251], v[244:247], v[88:91]
    s_waitcnt lgkmcnt(11)
    ds_read_u16_d16_hi v208, v208
    v_or_b32 v234, v228, v227
    v_pk_lshrrev_b16 v210, 3, v210 op_sel_hi:[0,1]
    v_mfma_f32_16x16x32_f16 v[188:191], a[52:55], v[132:135], 0
    v_mad_u32_u16 v211, v210, 2, s85
    v_mad_u32_u16 v210, v210, 2, s85 op_sel:[1,0,0,0]
    v_cvt_pkrtz_f16_f32 v212, v180, v181
    v_mfma_f32_16x16x32_bf16 v[92:95], a[252:255], v[244:247], v[92:95]
    ds_read_u16 v211, v211
    v_pk_lshrrev_b16 v212, 3, v212 op_sel_hi:[0,1]
    v_mad_u32_u16 v213, v212, 2, s85
    v_mfma_f32_16x16x32_f16 v[184:187], a[56:59], v[140:143], v[184:187]
    s_waitcnt lgkmcnt(11)
    ds_read_u16_d16_hi v210, v210
    v_or_b32 v235, v230, v229
    v_mad_u32_u16 v212, v212, 2, s85 op_sel:[1,0,0,0]
    v_mfma_f32_16x16x32_bf16 v[104:107], a[232:235], v[244:247], v[104:107]
    ds_read_u16 v213, v213
    v_cvt_pkrtz_f16_f32 v214, v182, v183
    v_pk_lshrrev_b16 v214, 3, v214 op_sel_hi:[0,1]
    v_mfma_f32_16x16x32_f16 v[188:191], a[60:63], v[140:143], v[188:191]
    s_waitcnt lgkmcnt(12)
    v_mad_u32_u16 v215, v214, 2, s85
    v_mad_u32_u16 v214, v214, 2, s85 op_sel:[1,0,0,0]
    s_waitcnt lgkmcnt(11)
    v_or_b32 v236, v248, v231
    v_mfma_f32_16x16x32_bf16 v[108:111], a[236:239], v[244:247], v[108:111]
    ds_read_u16_d16_hi v212, v212
    v_mfma_f32_16x16x32_f16 v[184:187], a[64:67], v[148:151], v[184:187]
    ds_read_u16 v215, v215
    v_mfma_f32_16x16x32_f16 v[188:191], a[68:71], v[148:151], v[188:191]
    v_mfma_f32_16x16x32_bf16 v[120:123], a[240:243], v[244:247], v[120:123]
    s_waitcnt lgkmcnt(11)
    ds_read_u16_d16_hi v214, v214
    v_or_b32 v237, v250, v249
    v_mfma_f32_16x16x32_bf16 v[124:127], a[244:247], v[244:247], v[124:127]
    s_nop 0
    v_cvt_pkrtz_f16_f32 v216, v184, v185
    v_pk_lshrrev_b16 v216, 3, v216 op_sel_hi:[0,1]
    v_mfma_f32_16x16x32_f16 v[176:179], a[96:99], v[128:131], 0
    v_mad_u32_u16 v217, v216, 2, s85
    v_mad_u32_u16 v216, v216, 2, s85 op_sel:[1,0,0,0]
    v_cvt_pkrtz_f16_f32 v218, v186, v187
    v_mfma_f32_16x16x32_bf16 v[32:35], a[24:27], v[232:235], v[32:35]
    s_waitcnt lgkmcnt(10)
    ds_read_u16 v217, v217
    ds_read_u16_d16_hi v216, v216
    v_or_b32 v238, v252, v251
    v_mfma_f32_16x16x32_f16 v[180:183], a[100:103], v[128:131], 0
    v_pk_lshrrev_b16 v218, 3, v218 op_sel_hi:[0,1]
    v_mad_u32_u16 v219, v218, 2, s85
    v_mad_u32_u16 v218, v218, 2, s85 op_sel:[1,0,0,0]
    v_mfma_f32_16x16x32_bf16 v[36:39], a[28:31], v[232:235], v[36:39]
    s_waitcnt lgkmcnt(10)
    ds_read_u16 v219, v219
    ds_read_u16_d16_hi v218, v218
    v_or_b32 v239, v0, v253
    v_mfma_f32_16x16x32_f16 v[176:179], a[104:107], v[136:139], v[176:179]
    v_cvt_pkrtz_f16_f32 v220, v188, v189
    v_pk_lshrrev_b16 v220, 3, v220 op_sel_hi:[0,1]
    v_mad_u32_u16 v221, v220, 2, s85
    v_mfma_f32_16x16x32_bf16 v[48:51], a[32:35], v[232:235], v[48:51]
    ds_read_u16 v221, v221
    v_mad_u32_u16 v220, v220, 2, s85 op_sel:[1,0,0,0]
    v_cvt_pkrtz_f16_f32 v222, v190, v191
    v_mfma_f32_16x16x32_f16 v[180:183], a[108:111], v[136:139], v[180:183]
    ds_read_u16_d16_hi v220, v220
    v_pk_lshrrev_b16 v222, 3, v222 op_sel_hi:[0,1]
    v_mad_u32_u16 v223, v222, 2, s85
    v_mfma_f32_16x16x32_bf16 v[52:55], a[36:39], v[232:235], v[52:55]
    v_mad_u32_u16 v222, v222, 2, s85 op_sel:[1,0,0,0]
    v_mfma_f32_16x16x32_f16 v[176:179], a[112:115], v[144:147], v[176:179]
    s_waitcnt lgkmcnt(13)
    ds_read_u16 v223, v223
    v_mfma_f32_16x16x32_bf16 v[64:67], a[40:43], v[232:235], v[64:67]
    s_waitcnt lgkmcnt(13)
    ds_read_u16_d16_hi v222, v222
    v_mfma_f32_16x16x32_f16 v[180:183], a[116:119], v[144:147], v[180:183]
    v_mfma_f32_16x16x32_bf16 v[68:71], a[44:47], v[232:235], v[68:71]
    s_waitcnt lgkmcnt(12)
    v_or_b32 v232, v209, v208
    v_or_b32 v233, v211, v210
    v_mfma_f32_16x16x32_f16 v[184:187], a[96:99], v[132:135], 0
    s_waitcnt lgkmcnt(11)
    v_cvt_pkrtz_f16_f32 v224, v176, v177
    v_pk_lshrrev_b16 v224, 3, v224 op_sel_hi:[0,1]
    s_waitcnt lgkmcnt(10)
    v_or_b32 v234, v213, v212
    v_mfma_f32_16x16x32_bf16 v[40:43], a[24:27], v[236:239], v[40:43]
    v_mad_u32_u16 v225, v224, 2, s85
    v_mad_u32_u16 v224, v224, 2, s85 op_sel:[1,0,0,0]
    v_cvt_pkrtz_f16_f32 v226, v178, v179
    v_mfma_f32_16x16x32_f16 v[188:191], a[100:103], v[132:135], 0
    ds_read_u16 v225, v225
    ds_read_u16_d16_hi v224, v224
    v_pk_lshrrev_b16 v226, 3, v226 op_sel_hi:[0,1]
    v_mfma_f32_16x16x32_bf16 v[44:47], a[28:31], v[236:239], v[44:47]
    s_waitcnt lgkmcnt(10)
    v_or_b32 v235, v215, v214
    v_mad_u32_u16 v227, v226, 2, s85
    v_mad_u32_u16 v226, v226, 2, s85 op_sel:[1,0,0,0]
    v_mfma_f32_16x16x32_f16 v[184:187], a[104:107], v[140:143], v[184:187]
    ds_read_u16 v227, v227
    ds_read_u16_d16_hi v226, v226
    v_cvt_pkrtz_f16_f32 v228, v180, v181
    v_mfma_f32_16x16x32_bf16 v[56:59], a[32:35], v[236:239], v[56:59]
    v_pk_lshrrev_b16 v228, 3, v228 op_sel_hi:[0,1]
    v_mad_u32_u16 v229, v228, 2, s85
    v_mad_u32_u16 v228, v228, 2, s85 op_sel:[1,0,0,0]
    v_mfma_f32_16x16x32_f16 v[188:191], a[108:111], v[140:143], v[188:191]
    ds_read_u16 v229, v229
    ds_read_u16_d16_hi v228, v228
    v_cvt_pkrtz_f16_f32 v230, v182, v183
    v_mfma_f32_16x16x32_bf16 v[60:63], a[36:39], v[236:239], v[60:63]
    v_pk_lshrrev_b16 v230, 3, v230 op_sel_hi:[0,1]
    v_mad_u32_u16 v231, v230, 2, s85
    v_mad_u32_u16 v230, v230, 2, s85 op_sel:[1,0,0,0]
    v_mfma_f32_16x16x32_f16 v[184:187], a[112:115], v[148:151], v[184:187]
    s_waitcnt lgkmcnt(13)
    ds_read_u16 v231, v231
    v_mfma_f32_16x16x32_f16 v[188:191], a[116:119], v[148:151], v[188:191]
    s_waitcnt lgkmcnt(13)
    ds_read_u16_d16_hi v230, v230
    v_mfma_f32_16x16x32_bf16 v[72:75], a[40:43], v[236:239], v[72:75]
    v_mfma_f32_16x16x32_bf16 v[76:79], a[44:47], v[236:239], v[76:79]
    s_waitcnt lgkmcnt(12)
    v_or_b32 v236, v217, v216
    v_or_b32 v237, v219, v218
    v_mfma_f32_16x16x32_f16 v[176:179], a[144:147], v[128:131], 0
    s_waitcnt lgkmcnt(10)
    v_or_b32 v238, v221, v220
    v_cvt_pkrtz_f16_f32 v248, v184, v185
    v_pk_lshrrev_b16 v248, 3, v248 op_sel_hi:[0,1]
    v_mfma_f32_16x16x32_bf16 v[32:35], a[72:75], v[232:235], v[32:35]
    v_mad_u32_u16 v249, v248, 2, s85
    v_mad_u32_u16 v248, v248, 2, s85 op_sel:[1,0,0,0]
    v_cvt_pkrtz_f16_f32 v250, v186, v187
    v_mfma_f32_16x16x32_f16 v[180:183], a[148:151], v[128:131], 0
    ds_read_u16 v249, v249
    ds_read_u16_d16_hi v248, v248
    v_pk_lshrrev_b16 v250, 3, v250 op_sel_hi:[0,1]
    v_mfma_f32_16x16x32_bf16 v[36:39], a[76:79], v[232:235], v[36:39]
    s_waitcnt lgkmcnt(10)
    v_or_b32 v239, v223, v222
    v_mad_u32_u16 v251, v250, 2, s85
    v_mad_u32_u16 v250, v250, 2, s85 op_sel:[1,0,0,0]
    v_mfma_f32_16x16x32_f16 v[176:179], a[152:155], v[136:139], v[176:179]
    ds_read_u16 v251, v251
    ds_read_u16_d16_hi v250, v250
    v_cvt_pkrtz_f16_f32 v252, v188, v189
    v_mfma_f32_16x16x32_bf16 v[48:51], a[80:83], v[232:235], v[48:51]
    v_pk_lshrrev_b16 v252, 3, v252 op_sel_hi:[0,1]
    v_mad_u32_u16 v253, v252, 2, s85
    v_mad_u32_u16 v252, v252, 2, s85 op_sel:[1,0,0,0]
    v_mfma_f32_16x16x32_f16 v[180:183], a[156:159], v[136:139], v[180:183]
    ds_read_u16 v253, v253
    ds_read_u16_d16_hi v252, v252
    v_cvt_pkrtz_f16_f32 v209, v190, v191
    v_mfma_f32_16x16x32_bf16 v[52:55], a[84:87], v[232:235], v[52:55]
    v_pk_fma_f16 v0, v209, v209, s53
    v_pk_mul_f16 v0, v0, v209 neg_lo:[1,0] neg_hi:[1,0]
    v_exp_f16 v208, v0
    v_mfma_f32_16x16x32_f16 v[176:179], a[160:163], v[144:147], v[176:179]
    v_exp_f16_sdwa v208, v0 dst_sel:WORD_1 dst_unused:UNUSED_PRESERVE src0_sel:WORD_1
    v_mfma_f32_16x16x32_bf16 v[64:67], a[88:91], v[232:235], v[64:67]
    v_pk_fma_f16 v208, v208, s86, s86
    v_rcp_f16 v0, v208
    v_mfma_f32_16x16x32_f16 v[180:183], a[164:167], v[144:147], v[180:183]
    v_rcp_f16_sdwa v0, v208 dst_sel:WORD_1 dst_unused:UNUSED_PRESERVE src0_sel:WORD_1
    v_mfma_f32_16x16x32_bf16 v[68:71], a[92:95], v[232:235], v[68:71]
    s_waitcnt lgkmcnt(12)
    v_fma_mix_f32 v208, v0, v209, 0 op_sel_hi:[1,1,0]
    v_fma_mix_f32 v0, v0, v209, 0 op_sel:[1,1,0] op_sel_hi:[1,1,0]
    v_or_b32 v232, v225, v224
    v_mfma_f32_16x16x32_f16 v[184:187], a[144:147], v[132:135], 0
    s_waitcnt lgkmcnt(8)
    v_or_b32 v233, v227, v226
    v_or_b32 v234, v229, v228
    v_cvt_pkrtz_f16_f32 v210, v176, v177
    v_mfma_f32_16x16x32_bf16 v[40:43], a[72:75], v[236:239], v[40:43]
    v_pk_lshrrev_b16 v210, 3, v210 op_sel_hi:[0,1]
    v_mad_u32_u16 v211, v210, 2, s85
    v_mad_u32_u16 v210, v210, 2, s85 op_sel:[1,0,0,0]
    v_mfma_f32_16x16x32_f16 v[188:191], a[148:151], v[132:135], 0
    s_waitcnt lgkmcnt(6)
    ds_read_u16 v211, v211
    ds_read_u16_d16_hi v210, v210
    v_or_b32 v235, v231, v230
    v_mfma_f32_16x16x32_bf16 v[44:47], a[76:79], v[236:239], v[44:47]
    s_waitcnt vmcnt(1)
    ds_read_b128 a[232:235], v8 offset:0
    v_cvt_pkrtz_f16_f32 v212, v178, v179
    v_pk_lshrrev_b16 v212, 3, v212 op_sel_hi:[0,1]
    v_mfma_f32_16x16x32_f16 v[184:187], a[152:155], v[140:143], v[184:187]
    v_mad_u32_u16 v213, v212, 2, s85
    v_mad_u32_u16 v212, v212, 2, s85 op_sel:[1,0,0,0]
    v_cvt_pkrtz_f16_f32 v214, v180, v181
    v_mfma_f32_16x16x32_bf16 v[56:59], a[80:83], v[236:239], v[56:59]
    ds_read_u16 v213, v213
    ds_read_u16_d16_hi v212, v212
    v_pk_lshrrev_b16 v214, 3, v214 op_sel_hi:[0,1]
    v_mfma_f32_16x16x32_f16 v[188:191], a[156:159], v[140:143], v[188:191]
    v_mad_u32_u16 v215, v214, 2, s85
    v_mad_u32_u16 v214, v214, 2, s85 op_sel:[1,0,0,0]
    v_cvt_pkrtz_f16_f32 v216, v182, v183
    v_mfma_f32_16x16x32_bf16 v[60:63], a[84:87], v[236:239], v[60:63]
    ds_read_u16 v215, v215
    ds_read_u16_d16_hi v214, v214
    v_pk_lshrrev_b16 v216, 3, v216 op_sel_hi:[0,1]
    v_mfma_f32_16x16x32_f16 v[184:187], a[160:163], v[148:151], v[184:187]
    v_mad_u32_u16 v217, v216, 2, s85
    v_mad_u32_u16 v216, v216, 2, s85 op_sel:[1,0,0,0]
    v_mfma_f32_16x16x32_f16 v[188:191], a[164:167], v[148:151], v[188:191]
    s_waitcnt lgkmcnt(12)
    ds_read_u16 v217, v217
    ds_read_u16_d16_hi v216, v216
    v_mfma_f32_16x16x32_bf16 v[72:75], a[88:91], v[236:239], v[72:75]
    s_nop 0
    v_cvt_pkrtz_f16_f32 v218, v184, v185
    v_pk_lshrrev_b16 v218, 3, v218 op_sel_hi:[0,1]
    v_mfma_f32_16x16x32_bf16 v[76:79], a[92:95], v[236:239], v[76:79]
    s_waitcnt lgkmcnt(9)
    v_or_b32 v236, v249, v248
    v_or_b32 v237, v251, v250
    v_or_b32 v238, v253, v252
    v_mfma_f32_16x16x32_f16 v[192:195], a[0:3], v[152:155], 0
    v_cvt_pk_bf16_f32 v239, v208, v0
    v_mad_u32_u16 v219, v218, 2, s85
    v_mad_u32_u16 v218, v218, 2, s85 op_sel:[1,0,0,0]
    v_mfma_f32_16x16x32_bf16 v[32:35], a[120:123], v[232:235], v[32:35]
    ds_read_u16 v219, v219
    ds_read_u16_d16_hi v218, v218
    v_cvt_pkrtz_f16_f32 v220, v186, v187
    v_mfma_f32_16x16x32_f16 v[196:199], a[4:7], v[152:155], 0
    ds_read_b128 a[248:251], v12 offset:2560
    v_pk_lshrrev_b16 v220, 3, v220 op_sel_hi:[0,1]
    v_mad_u32_u16 v221, v220, 2, s85
    v_mfma_f32_16x16x32_bf16 v[36:39], a[124:127], v[232:235], v[36:39]
    ds_read_u16 v221, v221
    v_mad_u32_u16 v220, v220, 2, s85 op_sel:[1,0,0,0]
    v_cvt_pkrtz_f16_f32 v222, v188, v189
    v_mfma_f32_16x16x32_f16 v[192:195], a[8:11], v[160:163], v[192:195]
    ds_read_u16_d16_hi v220, v220
    v_pk_lshrrev_b16 v222, 3, v222 op_sel_hi:[0,1]
    v_mad_u32_u16 v223, v222, 2, s85
    v_mfma_f32_16x16x32_bf16 v[48:51], a[128:131], v[232:235], v[48:51]
    s_waitcnt lgkmcnt(12)
    ds_read_u16 v223, v223
    ds_read_b128 a[240:243], v15 offset:1280
    v_mad_u32_u16 v222, v222, 2, s85 op_sel:[1,0,0,0]
    v_mfma_f32_16x16x32_f16 v[196:199], a[12:15], v[160:163], v[196:199]
    s_waitcnt lgkmcnt(13)
    ds_read_u16_d16_hi v222, v222
    v_cvt_pkrtz_f16_f32 v224, v190, v191
    v_pk_lshrrev_b16 v224, 3, v224 op_sel_hi:[0,1]
    v_mfma_f32_16x16x32_bf16 v[52:55], a[132:135], v[232:235], v[52:55]
    v_mad_u32_u16 v225, v224, 2, s85
    v_mad_u32_u16 v224, v224, 2, s85 op_sel:[1,0,0,0]
    v_mfma_f32_16x16x32_f16 v[192:195], a[16:19], v[168:171], v[192:195]
    s_waitcnt lgkmcnt(12)
    ds_read_u16 v225, v225
    ds_read_u16_d16_hi v224, v224
    v_mfma_f32_16x16x32_bf16 v[64:67], a[136:139], v[232:235], v[64:67]
    v_mfma_f32_16x16x32_f16 v[196:199], a[20:23], v[168:171], v[196:199]
    v_mfma_f32_16x16x32_bf16 v[68:71], a[140:143], v[232:235], v[68:71]
    s_waitcnt lgkmcnt(13)
    ds_read_b128 a[244:247], v8 offset:2560
    v_or_b32 v232, v211, v210
    v_or_b32 v233, v213, v212
    v_mfma_f32_16x16x32_f16 v[200:203], a[0:3], v[156:159], 0
    s_waitcnt lgkmcnt(11)
    v_or_b32 v234, v215, v214
    v_or_b32 v235, v217, v216
    v_cvt_pkrtz_f16_f32 v226, v192, v193
    v_mfma_f32_16x16x32_bf16 v[40:43], a[120:123], v[236:239], v[40:43]
    ds_read_b128 a[252:255], v15 offset:3840
    v_pk_lshrrev_b16 v226, 3, v226 op_sel_hi:[0,1]
    v_cvt_pkrtz_f16_f32 v228, v194, v195
    v_mfma_f32_16x16x32_f16 v[204:207], a[4:7], v[156:159], 0
    v_cvt_pkrtz_f16_f32 v230, v196, v197
    v_cvt_pkrtz_f16_f32 v248, v198, v199
    v_mad_u32_u16 v227, v226, 2, s85
    v_mfma_f32_16x16x32_bf16 v[44:47], a[124:127], v[236:239], v[44:47]
    ds_read_u16 v227, v227
    v_mad_u32_u16 v226, v226, 2, s85 op_sel:[1,0,0,0]
    v_pk_lshrrev_b16 v228, 3, v228 op_sel_hi:[0,1]
    v_mfma_f32_16x16x32_f16 v[200:203], a[8:11], v[164:167], v[200:203]
    ds_read_u16_d16_hi v226, v226
    v_mad_u32_u16 v229, v228, 2, s85
    v_mad_u32_u16 v228, v228, 2, s85 op_sel:[1,0,0,0]
    v_mfma_f32_16x16x32_bf16 v[56:59], a[128:131], v[236:239], v[56:59]
    s_waitcnt lgkmcnt(12)
    ds_read_u16 v229, v229
    ds_read_u16_d16_hi v228, v228
    v_pk_lshrrev_b16 v230, 3, v230 op_sel_hi:[0,1]
    v_mfma_f32_16x16x32_f16 v[204:207], a[12:15], v[164:167], v[204:207]
    s_waitcnt lgkmcnt(13)
    ds_read_b128 v[136:139], v11 offset:0
    v_mad_u32_u16 v231, v230, 2, s85
    v_mad_u32_u16 v230, v230, 2, s85 op_sel:[1,0,0,0]
    v_mfma_f32_16x16x32_bf16 v[60:63], a[132:135], v[236:239], v[60:63]
    s_waitcnt lgkmcnt(12)
    ds_read_u16 v231, v231
    ds_read_u16_d16_hi v230, v230
    v_pk_lshrrev_b16 v248, 3, v248 op_sel_hi:[0,1]
    v_mfma_f32_16x16x32_f16 v[200:203], a[16:19], v[172:175], v[200:203]
    v_mad_u32_u16 v249, v248, 2, s85
    v_mad_u32_u16 v248, v248, 2, s85 op_sel:[1,0,0,0]
    v_mfma_f32_16x16x32_f16 v[204:207], a[20:23], v[172:175], v[204:207]
    s_waitcnt lgkmcnt(13)
    ds_read_u16 v249, v249
    v_mfma_f32_16x16x32_bf16 v[72:75], a[136:139], v[236:239], v[72:75]
    s_waitcnt lgkmcnt(13)
    ds_read_u16_d16_hi v248, v248
    v_mfma_f32_16x16x32_bf16 v[76:79], a[140:143], v[236:239], v[76:79]
    s_waitcnt lgkmcnt(13)
    v_or_b32 v236, v219, v218
    v_or_b32 v237, v221, v220
    v_or_b32 v238, v223, v222
    v_mfma_f32_16x16x32_f16 v[192:195], a[48:51], v[152:155], 0
    s_waitcnt lgkmcnt(11)
    ds_read_b128 a[236:239], v12 offset:0
    v_or_b32 v239, v225, v224
    v_cvt_pkrtz_f16_f32 v250, v200, v201
    v_mfma_f32_16x16x32_bf16 v[32:35], a[168:171], v[232:235], v[32:35]
    v_cvt_pkrtz_f16_f32 v252, v202, v203
    v_cvt_pkrtz_f16_f32 v0, v204, v205
    v_cvt_pkrtz_f16_f32 v209, v206, v207
    v_mfma_f32_16x16x32_f16 v[196:199], a[52:55], v[152:155], 0
    v_pk_lshrrev_b16 v250, 3, v250 op_sel_hi:[0,1]
    v_mad_u32_u16 v251, v250, 2, s85
    v_mad_u32_u16 v250, v250, 2, s85 op_sel:[1,0,0,0]
    v_mfma_f32_16x16x32_bf16 v[36:39], a[172:175], v[232:235], v[36:39]
    s_waitcnt lgkmcnt(11)
    ds_read_u16 v251, v251
    ds_read_u16_d16_hi v250, v250
    ds_read_b128 v[140:143], v15 offset:0
    v_mfma_f32_16x16x32_f16 v[192:195], a[56:59], v[160:163], v[192:195]
    v_pk_lshrrev_b16 v252, 3, v252 op_sel_hi:[0,1]
    v_mad_u32_u16 v253, v252, 2, s85
    v_mad_u32_u16 v252, v252, 2, s85 op_sel:[1,0,0,0]
    v_mfma_f32_16x16x32_bf16 v[48:51], a[176:179], v[232:235], v[48:51]
    s_waitcnt lgkmcnt(12)
    ds_read_u16 v253, v253
    ds_read_u16_d16_hi v252, v252
    v_pk_lshrrev_b16 v0, 3, v0 op_sel_hi:[0,1]
    v_mfma_f32_16x16x32_f16 v[196:199], a[60:63], v[160:163], v[196:199]
    v_mad_u32_u16 v208, v0, 2, s85
    v_mad_u32_u16 v0, v0, 2, s85 op_sel:[1,0,0,0]
    v_pk_lshrrev_b16 v209, 3, v209 op_sel_hi:[0,1]
    v_mfma_f32_16x16x32_bf16 v[52:55], a[180:183], v[232:235], v[52:55]
    s_waitcnt lgkmcnt(13)
    ds_read_u16 v208, v208
    v_mad_u32_u16 v210, v209, 2, s85
    v_mad_u32_u16 v209, v209, 2, s85 op_sel:[1,0,0,0]
    v_mfma_f32_16x16x32_f16 v[192:195], a[64:67], v[168:171], v[192:195]
    s_waitcnt lgkmcnt(12)
    ds_read_u16_d16_hi v0, v0
    v_or_b32 v240, v227, v226
    v_or_b32 v241, v229, v228
    v_mfma_f32_16x16x32_bf16 v[64:67], a[184:187], v[232:235], v[64:67]
    ds_read_u16 v210, v210
    v_cvt_pk_bf16_f32 v32, v32, v33
    v_cvt_pk_bf16_f32 v33, v34, v35
    v_mfma_f32_16x16x32_f16 v[196:199], a[68:71], v[168:171], v[196:199]
    s_waitcnt lgkmcnt(11)
    ds_read_u16_d16_hi v209, v209
    v_or_b32 v242, v231, v230
    v_cvt_pkrtz_f16_f32 v211, v192, v193
    v_mfma_f32_16x16x32_bf16 v[68:71], a[188:191], v[232:235], v[68:71]
    v_pk_lshrrev_b16 v211, 3, v211 op_sel_hi:[0,1]
    v_cvt_pkrtz_f16_f32 v213, v194, v195
    v_mad_u32_u16 v212, v211, 2, s85
    v_mfma_f32_16x16x32_f16 v[200:203], a[48:51], v[156:159], 0
    ds_read_b128 v[148:151], v11 offset:2560
    v_cvt_pkrtz_f16_f32 v215, v196, v197
    v_cvt_pkrtz_f16_f32 v217, v198, v199
    v_mfma_f32_16x16x32_bf16 v[40:43], a[168:171], v[236:239], v[40:43]
    s_waitcnt lgkmcnt(11)
    ds_read_u16 v212, v212
    v_or_b32 v243, v249, v248
    v_mad_u32_u16 v211, v211, 2, s85 op_sel:[1,0,0,0]
    v_mfma_f32_16x16x32_f16 v[204:207], a[52:55], v[156:159], 0
    ds_read_b128 v[144:147], v12 offset:1280
    v_pk_lshrrev_b16 v213, 3, v213 op_sel_hi:[0,1]
    v_mad_u32_u16 v214, v213, 2, s85
    v_mfma_f32_16x16x32_bf16 v[44:47], a[172:175], v[236:239], v[44:47]
    ds_read_u16_d16_hi v211, v211
    v_mad_u32_u16 v213, v213, 2, s85 op_sel:[1,0,0,0]
    v_pk_lshrrev_b16 v215, 3, v215 op_sel_hi:[0,1]
    v_mfma_f32_16x16x32_f16 v[200:203], a[56:59], v[164:167], v[200:203]
    s_waitcnt lgkmcnt(11)
    v_mad_u32_u16 v216, v215, 2, s85
    v_or_b32 v244, v251, v250
    v_mad_u32_u16 v215, v215, 2, s85 op_sel:[1,0,0,0]
    v_mfma_f32_16x16x32_bf16 v[56:59], a[176:179], v[236:239], v[56:59]
    ds_read_b128 v[180:183], v13 offset:0
    ds_read_u16 v214, v214
    v_pk_lshrrev_b16 v217, 3, v217 op_sel_hi:[0,1]
    v_mfma_f32_16x16x32_f16 v[204:207], a[60:63], v[164:167], v[204:207]
    v_mad_u32_u16 v218, v217, 2, s85
    v_mad_u32_u16 v217, v217, 2, s85 op_sel:[1,0,0,0]
    v_cvt_pk_bf16_f32 v34, v36, v37
    v_mfma_f32_16x16x32_bf16 v[60:63], a[180:183], v[236:239], v[60:63]
    ds_read_u16_d16_hi v213, v213
    v_cvt_pk_bf16_f32 v35, v38, v39
    v_cvt_pk_bf16_f32 v40, v40, v41
    v_mfma_f32_16x16x32_f16 v[200:203], a[64:67], v[172:175], v[200:203]
    s_waitcnt lgkmcnt(11)
    ds_read_b128 v[188:191], v9 offset:2560
    v_or_b32 v245, v253, v252
    v_cvt_pk_bf16_f32 v41, v42, v43
    v_mfma_f32_16x16x32_f16 v[204:207], a[68:71], v[172:175], v[204:207]
    v_cvt_pk_bf16_f32 v42, v44, v45
    v_cvt_pk_bf16_f32 v43, v46, v47
    v_cvt_pk_bf16_f32 v48, v48, v49
    v_mfma_f32_16x16x32_bf16 v[72:75], a[184:187], v[236:239], v[72:75]
    s_waitcnt lgkmcnt(11)
    ds_read_u16 v216, v216
    v_cvt_pkrtz_f16_f32 v219, v200, v201
    s_waitcnt lgkmcnt(11)
    v_or_b32 v246, v208, v0
    v_mfma_f32_16x16x32_bf16 v[76:79], a[188:191], v[236:239], v[76:79]
    ds_read_u16_d16_hi v215, v215
    v_cvt_pkrtz_f16_f32 v221, v202, v203
    v_cvt_pkrtz_f16_f32 v223, v204, v205
    v_mfma_f32_16x16x32_f16 v[192:195], a[96:99], v[152:155], 0
    ds_read_u16 v218, v218
    v_cvt_pkrtz_f16_f32 v225, v206, v207
    v_pk_lshrrev_b16 v219, 3, v219 op_sel_hi:[0,1]
    v_mfma_f32_16x16x32_bf16 v[80:83], a[24:27], v[240:243], v[80:83]
    s_waitcnt lgkmcnt(11)
    v_mad_u32_u16 v220, v219, 2, s85
    v_or_b32 v247, v210, v209
    v_mad_u32_u16 v219, v219, 2, s85 op_sel:[1,0,0,0]
    v_mfma_f32_16x16x32_f16 v[196:199], a[100:103], v[152:155], 0
    ds_read_u16_d16_hi v217, v217
    ds_read_u16 v220, v220
    buffer_store_dwordx4 v[40:43], v26, s[24:27], s81 offen offset:0 sc0 sc1
    v_mfma_f32_16x16x32_bf16 v[84:87], a[28:31], v[240:243], v[84:87]
    ds_read_u16_d16_hi v219, v219
    v_pk_lshrrev_b16 v221, 3, v221 op_sel_hi:[0,1]
    v_mad_u32_u16 v222, v221, 2, s85
    v_mfma_f32_16x16x32_f16 v[192:195], a[104:107], v[160:163], v[192:195]
    s_waitcnt lgkmcnt(13)
    ds_read_u16 v222, v222
    buffer_store_dwordx4 v[32:35], v26, s[24:27], s80 offen offset:0 sc0 sc1
    v_mfma_f32_16x16x32_bf16 v[96:99], a[32:35], v[240:243], v[96:99]
    v_mad_u32_u16 v221, v221, 2, s85 op_sel:[1,0,0,0]
    v_pk_lshrrev_b16 v223, 3, v223 op_sel_hi:[0,1]
    v_mad_u32_u16 v224, v223, 2, s85
    v_mfma_f32_16x16x32_f16 v[196:199], a[108:111], v[160:163], v[196:199]
    s_waitcnt lgkmcnt(12)
    ds_read_u16_d16_hi v221, v221
    ds_read_u16 v224, v224
    v_mad_u32_u16 v223, v223, 2, s85 op_sel:[1,0,0,0]
    v_mfma_f32_16x16x32_bf16 v[100:103], a[36:39], v[240:243], v[100:103]
    s_waitcnt lgkmcnt(13)
    ds_read_u16_d16_hi v223, v223
    v_pk_lshrrev_b16 v225, 3, v225 op_sel_hi:[0,1]
    v_mad_u32_u16 v226, v225, 2, s85
    v_mfma_f32_16x16x32_f16 v[192:195], a[112:115], v[168:171], v[192:195]
    s_waitcnt lgkmcnt(13)
    ds_read_u16 v226, v226
    v_mad_u32_u16 v225, v225, 2, s85 op_sel:[1,0,0,0]
    v_cvt_pk_bf16_f32 v49, v50, v51
    v_mfma_f32_16x16x32_bf16 v[112:115], a[40:43], v[240:243], v[112:115]
    s_waitcnt lgkmcnt(13)
    ds_read_u16_d16_hi v225, v225
    v_cvt_pk_bf16_f32 v50, v52, v53
    v_cvt_pk_bf16_f32 v51, v54, v55
    v_mfma_f32_16x16x32_f16 v[196:199], a[116:119], v[168:171], v[196:199]
    v_cvt_pk_bf16_f32 v56, v56, v57
    v_cvt_pk_bf16_f32 v57, v58, v59
    v_cvt_pk_bf16_f32 v58, v60, v61
    v_mfma_f32_16x16x32_bf16 v[116:119], a[44:47], v[240:243], v[116:119]
    s_waitcnt lgkmcnt(13)
    ds_read_b128 v[232:235], v13 offset:2560
    v_cvt_pk_bf16_f32 v59, v62, v63
    v_cvt_pk_bf16_f32 v64, v64, v65
    v_mfma_f32_16x16x32_f16 v[200:203], a[96:99], v[156:159], 0
    s_waitcnt lgkmcnt(12)
    buffer_store_dwordx4 v[56:59], v26, s[24:27], s81 offen offset:64 sc0 sc1
    ds_read_b128 v[32:35], v10 offset:0
    buffer_store_dwordx4 v[48:51], v26, s[24:27], s80 offen offset:64 sc0 sc1
    ds_read_b128 v[176:179], v9 offset:0
    v_mfma_f32_16x16x32_bf16 v[88:91], a[24:27], v[244:247], v[88:91]
    v_cvt_pk_bf16_f32 v65, v66, v67
    v_cvt_pk_bf16_f32 v66, v68, v69
    v_cvt_pk_bf16_f32 v67, v70, v71
    v_mfma_f32_16x16x32_f16 v[204:207], a[100:103], v[156:159], 0
    v_cvt_pk_bf16_f32 v72, v72, v73
    v_cvt_pk_bf16_f32 v73, v74, v75
    v_cvt_pk_bf16_f32 v74, v76, v77
    v_mfma_f32_16x16x32_bf16 v[92:95], a[28:31], v[244:247], v[92:95]
    v_cvt_pk_bf16_f32 v75, v78, v79
    v_or_b32 v240, v212, v211
    v_or_b32 v241, v214, v213
    v_mfma_f32_16x16x32_f16 v[200:203], a[104:107], v[164:167], v[200:203]
    s_waitcnt lgkmcnt(11)
    ds_read_b128 v[184:187], v14 offset:1280
    v_or_b32 v242, v216, v215
    v_or_b32 v243, v218, v217
    v_mfma_f32_16x16x32_bf16 v[104:107], a[32:35], v[244:247], v[104:107]
    ds_read_b128 v[44:47], v10 offset:2560
    v_cvt_pkrtz_f16_f32 v227, v192, v193
    v_pk_lshrrev_b16 v227, 3, v227 op_sel_hi:[0,1]
    v_mfma_f32_16x16x32_f16 v[204:207], a[108:111], v[164:167], v[204:207]
    ds_read_b128 v[36:39], v14 offset:0
    v_cvt_pkrtz_f16_f32 v229, v194, v195
    v_cvt_pkrtz_f16_f32 v231, v196, v197
    v_mfma_f32_16x16x32_bf16 v[108:111], a[36:39], v[244:247], v[108:111]
    v_cvt_pkrtz_f16_f32 v249, v198, v199
    v_mad_u32_u16 v228, v227, 2, s85
    v_mad_u32_u16 v227, v227, 2, s85 op_sel:[1,0,0,0]
    v_mfma_f32_16x16x32_f16 v[200:203], a[112:115], v[172:175], v[200:203]
    s_waitcnt lgkmcnt(12)
    ds_read_u16 v228, v228
    ds_read_u16_d16_hi v227, v227
    v_pk_lshrrev_b16 v229, 3, v229 op_sel_hi:[0,1]
    v_mfma_f32_16x16x32_f16 v[204:207], a[116:119], v[172:175], v[204:207]
    buffer_store_dwordx4 v[72:75], v26, s[24:27], s81 offen offset:128 sc0 sc1
    v_mfma_f32_16x16x32_bf16 v[120:123], a[40:43], v[244:247], v[120:123]
    v_mad_u32_u16 v230, v229, 2, s85
    v_mad_u32_u16 v229, v229, 2, s85 op_sel:[1,0,0,0]
    v_cvt_pkrtz_f16_f32 v251, v200, v201
    v_mfma_f32_16x16x32_bf16 v[124:127], a[44:47], v[244:247], v[124:127]
    s_waitcnt lgkmcnt(12)
    ds_read_u16 v230, v230
    ds_read_u16_d16_hi v229, v229
    v_or_b32 v244, v220, v219
    v_mfma_f32_16x16x32_f16 v[192:195], a[144:147], v[152:155], 0
    s_waitcnt lgkmcnt(12)
    ds_read_b128 v[56:59], v20 offset:2560
    v_or_b32 v245, v222, v221
    v_or_b32 v246, v224, v223
    v_mfma_f32_16x16x32_bf16 v[80:83], a[72:75], v[240:243], v[80:83]
    s_waitcnt lgkmcnt(11)
    v_or_b32 v247, v226, v225
    v_cvt_pkrtz_f16_f32 v253, v202, v203
    v_cvt_pkrtz_f16_f32 v208, v204, v205
    v_mfma_f32_16x16x32_f16 v[196:199], a[148:151], v[152:155], 0
    ds_read_b128 v[60:63], v21 offset:2560
    v_cvt_pkrtz_f16_f32 v210, v206, v207
    v_pk_lshrrev_b16 v231, 3, v231 op_sel_hi:[0,1]
    v_mfma_f32_16x16x32_bf16 v[84:87], a[76:79], v[240:243], v[84:87]
    buffer_store_dwordx4 v[64:67], v26, s[24:27], s80 offen offset:128 sc0 sc1
    v_mfma_f32_16x16x32_f16 v[192:195], a[152:155], v[160:163], v[192:195]
    ds_read_b128 v[52:55], v21 offset:0
    v_mad_u32_u16 v248, v231, 2, s85
    v_mad_u32_u16 v231, v231, 2, s85 op_sel:[1,0,0,0]
    v_mfma_f32_16x16x32_bf16 v[96:99], a[80:83], v[240:243], v[96:99]
    s_waitcnt lgkmcnt(12)
    ds_read_u16 v248, v248
    ds_read_u16_d16_hi v231, v231
    v_pk_lshrrev_b16 v249, 3, v249 op_sel_hi:[0,1]
    v_mfma_f32_16x16x32_f16 v[196:199], a[156:159], v[160:163], v[196:199]
    s_waitcnt lgkmcnt(11)
    ds_read_b128 v[236:239], v14 offset:3840
    ds_read_b128 v[48:51], v20 offset:0
    ds_read_b128 v[40:43], v13 offset:1280
    v_mfma_f32_16x16x32_bf16 v[100:103], a[84:87], v[240:243], v[100:103]
    v_mad_u32_u16 v250, v249, 2, s85
    v_mad_u32_u16 v249, v249, 2, s85 op_sel:[1,0,0,0]
    v_pk_lshrrev_b16 v251, 3, v251 op_sel_hi:[0,1]
    v_mfma_f32_16x16x32_f16 v[192:195], a[160:163], v[168:171], v[192:195]
    s_waitcnt lgkmcnt(12)
    ds_read_u16 v250, v250
    ds_read_u16_d16_hi v249, v249
    v_mad_u32_u16 v252, v251, 2, s85
    v_mfma_f32_16x16x32_bf16 v[112:115], a[88:91], v[240:243], v[112:115]
    s_waitcnt lgkmcnt(13)
    ds_read_u16 v252, v252
    v_mad_u32_u16 v251, v251, 2, s85 op_sel:[1,0,0,0]
    v_pk_lshrrev_b16 v253, 3, v253 op_sel_hi:[0,1]
    v_mfma_f32_16x16x32_f16 v[196:199], a[164:167], v[168:171], v[196:199]
    s_waitcnt lgkmcnt(12)
    ds_read_u16_d16_hi v251, v251
    ds_read_b128 v[64:67], v14 offset:2560
    v_mad_u32_u16 v0, v253, 2, s85
    v_mfma_f32_16x16x32_bf16 v[116:119], a[92:95], v[240:243], v[116:119]
    s_waitcnt lgkmcnt(13)
    ds_read_u16 v0, v0
    v_mad_u32_u16 v253, v253, 2, s85 op_sel:[1,0,0,0]
    v_pk_lshrrev_b16 v208, 3, v208 op_sel_hi:[0,1]
    v_mfma_f32_16x16x32_f16 v[200:203], a[144:147], v[156:159], 0
    s_waitcnt lgkmcnt(13)
    ds_read_u16_d16_hi v253, v253
    v_mad_u32_u16 v209, v208, 2, s85
    v_mad_u32_u16 v208, v208, 2, s85 op_sel:[1,0,0,0]
    v_mfma_f32_16x16x32_bf16 v[88:91], a[72:75], v[244:247], v[88:91]
    v_pk_lshrrev_b16 v210, 3, v210 op_sel_hi:[0,1]
    v_mad_u32_u16 v211, v210, 2, s85
    v_mad_u32_u16 v210, v210, 2, s85 op_sel:[1,0,0,0]
    v_mfma_f32_16x16x32_f16 v[204:207], a[148:151], v[156:159], 0
    s_waitcnt lgkmcnt(13)
    ds_read_u16 v209, v209
    v_or_b32 v240, v228, v227
    v_or_b32 v241, v230, v229
    v_mfma_f32_16x16x32_bf16 v[92:95], a[76:79], v[244:247], v[92:95]
    s_waitcnt lgkmcnt(11)
    ds_read_u16_d16_hi v208, v208
    ds_read_u16 v211, v211
    v_or_b32 v242, v248, v231
    v_mfma_f32_16x16x32_f16 v[200:203], a[152:155], v[164:167], v[200:203]
    ds_read_u16_d16_hi v210, v210
    v_cvt_pkrtz_f16_f32 v212, v192, v193
    v_pk_lshrrev_b16 v212, 3, v212 op_sel_hi:[0,1]
    v_mfma_f32_16x16x32_bf16 v[104:107], a[80:83], v[244:247], v[104:107]
    s_waitcnt lgkmcnt(13)
    ds_read_b128 v[68:71], v13 offset:3840
    v_cvt_pkrtz_f16_f32 v214, v194, v195
    v_cvt_pkrtz_f16_f32 v216, v196, v197
    v_mfma_f32_16x16x32_f16 v[204:207], a[156:159], v[164:167], v[204:207]
    v_cvt_pkrtz_f16_f32 v218, v198, v199
    v_mad_u32_u16 v213, v212, 2, s85
    v_mad_u32_u16 v212, v212, 2, s85 op_sel:[1,0,0,0]
    v_mfma_f32_16x16x32_bf16 v[108:111], a[84:87], v[244:247], v[108:111]
    s_waitcnt lgkmcnt(13)
    ds_read_b128 v[72:75], v15 offset:2560
    v_pk_lshrrev_b16 v214, 3, v214 op_sel_hi:[0,1]
    v_mad_u32_u16 v215, v214, 2, s85
    v_mfma_f32_16x16x32_f16 v[200:203], a[160:163], v[172:175], v[200:203]
    s_waitcnt lgkmcnt(11)
    ds_read_b128 v[76:79], v12 offset:3840
    v_or_b32 v243, v250, v249
    v_mad_u32_u16 v214, v214, 2, s85 op_sel:[1,0,0,0]
    v_mfma_f32_16x16x32_f16 v[204:207], a[164:167], v[172:175], v[204:207]
    ds_read_u16 v213, v213
    v_pk_lshrrev_b16 v216, 3, v216 op_sel_hi:[0,1]
    v_mad_u32_u16 v217, v216, 2, s85
    v_mfma_f32_16x16x32_bf16 v[120:123], a[88:91], v[244:247], v[120:123]
    v_cvt_pkrtz_f16_f32 v220, v200, v201
    v_cvt_pkrtz_f16_f32 v222, v202, v203
    v_mad_u32_u16 v216, v216, 2, s85 op_sel:[1,0,0,0]
    v_mfma_f32_16x16x32_bf16 v[124:127], a[92:95], v[244:247], v[124:127]
    s_waitcnt lgkmcnt(11)
    ds_read_u16_d16_hi v212, v212
    ds_read_u16 v215, v215
    v_or_b32 v244, v252, v251
    v_mfma_f32_16x16x32_bf16 v[80:83], a[120:123], v[240:243], v[80:83]
    v_cvt_pkrtz_f16_f32 v224, v204, v205
    v_cvt_pkrtz_f16_f32 v226, v206, v207
    v_pk_lshrrev_b16 v218, 3, v218 op_sel_hi:[0,1]
    v_mfma_f32_16x16x32_bf16 v[84:87], a[124:127], v[240:243], v[84:87]
    s_add_u32 m0, s56, -128
    ds_read_u16_d16_hi v214, v214
    v_mad_u32_u16 v219, v218, 2, s85
    v_mad_u32_u16 v218, v218, 2, s85 op_sel:[1,0,0,0]
    v_mfma_f32_16x16x32_bf16 v[96:99], a[128:131], v[240:243], v[96:99]
    s_waitcnt lgkmcnt(11)
    ds_read_u16 v217, v217
    v_or_b32 v245, v0, v253
    v_pk_lshrrev_b16 v220, 3, v220 op_sel_hi:[0,1]
    v_mfma_f32_16x16x32_bf16 v[100:103], a[132:135], v[240:243], v[100:103]
    v_mad_u32_u16 v221, v220, 2, s85
    v_mad_u32_u16 v220, v220, 2, s85 op_sel:[1,0,0,0]
    v_pk_lshrrev_b16 v222, 3, v222 op_sel_hi:[0,1]
    v_mfma_f32_16x16x32_bf16 v[112:115], a[136:139], v[240:243], v[112:115]
    s_waitcnt lgkmcnt(11)
    ds_read_u16_d16_hi v216, v216
    v_mad_u32_u16 v223, v222, 2, s85
    s_waitcnt lgkmcnt(11)
    v_or_b32 v246, v209, v208
    v_mfma_f32_16x16x32_bf16 v[116:119], a[140:143], v[240:243], v[116:119]
    ds_read_u16 v219, v219
    v_mad_u32_u16 v222, v222, 2, s85 op_sel:[1,0,0,0]
    v_pk_lshrrev_b16 v224, 3, v224 op_sel_hi:[0,1]
    v_mad_u32_u16 v225, v224, 2, s85
    v_mad_u32_u16 v224, v224, 2, s85 op_sel:[1,0,0,0]
    v_pk_lshrrev_b16 v226, 3, v226 op_sel_hi:[0,1]
    v_mad_u32_u16 v227, v226, 2, s85
    v_mad_u32_u16 v226, v226, 2, s85 op_sel:[1,0,0,0]
    ds_read_u16_d16_hi v218, v218
    s_waitcnt lgkmcnt(11)
    v_or_b32 v247, v211, v210
    s_nop 1
    v_mfma_f32_16x16x32_bf16 v[88:91], a[120:123], v[244:247], v[88:91]
    ds_read_u16 v221, v221
    ds_read_u16_d16_hi v220, v220
    v_mfma_f32_16x16x32_bf16 v[92:95], a[124:127], v[244:247], v[92:95]
    ds_read_u16 v223, v223
    v_mfma_f32_16x16x32_bf16 v[104:107], a[128:131], v[244:247], v[104:107]
    s_waitcnt lgkmcnt(11)
    ds_read_u16_d16_hi v222, v222
    buffer_load_dwordx4 v1, s[20:23], 0 offen offset:128 lds
    s_add_u32 m0, s56, 896
    v_mfma_f32_16x16x32_bf16 v[108:111], a[132:135], v[244:247], v[108:111]
    s_waitcnt lgkmcnt(11)
    ds_read_u16 v225, v225
    buffer_load_dwordx4 v2, s[20:23], 0 offen offset:128 lds
    s_add_u32 m0, s56, 1920
    ds_read_u16_d16_hi v224, v224
    buffer_load_dwordx4 v3, s[20:23], 0 offen offset:128 lds
    v_mfma_f32_16x16x32_bf16 v[120:123], a[136:139], v[244:247], v[120:123]
    s_add_u32 m0, s56, 2944
    s_waitcnt lgkmcnt(12)
    v_or_b32 v240, v213, v212
    v_mfma_f32_16x16x32_bf16 v[124:127], a[140:143], v[244:247], v[124:127]
    s_waitcnt lgkmcnt(9)
    ds_read_u16 v227, v227
    buffer_load_dwordx4 v4, s[20:23], 0 offen offset:128 lds
    ds_read_u16_d16_hi v226, v226
    v_or_b32 v241, v215, v214
    s_add_u32 m0, s56, 3968
    s_nop 0
    buffer_load_dwordx4 v5, s[20:23], 0 offen offset:128 lds
    ds_read_b128 v[192:195], v22 offset:0
    s_add_u32 m0, s56, 4992
    s_nop 0
    buffer_load_dwordx4 v6, s[20:23], 0 offen offset:128 lds
    s_waitcnt lgkmcnt(11)
    v_or_b32 v242, v217, v216
    s_add_u32 m0, s56, 6016
    ds_read_b128 v[196:199], v22 offset:256
    buffer_load_dword v7, s[20:23], 0 offen offset:128 lds
    ds_read_b128 v[204:207], v22 offset:272
    s_waitcnt lgkmcnt(11)
    v_or_b32 v243, v219, v218
    s_nop 1
    v_mfma_f32_16x16x32_bf16 v[80:83], a[168:171], v[240:243], v[80:83]
    v_mfma_f32_16x16x32_bf16 v[84:87], a[172:175], v[240:243], v[84:87]
    v_mfma_f32_16x16x32_bf16 v[96:99], a[176:179], v[240:243], v[96:99]
    s_waitcnt lgkmcnt(9)
    ds_read_b128 v[200:203], v22 offset:16
    v_or_b32 v244, v221, v220
    v_mfma_f32_16x16x32_bf16 v[100:103], a[180:183], v[240:243], v[100:103]
    v_mfma_f32_16x16x32_bf16 v[112:115], a[184:187], v[240:243], v[112:115]
    s_waitcnt lgkmcnt(9)
    v_mfma_f32_16x16x32_bf16 v[116:119], a[188:191], v[240:243], v[116:119]
    s_add_u32 s52, s52, 1
    s_cmp_eq_u32 s52, 4
    s_waitcnt lgkmcnt(8)
    v_or_b32 v245, v223, v222
    s_waitcnt lgkmcnt(6)
    v_or_b32 v246, v225, v224
    s_waitcnt lgkmcnt(4)
    v_or_b32 v247, v227, v226
    s_cbranch_scc0 L_conv
L_last:
    s_branch L_final
.section .rodata,"a"
.p2align 6
.amdhsa_kernel standalone__modern_conv_block_convnext__vision_kernel
  .amdhsa_next_free_vgpr 512
  .amdhsa_next_free_sgpr 102
  .amdhsa_accum_offset 256
  .amdhsa_group_segment_fixed_size 0
  .amdhsa_kernarg_size 80
  .amdhsa_user_sgpr_count 2
  .amdhsa_user_sgpr_kernarg_segment_ptr 1
  .amdhsa_system_sgpr_workgroup_id_x 1
.end_amdhsa_kernel
```

```asm
; @launch grid=(256,1,1) block=(256,1,1) lds=163840
.amdgcn_target "amdgcn-amd-amdhsa--gfx950"
.text
.globl standalone__modern_conv_block_convnext__vision_kernel
.p2align 8
.type standalone__modern_conv_block_convnext__vision_kernel,@function
standalone__modern_conv_block_convnext__vision_kernel:
    s_cmp_ge_u32 s2, 256
    s_cbranch_scc1 L_end
    s_load_dwordx16 s[4:19], s[0:1], 0
    v_readfirstlane_b32 s3, v0
    v_and_b32 v129, 63, v0
    s_and_b32 s60, s2, 7
    s_lshr_b32 s61, s2, 7
    s_lshl1_add_u32 s60, s60, s61
    s_lshr_b32 s3, s3, 6
    s_getpc_b64 s[62:63]
L_pc:
    v_min_u32 v18, 2, v129
    s_lshr_b32 s71, s2, 3
    s_lshl2_add_u32 s71, s71, s3
    v_mad_u32_u24 v18, s71, 3, v18
    v_min_u32 v18, (L_last-L_pc)/128, v18
    v_lshlrev_b32 v18, 1, v18
    v_mad_u64_u32 v[18:19], vcc, v18, 64, s[62:63]
    global_load_dword v251, v[18:19], off
    s_bfe_u32 s61, s2, 0x40003
    s_lshl2_add_u32 s55, s61, s3
    s_mul_i32 s60, s60, 3145728
    s_mul_i32 s61, s55, 1536
    s_add_u32 s63, s60, s61
    s_sub_u32 s64, s63, 98496
    s_movk_i32 s65, 0
    s_movk_i32 s66, 2048
    s_cmp_eq_u32 s55, 0
    s_cmovk_i32 s65, 100
    s_cmovk_i32 s66, 1948
    s_cmp_eq_u32 s55, 63
    s_cmovk_i32 s66, 1800
    s_mul_i32 s56, s3, 12800
    s_add_u32 s56, s56, 90112
    s_mov_b32 s68, 96384
    v_lshrrev_b32 v131, 2, v129
    v_mul_u32_u24 v130, 205, v131
    v_mul_u32_u24 v131, 192, v131
    v_add_u32 v131, s64, v131
    v_lshlrev_b32 v132, 4, v0
    v_and_b32 v133, 16, v0
    v_bitop3_b32 v132, v132, v133, 48 bitop3:0x28
    v_bfrev_b32 v136, 1
    s_waitcnt lgkmcnt(0)
    s_mov_b32 s20, s4
    s_mov_b32 s21, s5
    s_mov_b32 s22, 50331648
    s_mov_b32 s23, 0x20000
    s_mulk_i32 s71, 640
    v_lshlrev_b32 v141, 7, v129
    v_cmp_gt_u32 vcc, 5, v129
    s_nop 1
    v_cndmask_b32 v141, v136, v141, vcc
    s_mov_b32 s44, s8
    s_mov_b32 s45, s9
    s_mov_b32 s46, 73728
    s_mov_b32 s47, 0x20000
    s_mov_b32 s48, s12
    s_mov_b32 s49, s13
    s_mov_b32 s50, 73728
    s_mov_b32 s51, 0x20000
    buffer_load_dword v142, v141, s[44:47], s71 offen
    buffer_load_dword v143, v141, s[48:51], s71 offen
    v_lshrrev_b32 v138, 5, v129
    s_movk_i32 s69, 192
    v_mul_u32_u24 v139, 1366, v0
    v_lshrrev_b32 v139, 16, v139
    v_mul_u32_u24 v139, 384, v139
    v_lshl_add_u32 v139, v0, 2, v139
    v_lshlrev_b32 v140, 3, v0
    s_mov_b32 s28, s6
    s_mov_b32 s29, s7
    s_mov_b32 s30, 1728
    s_mov_b32 s31, 0x20000
    s_mov_b32 s36, s14
    s_mov_b32 s37, s15
    s_mov_b32 s38, 192
    s_mov_b32 s39, 0x20000
    s_mov_b32 s40, s16
    s_mov_b32 s41, s17
    s_mov_b32 s42, 192
    s_mov_b32 s43, 0x20000
    s_mov_b32 s32, s10
    s_mov_b32 s33, s11
    s_mov_b32 s34, 768
    s_mov_b32 s35, 0x20000
    buffer_load_dword v144, v139, s[28:31], 0 offen
    buffer_load_dword v145, v139, s[28:31], 0 offen offset:192
    buffer_load_dword v146, v139, s[28:31], 0 offen offset:384
    buffer_load_dwordx2 v[148:149], v140, s[36:39], 0 offen
    buffer_load_dwordx2 v[150:151], v140, s[40:43], 0 offen
    s_cmp_ge_u32 s3, 2
    s_cbranch_scc1 L_prep1
L_prep0:
    v_bfe_u32 v158, v129, 2, 1
    v_bfe_u32 v159, v129, 3, 2
    v_lshl_add_u32 v159, v158, 2, v159
    v_and_b32 v160, 3, v129
    v_lshl_add_u32 v236, v138, 2, v160
    s_lshl_b32 s60, s3, 7
    v_lshl_add_u32 v236, v236, 4, s60
    v_mul_u32_u24 v159, 768, v159
    v_add_u32 v232, v159, v236
    v_add_u32 v233, 6144, v232
    v_and_b32 v159, 0x1c, v129
    v_cmp_eq_u32 vcc, 0x1c, v159
    s_mov_b32 s72, 72960
    s_mul_i32 s60, s3, 24576
    s_add_u32 s60, s60, 40960
    v_cndmask_b32 v237, v136, v236, vcc
    v_lshl_add_u32 v234, v129, 4, s60
    s_lshl_b32 s60, s3, 12
    s_add_u32 s60, s60, 40960
    v_mov_b32 v238, s60
    buffer_load_dwordx4 v[176:179], v236, s[44:47], s72 offen offset:0
    buffer_load_dwordx4 a[232:235], v237, s[32:35], 0 offen offset:0
    buffer_load_dwordx4 v[180:183], v236, s[44:47], s72 offen offset:256
    buffer_load_dwordx4 a[236:239], v237, s[32:35], 0 offen offset:256
    buffer_load_dwordx4 v[184:187], v236, s[44:47], s72 offen offset:512
    buffer_load_dwordx4 a[240:243], v237, s[32:35], 0 offen offset:512
    s_mov_b32 m0, s56
    s_movk_i32 s70, 5
L_xl0:
    v_lshrrev_b32 v134, 11, v130
    v_subrev_u32 v135, s65, v130
    v_mad_u32_u24 v134, v134, s68, v131
    v_and_b32 v135, 0x7ff, v135
    v_cmp_gt_u32 vcc, s66, v135
    v_lshrrev_b32 v135, 7, v130
    v_and_b32 v135, 32, v135
    v_xad_u32 v134, v132, v135, v134
    v_cndmask_b32 v134, v136, v134, vcc
    v_add_u32 v130, 3280, v130
    v_add_u32 v131, 3072, v131
    buffer_load_dwordx4 v134, s[20:23], 0 offen lds
    s_add_u32 m0, m0, 1024
    s_sub_u32 s70, s70, 1
    s_cbranch_scc0 L_xl0
    s_branch L_prb0
L_prep1:
    v_bfe_u32 v158, v129, 2, 1
    v_bfe_u32 v159, v129, 3, 2
    v_lshl_add_u32 v159, v158, 2, v159
    v_and_b32 v160, 3, v129
    v_lshl_add_u32 v159, v138, 4, v159
    s_lshl_b32 s60, s3, 6
    s_sub_u32 s60, s60, 128
    v_add_u32 v159, s60, v159
    v_xor_b32 v236, v138, v160
    v_lshlrev_b32 v236, 4, v236
    v_mad_u32_u24 v232, v159, s69, v236
    s_lshl_b32 s60, s3, 1
    s_sub_u32 s60, s60, 4
    v_add_u32 v159, s60, v158
    v_lshlrev_b32 v238, 11, v159
    v_add_u32 v238, 43008, v238
    v_mul_u32_u24 v159, 768, v159
    v_lshl_add_u32 v159, v158, 2, v159
    v_add_u32 v159, v160, v159
    v_bfe_u32 v160, v129, 3, 1
    v_lshl_add_u32 v159, v160, 6, v159
    v_lshrrev_b32 v160, 4, v129
    v_lshl_add_u32 v159, v160, 4, v159
    v_lshlrev_b32 v159, 4, v159
    v_add_u32 v234, 40960, v159
    v_xor_b32 v235, 64, v234
    buffer_load_dwordx4 v[208:211], v236, s[40:43], 0 offen offset:0
    buffer_load_dwordx4 v[212:215], v236, s[40:43], 0 offen offset:64
    buffer_load_dwordx4 v[216:219], v236, s[40:43], 0 offen offset:128
    s_mov_b32 m0, s56
    s_movk_i32 s70, 5
L_xl1:
    v_lshrrev_b32 v134, 11, v130
    v_subrev_u32 v135, s65, v130
    v_mad_u32_u24 v134, v134, s68, v131
    v_and_b32 v135, 0x7ff, v135
    v_cmp_gt_u32 vcc, s66, v135
    v_lshrrev_b32 v135, 7, v130
    v_and_b32 v135, 32, v135
    v_xad_u32 v134, v132, v135, v134
    v_cndmask_b32 v134, v136, v134, vcc
    v_add_u32 v130, 3280, v130
    v_add_u32 v131, 3072, v131
    buffer_load_dwordx4 v134, s[20:23], 0 offen lds
    s_add_u32 m0, m0, 1024
    s_sub_u32 s70, s70, 1
    s_cbranch_scc0 L_xl1
L_prb1:
    v_lshrrev_b32 v131, 4, v129
    v_add_u32 v131, 96, v131
    v_mul_u32_u24 v130, 205, v131
    v_mul_u32_u24 v131, 192, v131
    v_add_u32 v131, s64, v131
    v_lshlrev_b32 v133, 2, v129
    v_and_b32 v133, 63, v133
    v_lshrrev_b32 v134, 11, v130
    v_subrev_u32 v135, s65, v130
    v_mad_u32_u24 v134, v134, s68, v131
    v_and_b32 v135, 0x7ff, v135
    v_cmp_gt_u32 vcc, s66, v135
    v_lshrrev_b32 v135, 7, v130
    v_and_b32 v135, 32, v135
    v_xad_u32 v134, v133, v135, v134
    v_cndmask_b32 v7, v136, v134, vcc
    s_add_u32 m0, s56, 6144
    s_nop 0
    buffer_load_dword v7, s[20:23], 0 offen offset:0 lds
    v_lshrrev_b32 v131, 2, v129
    v_mul_u32_u24 v130, 205, v131
    v_mul_u32_u24 v131, 192, v131
    v_add_u32 v131, s64, v131
    v_lshrrev_b32 v134, 11, v130
    v_subrev_u32 v135, s65, v130
    v_mad_u32_u24 v134, v134, s68, v131
    v_and_b32 v135, 0x7ff, v135
    v_cmp_gt_u32 vcc, s66, v135
    v_lshrrev_b32 v135, 7, v130
    v_and_b32 v135, 32, v135
    v_xad_u32 v134, v132, v135, v134
    v_cndmask_b32 v1, v136, v134, vcc
    v_add_u32 v130, 3280, v130
    v_add_u32 v131, 3072, v131
    v_lshrrev_b32 v134, 11, v130
    v_subrev_u32 v135, s65, v130
    v_mad_u32_u24 v134, v134, s68, v131
    v_and_b32 v135, 0x7ff, v135
    v_cmp_gt_u32 vcc, s66, v135
    v_lshrrev_b32 v135, 7, v130
    v_and_b32 v135, 32, v135
    v_xad_u32 v134, v132, v135, v134
    v_cndmask_b32 v2, v136, v134, vcc
    v_add_u32 v130, 3280, v130
    v_add_u32 v131, 3072, v131
    v_lshrrev_b32 v134, 11, v130
    v_subrev_u32 v135, s65, v130
    v_mad_u32_u24 v134, v134, s68, v131
    v_and_b32 v135, 0x7ff, v135
    v_cmp_gt_u32 vcc, s66, v135
    v_lshrrev_b32 v135, 7, v130
    v_and_b32 v135, 32, v135
    v_xad_u32 v134, v132, v135, v134
    v_cndmask_b32 v3, v136, v134, vcc
    v_add_u32 v130, 3280, v130
    v_add_u32 v131, 3072, v131
    v_lshrrev_b32 v134, 11, v130
    v_subrev_u32 v135, s65, v130
    v_mad_u32_u24 v134, v134, s68, v131
    v_and_b32 v135, 0x7ff, v135
    v_cmp_gt_u32 vcc, s66, v135
    v_lshrrev_b32 v135, 7, v130
    v_and_b32 v135, 32, v135
    v_xad_u32 v134, v132, v135, v134
    v_cndmask_b32 v4, v136, v134, vcc
    v_add_u32 v130, 3280, v130
    v_add_u32 v131, 3072, v131
    v_lshrrev_b32 v134, 11, v130
    v_subrev_u32 v135, s65, v130
    v_mad_u32_u24 v134, v134, s68, v131
    v_and_b32 v135, 0x7ff, v135
    v_cmp_gt_u32 vcc, s66, v135
    v_lshrrev_b32 v135, 7, v130
    v_and_b32 v135, 32, v135
    v_xad_u32 v134, v132, v135, v134
    v_cndmask_b32 v5, v136, v134, vcc
    v_add_u32 v130, 3280, v130
    v_add_u32 v131, 3072, v131
    v_lshrrev_b32 v134, 11, v130
    v_subrev_u32 v135, s65, v130
    v_mad_u32_u24 v134, v134, s68, v131
    v_and_b32 v135, 0x7ff, v135
    v_cmp_gt_u32 vcc, s66, v135
    v_lshrrev_b32 v135, 7, v130
    v_and_b32 v135, 32, v135
    v_xad_u32 v134, v132, v135, v134
    v_cndmask_b32 v6, v136, v134, vcc
    s_cmp_lt_u32 s55, 63
    s_cselect_b32 s66, 10, 0
    s_add_u32 s64, s64, 1856
    v_mul_u32_u24 v134, 98304, v129
    v_add_u32 v134, s64, v134
    v_cmp_gt_u32 vcc, s66, v129
    s_nop 1
    v_cndmask_b32 v31, v136, v134, vcc
    v_mov_b32 v157, 268435456
    v_and_b32 v152, 15, v129
    v_lshrrev_b32 v153, 4, v129
    v_add_u32 v154, 4, v152
    v_lshrrev_b32 v154, 3, v154
    v_mad_i32_i24 v155, v154, -4, v152
    v_and_b32 v154, 1, v154
    v_and_b32 v156, 1, v153
    v_lshlrev_b32 v158, 1, v154
    v_mul_u32_u24 v159, 98304, v158
    v_mad_u32_u24 v159, v155, s69, v159
    v_lshl_add_u32 v159, v153, 4, v159
    v_add_u32 v26, s63, v159
    v_xor_b32 v26, 0x80000000, v26
    s_mov_b32 s54, 2147483648
    v_xor_b32 v161, v154, v138
    v_add_u32 v159, v153, v158
    v_add_u32 v160, 0, v155
    v_mad_u32_u24 v159, v159, 10, v160
    v_bfe_u32 v160, v159, 2, 1
    v_lshl_or_b32 v160, v161, 1, v160
    v_lshl_add_u32 v160, v159, 2, v160
    v_lshl_add_u32 v8, v160, 4, s56
    v_add_u32 v162, 1, v156
    v_add_u32 v159, v138, v158
    v_add_u32 v160, v162, v155
    v_mad_u32_u24 v159, v159, 10, v160
    v_bfe_u32 v160, v159, 2, 1
    v_lshl_or_b32 v160, v154, 1, v160
    v_lshl_add_u32 v160, v159, 2, v160
    v_lshl_add_u32 v12, v160, 4, s56
    v_xor_b32 v9, 16, v8
    v_xor_b32 v10, 32, v8
    v_xor_b32 v11, 48, v8
    v_xor_b32 v13, 16, v12
    v_xor_b32 v14, 32, v12
    v_xor_b32 v15, 48, v12
    v_add_u32 v159, 1, v158
    v_add_u32 v160, 1, v155
    v_mad_u32_u24 v159, v159, 10, v160
    v_bfe_u32 v160, v159, 2, 1
    v_lshl_or_b32 v160, v154, 1, v160
    v_xor_b32 v160, v153, v160
    v_lshl_add_u32 v160, v159, 2, v160
    v_lshl_add_u32 v20, v160, 4, s56
    v_xor_b32 v161, 1, v154
    v_add_u32 v159, 2, v158
    v_add_u32 v160, 1, v155
    v_mad_u32_u24 v159, v159, 10, v160
    v_bfe_u32 v160, v159, 2, 1
    v_lshl_or_b32 v160, v161, 1, v160
    v_xor_b32 v160, v153, v160
    v_lshl_add_u32 v160, v159, 2, v160
    v_lshl_add_u32 v21, v160, 4, s56
    v_bfe_u32 v158, v152, 2, 1
    v_sub_u32 v158, v153, v158
    v_and_b32 v159, 3, v152
    v_mul_u32_u24 v16, 0x1111, v159
    v_lshrrev_b32 v160, 3, v152
    v_lshl_add_u32 v159, v160, 2, v159
    v_lshlrev_b32 v159, 5, v159
    v_add_u32 v159, 141312, v159
    s_movk_i32 s70, 3072
    v_cmp_gt_u32 vcc, 3, v158
    v_mad_u32_u24 v159, v158, s70, v159
    s_nop 0
    v_cndmask_b32 v22, v157, v159, vcc
    v_lshlrev_b32 v23, 4, v129
    v_add_u32 v24, 40960, v23
    v_lshlrev_b32 v25, 5, v153
    v_add_u32 v25, 150528, v25
    v_and_b32 v160, 1, v129
    v_lshlrev_b32 v160, 4, v160
    v_mov_b32 v161, 0x3f80
    v_lshlrev_b32 v160, v160, v161
    v_bfe_u32 v158, v129, 1, 1
    v_bfe_u32 v159, v129, 3, 2
    v_lshl_add_u32 v159, v159, 1, v158
    v_bfe_u32 v161, v129, 2, 1
    v_xor_b32 v161, v161, v138
    v_lshl_add_u32 v159, v161, 3, v159
    v_lshlrev_b32 v159, v159, 1
    v_lshrrev_b32 v161, 2, v152
    v_xor_b32 v161, v161, v153
    v_lshl_add_u32 v158, v161, 1, v158
    v_lshlrev_b32 v158, v158, 1
    v_bfe_i32 v240, v159, 0, 1
    v_bfe_i32 v241, v159, 1, 1
    v_bfe_i32 v242, v159, 2, 1
    v_bfe_i32 v243, v159, 3, 1
    v_bfe_i32 v244, v159, 4, 1
    v_bfe_i32 v245, v159, 5, 1
    v_bfe_i32 v246, v159, 6, 1
    v_bfe_i32 v247, v159, 7, 1
    v_bfe_i32 v18, v158, 0, 1
    v_bfe_i32 v19, v158, 1, 1
    v_and_b32 v240, v160, v240
    v_and_b32 v241, v160, v241
    v_and_b32 v242, v160, v242
    v_and_b32 v243, v160, v243
    v_and_b32 v244, v160, v244
    v_and_b32 v245, v160, v245
    v_and_b32 v246, v160, v246
    v_and_b32 v247, v160, v247
    v_and_b32 v18, v160, v18
    v_and_b32 v19, v160, v19
    s_mov_b32 s24, s18
    s_mov_b32 s25, s19
    s_mov_b32 s26, 50331648
    s_mov_b32 s27, 0x20000
    s_mov_b32 s52, 0
    s_mov_b32 s80, 0
    s_mov_b32 s81, 98304
    s_mov_b32 s82, 393216
    s_mov_b32 s83, 491520
    s_mov_b32 s53, 1156138217
    s_mov_b32 s58, 0x3c003c00
    s_mov_b32 s85, 150912
    s_mov_b32 s86, 0x37803780
    s_mov_b32 s87, 0xffffffff
    s_mov_b32 s84, 0x37800000
    v_lshrrev_b32 v158, 2, v152
    v_xor_b32 v158, v158, v153
    v_bfe_i32 v158, v158, 0, 1
    v_bfi_b32 v158, v158, 0, s58
    v_accvgpr_write_b32 a228, v158
    v_accvgpr_write_b32 a229, v158
    v_accvgpr_write_b32 a230, v158
    v_accvgpr_write_b32 a231, v158
    v_and_b32 v17, v138, v153
    v_lshlrev_b32 v17, 4, v17
    v_lshrrev_b32 v17, v17, -1
    s_mov_b32 s73, 0x409d2a01
    s_mov_b32 s59, 0x3ef00000
    v_mul_u32_u24 v252, 0x100010, v0
    v_add_u32 v252, 0xc0004, v252
    v_lshlrev_b32 v253, 2, v0
    v_add_u32 v253, 150912, v253
    v_add_u32 v160, 0x0, v252
    v_add_u32 v168, 0x10001000, v252
    v_cvt_f32_f16 v161, v160
    v_cvt_f32_f16 v169, v168
    v_cvt_f32_f16_sdwa v162, v160 dst_sel:DWORD dst_unused:UNUSED_PAD src0_sel:WORD_1
    v_cvt_f32_f16_sdwa v170, v168 dst_sel:DWORD dst_unused:UNUSED_PAD src0_sel:WORD_1
    v_mul_f32 v163, 0x3f7fdde7, v161
    v_mul_f32 v171, 0x3f7fdde7, v169
    v_mul_f32 v164, 0x3f7fdde7, v162
    v_mul_f32 v172, 0x3f7fdde7, v170
    v_fma_f32 v163, v163, v161, s73
    v_fma_f32 v171, v171, v169, s73
    v_fma_f32 v164, v164, v162, s73
    v_fma_f32 v172, v172, v170, s73
    v_mul_f32 v163, -v161, v163
    v_mul_f32 v171, -v169, v171
    v_mul_f32 v164, -v162, v164
    v_mul_f32 v172, -v170, v172
    v_exp_f32 v165, v163
    v_exp_f32 v173, v171
    v_exp_f32 v166, v164
    v_exp_f32 v174, v172
    v_fma_f32 v163, v165, s59, s59
    v_fma_f32 v171, v173, s59, s59
    v_fma_f32 v164, v166, s59, s59
    v_fma_f32 v172, v174, s59, s59
    v_rcp_f32 v163, v163
    v_rcp_f32 v171, v171
    v_rcp_f32 v164, v164
    v_rcp_f32 v172, v172
    v_mul_f32 v163, v161, v163
    v_mul_f32 v171, v169, v171
    v_mul_f32 v164, v162, v164
    v_mul_f32 v172, v170, v172
    v_mul_f32 v165, -v165, v163
    v_mul_f32 v173, -v173, v171
    v_mul_f32 v166, -v166, v164
    v_mul_f32 v174, -v174, v172
    v_cvt_pk_bf16_f32 v167, v165, v166
    v_cvt_pk_bf16_f32 v175, v173, v174
    v_cvt_pk_bf16_f32 v160, v163, v164
    v_cvt_pk_bf16_f32 v168, v171, v172
    ds_write_b32 v253, v167 offset:8192
    ds_write_b32 v253, v160 offset:0
    ds_write_b32 v253, v175 offset:9216
    ds_write_b32 v253, v168 offset:1024
    v_add_u32 v160, 0x20002000, v252
    s_nop 0
    v_add_u32 v168, 0x30003000, v252
    v_cvt_f32_f16 v161, v160
    v_cvt_f32_f16 v169, v168
    v_cvt_f32_f16_sdwa v162, v160 dst_sel:DWORD dst_unused:UNUSED_PAD src0_sel:WORD_1
    v_cvt_f32_f16_sdwa v170, v168 dst_sel:DWORD dst_unused:UNUSED_PAD src0_sel:WORD_1
    v_mul_f32 v163, 0x3f7fdde7, v161
    v_mul_f32 v171, 0x3f7fdde7, v169
    v_mul_f32 v164, 0x3f7fdde7, v162
    v_mul_f32 v172, 0x3f7fdde7, v170
    v_fma_f32 v163, v163, v161, s73
    v_fma_f32 v171, v171, v169, s73
    v_fma_f32 v164, v164, v162, s73
    v_fma_f32 v172, v172, v170, s73
    v_mul_f32 v163, -v161, v163
    v_mul_f32 v171, -v169, v171
    v_mul_f32 v164, -v162, v164
    v_mul_f32 v172, -v170, v172
    v_exp_f32 v165, v163
    v_exp_f32 v173, v171
    v_exp_f32 v166, v164
    v_exp_f32 v174, v172
    v_fma_f32 v163, v165, s59, s59
    v_fma_f32 v171, v173, s59, s59
    v_fma_f32 v164, v166, s59, s59
    v_fma_f32 v172, v174, s59, s59
    v_rcp_f32 v163, v163
    v_rcp_f32 v171, v171
    v_rcp_f32 v164, v164
    v_rcp_f32 v172, v172
    v_mul_f32 v163, v161, v163
    v_mul_f32 v171, v169, v171
    v_mul_f32 v164, v162, v164
    v_mul_f32 v172, v170, v172
    v_mul_f32 v165, -v165, v163
    v_mul_f32 v173, -v173, v171
    v_mul_f32 v166, -v166, v164
    v_mul_f32 v174, -v174, v172
    v_cvt_pk_bf16_f32 v167, v165, v166
    v_cvt_pk_bf16_f32 v175, v173, v174
    v_cvt_pk_bf16_f32 v160, v163, v164
    v_cvt_pk_bf16_f32 v168, v171, v172
    ds_write_b32 v253, v167 offset:10240
    ds_write_b32 v253, v160 offset:2048
    ds_write_b32 v253, v175 offset:11264
    ds_write_b32 v253, v168 offset:3072
    v_add_u32 v160, 0x40004000, v252
    s_nop 0
    v_add_u32 v168, 0x50005000, v252
    v_cvt_f32_f16 v161, v160
    v_cvt_f32_f16 v169, v168
    v_cvt_f32_f16_sdwa v162, v160 dst_sel:DWORD dst_unused:UNUSED_PAD src0_sel:WORD_1
    v_cvt_f32_f16_sdwa v170, v168 dst_sel:DWORD dst_unused:UNUSED_PAD src0_sel:WORD_1
    v_mul_f32 v163, 0x3f7fdde7, v161
    v_mul_f32 v171, 0x40088889, v169
    v_mul_f32 v164, 0x3f7fdde7, v162
    v_mul_f32 v172, 0x40088889, v170
    v_fma_f32 v163, v163, v161, s73
    v_cvt_pk_bf16_f32 v168, v171, v172
    v_fma_f32 v164, v164, v162, s73
    v_mul_f32 v163, -v161, v163
    v_mul_f32 v164, -v162, v164
    v_exp_f32 v165, v163
    v_exp_f32 v166, v164
    v_fma_f32 v163, v165, s59, s59
    v_fma_f32 v164, v166, s59, s59
    v_rcp_f32 v163, v163
    v_rcp_f32 v164, v164
    v_mul_f32 v163, v161, v163
    v_mul_f32 v164, v162, v164
    v_mul_f32 v165, -v165, v163
    v_mul_f32 v166, -v166, v164
    v_cvt_pk_bf16_f32 v167, v165, v166
    v_cvt_pk_bf16_f32 v160, v163, v164
    ds_write_b32 v253, v167 offset:12288
    ds_write_b32 v253, v160 offset:4096
    ds_write_b32 v253, v168 offset:5120
    s_nop 0
    v_add_u32 v160, 0x60006000, v252
    v_add_u32 v168, 0x70007000, v252
    v_cvt_f32_f16 v161, v160
    v_cvt_f32_f16 v169, v168
    v_cvt_f32_f16_sdwa v162, v160 dst_sel:DWORD dst_unused:UNUSED_PAD src0_sel:WORD_1
    v_cvt_f32_f16_sdwa v170, v168 dst_sel:DWORD dst_unused:UNUSED_PAD src0_sel:WORD_1
    v_mul_f32 v163, 0x40088889, v161
    v_mul_f32 v171, 0x40088889, v169
    v_mul_f32 v164, 0x40088889, v162
    v_mul_f32 v172, 0x40088889, v170
    v_cvt_pk_bf16_f32 v160, v163, v164
    v_cvt_pk_bf16_f32 v168, v171, v172
    ds_write_b32 v253, v160 offset:6144
    ds_write_b32 v253, v168 offset:7168
    v_lshlrev_b32 v158, 6, v0
    v_add_u32 v158, 141312, v158
    v_cmp_gt_u32 vcc, 144, v0
    s_nop 1
    v_cndmask_b32 v158, v157, v158, vcc
    v_and_b32 v159, 3, v0
    v_lshl_add_u32 v160, v159, 2, v158
    v_lshrrev_b32 v159, 1, v159
    v_lshl_add_u32 v159, v159, 2, v158
    v_lshlrev_b32 v161, 4, v0
    v_add_u32 v161, 150528, v161
    v_cmp_gt_u32 vcc, 24, v0
    s_nop 1
    v_cndmask_b32 v161, v157, v161, vcc
    v_mov_b32 v164, 0
    v_mov_b32 v165, 0
    v_mov_b32 v166, 0
    v_mov_b32 v167, 0
    ds_write_b128 v158, v[164:167]
    ds_write_b128 v158, v[164:167] offset:16
    s_waitcnt lgkmcnt(9)
    ds_write_b128 v158, v[164:167] offset:32
    ds_write_b128 v158, v[164:167] offset:48
    s_waitcnt vmcnt(14)
    ds_write_b16 v160, v144
    ds_write_b16_d16_hi v160, v144 offset:34
    s_waitcnt vmcnt(13)
    ds_write_b16 v159, v145 offset:16
    ds_write_b16_d16_hi v159, v145 offset:48
    s_waitcnt vmcnt(12) lgkmcnt(13)
    ds_write_b16 v159, v146 offset:24
    ds_write_b16_d16_hi v159, v146 offset:56
    s_waitcnt vmcnt(11)
    v_lshlrev_b32 v168, 16, v148
    v_and_b32 v169, 0xffff0000, v148
    v_lshlrev_b32 v170, 16, v149
    v_and_b32 v171, 0xffff0000, v149
    s_waitcnt vmcnt(10)
    v_lshlrev_b32 v172, 16, v150
    v_and_b32 v173, 0xffff0000, v150
    v_lshlrev_b32 v174, 16, v151
    v_and_b32 v175, 0xffff0000, v151
    v_mul_f32 v168, v168, v172
    v_mul_f32 v169, v169, v173
    v_mul_f32 v170, v170, v174
    v_mul_f32 v171, v171, v175
    s_waitcnt lgkmcnt(14)
    ds_write_b128 v161, v[168:171]
    s_waitcnt vmcnt(9)
    v_mfma_f32_32x32x16_bf16 v[176:191], v[208:211], v[240:243], 0
    v_mfma_f32_32x32x16_bf16 v[176:191], v[208:211], v[244:247], v[176:191]
    s_waitcnt vmcnt(8)
    s_nop 10
    v_mfma_f32_32x32x16_bf16 v[180:195], v[212:215], v[240:243], 0
    v_mfma_f32_32x32x16_bf16 v[180:195], v[212:215], v[244:247], v[180:195]
    s_waitcnt vmcnt(7)
    s_nop 10
    v_mfma_f32_32x32x16_bf16 v[184:199], v[216:219], v[240:243], 0
    v_mfma_f32_32x32x16_bf16 v[184:199], v[216:219], v[244:247], v[184:199]
    s_mov_b32 s74, 0
    s_mov_b32 s75, 6144
    buffer_load_dwordx4 a[0:3], v232, s[48:51], s74 offen offset:0
    buffer_load_dwordx4 a[4:7], v232, s[48:51], s75 offen offset:0
    buffer_load_dwordx4 a[8:11], v232, s[48:51], s74 offen offset:1536
    buffer_load_dwordx4 a[12:15], v232, s[48:51], s75 offen offset:1536
    buffer_load_dwordx4 a[16:19], v232, s[48:51], s74 offen offset:64
    buffer_load_dwordx4 a[20:23], v232, s[48:51], s75 offen offset:64
    buffer_load_dwordx4 a[24:27], v232, s[48:51], s74 offen offset:1600
    buffer_load_dwordx4 a[28:31], v232, s[48:51], s75 offen offset:1600
    buffer_load_dwordx4 a[32:35], v232, s[48:51], s74 offen offset:128
    buffer_load_dwordx4 a[36:39], v232, s[48:51], s75 offen offset:128
    buffer_load_dwordx4 a[40:43], v232, s[48:51], s74 offen offset:1664
    buffer_load_dwordx4 a[44:47], v232, s[48:51], s75 offen offset:1664
    s_mov_b32 s74, 24576
    s_mov_b32 s75, 30720
    buffer_load_dwordx4 a[48:51], v232, s[48:51], s74 offen offset:0
    buffer_load_dwordx4 a[52:55], v232, s[48:51], s75 offen offset:0
    buffer_load_dwordx4 a[56:59], v232, s[48:51], s74 offen offset:1536
    buffer_load_dwordx4 a[60:63], v232, s[48:51], s75 offen offset:1536
    buffer_load_dwordx4 a[64:67], v232, s[48:51], s74 offen offset:64
    buffer_load_dwordx4 a[68:71], v232, s[48:51], s75 offen offset:64
    buffer_load_dwordx4 a[72:75], v232, s[48:51], s74 offen offset:1600
    buffer_load_dwordx4 a[76:79], v232, s[48:51], s75 offen offset:1600
    buffer_load_dwordx4 a[80:83], v232, s[48:51], s74 offen offset:128
    buffer_load_dwordx4 a[84:87], v232, s[48:51], s75 offen offset:128
    buffer_load_dwordx4 a[88:91], v232, s[48:51], s74 offen offset:1664
    buffer_load_dwordx4 a[92:95], v232, s[48:51], s75 offen offset:1664
    s_waitcnt vmcnt(23)
    v_mfma_f32_32x32x16_bf16 v[80:95], a[0:3], v[240:243], 0
    s_waitcnt vmcnt(21)
    v_mfma_f32_32x32x16_bf16 v[96:111], a[8:11], v[240:243], 0
    v_mfma_f32_32x32x16_bf16 v[80:95], a[4:7], v[244:247], v[80:95]
    s_waitcnt vmcnt(20)
    v_mfma_f32_32x32x16_bf16 v[96:111], a[12:15], v[244:247], v[96:111]
    s_waitcnt vmcnt(19)
    v_mfma_f32_32x32x16_bf16 v[112:127], a[16:19], v[240:243], 0
    s_waitcnt vmcnt(17)
    v_mfma_f32_32x32x16_bf16 v[128:143], a[24:27], v[240:243], 0
    v_mfma_f32_32x32x16_bf16 v[112:127], a[20:23], v[244:247], v[112:127]
    s_waitcnt vmcnt(16)
    v_mfma_f32_32x32x16_bf16 v[128:143], a[28:31], v[244:247], v[128:143]
    s_nop 2
    v_pk_mul_f32 v[80:81], v[80:81], v[176:177]
    v_pk_mul_f32 v[84:85], v[84:85], v[176:177]
    v_pk_mul_f32 v[88:89], v[88:89], v[176:177]
    v_pk_mul_f32 v[92:93], v[92:93], v[176:177]
    v_pk_mul_f32 v[96:97], v[96:97], v[176:177]
    v_pk_mul_f32 v[100:101], v[100:101], v[176:177]
    v_pk_mul_f32 v[104:105], v[104:105], v[176:177]
    v_pk_mul_f32 v[108:109], v[108:109], v[176:177]
    v_cvt_pk_bf16_f32 v224, v80, v84
    v_cvt_pk_bf16_f32 v225, v88, v92
    v_cvt_pk_bf16_f32 v226, v96, v100
    v_cvt_pk_bf16_f32 v227, v104, v108
    s_waitcnt vmcnt(15)
    v_mfma_f32_32x32x16_bf16 v[144:159], a[32:35], v[240:243], 0
    s_waitcnt lgkmcnt(14)
    ds_write_b128 v234, v[224:227] offset:6144
    s_mov_b32 s74, 49152
    v_cvt_pk_bf16_f32 v228, v81, v85
    v_cvt_pk_bf16_f32 v229, v89, v93
    v_cvt_pk_bf16_f32 v230, v97, v101
    v_cvt_pk_bf16_f32 v231, v105, v109
    s_waitcnt vmcnt(13)
    v_mfma_f32_32x32x16_bf16 v[160:175], a[40:43], v[240:243], 0
    s_waitcnt lgkmcnt(14)
    ds_write_b128 v235, v[228:231] offset:6144
    s_mov_b32 s75, 55296
    buffer_load_dwordx4 v[32:35], v232, s[48:51], s74 offen offset:0
    v_pk_mul_f32 v[82:83], v[82:83], v[178:179]
    v_pk_mul_f32 v[86:87], v[86:87], v[178:179]
    v_pk_mul_f32 v[90:91], v[90:91], v[178:179]
    v_pk_mul_f32 v[94:95], v[94:95], v[178:179]
    v_pk_mul_f32 v[98:99], v[98:99], v[178:179]
    v_pk_mul_f32 v[102:103], v[102:103], v[178:179]
    v_pk_mul_f32 v[106:107], v[106:107], v[178:179]
    v_pk_mul_f32 v[110:111], v[110:111], v[178:179]
    v_cvt_pk_bf16_f32 v224, v82, v86
    v_cvt_pk_bf16_f32 v225, v90, v94
    v_cvt_pk_bf16_f32 v226, v98, v102
    v_cvt_pk_bf16_f32 v227, v106, v110
    v_mfma_f32_32x32x16_bf16 v[144:159], a[36:39], v[244:247], v[144:159]
    s_waitcnt lgkmcnt(14)
    ds_write_b128 v234, v[224:227] offset:6272
    buffer_load_dwordx4 v[36:39], v232, s[48:51], s75 offen offset:0
    v_cvt_pk_bf16_f32 v228, v83, v87
    v_cvt_pk_bf16_f32 v229, v91, v95
    v_cvt_pk_bf16_f32 v230, v99, v103
    v_cvt_pk_bf16_f32 v231, v107, v111
    s_waitcnt vmcnt(14)
    v_mfma_f32_32x32x16_bf16 v[160:175], a[44:47], v[244:247], v[160:175]
    s_waitcnt vmcnt(10)
    s_waitcnt lgkmcnt(14)
    ds_write_b128 v235, v[228:231] offset:6272
    buffer_load_dwordx4 v[40:43], v232, s[48:51], s74 offen offset:1536
    buffer_load_dwordx4 v[44:47], v232, s[48:51], s75 offen offset:1536
    v_pk_mul_f32 v[112:113], v[112:113], v[180:181]
    v_pk_mul_f32 v[116:117], v[116:117], v[180:181]
    v_pk_mul_f32 v[120:121], v[120:121], v[180:181]
    v_pk_mul_f32 v[124:125], v[124:125], v[180:181]
    v_pk_mul_f32 v[128:129], v[128:129], v[180:181]
    v_pk_mul_f32 v[132:133], v[132:133], v[180:181]
    v_pk_mul_f32 v[136:137], v[136:137], v[180:181]
    v_pk_mul_f32 v[140:141], v[140:141], v[180:181]
    v_cvt_pk_bf16_f32 v224, v112, v116
    v_cvt_pk_bf16_f32 v225, v120, v124
    v_cvt_pk_bf16_f32 v226, v128, v132
    v_cvt_pk_bf16_f32 v227, v136, v140
    v_mfma_f32_32x32x16_bf16 v[80:95], a[48:51], v[240:243], 0
    s_waitcnt lgkmcnt(14)
    ds_write_b128 v234, v[224:227] offset:8192
    buffer_load_dwordx4 v[48:51], v232, s[48:51], s74 offen offset:64
    v_cvt_pk_bf16_f32 v228, v113, v117
    v_cvt_pk_bf16_f32 v229, v121, v125
    v_cvt_pk_bf16_f32 v230, v129, v133
    v_cvt_pk_bf16_f32 v231, v137, v141
    v_mfma_f32_32x32x16_bf16 v[96:111], a[56:59], v[240:243], 0
    s_waitcnt lgkmcnt(14)
    ds_write_b128 v235, v[228:231] offset:8192
    buffer_load_dwordx4 v[52:55], v232, s[48:51], s75 offen offset:64
    v_pk_mul_f32 v[114:115], v[114:115], v[182:183]
    v_pk_mul_f32 v[118:119], v[118:119], v[182:183]
    v_pk_mul_f32 v[122:123], v[122:123], v[182:183]
    v_pk_mul_f32 v[126:127], v[126:127], v[182:183]
    v_pk_mul_f32 v[130:131], v[130:131], v[182:183]
    v_pk_mul_f32 v[134:135], v[134:135], v[182:183]
    v_pk_mul_f32 v[138:139], v[138:139], v[182:183]
    v_pk_mul_f32 v[142:143], v[142:143], v[182:183]
    v_cvt_pk_bf16_f32 v224, v114, v118
    v_cvt_pk_bf16_f32 v225, v122, v126
    v_cvt_pk_bf16_f32 v226, v130, v134
    v_cvt_pk_bf16_f32 v227, v138, v142
    v_mfma_f32_32x32x16_bf16 v[80:95], a[52:55], v[244:247], v[80:95]
    s_waitcnt lgkmcnt(14)
    ds_write_b128 v234, v[224:227] offset:8320
    buffer_load_dwordx4 v[56:59], v232, s[48:51], s74 offen offset:1600
    v_cvt_pk_bf16_f32 v228, v115, v119
    v_cvt_pk_bf16_f32 v229, v123, v127
    v_cvt_pk_bf16_f32 v230, v131, v135
    v_cvt_pk_bf16_f32 v231, v139, v143
    v_mfma_f32_32x32x16_bf16 v[96:111], a[60:63], v[244:247], v[96:111]
    s_waitcnt vmcnt(11)
    s_waitcnt lgkmcnt(14)
    ds_write_b128 v235, v[228:231] offset:8320
    buffer_load_dwordx4 v[60:63], v232, s[48:51], s75 offen offset:1600
    v_pk_mul_f32 v[144:145], v[144:145], v[184:185]
    v_pk_mul_f32 v[148:149], v[148:149], v[184:185]
    v_pk_mul_f32 v[152:153], v[152:153], v[184:185]
    v_pk_mul_f32 v[156:157], v[156:157], v[184:185]
    v_pk_mul_f32 v[160:161], v[160:161], v[184:185]
    v_pk_mul_f32 v[164:165], v[164:165], v[184:185]
    v_pk_mul_f32 v[168:169], v[168:169], v[184:185]
    v_pk_mul_f32 v[172:173], v[172:173], v[184:185]
    v_cvt_pk_bf16_f32 v224, v144, v148
    v_cvt_pk_bf16_f32 v225, v152, v156
    v_cvt_pk_bf16_f32 v226, v160, v164
    v_cvt_pk_bf16_f32 v227, v168, v172
    v_mfma_f32_32x32x16_bf16 v[112:127], a[64:67], v[240:243], 0
    s_waitcnt lgkmcnt(14)
    ds_write_b128 v234, v[224:227] offset:10240
    buffer_load_dwordx4 v[64:67], v232, s[48:51], s74 offen offset:128
    v_cvt_pk_bf16_f32 v228, v145, v149
    v_cvt_pk_bf16_f32 v229, v153, v157
    v_cvt_pk_bf16_f32 v230, v161, v165
    v_cvt_pk_bf16_f32 v231, v169, v173
    v_mfma_f32_32x32x16_bf16 v[128:143], a[72:75], v[240:243], 0
    s_waitcnt lgkmcnt(14)
    ds_write_b128 v235, v[228:231] offset:10240
    buffer_load_dwordx4 v[68:71], v232, s[48:51], s75 offen offset:128
    v_pk_mul_f32 v[146:147], v[146:147], v[186:187]
    v_pk_mul_f32 v[150:151], v[150:151], v[186:187]
    v_pk_mul_f32 v[154:155], v[154:155], v[186:187]
    v_pk_mul_f32 v[158:159], v[158:159], v[186:187]
    v_pk_mul_f32 v[162:163], v[162:163], v[186:187]
    v_pk_mul_f32 v[166:167], v[166:167], v[186:187]
    v_pk_mul_f32 v[170:171], v[170:171], v[186:187]
    v_pk_mul_f32 v[174:175], v[174:175], v[186:187]
    v_cvt_pk_bf16_f32 v224, v146, v150
    v_cvt_pk_bf16_f32 v225, v154, v158
    v_cvt_pk_bf16_f32 v226, v162, v166
    v_cvt_pk_bf16_f32 v227, v170, v174
    v_mfma_f32_32x32x16_bf16 v[112:127], a[68:71], v[244:247], v[112:127]
    s_waitcnt lgkmcnt(14)
    ds_write_b128 v234, v[224:227] offset:10368
    buffer_load_dwordx4 v[72:75], v232, s[48:51], s74 offen offset:1664
    v_cvt_pk_bf16_f32 v228, v147, v151
    v_cvt_pk_bf16_f32 v229, v155, v159
    v_cvt_pk_bf16_f32 v230, v163, v167
    v_cvt_pk_bf16_f32 v231, v171, v175
    v_mfma_f32_32x32x16_bf16 v[128:143], a[76:79], v[244:247], v[128:143]
    s_waitcnt vmcnt(11)
    s_waitcnt lgkmcnt(14)
    ds_write_b128 v235, v[228:231] offset:10368
    buffer_load_dwordx4 v[76:79], v232, s[48:51], s75 offen offset:1664
    v_sub_u32 v234, v234, v238
    v_sub_u32 v235, v235, v238
    v_pk_mul_f32 v[80:81], v[80:81], v[176:177]
    v_pk_mul_f32 v[84:85], v[84:85], v[176:177]
    v_pk_mul_f32 v[88:89], v[88:89], v[176:177]
    v_pk_mul_f32 v[92:93], v[92:93], v[176:177]
    v_pk_mul_f32 v[96:97], v[96:97], v[176:177]
    v_pk_mul_f32 v[100:101], v[100:101], v[176:177]
    v_pk_mul_f32 v[104:105], v[104:105], v[176:177]
    v_pk_mul_f32 v[108:109], v[108:109], v[176:177]
    v_cvt_pk_bf16_f32 v224, v80, v84
    v_cvt_pk_bf16_f32 v225, v88, v92
    v_cvt_pk_bf16_f32 v226, v96, v100
    v_cvt_pk_bf16_f32 v227, v104, v108
    v_mfma_f32_32x32x16_bf16 v[144:159], a[80:83], v[240:243], 0
    s_waitcnt lgkmcnt(14)
    ds_write_b128 v234, v[224:227] offset:6144
    s_add_u32 m0, s56, 6336
    s_nop 0
    buffer_load_dwordx4 v1, s[20:23], 0 offen offset:64 lds
    v_cvt_pk_bf16_f32 v228, v81, v85
    v_cvt_pk_bf16_f32 v229, v89, v93
    v_cvt_pk_bf16_f32 v230, v97, v101
    v_cvt_pk_bf16_f32 v231, v105, v109
    v_mfma_f32_32x32x16_bf16 v[160:175], a[88:91], v[240:243], 0
    s_waitcnt lgkmcnt(14)
    ds_write_b128 v235, v[228:231] offset:6144
    s_add_u32 m0, s56, 7360
    s_nop 0
    buffer_load_dwordx4 v2, s[20:23], 0 offen offset:64 lds
    v_pk_mul_f32 v[82:83], v[82:83], v[178:179]
    v_pk_mul_f32 v[86:87], v[86:87], v[178:179]
    v_pk_mul_f32 v[90:91], v[90:91], v[178:179]
    v_pk_mul_f32 v[94:95], v[94:95], v[178:179]
    v_pk_mul_f32 v[98:99], v[98:99], v[178:179]
    v_pk_mul_f32 v[102:103], v[102:103], v[178:179]
    v_pk_mul_f32 v[106:107], v[106:107], v[178:179]
    v_pk_mul_f32 v[110:111], v[110:111], v[178:179]
    v_cvt_pk_bf16_f32 v224, v82, v86
    v_cvt_pk_bf16_f32 v225, v90, v94
    v_cvt_pk_bf16_f32 v226, v98, v102
    v_cvt_pk_bf16_f32 v227, v106, v110
    v_mfma_f32_32x32x16_bf16 v[144:159], a[84:87], v[244:247], v[144:159]
    s_waitcnt lgkmcnt(14)
    ds_write_b128 v234, v[224:227] offset:6272
    s_add_u32 m0, s56, 8384
    s_nop 0
    buffer_load_dwordx4 v3, s[20:23], 0 offen offset:64 lds
    v_cvt_pk_bf16_f32 v228, v83, v87
    v_cvt_pk_bf16_f32 v229, v91, v95
    v_cvt_pk_bf16_f32 v230, v99, v103
    v_cvt_pk_bf16_f32 v231, v107, v111
    v_mfma_f32_32x32x16_bf16 v[160:175], a[92:95], v[244:247], v[160:175]
    s_waitcnt vmcnt(11)
    s_waitcnt lgkmcnt(14)
    ds_write_b128 v235, v[228:231] offset:6272
    s_add_u32 m0, s56, 9408
    s_nop 0
    buffer_load_dwordx4 v4, s[20:23], 0 offen offset:64 lds
    v_pk_mul_f32 v[112:113], v[112:113], v[180:181]
    v_pk_mul_f32 v[116:117], v[116:117], v[180:181]
    v_pk_mul_f32 v[120:121], v[120:121], v[180:181]
    v_pk_mul_f32 v[124:125], v[124:125], v[180:181]
    v_pk_mul_f32 v[128:129], v[128:129], v[180:181]
    v_pk_mul_f32 v[132:133], v[132:133], v[180:181]
    v_pk_mul_f32 v[136:137], v[136:137], v[180:181]
    v_pk_mul_f32 v[140:141], v[140:141], v[180:181]
    v_cvt_pk_bf16_f32 v224, v112, v116
    v_cvt_pk_bf16_f32 v225, v120, v124
    v_cvt_pk_bf16_f32 v226, v128, v132
    v_cvt_pk_bf16_f32 v227, v136, v140
    v_mfma_f32_32x32x16_bf16 v[80:95], v[32:35], v[240:243], 0
    s_waitcnt lgkmcnt(0)
    s_barrier
    ds_write_b128 v234, v[224:227] offset:8192
    ds_read_b128 a[192:195], v23 offset:4096
    ds_read_b128 a[196:199], v23 offset:5120
    ds_read_b128 a[200:203], v23 offset:14336
    ds_read_b128 a[204:207], v23 offset:15360
    ds_read_b128 a[208:211], v23 offset:24576
    ds_read_b128 a[212:215], v23 offset:25600
    ds_read_b128 a[216:219], v23 offset:34816
    s_add_u32 m0, s56, 10432
    v_cvt_pk_bf16_f32 v228, v113, v117
    v_cvt_pk_bf16_f32 v229, v121, v125
    v_cvt_pk_bf16_f32 v230, v129, v133
    v_cvt_pk_bf16_f32 v231, v137, v141
    v_mfma_f32_32x32x16_bf16 v[96:111], v[40:43], v[240:243], 0
    ds_write_b128 v235, v[228:231] offset:8192
    ds_read_b128 a[220:223], v23 offset:35840
    ds_read_b128 a[0:3], v24 offset:0
    ds_read_b128 a[4:7], v24 offset:1024
    ds_read_b128 a[24:27], v24 offset:6144
    ds_read_b128 a[28:31], v24 offset:7168
    ds_read_b128 a[96:99], v24 offset:24576
    s_waitcnt lgkmcnt(14)
    ds_read_b128 a[100:103], v24 offset:25600
    buffer_load_dwordx4 v5, s[20:23], 0 offen offset:64 lds
    s_add_u32 m0, s56, 11456
    v_pk_mul_f32 v[114:115], v[114:115], v[182:183]
    v_pk_mul_f32 v[118:119], v[118:119], v[182:183]
    v_pk_mul_f32 v[122:123], v[122:123], v[182:183]
    v_pk_mul_f32 v[126:127], v[126:127], v[182:183]
    v_pk_mul_f32 v[130:131], v[130:131], v[182:183]
    v_pk_mul_f32 v[134:135], v[134:135], v[182:183]
    v_pk_mul_f32 v[138:139], v[138:139], v[182:183]
    v_pk_mul_f32 v[142:143], v[142:143], v[182:183]
    v_cvt_pk_bf16_f32 v224, v114, v118
    v_cvt_pk_bf16_f32 v225, v122, v126
    v_cvt_pk_bf16_f32 v226, v130, v134
    v_cvt_pk_bf16_f32 v227, v138, v142
    v_mfma_f32_32x32x16_bf16 v[80:95], v[36:39], v[244:247], v[80:95]
    s_waitcnt lgkmcnt(9)
    ds_write_b128 v234, v[224:227] offset:8320
    ds_read_b128 a[120:123], v24 offset:30720
    ds_read_b128 a[124:127], v24 offset:31744
    ds_read_b128 a[144:147], v24 offset:36864
    ds_read_b128 a[148:151], v24 offset:37888
    ds_read_b128 a[168:171], v24 offset:43008
    s_waitcnt lgkmcnt(13)
    ds_read_b128 a[172:175], v24 offset:44032
    ds_read_b128 a[48:51], v24 offset:12288
    buffer_load_dwordx4 v6, s[20:23], 0 offen offset:64 lds
    s_add_u32 m0, s56, 12480
    v_cvt_pk_bf16_f32 v228, v115, v119
    v_cvt_pk_bf16_f32 v229, v123, v127
    v_cvt_pk_bf16_f32 v230, v131, v135
    v_cvt_pk_bf16_f32 v231, v139, v143
    v_mfma_f32_32x32x16_bf16 v[96:111], v[44:47], v[244:247], v[96:111]
    s_waitcnt vmcnt(10)
    s_waitcnt lgkmcnt(9)
    ds_write_b128 v235, v[228:231] offset:8320
    ds_read_b128 a[52:55], v24 offset:13312
    ds_read_b128 a[72:75], v24 offset:18432
    ds_read_b128 a[76:79], v24 offset:19456
    ds_read_b128 a[8:11], v24 offset:2048
    ds_read_b128 a[12:15], v24 offset:3072
    s_waitcnt lgkmcnt(13)
    ds_read_b128 a[32:35], v24 offset:8192
    ds_read_b128 a[36:39], v24 offset:9216
    buffer_load_dword v7, s[20:23], 0 offen offset:64 lds
    buffer_load_dword v254, v31, s[20:23], 0 offen
    v_pk_mul_f32 v[144:145], v[144:145], v[184:185]
    v_pk_mul_f32 v[148:149], v[148:149], v[184:185]
    v_pk_mul_f32 v[152:153], v[152:153], v[184:185]
    v_pk_mul_f32 v[156:157], v[156:157], v[184:185]
    v_pk_mul_f32 v[160:161], v[160:161], v[184:185]
    v_pk_mul_f32 v[164:165], v[164:165], v[184:185]
    v_pk_mul_f32 v[168:169], v[168:169], v[184:185]
    v_pk_mul_f32 v[172:173], v[172:173], v[184:185]
    v_cvt_pk_bf16_f32 v224, v144, v148
    v_cvt_pk_bf16_f32 v225, v152, v156
    v_cvt_pk_bf16_f32 v226, v160, v164
    v_cvt_pk_bf16_f32 v227, v168, v172
    v_mfma_f32_32x32x16_bf16 v[112:127], v[48:51], v[240:243], 0
    s_waitcnt lgkmcnt(9)
    ds_write_b128 v234, v[224:227] offset:10240
    ds_read_b128 a[104:107], v24 offset:26624
    ds_read_b128 a[108:111], v24 offset:27648
    ds_read_b128 a[128:131], v24 offset:32768
    ds_read_b128 a[132:135], v24 offset:33792
    ds_read_b128 a[152:155], v24 offset:38912
    s_waitcnt lgkmcnt(13)
    ds_read_b128 a[156:159], v24 offset:39936
    ds_read_b128 a[176:179], v24 offset:45056
    v_cvt_pk_bf16_f32 v228, v145, v149
    v_cvt_pk_bf16_f32 v229, v153, v157
    v_cvt_pk_bf16_f32 v230, v161, v165
    v_cvt_pk_bf16_f32 v231, v169, v173
    v_mfma_f32_32x32x16_bf16 v[128:143], v[56:59], v[240:243], 0
    s_waitcnt lgkmcnt(9)
    ds_write_b128 v235, v[228:231] offset:10240
    ds_read_b128 a[180:183], v24 offset:46080
    ds_read_b128 a[56:59], v24 offset:14336
    ds_read_b128 a[60:63], v24 offset:15360
    ds_read_b128 a[80:83], v24 offset:20480
    ds_read_b128 a[84:87], v24 offset:21504
    s_waitcnt lgkmcnt(13)
    ds_read_b128 a[16:19], v24 offset:4096
    ds_read_b128 a[20:23], v24 offset:5120
    v_pk_mul_f32 v[146:147], v[146:147], v[186:187]
    v_pk_mul_f32 v[150:151], v[150:151], v[186:187]
    v_pk_mul_f32 v[154:155], v[154:155], v[186:187]
    v_pk_mul_f32 v[158:159], v[158:159], v[186:187]
    v_pk_mul_f32 v[162:163], v[162:163], v[186:187]
    v_pk_mul_f32 v[166:167], v[166:167], v[186:187]
    v_pk_mul_f32 v[170:171], v[170:171], v[186:187]
    v_pk_mul_f32 v[174:175], v[174:175], v[186:187]
    v_cvt_pk_bf16_f32 v224, v146, v150
    v_cvt_pk_bf16_f32 v225, v154, v158
    v_cvt_pk_bf16_f32 v226, v162, v166
    v_cvt_pk_bf16_f32 v227, v170, v174
    v_mfma_f32_32x32x16_bf16 v[112:127], v[52:55], v[244:247], v[112:127]
    s_waitcnt lgkmcnt(9)
    ds_write_b128 v234, v[224:227] offset:10368
    ds_read_b128 a[40:43], v24 offset:10240
    ds_read_b128 a[44:47], v24 offset:11264
    ds_read_b128 a[112:115], v24 offset:28672
    ds_read_b128 a[116:119], v24 offset:29696
    ds_read_b128 a[136:139], v24 offset:34816
    s_waitcnt lgkmcnt(13)
    ds_read_b128 a[140:143], v24 offset:35840
    ds_read_b128 a[160:163], v24 offset:40960
    v_cvt_pk_bf16_f32 v228, v147, v151
    v_cvt_pk_bf16_f32 v229, v155, v159
    v_cvt_pk_bf16_f32 v230, v163, v167
    v_cvt_pk_bf16_f32 v231, v171, v175
    v_mfma_f32_32x32x16_bf16 v[128:143], v[60:63], v[244:247], v[128:143]
    s_waitcnt vmcnt(8)
    s_waitcnt lgkmcnt(9)
    ds_write_b128 v235, v[228:231] offset:10368
    ds_read_b128 a[164:167], v24 offset:41984
    ds_read_b128 a[184:187], v24 offset:47104
    ds_read_b128 a[188:191], v24 offset:48128
    ds_read_b128 a[64:67], v24 offset:16384
    ds_read_b128 a[68:71], v24 offset:17408
    s_waitcnt lgkmcnt(13)
    ds_read_b128 a[88:91], v24 offset:22528
    ds_read_b128 a[92:95], v24 offset:23552
    v_add_u32 v234, v234, v238
    v_add_u32 v235, v235, v238
    v_pk_mul_f32 v[80:81], v[80:81], v[176:177]
    v_pk_mul_f32 v[84:85], v[84:85], v[176:177]
    v_pk_mul_f32 v[88:89], v[88:89], v[176:177]
    v_pk_mul_f32 v[92:93], v[92:93], v[176:177]
    v_pk_mul_f32 v[96:97], v[96:97], v[176:177]
    v_pk_mul_f32 v[100:101], v[100:101], v[176:177]
    v_pk_mul_f32 v[104:105], v[104:105], v[176:177]
    v_pk_mul_f32 v[108:109], v[108:109], v[176:177]
    v_cvt_pk_bf16_f32 v224, v80, v84
    v_cvt_pk_bf16_f32 v225, v88, v92
    v_cvt_pk_bf16_f32 v226, v96, v100
    v_cvt_pk_bf16_f32 v227, v104, v108
    v_mfma_f32_32x32x16_bf16 v[144:159], v[64:67], v[240:243], 0
    s_waitcnt lgkmcnt(0)
    s_barrier
    ds_write_b128 v234, v[224:227] offset:6144
    v_cvt_pk_bf16_f32 v228, v81, v85
    v_cvt_pk_bf16_f32 v229, v89, v93
    v_cvt_pk_bf16_f32 v230, v97, v101
    v_cvt_pk_bf16_f32 v231, v105, v109
    v_mfma_f32_32x32x16_bf16 v[160:175], v[72:75], v[240:243], 0
    ds_write_b128 v235, v[228:231] offset:6144
    v_pk_mul_f32 v[82:83], v[82:83], v[178:179]
    v_pk_mul_f32 v[86:87], v[86:87], v[178:179]
    v_pk_mul_f32 v[90:91], v[90:91], v[178:179]
    v_pk_mul_f32 v[94:95], v[94:95], v[178:179]
    v_pk_mul_f32 v[98:99], v[98:99], v[178:179]
    v_pk_mul_f32 v[102:103], v[102:103], v[178:179]
    v_pk_mul_f32 v[106:107], v[106:107], v[178:179]
    v_pk_mul_f32 v[110:111], v[110:111], v[178:179]
    v_cvt_pk_bf16_f32 v224, v82, v86
    v_cvt_pk_bf16_f32 v225, v90, v94
    v_cvt_pk_bf16_f32 v226, v98, v102
    v_cvt_pk_bf16_f32 v227, v106, v110
    v_mfma_f32_32x32x16_bf16 v[144:159], v[68:71], v[244:247], v[144:159]
    ds_write_b128 v234, v[224:227] offset:6272
    v_cvt_pk_bf16_f32 v228, v83, v87
    v_cvt_pk_bf16_f32 v229, v91, v95
    v_cvt_pk_bf16_f32 v230, v99, v103
    v_cvt_pk_bf16_f32 v231, v107, v111
    v_mfma_f32_32x32x16_bf16 v[160:175], v[76:79], v[244:247], v[160:175]
    ds_write_b128 v235, v[228:231] offset:6272
    v_pk_mul_f32 v[112:113], v[112:113], v[180:181]
    v_pk_mul_f32 v[116:117], v[116:117], v[180:181]
    v_pk_mul_f32 v[120:121], v[120:121], v[180:181]
    v_pk_mul_f32 v[124:125], v[124:125], v[180:181]
    v_pk_mul_f32 v[128:129], v[128:129], v[180:181]
    v_pk_mul_f32 v[132:133], v[132:133], v[180:181]
    v_pk_mul_f32 v[136:137], v[136:137], v[180:181]
    v_pk_mul_f32 v[140:141], v[140:141], v[180:181]
    v_cvt_pk_bf16_f32 v224, v112, v116
    v_cvt_pk_bf16_f32 v225, v120, v124
    v_cvt_pk_bf16_f32 v226, v128, v132
    v_cvt_pk_bf16_f32 v227, v136, v140
    ds_write_b128 v234, v[224:227] offset:8192
    v_cvt_pk_bf16_f32 v228, v113, v117
    v_cvt_pk_bf16_f32 v229, v121, v125
    v_cvt_pk_bf16_f32 v230, v129, v133
    v_cvt_pk_bf16_f32 v231, v137, v141
    ds_write_b128 v235, v[228:231] offset:8192
    v_pk_mul_f32 v[114:115], v[114:115], v[182:183]
    v_pk_mul_f32 v[118:119], v[118:119], v[182:183]
    v_pk_mul_f32 v[122:123], v[122:123], v[182:183]
    v_pk_mul_f32 v[126:127], v[126:127], v[182:183]
    v_pk_mul_f32 v[130:131], v[130:131], v[182:183]
    v_pk_mul_f32 v[134:135], v[134:135], v[182:183]
    v_pk_mul_f32 v[138:139], v[138:139], v[182:183]
    v_pk_mul_f32 v[142:143], v[142:143], v[182:183]
    v_cvt_pk_bf16_f32 v224, v114, v118
    v_cvt_pk_bf16_f32 v225, v122, v126
    v_cvt_pk_bf16_f32 v226, v130, v134
    v_cvt_pk_bf16_f32 v227, v138, v142
    ds_write_b128 v234, v[224:227] offset:8320
    v_cvt_pk_bf16_f32 v228, v115, v119
    v_cvt_pk_bf16_f32 v229, v123, v127
    v_cvt_pk_bf16_f32 v230, v131, v135
    v_cvt_pk_bf16_f32 v231, v139, v143
    ds_write_b128 v235, v[228:231] offset:8320
    v_pk_mul_f32 v[144:145], v[144:145], v[184:185]
    v_pk_mul_f32 v[148:149], v[148:149], v[184:185]
    v_pk_mul_f32 v[152:153], v[152:153], v[184:185]
    v_pk_mul_f32 v[156:157], v[156:157], v[184:185]
    v_pk_mul_f32 v[160:161], v[160:161], v[184:185]
    v_pk_mul_f32 v[164:165], v[164:165], v[184:185]
    v_pk_mul_f32 v[168:169], v[168:169], v[184:185]
    v_pk_mul_f32 v[172:173], v[172:173], v[184:185]
    v_cvt_pk_bf16_f32 v224, v144, v148
    v_cvt_pk_bf16_f32 v225, v152, v156
    v_cvt_pk_bf16_f32 v226, v160, v164
    v_cvt_pk_bf16_f32 v227, v168, v172
    ds_write_b128 v234, v[224:227] offset:10240
    v_cvt_pk_bf16_f32 v228, v145, v149
    v_cvt_pk_bf16_f32 v229, v153, v157
    v_cvt_pk_bf16_f32 v230, v161, v165
    v_cvt_pk_bf16_f32 v231, v169, v173
    ds_write_b128 v235, v[228:231] offset:10240
    v_pk_mul_f32 v[146:147], v[146:147], v[186:187]
    v_pk_mul_f32 v[150:151], v[150:151], v[186:187]
    v_pk_mul_f32 v[154:155], v[154:155], v[186:187]
    v_pk_mul_f32 v[158:159], v[158:159], v[186:187]
    v_pk_mul_f32 v[162:163], v[162:163], v[186:187]
    v_pk_mul_f32 v[166:167], v[166:167], v[186:187]
    v_pk_mul_f32 v[170:171], v[170:171], v[186:187]
    v_pk_mul_f32 v[174:175], v[174:175], v[186:187]
    v_cvt_pk_bf16_f32 v224, v146, v150
    v_cvt_pk_bf16_f32 v225, v154, v158
    v_cvt_pk_bf16_f32 v226, v162, v166
    v_cvt_pk_bf16_f32 v227, v170, v174
    ds_write_b128 v234, v[224:227] offset:10368
    v_cvt_pk_bf16_f32 v228, v147, v151
    v_cvt_pk_bf16_f32 v229, v155, v159
    v_cvt_pk_bf16_f32 v230, v163, v167
    v_cvt_pk_bf16_f32 v231, v171, v175
    ds_write_b128 v235, v[228:231] offset:10368
    s_branch L_conv0
L_prb0:
    v_lshrrev_b32 v131, 4, v129
    v_add_u32 v131, 96, v131
    v_mul_u32_u24 v130, 205, v131
    v_mul_u32_u24 v131, 192, v131
    v_add_u32 v131, s64, v131
    v_lshlrev_b32 v133, 2, v129
    v_and_b32 v133, 63, v133
    v_lshrrev_b32 v134, 11, v130
    v_subrev_u32 v135, s65, v130
    v_mad_u32_u24 v134, v134, s68, v131
    v_and_b32 v135, 0x7ff, v135
    v_cmp_gt_u32 vcc, s66, v135
    v_lshrrev_b32 v135, 7, v130
    v_and_b32 v135, 32, v135
    v_xad_u32 v134, v133, v135, v134
    v_cndmask_b32 v7, v136, v134, vcc
    s_add_u32 m0, s56, 6144
    s_nop 0
    buffer_load_dword v7, s[20:23], 0 offen offset:0 lds
    v_lshrrev_b32 v131, 2, v129
    v_mul_u32_u24 v130, 205, v131
    v_mul_u32_u24 v131, 192, v131
    v_add_u32 v131, s64, v131
    v_lshrrev_b32 v134, 11, v130
    v_subrev_u32 v135, s65, v130
    v_mad_u32_u24 v134, v134, s68, v131
    v_and_b32 v135, 0x7ff, v135
    v_cmp_gt_u32 vcc, s66, v135
    v_lshrrev_b32 v135, 7, v130
    v_and_b32 v135, 32, v135
    v_xad_u32 v134, v132, v135, v134
    v_cndmask_b32 v1, v136, v134, vcc
    v_add_u32 v130, 3280, v130
    v_add_u32 v131, 3072, v131
    v_lshrrev_b32 v134, 11, v130
    v_subrev_u32 v135, s65, v130
    v_mad_u32_u24 v134, v134, s68, v131
    v_and_b32 v135, 0x7ff, v135
    v_cmp_gt_u32 vcc, s66, v135
    v_lshrrev_b32 v135, 7, v130
    v_and_b32 v135, 32, v135
    v_xad_u32 v134, v132, v135, v134
    v_cndmask_b32 v2, v136, v134, vcc
    v_add_u32 v130, 3280, v130
    v_add_u32 v131, 3072, v131
    v_lshrrev_b32 v134, 11, v130
    v_subrev_u32 v135, s65, v130
    v_mad_u32_u24 v134, v134, s68, v131
    v_and_b32 v135, 0x7ff, v135
    v_cmp_gt_u32 vcc, s66, v135
    v_lshrrev_b32 v135, 7, v130
    v_and_b32 v135, 32, v135
    v_xad_u32 v134, v132, v135, v134
    v_cndmask_b32 v3, v136, v134, vcc
    v_add_u32 v130, 3280, v130
    v_add_u32 v131, 3072, v131
    v_lshrrev_b32 v134, 11, v130
    v_subrev_u32 v135, s65, v130
    v_mad_u32_u24 v134, v134, s68, v131
    v_and_b32 v135, 0x7ff, v135
    v_cmp_gt_u32 vcc, s66, v135
    v_lshrrev_b32 v135, 7, v130
    v_and_b32 v135, 32, v135
    v_xad_u32 v134, v132, v135, v134
    v_cndmask_b32 v4, v136, v134, vcc
    v_add_u32 v130, 3280, v130
    v_add_u32 v131, 3072, v131
    v_lshrrev_b32 v134, 11, v130
    v_subrev_u32 v135, s65, v130
    v_mad_u32_u24 v134, v134, s68, v131
    v_and_b32 v135, 0x7ff, v135
    v_cmp_gt_u32 vcc, s66, v135
    v_lshrrev_b32 v135, 7, v130
    v_and_b32 v135, 32, v135
    v_xad_u32 v134, v132, v135, v134
    v_cndmask_b32 v5, v136, v134, vcc
    v_add_u32 v130, 3280, v130
    v_add_u32 v131, 3072, v131
    v_lshrrev_b32 v134, 11, v130
    v_subrev_u32 v135, s65, v130
    v_mad_u32_u24 v134, v134, s68, v131
    v_and_b32 v135, 0x7ff, v135
    v_cmp_gt_u32 vcc, s66, v135
    v_lshrrev_b32 v135, 7, v130
    v_and_b32 v135, 32, v135
    v_xad_u32 v134, v132, v135, v134
    v_cndmask_b32 v6, v136, v134, vcc
    s_cmp_lt_u32 s55, 63
    s_cselect_b32 s66, 10, 0
    s_add_u32 s64, s64, 1856
    v_mul_u32_u24 v134, 98304, v129
    v_add_u32 v134, s64, v134
    v_cmp_gt_u32 vcc, s66, v129
    s_nop 1
    v_cndmask_b32 v31, v136, v134, vcc
    v_mov_b32 v157, 268435456
    v_and_b32 v152, 15, v129
    v_lshrrev_b32 v153, 4, v129
    v_add_u32 v154, 4, v152
    v_lshrrev_b32 v154, 3, v154
    v_mad_i32_i24 v155, v154, -4, v152
    v_and_b32 v154, 1, v154
    v_and_b32 v156, 1, v153
    v_lshlrev_b32 v158, 1, v154
    v_mul_u32_u24 v159, 98304, v158
    v_mad_u32_u24 v159, v155, s69, v159
    v_lshl_add_u32 v159, v153, 4, v159
    v_add_u32 v26, s63, v159
    v_xor_b32 v26, 0x80000000, v26
    s_mov_b32 s54, 2147483648
    v_xor_b32 v161, v154, v138
    v_add_u32 v159, v153, v158
    v_add_u32 v160, 0, v155
    v_mad_u32_u24 v159, v159, 10, v160
    v_bfe_u32 v160, v159, 2, 1
    v_lshl_or_b32 v160, v161, 1, v160
    v_lshl_add_u32 v160, v159, 2, v160
    v_lshl_add_u32 v8, v160, 4, s56
    v_add_u32 v162, 1, v156
    v_add_u32 v159, v138, v158
    v_add_u32 v160, v162, v155
    v_mad_u32_u24 v159, v159, 10, v160
    v_bfe_u32 v160, v159, 2, 1
    v_lshl_or_b32 v160, v154, 1, v160
    v_lshl_add_u32 v160, v159, 2, v160
    v_lshl_add_u32 v12, v160, 4, s56
    v_xor_b32 v9, 16, v8
    v_xor_b32 v10, 32, v8
    v_xor_b32 v11, 48, v8
    v_xor_b32 v13, 16, v12
    v_xor_b32 v14, 32, v12
    v_xor_b32 v15, 48, v12
    v_add_u32 v159, 1, v158
    v_add_u32 v160, 1, v155
    v_mad_u32_u24 v159, v159, 10, v160
    v_bfe_u32 v160, v159, 2, 1
    v_lshl_or_b32 v160, v154, 1, v160
    v_xor_b32 v160, v153, v160
    v_lshl_add_u32 v160, v159, 2, v160
    v_lshl_add_u32 v20, v160, 4, s56
    v_xor_b32 v161, 1, v154
    v_add_u32 v159, 2, v158
    v_add_u32 v160, 1, v155
    v_mad_u32_u24 v159, v159, 10, v160
    v_bfe_u32 v160, v159, 2, 1
    v_lshl_or_b32 v160, v161, 1, v160
    v_xor_b32 v160, v153, v160
    v_lshl_add_u32 v160, v159, 2, v160
    v_lshl_add_u32 v21, v160, 4, s56
    v_bfe_u32 v158, v152, 2, 1
    v_sub_u32 v158, v153, v158
    v_and_b32 v159, 3, v152
    v_mul_u32_u24 v16, 0x1111, v159
    v_lshrrev_b32 v160, 3, v152
    v_lshl_add_u32 v159, v160, 2, v159
    v_lshlrev_b32 v159, 5, v159
    v_add_u32 v159, 141312, v159
    s_movk_i32 s70, 3072
    v_cmp_gt_u32 vcc, 3, v158
    v_mad_u32_u24 v159, v158, s70, v159
    s_nop 0
    v_cndmask_b32 v22, v157, v159, vcc
    v_lshlrev_b32 v23, 4, v129
    v_add_u32 v24, 40960, v23
    v_lshlrev_b32 v25, 5, v153
    v_add_u32 v25, 150528, v25
    v_and_b32 v160, 1, v129
    v_lshlrev_b32 v160, 4, v160
    v_mov_b32 v161, 0x3f80
    v_lshlrev_b32 v160, v160, v161
    v_bfe_u32 v158, v129, 1, 1
    v_bfe_u32 v159, v129, 3, 2
    v_lshl_add_u32 v159, v159, 1, v158
    v_bfe_u32 v161, v129, 2, 1
    v_xor_b32 v161, v161, v138
    v_lshl_add_u32 v159, v161, 3, v159
    v_lshlrev_b32 v159, v159, 1
    v_lshrrev_b32 v161, 2, v152
    v_xor_b32 v161, v161, v153
    v_lshl_add_u32 v158, v161, 1, v158
    v_lshlrev_b32 v158, v158, 1
    v_bfe_i32 v240, v159, 0, 1
    v_bfe_i32 v241, v159, 1, 1
    v_bfe_i32 v242, v159, 2, 1
    v_bfe_i32 v243, v159, 3, 1
    v_bfe_i32 v244, v159, 4, 1
    v_bfe_i32 v245, v159, 5, 1
    v_bfe_i32 v246, v159, 6, 1
    v_bfe_i32 v247, v159, 7, 1
    v_bfe_i32 v18, v158, 0, 1
    v_bfe_i32 v19, v158, 1, 1
    v_and_b32 v240, v160, v240
    v_and_b32 v241, v160, v241
    v_and_b32 v242, v160, v242
    v_and_b32 v243, v160, v243
    v_and_b32 v244, v160, v244
    v_and_b32 v245, v160, v245
    v_and_b32 v246, v160, v246
    v_and_b32 v247, v160, v247
    v_and_b32 v18, v160, v18
    v_and_b32 v19, v160, v19
    s_mov_b32 s24, s18
    s_mov_b32 s25, s19
    s_mov_b32 s26, 50331648
    s_mov_b32 s27, 0x20000
    s_mov_b32 s52, 0
    s_mov_b32 s80, 0
    s_mov_b32 s81, 98304
    s_mov_b32 s82, 393216
    s_mov_b32 s83, 491520
    s_mov_b32 s53, 1156138217
    s_mov_b32 s58, 0x3c003c00
    s_mov_b32 s85, 150912
    s_mov_b32 s86, 0x37803780
    s_mov_b32 s87, 0xffffffff
    s_mov_b32 s84, 0x37800000
    v_lshrrev_b32 v158, 2, v152
    v_xor_b32 v158, v158, v153
    v_bfe_i32 v158, v158, 0, 1
    v_bfi_b32 v158, v158, 0, s58
    v_accvgpr_write_b32 a228, v158
    v_accvgpr_write_b32 a229, v158
    v_accvgpr_write_b32 a230, v158
    v_accvgpr_write_b32 a231, v158
    v_and_b32 v17, v138, v153
    v_lshlrev_b32 v17, 4, v17
    v_lshrrev_b32 v17, v17, -1
    s_mov_b32 s73, 0x409d2a01
    s_mov_b32 s59, 0x3ef00000
    v_mul_u32_u24 v252, 0x100010, v0
    v_add_u32 v252, 0xc0004, v252
    v_lshlrev_b32 v253, 2, v0
    v_add_u32 v253, 150912, v253
    v_add_u32 v160, 0x0, v252
    v_add_u32 v168, 0x10001000, v252
    v_cvt_f32_f16 v161, v160
    v_cvt_f32_f16 v169, v168
    v_cvt_f32_f16_sdwa v162, v160 dst_sel:DWORD dst_unused:UNUSED_PAD src0_sel:WORD_1
    v_cvt_f32_f16_sdwa v170, v168 dst_sel:DWORD dst_unused:UNUSED_PAD src0_sel:WORD_1
    v_mul_f32 v163, 0x3f7fdde7, v161
    v_mul_f32 v171, 0x3f7fdde7, v169
    v_mul_f32 v164, 0x3f7fdde7, v162
    v_mul_f32 v172, 0x3f7fdde7, v170
    v_fma_f32 v163, v163, v161, s73
    v_fma_f32 v171, v171, v169, s73
    v_fma_f32 v164, v164, v162, s73
    v_fma_f32 v172, v172, v170, s73
    v_mul_f32 v163, -v161, v163
    v_mul_f32 v171, -v169, v171
    v_mul_f32 v164, -v162, v164
    v_mul_f32 v172, -v170, v172
    v_exp_f32 v165, v163
    v_exp_f32 v173, v171
    v_exp_f32 v166, v164
    v_exp_f32 v174, v172
    v_fma_f32 v163, v165, s59, s59
    v_fma_f32 v171, v173, s59, s59
    v_fma_f32 v164, v166, s59, s59
    v_fma_f32 v172, v174, s59, s59
    v_rcp_f32 v163, v163
    v_rcp_f32 v171, v171
    v_rcp_f32 v164, v164
    v_rcp_f32 v172, v172
    v_mul_f32 v163, v161, v163
    v_mul_f32 v171, v169, v171
    v_mul_f32 v164, v162, v164
    v_mul_f32 v172, v170, v172
    v_mul_f32 v165, -v165, v163
    v_mul_f32 v173, -v173, v171
    v_mul_f32 v166, -v166, v164
    v_mul_f32 v174, -v174, v172
    v_cvt_pk_bf16_f32 v167, v165, v166
    v_cvt_pk_bf16_f32 v175, v173, v174
    v_cvt_pk_bf16_f32 v160, v163, v164
    v_cvt_pk_bf16_f32 v168, v171, v172
    ds_write_b32 v253, v167 offset:8192
    ds_write_b32 v253, v160 offset:0
    ds_write_b32 v253, v175 offset:9216
    ds_write_b32 v253, v168 offset:1024
    v_add_u32 v160, 0x20002000, v252
    s_nop 0
    v_add_u32 v168, 0x30003000, v252
    v_cvt_f32_f16 v161, v160
    v_cvt_f32_f16 v169, v168
    v_cvt_f32_f16_sdwa v162, v160 dst_sel:DWORD dst_unused:UNUSED_PAD src0_sel:WORD_1
    v_cvt_f32_f16_sdwa v170, v168 dst_sel:DWORD dst_unused:UNUSED_PAD src0_sel:WORD_1
    v_mul_f32 v163, 0x3f7fdde7, v161
    v_mul_f32 v171, 0x3f7fdde7, v169
    v_mul_f32 v164, 0x3f7fdde7, v162
    v_mul_f32 v172, 0x3f7fdde7, v170
    v_fma_f32 v163, v163, v161, s73
    v_fma_f32 v171, v171, v169, s73
    v_fma_f32 v164, v164, v162, s73
    v_fma_f32 v172, v172, v170, s73
    v_mul_f32 v163, -v161, v163
    v_mul_f32 v171, -v169, v171
    v_mul_f32 v164, -v162, v164
    v_mul_f32 v172, -v170, v172
    v_exp_f32 v165, v163
    v_exp_f32 v173, v171
    v_exp_f32 v166, v164
    v_exp_f32 v174, v172
    v_fma_f32 v163, v165, s59, s59
    v_fma_f32 v171, v173, s59, s59
    v_fma_f32 v164, v166, s59, s59
    v_fma_f32 v172, v174, s59, s59
    v_rcp_f32 v163, v163
    v_rcp_f32 v171, v171
    v_rcp_f32 v164, v164
    v_rcp_f32 v172, v172
    v_mul_f32 v163, v161, v163
    v_mul_f32 v171, v169, v171
    v_mul_f32 v164, v162, v164
    v_mul_f32 v172, v170, v172
    v_mul_f32 v165, -v165, v163
    v_mul_f32 v173, -v173, v171
    v_mul_f32 v166, -v166, v164
    v_mul_f32 v174, -v174, v172
    v_cvt_pk_bf16_f32 v167, v165, v166
    v_cvt_pk_bf16_f32 v175, v173, v174
    v_cvt_pk_bf16_f32 v160, v163, v164
    v_cvt_pk_bf16_f32 v168, v171, v172
    ds_write_b32 v253, v167 offset:10240
    ds_write_b32 v253, v160 offset:2048
    ds_write_b32 v253, v175 offset:11264
    ds_write_b32 v253, v168 offset:3072
    v_add_u32 v160, 0x40004000, v252
    s_nop 0
    v_add_u32 v168, 0x50005000, v252
    v_cvt_f32_f16 v161, v160
    v_cvt_f32_f16 v169, v168
    v_cvt_f32_f16_sdwa v162, v160 dst_sel:DWORD dst_unused:UNUSED_PAD src0_sel:WORD_1
    v_cvt_f32_f16_sdwa v170, v168 dst_sel:DWORD dst_unused:UNUSED_PAD src0_sel:WORD_1
    v_mul_f32 v163, 0x3f7fdde7, v161
    v_mul_f32 v171, 0x40088889, v169
    v_mul_f32 v164, 0x3f7fdde7, v162
    v_mul_f32 v172, 0x40088889, v170
    v_fma_f32 v163, v163, v161, s73
    v_cvt_pk_bf16_f32 v168, v171, v172
    v_fma_f32 v164, v164, v162, s73
    v_mul_f32 v163, -v161, v163
    v_mul_f32 v164, -v162, v164
    v_exp_f32 v165, v163
    v_exp_f32 v166, v164
    v_fma_f32 v163, v165, s59, s59
    v_fma_f32 v164, v166, s59, s59
    v_rcp_f32 v163, v163
    v_rcp_f32 v164, v164
    v_mul_f32 v163, v161, v163
    v_mul_f32 v164, v162, v164
    v_mul_f32 v165, -v165, v163
    v_mul_f32 v166, -v166, v164
    v_cvt_pk_bf16_f32 v167, v165, v166
    v_cvt_pk_bf16_f32 v160, v163, v164
    ds_write_b32 v253, v167 offset:12288
    ds_write_b32 v253, v160 offset:4096
    ds_write_b32 v253, v168 offset:5120
    s_nop 0
    v_add_u32 v160, 0x60006000, v252
    v_add_u32 v168, 0x70007000, v252
    v_cvt_f32_f16 v161, v160
    v_cvt_f32_f16 v169, v168
    v_cvt_f32_f16_sdwa v162, v160 dst_sel:DWORD dst_unused:UNUSED_PAD src0_sel:WORD_1
    v_cvt_f32_f16_sdwa v170, v168 dst_sel:DWORD dst_unused:UNUSED_PAD src0_sel:WORD_1
    v_mul_f32 v163, 0x40088889, v161
    v_mul_f32 v171, 0x40088889, v169
    v_mul_f32 v164, 0x40088889, v162
    v_mul_f32 v172, 0x40088889, v170
    v_cvt_pk_bf16_f32 v160, v163, v164
    v_cvt_pk_bf16_f32 v168, v171, v172
    ds_write_b32 v253, v160 offset:6144
    ds_write_b32 v253, v168 offset:7168
    v_lshlrev_b32 v158, 6, v0
    v_add_u32 v158, 141312, v158
    v_cmp_gt_u32 vcc, 144, v0
    s_nop 1
    v_cndmask_b32 v158, v157, v158, vcc
    v_and_b32 v159, 3, v0
    v_lshl_add_u32 v160, v159, 2, v158
    v_lshrrev_b32 v159, 1, v159
    v_lshl_add_u32 v159, v159, 2, v158
    v_lshlrev_b32 v161, 4, v0
    v_add_u32 v161, 150528, v161
    v_cmp_gt_u32 vcc, 24, v0
    s_nop 1
    v_cndmask_b32 v161, v157, v161, vcc
    v_mov_b32 v164, 0
    v_mov_b32 v165, 0
    v_mov_b32 v166, 0
    v_mov_b32 v167, 0
    ds_write_b128 v158, v[164:167]
    ds_write_b128 v158, v[164:167] offset:16
    s_waitcnt lgkmcnt(9)
    ds_write_b128 v158, v[164:167] offset:32
    ds_write_b128 v158, v[164:167] offset:48
    s_waitcnt vmcnt(17)
    ds_write_b16 v160, v144
    ds_write_b16_d16_hi v160, v144 offset:34
    s_waitcnt vmcnt(16)
    ds_write_b16 v159, v145 offset:16
    ds_write_b16_d16_hi v159, v145 offset:48
    s_waitcnt vmcnt(15) lgkmcnt(13)
    ds_write_b16 v159, v146 offset:24
    ds_write_b16_d16_hi v159, v146 offset:56
    s_waitcnt vmcnt(14)
    v_lshlrev_b32 v168, 16, v148
    v_and_b32 v169, 0xffff0000, v148
    v_lshlrev_b32 v170, 16, v149
    v_and_b32 v171, 0xffff0000, v149
    s_waitcnt vmcnt(13)
    v_lshlrev_b32 v172, 16, v150
    v_and_b32 v173, 0xffff0000, v150
    v_lshlrev_b32 v174, 16, v151
    v_and_b32 v175, 0xffff0000, v151
    v_mul_f32 v168, v168, v172
    v_mul_f32 v169, v169, v173
    v_mul_f32 v170, v170, v174
    v_mul_f32 v171, v171, v175
    s_waitcnt lgkmcnt(14)
    ds_write_b128 v161, v[168:171]
    s_waitcnt vmcnt(12)
    v_xor_b32 v176, 0x80008000, v176
    v_xor_b32 v177, 0x80008000, v177
    v_xor_b32 v178, 0x80008000, v178
    v_xor_b32 v179, 0x80008000, v179
    s_nop 1
    v_mfma_f32_32x32x16_bf16 v[208:223], v[176:179], v[240:243], 0
    v_mfma_f32_32x32x16_bf16 v[208:223], v[176:179], v[244:247], v[208:223]
    s_waitcnt vmcnt(10)
    v_xor_b32 v180, 0x80008000, v180
    v_xor_b32 v181, 0x80008000, v181
    v_xor_b32 v182, 0x80008000, v182
    v_xor_b32 v183, 0x80008000, v183
    s_nop 1
    v_mfma_f32_32x32x16_bf16 v[192:207], v[180:183], v[240:243], 0
    v_mfma_f32_32x32x16_bf16 v[192:207], v[180:183], v[244:247], v[192:207]
    s_mov_b32 s74, 0
    s_mov_b32 s75, 12288
    buffer_load_dwordx4 a[0:3], v232, s[44:47], s74 offen offset:0
    buffer_load_dwordx4 a[4:7], v232, s[44:47], s75 offen offset:0
    buffer_load_dwordx4 a[8:11], v233, s[44:47], s74 offen offset:0
    buffer_load_dwordx4 a[12:15], v233, s[44:47], s75 offen offset:0
    s_mov_b32 s74, 24576
    s_mov_b32 s75, 36864
    buffer_load_dwordx4 a[16:19], v232, s[44:47], s74 offen offset:0
    buffer_load_dwordx4 a[20:23], v232, s[44:47], s75 offen offset:0
    buffer_load_dwordx4 a[24:27], v233, s[44:47], s74 offen offset:0
    buffer_load_dwordx4 a[28:31], v233, s[44:47], s75 offen offset:0
    s_mov_b32 s74, 49152
    s_mov_b32 s75, 61440
    buffer_load_dwordx4 a[32:35], v232, s[44:47], s74 offen offset:0
    buffer_load_dwordx4 a[36:39], v232, s[44:47], s75 offen offset:0
    buffer_load_dwordx4 a[40:43], v233, s[44:47], s74 offen offset:0
    buffer_load_dwordx4 a[44:47], v233, s[44:47], s75 offen offset:0
    s_mov_b32 s74, 0
    s_mov_b32 s75, 12288
    buffer_load_dwordx4 a[48:51], v232, s[44:47], s74 offen offset:256
    buffer_load_dwordx4 a[52:55], v232, s[44:47], s75 offen offset:256
    buffer_load_dwordx4 a[56:59], v233, s[44:47], s74 offen offset:256
    buffer_load_dwordx4 a[60:63], v233, s[44:47], s75 offen offset:256
    s_mov_b32 s74, 24576
    s_mov_b32 s75, 36864
    buffer_load_dwordx4 a[64:67], v232, s[44:47], s74 offen offset:256
    buffer_load_dwordx4 a[68:71], v232, s[44:47], s75 offen offset:256
    buffer_load_dwordx4 a[72:75], v233, s[44:47], s74 offen offset:256
    buffer_load_dwordx4 a[76:79], v233, s[44:47], s75 offen offset:256
    s_mov_b32 s74, 49152
    s_mov_b32 s75, 61440
    buffer_load_dwordx4 a[80:83], v232, s[44:47], s74 offen offset:256
    buffer_load_dwordx4 a[84:87], v232, s[44:47], s75 offen offset:256
    buffer_load_dwordx4 a[88:91], v233, s[44:47], s74 offen offset:256
    buffer_load_dwordx4 a[92:95], v233, s[44:47], s75 offen offset:256
    s_waitcnt vmcnt(23)
    v_mfma_f32_32x32x16_bf16 v[80:95], a[0:3], v[240:243], v[208:223]
    s_waitcnt vmcnt(21)
    v_mfma_f32_32x32x16_bf16 v[96:111], a[8:11], v[240:243], v[208:223]
    v_mfma_f32_32x32x16_bf16 v[80:95], a[4:7], v[244:247], v[80:95]
    s_waitcnt vmcnt(20)
    v_mfma_f32_32x32x16_bf16 v[96:111], a[12:15], v[244:247], v[96:111]
    s_waitcnt vmcnt(19)
    v_mfma_f32_32x32x16_bf16 v[112:127], a[16:19], v[240:243], v[208:223]
    s_waitcnt vmcnt(17)
    v_mfma_f32_32x32x16_bf16 v[128:143], a[24:27], v[240:243], v[208:223]
    v_mfma_f32_32x32x16_bf16 v[112:127], a[20:23], v[244:247], v[112:127]
    s_waitcnt vmcnt(16)
    v_mfma_f32_32x32x16_bf16 v[128:143], a[28:31], v[244:247], v[128:143]
    s_nop 2
    v_cvt_pk_f16_f32 v224, v80, v84
    v_cvt_pk_f16_f32 v225, v88, v92
    v_cvt_pk_f16_f32 v226, v96, v100
    v_cvt_pk_f16_f32 v227, v104, v108
    s_waitcnt vmcnt(15)
    v_mfma_f32_32x32x16_bf16 v[144:159], a[32:35], v[240:243], v[208:223]
    s_waitcnt lgkmcnt(14)
    ds_write_b128 v234, v[224:227] offset:0
    s_mov_b32 s74, 0
    v_cvt_pk_f16_f32 v228, v81, v85
    v_cvt_pk_f16_f32 v229, v89, v93
    v_cvt_pk_f16_f32 v230, v97, v101
    v_cvt_pk_f16_f32 v231, v105, v109
    s_waitcnt vmcnt(13)
    v_mfma_f32_32x32x16_bf16 v[160:175], a[40:43], v[240:243], v[208:223]
    s_waitcnt lgkmcnt(14)
    ds_write_b128 v234, v[228:231] offset:1024
    s_mov_b32 s75, 12288
    buffer_load_dwordx4 v[32:35], v232, s[44:47], s74 offen offset:512
    v_cvt_pk_f16_f32 v224, v82, v86
    v_cvt_pk_f16_f32 v225, v90, v94
    v_cvt_pk_f16_f32 v226, v98, v102
    v_cvt_pk_f16_f32 v227, v106, v110
    v_mfma_f32_32x32x16_bf16 v[144:159], a[36:39], v[244:247], v[144:159]
    s_waitcnt lgkmcnt(14)
    ds_write_b128 v234, v[224:227] offset:12288
    buffer_load_dwordx4 v[36:39], v232, s[44:47], s75 offen offset:512
    v_cvt_pk_f16_f32 v228, v83, v87
    v_cvt_pk_f16_f32 v229, v91, v95
    v_cvt_pk_f16_f32 v230, v99, v103
    v_cvt_pk_f16_f32 v231, v107, v111
    s_waitcnt vmcnt(14)
    v_mfma_f32_32x32x16_bf16 v[160:175], a[44:47], v[244:247], v[160:175]
    s_waitcnt vmcnt(10)
    s_waitcnt lgkmcnt(14)
    ds_write_b128 v234, v[228:231] offset:13312
    buffer_load_dwordx4 v[40:43], v233, s[44:47], s74 offen offset:512
    buffer_load_dwordx4 v[44:47], v233, s[44:47], s75 offen offset:512
    v_mfma_f32_32x32x16_bf16 v[160:175], a[232:235], v[244:247], v[160:175]
    v_cvt_pk_f16_f32 v224, v112, v116
    v_cvt_pk_f16_f32 v225, v120, v124
    v_cvt_pk_f16_f32 v226, v128, v132
    v_cvt_pk_f16_f32 v227, v136, v140
    v_mfma_f32_32x32x16_bf16 v[80:95], a[48:51], v[240:243], v[192:207]
    s_waitcnt lgkmcnt(14)
    ds_write_b128 v234, v[224:227] offset:2048
    s_mov_b32 s74, 24576
    v_cvt_pk_f16_f32 v228, v113, v117
    v_cvt_pk_f16_f32 v229, v121, v125
    v_cvt_pk_f16_f32 v230, v129, v133
    v_cvt_pk_f16_f32 v231, v137, v141
    v_mfma_f32_32x32x16_bf16 v[96:111], a[56:59], v[240:243], v[192:207]
    s_waitcnt lgkmcnt(14)
    ds_write_b128 v234, v[228:231] offset:3072
    s_mov_b32 s75, 36864
    buffer_load_dwordx4 v[48:51], v232, s[44:47], s74 offen offset:512
    v_cvt_pk_f16_f32 v224, v114, v118
    v_cvt_pk_f16_f32 v225, v122, v126
    v_cvt_pk_f16_f32 v226, v130, v134
    v_cvt_pk_f16_f32 v227, v138, v142
    v_mfma_f32_32x32x16_bf16 v[80:95], a[52:55], v[244:247], v[80:95]
    s_waitcnt lgkmcnt(14)
    ds_write_b128 v234, v[224:227] offset:14336
    buffer_load_dwordx4 v[52:55], v232, s[44:47], s75 offen offset:512
    v_cvt_pk_f16_f32 v228, v115, v119
    v_cvt_pk_f16_f32 v229, v123, v127
    v_cvt_pk_f16_f32 v230, v131, v135
    v_cvt_pk_f16_f32 v231, v139, v143
    v_mfma_f32_32x32x16_bf16 v[96:111], a[60:63], v[244:247], v[96:111]
    s_waitcnt vmcnt(10)
    s_waitcnt lgkmcnt(14)
    ds_write_b128 v234, v[228:231] offset:15360
    buffer_load_dwordx4 v[56:59], v233, s[44:47], s74 offen offset:512
    buffer_load_dwordx4 v[60:63], v233, s[44:47], s75 offen offset:512
    v_xor_b32 v184, 0x80008000, v184
    v_xor_b32 v185, 0x80008000, v185
    v_xor_b32 v186, 0x80008000, v186
    v_xor_b32 v187, 0x80008000, v187
    v_cvt_pk_f16_f32 v224, v144, v148
    v_cvt_pk_f16_f32 v225, v152, v156
    v_cvt_pk_f16_f32 v226, v160, v164
    v_cvt_pk_f16_f32 v227, v168, v172
    v_mfma_f32_32x32x16_bf16 v[112:127], a[64:67], v[240:243], v[192:207]
    s_waitcnt lgkmcnt(14)
    ds_write_b128 v234, v[224:227] offset:4096
    s_mov_b32 s74, 49152
    v_cvt_pk_f16_f32 v228, v145, v149
    v_cvt_pk_f16_f32 v229, v153, v157
    v_cvt_pk_f16_f32 v230, v161, v165
    v_cvt_pk_f16_f32 v231, v169, v173
    v_mfma_f32_32x32x16_bf16 v[128:143], a[72:75], v[240:243], v[192:207]
    s_waitcnt lgkmcnt(14)
    ds_write_b128 v234, v[228:231] offset:5120
    s_mov_b32 s75, 61440
    buffer_load_dwordx4 v[64:67], v232, s[44:47], s74 offen offset:512
    v_cvt_pk_f16_f32 v224, v146, v150
    v_cvt_pk_f16_f32 v225, v154, v158
    v_cvt_pk_f16_f32 v226, v162, v166
    v_cvt_pk_f16_f32 v227, v170, v174
    v_mfma_f32_32x32x16_bf16 v[112:127], a[68:71], v[244:247], v[112:127]
    s_waitcnt lgkmcnt(14)
    ds_write_b128 v234, v[224:227] offset:16384
    buffer_load_dwordx4 v[68:71], v232, s[44:47], s75 offen offset:512
    v_cvt_pk_f16_f32 v228, v147, v151
    v_cvt_pk_f16_f32 v229, v155, v159
    v_cvt_pk_f16_f32 v230, v163, v167
    v_cvt_pk_f16_f32 v231, v171, v175
    v_mfma_f32_32x32x16_bf16 v[128:143], a[76:79], v[244:247], v[128:143]
    s_waitcnt vmcnt(10)
    s_waitcnt lgkmcnt(14)
    ds_write_b128 v234, v[228:231] offset:17408
    buffer_load_dwordx4 v[72:75], v233, s[44:47], s74 offen offset:512
    buffer_load_dwordx4 v[76:79], v233, s[44:47], s75 offen offset:512
    v_sub_u32 v234, v234, v238
    v_mfma_f32_32x32x16_bf16 v[208:223], v[184:187], v[240:243], 0
    v_mfma_f32_32x32x16_bf16 v[208:223], v[184:187], v[244:247], v[208:223]
    v_cvt_pk_f16_f32 v224, v80, v84
    v_cvt_pk_f16_f32 v225, v88, v92
    v_cvt_pk_f16_f32 v226, v96, v100
    v_cvt_pk_f16_f32 v227, v104, v108
    v_mfma_f32_32x32x16_bf16 v[144:159], a[80:83], v[240:243], v[192:207]
    s_waitcnt lgkmcnt(0)
    s_barrier
    ds_write_b128 v234, v[224:227] offset:0
    ds_read_b128 a[192:195], v23 offset:4096
    ds_read_b128 a[196:199], v23 offset:5120
    ds_read_b128 a[200:203], v23 offset:14336
    ds_read_b128 a[204:207], v23 offset:15360
    ds_read_b128 a[208:211], v23 offset:24576
    ds_read_b128 a[212:215], v23 offset:25600
    ds_read_b128 a[216:219], v23 offset:34816
    s_add_u32 m0, s56, 6336
    s_nop 0
    buffer_load_dwordx4 v1, s[20:23], 0 offen offset:64 lds
    v_cvt_pk_f16_f32 v228, v81, v85
    v_cvt_pk_f16_f32 v229, v89, v93
    v_cvt_pk_f16_f32 v230, v97, v101
    v_cvt_pk_f16_f32 v231, v105, v109
    v_mfma_f32_32x32x16_bf16 v[160:175], a[88:91], v[240:243], v[192:207]
    ds_write_b128 v234, v[228:231] offset:1024
    ds_read_b128 a[220:223], v23 offset:35840
    ds_read_b128 a[0:3], v24 offset:0
    ds_read_b128 a[4:7], v24 offset:1024
    ds_read_b128 a[24:27], v24 offset:6144
    ds_read_b128 a[28:31], v24 offset:7168
    ds_read_b128 a[96:99], v24 offset:24576
    s_waitcnt lgkmcnt(14)
    ds_read_b128 a[100:103], v24 offset:25600
    s_add_u32 m0, s56, 7360
    s_nop 0
    buffer_load_dwordx4 v2, s[20:23], 0 offen offset:64 lds
    v_cvt_pk_f16_f32 v224, v82, v86
    v_cvt_pk_f16_f32 v225, v90, v94
    v_cvt_pk_f16_f32 v226, v98, v102
    v_cvt_pk_f16_f32 v227, v106, v110
    v_mfma_f32_32x32x16_bf16 v[144:159], a[84:87], v[244:247], v[144:159]
    s_waitcnt lgkmcnt(9)
    ds_write_b128 v234, v[224:227] offset:10240
    ds_read_b128 a[120:123], v24 offset:30720
    ds_read_b128 a[124:127], v24 offset:31744
    ds_read_b128 a[144:147], v24 offset:36864
    ds_read_b128 a[148:151], v24 offset:37888
    ds_read_b128 a[168:171], v24 offset:43008
    s_waitcnt lgkmcnt(13)
    ds_read_b128 a[172:175], v24 offset:44032
    ds_read_b128 a[48:51], v24 offset:12288
    s_add_u32 m0, s56, 8384
    s_nop 0
    buffer_load_dwordx4 v3, s[20:23], 0 offen offset:64 lds
    v_cvt_pk_f16_f32 v228, v83, v87
    v_cvt_pk_f16_f32 v229, v91, v95
    v_cvt_pk_f16_f32 v230, v99, v103
    v_cvt_pk_f16_f32 v231, v107, v111
    v_mfma_f32_32x32x16_bf16 v[160:175], a[92:95], v[244:247], v[160:175]
    s_waitcnt vmcnt(11)
    s_waitcnt lgkmcnt(9)
    ds_write_b128 v234, v[228:231] offset:11264
    ds_read_b128 a[52:55], v24 offset:13312
    ds_read_b128 a[72:75], v24 offset:18432
    ds_read_b128 a[76:79], v24 offset:19456
    ds_read_b128 a[8:11], v24 offset:2048
    ds_read_b128 a[12:15], v24 offset:3072
    s_waitcnt lgkmcnt(13)
    ds_read_b128 a[32:35], v24 offset:8192
    ds_read_b128 a[36:39], v24 offset:9216
    s_add_u32 m0, s56, 9408
    s_nop 0
    buffer_load_dwordx4 v4, s[20:23], 0 offen offset:64 lds
    v_mfma_f32_32x32x16_bf16 v[160:175], a[236:239], v[244:247], v[160:175]
    v_cvt_pk_f16_f32 v224, v112, v116
    v_cvt_pk_f16_f32 v225, v120, v124
    v_cvt_pk_f16_f32 v226, v128, v132
    v_cvt_pk_f16_f32 v227, v136, v140
    v_mfma_f32_32x32x16_bf16 v[80:95], v[32:35], v[240:243], v[208:223]
    s_waitcnt lgkmcnt(9)
    ds_write_b128 v234, v[224:227] offset:2048
    ds_read_b128 a[104:107], v24 offset:26624
    ds_read_b128 a[108:111], v24 offset:27648
    ds_read_b128 a[128:131], v24 offset:32768
    ds_read_b128 a[132:135], v24 offset:33792
    ds_read_b128 a[152:155], v24 offset:38912
    s_waitcnt lgkmcnt(13)
    ds_read_b128 a[156:159], v24 offset:39936
    ds_read_b128 a[176:179], v24 offset:45056
    s_add_u32 m0, s56, 10432
    v_cvt_pk_f16_f32 v228, v113, v117
    v_cvt_pk_f16_f32 v229, v121, v125
    v_cvt_pk_f16_f32 v230, v129, v133
    v_cvt_pk_f16_f32 v231, v137, v141
    v_mfma_f32_32x32x16_bf16 v[96:111], v[40:43], v[240:243], v[208:223]
    s_waitcnt lgkmcnt(9)
    ds_write_b128 v234, v[228:231] offset:3072
    ds_read_b128 a[180:183], v24 offset:46080
    ds_read_b128 a[56:59], v24 offset:14336
    ds_read_b128 a[60:63], v24 offset:15360
    ds_read_b128 a[80:83], v24 offset:20480
    ds_read_b128 a[84:87], v24 offset:21504
    s_waitcnt lgkmcnt(13)
    ds_read_b128 a[16:19], v24 offset:4096
    ds_read_b128 a[20:23], v24 offset:5120
    buffer_load_dwordx4 v5, s[20:23], 0 offen offset:64 lds
    s_add_u32 m0, s56, 11456
    v_cvt_pk_f16_f32 v224, v114, v118
    v_cvt_pk_f16_f32 v225, v122, v126
    v_cvt_pk_f16_f32 v226, v130, v134
    v_cvt_pk_f16_f32 v227, v138, v142
    v_mfma_f32_32x32x16_bf16 v[80:95], v[36:39], v[244:247], v[80:95]
    s_waitcnt lgkmcnt(9)
    ds_write_b128 v234, v[224:227] offset:12288
    ds_read_b128 a[40:43], v24 offset:10240
    ds_read_b128 a[44:47], v24 offset:11264
    ds_read_b128 a[112:115], v24 offset:28672
    ds_read_b128 a[116:119], v24 offset:29696
    ds_read_b128 a[136:139], v24 offset:34816
    s_waitcnt lgkmcnt(13)
    ds_read_b128 a[140:143], v24 offset:35840
    ds_read_b128 a[160:163], v24 offset:40960
    buffer_load_dwordx4 v6, s[20:23], 0 offen offset:64 lds
    s_add_u32 m0, s56, 12480
    v_cvt_pk_f16_f32 v228, v115, v119
    v_cvt_pk_f16_f32 v229, v123, v127
    v_cvt_pk_f16_f32 v230, v131, v135
    v_cvt_pk_f16_f32 v231, v139, v143
    v_mfma_f32_32x32x16_bf16 v[96:111], v[44:47], v[244:247], v[96:111]
    s_waitcnt vmcnt(10)
    s_waitcnt lgkmcnt(9)
    ds_write_b128 v234, v[228:231] offset:13312
    ds_read_b128 a[164:167], v24 offset:41984
    ds_read_b128 a[184:187], v24 offset:47104
    ds_read_b128 a[188:191], v24 offset:48128
    ds_read_b128 a[64:67], v24 offset:16384
    ds_read_b128 a[68:71], v24 offset:17408
    s_waitcnt lgkmcnt(13)
    ds_read_b128 a[88:91], v24 offset:22528
    ds_read_b128 a[92:95], v24 offset:23552
    buffer_load_dword v7, s[20:23], 0 offen offset:64 lds
    buffer_load_dword v254, v31, s[20:23], 0 offen
    v_cvt_pk_f16_f32 v224, v144, v148
    v_cvt_pk_f16_f32 v225, v152, v156
    v_cvt_pk_f16_f32 v226, v160, v164
    v_cvt_pk_f16_f32 v227, v168, v172
    v_mfma_f32_32x32x16_bf16 v[112:127], v[48:51], v[240:243], v[208:223]
    s_waitcnt lgkmcnt(0)
    s_barrier
    ds_write_b128 v234, v[224:227] offset:4096
    v_cvt_pk_f16_f32 v228, v145, v149
    v_cvt_pk_f16_f32 v229, v153, v157
    v_cvt_pk_f16_f32 v230, v161, v165
    v_cvt_pk_f16_f32 v231, v169, v173
    v_mfma_f32_32x32x16_bf16 v[128:143], v[56:59], v[240:243], v[208:223]
    ds_write_b128 v234, v[228:231] offset:5120
    v_cvt_pk_f16_f32 v224, v146, v150
    v_cvt_pk_f16_f32 v225, v154, v158
    v_cvt_pk_f16_f32 v226, v162, v166
    v_cvt_pk_f16_f32 v227, v170, v174
    v_mfma_f32_32x32x16_bf16 v[112:127], v[52:55], v[244:247], v[112:127]
    ds_write_b128 v234, v[224:227] offset:14336
    v_cvt_pk_f16_f32 v228, v147, v151
    v_cvt_pk_f16_f32 v229, v155, v159
    v_cvt_pk_f16_f32 v230, v163, v167
    v_cvt_pk_f16_f32 v231, v171, v175
    v_mfma_f32_32x32x16_bf16 v[128:143], v[60:63], v[244:247], v[128:143]
    s_waitcnt vmcnt(8)
    ds_write_b128 v234, v[228:231] offset:15360
    v_add_u32 v234, v234, v238
    v_cvt_pk_f16_f32 v224, v80, v84
    v_cvt_pk_f16_f32 v225, v88, v92
    v_cvt_pk_f16_f32 v226, v96, v100
    v_cvt_pk_f16_f32 v227, v104, v108
    v_mfma_f32_32x32x16_bf16 v[144:159], v[64:67], v[240:243], v[208:223]
    ds_write_b128 v234, v[224:227] offset:0
    v_cvt_pk_f16_f32 v228, v81, v85
    v_cvt_pk_f16_f32 v229, v89, v93
    v_cvt_pk_f16_f32 v230, v97, v101
    v_cvt_pk_f16_f32 v231, v105, v109
    v_mfma_f32_32x32x16_bf16 v[160:175], v[72:75], v[240:243], v[208:223]
    ds_write_b128 v234, v[228:231] offset:1024
    v_cvt_pk_f16_f32 v224, v82, v86
    v_cvt_pk_f16_f32 v225, v90, v94
    v_cvt_pk_f16_f32 v226, v98, v102
    v_cvt_pk_f16_f32 v227, v106, v110
    v_mfma_f32_32x32x16_bf16 v[144:159], v[68:71], v[244:247], v[144:159]
    ds_write_b128 v234, v[224:227] offset:12288
    v_cvt_pk_f16_f32 v228, v83, v87
    v_cvt_pk_f16_f32 v229, v91, v95
    v_cvt_pk_f16_f32 v230, v99, v103
    v_cvt_pk_f16_f32 v231, v107, v111
    v_mfma_f32_32x32x16_bf16 v[160:175], v[76:79], v[244:247], v[160:175]
    ds_write_b128 v234, v[228:231] offset:13312
    v_mfma_f32_32x32x16_bf16 v[160:175], a[240:243], v[244:247], v[160:175]
    v_cvt_pk_f16_f32 v224, v112, v116
    v_cvt_pk_f16_f32 v225, v120, v124
    v_cvt_pk_f16_f32 v226, v128, v132
    v_cvt_pk_f16_f32 v227, v136, v140
    ds_write_b128 v234, v[224:227] offset:2048
    v_cvt_pk_f16_f32 v228, v113, v117
    v_cvt_pk_f16_f32 v229, v121, v125
    v_cvt_pk_f16_f32 v230, v129, v133
    v_cvt_pk_f16_f32 v231, v137, v141
    ds_write_b128 v234, v[228:231] offset:3072
    v_cvt_pk_f16_f32 v224, v114, v118
    v_cvt_pk_f16_f32 v225, v122, v126
    v_cvt_pk_f16_f32 v226, v130, v134
    v_cvt_pk_f16_f32 v227, v138, v142
    ds_write_b128 v234, v[224:227] offset:14336
    v_cvt_pk_f16_f32 v228, v115, v119
    v_cvt_pk_f16_f32 v229, v123, v127
    v_cvt_pk_f16_f32 v230, v131, v135
    v_cvt_pk_f16_f32 v231, v139, v143
    ds_write_b128 v234, v[228:231] offset:15360
    v_cvt_pk_f16_f32 v224, v144, v148
    v_cvt_pk_f16_f32 v225, v152, v156
    v_cvt_pk_f16_f32 v226, v160, v164
    v_cvt_pk_f16_f32 v227, v168, v172
    ds_write_b128 v234, v[224:227] offset:4096
    v_cvt_pk_f16_f32 v228, v145, v149
    v_cvt_pk_f16_f32 v229, v153, v157
    v_cvt_pk_f16_f32 v230, v161, v165
    v_cvt_pk_f16_f32 v231, v169, v173
    ds_write_b128 v234, v[228:231] offset:5120
    v_cvt_pk_f16_f32 v224, v146, v150
    v_cvt_pk_f16_f32 v225, v154, v158
    v_cvt_pk_f16_f32 v226, v162, v166
    v_cvt_pk_f16_f32 v227, v170, v174
    ds_write_b128 v234, v[224:227] offset:16384
    v_cvt_pk_f16_f32 v228, v147, v151
    v_cvt_pk_f16_f32 v229, v155, v159
    v_cvt_pk_f16_f32 v230, v163, v167
    v_cvt_pk_f16_f32 v231, v171, v175
    s_waitcnt lgkmcnt(14)
    ds_write_b128 v234, v[228:231] offset:17408
L_conv0:
    s_waitcnt lgkmcnt(9)
    ds_read_b128 a[232:235], v8 offset:0
    ds_read_b128 a[244:247], v8 offset:2560
    ds_read_b128 a[236:239], v12 offset:0
    ds_read_b128 a[248:251], v12 offset:2560
    ds_read_b128 a[240:243], v15 offset:1280
    ds_read_b128 a[252:255], v15 offset:3840
    s_waitcnt lgkmcnt(9)
    ds_read_b128 v[176:179], v9 offset:0
    ds_read_b128 v[188:191], v9 offset:2560
    ds_read_b128 v[180:183], v13 offset:0
    ds_read_b128 v[232:235], v13 offset:2560
    ds_read_b128 v[184:187], v14 offset:1280
    ds_read_b128 v[236:239], v14 offset:3840
    s_waitcnt lgkmcnt(9)
    ds_read_b128 v[32:35], v10 offset:0
    ds_read_b128 v[44:47], v10 offset:2560
    ds_read_b128 v[36:39], v14 offset:0
    ds_read_b128 v[64:67], v14 offset:2560
    ds_read_b128 v[40:43], v13 offset:1280
    ds_read_b128 v[68:71], v13 offset:3840
    s_waitcnt lgkmcnt(9)
    ds_read_b128 v[136:139], v11 offset:0
    ds_read_b128 v[148:151], v11 offset:2560
    ds_read_b128 v[140:143], v15 offset:0
    ds_read_b128 v[72:75], v15 offset:2560
    ds_read_b128 v[144:147], v12 offset:1280
    ds_read_b128 v[76:79], v12 offset:3840
    s_waitcnt lgkmcnt(9)
    ds_read_b128 v[56:59], v20 offset:2560
    ds_read_b128 v[60:63], v21 offset:2560
    ds_read_b128 v[52:55], v21 offset:0
    ds_read_b128 v[48:51], v20 offset:0
    ds_read_b128 v[192:195], v22 offset:0
    ds_read_b128 v[200:203], v22 offset:16
    s_waitcnt lgkmcnt(13)
    ds_read_b128 v[196:199], v22 offset:256
    ds_read_b128 v[204:207], v22 offset:272
    s_waitcnt lgkmcnt(0)
    s_barrier
    s_add_u32 m0, s56, -128
    s_nop 0
    buffer_load_dwordx4 v1, s[20:23], 0 offen offset:128 lds
    s_add_u32 m0, s56, 896
    s_nop 0
    buffer_load_dwordx4 v2, s[20:23], 0 offen offset:128 lds
    s_add_u32 m0, s56, 1920
    s_nop 0
    buffer_load_dwordx4 v3, s[20:23], 0 offen offset:128 lds
    s_add_u32 m0, s56, 2944
    s_nop 0
    buffer_load_dwordx4 v4, s[20:23], 0 offen offset:128 lds
    s_add_u32 m0, s56, 3968
    s_nop 0
    buffer_load_dwordx4 v5, s[20:23], 0 offen offset:128 lds
    s_add_u32 m0, s56, 4992
    s_nop 0
    buffer_load_dwordx4 v6, s[20:23], 0 offen offset:128 lds
    s_add_u32 m0, s56, 6016
    s_nop 0
    buffer_load_dword v7, s[20:23], 0 offen offset:128 lds
    s_branch L_conv
.p2alignl 12, 0xbf800000
.fill 623, 4, 0xbf800000
L_conv:
    v_cvt_pk_bf16_f32 v80, v80, v81
    v_cvt_pk_bf16_f32 v81, v82, v83
    v_cvt_pk_bf16_f32 v82, v84, v85
    s_waitcnt lgkmcnt(3)
    v_mfma_f32_16x16x32_bf16 v[128:131], v[192:195], a[232:235], 0
    s_waitcnt vmcnt(8)
    ds_read_b128 a[232:235], v8 offset:6400
    v_cvt_pk_bf16_f32 v83, v86, v87
    v_cvt_pk_bf16_f32 v96, v96, v97
    v_mfma_f32_16x16x32_bf16 v[88:91], a[168:171], v[244:247], v[88:91]
    v_cvt_pk_bf16_f32 v97, v98, v99
    v_cvt_pk_bf16_f32 v98, v100, v101
    v_cvt_pk_bf16_f32 v99, v102, v103
    v_mfma_f32_16x16x32_bf16 v[152:155], v[192:195], a[244:247], 0
    ds_read_b128 a[244:247], v8 offset:8960
    ds_read_b128 v[192:195], v22 offset:512
    v_cvt_pk_bf16_f32 v112, v112, v113
    v_mfma_f32_16x16x32_bf16 v[92:95], a[172:175], v[244:247], v[92:95]
    s_waitcnt lgkmcnt(3)
    v_cvt_pk_bf16_f32 v88, v88, v89
    v_cvt_pk_bf16_f32 v89, v90, v91
    v_cvt_pk_bf16_f32 v113, v114, v115
    v_smfmac_f32_16x16x64_bf16 v[128:131], v[200:203], a[236:243], v16
    ds_read_b128 a[236:239], v12 offset:6400
    ds_read_b128 a[240:243], v15 offset:7680
    v_cvt_pk_bf16_f32 v114, v116, v117
    v_smfmac_f32_16x16x64_bf16 v[152:155], v[200:203], a[248:255], v16
    ds_read_b128 a[248:251], v12 offset:8960
    ds_read_b128 a[252:255], v15 offset:10240
    ds_read_b128 v[200:203], v22 offset:528
    v_mfma_f32_16x16x32_bf16 v[224:227], v[196:199], v[176:179], 0
    ds_read_b128 v[176:179], v9 offset:6400
    v_cvt_pkrtz_f16_f32 v128, v128, v129
    v_cvt_pkrtz_f16_f32 v129, v130, v131
    v_mfma_f32_16x16x32_bf16 v[228:231], v[196:199], v[188:191], 0
    ds_read_b128 v[188:191], v9 offset:8960
    ds_read_b128 v[196:199], v22 offset:768
    v_cvt_pkrtz_f16_f32 v152, v152, v153
    v_smfmac_f32_16x16x64_bf16 v[224:227], v[204:207], v[180:187], v16
    ds_read_b128 v[180:183], v13 offset:6400
    ds_read_b128 v[184:187], v14 offset:7680
    v_cvt_pkrtz_f16_f32 v153, v154, v155
    v_smfmac_f32_16x16x64_bf16 v[228:231], v[204:207], v[232:239], v16
    s_waitcnt lgkmcnt(10)
    ds_read_b128 v[232:235], v13 offset:8960
    ds_read_b128 v[236:239], v14 offset:10240
    ds_read_b128 v[204:207], v22 offset:784
    v_mfma_f32_16x16x32_bf16 v[132:135], v[192:195], v[32:35], 0
    v_cvt_pkrtz_f16_f32 v130, v224, v225
    v_cvt_pkrtz_f16_f32 v131, v226, v227
    v_cvt_pk_bf16_f32 v90, v92, v93
    v_mfma_f32_16x16x32_bf16 v[104:107], a[176:179], v[244:247], v[104:107]
    v_cvt_pkrtz_f16_f32 v154, v228, v229
    v_cvt_pkrtz_f16_f32 v155, v230, v231
    v_cvt_pk_bf16_f32 v91, v94, v95
    v_mfma_f32_16x16x32_bf16 v[156:159], v[192:195], v[44:47], 0
    ds_read_b128 v[192:195], v22 offset:1024
    v_cvt_pk_bf16_f32 v115, v118, v119
    v_mfma_f32_16x16x32_bf16 v[108:111], a[180:183], v[244:247], v[108:111]
    s_waitcnt lgkmcnt(9)
    ds_read_b128 v[32:35], v25 offset:0
    v_cvt_pk_bf16_f32 v104, v104, v105
    v_cvt_pk_bf16_f32 v105, v106, v107
    v_smfmac_f32_16x16x64_bf16 v[132:135], v[200:203], v[36:43], v16
    v_smfmac_f32_16x16x64_bf16 v[156:159], v[200:203], v[64:71], v16
    ds_read_b128 v[200:203], v22 offset:1040
    ds_read_b128 v[36:39], v25 offset:16
    v_mfma_f32_16x16x32_f16 v[248:251], a[228:231], v[128:131], 0
    v_cvt_pk_bf16_f32 v106, v108, v109
    v_cvt_pk_bf16_f32 v107, v110, v111
    s_waitcnt vmcnt(7)
    v_mfma_f32_16x16x32_f16 v[252:255], a[228:231], v[152:155], 0
    s_waitcnt lgkmcnt(9)
    v_cvt_pkrtz_f16_f32 v132, v132, v133
    v_cvt_pkrtz_f16_f32 v156, v156, v157
    v_cvt_pkrtz_f16_f32 v133, v134, v135
    v_cvt_pkrtz_f16_f32 v157, v158, v159
    v_dot2_f32_f16 v28, v128, v128, 0
    v_dot2_f32_f16 v30, v152, v152, 0
    v_dot2_f32_f16 v28, v129, v129, v28
    v_dot2_f32_f16 v30, v153, v153, v30
    v_dot2_f32_f16 v28, v130, v130, v28
    v_dot2_f32_f16 v30, v154, v154, v30
    v_dot2_f32_f16 v28, v131, v131, v28
    v_dot2_f32_f16 v30, v155, v155, v30
    v_dot2_f32_f16 v28, v132, v132, v28
    v_dot2_f32_f16 v30, v156, v156, v30
    v_dot2_f32_f16 v28, v133, v133, v28
    v_mfma_f32_16x16x32_bf16 v[224:227], v[196:199], v[136:139], 0
    ds_read_b128 v[216:219], v20 offset:8960
    v_mfma_f32_16x16x32_bf16 v[228:231], v[196:199], v[148:151], 0
    s_waitcnt lgkmcnt(5)
    ds_read_b128 v[196:199], v22 offset:1280
    s_nop 1
    v_smfmac_f32_16x16x64_bf16 v[224:227], v[204:207], v[140:147], v16
    buffer_store_dwordx4 v[80:83], v26, s[24:27], s82 offen offset:0 sc0 sc1
    v_smfmac_f32_16x16x64_bf16 v[228:231], v[204:207], v[72:79], v16
    s_waitcnt lgkmcnt(5)
    ds_read_b128 v[204:207], v22 offset:1296
    v_mfma_f32_16x16x32_bf16 v[136:139], v[192:195], a[232:235], 0
    ds_read_b128 a[232:235], v10 offset:6400
    v_mfma_f32_16x16x32_bf16 v[120:123], a[184:187], v[244:247], v[120:123]
    s_nop 0
    v_cvt_pkrtz_f16_f32 v134, v224, v225
    v_cvt_pkrtz_f16_f32 v135, v226, v227
    v_mfma_f32_16x16x32_bf16 v[160:163], v[192:195], a[244:247], 0
    s_waitcnt lgkmcnt(6)
    ds_read_b128 a[244:247], v10 offset:8960
    ds_read_b128 v[192:195], v22 offset:1536
    v_cvt_pkrtz_f16_f32 v158, v228, v229
    v_mfma_f32_16x16x16_bf16 v[80:83], v[18:19], v[56:57], v[32:35]
    s_waitcnt lgkmcnt(7)
    v_cvt_pkrtz_f16_f32 v159, v230, v231
    v_cvt_pk_bf16_f32 v120, v120, v121
    v_cvt_pk_bf16_f32 v121, v122, v123
    v_smfmac_f32_16x16x64_bf16 v[136:139], v[200:203], a[236:243], v16
    ds_read_b128 a[236:239], v14 offset:6400
    ds_read_b128 a[240:243], v13 offset:7680
    v_mfma_f32_16x16x32_bf16 v[124:127], a[188:191], v[244:247], v[124:127]
    buffer_store_dwordx4 v[88:91], v26, s[24:27], s83 offen offset:0 sc0 sc1
    v_smfmac_f32_16x16x64_bf16 v[160:163], v[200:203], a[248:255], v16
    ds_read_b128 a[248:251], v14 offset:8960
    ds_read_b128 a[252:255], v13 offset:10240
    ds_read_b128 v[200:203], v22 offset:1552
    v_mfma_f32_16x16x32_f16 v[248:251], a[228:231], v[132:135], v[248:251]
    v_cvt_pkrtz_f16_f32 v136, v136, v137
    v_cvt_pkrtz_f16_f32 v137, v138, v139
    v_cvt_pk_bf16_f32 v122, v124, v125
    v_mfma_f32_16x16x32_f16 v[252:255], a[228:231], v[156:159], v[252:255]
    s_waitcnt lgkmcnt(9)
    v_cvt_pkrtz_f16_f32 v160, v160, v161
    v_cvt_pkrtz_f16_f32 v161, v162, v163
    v_cvt_pk_bf16_f32 v123, v126, v127
    v_mfma_f32_16x16x32_bf16 v[224:227], v[196:199], v[176:179], 0
    ds_read_b128 v[176:179], v11 offset:6400
    v_permlane16_swap_b32 v128, v132
    v_mfma_f32_16x16x16_bf16 v[84:87], v[18:19], v[58:59], v[36:39]
    v_permlane16_swap_b32 v152, v156
    v_permlane16_swap_b32 v129, v133
    v_mfma_f32_16x16x32_bf16 v[228:231], v[196:199], v[188:191], 0
    ds_read_b128 v[188:191], v11 offset:8960
    ds_read_b128 v[196:199], v22 offset:1792
    v_mfma_f32_16x16x16_bf16 v[88:91], v[18:19], v[60:61], v[32:35]
    s_waitcnt lgkmcnt(11)
    v_smfmac_f32_16x16x64_bf16 v[224:227], v[204:207], v[180:187], v16
    ds_read_b128 v[180:183], v15 offset:6400
    ds_read_b128 v[184:187], v12 offset:7680
    v_smfmac_f32_16x16x64_bf16 v[228:231], v[204:207], v[232:239], v16
    s_waitcnt lgkmcnt(11)
    ds_read_b128 v[232:235], v15 offset:8960
    ds_read_b128 v[236:239], v12 offset:10240
    ds_read_b128 v[204:207], v22 offset:1808
    v_mfma_f32_16x16x16_bf16 v[92:95], v[18:19], v[62:63], v[36:39]
    s_waitcnt lgkmcnt(13)
    v_cvt_pkrtz_f16_f32 v138, v224, v225
    v_cvt_pkrtz_f16_f32 v139, v226, v227
    v_mfma_f32_16x16x32_bf16 v[140:143], v[192:195], a[232:235], 0
    s_waitcnt vmcnt(2)
    ds_read_b128 a[232:235], v8 offset:0
    buffer_store_dwordx4 v[96:99], v26, s[24:27], s82 offen offset:64 sc0 sc1
    v_mfma_f32_16x16x16_bf16 v[40:43], v[18:19], v[52:53], v[32:35]
    v_cvt_pkrtz_f16_f32 v162, v228, v229
    v_cvt_pkrtz_f16_f32 v163, v230, v231
    v_mfma_f32_16x16x32_bf16 v[164:167], v[192:195], a[244:247], 0
    s_waitcnt lgkmcnt(9)
    ds_read_b128 a[244:247], v8 offset:2560
    ds_read_b128 v[192:195], v22 offset:2048
    buffer_store_dwordx4 v[104:107], v26, s[24:27], s83 offen offset:64 sc0 sc1
    v_smfmac_f32_16x16x64_bf16 v[140:143], v[200:203], a[236:243], v16
    ds_read_b128 a[236:239], v12 offset:0
    ds_read_b128 a[240:243], v15 offset:1280
    v_smfmac_f32_16x16x64_bf16 v[164:167], v[200:203], a[248:255], v16
    s_waitcnt lgkmcnt(11)
    ds_read_b128 a[248:251], v12 offset:2560
    ds_read_b128 a[252:255], v15 offset:3840
    ds_read_b128 v[200:203], v22 offset:2064
    v_mfma_f32_16x16x32_f16 v[248:251], a[228:231], v[136:139], v[248:251]
    v_cvt_pkrtz_f16_f32 v140, v140, v141
    v_cvt_pkrtz_f16_f32 v141, v142, v143
    v_mfma_f32_16x16x32_f16 v[252:255], a[228:231], v[160:163], v[252:255]
    s_waitcnt lgkmcnt(13)
    v_cvt_pkrtz_f16_f32 v164, v164, v165
    v_cvt_pkrtz_f16_f32 v165, v166, v167
    v_mfma_f32_16x16x32_bf16 v[224:227], v[196:199], v[176:179], 0
    ds_read_b128 v[176:179], v9 offset:0
    buffer_store_dwordx4 v[112:115], v26, s[24:27], s82 offen offset:128 sc0 sc1
    v_mfma_f32_16x16x16_bf16 v[44:47], v[18:19], v[54:55], v[36:39]
    s_waitcnt lgkmcnt(13)
    ds_read_b128 v[220:223], v21 offset:8960
    v_mfma_f32_16x16x32_bf16 v[228:231], v[196:199], v[188:191], 0
    s_waitcnt lgkmcnt(10)
    ds_read_b128 v[188:191], v9 offset:2560
    ds_read_b128 v[196:199], v22 offset:2304
    v_smfmac_f32_16x16x64_bf16 v[224:227], v[204:207], v[180:187], v16
    ds_read_b128 v[180:183], v13 offset:0
    ds_read_b128 v[184:187], v14 offset:1280
    v_smfmac_f32_16x16x64_bf16 v[228:231], v[204:207], v[232:239], v16
    s_waitcnt lgkmcnt(11)
    ds_read_b128 v[232:235], v13 offset:2560
    ds_read_b128 v[236:239], v14 offset:3840
    ds_read_b128 v[204:207], v22 offset:2320
    v_mfma_f32_16x16x16_bf16 v[32:35], v[18:19], v[48:49], v[32:35]
    s_waitcnt lgkmcnt(13)
    ds_read_b128 v[212:215], v21 offset:6400
    v_cvt_pkrtz_f16_f32 v142, v224, v225
    v_cvt_pkrtz_f16_f32 v143, v226, v227
    v_cvt_pkrtz_f16_f32 v166, v228, v229
    v_dot2_f32_f16 v30, v157, v157, v30
    v_dot2_f32_f16 v28, v134, v134, v28
    v_dot2_f32_f16 v30, v158, v158, v30
    v_dot2_f32_f16 v28, v135, v135, v28
    v_dot2_f32_f16 v30, v159, v159, v30
    v_dot2_f32_f16 v28, v136, v136, v28
    v_dot2_f32_f16 v30, v160, v160, v30
    v_dot2_f32_f16 v28, v137, v137, v28
    v_dot2_f32_f16 v30, v161, v161, v30
    v_dot2_f32_f16 v28, v138, v138, v28
    v_dot2_f32_f16 v30, v162, v162, v30
    v_dot2_f32_f16 v28, v139, v139, v28
    v_dot2_f32_f16 v30, v163, v163, v30
    v_dot2_f32_f16 v28, v140, v140, v28
    v_dot2_f32_f16 v30, v164, v164, v30
    v_dot2_f32_f16 v28, v141, v141, v28
    v_dot2_f32_f16 v30, v165, v165, v30
    v_permlane16_swap_b32 v153, v157
    v_permlane16_swap_b32 v130, v134
    v_permlane16_swap_b32 v154, v158
    v_mfma_f32_16x16x32_bf16 v[144:147], v[192:195], a[232:235], 0
    s_waitcnt lgkmcnt(13)
    ds_read_b128 a[232:235], v10 offset:0
    v_permlane16_swap_b32 v131, v135
    v_mfma_f32_16x16x32_bf16 v[168:171], v[192:195], a[244:247], 0
    s_waitcnt lgkmcnt(11)
    ds_read_b128 a[244:247], v10 offset:2560
    ds_read_b128 v[192:195], v22 offset:2560
    v_permlane16_swap_b32 v155, v159
    v_smfmac_f32_16x16x64_bf16 v[144:147], v[200:203], a[236:243], v16
    s_waitcnt lgkmcnt(12)
    ds_read_b128 a[236:239], v14 offset:0
    ds_read_b128 a[240:243], v13 offset:1280
    v_cvt_pkrtz_f16_f32 v167, v230, v231
    v_smfmac_f32_16x16x64_bf16 v[168:171], v[200:203], a[248:255], v16
    s_waitcnt lgkmcnt(11)
    ds_read_b128 a[248:251], v14 offset:2560
    ds_read_b128 a[252:255], v13 offset:3840
    ds_read_b128 v[200:203], v22 offset:2576
    v_mfma_f32_16x16x32_f16 v[248:251], a[228:231], v[140:143], v[248:251]
    v_cvt_pkrtz_f16_f32 v144, v144, v145
    v_cvt_pkrtz_f16_f32 v145, v146, v147
    v_mfma_f32_16x16x32_f16 v[252:255], a[228:231], v[164:167], v[252:255]
    v_cvt_pkrtz_f16_f32 v168, v168, v169
    v_cvt_pkrtz_f16_f32 v169, v170, v171
    v_mfma_f32_16x16x32_bf16 v[224:227], v[196:199], v[176:179], 0
    s_waitcnt lgkmcnt(13)
    ds_read_b128 v[176:179], v11 offset:0
    v_mfma_f32_16x16x32_bf16 v[228:231], v[196:199], v[188:191], 0
    s_waitcnt lgkmcnt(10)
    ds_read_b128 v[188:191], v11 offset:2560
    ds_read_b128 v[196:199], v22 offset:2816
    v_smfmac_f32_16x16x64_bf16 v[224:227], v[204:207], v[180:187], v16
    ds_read_b128 v[180:183], v15 offset:0
    ds_read_b128 v[184:187], v12 offset:1280
    v_mfma_f32_16x16x16_bf16 v[36:39], v[18:19], v[50:51], v[36:39]
    s_waitcnt lgkmcnt(12)
    ds_read_b128 v[48:51], v25 offset:128
    ds_read_b128 v[52:55], v25 offset:144
    v_smfmac_f32_16x16x64_bf16 v[228:231], v[204:207], v[232:239], v16
    s_waitcnt lgkmcnt(11)
    ds_read_b128 v[232:235], v15 offset:2560
    ds_read_b128 v[236:239], v12 offset:3840
    ds_read_b128 v[204:207], v22 offset:2832
    v_mfma_f32_16x16x32_bf16 v[148:151], v[192:195], a[232:235], 0
    v_cvt_pkrtz_f16_f32 v146, v224, v225
    v_cvt_pkrtz_f16_f32 v147, v226, v227
    v_mfma_f32_16x16x32_bf16 v[172:175], v[192:195], a[244:247], 0
    s_waitcnt lgkmcnt(10)
    buffer_store_dwordx4 v[120:123], v26, s[24:27], s83 offen offset:128 sc0 sc1
    v_cvt_pkrtz_f16_f32 v170, v228, v229
    v_cvt_pkrtz_f16_f32 v171, v230, v231
    v_smfmac_f32_16x16x64_bf16 v[148:151], v[200:203], a[236:243], v16
    ds_read_b128 v[64:67], v25 offset:256
    v_add_u32 v26, s54, v26
    v_smfmac_f32_16x16x64_bf16 v[172:175], v[200:203], a[248:255], v16
    ds_read_b128 v[68:71], v25 offset:272
    ds_read_b128 a[232:235], v23 offset:0
    ds_read_b128 a[236:239], v23 offset:1024
    v_mfma_f32_16x16x32_f16 v[248:251], a[228:231], v[144:147], v[248:251]
    s_nop 0
    v_cvt_pkrtz_f16_f32 v148, v148, v149
    v_cvt_pkrtz_f16_f32 v149, v150, v151
    v_mfma_f32_16x16x32_f16 v[252:255], a[228:231], v[168:171], v[252:255]
    s_waitcnt lgkmcnt(11)
    v_cvt_pkrtz_f16_f32 v172, v172, v173
    v_cvt_pkrtz_f16_f32 v173, v174, v175
    v_mfma_f32_16x16x32_bf16 v[224:227], v[196:199], v[176:179], 0
    s_waitcnt lgkmcnt(9)
    v_mfma_f32_16x16x32_bf16 v[228:231], v[196:199], v[188:191], 0
    s_mov_b32 s54, 786432
    ds_read_b128 a[240:243], v23 offset:2048
    ds_read_b128 a[244:247], v23 offset:3072
    s_waitcnt lgkmcnt(6)
    v_smfmac_f32_16x16x64_bf16 v[224:227], v[204:207], v[180:187], v16
    ds_read_b128 v[208:211], v20 offset:6400
    ds_read_b128 a[248:251], v23 offset:4096
    v_smfmac_f32_16x16x64_bf16 v[228:231], v[204:207], v[232:239], v16
    ds_read_b128 a[252:255], v23 offset:5120
L_mid:
    v_permlane16_swap_b32 v136, v140
    v_permlane16_swap_b32 v160, v164
    v_dot2_f32_f16 v28, v142, v142, v28
    v_dot2_f32_f16 v30, v166, v166, v30
    v_cvt_pkrtz_f16_f32 v150, v224, v225
    v_cvt_pkrtz_f16_f32 v151, v226, v227
    v_dot2_f32_f16 v28, v143, v143, v28
    v_cvt_pkrtz_f16_f32 v174, v228, v229
    v_mfma_f32_16x16x32_f16 v[248:251], a[228:231], v[148:151], v[248:251]
    v_cvt_pkrtz_f16_f32 v175, v230, v231
    v_permlane16_swap_b32 v137, v141
    v_permlane16_swap_b32 v161, v165
    v_mfma_f32_16x16x32_f16 v[252:255], a[228:231], v[172:175], v[252:255]
    s_cmp_eq_u32 s52, 3
    v_permlane16_swap_b32 v138, v142
    v_permlane16_swap_b32 v162, v166
    v_permlane16_swap_b32 v139, v143
    v_dot2_f32_f16 v30, v167, v167, v30
    v_dot2_f32_f16 v28, v144, v144, v28
    v_dot2_f32_f16 v30, v168, v168, v30
    v_dot2_f32_f16 v28, v145, v145, v28
    v_dot2_f32_f16 v30, v169, v169, v30
    v_dot2_f32_f16 v28, v146, v146, v28
    v_dot2_f32_f16 v30, v170, v170, v30
    v_dot2_f32_f16 v28, v147, v147, v28
    v_dot2_f32_f16 v30, v171, v171, v30
    v_dot2_f32_f16 v28, v148, v148, v28
    v_dot2_f32_f16 v30, v172, v172, v30
    v_dot2_f32_f16 v28, v149, v149, v28
    v_dot2_f32_f16 v30, v173, v173, v30
    v_dot2_f32_f16 v28, v150, v150, v28
    v_dot2_f32_f16 v30, v174, v174, v30
    v_dot2_f32_f16 v28, v151, v151, v28
    v_dot2_f32_f16 v30, v175, v175, v30
    v_permlane16_swap_b32 v163, v167
    v_permlane16_swap_b32 v144, v148
    v_permlane16_swap_b32 v168, v172
    v_mfma_f32_16x16x16_bf16 v[96:99], v[18:19], v[216:217], v[48:51]
    s_cselect_b32 s57, 0x40000000, 786432
    ds_read_b128 v[240:243], v20 offset:2560
    ds_read_b128 v[244:247], v21 offset:2560
    v_add_u32 v1, s57, v1
    v_mfma_f32_16x16x16_bf16 v[100:103], v[18:19], v[218:219], v[52:55]
    ds_read_b128 v[236:239], v21 offset:0
    ds_read_b128 v[232:235], v20 offset:0
    v_add_u32 v2, s57, v2
    v_mfma_f32_16x16x16_bf16 v[104:107], v[18:19], v[220:221], v[48:51]
    v_add_u32 v3, s57, v3
    v_add_u32 v4, s57, v4
    v_add_u32 v5, s57, v5
    v_mfma_f32_16x16x16_bf16 v[108:111], v[18:19], v[222:223], v[52:55]
    v_add_u32 v6, s57, v6
    v_add_u32 v7, s57, v7
    v_add_u32 v31, s57, v31
    v_mfma_f32_16x16x16_bf16 v[56:59], v[18:19], v[212:213], v[48:51]
    v_permlane16_swap_b32 v145, v149
    v_permlane16_swap_b32 v169, v173
    v_mfma_f32_16x16x16_bf16 v[60:63], v[18:19], v[214:215], v[52:55]
    s_waitcnt lgkmcnt(6)
    v_permlane16_swap_b32 v146, v150
    v_permlane16_swap_b32 v170, v174
    v_mfma_f32_16x16x16_bf16 v[48:51], v[18:19], v[208:209], v[48:51]
    v_permlane16_swap_b32 v147, v151
    v_permlane16_swap_b32 v171, v175
    v_mfma_f32_16x16x16_bf16 v[52:55], v[18:19], v[210:211], v[52:55]
    v_mov_b32 v27, v28
    v_mov_b32 v29, v30
    s_nop 0
    v_permlane32_swap_b32 v27, v28
    v_permlane32_swap_b32 v29, v30
    v_add_f32 v28, v27, v28
    v_add_f32 v30, v29, v30
    v_mul_f32 v27, 0x3c2aaaab, v248
    v_mul_f32 v29, 0x3c2aaaab, v252
    v_mul_f32 v28, 0x3c2aaaab, v28
    v_mul_f32 v30, 0x3c2aaaab, v30
    v_fma_f32 v28, -v27, v27, v28
    v_fma_f32 v30, -v29, v29, v30
    v_max_f32 v28, 0, v28
    v_max_f32 v30, 0, v30
    v_add_f32 v28, 0x3727c5ac, v28
    v_add_f32 v30, 0x3727c5ac, v30
    v_rsq_f32 v28, v28
    v_rsq_f32 v30, v30
    v_fma_mixlo_f16 v28, v28, s59, 0
    v_fma_mixlo_f16 v30, v30, s59, 0
    v_fma_mixhi_f16 v28, -v27, v28, 0 op_sel_hi:[0,1,0]
    v_fma_mixhi_f16 v30, -v29, v30, 0 op_sel_hi:[0,1,0]
    v_mov_b32 v27, v28
    v_mov_b32 v29, v30
    s_nop 0
    v_permlane16_swap_b32 v28, v27
    v_permlane16_swap_b32 v30, v29
    v_pk_fma_f16 v128, v128, v28, v28 op_sel:[0,0,1] op_sel_hi:[1,0,1]
    v_pk_fma_f16 v129, v129, v28, v28 op_sel:[0,0,1] op_sel_hi:[1,0,1]
    v_pk_fma_f16 v130, v130, v28, v28 op_sel:[0,0,1] op_sel_hi:[1,0,1]
    v_pk_fma_f16 v131, v131, v28, v28 op_sel:[0,0,1] op_sel_hi:[1,0,1]
    v_pk_fma_f16 v132, v132, v27, v27 op_sel:[0,0,1] op_sel_hi:[1,0,1]
    v_pk_fma_f16 v133, v133, v27, v27 op_sel:[0,0,1] op_sel_hi:[1,0,1]
    v_mfma_f32_16x16x32_f16 v[176:179], a[232:235], v[128:131], 0
    v_pk_fma_f16 v134, v134, v27, v27 op_sel:[0,0,1] op_sel_hi:[1,0,1]
    v_pk_fma_f16 v135, v135, v27, v27 op_sel:[0,0,1] op_sel_hi:[1,0,1]
    v_pk_fma_f16 v136, v136, v28, v28 op_sel:[0,0,1] op_sel_hi:[1,0,1]
    v_pk_fma_f16 v137, v137, v28, v28 op_sel:[0,0,1] op_sel_hi:[1,0,1]
    v_mfma_f32_16x16x32_f16 v[184:187], a[232:235], v[132:135], 0
    v_pk_fma_f16 v138, v138, v28, v28 op_sel:[0,0,1] op_sel_hi:[1,0,1]
    v_pk_fma_f16 v139, v139, v28, v28 op_sel:[0,0,1] op_sel_hi:[1,0,1]
    v_pk_fma_f16 v140, v140, v27, v27 op_sel:[0,0,1] op_sel_hi:[1,0,1]
    v_mfma_f32_16x16x32_f16 v[180:183], a[236:239], v[128:131], 0
    v_pk_fma_f16 v141, v141, v27, v27 op_sel:[0,0,1] op_sel_hi:[1,0,1]
    v_pk_fma_f16 v142, v142, v27, v27 op_sel:[0,0,1] op_sel_hi:[1,0,1]
    v_pk_fma_f16 v143, v143, v27, v27 op_sel:[0,0,1] op_sel_hi:[1,0,1]
    v_mfma_f32_16x16x32_f16 v[188:191], a[236:239], v[132:135], 0
    v_pk_fma_f16 v147, v147, v28, v28 op_sel:[0,0,1] op_sel_hi:[1,0,1]
    v_pk_fma_f16 v144, v144, v28, v28 op_sel:[0,0,1] op_sel_hi:[1,0,1]
    v_pk_fma_f16 v145, v145, v28, v28 op_sel:[0,0,1] op_sel_hi:[1,0,1]
    v_mfma_f32_16x16x32_f16 v[176:179], a[240:243], v[136:139], v[176:179]
    v_bfi_b32 v147, v17, v147, s84
    v_pk_fma_f16 v146, v146, v28, v28 op_sel:[0,0,1] op_sel_hi:[1,0,1]
    v_pk_fma_f16 v151, v151, v27, v27 op_sel:[0,0,1] op_sel_hi:[1,0,1]
    v_mfma_f32_16x16x32_f16 v[184:187], a[240:243], v[140:143], v[184:187]
    v_pk_fma_f16 v148, v148, v27, v27 op_sel:[0,0,1] op_sel_hi:[1,0,1]
    v_pk_fma_f16 v149, v149, v27, v27 op_sel:[0,0,1] op_sel_hi:[1,0,1]
    v_bfi_b32 v151, v17, v151, s84
    v_mfma_f32_16x16x32_f16 v[180:183], a[244:247], v[136:139], v[180:183]
    v_pk_fma_f16 v150, v150, v27, v27 op_sel:[0,0,1] op_sel_hi:[1,0,1]
    v_pk_fma_f16 v152, v152, v30, v30 op_sel:[0,0,1] op_sel_hi:[1,0,1]
    v_pk_fma_f16 v153, v153, v30, v30 op_sel:[0,0,1] op_sel_hi:[1,0,1]
    v_mfma_f32_16x16x32_f16 v[188:191], a[244:247], v[140:143], v[188:191]
    s_waitcnt lgkmcnt(5)
    v_pk_fma_f16 v154, v154, v30, v30 op_sel:[0,0,1] op_sel_hi:[1,0,1]
    v_pk_fma_f16 v155, v155, v30, v30 op_sel:[0,0,1] op_sel_hi:[1,0,1]
    v_pk_fma_f16 v156, v156, v29, v29 op_sel:[0,0,1] op_sel_hi:[1,0,1]
    v_mfma_f32_16x16x32_f16 v[176:179], a[248:251], v[144:147], v[176:179]
    v_pk_fma_f16 v157, v157, v29, v29 op_sel:[0,0,1] op_sel_hi:[1,0,1]
    v_pk_fma_f16 v158, v158, v29, v29 op_sel:[0,0,1] op_sel_hi:[1,0,1]
    v_pk_fma_f16 v159, v159, v29, v29 op_sel:[0,0,1] op_sel_hi:[1,0,1]
    v_mfma_f32_16x16x32_f16 v[184:187], a[248:251], v[148:151], v[184:187]
    s_waitcnt lgkmcnt(4)
    v_pk_fma_f16 v160, v160, v30, v30 op_sel:[0,0,1] op_sel_hi:[1,0,1]
    v_pk_fma_f16 v161, v161, v30, v30 op_sel:[0,0,1] op_sel_hi:[1,0,1]
    v_pk_fma_f16 v162, v162, v30, v30 op_sel:[0,0,1] op_sel_hi:[1,0,1]
    v_mfma_f32_16x16x32_f16 v[180:183], a[252:255], v[144:147], v[180:183]
    v_pk_fma_f16 v163, v163, v30, v30 op_sel:[0,0,1] op_sel_hi:[1,0,1]
    v_pk_fma_f16 v164, v164, v29, v29 op_sel:[0,0,1] op_sel_hi:[1,0,1]
    v_pk_fma_f16 v165, v165, v29, v29 op_sel:[0,0,1] op_sel_hi:[1,0,1]
    v_mfma_f32_16x16x32_f16 v[188:191], a[252:255], v[148:151], v[188:191]
    v_pk_fma_f16 v166, v166, v29, v29 op_sel:[0,0,1] op_sel_hi:[1,0,1]
    v_pk_fma_f16 v167, v167, v29, v29 op_sel:[0,0,1] op_sel_hi:[1,0,1]
    v_pk_fma_f16 v171, v171, v30, v30 op_sel:[0,0,1] op_sel_hi:[1,0,1]
    v_mfma_f32_16x16x32_f16 v[192:195], a[232:235], v[152:155], 0
    v_pk_fma_f16 v168, v168, v30, v30 op_sel:[0,0,1] op_sel_hi:[1,0,1]
    v_pk_fma_f16 v169, v169, v30, v30 op_sel:[0,0,1] op_sel_hi:[1,0,1]
    v_bfi_b32 v171, v17, v171, s84
    v_mfma_f32_16x16x32_f16 v[200:203], a[232:235], v[156:159], 0
    ds_read_b128 a[232:235], v23 offset:10240
    v_pk_fma_f16 v170, v170, v30, v30 op_sel:[0,0,1] op_sel_hi:[1,0,1]
    v_pk_fma_f16 v175, v175, v29, v29 op_sel:[0,0,1] op_sel_hi:[1,0,1]
    v_mfma_f32_16x16x32_f16 v[196:199], a[236:239], v[152:155], 0
    v_pk_fma_f16 v172, v172, v29, v29 op_sel:[0,0,1] op_sel_hi:[1,0,1]
    v_pk_fma_f16 v173, v173, v29, v29 op_sel:[0,0,1] op_sel_hi:[1,0,1]
    v_bfi_b32 v175, v17, v175, s84
    v_mfma_f32_16x16x32_f16 v[204:207], a[236:239], v[156:159], 0
    ds_read_b128 a[236:239], v23 offset:11264
    v_pk_fma_f16 v174, v174, v29, v29 op_sel:[0,0,1] op_sel_hi:[1,0,1]
    v_cvt_pkrtz_f16_f32 v208, v176, v177
    v_mfma_f32_16x16x32_f16 v[192:195], a[240:243], v[160:163], v[192:195]
    v_pk_lshrrev_b16 v208, 3, v208 op_sel_hi:[0,1]
    v_mad_u32_u16 v209, v208, 2, s85
    v_mad_u32_u16 v208, v208, 2, s85 op_sel:[1,0,0,0]
    v_mfma_f32_16x16x32_f16 v[200:203], a[240:243], v[164:167], v[200:203]
    ds_read_u16 v209, v209
    ds_read_u16_d16_hi v208, v208
    ds_read_b128 a[240:243], v23 offset:12288
    v_mfma_f32_16x16x32_f16 v[196:199], a[244:247], v[160:163], v[196:199]
    v_cvt_pkrtz_f16_f32 v210, v178, v179
    v_pk_lshrrev_b16 v210, 3, v210 op_sel_hi:[0,1]
    v_mad_u32_u16 v211, v210, 2, s85
    v_mfma_f32_16x16x32_f16 v[204:207], a[244:247], v[164:167], v[204:207]
    ds_read_u16 v211, v211
    ds_read_b128 a[244:247], v23 offset:13312
    v_mad_u32_u16 v210, v210, 2, s85 op_sel:[1,0,0,0]
    v_mfma_f32_16x16x32_f16 v[192:195], a[248:251], v[168:171], v[192:195]
    ds_read_u16_d16_hi v210, v210
    v_cvt_pkrtz_f16_f32 v212, v180, v181
    v_pk_lshrrev_b16 v212, 3, v212 op_sel_hi:[0,1]
    v_mfma_f32_16x16x32_f16 v[200:203], a[248:251], v[172:175], v[200:203]
    s_waitcnt lgkmcnt(11)
    ds_read_b128 a[248:251], v23 offset:14336
    v_mad_u32_u16 v213, v212, 2, s85
    v_mad_u32_u16 v212, v212, 2, s85 op_sel:[1,0,0,0]
    v_mfma_f32_16x16x32_f16 v[196:199], a[252:255], v[168:171], v[196:199]
    s_add_u32 m0, s56, 6336
    ds_read_u16 v213, v213
    ds_read_u16_d16_hi v212, v212
    buffer_load_dwordx4 v1, s[20:23], 0 offen offset:64 lds
    v_mfma_f32_16x16x32_f16 v[204:207], a[252:255], v[172:175], v[204:207]
    s_waitcnt lgkmcnt(13)
    ds_read_b128 a[252:255], v23 offset:15360
    v_cvt_pkrtz_f16_f32 v214, v182, v183
    v_pk_lshrrev_b16 v214, 3, v214 op_sel_hi:[0,1]
    v_mfma_f32_16x16x16_bf16 v[112:115], v[18:19], v[240:241], v[64:67]
    v_mad_u32_u16 v215, v214, 2, s85
    v_mad_u32_u16 v214, v214, 2, s85 op_sel:[1,0,0,0]
    v_cvt_pkrtz_f16_f32 v216, v184, v185
    v_mfma_f32_16x16x16_bf16 v[116:119], v[18:19], v[242:243], v[68:71]
    s_waitcnt lgkmcnt(12)
    ds_read_u16 v215, v215
    ds_read_u16_d16_hi v214, v214
    v_pk_lshrrev_b16 v216, 3, v216 op_sel_hi:[0,1]
    v_mfma_f32_16x16x16_bf16 v[120:123], v[18:19], v[244:245], v[64:67]
    v_mad_u32_u16 v217, v216, 2, s85
    v_mad_u32_u16 v216, v216, 2, s85 op_sel:[1,0,0,0]
    v_cvt_pkrtz_f16_f32 v218, v186, v187
    v_mfma_f32_16x16x16_bf16 v[124:127], v[18:19], v[246:247], v[68:71]
    s_waitcnt lgkmcnt(12)
    ds_read_u16 v217, v217
    ds_read_u16_d16_hi v216, v216
    v_pk_lshrrev_b16 v218, 3, v218 op_sel_hi:[0,1]
    v_mfma_f32_16x16x16_bf16 v[72:75], v[18:19], v[236:237], v[64:67]
    v_mad_u32_u16 v219, v218, 2, s85
    v_mad_u32_u16 v218, v218, 2, s85 op_sel:[1,0,0,0]
    v_cvt_pkrtz_f16_f32 v220, v188, v189
    v_mfma_f32_16x16x16_bf16 v[76:79], v[18:19], v[238:239], v[68:71]
    s_waitcnt lgkmcnt(12)
    ds_read_u16 v219, v219
    ds_read_u16_d16_hi v218, v218
    v_pk_lshrrev_b16 v220, 3, v220 op_sel_hi:[0,1]
    v_mfma_f32_16x16x16_bf16 v[64:67], v[18:19], v[232:233], v[64:67]
    v_mad_u32_u16 v221, v220, 2, s85
    v_mad_u32_u16 v220, v220, 2, s85 op_sel:[1,0,0,0]
    v_cvt_pkrtz_f16_f32 v222, v190, v191
    v_mfma_f32_16x16x16_bf16 v[68:71], v[18:19], v[234:235], v[68:71]
    s_waitcnt lgkmcnt(12)
    ds_read_u16 v221, v221
    ds_read_u16_d16_hi v220, v220
    v_pk_lshrrev_b16 v222, 3, v222 op_sel_hi:[0,1]
    v_mfma_f32_16x16x32_f16 v[176:179], a[232:235], v[128:131], 0
    v_mad_u32_u16 v223, v222, 2, s85
    v_mad_u32_u16 v222, v222, 2, s85 op_sel:[1,0,0,0]
    v_or_b32 v232, v209, v208
    v_mfma_f32_16x16x32_f16 v[184:187], a[232:235], v[132:135], 0
    s_waitcnt lgkmcnt(12)
    ds_read_u16 v223, v223
    ds_read_u16_d16_hi v222, v222
    v_or_b32 v233, v211, v210
    v_mfma_f32_16x16x32_f16 v[180:183], a[236:239], v[128:131], 0
    s_waitcnt lgkmcnt(8)
    v_or_b32 v234, v213, v212
    v_or_b32 v235, v215, v214
    v_cvt_pkrtz_f16_f32 v224, v192, v193
    v_mfma_f32_16x16x32_f16 v[188:191], a[236:239], v[132:135], 0
    s_waitcnt lgkmcnt(7)
    v_pk_lshrrev_b16 v224, 3, v224 op_sel_hi:[0,1]
    v_cvt_pkrtz_f16_f32 v226, v194, v195
    s_waitcnt lgkmcnt(6)
    v_or_b32 v236, v217, v216
    v_mfma_f32_16x16x32_f16 v[192:195], a[232:235], v[152:155], 0
    v_cvt_pkrtz_f16_f32 v228, v196, v197
    v_cvt_pkrtz_f16_f32 v230, v198, v199
    v_cvt_pkrtz_f16_f32 v248, v200, v201
    v_cvt_pkrtz_f16_f32 v250, v202, v203
    v_mfma_f32_16x16x32_f16 v[200:203], a[232:235], v[156:159], 0
    ds_read_b128 a[232:235], v23 offset:6144
    v_cvt_pkrtz_f16_f32 v252, v204, v205
    v_cvt_pkrtz_f16_f32 v0, v206, v207
    v_mfma_f32_16x16x32_f16 v[176:179], a[240:243], v[136:139], v[176:179]
    s_waitcnt lgkmcnt(5)
    v_or_b32 v237, v219, v218
    v_mad_u32_u16 v225, v224, 2, s85
    v_mad_u32_u16 v224, v224, 2, s85 op_sel:[1,0,0,0]
    v_mfma_f32_16x16x32_f16 v[184:187], a[240:243], v[140:143], v[184:187]
    ds_read_u16 v225, v225
    ds_read_u16_d16_hi v224, v224
    v_pk_lshrrev_b16 v226, 3, v226 op_sel_hi:[0,1]
    v_mfma_f32_16x16x32_f16 v[196:199], a[236:239], v[152:155], 0
    v_mad_u32_u16 v227, v226, 2, s85
    v_mad_u32_u16 v226, v226, 2, s85 op_sel:[1,0,0,0]
    v_pk_lshrrev_b16 v228, 3, v228 op_sel_hi:[0,1]
    v_mfma_f32_16x16x32_f16 v[204:207], a[236:239], v[156:159], 0
    ds_read_u16 v227, v227
    ds_read_u16_d16_hi v226, v226
    ds_read_b128 a[236:239], v23 offset:7168
    v_mfma_f32_16x16x32_f16 v[180:183], a[244:247], v[136:139], v[180:183]
    s_waitcnt lgkmcnt(8)
    v_or_b32 v238, v221, v220
    v_mad_u32_u16 v229, v228, 2, s85
    v_mad_u32_u16 v228, v228, 2, s85 op_sel:[1,0,0,0]
    v_mfma_f32_16x16x32_f16 v[188:191], a[244:247], v[140:143], v[188:191]
    s_waitcnt lgkmcnt(6)
    ds_read_u16 v229, v229
    ds_read_u16_d16_hi v228, v228
    v_or_b32 v239, v223, v222
    v_mfma_f32_16x16x32_f16 v[192:195], a[240:243], v[160:163], v[192:195]
    v_pk_lshrrev_b16 v230, 3, v230 op_sel_hi:[0,1]
    v_mad_u32_u16 v231, v230, 2, s85
    v_mad_u32_u16 v230, v230, 2, s85 op_sel:[1,0,0,0]
    v_mfma_f32_16x16x32_f16 v[200:203], a[240:243], v[164:167], v[200:203]
    ds_read_u16 v231, v231
    ds_read_u16_d16_hi v230, v230
    ds_read_b128 a[240:243], v23 offset:8192
    v_mfma_f32_16x16x32_f16 v[176:179], a[248:251], v[144:147], v[176:179]
    v_pk_lshrrev_b16 v248, 3, v248 op_sel_hi:[0,1]
    v_mad_u32_u16 v249, v248, 2, s85
    v_mad_u32_u16 v248, v248, 2, s85 op_sel:[1,0,0,0]
    v_mfma_f32_16x16x32_f16 v[184:187], a[248:251], v[148:151], v[184:187]
    ds_read_u16 v249, v249
    ds_read_u16_d16_hi v248, v248
    v_pk_lshrrev_b16 v250, 3, v250 op_sel_hi:[0,1]
    v_mfma_f32_16x16x32_f16 v[196:199], a[244:247], v[160:163], v[196:199]
    v_mad_u32_u16 v251, v250, 2, s85
    v_mad_u32_u16 v250, v250, 2, s85 op_sel:[1,0,0,0]
    v_pk_lshrrev_b16 v252, 3, v252 op_sel_hi:[0,1]
    v_mfma_f32_16x16x32_f16 v[204:207], a[244:247], v[164:167], v[204:207]
    s_waitcnt lgkmcnt(11)
    ds_read_u16 v251, v251
    ds_read_u16_d16_hi v250, v250
    ds_read_b128 a[244:247], v23 offset:9216
    v_mfma_f32_16x16x32_f16 v[180:183], a[252:255], v[144:147], v[180:183]
    s_add_u32 m0, s56, 7360
    v_mad_u32_u16 v253, v252, 2, s85
    v_mad_u32_u16 v252, v252, 2, s85 op_sel:[1,0,0,0]
    v_pk_lshrrev_b16 v0, 3, v0 op_sel_hi:[0,1]
    v_mfma_f32_16x16x32_f16 v[188:191], a[252:255], v[148:151], v[188:191]
    s_waitcnt lgkmcnt(12)
    ds_read_u16 v253, v253
    ds_read_u16_d16_hi v252, v252
    buffer_load_dwordx4 v2, s[20:23], 0 offen offset:64 lds
    v_mfma_f32_16x16x32_f16 v[192:195], a[248:251], v[168:171], v[192:195]
    v_mad_u32_u16 v208, v0, 2, s85
    v_mad_u32_u16 v0, v0, 2, s85 op_sel:[1,0,0,0]
    v_or_b32 v240, v225, v224
    v_mfma_f32_16x16x32_f16 v[200:203], a[248:251], v[172:175], v[200:203]
    s_waitcnt lgkmcnt(12)
    ds_read_u16 v208, v208
    ds_read_u16_d16_hi v0, v0
    v_or_b32 v241, v227, v226
    v_mfma_f32_16x16x32_f16 v[196:199], a[252:255], v[168:171], v[196:199]
    s_waitcnt lgkmcnt(12)
    ds_read_b128 a[248:251], v23 offset:20480
    v_or_b32 v242, v229, v228
    v_cvt_pkrtz_f16_f32 v209, v176, v177
    v_mfma_f32_16x16x32_f16 v[204:207], a[252:255], v[172:175], v[204:207]
    s_waitcnt lgkmcnt(11)
    v_pk_lshrrev_b16 v209, 3, v209 op_sel_hi:[0,1]
    v_or_b32 v243, v231, v230
    v_mad_u32_u16 v210, v209, 2, s85
    v_mfma_f32_16x16x32_bf16 v[32:35], a[192:195], v[232:235], v[32:35]
    ds_read_b128 a[252:255], v23 offset:21504
    ds_read_u16 v210, v210
    v_mad_u32_u16 v209, v209, 2, s85 op_sel:[1,0,0,0]
    v_mfma_f32_16x16x32_bf16 v[40:43], a[192:195], v[236:239], v[40:43]
    v_cvt_pkrtz_f16_f32 v211, v178, v179
    v_pk_lshrrev_b16 v211, 3, v211 op_sel_hi:[0,1]
    v_mad_u32_u16 v212, v211, 2, s85
    v_mfma_f32_16x16x32_bf16 v[36:39], a[196:199], v[232:235], v[36:39]
    ds_read_u16_d16_hi v209, v209
    v_mad_u32_u16 v211, v211, 2, s85 op_sel:[1,0,0,0]
    v_cvt_pkrtz_f16_f32 v213, v180, v181
    v_mfma_f32_16x16x32_bf16 v[44:47], a[196:199], v[236:239], v[44:47]
    s_waitcnt lgkmcnt(11)
    ds_read_u16 v212, v212
    v_or_b32 v244, v249, v248
    v_pk_lshrrev_b16 v213, 3, v213 op_sel_hi:[0,1]
    v_mfma_f32_16x16x32_bf16 v[80:83], a[192:195], v[240:243], v[80:83]
    s_waitcnt lgkmcnt(11)
    v_mad_u32_u16 v214, v213, 2, s85
    v_mad_u32_u16 v213, v213, 2, s85 op_sel:[1,0,0,0]
    v_cvt_pkrtz_f16_f32 v215, v182, v183
    v_pk_lshrrev_b16 v215, 3, v215 op_sel_hi:[0,1]
    v_mad_u32_u16 v216, v215, 2, s85
    v_mad_u32_u16 v215, v215, 2, s85 op_sel:[1,0,0,0]
    v_cvt_pkrtz_f16_f32 v217, v184, v185
    s_waitcnt lgkmcnt(10)
    v_or_b32 v245, v251, v250
    v_pk_lshrrev_b16 v217, 3, v217 op_sel_hi:[0,1]
    v_mad_u32_u16 v218, v217, 2, s85
    v_mad_u32_u16 v217, v217, 2, s85 op_sel:[1,0,0,0]
    v_cvt_pkrtz_f16_f32 v219, v186, v187
    v_pk_lshrrev_b16 v219, 3, v219 op_sel_hi:[0,1]
    v_mad_u32_u16 v220, v219, 2, s85
    v_mad_u32_u16 v219, v219, 2, s85 op_sel:[1,0,0,0]
    v_cvt_pkrtz_f16_f32 v221, v188, v189
    v_pk_lshrrev_b16 v221, 3, v221 op_sel_hi:[0,1]
    v_mad_u32_u16 v222, v221, 2, s85
    v_mad_u32_u16 v221, v221, 2, s85 op_sel:[1,0,0,0]
    v_cvt_pkrtz_f16_f32 v223, v190, v191
    v_pk_lshrrev_b16 v223, 3, v223 op_sel_hi:[0,1]
    v_mad_u32_u16 v224, v223, 2, s85
    v_mad_u32_u16 v223, v223, 2, s85 op_sel:[1,0,0,0]
    v_cvt_pkrtz_f16_f32 v225, v192, v193
    v_pk_lshrrev_b16 v225, 3, v225 op_sel_hi:[0,1]
    s_waitcnt lgkmcnt(7)
    v_or_b32 v246, v253, v252
    v_cvt_pkrtz_f16_f32 v227, v194, v195
    v_cvt_pkrtz_f16_f32 v229, v196, v197
    v_cvt_pkrtz_f16_f32 v231, v198, v199
    v_cvt_pkrtz_f16_f32 v249, v200, v201
    v_cvt_pkrtz_f16_f32 v251, v202, v203
    v_mad_u32_u16 v226, v225, 2, s85
    v_mad_u32_u16 v225, v225, 2, s85 op_sel:[1,0,0,0]
    v_pk_lshrrev_b16 v227, 3, v227 op_sel_hi:[0,1]
    v_mad_u32_u16 v228, v227, 2, s85
    v_mad_u32_u16 v227, v227, 2, s85 op_sel:[1,0,0,0]
    v_pk_lshrrev_b16 v229, 3, v229 op_sel_hi:[0,1]
    v_mad_u32_u16 v230, v229, 2, s85
    s_waitcnt lgkmcnt(5)
    v_or_b32 v247, v208, v0
    v_cvt_pkrtz_f16_f32 v208, v204, v205
    v_mad_u32_u16 v229, v229, 2, s85 op_sel:[1,0,0,0]
    v_mfma_f32_16x16x32_bf16 v[88:91], a[192:195], v[244:247], v[88:91]
    ds_read_u16_d16_hi v211, v211
    ds_read_u16 v214, v214
    ds_read_u16_d16_hi v213, v213
    ds_read_u16 v216, v216
    v_mfma_f32_16x16x32_bf16 v[48:51], a[232:235], v[232:235], v[48:51]
    ds_read_u16_d16_hi v215, v215
    ds_read_u16 v218, v218
    ds_read_u16_d16_hi v217, v217
    ds_read_u16 v220, v220
    v_mfma_f32_16x16x32_bf16 v[56:59], a[232:235], v[236:239], v[56:59]
    s_waitcnt lgkmcnt(12)
    ds_read_u16_d16_hi v219, v219
    ds_read_u16 v222, v222
    v_pk_lshrrev_b16 v231, 3, v231 op_sel_hi:[0,1]
    v_mfma_f32_16x16x32_bf16 v[84:87], a[196:199], v[240:243], v[84:87]
    s_waitcnt lgkmcnt(13)
    ds_read_u16_d16_hi v221, v221
    v_mad_u32_u16 v248, v231, 2, s85
    v_mad_u32_u16 v231, v231, 2, s85 op_sel:[1,0,0,0]
    v_mfma_f32_16x16x32_bf16 v[92:95], a[196:199], v[244:247], v[92:95]
    v_pk_lshrrev_b16 v249, 3, v249 op_sel_hi:[0,1]
    v_mad_u32_u16 v250, v249, 2, s85
    v_mad_u32_u16 v249, v249, 2, s85 op_sel:[1,0,0,0]
    v_mfma_f32_16x16x32_bf16 v[52:55], a[236:239], v[232:235], v[52:55]
    s_waitcnt lgkmcnt(13)
    ds_read_u16 v224, v224
    v_pk_lshrrev_b16 v251, 3, v251 op_sel_hi:[0,1]
    v_mad_u32_u16 v252, v251, 2, s85
    v_mfma_f32_16x16x32_bf16 v[60:63], a[236:239], v[236:239], v[60:63]
    s_waitcnt lgkmcnt(13)
    ds_read_u16_d16_hi v223, v223
    v_mad_u32_u16 v251, v251, 2, s85 op_sel:[1,0,0,0]
    v_pk_fma_f16 v253, v208, v208, s53
    v_mfma_f32_16x16x32_bf16 v[96:99], a[232:235], v[240:243], v[96:99]
    s_waitcnt lgkmcnt(13)
    ds_read_u16 v226, v226
    v_pk_mul_f16 v253, v253, v208 neg_lo:[1,0] neg_hi:[1,0]
    v_exp_f16 v0, v253
    v_mfma_f32_16x16x32_bf16 v[104:107], a[232:235], v[244:247], v[104:107]
    s_add_u32 m0, s56, 8384
    v_exp_f16_sdwa v0, v253 dst_sel:WORD_1 dst_unused:UNUSED_PRESERVE src0_sel:WORD_1
    v_mfma_f32_16x16x32_bf16 v[64:67], a[240:243], v[232:235], v[64:67]
    s_waitcnt lgkmcnt(12)
    ds_read_b128 a[232:235], v23 offset:22528
    buffer_load_dwordx4 v3, s[20:23], 0 offen offset:64 lds
    ds_read_u16_d16_hi v225, v225
    v_mfma_f32_16x16x32_bf16 v[72:75], a[240:243], v[236:239], v[72:75]
    v_pk_fma_f16 v0, v0, s86, s86
    v_rcp_f16 v253, v0
    v_mfma_f32_16x16x32_bf16 v[100:103], a[236:239], v[240:243], v[100:103]
    s_waitcnt lgkmcnt(13)
    ds_read_u16 v228, v228
    v_rcp_f16_sdwa v253, v0 dst_sel:WORD_1 dst_unused:UNUSED_PRESERVE src0_sel:WORD_1
    v_mfma_f32_16x16x32_bf16 v[108:111], a[236:239], v[244:247], v[108:111]
    s_waitcnt lgkmcnt(13)
    ds_read_b128 a[236:239], v23 offset:23552
    v_fma_mix_f32 v0, v253, v208, 0 op_sel_hi:[1,1,0]
    v_fma_mix_f32 v253, v253, v208, 0 op_sel:[1,1,0] op_sel_hi:[1,1,0]
    v_mfma_f32_16x16x32_bf16 v[68:71], a[244:247], v[232:235], v[68:71]
    v_or_b32 v232, v210, v209
    v_or_b32 v233, v212, v211
    v_or_b32 v234, v214, v213
    v_mfma_f32_16x16x32_bf16 v[76:79], a[244:247], v[236:239], v[76:79]
    s_waitcnt lgkmcnt(11)
    ds_read_u16_d16_hi v227, v227
    v_or_b32 v235, v216, v215
    v_or_b32 v236, v218, v217
    v_mfma_f32_16x16x32_bf16 v[112:115], a[240:243], v[240:243], v[112:115]
    ds_read_u16 v230, v230
    v_cvt_pkrtz_f16_f32 v211, v206, v207
    v_pk_fma_f16 v209, v211, v211, s53
    v_mfma_f32_16x16x32_bf16 v[120:123], a[240:243], v[244:247], v[120:123]
    s_waitcnt lgkmcnt(11)
    ds_read_b128 a[240:243], v23 offset:24576
    v_or_b32 v237, v220, v219
    v_pk_mul_f16 v209, v209, v211 neg_lo:[1,0] neg_hi:[1,0]
    v_mfma_f32_16x16x32_bf16 v[116:119], a[244:247], v[240:243], v[116:119]
    v_exp_f16 v210, v209
    v_mfma_f32_16x16x32_bf16 v[124:127], a[244:247], v[244:247], v[124:127]
    ds_read_b128 a[244:247], v23 offset:25600
    v_exp_f16_sdwa v210, v209 dst_sel:WORD_1 dst_unused:UNUSED_PRESERVE src0_sel:WORD_1
    v_mfma_f32_16x16x32_f16 v[176:179], a[248:251], v[128:131], 0
    s_waitcnt lgkmcnt(11)
    ds_read_u16_d16_hi v229, v229
    v_or_b32 v238, v222, v221
    v_pk_fma_f16 v210, v210, s86, s86
    v_mfma_f32_16x16x32_f16 v[184:187], a[248:251], v[132:135], 0
    v_rcp_f16 v209, v210
    v_cvt_pk_bf16_f32 v246, v0, v253
    v_mfma_f32_16x16x32_f16 v[180:183], a[252:255], v[128:131], 0
    ds_read_u16 v248, v248
    v_rcp_f16_sdwa v209, v210 dst_sel:WORD_1 dst_unused:UNUSED_PRESERVE src0_sel:WORD_1
    v_mfma_f32_16x16x32_f16 v[188:191], a[252:255], v[132:135], 0
    s_waitcnt lgkmcnt(11)
    ds_read_u16_d16_hi v231, v231
    v_or_b32 v239, v224, v223
    v_fma_mix_f32 v210, v209, v211, 0 op_sel_hi:[1,1,0]
    v_mfma_f32_16x16x32_f16 v[192:195], a[248:251], v[152:155], 0
    ds_read_u16 v250, v250
    v_fma_mix_f32 v209, v209, v211, 0 op_sel:[1,1,0] op_sel_hi:[1,1,0]
    v_cvt_pk_bf16_f32 v247, v210, v209
    v_mfma_f32_16x16x32_f16 v[200:203], a[248:251], v[156:159], 0
    s_waitcnt lgkmcnt(11)
    ds_read_u16_d16_hi v249, v249
    v_mfma_f32_16x16x32_f16 v[176:179], a[232:235], v[136:139], v[176:179]
    ds_read_u16 v252, v252
    v_mfma_f32_16x16x32_f16 v[184:187], a[232:235], v[140:143], v[184:187]
    s_waitcnt lgkmcnt(12)
    v_or_b32 v240, v226, v225
    v_mfma_f32_16x16x32_f16 v[196:199], a[252:255], v[152:155], 0
    ds_read_u16_d16_hi v251, v251
    v_mfma_f32_16x16x32_f16 v[204:207], a[252:255], v[156:159], 0
    s_waitcnt lgkmcnt(11)
    ds_read_b128 a[248:251], v23 offset:16384
    v_mfma_f32_16x16x32_f16 v[180:183], a[236:239], v[136:139], v[180:183]
    v_mfma_f32_16x16x32_f16 v[188:191], a[236:239], v[140:143], v[188:191]
    s_waitcnt lgkmcnt(11)
    ds_read_b128 a[252:255], v23 offset:17408
    v_or_b32 v241, v228, v227
    v_mfma_f32_16x16x32_f16 v[192:195], a[232:235], v[160:163], v[192:195]
    v_mfma_f32_16x16x32_f16 v[200:203], a[232:235], v[164:167], v[200:203]
    ds_read_b128 a[232:235], v23 offset:18432
    s_waitcnt lgkmcnt(11)
    v_mfma_f32_16x16x32_f16 v[176:179], a[240:243], v[144:147], v[176:179]
    s_add_u32 m0, s56, 10432
    v_mfma_f32_16x16x32_f16 v[184:187], a[240:243], v[148:151], v[184:187]
    buffer_load_dwordx4 v5, s[20:23], 0 offen offset:64 lds
    s_add_u32 m0, s56, 9408
    v_mfma_f32_16x16x32_f16 v[196:199], a[236:239], v[160:163], v[196:199]
    buffer_load_dwordx4 v4, s[20:23], 0 offen offset:64 lds
    v_mfma_f32_16x16x32_f16 v[204:207], a[236:239], v[164:167], v[204:207]
    s_waitcnt lgkmcnt(9)
    ds_read_b128 a[236:239], v23 offset:19456
    v_or_b32 v242, v230, v229
    v_cvt_pkrtz_f16_f32 v212, v176, v177
    v_mfma_f32_16x16x32_f16 v[180:183], a[244:247], v[144:147], v[180:183]
    s_waitcnt lgkmcnt(9)
    v_pk_lshrrev_b16 v212, 3, v212 op_sel_hi:[0,1]
    v_mad_u32_u16 v213, v212, 2, s85
    s_waitcnt lgkmcnt(8)
    v_or_b32 v243, v248, v231
    v_mfma_f32_16x16x32_f16 v[188:191], a[244:247], v[148:151], v[188:191]
    ds_read_u16 v213, v213
    v_mad_u32_u16 v212, v212, 2, s85 op_sel:[1,0,0,0]
    v_cvt_pkrtz_f16_f32 v214, v178, v179
    v_mfma_f32_16x16x32_f16 v[192:195], a[240:243], v[168:171], v[192:195]
    ds_read_u16_d16_hi v212, v212
    v_pk_lshrrev_b16 v214, 3, v214 op_sel_hi:[0,1]
    v_mad_u32_u16 v215, v214, 2, s85
    v_mfma_f32_16x16x32_f16 v[200:203], a[240:243], v[172:175], v[200:203]
    s_waitcnt lgkmcnt(8)
    ds_read_b128 a[240:243], v23 offset:30720
    ds_read_u16 v215, v215
    v_or_b32 v244, v250, v249
    v_mfma_f32_16x16x32_f16 v[196:199], a[244:247], v[168:171], v[196:199]
    v_mad_u32_u16 v214, v214, 2, s85 op_sel:[1,0,0,0]
    v_cvt_pkrtz_f16_f32 v216, v180, v181
    v_pk_lshrrev_b16 v216, 3, v216 op_sel_hi:[0,1]
    v_mfma_f32_16x16x32_f16 v[204:207], a[244:247], v[172:175], v[204:207]
    ds_read_b128 a[244:247], v23 offset:31744
    ds_read_u16_d16_hi v214, v214
    v_mad_u32_u16 v217, v216, 2, s85
    v_mfma_f32_16x16x32_bf16 v[32:35], a[200:203], v[232:235], v[32:35]
    s_waitcnt lgkmcnt(10)
    ds_read_u16 v217, v217
    v_or_b32 v245, v252, v251
    v_mad_u32_u16 v216, v216, 2, s85 op_sel:[1,0,0,0]
    v_mfma_f32_16x16x32_bf16 v[40:43], a[200:203], v[236:239], v[40:43]
    ds_read_u16_d16_hi v216, v216
    v_cvt_pkrtz_f16_f32 v218, v182, v183
    v_pk_lshrrev_b16 v218, 3, v218 op_sel_hi:[0,1]
    v_mfma_f32_16x16x32_bf16 v[36:39], a[204:207], v[232:235], v[36:39]
    v_mad_u32_u16 v219, v218, 2, s85
    v_mad_u32_u16 v218, v218, 2, s85 op_sel:[1,0,0,0]
    v_cvt_pkrtz_f16_f32 v220, v184, v185
    v_mfma_f32_16x16x32_bf16 v[44:47], a[204:207], v[236:239], v[44:47]
    ds_read_u16 v219, v219
    ds_read_u16_d16_hi v218, v218
    v_pk_lshrrev_b16 v220, 3, v220 op_sel_hi:[0,1]
    v_mfma_f32_16x16x32_bf16 v[80:83], a[200:203], v[240:243], v[80:83]
    v_mad_u32_u16 v221, v220, 2, s85
    v_mad_u32_u16 v220, v220, 2, s85 op_sel:[1,0,0,0]
    v_cvt_pkrtz_f16_f32 v222, v186, v187
    v_mfma_f32_16x16x32_bf16 v[88:91], a[200:203], v[244:247], v[88:91]
    s_waitcnt lgkmcnt(12)
    ds_read_u16 v221, v221
    ds_read_u16_d16_hi v220, v220
    v_pk_lshrrev_b16 v222, 3, v222 op_sel_hi:[0,1]
    v_mfma_f32_16x16x32_bf16 v[48:51], a[248:251], v[232:235], v[48:51]
    v_mad_u32_u16 v223, v222, 2, s85
    v_mad_u32_u16 v222, v222, 2, s85 op_sel:[1,0,0,0]
    v_cvt_pkrtz_f16_f32 v224, v188, v189
    v_mfma_f32_16x16x32_bf16 v[56:59], a[248:251], v[236:239], v[56:59]
    s_waitcnt lgkmcnt(12)
    ds_read_u16 v223, v223
    ds_read_u16_d16_hi v222, v222
    v_pk_lshrrev_b16 v224, 3, v224 op_sel_hi:[0,1]
    v_mfma_f32_16x16x32_bf16 v[84:87], a[204:207], v[240:243], v[84:87]
    v_mad_u32_u16 v225, v224, 2, s85
    v_mad_u32_u16 v224, v224, 2, s85 op_sel:[1,0,0,0]
    v_cvt_pkrtz_f16_f32 v226, v190, v191
    v_mfma_f32_16x16x32_bf16 v[92:95], a[204:207], v[244:247], v[92:95]
    s_waitcnt lgkmcnt(12)
    ds_read_u16 v225, v225
    ds_read_u16_d16_hi v224, v224
    v_pk_lshrrev_b16 v226, 3, v226 op_sel_hi:[0,1]
    v_mfma_f32_16x16x32_bf16 v[52:55], a[252:255], v[232:235], v[52:55]
    v_mad_u32_u16 v227, v226, 2, s85
    v_mad_u32_u16 v226, v226, 2, s85 op_sel:[1,0,0,0]
    v_cvt_pkrtz_f16_f32 v228, v192, v193
    v_mfma_f32_16x16x32_bf16 v[60:63], a[252:255], v[236:239], v[60:63]
    s_waitcnt lgkmcnt(12)
    ds_read_u16 v227, v227
    ds_read_u16_d16_hi v226, v226
    v_pk_lshrrev_b16 v228, 3, v228 op_sel_hi:[0,1]
    v_mfma_f32_16x16x32_bf16 v[96:99], a[248:251], v[240:243], v[96:99]
    v_cvt_pkrtz_f16_f32 v230, v194, v195
    v_cvt_pkrtz_f16_f32 v248, v196, v197
    v_cvt_pkrtz_f16_f32 v250, v198, v199
    v_mfma_f32_16x16x32_bf16 v[104:107], a[248:251], v[244:247], v[104:107]
    s_waitcnt lgkmcnt(13)
    ds_read_b128 a[248:251], v23 offset:32768
    v_cvt_pkrtz_f16_f32 v252, v200, v201
    v_cvt_pkrtz_f16_f32 v0, v202, v203
    v_mfma_f32_16x16x32_bf16 v[64:67], a[232:235], v[232:235], v[64:67]
    v_cvt_pkrtz_f16_f32 v209, v204, v205
    v_cvt_pkrtz_f16_f32 v211, v206, v207
    v_mad_u32_u16 v229, v228, 2, s85
    v_mfma_f32_16x16x32_bf16 v[72:75], a[232:235], v[236:239], v[72:75]
    s_waitcnt lgkmcnt(13)
    ds_read_u16 v229, v229
    v_mad_u32_u16 v228, v228, 2, s85 op_sel:[1,0,0,0]
    v_pk_lshrrev_b16 v230, 3, v230 op_sel_hi:[0,1]
    v_mfma_f32_16x16x32_bf16 v[100:103], a[252:255], v[240:243], v[100:103]
    s_waitcnt lgkmcnt(13)
    ds_read_u16_d16_hi v228, v228
    v_mad_u32_u16 v231, v230, 2, s85
    v_mad_u32_u16 v230, v230, 2, s85 op_sel:[1,0,0,0]
    v_mfma_f32_16x16x32_bf16 v[108:111], a[252:255], v[244:247], v[108:111]
    s_waitcnt lgkmcnt(12)
    ds_read_b128 a[252:255], v23 offset:33792
    ds_read_u16 v231, v231
    v_pk_lshrrev_b16 v248, 3, v248 op_sel_hi:[0,1]
    v_mfma_f32_16x16x32_bf16 v[68:71], a[236:239], v[232:235], v[68:71]
    s_waitcnt lgkmcnt(13)
    ds_read_u16_d16_hi v230, v230
    v_or_b32 v232, v213, v212
    v_or_b32 v233, v215, v214
    v_mfma_f32_16x16x32_bf16 v[76:79], a[236:239], v[236:239], v[76:79]
    s_waitcnt lgkmcnt(12)
    v_or_b32 v234, v217, v216
    v_or_b32 v235, v219, v218
    v_or_b32 v236, v221, v220
    v_mfma_f32_16x16x32_bf16 v[112:115], a[232:235], v[240:243], v[112:115]
    v_mad_u32_u16 v249, v248, 2, s85
    v_mad_u32_u16 v248, v248, 2, s85 op_sel:[1,0,0,0]
    v_pk_lshrrev_b16 v250, 3, v250 op_sel_hi:[0,1]
    v_mfma_f32_16x16x32_bf16 v[120:123], a[232:235], v[244:247], v[120:123]
    s_waitcnt lgkmcnt(10)
    ds_read_b128 a[232:235], v23 offset:34816
    ds_read_u16 v249, v249
    v_or_b32 v237, v223, v222
    v_mfma_f32_16x16x32_bf16 v[116:119], a[236:239], v[240:243], v[116:119]
    v_mad_u32_u16 v251, v250, 2, s85
    v_mad_u32_u16 v250, v250, 2, s85 op_sel:[1,0,0,0]
    v_pk_lshrrev_b16 v252, 3, v252 op_sel_hi:[0,1]
    v_mfma_f32_16x16x32_bf16 v[124:127], a[236:239], v[244:247], v[124:127]
    s_waitcnt lgkmcnt(11)
    ds_read_b128 a[236:239], v23 offset:35840
    v_mad_u32_u16 v253, v252, 2, s85
    s_waitcnt lgkmcnt(11)
    v_or_b32 v238, v225, v224
    v_mfma_f32_16x16x32_f16 v[176:179], a[240:243], v[128:131], 0
    ds_read_u16_d16_hi v248, v248
    v_mad_u32_u16 v252, v252, 2, s85 op_sel:[1,0,0,0]
    v_pk_lshrrev_b16 v0, 3, v0 op_sel_hi:[0,1]
    v_mfma_f32_16x16x32_f16 v[184:187], a[240:243], v[132:135], 0
    ds_read_u16 v251, v251
    v_mad_u32_u16 v208, v0, 2, s85
    v_mad_u32_u16 v0, v0, 2, s85 op_sel:[1,0,0,0]
    v_mfma_f32_16x16x32_f16 v[180:183], a[244:247], v[128:131], 0
    s_waitcnt lgkmcnt(11)
    v_pk_lshrrev_b16 v209, 3, v209 op_sel_hi:[0,1]
    v_or_b32 v239, v227, v226
    v_mad_u32_u16 v210, v209, 2, s85
    v_mfma_f32_16x16x32_f16 v[188:191], a[244:247], v[132:135], 0
    ds_read_u16_d16_hi v250, v250
    ds_read_u16 v253, v253
    v_mad_u32_u16 v209, v209, 2, s85 op_sel:[1,0,0,0]
    v_mfma_f32_16x16x32_f16 v[192:195], a[240:243], v[152:155], 0
    v_pk_lshrrev_b16 v211, 3, v211 op_sel_hi:[0,1]
    v_mad_u32_u16 v212, v211, 2, s85
    v_mad_u32_u16 v211, v211, 2, s85 op_sel:[1,0,0,0]
    v_mfma_f32_16x16x32_f16 v[200:203], a[240:243], v[156:159], 0
    s_waitcnt lgkmcnt(12)
    ds_read_u16_d16_hi v252, v252
    v_mfma_f32_16x16x32_f16 v[176:179], a[248:251], v[136:139], v[176:179]
    s_waitcnt lgkmcnt(11)
    ds_read_u16 v208, v208
    v_or_b32 v240, v229, v228
    v_mfma_f32_16x16x32_f16 v[184:187], a[248:251], v[140:143], v[184:187]
    ds_read_u16_d16_hi v0, v0
    v_mfma_f32_16x16x32_f16 v[196:199], a[244:247], v[152:155], 0
    v_mfma_f32_16x16x32_f16 v[204:207], a[244:247], v[156:159], 0
    s_waitcnt lgkmcnt(12)
    ds_read_u16 v210, v210
    v_mfma_f32_16x16x32_f16 v[180:183], a[252:255], v[136:139], v[180:183]
    s_waitcnt lgkmcnt(11)
    ds_read_u16_d16_hi v209, v209
    v_or_b32 v241, v231, v230
    v_mfma_f32_16x16x32_f16 v[188:191], a[252:255], v[140:143], v[188:191]
    ds_read_u16 v212, v212
    v_mfma_f32_16x16x32_f16 v[192:195], a[248:251], v[160:163], v[192:195]
    v_mfma_f32_16x16x32_f16 v[200:203], a[248:251], v[164:167], v[200:203]
    s_waitcnt lgkmcnt(12)
    ds_read_u16_d16_hi v211, v211
    v_mfma_f32_16x16x32_f16 v[176:179], a[232:235], v[144:147], v[176:179]
    s_add_u32 m0, s56, 11456
    ds_read_b128 a[240:243], v23 offset:26624
    buffer_load_dwordx4 v6, s[20:23], 0 offen offset:64 lds
    v_mfma_f32_16x16x32_f16 v[184:187], a[232:235], v[148:151], v[184:187]
    s_waitcnt lgkmcnt(11)
    ds_read_b128 a[244:247], v23 offset:27648
    v_or_b32 v242, v249, v248
    v_mfma_f32_16x16x32_f16 v[196:199], a[252:255], v[160:163], v[196:199]
    v_cvt_pkrtz_f16_f32 v213, v176, v177
    v_pk_lshrrev_b16 v213, 3, v213 op_sel_hi:[0,1]
    v_mad_u32_u16 v214, v213, 2, s85
    v_mfma_f32_16x16x32_f16 v[204:207], a[252:255], v[164:167], v[204:207]
    ds_read_b128 a[248:251], v23 offset:28672
    v_mad_u32_u16 v213, v213, 2, s85 op_sel:[1,0,0,0]
    v_cvt_pkrtz_f16_f32 v215, v178, v179
    v_mfma_f32_16x16x32_f16 v[180:183], a[236:239], v[144:147], v[180:183]
    s_waitcnt lgkmcnt(11)
    ds_read_b128 a[252:255], v23 offset:29696
    v_or_b32 v243, v251, v250
    v_pk_lshrrev_b16 v215, 3, v215 op_sel_hi:[0,1]
    v_mfma_f32_16x16x32_f16 v[188:191], a[236:239], v[148:151], v[188:191]
    v_mad_u32_u16 v216, v215, 2, s85
    v_mad_u32_u16 v215, v215, 2, s85 op_sel:[1,0,0,0]
    v_cvt_pkrtz_f16_f32 v221, v184, v185
    v_mfma_f32_16x16x32_f16 v[192:195], a[232:235], v[168:171], v[192:195]
    ds_read_u16 v214, v214
    v_cvt_pkrtz_f16_f32 v217, v180, v181
    v_pk_lshrrev_b16 v217, 3, v217 op_sel_hi:[0,1]
    v_mfma_f32_16x16x32_f16 v[200:203], a[232:235], v[172:175], v[200:203]
    s_waitcnt lgkmcnt(11)
    ds_read_b128 a[232:235], v24 offset:0
    v_or_b32 v244, v253, v252
    v_mad_u32_u16 v218, v217, 2, s85
    v_mfma_f32_16x16x32_f16 v[196:199], a[236:239], v[168:171], v[196:199]
    ds_read_u16_d16_hi v213, v213
    v_mad_u32_u16 v217, v217, 2, s85 op_sel:[1,0,0,0]
    v_cvt_pkrtz_f16_f32 v219, v182, v183
    v_mfma_f32_16x16x32_f16 v[204:207], a[236:239], v[172:175], v[204:207]
    s_waitcnt lgkmcnt(11)
    v_pk_lshrrev_b16 v219, 3, v219 op_sel_hi:[0,1]
    v_or_b32 v245, v208, v0
    v_mad_u32_u16 v220, v219, 2, s85
    v_mfma_f32_16x16x32_bf16 v[32:35], a[208:211], v[232:235], v[32:35]
    ds_read_b128 a[236:239], v24 offset:1024
    v_mad_u32_u16 v219, v219, 2, s85 op_sel:[1,0,0,0]
    v_pk_lshrrev_b16 v221, 3, v221 op_sel_hi:[0,1]
    v_mfma_f32_16x16x32_bf16 v[40:43], a[208:211], v[236:239], v[40:43]
    ds_read_u16 v216, v216
    v_mad_u32_u16 v222, v221, 2, s85
    v_mad_u32_u16 v221, v221, 2, s85 op_sel:[1,0,0,0]
    v_mfma_f32_16x16x32_bf16 v[36:39], a[212:215], v[232:235], v[36:39]
    s_waitcnt lgkmcnt(11)
    ds_read_u16_d16_hi v215, v215
    v_or_b32 v246, v210, v209
    v_cvt_pkrtz_f16_f32 v223, v186, v187
    v_mfma_f32_16x16x32_bf16 v[44:47], a[212:215], v[236:239], v[44:47]
    v_pk_lshrrev_b16 v223, 3, v223 op_sel_hi:[0,1]
    v_mad_u32_u16 v224, v223, 2, s85
    v_mad_u32_u16 v223, v223, 2, s85 op_sel:[1,0,0,0]
    v_mfma_f32_16x16x32_bf16 v[80:83], a[208:211], v[240:243], v[80:83]
    s_waitcnt lgkmcnt(11)
    ds_read_u16 v218, v218
    v_cvt_pkrtz_f16_f32 v225, v188, v189
    v_pk_lshrrev_b16 v225, 3, v225 op_sel_hi:[0,1]
    s_waitcnt lgkmcnt(11)
    v_or_b32 v247, v212, v211
    v_mad_u32_u16 v226, v225, 2, s85
    v_mad_u32_u16 v225, v225, 2, s85 op_sel:[1,0,0,0]
    v_mfma_f32_16x16x32_bf16 v[88:91], a[208:211], v[244:247], v[88:91]
    s_waitcnt lgkmcnt(10)
    ds_read_u16_d16_hi v217, v217
    ds_read_u16 v220, v220
    v_cvt_pkrtz_f16_f32 v227, v190, v191
    v_mfma_f32_16x16x32_bf16 v[48:51], a[240:243], v[232:235], v[48:51]
    ds_read_u16_d16_hi v219, v219
    v_pk_lshrrev_b16 v227, 3, v227 op_sel_hi:[0,1]
    v_mad_u32_u16 v228, v227, 2, s85
    v_mfma_f32_16x16x32_bf16 v[56:59], a[240:243], v[236:239], v[56:59]
    s_waitcnt lgkmcnt(12)
    ds_read_u16 v222, v222
    ds_read_u16_d16_hi v221, v221
    v_mad_u32_u16 v227, v227, 2, s85 op_sel:[1,0,0,0]
    v_mfma_f32_16x16x32_bf16 v[84:87], a[212:215], v[240:243], v[84:87]
    v_cvt_pkrtz_f16_f32 v229, v192, v193
    v_pk_lshrrev_b16 v229, 3, v229 op_sel_hi:[0,1]
    v_cvt_pkrtz_f16_f32 v231, v194, v195
    v_mfma_f32_16x16x32_bf16 v[92:95], a[212:215], v[244:247], v[92:95]
    s_waitcnt lgkmcnt(13)
    ds_read_u16 v224, v224
    v_cvt_pkrtz_f16_f32 v249, v196, v197
    v_cvt_pkrtz_f16_f32 v251, v198, v199
    v_mfma_f32_16x16x32_bf16 v[52:55], a[244:247], v[232:235], v[52:55]
    s_waitcnt lgkmcnt(13)
    ds_read_u16_d16_hi v223, v223
    v_cvt_pkrtz_f16_f32 v253, v200, v201
    v_cvt_pkrtz_f16_f32 v208, v202, v203
    v_mfma_f32_16x16x32_bf16 v[60:63], a[244:247], v[236:239], v[60:63]
    s_waitcnt lgkmcnt(13)
    ds_read_u16 v226, v226
    v_cvt_pkrtz_f16_f32 v210, v204, v205
    v_cvt_pkrtz_f16_f32 v212, v206, v207
    v_mfma_f32_16x16x32_bf16 v[96:99], a[240:243], v[240:243], v[96:99]
    s_waitcnt lgkmcnt(13)
    ds_read_u16_d16_hi v225, v225
    v_mad_u32_u16 v230, v229, 2, s85
    v_mad_u32_u16 v229, v229, 2, s85 op_sel:[1,0,0,0]
    v_mfma_f32_16x16x32_bf16 v[104:107], a[240:243], v[244:247], v[104:107]
    s_waitcnt lgkmcnt(13)
    ds_read_u16 v228, v228
    v_pk_lshrrev_b16 v231, 3, v231 op_sel_hi:[0,1]
    v_mad_u32_u16 v248, v231, 2, s85
    v_mfma_f32_16x16x32_bf16 v[64:67], a[248:251], v[232:235], v[64:67]
    v_mad_u32_u16 v231, v231, 2, s85 op_sel:[1,0,0,0]
    v_pk_lshrrev_b16 v249, 3, v249 op_sel_hi:[0,1]
    v_mad_u32_u16 v250, v249, 2, s85
    v_mfma_f32_16x16x32_bf16 v[72:75], a[248:251], v[236:239], v[72:75]
    s_waitcnt lgkmcnt(13)
    ds_read_u16_d16_hi v227, v227
    v_mad_u32_u16 v249, v249, 2, s85 op_sel:[1,0,0,0]
    v_pk_lshrrev_b16 v251, 3, v251 op_sel_hi:[0,1]
    v_mfma_f32_16x16x32_bf16 v[100:103], a[244:247], v[240:243], v[100:103]
    s_waitcnt lgkmcnt(13)
    ds_read_b128 a[240:243], v24 offset:2048
    v_mad_u32_u16 v252, v251, 2, s85
    v_mad_u32_u16 v251, v251, 2, s85 op_sel:[1,0,0,0]
    v_mfma_f32_16x16x32_bf16 v[108:111], a[244:247], v[244:247], v[108:111]
    s_waitcnt lgkmcnt(13)
    ds_read_b128 a[244:247], v24 offset:3072
    v_pk_lshrrev_b16 v253, 3, v253 op_sel_hi:[0,1]
    v_mad_u32_u16 v0, v253, 2, s85
    v_mfma_f32_16x16x32_bf16 v[68:71], a[252:255], v[232:235], v[68:71]
    s_waitcnt lgkmcnt(12)
    v_or_b32 v232, v214, v213
    v_or_b32 v233, v216, v215
    v_or_b32 v234, v218, v217
    v_mfma_f32_16x16x32_bf16 v[76:79], a[252:255], v[236:239], v[76:79]
    ds_read_u16 v230, v230
    v_mad_u32_u16 v253, v253, 2, s85 op_sel:[1,0,0,0]
    v_pk_lshrrev_b16 v208, 3, v208 op_sel_hi:[0,1]
    v_mfma_f32_16x16x32_bf16 v[112:115], a[248:251], v[240:243], v[112:115]
    s_waitcnt lgkmcnt(11)
    ds_read_u16_d16_hi v229, v229
    v_or_b32 v235, v220, v219
    v_mad_u32_u16 v209, v208, 2, s85
    v_mfma_f32_16x16x32_bf16 v[120:123], a[248:251], v[244:247], v[120:123]
    ds_read_b128 a[248:251], v24 offset:4096
    v_mad_u32_u16 v208, v208, 2, s85 op_sel:[1,0,0,0]
    v_pk_lshrrev_b16 v210, 3, v210 op_sel_hi:[0,1]
    v_mfma_f32_16x16x32_bf16 v[116:119], a[252:255], v[240:243], v[116:119]
    s_waitcnt lgkmcnt(12)
    v_mad_u32_u16 v211, v210, 2, s85
    v_mad_u32_u16 v210, v210, 2, s85 op_sel:[1,0,0,0]
    s_waitcnt lgkmcnt(11)
    v_or_b32 v236, v222, v221
    v_mfma_f32_16x16x32_bf16 v[124:127], a[252:255], v[244:247], v[124:127]
    ds_read_b128 a[252:255], v24 offset:5120
    v_pk_lshrrev_b16 v212, 3, v212 op_sel_hi:[0,1]
    v_mad_u32_u16 v213, v212, 2, s85
    v_mfma_f32_16x16x32_f16 v[176:179], a[232:235], v[128:131], 0
    ds_read_u16 v248, v248
    v_mad_u32_u16 v212, v212, 2, s85 op_sel:[1,0,0,0]
    v_mfma_f32_16x16x32_f16 v[184:187], a[232:235], v[132:135], 0
    s_waitcnt lgkmcnt(11)
    v_or_b32 v237, v224, v223
    v_mfma_f32_16x16x32_f16 v[180:183], a[236:239], v[128:131], 0
    ds_read_u16_d16_hi v231, v231
    v_mfma_f32_16x16x32_f16 v[188:191], a[236:239], v[132:135], 0
    ds_read_u16 v250, v250
    v_mfma_f32_16x16x32_f16 v[192:195], a[232:235], v[152:155], 0
    v_mfma_f32_16x16x32_f16 v[200:203], a[232:235], v[156:159], 0
    s_waitcnt lgkmcnt(11)
    ds_read_u16_d16_hi v249, v249
    v_or_b32 v238, v226, v225
    ds_read_u16 v252, v252
    s_waitcnt lgkmcnt(11)
    v_or_b32 v239, v228, v227
    s_waitcnt lgkmcnt(10)
    v_mfma_f32_16x16x32_f16 v[176:179], a[240:243], v[136:139], v[176:179]
    ds_read_u16_d16_hi v251, v251
    ds_read_u16 v0, v0
    ds_read_u16_d16_hi v253, v253
    v_mfma_f32_16x16x32_f16 v[184:187], a[240:243], v[140:143], v[184:187]
    v_mfma_f32_16x16x32_f16 v[196:199], a[236:239], v[152:155], 0
    s_waitcnt lgkmcnt(12)
    ds_read_u16 v209, v209
    v_mfma_f32_16x16x32_f16 v[204:207], a[236:239], v[156:159], 0
    s_add_u32 m0, s56, 12480
    v_mfma_f32_16x16x32_f16 v[180:183], a[244:247], v[136:139], v[180:183]
    s_waitcnt lgkmcnt(12)
    ds_read_u16_d16_hi v208, v208
    buffer_load_dword v7, s[20:23], 0 offen offset:64 lds
    ds_read_u16 v211, v211
    v_mfma_f32_16x16x32_f16 v[188:191], a[244:247], v[140:143], v[188:191]
    s_waitcnt lgkmcnt(13)
    ds_read_u16_d16_hi v210, v210
    v_or_b32 v240, v230, v229
    v_mfma_f32_16x16x32_f16 v[192:195], a[240:243], v[160:163], v[192:195]
    s_add_u32 m0, s56, 0
    v_mfma_f32_16x16x32_f16 v[200:203], a[240:243], v[164:167], v[200:203]
    s_waitcnt lgkmcnt(13)
    ds_read_u16 v213, v213
    buffer_load_dwordx4 v1, s[20:23], 0 offen offset:0 lds
    v_mfma_f32_16x16x32_f16 v[176:179], a[248:251], v[144:147], v[176:179]
    s_waitcnt lgkmcnt(11)
    ds_read_u16_d16_hi v212, v212
    v_or_b32 v241, v248, v231
    v_mfma_f32_16x16x32_f16 v[184:187], a[248:251], v[148:151], v[184:187]
    v_mfma_f32_16x16x32_f16 v[196:199], a[244:247], v[160:163], v[196:199]
    ds_read_b128 a[232:235], v23 offset:36864
    v_mfma_f32_16x16x32_f16 v[204:207], a[244:247], v[164:167], v[204:207]
    s_waitcnt lgkmcnt(11)
    ds_read_b128 a[236:239], v23 offset:37888
    v_or_b32 v242, v250, v249
    v_mfma_f32_16x16x32_f16 v[180:183], a[252:255], v[144:147], v[180:183]
    v_cvt_pkrtz_f16_f32 v214, v176, v177
    v_pk_lshrrev_b16 v214, 3, v214 op_sel_hi:[0,1]
    v_mad_u32_u16 v215, v214, 2, s85
    v_mfma_f32_16x16x32_f16 v[188:191], a[252:255], v[148:151], v[188:191]
    ds_read_b128 a[240:243], v23 offset:38912
    v_mad_u32_u16 v214, v214, 2, s85 op_sel:[1,0,0,0]
    v_cvt_pkrtz_f16_f32 v216, v178, v179
    v_mfma_f32_16x16x32_f16 v[192:195], a[248:251], v[168:171], v[192:195]
    s_waitcnt lgkmcnt(11)
    ds_read_b128 a[244:247], v23 offset:39936
    v_or_b32 v243, v252, v251
    v_pk_lshrrev_b16 v216, 3, v216 op_sel_hi:[0,1]
    v_mfma_f32_16x16x32_f16 v[200:203], a[248:251], v[172:175], v[200:203]
    v_mad_u32_u16 v217, v216, 2, s85
    v_mad_u32_u16 v216, v216, 2, s85 op_sel:[1,0,0,0]
    v_cvt_pkrtz_f16_f32 v218, v180, v181
    v_mfma_f32_16x16x32_f16 v[196:199], a[252:255], v[168:171], v[196:199]
    ds_read_b128 a[248:251], v24 offset:12288
    v_pk_lshrrev_b16 v218, 3, v218 op_sel_hi:[0,1]
    v_mad_u32_u16 v219, v218, 2, s85
    v_mfma_f32_16x16x32_f16 v[204:207], a[252:255], v[172:175], v[204:207]
    s_waitcnt lgkmcnt(11)
    ds_read_b128 a[252:255], v24 offset:13312
    v_or_b32 v244, v0, v253
    v_mad_u32_u16 v218, v218, 2, s85 op_sel:[1,0,0,0]
    v_mfma_f32_16x16x32_bf16 v[32:35], a[216:219], v[232:235], v[32:35]
    ds_read_u16 v215, v215
    v_cvt_pkrtz_f16_f32 v220, v182, v183
    v_pk_lshrrev_b16 v220, 3, v220 op_sel_hi:[0,1]
    v_mfma_f32_16x16x32_bf16 v[40:43], a[216:219], v[236:239], v[40:43]
    s_waitcnt lgkmcnt(12)
    v_mad_u32_u16 v221, v220, 2, s85
    v_mad_u32_u16 v220, v220, 2, s85 op_sel:[1,0,0,0]
    s_waitcnt lgkmcnt(11)
    v_or_b32 v245, v209, v208
    v_mfma_f32_16x16x32_bf16 v[36:39], a[220:223], v[232:235], v[36:39]
    ds_read_u16_d16_hi v214, v214
    v_cvt_pkrtz_f16_f32 v222, v184, v185
    v_pk_lshrrev_b16 v222, 3, v222 op_sel_hi:[0,1]
    v_mfma_f32_16x16x32_bf16 v[44:47], a[220:223], v[236:239], v[44:47]
    ds_read_u16 v217, v217
    v_mad_u32_u16 v223, v222, 2, s85
    v_mad_u32_u16 v222, v222, 2, s85 op_sel:[1,0,0,0]
    v_mfma_f32_16x16x32_bf16 v[80:83], a[216:219], v[240:243], v[80:83]
    s_waitcnt lgkmcnt(11)
    ds_read_u16_d16_hi v216, v216
    v_or_b32 v246, v211, v210
    v_cvt_pkrtz_f16_f32 v224, v186, v187
    v_pk_lshrrev_b16 v224, 3, v224 op_sel_hi:[0,1]
    v_mad_u32_u16 v225, v224, 2, s85
    v_mad_u32_u16 v224, v224, 2, s85 op_sel:[1,0,0,0]
    v_cvt_pkrtz_f16_f32 v228, v188, v189
    v_cvt_pkrtz_f16_f32 v231, v190, v191
    v_pk_fma_f16 v226, v228, v228, s53
    v_pk_fma_f16 v229, v231, v231, s53
    v_pk_mul_f16 v226, v226, v228 neg_lo:[1,0] neg_hi:[1,0]
    v_pk_mul_f16 v229, v229, v231 neg_lo:[1,0] neg_hi:[1,0]
    v_exp_f16 v227, v226
    s_waitcnt lgkmcnt(10)
    v_or_b32 v247, v213, v212
    v_exp_f16 v230, v229
    v_exp_f16_sdwa v227, v226 dst_sel:WORD_1 dst_unused:UNUSED_PRESERVE src0_sel:WORD_1
    v_mfma_f32_16x16x32_bf16 v[88:91], a[216:219], v[244:247], v[88:91]
    s_waitcnt lgkmcnt(9)
    ds_read_u16 v219, v219
    ds_read_u16_d16_hi v218, v218
    ds_read_u16 v221, v221
    ds_read_u16_d16_hi v220, v220
    v_mfma_f32_16x16x32_bf16 v[48:51], a[232:235], v[232:235], v[48:51]
    ds_read_u16 v223, v223
    v_exp_f16_sdwa v230, v229 dst_sel:WORD_1 dst_unused:UNUSED_PRESERVE src0_sel:WORD_1
    v_mfma_f32_16x16x32_bf16 v[56:59], a[232:235], v[236:239], v[56:59]
    s_waitcnt lgkmcnt(13)
    ds_read_u16_d16_hi v222, v222
    v_pk_fma_f16 v227, v227, s86, s86
    v_pk_fma_f16 v230, v230, s86, s86
    v_mfma_f32_16x16x32_bf16 v[84:87], a[220:223], v[240:243], v[84:87]
    s_waitcnt lgkmcnt(12)
    ds_read_u16 v225, v225
    ds_read_u16_d16_hi v224, v224
    v_rcp_f16 v226, v227
    v_mfma_f32_16x16x32_bf16 v[92:95], a[220:223], v[244:247], v[92:95]
    v_rcp_f16 v229, v230
    v_rcp_f16_sdwa v226, v227 dst_sel:WORD_1 dst_unused:UNUSED_PRESERVE src0_sel:WORD_1
    v_mfma_f32_16x16x32_bf16 v[52:55], a[236:239], v[232:235], v[52:55]
    v_rcp_f16_sdwa v229, v230 dst_sel:WORD_1 dst_unused:UNUSED_PRESERVE src0_sel:WORD_1
    v_fma_mix_f32 v227, v226, v228, 0 op_sel_hi:[1,1,0]
    v_mfma_f32_16x16x32_bf16 v[60:63], a[236:239], v[236:239], v[60:63]
    v_fma_mix_f32 v230, v229, v231, 0 op_sel_hi:[1,1,0]
    v_fma_mix_f32 v226, v226, v228, 0 op_sel:[1,1,0] op_sel_hi:[1,1,0]
    v_fma_mix_f32 v229, v229, v231, 0 op_sel:[1,1,0] op_sel_hi:[1,1,0]
    v_mfma_f32_16x16x32_bf16 v[96:99], a[232:235], v[240:243], v[96:99]
    v_cvt_pkrtz_f16_f32 v248, v192, v193
    v_pk_lshrrev_b16 v248, 3, v248 op_sel_hi:[0,1]
    v_cvt_pkrtz_f16_f32 v250, v194, v195
    v_mfma_f32_16x16x32_bf16 v[104:107], a[232:235], v[244:247], v[104:107]
    s_waitcnt lgkmcnt(13)
    ds_read_b128 a[232:235], v24 offset:14336
    v_cvt_pkrtz_f16_f32 v252, v196, v197
    v_cvt_pkrtz_f16_f32 v0, v198, v199
    v_mfma_f32_16x16x32_bf16 v[64:67], a[240:243], v[232:235], v[64:67]
    v_cvt_pkrtz_f16_f32 v209, v200, v201
    v_cvt_pkrtz_f16_f32 v211, v202, v203
    v_mad_u32_u16 v249, v248, 2, s85
    v_mfma_f32_16x16x32_bf16 v[72:75], a[240:243], v[236:239], v[72:75]
    s_waitcnt lgkmcnt(13)
    ds_read_u16 v249, v249
    v_mad_u32_u16 v248, v248, 2, s85 op_sel:[1,0,0,0]
    v_pk_lshrrev_b16 v250, 3, v250 op_sel_hi:[0,1]
    v_mfma_f32_16x16x32_bf16 v[100:103], a[236:239], v[240:243], v[100:103]
    s_waitcnt lgkmcnt(13)
    ds_read_u16_d16_hi v248, v248
    v_mad_u32_u16 v251, v250, 2, s85
    v_mad_u32_u16 v250, v250, 2, s85 op_sel:[1,0,0,0]
    v_mfma_f32_16x16x32_bf16 v[108:111], a[236:239], v[244:247], v[108:111]
    s_waitcnt lgkmcnt(11)
    ds_read_b128 a[236:239], v24 offset:15360
    ds_read_u16 v251, v251
    ds_read_u16_d16_hi v250, v250
    v_mfma_f32_16x16x32_bf16 v[68:71], a[244:247], v[232:235], v[68:71]
    s_waitcnt lgkmcnt(12)
    v_or_b32 v232, v215, v214
    v_or_b32 v233, v217, v216
    v_or_b32 v234, v219, v218
    v_mfma_f32_16x16x32_bf16 v[76:79], a[244:247], v[236:239], v[76:79]
    s_waitcnt lgkmcnt(10)
    v_or_b32 v235, v221, v220
    v_cvt_pk_bf16_f32 v238, v227, v226
    v_cvt_pk_bf16_f32 v239, v230, v229
    v_mfma_f32_16x16x32_bf16 v[112:115], a[240:243], v[240:243], v[112:115]
    v_cvt_pkrtz_f16_f32 v215, v204, v205
    v_cvt_pkrtz_f16_f32 v218, v206, v207
    v_pk_lshrrev_b16 v252, 3, v252 op_sel_hi:[0,1]
    v_mfma_f32_16x16x32_bf16 v[120:123], a[240:243], v[244:247], v[120:123]
    s_waitcnt lgkmcnt(8)
    ds_read_b128 a[240:243], v24 offset:16384
    v_or_b32 v236, v223, v222
    v_mad_u32_u16 v253, v252, 2, s85
    v_mfma_f32_16x16x32_bf16 v[116:119], a[244:247], v[240:243], v[116:119]
    ds_read_u16 v253, v253
    v_mad_u32_u16 v252, v252, 2, s85 op_sel:[1,0,0,0]
    v_pk_lshrrev_b16 v0, 3, v0 op_sel_hi:[0,1]
    v_mfma_f32_16x16x32_bf16 v[124:127], a[244:247], v[244:247], v[124:127]
    s_add_u32 m0, s56, 1024
    ds_read_b128 a[244:247], v24 offset:17408
    buffer_load_dwordx4 v2, s[20:23], 0 offen offset:0 lds
    ds_read_u16_d16_hi v252, v252
    v_mfma_f32_16x16x32_f16 v[176:179], a[248:251], v[128:131], 0
    s_waitcnt lgkmcnt(10)
    v_or_b32 v237, v225, v224
    v_mad_u32_u16 v208, v0, 2, s85
    v_mad_u32_u16 v0, v0, 2, s85 op_sel:[1,0,0,0]
    v_mfma_f32_16x16x32_f16 v[184:187], a[248:251], v[132:135], 0
    ds_read_u16 v208, v208
    ds_read_u16_d16_hi v0, v0
    v_pk_lshrrev_b16 v209, 3, v209 op_sel_hi:[0,1]
    v_mfma_f32_16x16x32_f16 v[180:183], a[252:255], v[128:131], 0
    v_mad_u32_u16 v210, v209, 2, s85
    v_mad_u32_u16 v209, v209, 2, s85 op_sel:[1,0,0,0]
    v_pk_lshrrev_b16 v211, 3, v211 op_sel_hi:[0,1]
    v_mfma_f32_16x16x32_f16 v[188:191], a[252:255], v[132:135], 0
    ds_read_u16 v210, v210
    ds_read_u16_d16_hi v209, v209
    v_mad_u32_u16 v212, v211, 2, s85
    v_mfma_f32_16x16x32_f16 v[192:195], a[248:251], v[152:155], 0
    s_waitcnt lgkmcnt(13)
    ds_read_u16 v212, v212
    v_mad_u32_u16 v211, v211, 2, s85 op_sel:[1,0,0,0]
    v_pk_fma_f16 v213, v215, v215, s53
    v_mfma_f32_16x16x32_f16 v[200:203], a[248:251], v[156:159], 0
    s_waitcnt lgkmcnt(12)
    ds_read_u16_d16_hi v211, v211
    ds_read_b128 a[248:251], v24 offset:6144
    v_pk_fma_f16 v216, v218, v218, s53
    v_mfma_f32_16x16x32_f16 v[176:179], a[232:235], v[136:139], v[176:179]
    v_pk_mul_f16 v213, v213, v215 neg_lo:[1,0] neg_hi:[1,0]
    v_pk_mul_f16 v216, v216, v218 neg_lo:[1,0] neg_hi:[1,0]
    v_exp_f16 v214, v213
    v_mfma_f32_16x16x32_f16 v[184:187], a[232:235], v[140:143], v[184:187]
    v_exp_f16 v217, v216
    v_exp_f16_sdwa v214, v213 dst_sel:WORD_1 dst_unused:UNUSED_PRESERVE src0_sel:WORD_1
    v_mfma_f32_16x16x32_f16 v[196:199], a[252:255], v[152:155], 0
    v_exp_f16_sdwa v217, v216 dst_sel:WORD_1 dst_unused:UNUSED_PRESERVE src0_sel:WORD_1
    v_pk_fma_f16 v214, v214, s86, s86
    v_mfma_f32_16x16x32_f16 v[204:207], a[252:255], v[156:159], 0
    s_waitcnt lgkmcnt(13)
    ds_read_b128 a[252:255], v24 offset:7168
    v_pk_fma_f16 v217, v217, s86, s86
    v_rcp_f16 v213, v214
    v_mfma_f32_16x16x32_f16 v[180:183], a[236:239], v[136:139], v[180:183]
    v_rcp_f16 v216, v217
    v_rcp_f16_sdwa v213, v214 dst_sel:WORD_1 dst_unused:UNUSED_PRESERVE src0_sel:WORD_1
    v_mfma_f32_16x16x32_f16 v[188:191], a[236:239], v[140:143], v[188:191]
    s_add_u32 m0, s56, 2048
    v_rcp_f16_sdwa v216, v217 dst_sel:WORD_1 dst_unused:UNUSED_PRESERVE src0_sel:WORD_1
    v_fma_mix_f32 v214, v213, v215, 0 op_sel_hi:[1,1,0]
    v_mfma_f32_16x16x32_f16 v[192:195], a[232:235], v[160:163], v[192:195]
    buffer_load_dwordx4 v3, s[20:23], 0 offen offset:0 lds
    v_mfma_f32_16x16x32_f16 v[200:203], a[232:235], v[164:167], v[200:203]
    s_waitcnt lgkmcnt(11)
    ds_read_b128 a[232:235], v24 offset:8192
    v_fma_mix_f32 v217, v216, v218, 0 op_sel_hi:[1,1,0]
    v_fma_mix_f32 v213, v213, v215, 0 op_sel:[1,1,0] op_sel_hi:[1,1,0]
    v_mfma_f32_16x16x32_f16 v[176:179], a[240:243], v[144:147], v[176:179]
    v_fma_mix_f32 v216, v216, v218, 0 op_sel:[1,1,0] op_sel_hi:[1,1,0]
    v_or_b32 v240, v249, v248
    v_or_b32 v241, v251, v250
    v_mfma_f32_16x16x32_f16 v[184:187], a[240:243], v[148:151], v[184:187]
    s_waitcnt lgkmcnt(6)
    v_or_b32 v242, v253, v252
    v_or_b32 v243, v208, v0
    s_waitcnt lgkmcnt(5)
    v_or_b32 v244, v210, v209
    v_mfma_f32_16x16x32_f16 v[196:199], a[236:239], v[160:163], v[196:199]
    v_cvt_pk_bf16_f32 v246, v214, v213
    v_cvt_pk_bf16_f32 v247, v217, v216
    v_cvt_pkrtz_f16_f32 v219, v176, v177
    v_mfma_f32_16x16x32_f16 v[204:207], a[236:239], v[164:167], v[204:207]
    ds_read_b128 a[236:239], v24 offset:9216
    v_pk_lshrrev_b16 v219, 3, v219 op_sel_hi:[0,1]
    v_mad_u32_u16 v220, v219, 2, s85
    v_mfma_f32_16x16x32_f16 v[180:183], a[244:247], v[144:147], v[180:183]
    s_waitcnt lgkmcnt(4)
    ds_read_u16 v220, v220
    v_or_b32 v245, v212, v211
    v_mad_u32_u16 v219, v219, 2, s85 op_sel:[1,0,0,0]
    v_mfma_f32_16x16x32_f16 v[188:191], a[244:247], v[148:151], v[188:191]
    ds_read_u16_d16_hi v219, v219
    v_cvt_pkrtz_f16_f32 v221, v178, v179
    v_pk_lshrrev_b16 v221, 3, v221 op_sel_hi:[0,1]
    v_mfma_f32_16x16x32_f16 v[192:195], a[240:243], v[168:171], v[192:195]
    v_mad_u32_u16 v222, v221, 2, s85
    v_mad_u32_u16 v221, v221, 2, s85 op_sel:[1,0,0,0]
    v_cvt_pkrtz_f16_f32 v223, v180, v181
    v_mfma_f32_16x16x32_f16 v[200:203], a[240:243], v[172:175], v[200:203]
    ds_read_b128 a[240:243], v24 offset:10240
    ds_read_u16 v222, v222
    ds_read_u16_d16_hi v221, v221
    v_mfma_f32_16x16x32_f16 v[196:199], a[244:247], v[168:171], v[196:199]
    v_pk_lshrrev_b16 v223, 3, v223 op_sel_hi:[0,1]
    v_mad_u32_u16 v224, v223, 2, s85
    v_mad_u32_u16 v223, v223, 2, s85 op_sel:[1,0,0,0]
    v_mfma_f32_16x16x32_f16 v[204:207], a[244:247], v[172:175], v[204:207]
    s_waitcnt lgkmcnt(8)
    ds_read_b128 a[244:247], v24 offset:11264
    ds_read_u16 v224, v224
    ds_read_u16_d16_hi v223, v223
    v_mfma_f32_16x16x32_bf16 v[32:35], a[248:251], v[232:235], v[32:35]
    v_cvt_pkrtz_f16_f32 v225, v182, v183
    v_pk_lshrrev_b16 v225, 3, v225 op_sel_hi:[0,1]
    v_mad_u32_u16 v226, v225, 2, s85
    v_mfma_f32_16x16x32_bf16 v[40:43], a[248:251], v[236:239], v[40:43]
    s_waitcnt lgkmcnt(10)
    ds_read_u16 v226, v226
    v_mad_u32_u16 v225, v225, 2, s85 op_sel:[1,0,0,0]
    v_cvt_pkrtz_f16_f32 v227, v184, v185
    v_mfma_f32_16x16x32_bf16 v[36:39], a[252:255], v[232:235], v[36:39]
    ds_read_u16_d16_hi v225, v225
    v_pk_lshrrev_b16 v227, 3, v227 op_sel_hi:[0,1]
    v_mad_u32_u16 v228, v227, 2, s85
    v_mfma_f32_16x16x32_bf16 v[44:47], a[252:255], v[236:239], v[44:47]
    ds_read_u16 v228, v228
    v_mad_u32_u16 v227, v227, 2, s85 op_sel:[1,0,0,0]
    v_cvt_pkrtz_f16_f32 v229, v186, v187
    v_mfma_f32_16x16x32_bf16 v[80:83], a[248:251], v[240:243], v[80:83]
    ds_read_u16_d16_hi v227, v227
    v_pk_lshrrev_b16 v229, 3, v229 op_sel_hi:[0,1]
    v_mad_u32_u16 v230, v229, 2, s85
    v_mfma_f32_16x16x32_bf16 v[88:91], a[248:251], v[244:247], v[88:91]
    s_waitcnt lgkmcnt(12)
    ds_read_u16 v230, v230
    ds_read_b128 a[248:251], v24 offset:24576
    v_mad_u32_u16 v229, v229, 2, s85 op_sel:[1,0,0,0]
    v_mfma_f32_16x16x32_bf16 v[48:51], a[232:235], v[232:235], v[48:51]
    s_waitcnt lgkmcnt(13)
    ds_read_u16_d16_hi v229, v229
    v_cvt_pkrtz_f16_f32 v231, v188, v189
    v_pk_lshrrev_b16 v231, 3, v231 op_sel_hi:[0,1]
    v_mfma_f32_16x16x32_bf16 v[56:59], a[232:235], v[236:239], v[56:59]
    v_mad_u32_u16 v248, v231, 2, s85
    v_mad_u32_u16 v231, v231, 2, s85 op_sel:[1,0,0,0]
    v_cvt_pkrtz_f16_f32 v249, v190, v191
    v_mfma_f32_16x16x32_bf16 v[84:87], a[252:255], v[240:243], v[84:87]
    s_waitcnt lgkmcnt(12)
    ds_read_u16 v248, v248
    ds_read_u16_d16_hi v231, v231
    v_pk_lshrrev_b16 v249, 3, v249 op_sel_hi:[0,1]
    v_mfma_f32_16x16x32_bf16 v[92:95], a[252:255], v[244:247], v[92:95]
    s_waitcnt lgkmcnt(13)
    ds_read_b128 a[252:255], v24 offset:25600
    v_mad_u32_u16 v250, v249, 2, s85
    v_mad_u32_u16 v249, v249, 2, s85 op_sel:[1,0,0,0]
    v_mfma_f32_16x16x32_bf16 v[52:55], a[236:239], v[232:235], v[52:55]
    s_waitcnt lgkmcnt(12)
    ds_read_u16 v250, v250
    ds_read_u16_d16_hi v249, v249
    v_cvt_pkrtz_f16_f32 v251, v192, v193
    v_mfma_f32_16x16x32_bf16 v[60:63], a[236:239], v[236:239], v[60:63]
    v_pk_lshrrev_b16 v251, 3, v251 op_sel_hi:[0,1]
    v_cvt_pkrtz_f16_f32 v253, v194, v195
    v_cvt_pkrtz_f16_f32 v208, v196, v197
    v_mfma_f32_16x16x32_bf16 v[96:99], a[232:235], v[240:243], v[96:99]
    v_cvt_pkrtz_f16_f32 v210, v198, v199
    v_cvt_pkrtz_f16_f32 v212, v200, v201
    v_cvt_pkrtz_f16_f32 v214, v202, v203
    v_mfma_f32_16x16x32_bf16 v[104:107], a[232:235], v[244:247], v[104:107]
    s_waitcnt lgkmcnt(13)
    ds_read_b128 a[232:235], v24 offset:26624
    v_cvt_pkrtz_f16_f32 v216, v204, v205
    v_cvt_pkrtz_f16_f32 v218, v206, v207
    v_mfma_f32_16x16x32_bf16 v[64:67], a[240:243], v[232:235], v[64:67]
    v_mad_u32_u16 v252, v251, 2, s85
    v_mad_u32_u16 v251, v251, 2, s85 op_sel:[1,0,0,0]
    v_pk_lshrrev_b16 v253, 3, v253 op_sel_hi:[0,1]
    v_mfma_f32_16x16x32_bf16 v[72:75], a[240:243], v[236:239], v[72:75]
    s_waitcnt lgkmcnt(12)
    ds_read_u16 v252, v252
    ds_read_u16_d16_hi v251, v251
    v_mad_u32_u16 v0, v253, 2, s85
    v_mfma_f32_16x16x32_bf16 v[100:103], a[236:239], v[240:243], v[100:103]
    s_waitcnt lgkmcnt(13)
    ds_read_u16 v0, v0
    v_mad_u32_u16 v253, v253, 2, s85 op_sel:[1,0,0,0]
    v_pk_lshrrev_b16 v208, 3, v208 op_sel_hi:[0,1]
    v_mfma_f32_16x16x32_bf16 v[108:111], a[236:239], v[244:247], v[108:111]
    s_waitcnt lgkmcnt(12)
    ds_read_b128 a[236:239], v24 offset:27648
    ds_read_u16_d16_hi v253, v253
    v_mad_u32_u16 v209, v208, 2, s85
    v_mfma_f32_16x16x32_bf16 v[68:71], a[244:247], v[232:235], v[68:71]
    s_waitcnt lgkmcnt(13)
    ds_read_u16 v209, v209
    v_or_b32 v232, v220, v219
    v_or_b32 v233, v222, v221
    v_mfma_f32_16x16x32_bf16 v[76:79], a[244:247], v[236:239], v[76:79]
    v_or_b32 v234, v224, v223
    v_or_b32 v235, v226, v225
    v_or_b32 v236, v228, v227
    v_mfma_f32_16x16x32_bf16 v[112:115], a[240:243], v[240:243], v[112:115]
    s_waitcnt lgkmcnt(10)
    v_or_b32 v237, v230, v229
    v_or_b32 v238, v248, v231
    v_mad_u32_u16 v208, v208, 2, s85 op_sel:[1,0,0,0]
    v_mfma_f32_16x16x32_bf16 v[120:123], a[240:243], v[244:247], v[120:123]
    ds_read_b128 a[240:243], v24 offset:28672
    ds_read_u16_d16_hi v208, v208
    v_pk_lshrrev_b16 v210, 3, v210 op_sel_hi:[0,1]
    v_mfma_f32_16x16x32_bf16 v[116:119], a[244:247], v[240:243], v[116:119]
    s_waitcnt lgkmcnt(9)
    v_mad_u32_u16 v211, v210, 2, s85
    v_or_b32 v239, v250, v249
    v_mad_u32_u16 v210, v210, 2, s85 op_sel:[1,0,0,0]
    v_mfma_f32_16x16x32_bf16 v[124:127], a[244:247], v[244:247], v[124:127]
    ds_read_b128 a[244:247], v24 offset:29696
    ds_read_u16 v211, v211
    ds_read_u16_d16_hi v210, v210
    v_mfma_f32_16x16x32_f16 v[176:179], a[248:251], v[128:131], 0
    v_pk_lshrrev_b16 v212, 3, v212 op_sel_hi:[0,1]
    v_mad_u32_u16 v213, v212, 2, s85
    v_mad_u32_u16 v212, v212, 2, s85 op_sel:[1,0,0,0]
    v_mfma_f32_16x16x32_f16 v[184:187], a[248:251], v[132:135], 0
    ds_read_u16 v213, v213
    ds_read_u16_d16_hi v212, v212
    v_pk_lshrrev_b16 v214, 3, v214 op_sel_hi:[0,1]
    v_mfma_f32_16x16x32_f16 v[180:183], a[252:255], v[128:131], 0
    s_waitcnt lgkmcnt(12)
    v_mad_u32_u16 v215, v214, 2, s85
    v_mad_u32_u16 v214, v214, 2, s85 op_sel:[1,0,0,0]
    v_pk_lshrrev_b16 v216, 3, v216 op_sel_hi:[0,1]
    v_mfma_f32_16x16x32_f16 v[188:191], a[252:255], v[132:135], 0
    s_add_u32 m0, s56, 3072
    ds_read_u16 v215, v215
    ds_read_u16_d16_hi v214, v214
    buffer_load_dwordx4 v4, s[20:23], 0 offen offset:0 lds
    v_mfma_f32_16x16x32_f16 v[192:195], a[248:251], v[152:155], 0
    v_mad_u32_u16 v217, v216, 2, s85
    v_mad_u32_u16 v216, v216, 2, s85 op_sel:[1,0,0,0]
    v_pk_lshrrev_b16 v218, 3, v218 op_sel_hi:[0,1]
    v_mfma_f32_16x16x32_f16 v[200:203], a[248:251], v[156:159], 0
    s_waitcnt lgkmcnt(12)
    ds_read_u16 v217, v217
    ds_read_u16_d16_hi v216, v216
    v_mad_u32_u16 v219, v218, 2, s85
    v_mfma_f32_16x16x32_f16 v[176:179], a[232:235], v[136:139], v[176:179]
    s_waitcnt lgkmcnt(12)
    v_mad_u32_u16 v218, v218, 2, s85 op_sel:[1,0,0,0]
    v_or_b32 v240, v252, v251
    v_or_b32 v241, v0, v253
    v_mfma_f32_16x16x32_f16 v[184:187], a[232:235], v[140:143], v[184:187]
    ds_read_u16 v219, v219
    ds_read_u16_d16_hi v218, v218
    v_mfma_f32_16x16x32_f16 v[196:199], a[252:255], v[152:155], 0
    v_mfma_f32_16x16x32_f16 v[204:207], a[252:255], v[156:159], 0
    s_waitcnt lgkmcnt(11)
    ds_read_b128 a[248:251], v24 offset:18432
    v_or_b32 v242, v209, v208
    v_mfma_f32_16x16x32_f16 v[180:183], a[236:239], v[136:139], v[180:183]
    ds_read_b128 a[252:255], v24 offset:19456
    v_mfma_f32_16x16x32_f16 v[188:191], a[236:239], v[140:143], v[188:191]
    v_mfma_f32_16x16x32_f16 v[192:195], a[232:235], v[160:163], v[192:195]
    v_mfma_f32_16x16x32_f16 v[200:203], a[232:235], v[164:167], v[200:203]
    s_waitcnt lgkmcnt(10)
    ds_read_b128 a[232:235], v24 offset:20480
    v_or_b32 v243, v211, v210
    v_mfma_f32_16x16x32_f16 v[176:179], a[240:243], v[144:147], v[176:179]
    v_mfma_f32_16x16x32_f16 v[184:187], a[240:243], v[148:151], v[184:187]
    s_add_u32 m0, s56, 4096
    v_mfma_f32_16x16x32_f16 v[196:199], a[236:239], v[160:163], v[196:199]
    buffer_load_dwordx4 v5, s[20:23], 0 offen offset:0 lds
    v_mfma_f32_16x16x32_f16 v[204:207], a[236:239], v[164:167], v[204:207]
    s_waitcnt lgkmcnt(9)
    ds_read_b128 a[236:239], v24 offset:21504
    v_or_b32 v244, v213, v212
    v_mfma_f32_16x16x32_f16 v[180:183], a[244:247], v[144:147], v[180:183]
    v_cvt_pkrtz_f16_f32 v220, v176, v177
    v_pk_lshrrev_b16 v220, 3, v220 op_sel_hi:[0,1]
    v_mad_u32_u16 v221, v220, 2, s85
    v_mfma_f32_16x16x32_f16 v[188:191], a[244:247], v[148:151], v[188:191]
    s_waitcnt lgkmcnt(8)
    ds_read_u16 v221, v221
    v_or_b32 v245, v215, v214
    v_mad_u32_u16 v220, v220, 2, s85 op_sel:[1,0,0,0]
    v_mfma_f32_16x16x32_f16 v[192:195], a[240:243], v[168:171], v[192:195]
    ds_read_u16_d16_hi v220, v220
    v_cvt_pkrtz_f16_f32 v222, v178, v179
    v_pk_lshrrev_b16 v222, 3, v222 op_sel_hi:[0,1]
    v_mfma_f32_16x16x32_f16 v[200:203], a[240:243], v[172:175], v[200:203]
    ds_read_b128 a[240:243], v24 offset:22528
    v_mad_u32_u16 v223, v222, 2, s85
    v_mad_u32_u16 v222, v222, 2, s85 op_sel:[1,0,0,0]
    v_mfma_f32_16x16x32_f16 v[196:199], a[244:247], v[168:171], v[196:199]
    s_waitcnt lgkmcnt(9)
    ds_read_u16 v223, v223
    ds_read_u16_d16_hi v222, v222
    v_or_b32 v246, v217, v216
    v_mfma_f32_16x16x32_f16 v[204:207], a[244:247], v[172:175], v[204:207]
    s_waitcnt lgkmcnt(9)
    ds_read_b128 a[244:247], v24 offset:23552
    v_cvt_pkrtz_f16_f32 v224, v180, v181
    v_pk_lshrrev_b16 v224, 3, v224 op_sel_hi:[0,1]
    v_mad_u32_u16 v225, v224, 2, s85
    v_mad_u32_u16 v224, v224, 2, s85 op_sel:[1,0,0,0]
    v_cvt_pkrtz_f16_f32 v226, v182, v183
    v_pk_lshrrev_b16 v226, 3, v226 op_sel_hi:[0,1]
    v_mad_u32_u16 v227, v226, 2, s85
    v_or_b32 v247, v219, v218
    v_mad_u32_u16 v226, v226, 2, s85 op_sel:[1,0,0,0]
    v_cvt_pkrtz_f16_f32 v228, v184, v185
    v_pk_lshrrev_b16 v228, 3, v228 op_sel_hi:[0,1]
    s_waitcnt lgkmcnt(9)
    v_mfma_f32_16x16x32_bf16 v[32:35], a[248:251], v[232:235], v[32:35]
    s_add_u32 m0, s56, 5120
    ds_read_u16 v225, v225
    ds_read_u16_d16_hi v224, v224
    ds_read_u16 v227, v227
    ds_read_u16_d16_hi v226, v226
    v_mfma_f32_16x16x32_bf16 v[40:43], a[248:251], v[236:239], v[40:43]
    s_waitcnt lgkmcnt(12)
    buffer_load_dwordx4 v6, s[20:23], 0 offen offset:0 lds
    v_mfma_f32_16x16x32_bf16 v[36:39], a[252:255], v[232:235], v[36:39]
    v_mad_u32_u16 v229, v228, 2, s85
    v_mad_u32_u16 v228, v228, 2, s85 op_sel:[1,0,0,0]
    v_cvt_pkrtz_f16_f32 v230, v186, v187
    v_mfma_f32_16x16x32_bf16 v[44:47], a[252:255], v[236:239], v[44:47]
    ds_read_u16 v229, v229
    ds_read_u16_d16_hi v228, v228
    v_pk_lshrrev_b16 v230, 3, v230 op_sel_hi:[0,1]
    v_mfma_f32_16x16x32_bf16 v[80:83], a[248:251], v[240:243], v[80:83]
    v_mad_u32_u16 v231, v230, 2, s85
    v_mad_u32_u16 v230, v230, 2, s85 op_sel:[1,0,0,0]
    v_cvt_pkrtz_f16_f32 v248, v188, v189
    v_mfma_f32_16x16x32_bf16 v[88:91], a[248:251], v[244:247], v[88:91]
    s_waitcnt lgkmcnt(11)
    ds_read_u16 v231, v231
    ds_read_u16_d16_hi v230, v230
    ds_read_b128 a[248:251], v24 offset:36864
    v_mfma_f32_16x16x32_bf16 v[48:51], a[232:235], v[232:235], v[48:51]
    v_pk_lshrrev_b16 v248, 3, v248 op_sel_hi:[0,1]
    v_mad_u32_u16 v249, v248, 2, s85
    v_mad_u32_u16 v248, v248, 2, s85 op_sel:[1,0,0,0]
    v_mfma_f32_16x16x32_bf16 v[56:59], a[232:235], v[236:239], v[56:59]
    s_waitcnt lgkmcnt(13)
    ds_read_u16 v249, v249
    v_cvt_pkrtz_f16_f32 v252, v190, v191
    v_pk_fma_f16 v250, v252, v252, s53
    v_mfma_f32_16x16x32_bf16 v[84:87], a[252:255], v[240:243], v[84:87]
    s_waitcnt lgkmcnt(13)
    ds_read_u16_d16_hi v248, v248
    v_pk_mul_f16 v250, v250, v252 neg_lo:[1,0] neg_hi:[1,0]
    v_exp_f16 v251, v250
    v_mfma_f32_16x16x32_bf16 v[92:95], a[252:255], v[244:247], v[92:95]
    s_waitcnt lgkmcnt(13)
    ds_read_b128 a[252:255], v24 offset:37888
    v_exp_f16_sdwa v251, v250 dst_sel:WORD_1 dst_unused:UNUSED_PRESERVE src0_sel:WORD_1
    v_mfma_f32_16x16x32_bf16 v[52:55], a[236:239], v[232:235], v[52:55]
    v_pk_fma_f16 v251, v251, s86, s86
    v_rcp_f16 v250, v251
    v_mfma_f32_16x16x32_bf16 v[60:63], a[236:239], v[236:239], v[60:63]
    v_rcp_f16_sdwa v250, v251 dst_sel:WORD_1 dst_unused:UNUSED_PRESERVE src0_sel:WORD_1
    v_cvt_pkrtz_f16_f32 v253, v192, v193
    v_mfma_f32_16x16x32_bf16 v[96:99], a[232:235], v[240:243], v[96:99]
    v_fma_mix_f32 v251, v250, v252, 0 op_sel_hi:[1,1,0]
    v_fma_mix_f32 v250, v250, v252, 0 op_sel:[1,1,0] op_sel_hi:[1,1,0]
    v_pk_lshrrev_b16 v253, 3, v253 op_sel_hi:[0,1]
    v_mfma_f32_16x16x32_bf16 v[104:107], a[232:235], v[244:247], v[104:107]
    s_waitcnt lgkmcnt(13)
    ds_read_b128 a[232:235], v24 offset:38912
    v_cvt_pkrtz_f16_f32 v208, v194, v195
    v_cvt_pkrtz_f16_f32 v210, v196, v197
    v_mfma_f32_16x16x32_bf16 v[64:67], a[240:243], v[232:235], v[64:67]
    v_cvt_pkrtz_f16_f32 v212, v198, v199
    v_cvt_pkrtz_f16_f32 v214, v200, v201
    v_cvt_pkrtz_f16_f32 v216, v202, v203
    v_mfma_f32_16x16x32_bf16 v[72:75], a[240:243], v[236:239], v[72:75]
    v_cvt_pkrtz_f16_f32 v218, v204, v205
    v_mad_u32_u16 v0, v253, 2, s85
    v_mad_u32_u16 v253, v253, 2, s85 op_sel:[1,0,0,0]
    v_mfma_f32_16x16x32_bf16 v[100:103], a[236:239], v[240:243], v[100:103]
    s_waitcnt lgkmcnt(12)
    ds_read_u16 v0, v0
    ds_read_u16_d16_hi v253, v253
    v_pk_lshrrev_b16 v208, 3, v208 op_sel_hi:[0,1]
    v_mfma_f32_16x16x32_bf16 v[108:111], a[236:239], v[244:247], v[108:111]
    s_waitcnt lgkmcnt(13)
    ds_read_b128 a[236:239], v24 offset:39936
    v_mad_u32_u16 v209, v208, 2, s85
    v_mad_u32_u16 v208, v208, 2, s85 op_sel:[1,0,0,0]
    v_mfma_f32_16x16x32_bf16 v[68:71], a[244:247], v[232:235], v[68:71]
    s_waitcnt lgkmcnt(12)
    ds_read_u16 v209, v209
    ds_read_u16_d16_hi v208, v208
    v_or_b32 v232, v221, v220
    v_mfma_f32_16x16x32_bf16 v[76:79], a[244:247], v[236:239], v[76:79]
    v_or_b32 v233, v223, v222
    v_or_b32 v234, v225, v224
    v_or_b32 v235, v227, v226
    v_mfma_f32_16x16x32_bf16 v[112:115], a[240:243], v[240:243], v[112:115]
    s_waitcnt lgkmcnt(10)
    v_or_b32 v236, v229, v228
    v_or_b32 v237, v231, v230
    v_cvt_pk_bf16_f32 v239, v251, v250
    v_mfma_f32_16x16x32_bf16 v[120:123], a[240:243], v[244:247], v[120:123]
    ds_read_b128 a[240:243], v24 offset:40960
    v_cvt_pkrtz_f16_f32 v220, v206, v207
    v_pk_lshrrev_b16 v210, 3, v210 op_sel_hi:[0,1]
    v_mfma_f32_16x16x32_bf16 v[116:119], a[244:247], v[240:243], v[116:119]
    v_mad_u32_u16 v211, v210, 2, s85
    v_mad_u32_u16 v210, v210, 2, s85 op_sel:[1,0,0,0]
    v_pk_lshrrev_b16 v212, 3, v212 op_sel_hi:[0,1]
    v_mfma_f32_16x16x32_bf16 v[124:127], a[244:247], v[244:247], v[124:127]
    s_waitcnt lgkmcnt(10)
    ds_read_b128 a[244:247], v24 offset:41984
    ds_read_u16 v211, v211
    ds_read_u16_d16_hi v210, v210
    v_mfma_f32_16x16x32_f16 v[176:179], a[248:251], v[128:131], 0
    s_waitcnt lgkmcnt(11)
    v_or_b32 v238, v249, v248
    v_mad_u32_u16 v213, v212, 2, s85
    v_mad_u32_u16 v212, v212, 2, s85 op_sel:[1,0,0,0]
    v_mfma_f32_16x16x32_f16 v[184:187], a[248:251], v[132:135], 0
    s_waitcnt lgkmcnt(10)
    ds_read_u16 v213, v213
    ds_read_u16_d16_hi v212, v212
    v_pk_lshrrev_b16 v214, 3, v214 op_sel_hi:[0,1]
    v_mfma_f32_16x16x32_f16 v[180:183], a[252:255], v[128:131], 0
    v_mad_u32_u16 v215, v214, 2, s85
    v_mad_u32_u16 v214, v214, 2, s85 op_sel:[1,0,0,0]
    v_pk_lshrrev_b16 v216, 3, v216 op_sel_hi:[0,1]
    v_mfma_f32_16x16x32_f16 v[188:191], a[252:255], v[132:135], 0
    s_add_u32 m0, s56, 6144
    ds_read_u16 v215, v215
    ds_read_u16_d16_hi v214, v214
    buffer_load_dword v7, s[20:23], 0 offen offset:0 lds
    v_mfma_f32_16x16x32_f16 v[192:195], a[248:251], v[152:155], 0
    v_mad_u32_u16 v217, v216, 2, s85
    v_mad_u32_u16 v216, v216, 2, s85 op_sel:[1,0,0,0]
    v_pk_lshrrev_b16 v218, 3, v218 op_sel_hi:[0,1]
    v_mfma_f32_16x16x32_f16 v[200:203], a[248:251], v[156:159], 0
    s_waitcnt lgkmcnt(11)
    ds_read_u16 v217, v217
    ds_read_u16_d16_hi v216, v216
    ds_read_b128 a[248:251], v24 offset:30720
    v_mfma_f32_16x16x32_f16 v[176:179], a[232:235], v[136:139], v[176:179]
    v_mad_u32_u16 v219, v218, 2, s85
    v_mad_u32_u16 v218, v218, 2, s85 op_sel:[1,0,0,0]
    v_pk_lshrrev_b16 v220, 3, v220 op_sel_hi:[0,1]
    v_mfma_f32_16x16x32_f16 v[184:187], a[232:235], v[140:143], v[184:187]
    s_waitcnt lgkmcnt(12)
    ds_read_u16 v219, v219
    ds_read_u16_d16_hi v218, v218
    v_mad_u32_u16 v221, v220, 2, s85
    v_mfma_f32_16x16x32_f16 v[196:199], a[252:255], v[152:155], 0
    s_waitcnt lgkmcnt(13)
    ds_read_u16 v221, v221
    v_mad_u32_u16 v220, v220, 2, s85 op_sel:[1,0,0,0]
    v_or_b32 v240, v0, v253
    v_mfma_f32_16x16x32_f16 v[204:207], a[252:255], v[156:159], 0
    v_or_b32 v241, v209, v208
    v_mfma_f32_16x16x32_f16 v[180:183], a[236:239], v[136:139], v[180:183]
    s_waitcnt lgkmcnt(13)
    ds_read_u16_d16_hi v220, v220
    v_mfma_f32_16x16x32_f16 v[188:191], a[236:239], v[140:143], v[188:191]
    s_waitcnt lgkmcnt(11)
    ds_read_b128 a[252:255], v24 offset:31744
    v_or_b32 v242, v211, v210
    v_mfma_f32_16x16x32_f16 v[192:195], a[232:235], v[160:163], v[192:195]
    v_mfma_f32_16x16x32_f16 v[200:203], a[232:235], v[164:167], v[200:203]
    ds_read_b128 a[232:235], v24 offset:32768
    v_mfma_f32_16x16x32_f16 v[176:179], a[240:243], v[144:147], v[176:179]
    s_waitcnt lgkmcnt(11)
    v_or_b32 v243, v213, v212
    v_mfma_f32_16x16x32_f16 v[184:187], a[240:243], v[148:151], v[184:187]
    v_mfma_f32_16x16x32_f16 v[196:199], a[236:239], v[160:163], v[196:199]
    v_mfma_f32_16x16x32_f16 v[204:207], a[236:239], v[164:167], v[204:207]
    ds_read_b128 a[236:239], v24 offset:33792
    v_mfma_f32_16x16x32_f16 v[180:183], a[244:247], v[144:147], v[180:183]
    s_waitcnt lgkmcnt(10)
    v_or_b32 v244, v215, v214
    v_mfma_f32_16x16x32_f16 v[188:191], a[244:247], v[148:151], v[188:191]
    v_cvt_pkrtz_f16_f32 v222, v176, v177
    v_pk_lshrrev_b16 v222, 3, v222 op_sel_hi:[0,1]
    v_mad_u32_u16 v223, v222, 2, s85
    v_mfma_f32_16x16x32_f16 v[192:195], a[240:243], v[168:171], v[192:195]
    ds_read_u16 v223, v223
    v_mad_u32_u16 v222, v222, 2, s85 op_sel:[1,0,0,0]
    v_cvt_pkrtz_f16_f32 v224, v178, v179
    v_mfma_f32_16x16x32_f16 v[200:203], a[240:243], v[172:175], v[200:203]
    s_waitcnt lgkmcnt(9)
    ds_read_b128 a[240:243], v24 offset:34816
    ds_read_u16_d16_hi v222, v222
    v_or_b32 v245, v217, v216
    v_mfma_f32_16x16x32_f16 v[196:199], a[244:247], v[168:171], v[196:199]
    v_pk_lshrrev_b16 v224, 3, v224 op_sel_hi:[0,1]
    v_mad_u32_u16 v225, v224, 2, s85
    v_mad_u32_u16 v224, v224, 2, s85 op_sel:[1,0,0,0]
    v_mfma_f32_16x16x32_f16 v[204:207], a[244:247], v[172:175], v[204:207]
    s_waitcnt lgkmcnt(10)
    ds_read_b128 a[244:247], v24 offset:35840
    ds_read_u16 v225, v225
    ds_read_u16_d16_hi v224, v224
    v_mfma_f32_16x16x32_bf16 v[32:35], a[248:251], v[232:235], v[32:35]
    s_waitcnt lgkmcnt(11)
    v_cvt_pkrtz_f16_f32 v226, v180, v181
    v_or_b32 v246, v219, v218
    v_pk_lshrrev_b16 v226, 3, v226 op_sel_hi:[0,1]
    v_mfma_f32_16x16x32_bf16 v[40:43], a[248:251], v[236:239], v[40:43]
    v_mad_u32_u16 v227, v226, 2, s85
    v_mad_u32_u16 v226, v226, 2, s85 op_sel:[1,0,0,0]
    v_cvt_pkrtz_f16_f32 v228, v182, v183
    v_pk_lshrrev_b16 v228, 3, v228 op_sel_hi:[0,1]
    v_mad_u32_u16 v229, v228, 2, s85
    v_mad_u32_u16 v228, v228, 2, s85 op_sel:[1,0,0,0]
    v_cvt_pkrtz_f16_f32 v230, v184, v185
    v_pk_lshrrev_b16 v230, 3, v230 op_sel_hi:[0,1]
    v_mad_u32_u16 v231, v230, 2, s85
    s_waitcnt lgkmcnt(9)
    v_or_b32 v247, v221, v220
    v_mad_u32_u16 v230, v230, 2, s85 op_sel:[1,0,0,0]
    v_cvt_pkrtz_f16_f32 v248, v186, v187
    v_pk_lshrrev_b16 v248, 3, v248 op_sel_hi:[0,1]
    s_waitcnt lgkmcnt(8)
    v_mfma_f32_16x16x32_bf16 v[36:39], a[252:255], v[232:235], v[36:39]
    ds_read_u16 v227, v227
    ds_read_u16_d16_hi v226, v226
    ds_read_u16 v229, v229
    ds_read_u16_d16_hi v228, v228
    v_mfma_f32_16x16x32_bf16 v[44:47], a[252:255], v[236:239], v[44:47]
    ds_read_u16 v231, v231
    ds_read_u16_d16_hi v230, v230
    v_mad_u32_u16 v249, v248, 2, s85
    v_mfma_f32_16x16x32_bf16 v[80:83], a[248:251], v[240:243], v[80:83]
    v_mad_u32_u16 v248, v248, 2, s85 op_sel:[1,0,0,0]
    v_cvt_pkrtz_f16_f32 v250, v188, v189
    v_pk_lshrrev_b16 v250, 3, v250 op_sel_hi:[0,1]
    v_mfma_f32_16x16x32_bf16 v[88:91], a[248:251], v[244:247], v[88:91]
    s_waitcnt lgkmcnt(12)
    ds_read_u16 v249, v249
    ds_read_u16_d16_hi v248, v248
    v_mad_u32_u16 v251, v250, 2, s85
    v_mfma_f32_16x16x32_bf16 v[48:51], a[232:235], v[232:235], v[48:51]
    v_mad_u32_u16 v250, v250, 2, s85 op_sel:[1,0,0,0]
    v_cvt_pkrtz_f16_f32 v252, v190, v191
    v_pk_lshrrev_b16 v252, 3, v252 op_sel_hi:[0,1]
    v_mfma_f32_16x16x32_bf16 v[56:59], a[232:235], v[236:239], v[56:59]
    s_waitcnt lgkmcnt(13)
    ds_read_u16 v251, v251
    v_mad_u32_u16 v253, v252, 2, s85
    v_mad_u32_u16 v252, v252, 2, s85 op_sel:[1,0,0,0]
    v_mfma_f32_16x16x32_bf16 v[84:87], a[252:255], v[240:243], v[84:87]
    s_waitcnt lgkmcnt(13)
    ds_read_u16_d16_hi v250, v250
    v_cvt_pkrtz_f16_f32 v0, v192, v193
    v_pk_lshrrev_b16 v0, 3, v0 op_sel_hi:[0,1]
    v_mfma_f32_16x16x32_bf16 v[92:95], a[252:255], v[244:247], v[92:95]
    s_waitcnt lgkmcnt(13)
    ds_read_u16 v253, v253
    v_cvt_pkrtz_f16_f32 v209, v194, v195
    v_cvt_pkrtz_f16_f32 v211, v196, v197
    v_mfma_f32_16x16x32_bf16 v[52:55], a[236:239], v[232:235], v[52:55]
    s_waitcnt lgkmcnt(13)
    ds_read_u16_d16_hi v252, v252
    v_cvt_pkrtz_f16_f32 v213, v198, v199
    v_cvt_pkrtz_f16_f32 v215, v200, v201
    v_mfma_f32_16x16x32_bf16 v[60:63], a[236:239], v[236:239], v[60:63]
    v_cvt_pkrtz_f16_f32 v217, v202, v203
    v_cvt_pkrtz_f16_f32 v219, v204, v205
    v_cvt_pkrtz_f16_f32 v221, v206, v207
    v_mfma_f32_16x16x32_bf16 v[96:99], a[232:235], v[240:243], v[96:99]
    s_waitcnt lgkmcnt(13)
    ds_read_b128 a[248:251], v24 offset:43008
    v_mad_u32_u16 v208, v0, 2, s85
    v_mad_u32_u16 v0, v0, 2, s85 op_sel:[1,0,0,0]
    v_mfma_f32_16x16x32_bf16 v[104:107], a[232:235], v[244:247], v[104:107]
    s_waitcnt lgkmcnt(13)
    ds_read_b128 a[252:255], v24 offset:44032
    buffer_load_dword v254, v31, s[20:23], 0 offen
    v_pk_lshrrev_b16 v209, 3, v209 op_sel_hi:[0,1]
    v_mfma_f32_16x16x32_bf16 v[64:67], a[240:243], v[232:235], v[64:67]
    v_mad_u32_u16 v210, v209, 2, s85
    v_mad_u32_u16 v209, v209, 2, s85 op_sel:[1,0,0,0]
    v_pk_lshrrev_b16 v211, 3, v211 op_sel_hi:[0,1]
    v_mfma_f32_16x16x32_bf16 v[72:75], a[240:243], v[236:239], v[72:75]
    s_waitcnt lgkmcnt(13)
    ds_read_b128 a[232:235], v24 offset:45056
    v_mad_u32_u16 v212, v211, 2, s85
    v_mad_u32_u16 v211, v211, 2, s85 op_sel:[1,0,0,0]
    v_mfma_f32_16x16x32_bf16 v[100:103], a[236:239], v[240:243], v[100:103]
    s_waitcnt lgkmcnt(13)
    ds_read_u16 v208, v208
    v_pk_lshrrev_b16 v213, 3, v213 op_sel_hi:[0,1]
    v_mad_u32_u16 v214, v213, 2, s85
    v_mfma_f32_16x16x32_bf16 v[108:111], a[236:239], v[244:247], v[108:111]
    s_waitcnt lgkmcnt(13)
    ds_read_b128 a[236:239], v24 offset:46080
    v_mad_u32_u16 v213, v213, 2, s85 op_sel:[1,0,0,0]
    v_pk_lshrrev_b16 v215, 3, v215 op_sel_hi:[0,1]
    v_mfma_f32_16x16x32_bf16 v[68:71], a[244:247], v[232:235], v[68:71]
    v_or_b32 v232, v223, v222
    v_or_b32 v233, v225, v224
    v_or_b32 v234, v227, v226
    v_mfma_f32_16x16x32_bf16 v[76:79], a[244:247], v[236:239], v[76:79]
    s_waitcnt lgkmcnt(11)
    ds_read_u16_d16_hi v0, v0
    v_or_b32 v235, v229, v228
    v_or_b32 v236, v231, v230
    v_mfma_f32_16x16x32_bf16 v[112:115], a[240:243], v[240:243], v[112:115]
    ds_read_u16 v210, v210
    v_mad_u32_u16 v216, v215, 2, s85
    v_mad_u32_u16 v215, v215, 2, s85 op_sel:[1,0,0,0]
    v_mfma_f32_16x16x32_bf16 v[120:123], a[240:243], v[244:247], v[120:123]
    s_waitcnt lgkmcnt(11)
    ds_read_b128 a[240:243], v24 offset:47104
    v_or_b32 v237, v249, v248
    v_pk_lshrrev_b16 v217, 3, v217 op_sel_hi:[0,1]
    v_mfma_f32_16x16x32_bf16 v[116:119], a[244:247], v[240:243], v[116:119]
    v_mad_u32_u16 v218, v217, 2, s85
    v_mad_u32_u16 v217, v217, 2, s85 op_sel:[1,0,0,0]
    v_pk_lshrrev_b16 v219, 3, v219 op_sel_hi:[0,1]
    v_mfma_f32_16x16x32_bf16 v[124:127], a[244:247], v[244:247], v[124:127]
    ds_read_b128 a[244:247], v24 offset:48128
    v_mad_u32_u16 v220, v219, 2, s85
    v_mad_u32_u16 v219, v219, 2, s85 op_sel:[1,0,0,0]
    v_mfma_f32_16x16x32_f16 v[176:179], a[0:3], v[128:131], 0
    s_waitcnt lgkmcnt(11)
    ds_read_u16_d16_hi v209, v209
    v_or_b32 v238, v251, v250
    v_pk_lshrrev_b16 v221, 3, v221 op_sel_hi:[0,1]
    v_mad_u32_u16 v222, v221, 2, s85
    v_mad_u32_u16 v221, v221, 2, s85 op_sel:[1,0,0,0]
    ds_read_u16 v212, v212
    s_waitcnt lgkmcnt(11)
    v_or_b32 v239, v253, v252
    s_waitcnt lgkmcnt(10)
    v_mfma_f32_16x16x32_bf16 v[32:35], a[248:251], v[232:235], v[32:35]
    ds_read_u16_d16_hi v211, v211
    ds_read_u16 v214, v214
    ds_read_u16_d16_hi v213, v213
    v_mfma_f32_16x16x32_f16 v[180:183], a[4:7], v[128:131], 0
    s_waitcnt lgkmcnt(12)
    v_mfma_f32_16x16x32_bf16 v[36:39], a[252:255], v[232:235], v[36:39]
    ds_read_u16 v216, v216
    v_mfma_f32_16x16x32_f16 v[176:179], a[8:11], v[136:139], v[176:179]
    s_waitcnt lgkmcnt(12)
    ds_read_u16_d16_hi v215, v215
    v_mfma_f32_16x16x32_bf16 v[48:51], a[232:235], v[232:235], v[48:51]
    ds_read_u16 v218, v218
    v_mfma_f32_16x16x32_f16 v[180:183], a[12:15], v[136:139], v[180:183]
    s_waitcnt lgkmcnt(12)
    v_mfma_f32_16x16x32_bf16 v[52:55], a[236:239], v[232:235], v[52:55]
    s_waitcnt lgkmcnt(11)
    ds_read_u16_d16_hi v217, v217
    v_or_b32 v240, v208, v0
    v_mfma_f32_16x16x32_f16 v[176:179], a[16:19], v[144:147], v[176:179]
    ds_read_u16 v220, v220
    s_waitcnt lgkmcnt(11)
    v_mfma_f32_16x16x32_bf16 v[64:67], a[240:243], v[232:235], v[64:67]
    ds_read_u16_d16_hi v219, v219
    v_mfma_f32_16x16x32_f16 v[180:183], a[20:23], v[144:147], v[180:183]
    s_waitcnt lgkmcnt(11)
    ds_read_u16 v222, v222
    v_mfma_f32_16x16x32_bf16 v[68:71], a[244:247], v[232:235], v[68:71]
    s_waitcnt lgkmcnt(11)
    ds_read_u16_d16_hi v221, v221
    v_or_b32 v241, v210, v209
    v_mfma_f32_16x16x32_f16 v[184:187], a[0:3], v[132:135], 0
    v_cvt_pkrtz_f16_f32 v223, v176, v177
    v_pk_lshrrev_b16 v223, 3, v223 op_sel_hi:[0,1]
    v_mad_u32_u16 v224, v223, 2, s85
    v_mfma_f32_16x16x32_bf16 v[40:43], a[248:251], v[236:239], v[40:43]
    ds_read_u16 v224, v224
    v_mad_u32_u16 v223, v223, 2, s85 op_sel:[1,0,0,0]
    v_cvt_pkrtz_f16_f32 v225, v178, v179
    v_mfma_f32_16x16x32_f16 v[188:191], a[4:7], v[132:135], 0
    s_waitcnt lgkmcnt(11)
    ds_read_u16_d16_hi v223, v223
    v_or_b32 v242, v212, v211
    v_pk_lshrrev_b16 v225, 3, v225 op_sel_hi:[0,1]
    v_mfma_f32_16x16x32_bf16 v[44:47], a[252:255], v[236:239], v[44:47]
    v_mad_u32_u16 v226, v225, 2, s85
    v_mad_u32_u16 v225, v225, 2, s85 op_sel:[1,0,0,0]
    v_cvt_pkrtz_f16_f32 v227, v180, v181
    v_mfma_f32_16x16x32_f16 v[184:187], a[8:11], v[140:143], v[184:187]
    ds_read_u16 v226, v226
    v_pk_lshrrev_b16 v227, 3, v227 op_sel_hi:[0,1]
    v_mad_u32_u16 v228, v227, 2, s85
    v_mfma_f32_16x16x32_bf16 v[56:59], a[232:235], v[236:239], v[56:59]
    s_waitcnt lgkmcnt(11)
    ds_read_u16_d16_hi v225, v225
    v_or_b32 v243, v214, v213
    v_mad_u32_u16 v227, v227, 2, s85 op_sel:[1,0,0,0]
    v_mfma_f32_16x16x32_f16 v[188:191], a[12:15], v[140:143], v[188:191]
    ds_read_u16 v228, v228
    v_cvt_pkrtz_f16_f32 v229, v182, v183
    v_pk_lshrrev_b16 v229, 3, v229 op_sel_hi:[0,1]
    v_mfma_f32_16x16x32_bf16 v[60:63], a[236:239], v[236:239], v[60:63]
    s_waitcnt lgkmcnt(12)
    v_mad_u32_u16 v230, v229, 2, s85
    v_mad_u32_u16 v229, v229, 2, s85 op_sel:[1,0,0,0]
    s_waitcnt lgkmcnt(11)
    v_or_b32 v244, v216, v215
    v_mfma_f32_16x16x32_f16 v[184:187], a[16:19], v[148:151], v[184:187]
    ds_read_u16_d16_hi v227, v227
    v_mfma_f32_16x16x32_f16 v[188:191], a[20:23], v[148:151], v[188:191]
    ds_read_u16 v230, v230
    v_mfma_f32_16x16x32_bf16 v[72:75], a[240:243], v[236:239], v[72:75]
    v_mfma_f32_16x16x32_bf16 v[76:79], a[244:247], v[236:239], v[76:79]
    s_waitcnt lgkmcnt(11)
    ds_read_u16_d16_hi v229, v229
    v_or_b32 v245, v218, v217
    v_mfma_f32_16x16x32_f16 v[176:179], a[48:51], v[128:131], 0
    v_cvt_pkrtz_f16_f32 v231, v184, v185
    v_pk_lshrrev_b16 v231, 3, v231 op_sel_hi:[0,1]
    v_mad_u32_u16 v248, v231, 2, s85
    v_mfma_f32_16x16x32_bf16 v[80:83], a[248:251], v[240:243], v[80:83]
    ds_read_u16 v248, v248
    v_mad_u32_u16 v231, v231, 2, s85 op_sel:[1,0,0,0]
    v_cvt_pkrtz_f16_f32 v249, v186, v187
    v_mfma_f32_16x16x32_f16 v[180:183], a[52:55], v[128:131], 0
    s_waitcnt lgkmcnt(11)
    ds_read_u16_d16_hi v231, v231
    v_or_b32 v246, v220, v219
    v_pk_lshrrev_b16 v249, 3, v249 op_sel_hi:[0,1]
    v_mfma_f32_16x16x32_bf16 v[84:87], a[252:255], v[240:243], v[84:87]
    v_mad_u32_u16 v250, v249, 2, s85
    v_mad_u32_u16 v249, v249, 2, s85 op_sel:[1,0,0,0]
    v_cvt_pkrtz_f16_f32 v251, v188, v189
    v_mfma_f32_16x16x32_f16 v[176:179], a[56:59], v[136:139], v[176:179]
    s_waitcnt lgkmcnt(10)
    ds_read_u16 v250, v250
    ds_read_u16_d16_hi v249, v249
    v_or_b32 v247, v222, v221
    v_mfma_f32_16x16x32_bf16 v[96:99], a[232:235], v[240:243], v[96:99]
    v_pk_lshrrev_b16 v251, 3, v251 op_sel_hi:[0,1]
    v_mad_u32_u16 v252, v251, 2, s85
    v_mad_u32_u16 v251, v251, 2, s85 op_sel:[1,0,0,0]
    v_mfma_f32_16x16x32_f16 v[180:183], a[60:63], v[136:139], v[180:183]
    ds_read_u16 v252, v252
    v_cvt_pkrtz_f16_f32 v253, v190, v191
    v_pk_lshrrev_b16 v253, 3, v253 op_sel_hi:[0,1]
    v_mfma_f32_16x16x32_bf16 v[100:103], a[236:239], v[240:243], v[100:103]
    ds_read_u16_d16_hi v251, v251
    v_mad_u32_u16 v0, v253, 2, s85
    v_mad_u32_u16 v253, v253, 2, s85 op_sel:[1,0,0,0]
    v_mfma_f32_16x16x32_f16 v[176:179], a[64:67], v[144:147], v[176:179]
    s_waitcnt lgkmcnt(12)
    v_or_b32 v232, v224, v223
    v_mfma_f32_16x16x32_bf16 v[112:115], a[240:243], v[240:243], v[112:115]
    ds_read_u16 v0, v0
    v_mfma_f32_16x16x32_f16 v[180:183], a[68:71], v[144:147], v[180:183]
    s_waitcnt lgkmcnt(11)
    ds_read_u16_d16_hi v253, v253
    v_or_b32 v233, v226, v225
    v_mfma_f32_16x16x32_bf16 v[116:119], a[244:247], v[240:243], v[116:119]
    v_cvt_pkrtz_f16_f32 v208, v176, v177
    v_pk_lshrrev_b16 v208, 3, v208 op_sel_hi:[0,1]
    v_mad_u32_u16 v209, v208, 2, s85
    v_mfma_f32_16x16x32_f16 v[184:187], a[48:51], v[132:135], 0
    ds_read_u16 v209, v209
    v_mad_u32_u16 v208, v208, 2, s85 op_sel:[1,0,0,0]
    v_cvt_pkrtz_f16_f32 v210, v178, v179
    v_mfma_f32_16x16x32_bf16 v[88:91], a[248:251], v[244:247], v[88:91]
    s_waitcnt lgkmcnt(11)
    ds_read_u16_d16_hi v208, v208
    v_or_b32 v234, v228, v227
    v_pk_lshrrev_b16 v210, 3, v210 op_sel_hi:[0,1]
    v_mfma_f32_16x16x32_f16 v[188:191], a[52:55], v[132:135], 0
    v_mad_u32_u16 v211, v210, 2, s85
    v_mad_u32_u16 v210, v210, 2, s85 op_sel:[1,0,0,0]
    v_cvt_pkrtz_f16_f32 v212, v180, v181
    v_mfma_f32_16x16x32_bf16 v[92:95], a[252:255], v[244:247], v[92:95]
    ds_read_u16 v211, v211
    v_pk_lshrrev_b16 v212, 3, v212 op_sel_hi:[0,1]
    v_mad_u32_u16 v213, v212, 2, s85
    v_mfma_f32_16x16x32_f16 v[184:187], a[56:59], v[140:143], v[184:187]
    s_waitcnt lgkmcnt(11)
    ds_read_u16_d16_hi v210, v210
    v_or_b32 v235, v230, v229
    v_mad_u32_u16 v212, v212, 2, s85 op_sel:[1,0,0,0]
    v_mfma_f32_16x16x32_bf16 v[104:107], a[232:235], v[244:247], v[104:107]
    ds_read_u16 v213, v213
    v_cvt_pkrtz_f16_f32 v214, v182, v183
    v_pk_lshrrev_b16 v214, 3, v214 op_sel_hi:[0,1]
    v_mfma_f32_16x16x32_f16 v[188:191], a[60:63], v[140:143], v[188:191]
    s_waitcnt lgkmcnt(12)
    v_mad_u32_u16 v215, v214, 2, s85
    v_mad_u32_u16 v214, v214, 2, s85 op_sel:[1,0,0,0]
    s_waitcnt lgkmcnt(11)
    v_or_b32 v236, v248, v231
    v_mfma_f32_16x16x32_bf16 v[108:111], a[236:239], v[244:247], v[108:111]
    ds_read_u16_d16_hi v212, v212
    v_mfma_f32_16x16x32_f16 v[184:187], a[64:67], v[148:151], v[184:187]
    ds_read_u16 v215, v215
    v_mfma_f32_16x16x32_f16 v[188:191], a[68:71], v[148:151], v[188:191]
    v_mfma_f32_16x16x32_bf16 v[120:123], a[240:243], v[244:247], v[120:123]
    s_waitcnt lgkmcnt(11)
    ds_read_u16_d16_hi v214, v214
    v_or_b32 v237, v250, v249
    v_mfma_f32_16x16x32_bf16 v[124:127], a[244:247], v[244:247], v[124:127]
    s_nop 0
    v_cvt_pkrtz_f16_f32 v216, v184, v185
    v_pk_lshrrev_b16 v216, 3, v216 op_sel_hi:[0,1]
    v_mfma_f32_16x16x32_f16 v[176:179], a[96:99], v[128:131], 0
    v_mad_u32_u16 v217, v216, 2, s85
    v_mad_u32_u16 v216, v216, 2, s85 op_sel:[1,0,0,0]
    v_cvt_pkrtz_f16_f32 v218, v186, v187
    v_mfma_f32_16x16x32_bf16 v[32:35], a[24:27], v[232:235], v[32:35]
    s_waitcnt lgkmcnt(10)
    ds_read_u16 v217, v217
    ds_read_u16_d16_hi v216, v216
    v_or_b32 v238, v252, v251
    v_mfma_f32_16x16x32_f16 v[180:183], a[100:103], v[128:131], 0
    v_pk_lshrrev_b16 v218, 3, v218 op_sel_hi:[0,1]
    v_mad_u32_u16 v219, v218, 2, s85
    v_mad_u32_u16 v218, v218, 2, s85 op_sel:[1,0,0,0]
    v_mfma_f32_16x16x32_bf16 v[36:39], a[28:31], v[232:235], v[36:39]
    s_waitcnt lgkmcnt(10)
    ds_read_u16 v219, v219
    ds_read_u16_d16_hi v218, v218
    v_or_b32 v239, v0, v253
    v_mfma_f32_16x16x32_f16 v[176:179], a[104:107], v[136:139], v[176:179]
    v_cvt_pkrtz_f16_f32 v220, v188, v189
    v_pk_lshrrev_b16 v220, 3, v220 op_sel_hi:[0,1]
    v_mad_u32_u16 v221, v220, 2, s85
    v_mfma_f32_16x16x32_bf16 v[48:51], a[32:35], v[232:235], v[48:51]
    ds_read_u16 v221, v221
    v_mad_u32_u16 v220, v220, 2, s85 op_sel:[1,0,0,0]
    v_cvt_pkrtz_f16_f32 v222, v190, v191
    v_mfma_f32_16x16x32_f16 v[180:183], a[108:111], v[136:139], v[180:183]
    ds_read_u16_d16_hi v220, v220
    v_pk_lshrrev_b16 v222, 3, v222 op_sel_hi:[0,1]
    v_mad_u32_u16 v223, v222, 2, s85
    v_mfma_f32_16x16x32_bf16 v[52:55], a[36:39], v[232:235], v[52:55]
    v_mad_u32_u16 v222, v222, 2, s85 op_sel:[1,0,0,0]
    v_mfma_f32_16x16x32_f16 v[176:179], a[112:115], v[144:147], v[176:179]
    s_waitcnt lgkmcnt(13)
    ds_read_u16 v223, v223
    v_mfma_f32_16x16x32_bf16 v[64:67], a[40:43], v[232:235], v[64:67]
    s_waitcnt lgkmcnt(13)
    ds_read_u16_d16_hi v222, v222
    v_mfma_f32_16x16x32_f16 v[180:183], a[116:119], v[144:147], v[180:183]
    v_mfma_f32_16x16x32_bf16 v[68:71], a[44:47], v[232:235], v[68:71]
    s_waitcnt lgkmcnt(12)
    v_or_b32 v232, v209, v208
    v_or_b32 v233, v211, v210
    v_mfma_f32_16x16x32_f16 v[184:187], a[96:99], v[132:135], 0
    s_waitcnt lgkmcnt(11)
    v_cvt_pkrtz_f16_f32 v224, v176, v177
    v_pk_lshrrev_b16 v224, 3, v224 op_sel_hi:[0,1]
    s_waitcnt lgkmcnt(10)
    v_or_b32 v234, v213, v212
    v_mfma_f32_16x16x32_bf16 v[40:43], a[24:27], v[236:239], v[40:43]
    v_mad_u32_u16 v225, v224, 2, s85
    v_mad_u32_u16 v224, v224, 2, s85 op_sel:[1,0,0,0]
    v_cvt_pkrtz_f16_f32 v226, v178, v179
    v_mfma_f32_16x16x32_f16 v[188:191], a[100:103], v[132:135], 0
    ds_read_u16 v225, v225
    ds_read_u16_d16_hi v224, v224
    v_pk_lshrrev_b16 v226, 3, v226 op_sel_hi:[0,1]
    v_mfma_f32_16x16x32_bf16 v[44:47], a[28:31], v[236:239], v[44:47]
    s_waitcnt lgkmcnt(10)
    v_or_b32 v235, v215, v214
    v_mad_u32_u16 v227, v226, 2, s85
    v_mad_u32_u16 v226, v226, 2, s85 op_sel:[1,0,0,0]
    v_mfma_f32_16x16x32_f16 v[184:187], a[104:107], v[140:143], v[184:187]
    ds_read_u16 v227, v227
    ds_read_u16_d16_hi v226, v226
    v_cvt_pkrtz_f16_f32 v228, v180, v181
    v_mfma_f32_16x16x32_bf16 v[56:59], a[32:35], v[236:239], v[56:59]
    v_pk_lshrrev_b16 v228, 3, v228 op_sel_hi:[0,1]
    v_mad_u32_u16 v229, v228, 2, s85
    v_mad_u32_u16 v228, v228, 2, s85 op_sel:[1,0,0,0]
    v_mfma_f32_16x16x32_f16 v[188:191], a[108:111], v[140:143], v[188:191]
    ds_read_u16 v229, v229
    ds_read_u16_d16_hi v228, v228
    v_cvt_pkrtz_f16_f32 v230, v182, v183
    v_mfma_f32_16x16x32_bf16 v[60:63], a[36:39], v[236:239], v[60:63]
    v_pk_lshrrev_b16 v230, 3, v230 op_sel_hi:[0,1]
    v_mad_u32_u16 v231, v230, 2, s85
    v_mad_u32_u16 v230, v230, 2, s85 op_sel:[1,0,0,0]
    v_mfma_f32_16x16x32_f16 v[184:187], a[112:115], v[148:151], v[184:187]
    s_waitcnt lgkmcnt(13)
    ds_read_u16 v231, v231
    v_mfma_f32_16x16x32_f16 v[188:191], a[116:119], v[148:151], v[188:191]
    s_waitcnt lgkmcnt(13)
    ds_read_u16_d16_hi v230, v230
    v_mfma_f32_16x16x32_bf16 v[72:75], a[40:43], v[236:239], v[72:75]
    v_mfma_f32_16x16x32_bf16 v[76:79], a[44:47], v[236:239], v[76:79]
    s_waitcnt lgkmcnt(12)
    v_or_b32 v236, v217, v216
    v_or_b32 v237, v219, v218
    v_mfma_f32_16x16x32_f16 v[176:179], a[144:147], v[128:131], 0
    s_waitcnt lgkmcnt(10)
    v_or_b32 v238, v221, v220
    v_cvt_pkrtz_f16_f32 v248, v184, v185
    v_pk_lshrrev_b16 v248, 3, v248 op_sel_hi:[0,1]
    v_mfma_f32_16x16x32_bf16 v[32:35], a[72:75], v[232:235], v[32:35]
    v_mad_u32_u16 v249, v248, 2, s85
    v_mad_u32_u16 v248, v248, 2, s85 op_sel:[1,0,0,0]
    v_cvt_pkrtz_f16_f32 v250, v186, v187
    v_mfma_f32_16x16x32_f16 v[180:183], a[148:151], v[128:131], 0
    ds_read_u16 v249, v249
    ds_read_u16_d16_hi v248, v248
    v_pk_lshrrev_b16 v250, 3, v250 op_sel_hi:[0,1]
    v_mfma_f32_16x16x32_bf16 v[36:39], a[76:79], v[232:235], v[36:39]
    s_waitcnt lgkmcnt(10)
    v_or_b32 v239, v223, v222
    v_mad_u32_u16 v251, v250, 2, s85
    v_mad_u32_u16 v250, v250, 2, s85 op_sel:[1,0,0,0]
    v_mfma_f32_16x16x32_f16 v[176:179], a[152:155], v[136:139], v[176:179]
    ds_read_u16 v251, v251
    ds_read_u16_d16_hi v250, v250
    v_cvt_pkrtz_f16_f32 v252, v188, v189
    v_mfma_f32_16x16x32_bf16 v[48:51], a[80:83], v[232:235], v[48:51]
    v_pk_lshrrev_b16 v252, 3, v252 op_sel_hi:[0,1]
    v_mad_u32_u16 v253, v252, 2, s85
    v_mad_u32_u16 v252, v252, 2, s85 op_sel:[1,0,0,0]
    v_mfma_f32_16x16x32_f16 v[180:183], a[156:159], v[136:139], v[180:183]
    ds_read_u16 v253, v253
    ds_read_u16_d16_hi v252, v252
    v_cvt_pkrtz_f16_f32 v209, v190, v191
    v_mfma_f32_16x16x32_bf16 v[52:55], a[84:87], v[232:235], v[52:55]
    v_pk_fma_f16 v0, v209, v209, s53
    v_pk_mul_f16 v0, v0, v209 neg_lo:[1,0] neg_hi:[1,0]
    v_exp_f16 v208, v0
    v_mfma_f32_16x16x32_f16 v[176:179], a[160:163], v[144:147], v[176:179]
    v_exp_f16_sdwa v208, v0 dst_sel:WORD_1 dst_unused:UNUSED_PRESERVE src0_sel:WORD_1
    v_mfma_f32_16x16x32_bf16 v[64:67], a[88:91], v[232:235], v[64:67]
    v_pk_fma_f16 v208, v208, s86, s86
    v_rcp_f16 v0, v208
    v_mfma_f32_16x16x32_f16 v[180:183], a[164:167], v[144:147], v[180:183]
    v_rcp_f16_sdwa v0, v208 dst_sel:WORD_1 dst_unused:UNUSED_PRESERVE src0_sel:WORD_1
    v_mfma_f32_16x16x32_bf16 v[68:71], a[92:95], v[232:235], v[68:71]
    s_waitcnt lgkmcnt(12)
    v_fma_mix_f32 v208, v0, v209, 0 op_sel_hi:[1,1,0]
    v_fma_mix_f32 v0, v0, v209, 0 op_sel:[1,1,0] op_sel_hi:[1,1,0]
    v_or_b32 v232, v225, v224
    v_mfma_f32_16x16x32_f16 v[184:187], a[144:147], v[132:135], 0
    s_waitcnt lgkmcnt(8)
    v_or_b32 v233, v227, v226
    v_or_b32 v234, v229, v228
    v_cvt_pkrtz_f16_f32 v210, v176, v177
    v_mfma_f32_16x16x32_bf16 v[40:43], a[72:75], v[236:239], v[40:43]
    v_pk_lshrrev_b16 v210, 3, v210 op_sel_hi:[0,1]
    v_mad_u32_u16 v211, v210, 2, s85
    v_mad_u32_u16 v210, v210, 2, s85 op_sel:[1,0,0,0]
    v_mfma_f32_16x16x32_f16 v[188:191], a[148:151], v[132:135], 0
    s_waitcnt lgkmcnt(6)
    ds_read_u16 v211, v211
    ds_read_u16_d16_hi v210, v210
    v_or_b32 v235, v231, v230
    v_mfma_f32_16x16x32_bf16 v[44:47], a[76:79], v[236:239], v[44:47]
    s_waitcnt vmcnt(1)
    ds_read_b128 a[232:235], v8 offset:0
    v_cvt_pkrtz_f16_f32 v212, v178, v179
    v_pk_lshrrev_b16 v212, 3, v212 op_sel_hi:[0,1]
    v_mfma_f32_16x16x32_f16 v[184:187], a[152:155], v[140:143], v[184:187]
    v_mad_u32_u16 v213, v212, 2, s85
    v_mad_u32_u16 v212, v212, 2, s85 op_sel:[1,0,0,0]
    v_cvt_pkrtz_f16_f32 v214, v180, v181
    v_mfma_f32_16x16x32_bf16 v[56:59], a[80:83], v[236:239], v[56:59]
    ds_read_u16 v213, v213
    ds_read_u16_d16_hi v212, v212
    v_pk_lshrrev_b16 v214, 3, v214 op_sel_hi:[0,1]
    v_mfma_f32_16x16x32_f16 v[188:191], a[156:159], v[140:143], v[188:191]
    v_mad_u32_u16 v215, v214, 2, s85
    v_mad_u32_u16 v214, v214, 2, s85 op_sel:[1,0,0,0]
    v_cvt_pkrtz_f16_f32 v216, v182, v183
    v_mfma_f32_16x16x32_bf16 v[60:63], a[84:87], v[236:239], v[60:63]
    ds_read_u16 v215, v215
    ds_read_u16_d16_hi v214, v214
    v_pk_lshrrev_b16 v216, 3, v216 op_sel_hi:[0,1]
    v_mfma_f32_16x16x32_f16 v[184:187], a[160:163], v[148:151], v[184:187]
    v_mad_u32_u16 v217, v216, 2, s85
    v_mad_u32_u16 v216, v216, 2, s85 op_sel:[1,0,0,0]
    v_mfma_f32_16x16x32_f16 v[188:191], a[164:167], v[148:151], v[188:191]
    s_waitcnt lgkmcnt(12)
    ds_read_u16 v217, v217
    ds_read_u16_d16_hi v216, v216
    v_mfma_f32_16x16x32_bf16 v[72:75], a[88:91], v[236:239], v[72:75]
    s_nop 0
    v_cvt_pkrtz_f16_f32 v218, v184, v185
    v_pk_lshrrev_b16 v218, 3, v218 op_sel_hi:[0,1]
    v_mfma_f32_16x16x32_bf16 v[76:79], a[92:95], v[236:239], v[76:79]
    s_waitcnt lgkmcnt(9)
    v_or_b32 v236, v249, v248
    v_or_b32 v237, v251, v250
    v_or_b32 v238, v253, v252
    v_mfma_f32_16x16x32_f16 v[192:195], a[0:3], v[152:155], 0
    v_cvt_pk_bf16_f32 v239, v208, v0
    v_mad_u32_u16 v219, v218, 2, s85
    v_mad_u32_u16 v218, v218, 2, s85 op_sel:[1,0,0,0]
    v_mfma_f32_16x16x32_bf16 v[32:35], a[120:123], v[232:235], v[32:35]
    ds_read_u16 v219, v219
    ds_read_u16_d16_hi v218, v218
    v_cvt_pkrtz_f16_f32 v220, v186, v187
    v_mfma_f32_16x16x32_f16 v[196:199], a[4:7], v[152:155], 0
    ds_read_b128 a[248:251], v12 offset:2560
    v_pk_lshrrev_b16 v220, 3, v220 op_sel_hi:[0,1]
    v_mad_u32_u16 v221, v220, 2, s85
    v_mfma_f32_16x16x32_bf16 v[36:39], a[124:127], v[232:235], v[36:39]
    ds_read_u16 v221, v221
    v_mad_u32_u16 v220, v220, 2, s85 op_sel:[1,0,0,0]
    v_cvt_pkrtz_f16_f32 v222, v188, v189
    v_mfma_f32_16x16x32_f16 v[192:195], a[8:11], v[160:163], v[192:195]
    ds_read_u16_d16_hi v220, v220
    v_pk_lshrrev_b16 v222, 3, v222 op_sel_hi:[0,1]
    v_mad_u32_u16 v223, v222, 2, s85
    v_mfma_f32_16x16x32_bf16 v[48:51], a[128:131], v[232:235], v[48:51]
    s_waitcnt lgkmcnt(12)
    ds_read_u16 v223, v223
    ds_read_b128 a[240:243], v15 offset:1280
    v_mad_u32_u16 v222, v222, 2, s85 op_sel:[1,0,0,0]
    v_mfma_f32_16x16x32_f16 v[196:199], a[12:15], v[160:163], v[196:199]
    s_waitcnt lgkmcnt(13)
    ds_read_u16_d16_hi v222, v222
    v_cvt_pkrtz_f16_f32 v224, v190, v191
    v_pk_lshrrev_b16 v224, 3, v224 op_sel_hi:[0,1]
    v_mfma_f32_16x16x32_bf16 v[52:55], a[132:135], v[232:235], v[52:55]
    v_mad_u32_u16 v225, v224, 2, s85
    v_mad_u32_u16 v224, v224, 2, s85 op_sel:[1,0,0,0]
    v_mfma_f32_16x16x32_f16 v[192:195], a[16:19], v[168:171], v[192:195]
    s_waitcnt lgkmcnt(12)
    ds_read_u16 v225, v225
    ds_read_u16_d16_hi v224, v224
    v_mfma_f32_16x16x32_bf16 v[64:67], a[136:139], v[232:235], v[64:67]
    v_mfma_f32_16x16x32_f16 v[196:199], a[20:23], v[168:171], v[196:199]
    v_mfma_f32_16x16x32_bf16 v[68:71], a[140:143], v[232:235], v[68:71]
    s_waitcnt lgkmcnt(13)
    ds_read_b128 a[244:247], v8 offset:2560
    v_or_b32 v232, v211, v210
    v_or_b32 v233, v213, v212
    v_mfma_f32_16x16x32_f16 v[200:203], a[0:3], v[156:159], 0
    s_waitcnt lgkmcnt(11)
    v_or_b32 v234, v215, v214
    v_or_b32 v235, v217, v216
    v_cvt_pkrtz_f16_f32 v226, v192, v193
    v_mfma_f32_16x16x32_bf16 v[40:43], a[120:123], v[236:239], v[40:43]
    ds_read_b128 a[252:255], v15 offset:3840
    v_pk_lshrrev_b16 v226, 3, v226 op_sel_hi:[0,1]
    v_cvt_pkrtz_f16_f32 v228, v194, v195
    v_mfma_f32_16x16x32_f16 v[204:207], a[4:7], v[156:159], 0
    v_cvt_pkrtz_f16_f32 v230, v196, v197
    v_cvt_pkrtz_f16_f32 v248, v198, v199
    v_mad_u32_u16 v227, v226, 2, s85
    v_mfma_f32_16x16x32_bf16 v[44:47], a[124:127], v[236:239], v[44:47]
    ds_read_u16 v227, v227
    v_mad_u32_u16 v226, v226, 2, s85 op_sel:[1,0,0,0]
    v_pk_lshrrev_b16 v228, 3, v228 op_sel_hi:[0,1]
    v_mfma_f32_16x16x32_f16 v[200:203], a[8:11], v[164:167], v[200:203]
    ds_read_u16_d16_hi v226, v226
    v_mad_u32_u16 v229, v228, 2, s85
    v_mad_u32_u16 v228, v228, 2, s85 op_sel:[1,0,0,0]
    v_mfma_f32_16x16x32_bf16 v[56:59], a[128:131], v[236:239], v[56:59]
    s_waitcnt lgkmcnt(12)
    ds_read_u16 v229, v229
    ds_read_u16_d16_hi v228, v228
    v_pk_lshrrev_b16 v230, 3, v230 op_sel_hi:[0,1]
    v_mfma_f32_16x16x32_f16 v[204:207], a[12:15], v[164:167], v[204:207]
    s_waitcnt lgkmcnt(13)
    ds_read_b128 v[136:139], v11 offset:0
    v_mad_u32_u16 v231, v230, 2, s85
    v_mad_u32_u16 v230, v230, 2, s85 op_sel:[1,0,0,0]
    v_mfma_f32_16x16x32_bf16 v[60:63], a[132:135], v[236:239], v[60:63]
    s_waitcnt lgkmcnt(12)
    ds_read_u16 v231, v231
    ds_read_u16_d16_hi v230, v230
    v_pk_lshrrev_b16 v248, 3, v248 op_sel_hi:[0,1]
    v_mfma_f32_16x16x32_f16 v[200:203], a[16:19], v[172:175], v[200:203]
    v_mad_u32_u16 v249, v248, 2, s85
    v_mad_u32_u16 v248, v248, 2, s85 op_sel:[1,0,0,0]
    v_mfma_f32_16x16x32_f16 v[204:207], a[20:23], v[172:175], v[204:207]
    s_waitcnt lgkmcnt(13)
    ds_read_u16 v249, v249
    v_mfma_f32_16x16x32_bf16 v[72:75], a[136:139], v[236:239], v[72:75]
    s_waitcnt lgkmcnt(13)
    ds_read_u16_d16_hi v248, v248
    v_mfma_f32_16x16x32_bf16 v[76:79], a[140:143], v[236:239], v[76:79]
    s_waitcnt lgkmcnt(13)
    v_or_b32 v236, v219, v218
    v_or_b32 v237, v221, v220
    v_or_b32 v238, v223, v222
    v_mfma_f32_16x16x32_f16 v[192:195], a[48:51], v[152:155], 0
    s_waitcnt lgkmcnt(11)
    ds_read_b128 a[236:239], v12 offset:0
    v_or_b32 v239, v225, v224
    v_cvt_pkrtz_f16_f32 v250, v200, v201
    v_mfma_f32_16x16x32_bf16 v[32:35], a[168:171], v[232:235], v[32:35]
    v_cvt_pkrtz_f16_f32 v252, v202, v203
    v_cvt_pkrtz_f16_f32 v0, v204, v205
    v_cvt_pkrtz_f16_f32 v209, v206, v207
    v_mfma_f32_16x16x32_f16 v[196:199], a[52:55], v[152:155], 0
    v_pk_lshrrev_b16 v250, 3, v250 op_sel_hi:[0,1]
    v_mad_u32_u16 v251, v250, 2, s85
    v_mad_u32_u16 v250, v250, 2, s85 op_sel:[1,0,0,0]
    v_mfma_f32_16x16x32_bf16 v[36:39], a[172:175], v[232:235], v[36:39]
    s_waitcnt lgkmcnt(11)
    ds_read_u16 v251, v251
    ds_read_u16_d16_hi v250, v250
    ds_read_b128 v[140:143], v15 offset:0
    v_mfma_f32_16x16x32_f16 v[192:195], a[56:59], v[160:163], v[192:195]
    v_pk_lshrrev_b16 v252, 3, v252 op_sel_hi:[0,1]
    v_mad_u32_u16 v253, v252, 2, s85
    v_mad_u32_u16 v252, v252, 2, s85 op_sel:[1,0,0,0]
    v_mfma_f32_16x16x32_bf16 v[48:51], a[176:179], v[232:235], v[48:51]
    s_waitcnt lgkmcnt(12)
    ds_read_u16 v253, v253
    ds_read_u16_d16_hi v252, v252
    v_pk_lshrrev_b16 v0, 3, v0 op_sel_hi:[0,1]
    v_mfma_f32_16x16x32_f16 v[196:199], a[60:63], v[160:163], v[196:199]
    v_mad_u32_u16 v208, v0, 2, s85
    v_mad_u32_u16 v0, v0, 2, s85 op_sel:[1,0,0,0]
    v_pk_lshrrev_b16 v209, 3, v209 op_sel_hi:[0,1]
    v_mfma_f32_16x16x32_bf16 v[52:55], a[180:183], v[232:235], v[52:55]
    s_waitcnt lgkmcnt(13)
    ds_read_u16 v208, v208
    v_mad_u32_u16 v210, v209, 2, s85
    v_mad_u32_u16 v209, v209, 2, s85 op_sel:[1,0,0,0]
    v_mfma_f32_16x16x32_f16 v[192:195], a[64:67], v[168:171], v[192:195]
    s_waitcnt lgkmcnt(12)
    ds_read_u16_d16_hi v0, v0
    v_or_b32 v240, v227, v226
    v_or_b32 v241, v229, v228
    v_mfma_f32_16x16x32_bf16 v[64:67], a[184:187], v[232:235], v[64:67]
    ds_read_u16 v210, v210
    v_cvt_pk_bf16_f32 v32, v32, v33
    v_cvt_pk_bf16_f32 v33, v34, v35
    v_mfma_f32_16x16x32_f16 v[196:199], a[68:71], v[168:171], v[196:199]
    s_waitcnt lgkmcnt(11)
    ds_read_u16_d16_hi v209, v209
    v_or_b32 v242, v231, v230
    v_cvt_pkrtz_f16_f32 v211, v192, v193
    v_mfma_f32_16x16x32_bf16 v[68:71], a[188:191], v[232:235], v[68:71]
    v_pk_lshrrev_b16 v211, 3, v211 op_sel_hi:[0,1]
    v_cvt_pkrtz_f16_f32 v213, v194, v195
    v_mad_u32_u16 v212, v211, 2, s85
    v_mfma_f32_16x16x32_f16 v[200:203], a[48:51], v[156:159], 0
    ds_read_b128 v[148:151], v11 offset:2560
    v_cvt_pkrtz_f16_f32 v215, v196, v197
    v_cvt_pkrtz_f16_f32 v217, v198, v199
    v_mfma_f32_16x16x32_bf16 v[40:43], a[168:171], v[236:239], v[40:43]
    s_waitcnt lgkmcnt(11)
    ds_read_u16 v212, v212
    v_or_b32 v243, v249, v248
    v_mad_u32_u16 v211, v211, 2, s85 op_sel:[1,0,0,0]
    v_mfma_f32_16x16x32_f16 v[204:207], a[52:55], v[156:159], 0
    ds_read_b128 v[144:147], v12 offset:1280
    v_pk_lshrrev_b16 v213, 3, v213 op_sel_hi:[0,1]
    v_mad_u32_u16 v214, v213, 2, s85
    v_mfma_f32_16x16x32_bf16 v[44:47], a[172:175], v[236:239], v[44:47]
    ds_read_u16_d16_hi v211, v211
    v_mad_u32_u16 v213, v213, 2, s85 op_sel:[1,0,0,0]
    v_pk_lshrrev_b16 v215, 3, v215 op_sel_hi:[0,1]
    v_mfma_f32_16x16x32_f16 v[200:203], a[56:59], v[164:167], v[200:203]
    s_waitcnt lgkmcnt(11)
    v_mad_u32_u16 v216, v215, 2, s85
    v_or_b32 v244, v251, v250
    v_mad_u32_u16 v215, v215, 2, s85 op_sel:[1,0,0,0]
    v_mfma_f32_16x16x32_bf16 v[56:59], a[176:179], v[236:239], v[56:59]
    ds_read_b128 v[180:183], v13 offset:0
    ds_read_u16 v214, v214
    v_pk_lshrrev_b16 v217, 3, v217 op_sel_hi:[0,1]
    v_mfma_f32_16x16x32_f16 v[204:207], a[60:63], v[164:167], v[204:207]
    v_mad_u32_u16 v218, v217, 2, s85
    v_mad_u32_u16 v217, v217, 2, s85 op_sel:[1,0,0,0]
    v_cvt_pk_bf16_f32 v34, v36, v37
    v_mfma_f32_16x16x32_bf16 v[60:63], a[180:183], v[236:239], v[60:63]
    ds_read_u16_d16_hi v213, v213
    v_cvt_pk_bf16_f32 v35, v38, v39
    v_cvt_pk_bf16_f32 v40, v40, v41
    v_mfma_f32_16x16x32_f16 v[200:203], a[64:67], v[172:175], v[200:203]
    s_waitcnt lgkmcnt(11)
    ds_read_b128 v[188:191], v9 offset:2560
    v_or_b32 v245, v253, v252
    v_cvt_pk_bf16_f32 v41, v42, v43
    v_mfma_f32_16x16x32_f16 v[204:207], a[68:71], v[172:175], v[204:207]
    v_cvt_pk_bf16_f32 v42, v44, v45
    v_cvt_pk_bf16_f32 v43, v46, v47
    v_cvt_pk_bf16_f32 v48, v48, v49
    v_mfma_f32_16x16x32_bf16 v[72:75], a[184:187], v[236:239], v[72:75]
    s_waitcnt lgkmcnt(11)
    ds_read_u16 v216, v216
    v_cvt_pkrtz_f16_f32 v219, v200, v201
    s_waitcnt lgkmcnt(11)
    v_or_b32 v246, v208, v0
    v_mfma_f32_16x16x32_bf16 v[76:79], a[188:191], v[236:239], v[76:79]
    ds_read_u16_d16_hi v215, v215
    v_cvt_pkrtz_f16_f32 v221, v202, v203
    v_cvt_pkrtz_f16_f32 v223, v204, v205
    v_mfma_f32_16x16x32_f16 v[192:195], a[96:99], v[152:155], 0
    ds_read_u16 v218, v218
    v_cvt_pkrtz_f16_f32 v225, v206, v207
    v_pk_lshrrev_b16 v219, 3, v219 op_sel_hi:[0,1]
    v_mfma_f32_16x16x32_bf16 v[80:83], a[24:27], v[240:243], v[80:83]
    s_waitcnt lgkmcnt(11)
    v_mad_u32_u16 v220, v219, 2, s85
    v_or_b32 v247, v210, v209
    v_mad_u32_u16 v219, v219, 2, s85 op_sel:[1,0,0,0]
    v_mfma_f32_16x16x32_f16 v[196:199], a[100:103], v[152:155], 0
    ds_read_u16_d16_hi v217, v217
    ds_read_u16 v220, v220
    buffer_store_dwordx4 v[40:43], v26, s[24:27], s81 offen offset:0 sc0 sc1
    v_mfma_f32_16x16x32_bf16 v[84:87], a[28:31], v[240:243], v[84:87]
    ds_read_u16_d16_hi v219, v219
    v_pk_lshrrev_b16 v221, 3, v221 op_sel_hi:[0,1]
    v_mad_u32_u16 v222, v221, 2, s85
    v_mfma_f32_16x16x32_f16 v[192:195], a[104:107], v[160:163], v[192:195]
    s_waitcnt lgkmcnt(13)
    ds_read_u16 v222, v222
    buffer_store_dwordx4 v[32:35], v26, s[24:27], s80 offen offset:0 sc0 sc1
    v_mfma_f32_16x16x32_bf16 v[96:99], a[32:35], v[240:243], v[96:99]
    v_mad_u32_u16 v221, v221, 2, s85 op_sel:[1,0,0,0]
    v_pk_lshrrev_b16 v223, 3, v223 op_sel_hi:[0,1]
    v_mad_u32_u16 v224, v223, 2, s85
    v_mfma_f32_16x16x32_f16 v[196:199], a[108:111], v[160:163], v[196:199]
    s_waitcnt lgkmcnt(12)
    ds_read_u16_d16_hi v221, v221
    ds_read_u16 v224, v224
    v_mad_u32_u16 v223, v223, 2, s85 op_sel:[1,0,0,0]
    v_mfma_f32_16x16x32_bf16 v[100:103], a[36:39], v[240:243], v[100:103]
    s_waitcnt lgkmcnt(13)
    ds_read_u16_d16_hi v223, v223
    v_pk_lshrrev_b16 v225, 3, v225 op_sel_hi:[0,1]
    v_mad_u32_u16 v226, v225, 2, s85
    v_mfma_f32_16x16x32_f16 v[192:195], a[112:115], v[168:171], v[192:195]
    s_waitcnt lgkmcnt(13)
    ds_read_u16 v226, v226
    v_mad_u32_u16 v225, v225, 2, s85 op_sel:[1,0,0,0]
    v_cvt_pk_bf16_f32 v49, v50, v51
    v_mfma_f32_16x16x32_bf16 v[112:115], a[40:43], v[240:243], v[112:115]
    s_waitcnt lgkmcnt(13)
    ds_read_u16_d16_hi v225, v225
    v_cvt_pk_bf16_f32 v50, v52, v53
    v_cvt_pk_bf16_f32 v51, v54, v55
    v_mfma_f32_16x16x32_f16 v[196:199], a[116:119], v[168:171], v[196:199]
    v_cvt_pk_bf16_f32 v56, v56, v57
    v_cvt_pk_bf16_f32 v57, v58, v59
    v_cvt_pk_bf16_f32 v58, v60, v61
    v_mfma_f32_16x16x32_bf16 v[116:119], a[44:47], v[240:243], v[116:119]
    s_waitcnt lgkmcnt(13)
    ds_read_b128 v[232:235], v13 offset:2560
    v_cvt_pk_bf16_f32 v59, v62, v63
    v_cvt_pk_bf16_f32 v64, v64, v65
    v_mfma_f32_16x16x32_f16 v[200:203], a[96:99], v[156:159], 0
    s_waitcnt lgkmcnt(12)
    buffer_store_dwordx4 v[56:59], v26, s[24:27], s81 offen offset:64 sc0 sc1
    ds_read_b128 v[32:35], v10 offset:0
    buffer_store_dwordx4 v[48:51], v26, s[24:27], s80 offen offset:64 sc0 sc1
    ds_read_b128 v[176:179], v9 offset:0
    v_mfma_f32_16x16x32_bf16 v[88:91], a[24:27], v[244:247], v[88:91]
    v_cvt_pk_bf16_f32 v65, v66, v67
    v_cvt_pk_bf16_f32 v66, v68, v69
    v_cvt_pk_bf16_f32 v67, v70, v71
    v_mfma_f32_16x16x32_f16 v[204:207], a[100:103], v[156:159], 0
    v_cvt_pk_bf16_f32 v72, v72, v73
    v_cvt_pk_bf16_f32 v73, v74, v75
    v_cvt_pk_bf16_f32 v74, v76, v77
    v_mfma_f32_16x16x32_bf16 v[92:95], a[28:31], v[244:247], v[92:95]
    v_cvt_pk_bf16_f32 v75, v78, v79
    v_or_b32 v240, v212, v211
    v_or_b32 v241, v214, v213
    v_mfma_f32_16x16x32_f16 v[200:203], a[104:107], v[164:167], v[200:203]
    s_waitcnt lgkmcnt(11)
    ds_read_b128 v[184:187], v14 offset:1280
    v_or_b32 v242, v216, v215
    v_or_b32 v243, v218, v217
    v_mfma_f32_16x16x32_bf16 v[104:107], a[32:35], v[244:247], v[104:107]
    ds_read_b128 v[44:47], v10 offset:2560
    v_cvt_pkrtz_f16_f32 v227, v192, v193
    v_pk_lshrrev_b16 v227, 3, v227 op_sel_hi:[0,1]
    v_mfma_f32_16x16x32_f16 v[204:207], a[108:111], v[164:167], v[204:207]
    ds_read_b128 v[36:39], v14 offset:0
    v_cvt_pkrtz_f16_f32 v229, v194, v195
    v_cvt_pkrtz_f16_f32 v231, v196, v197
    v_mfma_f32_16x16x32_bf16 v[108:111], a[36:39], v[244:247], v[108:111]
    v_cvt_pkrtz_f16_f32 v249, v198, v199
    v_mad_u32_u16 v228, v227, 2, s85
    v_mad_u32_u16 v227, v227, 2, s85 op_sel:[1,0,0,0]
    v_mfma_f32_16x16x32_f16 v[200:203], a[112:115], v[172:175], v[200:203]
    s_waitcnt lgkmcnt(12)
    ds_read_u16 v228, v228
    ds_read_u16_d16_hi v227, v227
    v_pk_lshrrev_b16 v229, 3, v229 op_sel_hi:[0,1]
    v_mfma_f32_16x16x32_f16 v[204:207], a[116:119], v[172:175], v[204:207]
    buffer_store_dwordx4 v[72:75], v26, s[24:27], s81 offen offset:128 sc0 sc1
    v_mfma_f32_16x16x32_bf16 v[120:123], a[40:43], v[244:247], v[120:123]
    v_mad_u32_u16 v230, v229, 2, s85
    v_mad_u32_u16 v229, v229, 2, s85 op_sel:[1,0,0,0]
    v_cvt_pkrtz_f16_f32 v251, v200, v201
    v_mfma_f32_16x16x32_bf16 v[124:127], a[44:47], v[244:247], v[124:127]
    s_waitcnt lgkmcnt(12)
    ds_read_u16 v230, v230
    ds_read_u16_d16_hi v229, v229
    v_or_b32 v244, v220, v219
    v_mfma_f32_16x16x32_f16 v[192:195], a[144:147], v[152:155], 0
    s_waitcnt lgkmcnt(12)
    ds_read_b128 v[56:59], v20 offset:2560
    v_or_b32 v245, v222, v221
    v_or_b32 v246, v224, v223
    v_mfma_f32_16x16x32_bf16 v[80:83], a[72:75], v[240:243], v[80:83]
    s_waitcnt lgkmcnt(11)
    v_or_b32 v247, v226, v225
    v_cvt_pkrtz_f16_f32 v253, v202, v203
    v_cvt_pkrtz_f16_f32 v208, v204, v205
    v_mfma_f32_16x16x32_f16 v[196:199], a[148:151], v[152:155], 0
    ds_read_b128 v[60:63], v21 offset:2560
    v_cvt_pkrtz_f16_f32 v210, v206, v207
    v_pk_lshrrev_b16 v231, 3, v231 op_sel_hi:[0,1]
    v_mfma_f32_16x16x32_bf16 v[84:87], a[76:79], v[240:243], v[84:87]
    buffer_store_dwordx4 v[64:67], v26, s[24:27], s80 offen offset:128 sc0 sc1
    v_mfma_f32_16x16x32_f16 v[192:195], a[152:155], v[160:163], v[192:195]
    ds_read_b128 v[52:55], v21 offset:0
    v_mad_u32_u16 v248, v231, 2, s85
    v_mad_u32_u16 v231, v231, 2, s85 op_sel:[1,0,0,0]
    v_mfma_f32_16x16x32_bf16 v[96:99], a[80:83], v[240:243], v[96:99]
    s_waitcnt lgkmcnt(12)
    ds_read_u16 v248, v248
    ds_read_u16_d16_hi v231, v231
    v_pk_lshrrev_b16 v249, 3, v249 op_sel_hi:[0,1]
    v_mfma_f32_16x16x32_f16 v[196:199], a[156:159], v[160:163], v[196:199]
    s_waitcnt lgkmcnt(11)
    ds_read_b128 v[236:239], v14 offset:3840
    ds_read_b128 v[48:51], v20 offset:0
    ds_read_b128 v[40:43], v13 offset:1280
    v_mfma_f32_16x16x32_bf16 v[100:103], a[84:87], v[240:243], v[100:103]
    v_mad_u32_u16 v250, v249, 2, s85
    v_mad_u32_u16 v249, v249, 2, s85 op_sel:[1,0,0,0]
    v_pk_lshrrev_b16 v251, 3, v251 op_sel_hi:[0,1]
    v_mfma_f32_16x16x32_f16 v[192:195], a[160:163], v[168:171], v[192:195]
    s_waitcnt lgkmcnt(12)
    ds_read_u16 v250, v250
    ds_read_u16_d16_hi v249, v249
    v_mad_u32_u16 v252, v251, 2, s85
    v_mfma_f32_16x16x32_bf16 v[112:115], a[88:91], v[240:243], v[112:115]
    s_waitcnt lgkmcnt(13)
    ds_read_u16 v252, v252
    v_mad_u32_u16 v251, v251, 2, s85 op_sel:[1,0,0,0]
    v_pk_lshrrev_b16 v253, 3, v253 op_sel_hi:[0,1]
    v_mfma_f32_16x16x32_f16 v[196:199], a[164:167], v[168:171], v[196:199]
    s_waitcnt lgkmcnt(12)
    ds_read_u16_d16_hi v251, v251
    ds_read_b128 v[64:67], v14 offset:2560
    v_mad_u32_u16 v0, v253, 2, s85
    v_mfma_f32_16x16x32_bf16 v[116:119], a[92:95], v[240:243], v[116:119]
    s_waitcnt lgkmcnt(13)
    ds_read_u16 v0, v0
    v_mad_u32_u16 v253, v253, 2, s85 op_sel:[1,0,0,0]
    v_pk_lshrrev_b16 v208, 3, v208 op_sel_hi:[0,1]
    v_mfma_f32_16x16x32_f16 v[200:203], a[144:147], v[156:159], 0
    s_waitcnt lgkmcnt(13)
    ds_read_u16_d16_hi v253, v253
    v_mad_u32_u16 v209, v208, 2, s85
    v_mad_u32_u16 v208, v208, 2, s85 op_sel:[1,0,0,0]
    v_mfma_f32_16x16x32_bf16 v[88:91], a[72:75], v[244:247], v[88:91]
    v_pk_lshrrev_b16 v210, 3, v210 op_sel_hi:[0,1]
    v_mad_u32_u16 v211, v210, 2, s85
    v_mad_u32_u16 v210, v210, 2, s85 op_sel:[1,0,0,0]
    v_mfma_f32_16x16x32_f16 v[204:207], a[148:151], v[156:159], 0
    s_waitcnt lgkmcnt(13)
    ds_read_u16 v209, v209
    v_or_b32 v240, v228, v227
    v_or_b32 v241, v230, v229
    v_mfma_f32_16x16x32_bf16 v[92:95], a[76:79], v[244:247], v[92:95]
    s_waitcnt lgkmcnt(11)
    ds_read_u16_d16_hi v208, v208
    ds_read_u16 v211, v211
    v_or_b32 v242, v248, v231
    v_mfma_f32_16x16x32_f16 v[200:203], a[152:155], v[164:167], v[200:203]
    ds_read_u16_d16_hi v210, v210
    v_cvt_pkrtz_f16_f32 v212, v192, v193
    v_pk_lshrrev_b16 v212, 3, v212 op_sel_hi:[0,1]
    v_mfma_f32_16x16x32_bf16 v[104:107], a[80:83], v[244:247], v[104:107]
    s_waitcnt lgkmcnt(13)
    ds_read_b128 v[68:71], v13 offset:3840
    v_cvt_pkrtz_f16_f32 v214, v194, v195
    v_cvt_pkrtz_f16_f32 v216, v196, v197
    v_mfma_f32_16x16x32_f16 v[204:207], a[156:159], v[164:167], v[204:207]
    v_cvt_pkrtz_f16_f32 v218, v198, v199
    v_mad_u32_u16 v213, v212, 2, s85
    v_mad_u32_u16 v212, v212, 2, s85 op_sel:[1,0,0,0]
    v_mfma_f32_16x16x32_bf16 v[108:111], a[84:87], v[244:247], v[108:111]
    s_waitcnt lgkmcnt(13)
    ds_read_b128 v[72:75], v15 offset:2560
    v_pk_lshrrev_b16 v214, 3, v214 op_sel_hi:[0,1]
    v_mad_u32_u16 v215, v214, 2, s85
    v_mfma_f32_16x16x32_f16 v[200:203], a[160:163], v[172:175], v[200:203]
    s_waitcnt lgkmcnt(11)
    ds_read_b128 v[76:79], v12 offset:3840
    v_or_b32 v243, v250, v249
    v_mad_u32_u16 v214, v214, 2, s85 op_sel:[1,0,0,0]
    v_mfma_f32_16x16x32_f16 v[204:207], a[164:167], v[172:175], v[204:207]
    ds_read_u16 v213, v213
    v_pk_lshrrev_b16 v216, 3, v216 op_sel_hi:[0,1]
    v_mad_u32_u16 v217, v216, 2, s85
    v_mfma_f32_16x16x32_bf16 v[120:123], a[88:91], v[244:247], v[120:123]
    v_cvt_pkrtz_f16_f32 v220, v200, v201
    v_cvt_pkrtz_f16_f32 v222, v202, v203
    v_mad_u32_u16 v216, v216, 2, s85 op_sel:[1,0,0,0]
    v_mfma_f32_16x16x32_bf16 v[124:127], a[92:95], v[244:247], v[124:127]
    s_waitcnt lgkmcnt(11)
    ds_read_u16_d16_hi v212, v212
    ds_read_u16 v215, v215
    v_or_b32 v244, v252, v251
    v_mfma_f32_16x16x32_bf16 v[80:83], a[120:123], v[240:243], v[80:83]
    v_cvt_pkrtz_f16_f32 v224, v204, v205
    v_cvt_pkrtz_f16_f32 v226, v206, v207
    v_pk_lshrrev_b16 v218, 3, v218 op_sel_hi:[0,1]
    v_mfma_f32_16x16x32_bf16 v[84:87], a[124:127], v[240:243], v[84:87]
    s_add_u32 m0, s56, -128
    ds_read_u16_d16_hi v214, v214
    v_mad_u32_u16 v219, v218, 2, s85
    v_mad_u32_u16 v218, v218, 2, s85 op_sel:[1,0,0,0]
    v_mfma_f32_16x16x32_bf16 v[96:99], a[128:131], v[240:243], v[96:99]
    s_waitcnt lgkmcnt(11)
    ds_read_u16 v217, v217
    v_or_b32 v245, v0, v253
    v_pk_lshrrev_b16 v220, 3, v220 op_sel_hi:[0,1]
    v_mfma_f32_16x16x32_bf16 v[100:103], a[132:135], v[240:243], v[100:103]
    v_mad_u32_u16 v221, v220, 2, s85
    v_mad_u32_u16 v220, v220, 2, s85 op_sel:[1,0,0,0]
    v_pk_lshrrev_b16 v222, 3, v222 op_sel_hi:[0,1]
    v_mfma_f32_16x16x32_bf16 v[112:115], a[136:139], v[240:243], v[112:115]
    s_waitcnt lgkmcnt(11)
    ds_read_u16_d16_hi v216, v216
    v_mad_u32_u16 v223, v222, 2, s85
    s_waitcnt lgkmcnt(11)
    v_or_b32 v246, v209, v208
    v_mfma_f32_16x16x32_bf16 v[116:119], a[140:143], v[240:243], v[116:119]
    ds_read_u16 v219, v219
    v_mad_u32_u16 v222, v222, 2, s85 op_sel:[1,0,0,0]
    v_pk_lshrrev_b16 v224, 3, v224 op_sel_hi:[0,1]
    v_mad_u32_u16 v225, v224, 2, s85
    v_mad_u32_u16 v224, v224, 2, s85 op_sel:[1,0,0,0]
    v_pk_lshrrev_b16 v226, 3, v226 op_sel_hi:[0,1]
    v_mad_u32_u16 v227, v226, 2, s85
    v_mad_u32_u16 v226, v226, 2, s85 op_sel:[1,0,0,0]
    ds_read_u16_d16_hi v218, v218
    s_waitcnt lgkmcnt(11)
    v_or_b32 v247, v211, v210
    s_nop 1
    v_mfma_f32_16x16x32_bf16 v[88:91], a[120:123], v[244:247], v[88:91]
    ds_read_u16 v221, v221
    ds_read_u16_d16_hi v220, v220
    v_mfma_f32_16x16x32_bf16 v[92:95], a[124:127], v[244:247], v[92:95]
    ds_read_u16 v223, v223
    v_mfma_f32_16x16x32_bf16 v[104:107], a[128:131], v[244:247], v[104:107]
    s_waitcnt lgkmcnt(11)
    ds_read_u16_d16_hi v222, v222
    buffer_load_dwordx4 v1, s[20:23], 0 offen offset:128 lds
    s_add_u32 m0, s56, 896
    v_mfma_f32_16x16x32_bf16 v[108:111], a[132:135], v[244:247], v[108:111]
    s_waitcnt lgkmcnt(11)
    ds_read_u16 v225, v225
    buffer_load_dwordx4 v2, s[20:23], 0 offen offset:128 lds
    s_add_u32 m0, s56, 1920
    ds_read_u16_d16_hi v224, v224
    buffer_load_dwordx4 v3, s[20:23], 0 offen offset:128 lds
    v_mfma_f32_16x16x32_bf16 v[120:123], a[136:139], v[244:247], v[120:123]
    s_add_u32 m0, s56, 2944
    s_waitcnt lgkmcnt(12)
    v_or_b32 v240, v213, v212
    v_mfma_f32_16x16x32_bf16 v[124:127], a[140:143], v[244:247], v[124:127]
    s_waitcnt lgkmcnt(9)
    ds_read_u16 v227, v227
    buffer_load_dwordx4 v4, s[20:23], 0 offen offset:128 lds
    ds_read_u16_d16_hi v226, v226
    v_or_b32 v241, v215, v214
    s_add_u32 m0, s56, 3968
    s_nop 0
    buffer_load_dwordx4 v5, s[20:23], 0 offen offset:128 lds
    ds_read_b128 v[192:195], v22 offset:0
    s_add_u32 m0, s56, 4992
    s_nop 0
    buffer_load_dwordx4 v6, s[20:23], 0 offen offset:128 lds
    s_waitcnt lgkmcnt(11)
    v_or_b32 v242, v217, v216
    s_add_u32 m0, s56, 6016
    ds_read_b128 v[196:199], v22 offset:256
    buffer_load_dword v7, s[20:23], 0 offen offset:128 lds
    ds_read_b128 v[204:207], v22 offset:272
    s_waitcnt lgkmcnt(11)
    v_or_b32 v243, v219, v218
    s_nop 1
    v_mfma_f32_16x16x32_bf16 v[80:83], a[168:171], v[240:243], v[80:83]
    v_mfma_f32_16x16x32_bf16 v[84:87], a[172:175], v[240:243], v[84:87]
    v_mfma_f32_16x16x32_bf16 v[96:99], a[176:179], v[240:243], v[96:99]
    s_waitcnt lgkmcnt(9)
    ds_read_b128 v[200:203], v22 offset:16
    v_or_b32 v244, v221, v220
    v_mfma_f32_16x16x32_bf16 v[100:103], a[180:183], v[240:243], v[100:103]
    v_mfma_f32_16x16x32_bf16 v[112:115], a[184:187], v[240:243], v[112:115]
    s_waitcnt lgkmcnt(9)
    v_mfma_f32_16x16x32_bf16 v[116:119], a[188:191], v[240:243], v[116:119]
    s_add_u32 s52, s52, 1
    s_cmp_eq_u32 s52, 4
    s_waitcnt lgkmcnt(8)
    v_or_b32 v245, v223, v222
    s_waitcnt lgkmcnt(6)
    v_or_b32 v246, v225, v224
    s_waitcnt lgkmcnt(4)
    v_or_b32 v247, v227, v226
    s_cbranch_scc0 L_conv
L_final:
    s_nop 0
    v_mfma_f32_16x16x32_bf16 v[88:91], a[168:171], v[244:247], v[88:91]
    v_cvt_pk_bf16_f32 v80, v80, v81
    v_cvt_pk_bf16_f32 v81, v82, v83
    v_cvt_pk_bf16_f32 v82, v84, v85
    v_mfma_f32_16x16x32_bf16 v[92:95], a[172:175], v[244:247], v[92:95]
    v_cvt_pk_bf16_f32 v83, v86, v87
    v_cvt_pk_bf16_f32 v96, v96, v97
    v_cvt_pk_bf16_f32 v97, v98, v99
    v_mfma_f32_16x16x32_bf16 v[104:107], a[176:179], v[244:247], v[104:107]
    buffer_store_dwordx4 v[80:83], v26, s[24:27], s82 offen offset:0 sc0 sc1
    v_mfma_f32_16x16x32_bf16 v[108:111], a[180:183], v[244:247], v[108:111]
    v_cvt_pk_bf16_f32 v98, v100, v101
    v_cvt_pk_bf16_f32 v99, v102, v103
    v_cvt_pk_bf16_f32 v112, v112, v113
    v_mfma_f32_16x16x32_bf16 v[120:123], a[184:187], v[244:247], v[120:123]
    buffer_store_dwordx4 v[96:99], v26, s[24:27], s82 offen offset:64 sc0 sc1
    v_mfma_f32_16x16x32_bf16 v[124:127], a[188:191], v[244:247], v[124:127]
    v_cvt_pk_bf16_f32 v113, v114, v115
    v_cvt_pk_bf16_f32 v114, v116, v117
    v_cvt_pk_bf16_f32 v115, v118, v119
    v_cvt_pk_bf16_f32 v88, v88, v89
    v_cvt_pk_bf16_f32 v89, v90, v91
    v_cvt_pk_bf16_f32 v90, v92, v93
    v_cvt_pk_bf16_f32 v91, v94, v95
    v_cvt_pk_bf16_f32 v104, v104, v105
    v_cvt_pk_bf16_f32 v105, v106, v107
    v_cvt_pk_bf16_f32 v106, v108, v109
    v_cvt_pk_bf16_f32 v107, v110, v111
    v_cvt_pk_bf16_f32 v120, v120, v121
    v_cvt_pk_bf16_f32 v121, v122, v123
    v_cvt_pk_bf16_f32 v122, v124, v125
    v_cvt_pk_bf16_f32 v123, v126, v127
    buffer_store_dwordx4 v[112:115], v26, s[24:27], s82 offen offset:128 sc0 sc1
    buffer_store_dwordx4 v[88:91], v26, s[24:27], s83 offen offset:0 sc0 sc1
    buffer_store_dwordx4 v[104:107], v26, s[24:27], s83 offen offset:64 sc0 sc1
    buffer_store_dwordx4 v[120:123], v26, s[24:27], s83 offen offset:128 sc0 sc1
L_end:
L_last:
    s_endpgm
.section .rodata,"a"
.p2align 6
.amdhsa_kernel standalone__modern_conv_block_convnext__vision_kernel
  .amdhsa_next_free_vgpr 512
  .amdhsa_next_free_sgpr 102
  .amdhsa_accum_offset 256
  .amdhsa_group_segment_fixed_size 0
  .amdhsa_kernarg_size 80
  .amdhsa_user_sgpr_count 2
  .amdhsa_user_sgpr_kernarg_segment_ptr 1
  .amdhsa_system_sgpr_workgroup_id_x 1
.end_amdhsa_kernel
```

```asm
; @launch grid=(256,1,1) block=(256,1,1) lds=163840
.amdgcn_target "amdgcn-amd-amdhsa--gfx950"
.text
.globl standalone__modern_conv_block_convnext__vision_kernel
.p2align 8
.type standalone__modern_conv_block_convnext__vision_kernel,@function
standalone__modern_conv_block_convnext__vision_kernel:
    s_cmp_ge_u32 s2, 256
    s_cbranch_scc1 L_end
    s_load_dwordx16 s[4:19], s[0:1], 0
    v_readfirstlane_b32 s3, v0
    v_and_b32 v129, 63, v0
    s_and_b32 s60, s2, 7
    s_lshr_b32 s61, s2, 7
    s_lshl1_add_u32 s60, s60, s61
    s_lshr_b32 s3, s3, 6
    s_getpc_b64 s[62:63]
L_pc:
    v_min_u32 v18, 2, v129
    s_lshr_b32 s71, s2, 3
    s_lshl2_add_u32 s71, s71, s3
    v_mad_u32_u24 v18, s71, 3, v18
    v_min_u32 v18, (L_last-L_pc)/128, v18
    v_lshlrev_b32 v18, 1, v18
    v_mad_u64_u32 v[18:19], vcc, v18, 64, s[62:63]
    global_load_dword v251, v[18:19], off
    s_bfe_u32 s61, s2, 0x40003
    s_lshl2_add_u32 s55, s61, s3
    s_mul_i32 s60, s60, 3145728
    s_mul_i32 s61, s55, 1536
    s_add_u32 s63, s60, s61
    s_sub_u32 s64, s63, 98496
    s_movk_i32 s65, 0
    s_movk_i32 s66, 2048
    s_cmp_eq_u32 s55, 0
    s_cmovk_i32 s65, 100
    s_cmovk_i32 s66, 1948
    s_cmp_eq_u32 s55, 63
    s_cmovk_i32 s66, 1800
    s_mul_i32 s56, s3, 12800
    s_add_u32 s56, s56, 90112
    s_mov_b32 s68, 96384
    v_lshrrev_b32 v131, 2, v129
    v_mul_u32_u24 v130, 205, v131
    v_mul_u32_u24 v131, 192, v131
    v_add_u32 v131, s64, v131
    v_lshlrev_b32 v132, 4, v0
    v_and_b32 v133, 16, v0
    v_bitop3_b32 v132, v132, v133, 48 bitop3:0x28
    v_bfrev_b32 v136, 1
    s_waitcnt lgkmcnt(0)
    s_mov_b32 s20, s4
    s_mov_b32 s21, s5
    s_mov_b32 s22, 50331648
    s_mov_b32 s23, 0x20000
    s_mulk_i32 s71, 640
    v_lshlrev_b32 v141, 7, v129
    v_cmp_gt_u32 vcc, 5, v129
    s_nop 1
    v_cndmask_b32 v141, v136, v141, vcc
    s_mov_b32 s44, s8
    s_mov_b32 s45, s9
    s_mov_b32 s46, 73728
    s_mov_b32 s47, 0x20000
    s_mov_b32 s48, s12
    s_mov_b32 s49, s13
    s_mov_b32 s50, 73728
    s_mov_b32 s51, 0x20000
    buffer_load_dword v142, v141, s[44:47], s71 offen
    buffer_load_dword v143, v141, s[48:51], s71 offen
    v_lshrrev_b32 v138, 5, v129
    s_movk_i32 s69, 192
    v_mul_u32_u24 v139, 1366, v0
    v_lshrrev_b32 v139, 16, v139
    v_mul_u32_u24 v139, 384, v139
    v_lshl_add_u32 v139, v0, 2, v139
    v_lshlrev_b32 v140, 3, v0
    s_mov_b32 s28, s6
    s_mov_b32 s29, s7
    s_mov_b32 s30, 1728
    s_mov_b32 s31, 0x20000
    s_mov_b32 s36, s14
    s_mov_b32 s37, s15
    s_mov_b32 s38, 192
    s_mov_b32 s39, 0x20000
    s_mov_b32 s40, s16
    s_mov_b32 s41, s17
    s_mov_b32 s42, 192
    s_mov_b32 s43, 0x20000
    s_mov_b32 s32, s10
    s_mov_b32 s33, s11
    s_mov_b32 s34, 768
    s_mov_b32 s35, 0x20000
    buffer_load_dword v144, v139, s[28:31], 0 offen
    buffer_load_dword v145, v139, s[28:31], 0 offen offset:192
    buffer_load_dword v146, v139, s[28:31], 0 offen offset:384
    buffer_load_dwordx2 v[148:149], v140, s[36:39], 0 offen
    buffer_load_dwordx2 v[150:151], v140, s[40:43], 0 offen
    s_cmp_ge_u32 s3, 2
    s_cbranch_scc1 L_prep1
L_prep0:
    v_bfe_u32 v158, v129, 2, 1
    v_bfe_u32 v159, v129, 3, 2
    v_lshl_add_u32 v159, v158, 2, v159
    v_and_b32 v160, 3, v129
    v_lshl_add_u32 v236, v138, 2, v160
    s_lshl_b32 s60, s3, 7
    v_lshl_add_u32 v236, v236, 4, s60
    v_mul_u32_u24 v159, 768, v159
    v_add_u32 v232, v159, v236
    v_add_u32 v233, 6144, v232
    v_and_b32 v159, 0x1c, v129
    v_cmp_eq_u32 vcc, 0x1c, v159
    s_mov_b32 s72, 72960
    s_mul_i32 s60, s3, 24576
    s_add_u32 s60, s60, 40960
    v_cndmask_b32 v237, v136, v236, vcc
    v_lshl_add_u32 v234, v129, 4, s60
    s_lshl_b32 s60, s3, 12
    s_add_u32 s60, s60, 40960
    v_mov_b32 v238, s60
    buffer_load_dwordx4 v[176:179], v236, s[44:47], s72 offen offset:0
    buffer_load_dwordx4 a[232:235], v237, s[32:35], 0 offen offset:0
    buffer_load_dwordx4 v[180:183], v236, s[44:47], s72 offen offset:256
    buffer_load_dwordx4 a[236:239], v237, s[32:35], 0 offen offset:256
    buffer_load_dwordx4 v[184:187], v236, s[44:47], s72 offen offset:512
    buffer_load_dwordx4 a[240:243], v237, s[32:35], 0 offen offset:512
    s_mov_b32 m0, s56
    s_movk_i32 s70, 5
L_xl0:
    v_lshrrev_b32 v134, 11, v130
    v_subrev_u32 v135, s65, v130
    v_mad_u32_u24 v134, v134, s68, v131
    v_and_b32 v135, 0x7ff, v135
    v_cmp_gt_u32 vcc, s66, v135
    v_lshrrev_b32 v135, 7, v130
    v_and_b32 v135, 32, v135
    v_xad_u32 v134, v132, v135, v134
    v_cndmask_b32 v134, v136, v134, vcc
    v_add_u32 v130, 3280, v130
    v_add_u32 v131, 3072, v131
    buffer_load_dwordx4 v134, s[20:23], 0 offen lds
    s_add_u32 m0, m0, 1024
    s_sub_u32 s70, s70, 1
    s_cbranch_scc0 L_xl0
    s_branch L_prb0
L_prep1:
    v_bfe_u32 v158, v129, 2, 1
    v_bfe_u32 v159, v129, 3, 2
    v_lshl_add_u32 v159, v158, 2, v159
    v_and_b32 v160, 3, v129
    v_lshl_add_u32 v159, v138, 4, v159
    s_lshl_b32 s60, s3, 6
    s_sub_u32 s60, s60, 128
    v_add_u32 v159, s60, v159
    v_xor_b32 v236, v138, v160
    v_lshlrev_b32 v236, 4, v236
    v_mad_u32_u24 v232, v159, s69, v236
    s_lshl_b32 s60, s3, 1
    s_sub_u32 s60, s60, 4
    v_add_u32 v159, s60, v158
    v_lshlrev_b32 v238, 11, v159
    v_add_u32 v238, 43008, v238
    v_mul_u32_u24 v159, 768, v159
    v_lshl_add_u32 v159, v158, 2, v159
    v_add_u32 v159, v160, v159
    v_bfe_u32 v160, v129, 3, 1
    v_lshl_add_u32 v159, v160, 6, v159
    v_lshrrev_b32 v160, 4, v129
    v_lshl_add_u32 v159, v160, 4, v159
    v_lshlrev_b32 v159, 4, v159
    v_add_u32 v234, 40960, v159
    v_xor_b32 v235, 64, v234
    buffer_load_dwordx4 v[208:211], v236, s[40:43], 0 offen offset:0
    buffer_load_dwordx4 v[212:215], v236, s[40:43], 0 offen offset:64
    buffer_load_dwordx4 v[216:219], v236, s[40:43], 0 offen offset:128
    s_mov_b32 m0, s56
    s_movk_i32 s70, 5
L_xl1:
    v_lshrrev_b32 v134, 11, v130
    v_subrev_u32 v135, s65, v130
    v_mad_u32_u24 v134, v134, s68, v131
    v_and_b32 v135, 0x7ff, v135
    v_cmp_gt_u32 vcc, s66, v135
    v_lshrrev_b32 v135, 7, v130
    v_and_b32 v135, 32, v135
    v_xad_u32 v134, v132, v135, v134
    v_cndmask_b32 v134, v136, v134, vcc
    v_add_u32 v130, 3280, v130
    v_add_u32 v131, 3072, v131
    buffer_load_dwordx4 v134, s[20:23], 0 offen lds
    s_add_u32 m0, m0, 1024
    s_sub_u32 s70, s70, 1
    s_cbranch_scc0 L_xl1
L_prb1:
    v_lshrrev_b32 v131, 4, v129
    v_add_u32 v131, 96, v131
    v_mul_u32_u24 v130, 205, v131
    v_mul_u32_u24 v131, 192, v131
    v_add_u32 v131, s64, v131
    v_lshlrev_b32 v133, 2, v129
    v_and_b32 v133, 63, v133
    v_lshrrev_b32 v134, 11, v130
    v_subrev_u32 v135, s65, v130
    v_mad_u32_u24 v134, v134, s68, v131
    v_and_b32 v135, 0x7ff, v135
    v_cmp_gt_u32 vcc, s66, v135
    v_lshrrev_b32 v135, 7, v130
    v_and_b32 v135, 32, v135
    v_xad_u32 v134, v133, v135, v134
    v_cndmask_b32 v7, v136, v134, vcc
    s_add_u32 m0, s56, 6144
    s_nop 0
    buffer_load_dword v7, s[20:23], 0 offen offset:0 lds
    v_lshrrev_b32 v131, 2, v129
    v_mul_u32_u24 v130, 205, v131
    v_mul_u32_u24 v131, 192, v131
    v_add_u32 v131, s64, v131
    v_lshrrev_b32 v134, 11, v130
    v_subrev_u32 v135, s65, v130
    v_mad_u32_u24 v134, v134, s68, v131
    v_and_b32 v135, 0x7ff, v135
    v_cmp_gt_u32 vcc, s66, v135
    v_lshrrev_b32 v135, 7, v130
    v_and_b32 v135, 32, v135
    v_xad_u32 v134, v132, v135, v134
    v_cndmask_b32 v1, v136, v134, vcc
    v_add_u32 v130, 3280, v130
    v_add_u32 v131, 3072, v131
    v_lshrrev_b32 v134, 11, v130
    v_subrev_u32 v135, s65, v130
    v_mad_u32_u24 v134, v134, s68, v131
    v_and_b32 v135, 0x7ff, v135
    v_cmp_gt_u32 vcc, s66, v135
    v_lshrrev_b32 v135, 7, v130
    v_and_b32 v135, 32, v135
    v_xad_u32 v134, v132, v135, v134
    v_cndmask_b32 v2, v136, v134, vcc
    v_add_u32 v130, 3280, v130
    v_add_u32 v131, 3072, v131
    v_lshrrev_b32 v134, 11, v130
    v_subrev_u32 v135, s65, v130
    v_mad_u32_u24 v134, v134, s68, v131
    v_and_b32 v135, 0x7ff, v135
    v_cmp_gt_u32 vcc, s66, v135
    v_lshrrev_b32 v135, 7, v130
    v_and_b32 v135, 32, v135
    v_xad_u32 v134, v132, v135, v134
    v_cndmask_b32 v3, v136, v134, vcc
    v_add_u32 v130, 3280, v130
    v_add_u32 v131, 3072, v131
    v_lshrrev_b32 v134, 11, v130
    v_subrev_u32 v135, s65, v130
    v_mad_u32_u24 v134, v134, s68, v131
    v_and_b32 v135, 0x7ff, v135
    v_cmp_gt_u32 vcc, s66, v135
    v_lshrrev_b32 v135, 7, v130
    v_and_b32 v135, 32, v135
    v_xad_u32 v134, v132, v135, v134
    v_cndmask_b32 v4, v136, v134, vcc
    v_add_u32 v130, 3280, v130
    v_add_u32 v131, 3072, v131
    v_lshrrev_b32 v134, 11, v130
    v_subrev_u32 v135, s65, v130
    v_mad_u32_u24 v134, v134, s68, v131
    v_and_b32 v135, 0x7ff, v135
    v_cmp_gt_u32 vcc, s66, v135
    v_lshrrev_b32 v135, 7, v130
    v_and_b32 v135, 32, v135
    v_xad_u32 v134, v132, v135, v134
    v_cndmask_b32 v5, v136, v134, vcc
    v_add_u32 v130, 3280, v130
    v_add_u32 v131, 3072, v131
    v_lshrrev_b32 v134, 11, v130
    v_subrev_u32 v135, s65, v130
    v_mad_u32_u24 v134, v134, s68, v131
    v_and_b32 v135, 0x7ff, v135
    v_cmp_gt_u32 vcc, s66, v135
    v_lshrrev_b32 v135, 7, v130
    v_and_b32 v135, 32, v135
    v_xad_u32 v134, v132, v135, v134
    v_cndmask_b32 v6, v136, v134, vcc
    s_cmp_lt_u32 s55, 63
    s_cselect_b32 s66, 10, 0
    s_add_u32 s64, s64, 1856
    v_mul_u32_u24 v134, 98304, v129
    v_add_u32 v134, s64, v134
    v_cmp_gt_u32 vcc, s66, v129
    s_nop 1
    v_cndmask_b32 v31, v136, v134, vcc
    v_mov_b32 v157, 268435456
    v_and_b32 v152, 15, v129
    v_lshrrev_b32 v153, 4, v129
    v_add_u32 v154, 4, v152
    v_lshrrev_b32 v154, 3, v154
    v_mad_i32_i24 v155, v154, -4, v152
    v_and_b32 v154, 1, v154
    v_and_b32 v156, 1, v153
    v_lshlrev_b32 v158, 1, v154
    v_mul_u32_u24 v159, 98304, v158
    v_mad_u32_u24 v159, v155, s69, v159
    v_lshl_add_u32 v159, v153, 4, v159
    v_add_u32 v26, s63, v159
    v_xor_b32 v26, 0x80000000, v26
    s_mov_b32 s54, 2147483648
    v_xor_b32 v161, v154, v138
    v_add_u32 v159, v153, v158
    v_add_u32 v160, 0, v155
    v_mad_u32_u24 v159, v159, 10, v160
    v_bfe_u32 v160, v159, 2, 1
    v_lshl_or_b32 v160, v161, 1, v160
    v_lshl_add_u32 v160, v159, 2, v160
    v_lshl_add_u32 v8, v160, 4, s56
    v_add_u32 v162, 1, v156
    v_add_u32 v159, v138, v158
    v_add_u32 v160, v162, v155
    v_mad_u32_u24 v159, v159, 10, v160
    v_bfe_u32 v160, v159, 2, 1
    v_lshl_or_b32 v160, v154, 1, v160
    v_lshl_add_u32 v160, v159, 2, v160
    v_lshl_add_u32 v12, v160, 4, s56
    v_xor_b32 v9, 16, v8
    v_xor_b32 v10, 32, v8
    v_xor_b32 v11, 48, v8
    v_xor_b32 v13, 16, v12
    v_xor_b32 v14, 32, v12
    v_xor_b32 v15, 48, v12
    v_add_u32 v159, 1, v158
    v_add_u32 v160, 1, v155
    v_mad_u32_u24 v159, v159, 10, v160
    v_bfe_u32 v160, v159, 2, 1
    v_lshl_or_b32 v160, v154, 1, v160
    v_xor_b32 v160, v153, v160
    v_lshl_add_u32 v160, v159, 2, v160
    v_lshl_add_u32 v20, v160, 4, s56
    v_xor_b32 v161, 1, v154
    v_add_u32 v159, 2, v158
    v_add_u32 v160, 1, v155
    v_mad_u32_u24 v159, v159, 10, v160
    v_bfe_u32 v160, v159, 2, 1
    v_lshl_or_b32 v160, v161, 1, v160
    v_xor_b32 v160, v153, v160
    v_lshl_add_u32 v160, v159, 2, v160
    v_lshl_add_u32 v21, v160, 4, s56
    v_bfe_u32 v158, v152, 2, 1
    v_sub_u32 v158, v153, v158
    v_and_b32 v159, 3, v152
    v_mul_u32_u24 v16, 0x1111, v159
    v_lshrrev_b32 v160, 3, v152
    v_lshl_add_u32 v159, v160, 2, v159
    v_lshlrev_b32 v159, 5, v159
    v_add_u32 v159, 141312, v159
    s_movk_i32 s70, 3072
    v_cmp_gt_u32 vcc, 3, v158
    v_mad_u32_u24 v159, v158, s70, v159
    s_nop 0
    v_cndmask_b32 v22, v157, v159, vcc
    v_lshlrev_b32 v23, 4, v129
    v_add_u32 v24, 40960, v23
    v_lshlrev_b32 v25, 5, v153
    v_add_u32 v25, 150528, v25
    v_and_b32 v160, 1, v129
    v_lshlrev_b32 v160, 4, v160
    v_mov_b32 v161, 0x3f80
    v_lshlrev_b32 v160, v160, v161
    v_bfe_u32 v158, v129, 1, 1
    v_bfe_u32 v159, v129, 3, 2
    v_lshl_add_u32 v159, v159, 1, v158
    v_bfe_u32 v161, v129, 2, 1
    v_xor_b32 v161, v161, v138
    v_lshl_add_u32 v159, v161, 3, v159
    v_lshlrev_b32 v159, v159, 1
    v_lshrrev_b32 v161, 2, v152
    v_xor_b32 v161, v161, v153
    v_lshl_add_u32 v158, v161, 1, v158
    v_lshlrev_b32 v158, v158, 1
    v_bfe_i32 v240, v159, 0, 1
    v_bfe_i32 v241, v159, 1, 1
    v_bfe_i32 v242, v159, 2, 1
    v_bfe_i32 v243, v159, 3, 1
    v_bfe_i32 v244, v159, 4, 1
    v_bfe_i32 v245, v159, 5, 1
    v_bfe_i32 v246, v159, 6, 1
    v_bfe_i32 v247, v159, 7, 1
    v_bfe_i32 v18, v158, 0, 1
    v_bfe_i32 v19, v158, 1, 1
    v_and_b32 v240, v160, v240
    v_and_b32 v241, v160, v241
    v_and_b32 v242, v160, v242
    v_and_b32 v243, v160, v243
    v_and_b32 v244, v160, v244
    v_and_b32 v245, v160, v245
    v_and_b32 v246, v160, v246
    v_and_b32 v247, v160, v247
    v_and_b32 v18, v160, v18
    v_and_b32 v19, v160, v19
    s_mov_b32 s24, s18
    s_mov_b32 s25, s19
    s_mov_b32 s26, 50331648
    s_mov_b32 s27, 0x20000
    s_mov_b32 s52, 0
    s_mov_b32 s80, 0
    s_mov_b32 s81, 98304
    s_mov_b32 s82, 393216
    s_mov_b32 s83, 491520
    s_mov_b32 s53, 1156138217
    s_mov_b32 s58, 0x3c003c00
    s_mov_b32 s85, 150912
    s_mov_b32 s86, 0x37803780
    s_mov_b32 s87, 0xffffffff
    s_mov_b32 s84, 0x37800000
    v_lshrrev_b32 v158, 2, v152
    v_xor_b32 v158, v158, v153
    v_bfe_i32 v158, v158, 0, 1
    v_bfi_b32 v158, v158, 0, s58
    v_accvgpr_write_b32 a228, v158
    v_accvgpr_write_b32 a229, v158
    v_accvgpr_write_b32 a230, v158
    v_accvgpr_write_b32 a231, v158
    v_and_b32 v17, v138, v153
    v_lshlrev_b32 v17, 4, v17
    v_lshrrev_b32 v17, v17, -1
    s_mov_b32 s73, 0x409d2a01
    s_mov_b32 s59, 0x3ef00000
    v_mul_u32_u24 v252, 0x100010, v0
    v_add_u32 v252, 0xc0004, v252
    v_lshlrev_b32 v253, 2, v0
    v_add_u32 v253, 150912, v253
    v_add_u32 v160, 0x0, v252
    v_add_u32 v168, 0x10001000, v252
    v_cvt_f32_f16 v161, v160
    v_cvt_f32_f16 v169, v168
    v_cvt_f32_f16_sdwa v162, v160 dst_sel:DWORD dst_unused:UNUSED_PAD src0_sel:WORD_1
    v_cvt_f32_f16_sdwa v170, v168 dst_sel:DWORD dst_unused:UNUSED_PAD src0_sel:WORD_1
    v_mul_f32 v163, 0x3f7fdde7, v161
    v_mul_f32 v171, 0x3f7fdde7, v169
    v_mul_f32 v164, 0x3f7fdde7, v162
    v_mul_f32 v172, 0x3f7fdde7, v170
    v_fma_f32 v163, v163, v161, s73
    v_fma_f32 v171, v171, v169, s73
    v_fma_f32 v164, v164, v162, s73
    v_fma_f32 v172, v172, v170, s73
    v_mul_f32 v163, -v161, v163
    v_mul_f32 v171, -v169, v171
    v_mul_f32 v164, -v162, v164
    v_mul_f32 v172, -v170, v172
    v_exp_f32 v165, v163
    v_exp_f32 v173, v171
    v_exp_f32 v166, v164
    v_exp_f32 v174, v172
    v_fma_f32 v163, v165, s59, s59
    v_fma_f32 v171, v173, s59, s59
    v_fma_f32 v164, v166, s59, s59
    v_fma_f32 v172, v174, s59, s59
    v_rcp_f32 v163, v163
    v_rcp_f32 v171, v171
    v_rcp_f32 v164, v164
    v_rcp_f32 v172, v172
    v_mul_f32 v163, v161, v163
    v_mul_f32 v171, v169, v171
    v_mul_f32 v164, v162, v164
    v_mul_f32 v172, v170, v172
    v_mul_f32 v165, -v165, v163
    v_mul_f32 v173, -v173, v171
    v_mul_f32 v166, -v166, v164
    v_mul_f32 v174, -v174, v172
    v_cvt_pk_bf16_f32 v167, v165, v166
    v_cvt_pk_bf16_f32 v175, v173, v174
    v_cvt_pk_bf16_f32 v160, v163, v164
    v_cvt_pk_bf16_f32 v168, v171, v172
    ds_write_b32 v253, v167 offset:8192
    ds_write_b32 v253, v160 offset:0
    ds_write_b32 v253, v175 offset:9216
    ds_write_b32 v253, v168 offset:1024
    v_add_u32 v160, 0x20002000, v252
    s_nop 0
    v_add_u32 v168, 0x30003000, v252
    v_cvt_f32_f16 v161, v160
    v_cvt_f32_f16 v169, v168
    v_cvt_f32_f16_sdwa v162, v160 dst_sel:DWORD dst_unused:UNUSED_PAD src0_sel:WORD_1
    v_cvt_f32_f16_sdwa v170, v168 dst_sel:DWORD dst_unused:UNUSED_PAD src0_sel:WORD_1
    v_mul_f32 v163, 0x3f7fdde7, v161
    v_mul_f32 v171, 0x3f7fdde7, v169
    v_mul_f32 v164, 0x3f7fdde7, v162
    v_mul_f32 v172, 0x3f7fdde7, v170
    v_fma_f32 v163, v163, v161, s73
    v_fma_f32 v171, v171, v169, s73
    v_fma_f32 v164, v164, v162, s73
    v_fma_f32 v172, v172, v170, s73
    v_mul_f32 v163, -v161, v163
    v_mul_f32 v171, -v169, v171
    v_mul_f32 v164, -v162, v164
    v_mul_f32 v172, -v170, v172
    v_exp_f32 v165, v163
    v_exp_f32 v173, v171
    v_exp_f32 v166, v164
    v_exp_f32 v174, v172
    v_fma_f32 v163, v165, s59, s59
    v_fma_f32 v171, v173, s59, s59
    v_fma_f32 v164, v166, s59, s59
    v_fma_f32 v172, v174, s59, s59
    v_rcp_f32 v163, v163
    v_rcp_f32 v171, v171
    v_rcp_f32 v164, v164
    v_rcp_f32 v172, v172
    v_mul_f32 v163, v161, v163
    v_mul_f32 v171, v169, v171
    v_mul_f32 v164, v162, v164
    v_mul_f32 v172, v170, v172
    v_mul_f32 v165, -v165, v163
    v_mul_f32 v173, -v173, v171
    v_mul_f32 v166, -v166, v164
    v_mul_f32 v174, -v174, v172
    v_cvt_pk_bf16_f32 v167, v165, v166
    v_cvt_pk_bf16_f32 v175, v173, v174
    v_cvt_pk_bf16_f32 v160, v163, v164
    v_cvt_pk_bf16_f32 v168, v171, v172
    ds_write_b32 v253, v167 offset:10240
    ds_write_b32 v253, v160 offset:2048
    ds_write_b32 v253, v175 offset:11264
    ds_write_b32 v253, v168 offset:3072
    v_add_u32 v160, 0x40004000, v252
    s_nop 0
    v_add_u32 v168, 0x50005000, v252
    v_cvt_f32_f16 v161, v160
    v_cvt_f32_f16 v169, v168
    v_cvt_f32_f16_sdwa v162, v160 dst_sel:DWORD dst_unused:UNUSED_PAD src0_sel:WORD_1
    v_cvt_f32_f16_sdwa v170, v168 dst_sel:DWORD dst_unused:UNUSED_PAD src0_sel:WORD_1
    v_mul_f32 v163, 0x3f7fdde7, v161
    v_mul_f32 v171, 0x40088889, v169
    v_mul_f32 v164, 0x3f7fdde7, v162
    v_mul_f32 v172, 0x40088889, v170
    v_fma_f32 v163, v163, v161, s73
    v_cvt_pk_bf16_f32 v168, v171, v172
    v_fma_f32 v164, v164, v162, s73
    v_mul_f32 v163, -v161, v163
    v_mul_f32 v164, -v162, v164
    v_exp_f32 v165, v163
    v_exp_f32 v166, v164
    v_fma_f32 v163, v165, s59, s59
    v_fma_f32 v164, v166, s59, s59
    v_rcp_f32 v163, v163
    v_rcp_f32 v164, v164
    v_mul_f32 v163, v161, v163
    v_mul_f32 v164, v162, v164
    v_mul_f32 v165, -v165, v163
    v_mul_f32 v166, -v166, v164
    v_cvt_pk_bf16_f32 v167, v165, v166
    v_cvt_pk_bf16_f32 v160, v163, v164
    ds_write_b32 v253, v167 offset:12288
    ds_write_b32 v253, v160 offset:4096
    ds_write_b32 v253, v168 offset:5120
    s_nop 0
    v_add_u32 v160, 0x60006000, v252
    v_add_u32 v168, 0x70007000, v252
    v_cvt_f32_f16 v161, v160
    v_cvt_f32_f16 v169, v168
    v_cvt_f32_f16_sdwa v162, v160 dst_sel:DWORD dst_unused:UNUSED_PAD src0_sel:WORD_1
    v_cvt_f32_f16_sdwa v170, v168 dst_sel:DWORD dst_unused:UNUSED_PAD src0_sel:WORD_1
    v_mul_f32 v163, 0x40088889, v161
    v_mul_f32 v171, 0x40088889, v169
    v_mul_f32 v164, 0x40088889, v162
    v_mul_f32 v172, 0x40088889, v170
    v_cvt_pk_bf16_f32 v160, v163, v164
    v_cvt_pk_bf16_f32 v168, v171, v172
    ds_write_b32 v253, v160 offset:6144
    ds_write_b32 v253, v168 offset:7168
    v_lshlrev_b32 v158, 6, v0
    v_add_u32 v158, 141312, v158
    v_cmp_gt_u32 vcc, 144, v0
    s_nop 1
    v_cndmask_b32 v158, v157, v158, vcc
    v_and_b32 v159, 3, v0
    v_lshl_add_u32 v160, v159, 2, v158
    v_lshrrev_b32 v159, 1, v159
    v_lshl_add_u32 v159, v159, 2, v158
    v_lshlrev_b32 v161, 4, v0
    v_add_u32 v161, 150528, v161
    v_cmp_gt_u32 vcc, 24, v0
    s_nop 1
    v_cndmask_b32 v161, v157, v161, vcc
    v_mov_b32 v164, 0
    v_mov_b32 v165, 0
    v_mov_b32 v166, 0
    v_mov_b32 v167, 0
    ds_write_b128 v158, v[164:167]
    ds_write_b128 v158, v[164:167] offset:16
    s_waitcnt lgkmcnt(9)
    ds_write_b128 v158, v[164:167] offset:32
    ds_write_b128 v158, v[164:167] offset:48
    s_waitcnt vmcnt(14)
    ds_write_b16 v160, v144
    ds_write_b16_d16_hi v160, v144 offset:34
    s_waitcnt vmcnt(13)
    ds_write_b16 v159, v145 offset:16
    ds_write_b16_d16_hi v159, v145 offset:48
    s_waitcnt vmcnt(12) lgkmcnt(13)
    ds_write_b16 v159, v146 offset:24
    ds_write_b16_d16_hi v159, v146 offset:56
    s_waitcnt vmcnt(11)
    v_lshlrev_b32 v168, 16, v148
    v_and_b32 v169, 0xffff0000, v148
    v_lshlrev_b32 v170, 16, v149
    v_and_b32 v171, 0xffff0000, v149
    s_waitcnt vmcnt(10)
    v_lshlrev_b32 v172, 16, v150
    v_and_b32 v173, 0xffff0000, v150
    v_lshlrev_b32 v174, 16, v151
    v_and_b32 v175, 0xffff0000, v151
    v_mul_f32 v168, v168, v172
    v_mul_f32 v169, v169, v173
    v_mul_f32 v170, v170, v174
    v_mul_f32 v171, v171, v175
    s_waitcnt lgkmcnt(14)
    ds_write_b128 v161, v[168:171]
    s_waitcnt vmcnt(9)
    v_mfma_f32_32x32x16_bf16 v[176:191], v[208:211], v[240:243], 0
    v_mfma_f32_32x32x16_bf16 v[176:191], v[208:211], v[244:247], v[176:191]
    s_waitcnt vmcnt(8)
    s_nop 10
    v_mfma_f32_32x32x16_bf16 v[180:195], v[212:215], v[240:243], 0
    v_mfma_f32_32x32x16_bf16 v[180:195], v[212:215], v[244:247], v[180:195]
    s_waitcnt vmcnt(7)
    s_nop 10
    v_mfma_f32_32x32x16_bf16 v[184:199], v[216:219], v[240:243], 0
    v_mfma_f32_32x32x16_bf16 v[184:199], v[216:219], v[244:247], v[184:199]
    s_mov_b32 s74, 0
    s_mov_b32 s75, 6144
    buffer_load_dwordx4 a[0:3], v232, s[48:51], s74 offen offset:0
    buffer_load_dwordx4 a[4:7], v232, s[48:51], s75 offen offset:0
    buffer_load_dwordx4 a[8:11], v232, s[48:51], s74 offen offset:1536
    buffer_load_dwordx4 a[12:15], v232, s[48:51], s75 offen offset:1536
    buffer_load_dwordx4 a[16:19], v232, s[48:51], s74 offen offset:64
    buffer_load_dwordx4 a[20:23], v232, s[48:51], s75 offen offset:64
    buffer_load_dwordx4 a[24:27], v232, s[48:51], s74 offen offset:1600
    buffer_load_dwordx4 a[28:31], v232, s[48:51], s75 offen offset:1600
    buffer_load_dwordx4 a[32:35], v232, s[48:51], s74 offen offset:128
    buffer_load_dwordx4 a[36:39], v232, s[48:51], s75 offen offset:128
    buffer_load_dwordx4 a[40:43], v232, s[48:51], s74 offen offset:1664
    buffer_load_dwordx4 a[44:47], v232, s[48:51], s75 offen offset:1664
    s_mov_b32 s74, 24576
    s_mov_b32 s75, 30720
    buffer_load_dwordx4 a[48:51], v232, s[48:51], s74 offen offset:0
    buffer_load_dwordx4 a[52:55], v232, s[48:51], s75 offen offset:0
    buffer_load_dwordx4 a[56:59], v232, s[48:51], s74 offen offset:1536
    buffer_load_dwordx4 a[60:63], v232, s[48:51], s75 offen offset:1536
    buffer_load_dwordx4 a[64:67], v232, s[48:51], s74 offen offset:64
    buffer_load_dwordx4 a[68:71], v232, s[48:51], s75 offen offset:64
    buffer_load_dwordx4 a[72:75], v232, s[48:51], s74 offen offset:1600
    buffer_load_dwordx4 a[76:79], v232, s[48:51], s75 offen offset:1600
    buffer_load_dwordx4 a[80:83], v232, s[48:51], s74 offen offset:128
    buffer_load_dwordx4 a[84:87], v232, s[48:51], s75 offen offset:128
    buffer_load_dwordx4 a[88:91], v232, s[48:51], s74 offen offset:1664
    buffer_load_dwordx4 a[92:95], v232, s[48:51], s75 offen offset:1664
    s_waitcnt vmcnt(23)
    v_mfma_f32_32x32x16_bf16 v[80:95], a[0:3], v[240:243], 0
    s_waitcnt vmcnt(21)
    v_mfma_f32_32x32x16_bf16 v[96:111], a[8:11], v[240:243], 0
    v_mfma_f32_32x32x16_bf16 v[80:95], a[4:7], v[244:247], v[80:95]
    s_waitcnt vmcnt(20)
    v_mfma_f32_32x32x16_bf16 v[96:111], a[12:15], v[244:247], v[96:111]
    s_waitcnt vmcnt(19)
    v_mfma_f32_32x32x16_bf16 v[112:127], a[16:19], v[240:243], 0
    s_waitcnt vmcnt(17)
    v_mfma_f32_32x32x16_bf16 v[128:143], a[24:27], v[240:243], 0
    v_mfma_f32_32x32x16_bf16 v[112:127], a[20:23], v[244:247], v[112:127]
    s_waitcnt vmcnt(16)
    v_mfma_f32_32x32x16_bf16 v[128:143], a[28:31], v[244:247], v[128:143]
    s_nop 2
    v_pk_mul_f32 v[80:81], v[80:81], v[176:177]
    v_pk_mul_f32 v[84:85], v[84:85], v[176:177]
    v_pk_mul_f32 v[88:89], v[88:89], v[176:177]
    v_pk_mul_f32 v[92:93], v[92:93], v[176:177]
    v_pk_mul_f32 v[96:97], v[96:97], v[176:177]
    v_pk_mul_f32 v[100:101], v[100:101], v[176:177]
    v_pk_mul_f32 v[104:105], v[104:105], v[176:177]
    v_pk_mul_f32 v[108:109], v[108:109], v[176:177]
    v_cvt_pk_bf16_f32 v224, v80, v84
    v_cvt_pk_bf16_f32 v225, v88, v92
    v_cvt_pk_bf16_f32 v226, v96, v100
    v_cvt_pk_bf16_f32 v227, v104, v108
    s_waitcnt vmcnt(15)
    v_mfma_f32_32x32x16_bf16 v[144:159], a[32:35], v[240:243], 0
    s_waitcnt lgkmcnt(14)
    ds_write_b128 v234, v[224:227] offset:6144
    s_mov_b32 s74, 49152
    v_cvt_pk_bf16_f32 v228, v81, v85
    v_cvt_pk_bf16_f32 v229, v89, v93
    v_cvt_pk_bf16_f32 v230, v97, v101
    v_cvt_pk_bf16_f32 v231, v105, v109
    s_waitcnt vmcnt(13)
    v_mfma_f32_32x32x16_bf16 v[160:175], a[40:43], v[240:243], 0
    s_waitcnt lgkmcnt(14)
    ds_write_b128 v235, v[228:231] offset:6144
    s_mov_b32 s75, 55296
    buffer_load_dwordx4 v[32:35], v232, s[48:51], s74 offen offset:0
    v_pk_mul_f32 v[82:83], v[82:83], v[178:179]
    v_pk_mul_f32 v[86:87], v[86:87], v[178:179]
    v_pk_mul_f32 v[90:91], v[90:91], v[178:179]
    v_pk_mul_f32 v[94:95], v[94:95], v[178:179]
    v_pk_mul_f32 v[98:99], v[98:99], v[178:179]
    v_pk_mul_f32 v[102:103], v[102:103], v[178:179]
    v_pk_mul_f32 v[106:107], v[106:107], v[178:179]
    v_pk_mul_f32 v[110:111], v[110:111], v[178:179]
    v_cvt_pk_bf16_f32 v224, v82, v86
    v_cvt_pk_bf16_f32 v225, v90, v94
    v_cvt_pk_bf16_f32 v226, v98, v102
    v_cvt_pk_bf16_f32 v227, v106, v110
    v_mfma_f32_32x32x16_bf16 v[144:159], a[36:39], v[244:247], v[144:159]
    s_waitcnt lgkmcnt(14)
    ds_write_b128 v234, v[224:227] offset:6272
    buffer_load_dwordx4 v[36:39], v232, s[48:51], s75 offen offset:0
    v_cvt_pk_bf16_f32 v228, v83, v87
    v_cvt_pk_bf16_f32 v229, v91, v95
    v_cvt_pk_bf16_f32 v230, v99, v103
    v_cvt_pk_bf16_f32 v231, v107, v111
    s_waitcnt vmcnt(14)
    v_mfma_f32_32x32x16_bf16 v[160:175], a[44:47], v[244:247], v[160:175]
    s_waitcnt vmcnt(10)
    s_waitcnt lgkmcnt(14)
    ds_write_b128 v235, v[228:231] offset:6272
    buffer_load_dwordx4 v[40:43], v232, s[48:51], s74 offen offset:1536
    buffer_load_dwordx4 v[44:47], v232, s[48:51], s75 offen offset:1536
    v_pk_mul_f32 v[112:113], v[112:113], v[180:181]
    v_pk_mul_f32 v[116:117], v[116:117], v[180:181]
    v_pk_mul_f32 v[120:121], v[120:121], v[180:181]
    v_pk_mul_f32 v[124:125], v[124:125], v[180:181]
    v_pk_mul_f32 v[128:129], v[128:129], v[180:181]
    v_pk_mul_f32 v[132:133], v[132:133], v[180:181]
    v_pk_mul_f32 v[136:137], v[136:137], v[180:181]
    v_pk_mul_f32 v[140:141], v[140:141], v[180:181]
    v_cvt_pk_bf16_f32 v224, v112, v116
    v_cvt_pk_bf16_f32 v225, v120, v124
    v_cvt_pk_bf16_f32 v226, v128, v132
    v_cvt_pk_bf16_f32 v227, v136, v140
    v_mfma_f32_32x32x16_bf16 v[80:95], a[48:51], v[240:243], 0
    s_waitcnt lgkmcnt(14)
    ds_write_b128 v234, v[224:227] offset:8192
    buffer_load_dwordx4 v[48:51], v232, s[48:51], s74 offen offset:64
    v_cvt_pk_bf16_f32 v228, v113, v117
    v_cvt_pk_bf16_f32 v229, v121, v125
    v_cvt_pk_bf16_f32 v230, v129, v133
    v_cvt_pk_bf16_f32 v231, v137, v141
    v_mfma_f32_32x32x16_bf16 v[96:111], a[56:59], v[240:243], 0
    s_waitcnt lgkmcnt(14)
    ds_write_b128 v235, v[228:231] offset:8192
    buffer_load_dwordx4 v[52:55], v232, s[48:51], s75 offen offset:64
    v_pk_mul_f32 v[114:115], v[114:115], v[182:183]
    v_pk_mul_f32 v[118:119], v[118:119], v[182:183]
    v_pk_mul_f32 v[122:123], v[122:123], v[182:183]
    v_pk_mul_f32 v[126:127], v[126:127], v[182:183]
    v_pk_mul_f32 v[130:131], v[130:131], v[182:183]
    v_pk_mul_f32 v[134:135], v[134:135], v[182:183]
    v_pk_mul_f32 v[138:139], v[138:139], v[182:183]
    v_pk_mul_f32 v[142:143], v[142:143], v[182:183]
    v_cvt_pk_bf16_f32 v224, v114, v118
    v_cvt_pk_bf16_f32 v225, v122, v126
    v_cvt_pk_bf16_f32 v226, v130, v134
    v_cvt_pk_bf16_f32 v227, v138, v142
    v_mfma_f32_32x32x16_bf16 v[80:95], a[52:55], v[244:247], v[80:95]
    s_waitcnt lgkmcnt(14)
    ds_write_b128 v234, v[224:227] offset:8320
    buffer_load_dwordx4 v[56:59], v232, s[48:51], s74 offen offset:1600
    v_cvt_pk_bf16_f32 v228, v115, v119
    v_cvt_pk_bf16_f32 v229, v123, v127
    v_cvt_pk_bf16_f32 v230, v131, v135
    v_cvt_pk_bf16_f32 v231, v139, v143
    v_mfma_f32_32x32x16_bf16 v[96:111], a[60:63], v[244:247], v[96:111]
    s_waitcnt vmcnt(11)
    s_waitcnt lgkmcnt(14)
    ds_write_b128 v235, v[228:231] offset:8320
    buffer_load_dwordx4 v[60:63], v232, s[48:51], s75 offen offset:1600
    v_pk_mul_f32 v[144:145], v[144:145], v[184:185]
    v_pk_mul_f32 v[148:149], v[148:149], v[184:185]
    v_pk_mul_f32 v[152:153], v[152:153], v[184:185]
    v_pk_mul_f32 v[156:157], v[156:157], v[184:185]
    v_pk_mul_f32 v[160:161], v[160:161], v[184:185]
    v_pk_mul_f32 v[164:165], v[164:165], v[184:185]
    v_pk_mul_f32 v[168:169], v[168:169], v[184:185]
    v_pk_mul_f32 v[172:173], v[172:173], v[184:185]
    v_cvt_pk_bf16_f32 v224, v144, v148
    v_cvt_pk_bf16_f32 v225, v152, v156
    v_cvt_pk_bf16_f32 v226, v160, v164
    v_cvt_pk_bf16_f32 v227, v168, v172
    v_mfma_f32_32x32x16_bf16 v[112:127], a[64:67], v[240:243], 0
    s_waitcnt lgkmcnt(14)
    ds_write_b128 v234, v[224:227] offset:10240
    buffer_load_dwordx4 v[64:67], v232, s[48:51], s74 offen offset:128
    v_cvt_pk_bf16_f32 v228, v145, v149
    v_cvt_pk_bf16_f32 v229, v153, v157
    v_cvt_pk_bf16_f32 v230, v161, v165
    v_cvt_pk_bf16_f32 v231, v169, v173
    v_mfma_f32_32x32x16_bf16 v[128:143], a[72:75], v[240:243], 0
    s_waitcnt lgkmcnt(14)
    ds_write_b128 v235, v[228:231] offset:10240
    buffer_load_dwordx4 v[68:71], v232, s[48:51], s75 offen offset:128
    v_pk_mul_f32 v[146:147], v[146:147], v[186:187]
    v_pk_mul_f32 v[150:151], v[150:151], v[186:187]
    v_pk_mul_f32 v[154:155], v[154:155], v[186:187]
    v_pk_mul_f32 v[158:159], v[158:159], v[186:187]
    v_pk_mul_f32 v[162:163], v[162:163], v[186:187]
    v_pk_mul_f32 v[166:167], v[166:167], v[186:187]
    v_pk_mul_f32 v[170:171], v[170:171], v[186:187]
    v_pk_mul_f32 v[174:175], v[174:175], v[186:187]
    v_cvt_pk_bf16_f32 v224, v146, v150
    v_cvt_pk_bf16_f32 v225, v154, v158
    v_cvt_pk_bf16_f32 v226, v162, v166
    v_cvt_pk_bf16_f32 v227, v170, v174
    v_mfma_f32_32x32x16_bf16 v[112:127], a[68:71], v[244:247], v[112:127]
    s_waitcnt lgkmcnt(14)
    ds_write_b128 v234, v[224:227] offset:10368
    buffer_load_dwordx4 v[72:75], v232, s[48:51], s74 offen offset:1664
    v_cvt_pk_bf16_f32 v228, v147, v151
    v_cvt_pk_bf16_f32 v229, v155, v159
    v_cvt_pk_bf16_f32 v230, v163, v167
    v_cvt_pk_bf16_f32 v231, v171, v175
    v_mfma_f32_32x32x16_bf16 v[128:143], a[76:79], v[244:247], v[128:143]
    s_waitcnt vmcnt(11)
    s_waitcnt lgkmcnt(14)
    ds_write_b128 v235, v[228:231] offset:10368
    buffer_load_dwordx4 v[76:79], v232, s[48:51], s75 offen offset:1664
    v_sub_u32 v234, v234, v238
    v_sub_u32 v235, v235, v238
    v_pk_mul_f32 v[80:81], v[80:81], v[176:177]
    v_pk_mul_f32 v[84:85], v[84:85], v[176:177]
    v_pk_mul_f32 v[88:89], v[88:89], v[176:177]
    v_pk_mul_f32 v[92:93], v[92:93], v[176:177]
    v_pk_mul_f32 v[96:97], v[96:97], v[176:177]
    v_pk_mul_f32 v[100:101], v[100:101], v[176:177]
    v_pk_mul_f32 v[104:105], v[104:105], v[176:177]
    v_pk_mul_f32 v[108:109], v[108:109], v[176:177]
    v_cvt_pk_bf16_f32 v224, v80, v84
    v_cvt_pk_bf16_f32 v225, v88, v92
    v_cvt_pk_bf16_f32 v226, v96, v100
    v_cvt_pk_bf16_f32 v227, v104, v108
    v_mfma_f32_32x32x16_bf16 v[144:159], a[80:83], v[240:243], 0
    s_waitcnt lgkmcnt(14)
    ds_write_b128 v234, v[224:227] offset:6144
    s_add_u32 m0, s56, 6336
    s_nop 0
    buffer_load_dwordx4 v1, s[20:23], 0 offen offset:64 lds
    v_cvt_pk_bf16_f32 v228, v81, v85
    v_cvt_pk_bf16_f32 v229, v89, v93
    v_cvt_pk_bf16_f32 v230, v97, v101
    v_cvt_pk_bf16_f32 v231, v105, v109
    v_mfma_f32_32x32x16_bf16 v[160:175], a[88:91], v[240:243], 0
    s_waitcnt lgkmcnt(14)
    ds_write_b128 v235, v[228:231] offset:6144
    s_add_u32 m0, s56, 7360
    s_nop 0
    buffer_load_dwordx4 v2, s[20:23], 0 offen offset:64 lds
    v_pk_mul_f32 v[82:83], v[82:83], v[178:179]
    v_pk_mul_f32 v[86:87], v[86:87], v[178:179]
    v_pk_mul_f32 v[90:91], v[90:91], v[178:179]
    v_pk_mul_f32 v[94:95], v[94:95], v[178:179]
    v_pk_mul_f32 v[98:99], v[98:99], v[178:179]
    v_pk_mul_f32 v[102:103], v[102:103], v[178:179]
    v_pk_mul_f32 v[106:107], v[106:107], v[178:179]
    v_pk_mul_f32 v[110:111], v[110:111], v[178:179]
    v_cvt_pk_bf16_f32 v224, v82, v86
    v_cvt_pk_bf16_f32 v225, v90, v94
    v_cvt_pk_bf16_f32 v226, v98, v102
    v_cvt_pk_bf16_f32 v227, v106, v110
    v_mfma_f32_32x32x16_bf16 v[144:159], a[84:87], v[244:247], v[144:159]
    s_waitcnt lgkmcnt(14)
    ds_write_b128 v234, v[224:227] offset:6272
    s_add_u32 m0, s56, 8384
    s_nop 0
    buffer_load_dwordx4 v3, s[20:23], 0 offen offset:64 lds
    v_cvt_pk_bf16_f32 v228, v83, v87
    v_cvt_pk_bf16_f32 v229, v91, v95
    v_cvt_pk_bf16_f32 v230, v99, v103
    v_cvt_pk_bf16_f32 v231, v107, v111
    v_mfma_f32_32x32x16_bf16 v[160:175], a[92:95], v[244:247], v[160:175]
    s_waitcnt vmcnt(11)
    s_waitcnt lgkmcnt(14)
    ds_write_b128 v235, v[228:231] offset:6272
    s_add_u32 m0, s56, 9408
    s_nop 0
    buffer_load_dwordx4 v4, s[20:23], 0 offen offset:64 lds
    v_pk_mul_f32 v[112:113], v[112:113], v[180:181]
    v_pk_mul_f32 v[116:117], v[116:117], v[180:181]
    v_pk_mul_f32 v[120:121], v[120:121], v[180:181]
    v_pk_mul_f32 v[124:125], v[124:125], v[180:181]
    v_pk_mul_f32 v[128:129], v[128:129], v[180:181]
    v_pk_mul_f32 v[132:133], v[132:133], v[180:181]
    v_pk_mul_f32 v[136:137], v[136:137], v[180:181]
    v_pk_mul_f32 v[140:141], v[140:141], v[180:181]
    v_cvt_pk_bf16_f32 v224, v112, v116
    v_cvt_pk_bf16_f32 v225, v120, v124
    v_cvt_pk_bf16_f32 v226, v128, v132
    v_cvt_pk_bf16_f32 v227, v136, v140
    v_mfma_f32_32x32x16_bf16 v[80:95], v[32:35], v[240:243], 0
    s_waitcnt lgkmcnt(0)
    s_barrier
    ds_write_b128 v234, v[224:227] offset:8192
    ds_read_b128 a[192:195], v23 offset:4096
    ds_read_b128 a[196:199], v23 offset:5120
    ds_read_b128 a[200:203], v23 offset:14336
    ds_read_b128 a[204:207], v23 offset:15360
    ds_read_b128 a[208:211], v23 offset:24576
    ds_read_b128 a[212:215], v23 offset:25600
    ds_read_b128 a[216:219], v23 offset:34816
    s_add_u32 m0, s56, 10432
    v_cvt_pk_bf16_f32 v228, v113, v117
    v_cvt_pk_bf16_f32 v229, v121, v125
    v_cvt_pk_bf16_f32 v230, v129, v133
    v_cvt_pk_bf16_f32 v231, v137, v141
    v_mfma_f32_32x32x16_bf16 v[96:111], v[40:43], v[240:243], 0
    ds_write_b128 v235, v[228:231] offset:8192
    ds_read_b128 a[220:223], v23 offset:35840
    ds_read_b128 a[0:3], v24 offset:0
    ds_read_b128 a[4:7], v24 offset:1024
    ds_read_b128 a[24:27], v24 offset:6144
    ds_read_b128 a[28:31], v24 offset:7168
    ds_read_b128 a[96:99], v24 offset:24576
    s_waitcnt lgkmcnt(14)
    ds_read_b128 a[100:103], v24 offset:25600
    buffer_load_dwordx4 v5, s[20:23], 0 offen offset:64 lds
    s_add_u32 m0, s56, 11456
    v_pk_mul_f32 v[114:115], v[114:115], v[182:183]
    v_pk_mul_f32 v[118:119], v[118:119], v[182:183]
    v_pk_mul_f32 v[122:123], v[122:123], v[182:183]
    v_pk_mul_f32 v[126:127], v[126:127], v[182:183]
    v_pk_mul_f32 v[130:131], v[130:131], v[182:183]
    v_pk_mul_f32 v[134:135], v[134:135], v[182:183]
    v_pk_mul_f32 v[138:139], v[138:139], v[182:183]
    v_pk_mul_f32 v[142:143], v[142:143], v[182:183]
    v_cvt_pk_bf16_f32 v224, v114, v118
    v_cvt_pk_bf16_f32 v225, v122, v126
    v_cvt_pk_bf16_f32 v226, v130, v134
    v_cvt_pk_bf16_f32 v227, v138, v142
    v_mfma_f32_32x32x16_bf16 v[80:95], v[36:39], v[244:247], v[80:95]
    s_waitcnt lgkmcnt(9)
    ds_write_b128 v234, v[224:227] offset:8320
    ds_read_b128 a[120:123], v24 offset:30720
    ds_read_b128 a[124:127], v24 offset:31744
    ds_read_b128 a[144:147], v24 offset:36864
    ds_read_b128 a[148:151], v24 offset:37888
    ds_read_b128 a[168:171], v24 offset:43008
    s_waitcnt lgkmcnt(13)
    ds_read_b128 a[172:175], v24 offset:44032
    ds_read_b128 a[48:51], v24 offset:12288
    buffer_load_dwordx4 v6, s[20:23], 0 offen offset:64 lds
    s_add_u32 m0, s56, 12480
    v_cvt_pk_bf16_f32 v228, v115, v119
    v_cvt_pk_bf16_f32 v229, v123, v127
    v_cvt_pk_bf16_f32 v230, v131, v135
    v_cvt_pk_bf16_f32 v231, v139, v143
    v_mfma_f32_32x32x16_bf16 v[96:111], v[44:47], v[244:247], v[96:111]
    s_waitcnt vmcnt(10)
    s_waitcnt lgkmcnt(9)
    ds_write_b128 v235, v[228:231] offset:8320
    ds_read_b128 a[52:55], v24 offset:13312
    ds_read_b128 a[72:75], v24 offset:18432
    ds_read_b128 a[76:79], v24 offset:19456
    ds_read_b128 a[8:11], v24 offset:2048
    ds_read_b128 a[12:15], v24 offset:3072
    s_waitcnt lgkmcnt(13)
    ds_read_b128 a[32:35], v24 offset:8192
    ds_read_b128 a[36:39], v24 offset:9216
    buffer_load_dword v7, s[20:23], 0 offen offset:64 lds
    buffer_load_dword v254, v31, s[20:23], 0 offen
    v_pk_mul_f32 v[144:145], v[144:145], v[184:185]
    v_pk_mul_f32 v[148:149], v[148:149], v[184:185]
    v_pk_mul_f32 v[152:153], v[152:153], v[184:185]
    v_pk_mul_f32 v[156:157], v[156:157], v[184:185]
    v_pk_mul_f32 v[160:161], v[160:161], v[184:185]
    v_pk_mul_f32 v[164:165], v[164:165], v[184:185]
    v_pk_mul_f32 v[168:169], v[168:169], v[184:185]
    v_pk_mul_f32 v[172:173], v[172:173], v[184:185]
    v_cvt_pk_bf16_f32 v224, v144, v148
    v_cvt_pk_bf16_f32 v225, v152, v156
    v_cvt_pk_bf16_f32 v226, v160, v164
    v_cvt_pk_bf16_f32 v227, v168, v172
    v_mfma_f32_32x32x16_bf16 v[112:127], v[48:51], v[240:243], 0
    s_waitcnt lgkmcnt(9)
    ds_write_b128 v234, v[224:227] offset:10240
    ds_read_b128 a[104:107], v24 offset:26624
    ds_read_b128 a[108:111], v24 offset:27648
    ds_read_b128 a[128:131], v24 offset:32768
    ds_read_b128 a[132:135], v24 offset:33792
    ds_read_b128 a[152:155], v24 offset:38912
    s_waitcnt lgkmcnt(13)
    ds_read_b128 a[156:159], v24 offset:39936
    ds_read_b128 a[176:179], v24 offset:45056
    v_cvt_pk_bf16_f32 v228, v145, v149
    v_cvt_pk_bf16_f32 v229, v153, v157
    v_cvt_pk_bf16_f32 v230, v161, v165
    v_cvt_pk_bf16_f32 v231, v169, v173
    v_mfma_f32_32x32x16_bf16 v[128:143], v[56:59], v[240:243], 0
    s_waitcnt lgkmcnt(9)
    ds_write_b128 v235, v[228:231] offset:10240
    ds_read_b128 a[180:183], v24 offset:46080
    ds_read_b128 a[56:59], v24 offset:14336
    ds_read_b128 a[60:63], v24 offset:15360
    ds_read_b128 a[80:83], v24 offset:20480
    ds_read_b128 a[84:87], v24 offset:21504
    s_waitcnt lgkmcnt(13)
    ds_read_b128 a[16:19], v24 offset:4096
    ds_read_b128 a[20:23], v24 offset:5120
    v_pk_mul_f32 v[146:147], v[146:147], v[186:187]
    v_pk_mul_f32 v[150:151], v[150:151], v[186:187]
    v_pk_mul_f32 v[154:155], v[154:155], v[186:187]
    v_pk_mul_f32 v[158:159], v[158:159], v[186:187]
    v_pk_mul_f32 v[162:163], v[162:163], v[186:187]
    v_pk_mul_f32 v[166:167], v[166:167], v[186:187]
    v_pk_mul_f32 v[170:171], v[170:171], v[186:187]
    v_pk_mul_f32 v[174:175], v[174:175], v[186:187]
    v_cvt_pk_bf16_f32 v224, v146, v150
    v_cvt_pk_bf16_f32 v225, v154, v158
    v_cvt_pk_bf16_f32 v226, v162, v166
    v_cvt_pk_bf16_f32 v227, v170, v174
    v_mfma_f32_32x32x16_bf16 v[112:127], v[52:55], v[244:247], v[112:127]
    s_waitcnt lgkmcnt(9)
    ds_write_b128 v234, v[224:227] offset:10368
    ds_read_b128 a[40:43], v24 offset:10240
    ds_read_b128 a[44:47], v24 offset:11264
    ds_read_b128 a[112:115], v24 offset:28672
    ds_read_b128 a[116:119], v24 offset:29696
    ds_read_b128 a[136:139], v24 offset:34816
    s_waitcnt lgkmcnt(13)
    ds_read_b128 a[140:143], v24 offset:35840
    ds_read_b128 a[160:163], v24 offset:40960
    v_cvt_pk_bf16_f32 v228, v147, v151
    v_cvt_pk_bf16_f32 v229, v155, v159
    v_cvt_pk_bf16_f32 v230, v163, v167
    v_cvt_pk_bf16_f32 v231, v171, v175
    v_mfma_f32_32x32x16_bf16 v[128:143], v[60:63], v[244:247], v[128:143]
    s_waitcnt vmcnt(8)
    s_waitcnt lgkmcnt(9)
    ds_write_b128 v235, v[228:231] offset:10368
    ds_read_b128 a[164:167], v24 offset:41984
    ds_read_b128 a[184:187], v24 offset:47104
    ds_read_b128 a[188:191], v24 offset:48128
    ds_read_b128 a[64:67], v24 offset:16384
    ds_read_b128 a[68:71], v24 offset:17408
    s_waitcnt lgkmcnt(13)
    ds_read_b128 a[88:91], v24 offset:22528
    ds_read_b128 a[92:95], v24 offset:23552
    v_add_u32 v234, v234, v238
    v_add_u32 v235, v235, v238
    v_pk_mul_f32 v[80:81], v[80:81], v[176:177]
    v_pk_mul_f32 v[84:85], v[84:85], v[176:177]
    v_pk_mul_f32 v[88:89], v[88:89], v[176:177]
    v_pk_mul_f32 v[92:93], v[92:93], v[176:177]
    v_pk_mul_f32 v[96:97], v[96:97], v[176:177]
    v_pk_mul_f32 v[100:101], v[100:101], v[176:177]
    v_pk_mul_f32 v[104:105], v[104:105], v[176:177]
    v_pk_mul_f32 v[108:109], v[108:109], v[176:177]
    v_cvt_pk_bf16_f32 v224, v80, v84
    v_cvt_pk_bf16_f32 v225, v88, v92
    v_cvt_pk_bf16_f32 v226, v96, v100
    v_cvt_pk_bf16_f32 v227, v104, v108
    v_mfma_f32_32x32x16_bf16 v[144:159], v[64:67], v[240:243], 0
    s_waitcnt lgkmcnt(0)
    s_barrier
    ds_write_b128 v234, v[224:227] offset:6144
    v_cvt_pk_bf16_f32 v228, v81, v85
    v_cvt_pk_bf16_f32 v229, v89, v93
    v_cvt_pk_bf16_f32 v230, v97, v101
    v_cvt_pk_bf16_f32 v231, v105, v109
    v_mfma_f32_32x32x16_bf16 v[160:175], v[72:75], v[240:243], 0
    ds_write_b128 v235, v[228:231] offset:6144
    v_pk_mul_f32 v[82:83], v[82:83], v[178:179]
    v_pk_mul_f32 v[86:87], v[86:87], v[178:179]
    v_pk_mul_f32 v[90:91], v[90:91], v[178:179]
    v_pk_mul_f32 v[94:95], v[94:95], v[178:179]
    v_pk_mul_f32 v[98:99], v[98:99], v[178:179]
    v_pk_mul_f32 v[102:103], v[102:103], v[178:179]
    v_pk_mul_f32 v[106:107], v[106:107], v[178:179]
    v_pk_mul_f32 v[110:111], v[110:111], v[178:179]
    v_cvt_pk_bf16_f32 v224, v82, v86
    v_cvt_pk_bf16_f32 v225, v90, v94
    v_cvt_pk_bf16_f32 v226, v98, v102
    v_cvt_pk_bf16_f32 v227, v106, v110
    v_mfma_f32_32x32x16_bf16 v[144:159], v[68:71], v[244:247], v[144:159]
    ds_write_b128 v234, v[224:227] offset:6272
    v_cvt_pk_bf16_f32 v228, v83, v87
    v_cvt_pk_bf16_f32 v229, v91, v95
    v_cvt_pk_bf16_f32 v230, v99, v103
    v_cvt_pk_bf16_f32 v231, v107, v111
    v_mfma_f32_32x32x16_bf16 v[160:175], v[76:79], v[244:247], v[160:175]
    ds_write_b128 v235, v[228:231] offset:6272
    v_pk_mul_f32 v[112:113], v[112:113], v[180:181]
    v_pk_mul_f32 v[116:117], v[116:117], v[180:181]
    v_pk_mul_f32 v[120:121], v[120:121], v[180:181]
    v_pk_mul_f32 v[124:125], v[124:125], v[180:181]
    v_pk_mul_f32 v[128:129], v[128:129], v[180:181]
    v_pk_mul_f32 v[132:133], v[132:133], v[180:181]
    v_pk_mul_f32 v[136:137], v[136:137], v[180:181]
    v_pk_mul_f32 v[140:141], v[140:141], v[180:181]
    v_cvt_pk_bf16_f32 v224, v112, v116
    v_cvt_pk_bf16_f32 v225, v120, v124
    v_cvt_pk_bf16_f32 v226, v128, v132
    v_cvt_pk_bf16_f32 v227, v136, v140
    ds_write_b128 v234, v[224:227] offset:8192
    v_cvt_pk_bf16_f32 v228, v113, v117
    v_cvt_pk_bf16_f32 v229, v121, v125
    v_cvt_pk_bf16_f32 v230, v129, v133
    v_cvt_pk_bf16_f32 v231, v137, v141
    ds_write_b128 v235, v[228:231] offset:8192
    v_pk_mul_f32 v[114:115], v[114:115], v[182:183]
    v_pk_mul_f32 v[118:119], v[118:119], v[182:183]
    v_pk_mul_f32 v[122:123], v[122:123], v[182:183]
    v_pk_mul_f32 v[126:127], v[126:127], v[182:183]
    v_pk_mul_f32 v[130:131], v[130:131], v[182:183]
    v_pk_mul_f32 v[134:135], v[134:135], v[182:183]
    v_pk_mul_f32 v[138:139], v[138:139], v[182:183]
    v_pk_mul_f32 v[142:143], v[142:143], v[182:183]
    v_cvt_pk_bf16_f32 v224, v114, v118
    v_cvt_pk_bf16_f32 v225, v122, v126
    v_cvt_pk_bf16_f32 v226, v130, v134
    v_cvt_pk_bf16_f32 v227, v138, v142
    ds_write_b128 v234, v[224:227] offset:8320
    v_cvt_pk_bf16_f32 v228, v115, v119
    v_cvt_pk_bf16_f32 v229, v123, v127
    v_cvt_pk_bf16_f32 v230, v131, v135
    v_cvt_pk_bf16_f32 v231, v139, v143
    ds_write_b128 v235, v[228:231] offset:8320
    v_pk_mul_f32 v[144:145], v[144:145], v[184:185]
    v_pk_mul_f32 v[148:149], v[148:149], v[184:185]
    v_pk_mul_f32 v[152:153], v[152:153], v[184:185]
    v_pk_mul_f32 v[156:157], v[156:157], v[184:185]
    v_pk_mul_f32 v[160:161], v[160:161], v[184:185]
    v_pk_mul_f32 v[164:165], v[164:165], v[184:185]
    v_pk_mul_f32 v[168:169], v[168:169], v[184:185]
    v_pk_mul_f32 v[172:173], v[172:173], v[184:185]
    v_cvt_pk_bf16_f32 v224, v144, v148
    v_cvt_pk_bf16_f32 v225, v152, v156
    v_cvt_pk_bf16_f32 v226, v160, v164
    v_cvt_pk_bf16_f32 v227, v168, v172
    ds_write_b128 v234, v[224:227] offset:10240
    v_cvt_pk_bf16_f32 v228, v145, v149
    v_cvt_pk_bf16_f32 v229, v153, v157
    v_cvt_pk_bf16_f32 v230, v161, v165
    v_cvt_pk_bf16_f32 v231, v169, v173
    ds_write_b128 v235, v[228:231] offset:10240
    v_pk_mul_f32 v[146:147], v[146:147], v[186:187]
    v_pk_mul_f32 v[150:151], v[150:151], v[186:187]
    v_pk_mul_f32 v[154:155], v[154:155], v[186:187]
    v_pk_mul_f32 v[158:159], v[158:159], v[186:187]
    v_pk_mul_f32 v[162:163], v[162:163], v[186:187]
    v_pk_mul_f32 v[166:167], v[166:167], v[186:187]
    v_pk_mul_f32 v[170:171], v[170:171], v[186:187]
    v_pk_mul_f32 v[174:175], v[174:175], v[186:187]
    v_cvt_pk_bf16_f32 v224, v146, v150
    v_cvt_pk_bf16_f32 v225, v154, v158
    v_cvt_pk_bf16_f32 v226, v162, v166
    v_cvt_pk_bf16_f32 v227, v170, v174
    ds_write_b128 v234, v[224:227] offset:10368
    v_cvt_pk_bf16_f32 v228, v147, v151
    v_cvt_pk_bf16_f32 v229, v155, v159
    v_cvt_pk_bf16_f32 v230, v163, v167
    v_cvt_pk_bf16_f32 v231, v171, v175
    ds_write_b128 v235, v[228:231] offset:10368
    s_branch L_conv0
L_prb0:
    v_lshrrev_b32 v131, 4, v129
    v_add_u32 v131, 96, v131
    v_mul_u32_u24 v130, 205, v131
    v_mul_u32_u24 v131, 192, v131
    v_add_u32 v131, s64, v131
    v_lshlrev_b32 v133, 2, v129
    v_and_b32 v133, 63, v133
    v_lshrrev_b32 v134, 11, v130
    v_subrev_u32 v135, s65, v130
    v_mad_u32_u24 v134, v134, s68, v131
    v_and_b32 v135, 0x7ff, v135
    v_cmp_gt_u32 vcc, s66, v135
    v_lshrrev_b32 v135, 7, v130
    v_and_b32 v135, 32, v135
    v_xad_u32 v134, v133, v135, v134
    v_cndmask_b32 v7, v136, v134, vcc
    s_add_u32 m0, s56, 6144
    s_nop 0
    buffer_load_dword v7, s[20:23], 0 offen offset:0 lds
    v_lshrrev_b32 v131, 2, v129
    v_mul_u32_u24 v130, 205, v131
    v_mul_u32_u24 v131, 192, v131
    v_add_u32 v131, s64, v131
    v_lshrrev_b32 v134, 11, v130
    v_subrev_u32 v135, s65, v130
    v_mad_u32_u24 v134, v134, s68, v131
    v_and_b32 v135, 0x7ff, v135
    v_cmp_gt_u32 vcc, s66, v135
    v_lshrrev_b32 v135, 7, v130
    v_and_b32 v135, 32, v135
    v_xad_u32 v134, v132, v135, v134
    v_cndmask_b32 v1, v136, v134, vcc
    v_add_u32 v130, 3280, v130
    v_add_u32 v131, 3072, v131
    v_lshrrev_b32 v134, 11, v130
    v_subrev_u32 v135, s65, v130
    v_mad_u32_u24 v134, v134, s68, v131
    v_and_b32 v135, 0x7ff, v135
    v_cmp_gt_u32 vcc, s66, v135
    v_lshrrev_b32 v135, 7, v130
    v_and_b32 v135, 32, v135
    v_xad_u32 v134, v132, v135, v134
    v_cndmask_b32 v2, v136, v134, vcc
    v_add_u32 v130, 3280, v130
    v_add_u32 v131, 3072, v131
    v_lshrrev_b32 v134, 11, v130
    v_subrev_u32 v135, s65, v130
    v_mad_u32_u24 v134, v134, s68, v131
    v_and_b32 v135, 0x7ff, v135
    v_cmp_gt_u32 vcc, s66, v135
    v_lshrrev_b32 v135, 7, v130
    v_and_b32 v135, 32, v135
    v_xad_u32 v134, v132, v135, v134
    v_cndmask_b32 v3, v136, v134, vcc
    v_add_u32 v130, 3280, v130
    v_add_u32 v131, 3072, v131
    v_lshrrev_b32 v134, 11, v130
    v_subrev_u32 v135, s65, v130
    v_mad_u32_u24 v134, v134, s68, v131
    v_and_b32 v135, 0x7ff, v135
    v_cmp_gt_u32 vcc, s66, v135
    v_lshrrev_b32 v135, 7, v130
    v_and_b32 v135, 32, v135
    v_xad_u32 v134, v132, v135, v134
    v_cndmask_b32 v4, v136, v134, vcc
    v_add_u32 v130, 3280, v130
    v_add_u32 v131, 3072, v131
    v_lshrrev_b32 v134, 11, v130
    v_subrev_u32 v135, s65, v130
    v_mad_u32_u24 v134, v134, s68, v131
    v_and_b32 v135, 0x7ff, v135
    v_cmp_gt_u32 vcc, s66, v135
    v_lshrrev_b32 v135, 7, v130
    v_and_b32 v135, 32, v135
    v_xad_u32 v134, v132, v135, v134
    v_cndmask_b32 v5, v136, v134, vcc
    v_add_u32 v130, 3280, v130
    v_add_u32 v131, 3072, v131
    v_lshrrev_b32 v134, 11, v130
    v_subrev_u32 v135, s65, v130
    v_mad_u32_u24 v134, v134, s68, v131
    v_and_b32 v135, 0x7ff, v135
    v_cmp_gt_u32 vcc, s66, v135
    v_lshrrev_b32 v135, 7, v130
    v_and_b32 v135, 32, v135
    v_xad_u32 v134, v132, v135, v134
    v_cndmask_b32 v6, v136, v134, vcc
    s_cmp_lt_u32 s55, 63
    s_cselect_b32 s66, 10, 0
    s_add_u32 s64, s64, 1856
    v_mul_u32_u24 v134, 98304, v129
    v_add_u32 v134, s64, v134
    v_cmp_gt_u32 vcc, s66, v129
    s_nop 1
    v_cndmask_b32 v31, v136, v134, vcc
    v_mov_b32 v157, 268435456
    v_and_b32 v152, 15, v129
    v_lshrrev_b32 v153, 4, v129
    v_add_u32 v154, 4, v152
    v_lshrrev_b32 v154, 3, v154
    v_mad_i32_i24 v155, v154, -4, v152
    v_and_b32 v154, 1, v154
    v_and_b32 v156, 1, v153
    v_lshlrev_b32 v158, 1, v154
    v_mul_u32_u24 v159, 98304, v158
    v_mad_u32_u24 v159, v155, s69, v159
    v_lshl_add_u32 v159, v153, 4, v159
    v_add_u32 v26, s63, v159
    v_xor_b32 v26, 0x80000000, v26
    s_mov_b32 s54, 2147483648
    v_xor_b32 v161, v154, v138
    v_add_u32 v159, v153, v158
    v_add_u32 v160, 0, v155
    v_mad_u32_u24 v159, v159, 10, v160
    v_bfe_u32 v160, v159, 2, 1
    v_lshl_or_b32 v160, v161, 1, v160
    v_lshl_add_u32 v160, v159, 2, v160
    v_lshl_add_u32 v8, v160, 4, s56
    v_add_u32 v162, 1, v156
    v_add_u32 v159, v138, v158
    v_add_u32 v160, v162, v155
    v_mad_u32_u24 v159, v159, 10, v160
    v_bfe_u32 v160, v159, 2, 1
    v_lshl_or_b32 v160, v154, 1, v160
    v_lshl_add_u32 v160, v159, 2, v160
    v_lshl_add_u32 v12, v160, 4, s56
    v_xor_b32 v9, 16, v8
    v_xor_b32 v10, 32, v8
    v_xor_b32 v11, 48, v8
    v_xor_b32 v13, 16, v12
    v_xor_b32 v14, 32, v12
    v_xor_b32 v15, 48, v12
    v_add_u32 v159, 1, v158
    v_add_u32 v160, 1, v155
    v_mad_u32_u24 v159, v159, 10, v160
    v_bfe_u32 v160, v159, 2, 1
    v_lshl_or_b32 v160, v154, 1, v160
    v_xor_b32 v160, v153, v160
    v_lshl_add_u32 v160, v159, 2, v160
    v_lshl_add_u32 v20, v160, 4, s56
    v_xor_b32 v161, 1, v154
    v_add_u32 v159, 2, v158
    v_add_u32 v160, 1, v155
    v_mad_u32_u24 v159, v159, 10, v160
    v_bfe_u32 v160, v159, 2, 1
    v_lshl_or_b32 v160, v161, 1, v160
    v_xor_b32 v160, v153, v160
    v_lshl_add_u32 v160, v159, 2, v160
    v_lshl_add_u32 v21, v160, 4, s56
    v_bfe_u32 v158, v152, 2, 1
    v_sub_u32 v158, v153, v158
    v_and_b32 v159, 3, v152
    v_mul_u32_u24 v16, 0x1111, v159
    v_lshrrev_b32 v160, 3, v152
    v_lshl_add_u32 v159, v160, 2, v159
    v_lshlrev_b32 v159, 5, v159
    v_add_u32 v159, 141312, v159
    s_movk_i32 s70, 3072
    v_cmp_gt_u32 vcc, 3, v158
    v_mad_u32_u24 v159, v158, s70, v159
    s_nop 0
    v_cndmask_b32 v22, v157, v159, vcc
    v_lshlrev_b32 v23, 4, v129
    v_add_u32 v24, 40960, v23
    v_lshlrev_b32 v25, 5, v153
    v_add_u32 v25, 150528, v25
    v_and_b32 v160, 1, v129
    v_lshlrev_b32 v160, 4, v160
    v_mov_b32 v161, 0x3f80
    v_lshlrev_b32 v160, v160, v161
    v_bfe_u32 v158, v129, 1, 1
    v_bfe_u32 v159, v129, 3, 2
    v_lshl_add_u32 v159, v159, 1, v158
    v_bfe_u32 v161, v129, 2, 1
    v_xor_b32 v161, v161, v138
    v_lshl_add_u32 v159, v161, 3, v159
    v_lshlrev_b32 v159, v159, 1
    v_lshrrev_b32 v161, 2, v152
    v_xor_b32 v161, v161, v153
    v_lshl_add_u32 v158, v161, 1, v158
    v_lshlrev_b32 v158, v158, 1
    v_bfe_i32 v240, v159, 0, 1
    v_bfe_i32 v241, v159, 1, 1
    v_bfe_i32 v242, v159, 2, 1
    v_bfe_i32 v243, v159, 3, 1
    v_bfe_i32 v244, v159, 4, 1
    v_bfe_i32 v245, v159, 5, 1
    v_bfe_i32 v246, v159, 6, 1
    v_bfe_i32 v247, v159, 7, 1
    v_bfe_i32 v18, v158, 0, 1
    v_bfe_i32 v19, v158, 1, 1
    v_and_b32 v240, v160, v240
    v_and_b32 v241, v160, v241
    v_and_b32 v242, v160, v242
    v_and_b32 v243, v160, v243
    v_and_b32 v244, v160, v244
    v_and_b32 v245, v160, v245
    v_and_b32 v246, v160, v246
    v_and_b32 v247, v160, v247
    v_and_b32 v18, v160, v18
    v_and_b32 v19, v160, v19
    s_mov_b32 s24, s18
    s_mov_b32 s25, s19
    s_mov_b32 s26, 50331648
    s_mov_b32 s27, 0x20000
    s_mov_b32 s52, 0
    s_mov_b32 s80, 0
    s_mov_b32 s81, 98304
    s_mov_b32 s82, 393216
    s_mov_b32 s83, 491520
    s_mov_b32 s53, 1156138217
    s_mov_b32 s58, 0x3c003c00
    s_mov_b32 s85, 150912
    s_mov_b32 s86, 0x37803780
    s_mov_b32 s87, 0xffffffff
    s_mov_b32 s84, 0x37800000
    v_lshrrev_b32 v158, 2, v152
    v_xor_b32 v158, v158, v153
    v_bfe_i32 v158, v158, 0, 1
    v_bfi_b32 v158, v158, 0, s58
    v_accvgpr_write_b32 a228, v158
    v_accvgpr_write_b32 a229, v158
    v_accvgpr_write_b32 a230, v158
    v_accvgpr_write_b32 a231, v158
    v_and_b32 v17, v138, v153
    v_lshlrev_b32 v17, 4, v17
    v_lshrrev_b32 v17, v17, -1
    s_mov_b32 s73, 0x409d2a01
    s_mov_b32 s59, 0x3ef00000
    v_mul_u32_u24 v252, 0x100010, v0
    v_add_u32 v252, 0xc0004, v252
    v_lshlrev_b32 v253, 2, v0
    v_add_u32 v253, 150912, v253
    v_add_u32 v160, 0x0, v252
    v_add_u32 v168, 0x10001000, v252
    v_cvt_f32_f16 v161, v160
    v_cvt_f32_f16 v169, v168
    v_cvt_f32_f16_sdwa v162, v160 dst_sel:DWORD dst_unused:UNUSED_PAD src0_sel:WORD_1
    v_cvt_f32_f16_sdwa v170, v168 dst_sel:DWORD dst_unused:UNUSED_PAD src0_sel:WORD_1
    v_mul_f32 v163, 0x3f7fdde7, v161
    v_mul_f32 v171, 0x3f7fdde7, v169
    v_mul_f32 v164, 0x3f7fdde7, v162
    v_mul_f32 v172, 0x3f7fdde7, v170
    v_fma_f32 v163, v163, v161, s73
    v_fma_f32 v171, v171, v169, s73
    v_fma_f32 v164, v164, v162, s73
    v_fma_f32 v172, v172, v170, s73
    v_mul_f32 v163, -v161, v163
    v_mul_f32 v171, -v169, v171
    v_mul_f32 v164, -v162, v164
    v_mul_f32 v172, -v170, v172
    v_exp_f32 v165, v163
    v_exp_f32 v173, v171
    v_exp_f32 v166, v164
    v_exp_f32 v174, v172
    v_fma_f32 v163, v165, s59, s59
    v_fma_f32 v171, v173, s59, s59
    v_fma_f32 v164, v166, s59, s59
    v_fma_f32 v172, v174, s59, s59
    v_rcp_f32 v163, v163
    v_rcp_f32 v171, v171
    v_rcp_f32 v164, v164
    v_rcp_f32 v172, v172
    v_mul_f32 v163, v161, v163
    v_mul_f32 v171, v169, v171
    v_mul_f32 v164, v162, v164
    v_mul_f32 v172, v170, v172
    v_mul_f32 v165, -v165, v163
    v_mul_f32 v173, -v173, v171
    v_mul_f32 v166, -v166, v164
    v_mul_f32 v174, -v174, v172
    v_cvt_pk_bf16_f32 v167, v165, v166
    v_cvt_pk_bf16_f32 v175, v173, v174
    v_cvt_pk_bf16_f32 v160, v163, v164
    v_cvt_pk_bf16_f32 v168, v171, v172
    ds_write_b32 v253, v167 offset:8192
    ds_write_b32 v253, v160 offset:0
    ds_write_b32 v253, v175 offset:9216
    ds_write_b32 v253, v168 offset:1024
    v_add_u32 v160, 0x20002000, v252
    s_nop 0
    v_add_u32 v168, 0x30003000, v252
    v_cvt_f32_f16 v161, v160
    v_cvt_f32_f16 v169, v168
    v_cvt_f32_f16_sdwa v162, v160 dst_sel:DWORD dst_unused:UNUSED_PAD src0_sel:WORD_1
    v_cvt_f32_f16_sdwa v170, v168 dst_sel:DWORD dst_unused:UNUSED_PAD src0_sel:WORD_1
    v_mul_f32 v163, 0x3f7fdde7, v161
    v_mul_f32 v171, 0x3f7fdde7, v169
    v_mul_f32 v164, 0x3f7fdde7, v162
    v_mul_f32 v172, 0x3f7fdde7, v170
    v_fma_f32 v163, v163, v161, s73
    v_fma_f32 v171, v171, v169, s73
    v_fma_f32 v164, v164, v162, s73
    v_fma_f32 v172, v172, v170, s73
    v_mul_f32 v163, -v161, v163
    v_mul_f32 v171, -v169, v171
    v_mul_f32 v164, -v162, v164
    v_mul_f32 v172, -v170, v172
    v_exp_f32 v165, v163
    v_exp_f32 v173, v171
    v_exp_f32 v166, v164
    v_exp_f32 v174, v172
    v_fma_f32 v163, v165, s59, s59
    v_fma_f32 v171, v173, s59, s59
    v_fma_f32 v164, v166, s59, s59
    v_fma_f32 v172, v174, s59, s59
    v_rcp_f32 v163, v163
    v_rcp_f32 v171, v171
    v_rcp_f32 v164, v164
    v_rcp_f32 v172, v172
    v_mul_f32 v163, v161, v163
    v_mul_f32 v171, v169, v171
    v_mul_f32 v164, v162, v164
    v_mul_f32 v172, v170, v172
    v_mul_f32 v165, -v165, v163
    v_mul_f32 v173, -v173, v171
    v_mul_f32 v166, -v166, v164
    v_mul_f32 v174, -v174, v172
    v_cvt_pk_bf16_f32 v167, v165, v166
    v_cvt_pk_bf16_f32 v175, v173, v174
    v_cvt_pk_bf16_f32 v160, v163, v164
    v_cvt_pk_bf16_f32 v168, v171, v172
    ds_write_b32 v253, v167 offset:10240
    ds_write_b32 v253, v160 offset:2048
    ds_write_b32 v253, v175 offset:11264
    ds_write_b32 v253, v168 offset:3072
    v_add_u32 v160, 0x40004000, v252
    s_nop 0
    v_add_u32 v168, 0x50005000, v252
    v_cvt_f32_f16 v161, v160
    v_cvt_f32_f16 v169, v168
    v_cvt_f32_f16_sdwa v162, v160 dst_sel:DWORD dst_unused:UNUSED_PAD src0_sel:WORD_1
    v_cvt_f32_f16_sdwa v170, v168 dst_sel:DWORD dst_unused:UNUSED_PAD src0_sel:WORD_1
    v_mul_f32 v163, 0x3f7fdde7, v161
    v_mul_f32 v171, 0x40088889, v169
    v_mul_f32 v164, 0x3f7fdde7, v162
    v_mul_f32 v172, 0x40088889, v170
    v_fma_f32 v163, v163, v161, s73
    v_cvt_pk_bf16_f32 v168, v171, v172
    v_fma_f32 v164, v164, v162, s73
    v_mul_f32 v163, -v161, v163
    v_mul_f32 v164, -v162, v164
    v_exp_f32 v165, v163
    v_exp_f32 v166, v164
    v_fma_f32 v163, v165, s59, s59
    v_fma_f32 v164, v166, s59, s59
    v_rcp_f32 v163, v163
    v_rcp_f32 v164, v164
    v_mul_f32 v163, v161, v163
    v_mul_f32 v164, v162, v164
    v_mul_f32 v165, -v165, v163
    v_mul_f32 v166, -v166, v164
    v_cvt_pk_bf16_f32 v167, v165, v166
    v_cvt_pk_bf16_f32 v160, v163, v164
    ds_write_b32 v253, v167 offset:12288
    ds_write_b32 v253, v160 offset:4096
    ds_write_b32 v253, v168 offset:5120
    s_nop 0
    v_add_u32 v160, 0x60006000, v252
    v_add_u32 v168, 0x70007000, v252
    v_cvt_f32_f16 v161, v160
    v_cvt_f32_f16 v169, v168
    v_cvt_f32_f16_sdwa v162, v160 dst_sel:DWORD dst_unused:UNUSED_PAD src0_sel:WORD_1
    v_cvt_f32_f16_sdwa v170, v168 dst_sel:DWORD dst_unused:UNUSED_PAD src0_sel:WORD_1
    v_mul_f32 v163, 0x40088889, v161
    v_mul_f32 v171, 0x40088889, v169
    v_mul_f32 v164, 0x40088889, v162
    v_mul_f32 v172, 0x40088889, v170
    v_cvt_pk_bf16_f32 v160, v163, v164
    v_cvt_pk_bf16_f32 v168, v171, v172
    ds_write_b32 v253, v160 offset:6144
    ds_write_b32 v253, v168 offset:7168
    v_lshlrev_b32 v158, 6, v0
    v_add_u32 v158, 141312, v158
    v_cmp_gt_u32 vcc, 144, v0
    s_nop 1
    v_cndmask_b32 v158, v157, v158, vcc
    v_and_b32 v159, 3, v0
    v_lshl_add_u32 v160, v159, 2, v158
    v_lshrrev_b32 v159, 1, v159
    v_lshl_add_u32 v159, v159, 2, v158
    v_lshlrev_b32 v161, 4, v0
    v_add_u32 v161, 150528, v161
    v_cmp_gt_u32 vcc, 24, v0
    s_nop 1
    v_cndmask_b32 v161, v157, v161, vcc
    v_mov_b32 v164, 0
    v_mov_b32 v165, 0
    v_mov_b32 v166, 0
    v_mov_b32 v167, 0
    ds_write_b128 v158, v[164:167]
    ds_write_b128 v158, v[164:167] offset:16
    s_waitcnt lgkmcnt(9)
    ds_write_b128 v158, v[164:167] offset:32
    ds_write_b128 v158, v[164:167] offset:48
    s_waitcnt vmcnt(17)
    ds_write_b16 v160, v144
    ds_write_b16_d16_hi v160, v144 offset:34
    s_waitcnt vmcnt(16)
    ds_write_b16 v159, v145 offset:16
    ds_write_b16_d16_hi v159, v145 offset:48
    s_waitcnt vmcnt(15) lgkmcnt(13)
    ds_write_b16 v159, v146 offset:24
    ds_write_b16_d16_hi v159, v146 offset:56
    s_waitcnt vmcnt(14)
    v_lshlrev_b32 v168, 16, v148
    v_and_b32 v169, 0xffff0000, v148
    v_lshlrev_b32 v170, 16, v149
    v_and_b32 v171, 0xffff0000, v149
    s_waitcnt vmcnt(13)
    v_lshlrev_b32 v172, 16, v150
    v_and_b32 v173, 0xffff0000, v150
    v_lshlrev_b32 v174, 16, v151
    v_and_b32 v175, 0xffff0000, v151
    v_mul_f32 v168, v168, v172
    v_mul_f32 v169, v169, v173
    v_mul_f32 v170, v170, v174
    v_mul_f32 v171, v171, v175
    s_waitcnt lgkmcnt(14)
    ds_write_b128 v161, v[168:171]
    s_waitcnt vmcnt(12)
    v_xor_b32 v176, 0x80008000, v176
    v_xor_b32 v177, 0x80008000, v177
    v_xor_b32 v178, 0x80008000, v178
    v_xor_b32 v179, 0x80008000, v179
    s_nop 1
    v_mfma_f32_32x32x16_bf16 v[208:223], v[176:179], v[240:243], 0
    v_mfma_f32_32x32x16_bf16 v[208:223], v[176:179], v[244:247], v[208:223]
    s_waitcnt vmcnt(10)
    v_xor_b32 v180, 0x80008000, v180
    v_xor_b32 v181, 0x80008000, v181
    v_xor_b32 v182, 0x80008000, v182
    v_xor_b32 v183, 0x80008000, v183
    s_nop 1
    v_mfma_f32_32x32x16_bf16 v[192:207], v[180:183], v[240:243], 0
    v_mfma_f32_32x32x16_bf16 v[192:207], v[180:183], v[244:247], v[192:207]
    s_mov_b32 s74, 0
    s_mov_b32 s75, 12288
    buffer_load_dwordx4 a[0:3], v232, s[44:47], s74 offen offset:0
    buffer_load_dwordx4 a[4:7], v232, s[44:47], s75 offen offset:0
    buffer_load_dwordx4 a[8:11], v233, s[44:47], s74 offen offset:0
    buffer_load_dwordx4 a[12:15], v233, s[44:47], s75 offen offset:0
    s_mov_b32 s74, 24576
    s_mov_b32 s75, 36864
    buffer_load_dwordx4 a[16:19], v232, s[44:47], s74 offen offset:0
    buffer_load_dwordx4 a[20:23], v232, s[44:47], s75 offen offset:0
    buffer_load_dwordx4 a[24:27], v233, s[44:47], s74 offen offset:0
    buffer_load_dwordx4 a[28:31], v233, s[44:47], s75 offen offset:0
    s_mov_b32 s74, 49152
    s_mov_b32 s75, 61440
    buffer_load_dwordx4 a[32:35], v232, s[44:47], s74 offen offset:0
    buffer_load_dwordx4 a[36:39], v232, s[44:47], s75 offen offset:0
    buffer_load_dwordx4 a[40:43], v233, s[44:47], s74 offen offset:0
    buffer_load_dwordx4 a[44:47], v233, s[44:47], s75 offen offset:0
    s_mov_b32 s74, 0
    s_mov_b32 s75, 12288
    buffer_load_dwordx4 a[48:51], v232, s[44:47], s74 offen offset:256
    buffer_load_dwordx4 a[52:55], v232, s[44:47], s75 offen offset:256
    buffer_load_dwordx4 a[56:59], v233, s[44:47], s74 offen offset:256
    buffer_load_dwordx4 a[60:63], v233, s[44:47], s75 offen offset:256
    s_mov_b32 s74, 24576
    s_mov_b32 s75, 36864
    buffer_load_dwordx4 a[64:67], v232, s[44:47], s74 offen offset:256
    buffer_load_dwordx4 a[68:71], v232, s[44:47], s75 offen offset:256
    buffer_load_dwordx4 a[72:75], v233, s[44:47], s74 offen offset:256
    buffer_load_dwordx4 a[76:79], v233, s[44:47], s75 offen offset:256
    s_mov_b32 s74, 49152
    s_mov_b32 s75, 61440
    buffer_load_dwordx4 a[80:83], v232, s[44:47], s74 offen offset:256
    buffer_load_dwordx4 a[84:87], v232, s[44:47], s75 offen offset:256
    buffer_load_dwordx4 a[88:91], v233, s[44:47], s74 offen offset:256
    buffer_load_dwordx4 a[92:95], v233, s[44:47], s75 offen offset:256
    s_waitcnt vmcnt(23)
    v_mfma_f32_32x32x16_bf16 v[80:95], a[0:3], v[240:243], v[208:223]
    s_waitcnt vmcnt(21)
    v_mfma_f32_32x32x16_bf16 v[96:111], a[8:11], v[240:243], v[208:223]
    v_mfma_f32_32x32x16_bf16 v[80:95], a[4:7], v[244:247], v[80:95]
    s_waitcnt vmcnt(20)
    v_mfma_f32_32x32x16_bf16 v[96:111], a[12:15], v[244:247], v[96:111]
    s_waitcnt vmcnt(19)
    v_mfma_f32_32x32x16_bf16 v[112:127], a[16:19], v[240:243], v[208:223]
    s_waitcnt vmcnt(17)
    v_mfma_f32_32x32x16_bf16 v[128:143], a[24:27], v[240:243], v[208:223]
    v_mfma_f32_32x32x16_bf16 v[112:127], a[20:23], v[244:247], v[112:127]
    s_waitcnt vmcnt(16)
    v_mfma_f32_32x32x16_bf16 v[128:143], a[28:31], v[244:247], v[128:143]
    s_nop 2
    v_cvt_pk_f16_f32 v224, v80, v84
    v_cvt_pk_f16_f32 v225, v88, v92
    v_cvt_pk_f16_f32 v226, v96, v100
    v_cvt_pk_f16_f32 v227, v104, v108
    s_waitcnt vmcnt(15)
    v_mfma_f32_32x32x16_bf16 v[144:159], a[32:35], v[240:243], v[208:223]
    s_waitcnt lgkmcnt(14)
    ds_write_b128 v234, v[224:227] offset:0
    s_mov_b32 s74, 0
    v_cvt_pk_f16_f32 v228, v81, v85
    v_cvt_pk_f16_f32 v229, v89, v93
    v_cvt_pk_f16_f32 v230, v97, v101
    v_cvt_pk_f16_f32 v231, v105, v109
    s_waitcnt vmcnt(13)
    v_mfma_f32_32x32x16_bf16 v[160:175], a[40:43], v[240:243], v[208:223]
    s_waitcnt lgkmcnt(14)
    ds_write_b128 v234, v[228:231] offset:1024
    s_mov_b32 s75, 12288
    buffer_load_dwordx4 v[32:35], v232, s[44:47], s74 offen offset:512
    v_cvt_pk_f16_f32 v224, v82, v86
    v_cvt_pk_f16_f32 v225, v90, v94
    v_cvt_pk_f16_f32 v226, v98, v102
    v_cvt_pk_f16_f32 v227, v106, v110
    v_mfma_f32_32x32x16_bf16 v[144:159], a[36:39], v[244:247], v[144:159]
    s_waitcnt lgkmcnt(14)
    ds_write_b128 v234, v[224:227] offset:12288
    buffer_load_dwordx4 v[36:39], v232, s[44:47], s75 offen offset:512
    v_cvt_pk_f16_f32 v228, v83, v87
    v_cvt_pk_f16_f32 v229, v91, v95
    v_cvt_pk_f16_f32 v230, v99, v103
    v_cvt_pk_f16_f32 v231, v107, v111
    s_waitcnt vmcnt(14)
    v_mfma_f32_32x32x16_bf16 v[160:175], a[44:47], v[244:247], v[160:175]
    s_waitcnt vmcnt(10)
    s_waitcnt lgkmcnt(14)
    ds_write_b128 v234, v[228:231] offset:13312
    buffer_load_dwordx4 v[40:43], v233, s[44:47], s74 offen offset:512
    buffer_load_dwordx4 v[44:47], v233, s[44:47], s75 offen offset:512
    v_mfma_f32_32x32x16_bf16 v[160:175], a[232:235], v[244:247], v[160:175]
    v_cvt_pk_f16_f32 v224, v112, v116
    v_cvt_pk_f16_f32 v225, v120, v124
    v_cvt_pk_f16_f32 v226, v128, v132
    v_cvt_pk_f16_f32 v227, v136, v140
    v_mfma_f32_32x32x16_bf16 v[80:95], a[48:51], v[240:243], v[192:207]
    s_waitcnt lgkmcnt(14)
    ds_write_b128 v234, v[224:227] offset:2048
    s_mov_b32 s74, 24576
    v_cvt_pk_f16_f32 v228, v113, v117
    v_cvt_pk_f16_f32 v229, v121, v125
    v_cvt_pk_f16_f32 v230, v129, v133
    v_cvt_pk_f16_f32 v231, v137, v141
    v_mfma_f32_32x32x16_bf16 v[96:111], a[56:59], v[240:243], v[192:207]
    s_waitcnt lgkmcnt(14)
    ds_write_b128 v234, v[228:231] offset:3072
    s_mov_b32 s75, 36864
    buffer_load_dwordx4 v[48:51], v232, s[44:47], s74 offen offset:512
    v_cvt_pk_f16_f32 v224, v114, v118
    v_cvt_pk_f16_f32 v225, v122, v126
    v_cvt_pk_f16_f32 v226, v130, v134
    v_cvt_pk_f16_f32 v227, v138, v142
    v_mfma_f32_32x32x16_bf16 v[80:95], a[52:55], v[244:247], v[80:95]
    s_waitcnt lgkmcnt(14)
    ds_write_b128 v234, v[224:227] offset:14336
    buffer_load_dwordx4 v[52:55], v232, s[44:47], s75 offen offset:512
    v_cvt_pk_f16_f32 v228, v115, v119
    v_cvt_pk_f16_f32 v229, v123, v127
    v_cvt_pk_f16_f32 v230, v131, v135
    v_cvt_pk_f16_f32 v231, v139, v143
    v_mfma_f32_32x32x16_bf16 v[96:111], a[60:63], v[244:247], v[96:111]
    s_waitcnt vmcnt(10)
    s_waitcnt lgkmcnt(14)
    ds_write_b128 v234, v[228:231] offset:15360
    buffer_load_dwordx4 v[56:59], v233, s[44:47], s74 offen offset:512
    buffer_load_dwordx4 v[60:63], v233, s[44:47], s75 offen offset:512
    v_xor_b32 v184, 0x80008000, v184
    v_xor_b32 v185, 0x80008000, v185
    v_xor_b32 v186, 0x80008000, v186
    v_xor_b32 v187, 0x80008000, v187
    v_cvt_pk_f16_f32 v224, v144, v148
    v_cvt_pk_f16_f32 v225, v152, v156
    v_cvt_pk_f16_f32 v226, v160, v164
    v_cvt_pk_f16_f32 v227, v168, v172
    v_mfma_f32_32x32x16_bf16 v[112:127], a[64:67], v[240:243], v[192:207]
    s_waitcnt lgkmcnt(14)
    ds_write_b128 v234, v[224:227] offset:4096
    s_mov_b32 s74, 49152
    v_cvt_pk_f16_f32 v228, v145, v149
    v_cvt_pk_f16_f32 v229, v153, v157
    v_cvt_pk_f16_f32 v230, v161, v165
    v_cvt_pk_f16_f32 v231, v169, v173
    v_mfma_f32_32x32x16_bf16 v[128:143], a[72:75], v[240:243], v[192:207]
    s_waitcnt lgkmcnt(14)
    ds_write_b128 v234, v[228:231] offset:5120
    s_mov_b32 s75, 61440
    buffer_load_dwordx4 v[64:67], v232, s[44:47], s74 offen offset:512
    v_cvt_pk_f16_f32 v224, v146, v150
    v_cvt_pk_f16_f32 v225, v154, v158
    v_cvt_pk_f16_f32 v226, v162, v166
    v_cvt_pk_f16_f32 v227, v170, v174
    v_mfma_f32_32x32x16_bf16 v[112:127], a[68:71], v[244:247], v[112:127]
    s_waitcnt lgkmcnt(14)
    ds_write_b128 v234, v[224:227] offset:16384
    buffer_load_dwordx4 v[68:71], v232, s[44:47], s75 offen offset:512
    v_cvt_pk_f16_f32 v228, v147, v151
    v_cvt_pk_f16_f32 v229, v155, v159
    v_cvt_pk_f16_f32 v230, v163, v167
    v_cvt_pk_f16_f32 v231, v171, v175
    v_mfma_f32_32x32x16_bf16 v[128:143], a[76:79], v[244:247], v[128:143]
    s_waitcnt vmcnt(10)
    s_waitcnt lgkmcnt(14)
    ds_write_b128 v234, v[228:231] offset:17408
    buffer_load_dwordx4 v[72:75], v233, s[44:47], s74 offen offset:512
    buffer_load_dwordx4 v[76:79], v233, s[44:47], s75 offen offset:512
    v_sub_u32 v234, v234, v238
    v_mfma_f32_32x32x16_bf16 v[208:223], v[184:187], v[240:243], 0
    v_mfma_f32_32x32x16_bf16 v[208:223], v[184:187], v[244:247], v[208:223]
    v_cvt_pk_f16_f32 v224, v80, v84
    v_cvt_pk_f16_f32 v225, v88, v92
    v_cvt_pk_f16_f32 v226, v96, v100
    v_cvt_pk_f16_f32 v227, v104, v108
    v_mfma_f32_32x32x16_bf16 v[144:159], a[80:83], v[240:243], v[192:207]
    s_waitcnt lgkmcnt(0)
    s_barrier
    ds_write_b128 v234, v[224:227] offset:0
    ds_read_b128 a[192:195], v23 offset:4096
    ds_read_b128 a[196:199], v23 offset:5120
    ds_read_b128 a[200:203], v23 offset:14336
    ds_read_b128 a[204:207], v23 offset:15360
    ds_read_b128 a[208:211], v23 offset:24576
    ds_read_b128 a[212:215], v23 offset:25600
    ds_read_b128 a[216:219], v23 offset:34816
    s_add_u32 m0, s56, 6336
    s_nop 0
    buffer_load_dwordx4 v1, s[20:23], 0 offen offset:64 lds
    v_cvt_pk_f16_f32 v228, v81, v85
    v_cvt_pk_f16_f32 v229, v89, v93
    v_cvt_pk_f16_f32 v230, v97, v101
    v_cvt_pk_f16_f32 v231, v105, v109
    v_mfma_f32_32x32x16_bf16 v[160:175], a[88:91], v[240:243], v[192:207]
    ds_write_b128 v234, v[228:231] offset:1024
    ds_read_b128 a[220:223], v23 offset:35840
    ds_read_b128 a[0:3], v24 offset:0
    ds_read_b128 a[4:7], v24 offset:1024
    ds_read_b128 a[24:27], v24 offset:6144
    ds_read_b128 a[28:31], v24 offset:7168
    ds_read_b128 a[96:99], v24 offset:24576
    s_waitcnt lgkmcnt(14)
    ds_read_b128 a[100:103], v24 offset:25600
    s_add_u32 m0, s56, 7360
    s_nop 0
    buffer_load_dwordx4 v2, s[20:23], 0 offen offset:64 lds
    v_cvt_pk_f16_f32 v224, v82, v86
    v_cvt_pk_f16_f32 v225, v90, v94
    v_cvt_pk_f16_f32 v226, v98, v102
    v_cvt_pk_f16_f32 v227, v106, v110
    v_mfma_f32_32x32x16_bf16 v[144:159], a[84:87], v[244:247], v[144:159]
    s_waitcnt lgkmcnt(9)
    ds_write_b128 v234, v[224:227] offset:10240
    ds_read_b128 a[120:123], v24 offset:30720
    ds_read_b128 a[124:127], v24 offset:31744
    ds_read_b128 a[144:147], v24 offset:36864
    ds_read_b128 a[148:151], v24 offset:37888
    ds_read_b128 a[168:171], v24 offset:43008
    s_waitcnt lgkmcnt(13)
    ds_read_b128 a[172:175], v24 offset:44032
    ds_read_b128 a[48:51], v24 offset:12288
    s_add_u32 m0, s56, 8384
    s_nop 0
    buffer_load_dwordx4 v3, s[20:23], 0 offen offset:64 lds
    v_cvt_pk_f16_f32 v228, v83, v87
    v_cvt_pk_f16_f32 v229, v91, v95
    v_cvt_pk_f16_f32 v230, v99, v103
    v_cvt_pk_f16_f32 v231, v107, v111
    v_mfma_f32_32x32x16_bf16 v[160:175], a[92:95], v[244:247], v[160:175]
    s_waitcnt vmcnt(11)
    s_waitcnt lgkmcnt(9)
    ds_write_b128 v234, v[228:231] offset:11264
    ds_read_b128 a[52:55], v24 offset:13312
    ds_read_b128 a[72:75], v24 offset:18432
    ds_read_b128 a[76:79], v24 offset:19456
    ds_read_b128 a[8:11], v24 offset:2048
    ds_read_b128 a[12:15], v24 offset:3072
    s_waitcnt lgkmcnt(13)
    ds_read_b128 a[32:35], v24 offset:8192
    ds_read_b128 a[36:39], v24 offset:9216
    s_add_u32 m0, s56, 9408
    s_nop 0
    buffer_load_dwordx4 v4, s[20:23], 0 offen offset:64 lds
    v_mfma_f32_32x32x16_bf16 v[160:175], a[236:239], v[244:247], v[160:175]
    v_cvt_pk_f16_f32 v224, v112, v116
    v_cvt_pk_f16_f32 v225, v120, v124
    v_cvt_pk_f16_f32 v226, v128, v132
    v_cvt_pk_f16_f32 v227, v136, v140
    v_mfma_f32_32x32x16_bf16 v[80:95], v[32:35], v[240:243], v[208:223]
    s_waitcnt lgkmcnt(9)
    ds_write_b128 v234, v[224:227] offset:2048
    ds_read_b128 a[104:107], v24 offset:26624
    ds_read_b128 a[108:111], v24 offset:27648
    ds_read_b128 a[128:131], v24 offset:32768
    ds_read_b128 a[132:135], v24 offset:33792
    ds_read_b128 a[152:155], v24 offset:38912
    s_waitcnt lgkmcnt(13)
    ds_read_b128 a[156:159], v24 offset:39936
    ds_read_b128 a[176:179], v24 offset:45056
    s_add_u32 m0, s56, 10432
    v_cvt_pk_f16_f32 v228, v113, v117
    v_cvt_pk_f16_f32 v229, v121, v125
    v_cvt_pk_f16_f32 v230, v129, v133
    v_cvt_pk_f16_f32 v231, v137, v141
    v_mfma_f32_32x32x16_bf16 v[96:111], v[40:43], v[240:243], v[208:223]
    s_waitcnt lgkmcnt(9)
    ds_write_b128 v234, v[228:231] offset:3072
    ds_read_b128 a[180:183], v24 offset:46080
    ds_read_b128 a[56:59], v24 offset:14336
    ds_read_b128 a[60:63], v24 offset:15360
    ds_read_b128 a[80:83], v24 offset:20480
    ds_read_b128 a[84:87], v24 offset:21504
    s_waitcnt lgkmcnt(13)
    ds_read_b128 a[16:19], v24 offset:4096
    ds_read_b128 a[20:23], v24 offset:5120
    buffer_load_dwordx4 v5, s[20:23], 0 offen offset:64 lds
    s_add_u32 m0, s56, 11456
    v_cvt_pk_f16_f32 v224, v114, v118
    v_cvt_pk_f16_f32 v225, v122, v126
    v_cvt_pk_f16_f32 v226, v130, v134
    v_cvt_pk_f16_f32 v227, v138, v142
    v_mfma_f32_32x32x16_bf16 v[80:95], v[36:39], v[244:247], v[80:95]
    s_waitcnt lgkmcnt(9)
    ds_write_b128 v234, v[224:227] offset:12288
    ds_read_b128 a[40:43], v24 offset:10240
    ds_read_b128 a[44:47], v24 offset:11264
    ds_read_b128 a[112:115], v24 offset:28672
    ds_read_b128 a[116:119], v24 offset:29696
    ds_read_b128 a[136:139], v24 offset:34816
    s_waitcnt lgkmcnt(13)
    ds_read_b128 a[140:143], v24 offset:35840
    ds_read_b128 a[160:163], v24 offset:40960
    buffer_load_dwordx4 v6, s[20:23], 0 offen offset:64 lds
    s_add_u32 m0, s56, 12480
    v_cvt_pk_f16_f32 v228, v115, v119
    v_cvt_pk_f16_f32 v229, v123, v127
    v_cvt_pk_f16_f32 v230, v131, v135
    v_cvt_pk_f16_f32 v231, v139, v143
    v_mfma_f32_32x32x16_bf16 v[96:111], v[44:47], v[244:247], v[96:111]
    s_waitcnt vmcnt(10)
    s_waitcnt lgkmcnt(9)
    ds_write_b128 v234, v[228:231] offset:13312
    ds_read_b128 a[164:167], v24 offset:41984
    ds_read_b128 a[184:187], v24 offset:47104
    ds_read_b128 a[188:191], v24 offset:48128
    ds_read_b128 a[64:67], v24 offset:16384
    ds_read_b128 a[68:71], v24 offset:17408
    s_waitcnt lgkmcnt(13)
    ds_read_b128 a[88:91], v24 offset:22528
    ds_read_b128 a[92:95], v24 offset:23552
    buffer_load_dword v7, s[20:23], 0 offen offset:64 lds
    buffer_load_dword v254, v31, s[20:23], 0 offen
    v_cvt_pk_f16_f32 v224, v144, v148
    v_cvt_pk_f16_f32 v225, v152, v156
    v_cvt_pk_f16_f32 v226, v160, v164
    v_cvt_pk_f16_f32 v227, v168, v172
    v_mfma_f32_32x32x16_bf16 v[112:127], v[48:51], v[240:243], v[208:223]
    s_waitcnt lgkmcnt(0)
    s_barrier
    ds_write_b128 v234, v[224:227] offset:4096
    v_cvt_pk_f16_f32 v228, v145, v149
    v_cvt_pk_f16_f32 v229, v153, v157
    v_cvt_pk_f16_f32 v230, v161, v165
    v_cvt_pk_f16_f32 v231, v169, v173
    v_mfma_f32_32x32x16_bf16 v[128:143], v[56:59], v[240:243], v[208:223]
    ds_write_b128 v234, v[228:231] offset:5120
    v_cvt_pk_f16_f32 v224, v146, v150
    v_cvt_pk_f16_f32 v225, v154, v158
    v_cvt_pk_f16_f32 v226, v162, v166
    v_cvt_pk_f16_f32 v227, v170, v174
    v_mfma_f32_32x32x16_bf16 v[112:127], v[52:55], v[244:247], v[112:127]
    ds_write_b128 v234, v[224:227] offset:14336
    v_cvt_pk_f16_f32 v228, v147, v151
    v_cvt_pk_f16_f32 v229, v155, v159
    v_cvt_pk_f16_f32 v230, v163, v167
    v_cvt_pk_f16_f32 v231, v171, v175
    v_mfma_f32_32x32x16_bf16 v[128:143], v[60:63], v[244:247], v[128:143]
    s_waitcnt vmcnt(8)
    ds_write_b128 v234, v[228:231] offset:15360
    v_add_u32 v234, v234, v238
    v_cvt_pk_f16_f32 v224, v80, v84
    v_cvt_pk_f16_f32 v225, v88, v92
    v_cvt_pk_f16_f32 v226, v96, v100
    v_cvt_pk_f16_f32 v227, v104, v108
    v_mfma_f32_32x32x16_bf16 v[144:159], v[64:67], v[240:243], v[208:223]
    ds_write_b128 v234, v[224:227] offset:0
    v_cvt_pk_f16_f32 v228, v81, v85
    v_cvt_pk_f16_f32 v229, v89, v93
    v_cvt_pk_f16_f32 v230, v97, v101
    v_cvt_pk_f16_f32 v231, v105, v109
    v_mfma_f32_32x32x16_bf16 v[160:175], v[72:75], v[240:243], v[208:223]
    ds_write_b128 v234, v[228:231] offset:1024
    v_cvt_pk_f16_f32 v224, v82, v86
    v_cvt_pk_f16_f32 v225, v90, v94
    v_cvt_pk_f16_f32 v226, v98, v102
    v_cvt_pk_f16_f32 v227, v106, v110
    v_mfma_f32_32x32x16_bf16 v[144:159], v[68:71], v[244:247], v[144:159]
    ds_write_b128 v234, v[224:227] offset:12288
    v_cvt_pk_f16_f32 v228, v83, v87
    v_cvt_pk_f16_f32 v229, v91, v95
    v_cvt_pk_f16_f32 v230, v99, v103
    v_cvt_pk_f16_f32 v231, v107, v111
    v_mfma_f32_32x32x16_bf16 v[160:175], v[76:79], v[244:247], v[160:175]
    ds_write_b128 v234, v[228:231] offset:13312
    v_mfma_f32_32x32x16_bf16 v[160:175], a[240:243], v[244:247], v[160:175]
    v_cvt_pk_f16_f32 v224, v112, v116
    v_cvt_pk_f16_f32 v225, v120, v124
    v_cvt_pk_f16_f32 v226, v128, v132
    v_cvt_pk_f16_f32 v227, v136, v140
    ds_write_b128 v234, v[224:227] offset:2048
    v_cvt_pk_f16_f32 v228, v113, v117
    v_cvt_pk_f16_f32 v229, v121, v125
    v_cvt_pk_f16_f32 v230, v129, v133
    v_cvt_pk_f16_f32 v231, v137, v141
    ds_write_b128 v234, v[228:231] offset:3072
    v_cvt_pk_f16_f32 v224, v114, v118
    v_cvt_pk_f16_f32 v225, v122, v126
    v_cvt_pk_f16_f32 v226, v130, v134
    v_cvt_pk_f16_f32 v227, v138, v142
    ds_write_b128 v234, v[224:227] offset:14336
    v_cvt_pk_f16_f32 v228, v115, v119
    v_cvt_pk_f16_f32 v229, v123, v127
    v_cvt_pk_f16_f32 v230, v131, v135
    v_cvt_pk_f16_f32 v231, v139, v143
    ds_write_b128 v234, v[228:231] offset:15360
    v_cvt_pk_f16_f32 v224, v144, v148
    v_cvt_pk_f16_f32 v225, v152, v156
    v_cvt_pk_f16_f32 v226, v160, v164
    v_cvt_pk_f16_f32 v227, v168, v172
    ds_write_b128 v234, v[224:227] offset:4096
    v_cvt_pk_f16_f32 v228, v145, v149
    v_cvt_pk_f16_f32 v229, v153, v157
    v_cvt_pk_f16_f32 v230, v161, v165
    v_cvt_pk_f16_f32 v231, v169, v173
    ds_write_b128 v234, v[228:231] offset:5120
    v_cvt_pk_f16_f32 v224, v146, v150
    v_cvt_pk_f16_f32 v225, v154, v158
    v_cvt_pk_f16_f32 v226, v162, v166
    v_cvt_pk_f16_f32 v227, v170, v174
    ds_write_b128 v234, v[224:227] offset:16384
    v_cvt_pk_f16_f32 v228, v147, v151
    v_cvt_pk_f16_f32 v229, v155, v159
    v_cvt_pk_f16_f32 v230, v163, v167
    v_cvt_pk_f16_f32 v231, v171, v175
    s_waitcnt lgkmcnt(14)
    ds_write_b128 v234, v[228:231] offset:17408
L_conv0:
    s_waitcnt lgkmcnt(0)
    s_barrier
    ds_read_b128 a[232:235], v8 offset:0
    ds_read_b128 a[244:247], v8 offset:2560
    ds_read_b128 a[236:239], v12 offset:0
    ds_read_b128 a[248:251], v12 offset:2560
    ds_read_b128 a[240:243], v15 offset:1280
    ds_read_b128 a[252:255], v15 offset:3840
    ds_read_b128 v[176:179], v9 offset:0
    ds_read_b128 v[188:191], v9 offset:2560
    ds_read_b128 v[180:183], v13 offset:0
    ds_read_b128 v[232:235], v13 offset:2560
    ds_read_b128 v[184:187], v14 offset:1280
    ds_read_b128 v[236:239], v14 offset:3840
    ds_read_b128 v[32:35], v10 offset:0
    ds_read_b128 v[44:47], v10 offset:2560
    ds_read_b128 v[36:39], v14 offset:0
    s_waitcnt lgkmcnt(9)
    ds_read_b128 v[64:67], v14 offset:2560
    ds_read_b128 v[40:43], v13 offset:1280
    ds_read_b128 v[68:71], v13 offset:3840
    ds_read_b128 v[136:139], v11 offset:0
    ds_read_b128 v[148:151], v11 offset:2560
    ds_read_b128 v[140:143], v15 offset:0
    s_waitcnt lgkmcnt(9)
    ds_read_b128 v[72:75], v15 offset:2560
    ds_read_b128 v[144:147], v12 offset:1280
    ds_read_b128 v[76:79], v12 offset:3840
    ds_read_b128 v[56:59], v20 offset:2560
    ds_read_b128 v[60:63], v21 offset:2560
    ds_read_b128 v[52:55], v21 offset:0
    s_waitcnt lgkmcnt(13)
    ds_read_b128 v[48:51], v20 offset:0
    s_add_u32 m0, s56, -128
    ds_read_b128 v[192:195], v22 offset:0
    s_waitcnt lgkmcnt(1)
    buffer_load_dwordx4 v1, s[20:23], 0 offen offset:128 lds
    s_add_u32 m0, s56, 896
    ds_read_b128 v[200:203], v22 offset:16
    buffer_load_dwordx4 v2, s[20:23], 0 offen offset:128 lds
    s_add_u32 m0, s56, 1920
    ds_read_b128 v[196:199], v22 offset:256
    buffer_load_dwordx4 v3, s[20:23], 0 offen offset:128 lds
    s_add_u32 m0, s56, 2944
    ds_read_b128 v[204:207], v22 offset:272
    buffer_load_dwordx4 v4, s[20:23], 0 offen offset:128 lds
    s_add_u32 m0, s56, 3968
    s_nop 0
    buffer_load_dwordx4 v5, s[20:23], 0 offen offset:128 lds
    s_add_u32 m0, s56, 4992
    s_nop 0
    buffer_load_dwordx4 v6, s[20:23], 0 offen offset:128 lds
    s_add_u32 m0, s56, 6016
    s_nop 0
    buffer_load_dword v7, s[20:23], 0 offen offset:128 lds
    s_waitcnt vmcnt(7)
    s_branch L_conv
.p2alignl 12, 0xbf800000
.fill 622, 4, 0xbf800000
L_conv:
    v_cvt_pk_bf16_f32 v80, v80, v81
    v_cvt_pk_bf16_f32 v81, v82, v83
    v_cvt_pk_bf16_f32 v82, v84, v85
    s_waitcnt lgkmcnt(3)
    v_mfma_f32_16x16x32_bf16 v[128:131], v[192:195], a[232:235], 0
    ds_read_b128 a[232:235], v8 offset:6400
    v_cvt_pk_bf16_f32 v83, v86, v87
    v_cvt_pk_bf16_f32 v96, v96, v97
    v_mfma_f32_16x16x32_bf16 v[88:91], a[168:171], v[244:247], v[88:91]
    v_cvt_pk_bf16_f32 v97, v98, v99
    v_cvt_pk_bf16_f32 v98, v100, v101
    v_cvt_pk_bf16_f32 v99, v102, v103
    v_mfma_f32_16x16x32_bf16 v[152:155], v[192:195], a[244:247], 0
    ds_read_b128 a[244:247], v8 offset:8960
    ds_read_b128 v[192:195], v22 offset:512
    v_cvt_pk_bf16_f32 v112, v112, v113
    v_mfma_f32_16x16x32_bf16 v[92:95], a[172:175], v[244:247], v[92:95]
    s_waitcnt lgkmcnt(3)
    v_cvt_pk_bf16_f32 v88, v88, v89
    v_cvt_pk_bf16_f32 v89, v90, v91
    v_cvt_pk_bf16_f32 v113, v114, v115
    v_smfmac_f32_16x16x64_bf16 v[128:131], v[200:203], a[236:243], v16
    ds_read_b128 a[236:239], v12 offset:6400
    ds_read_b128 a[240:243], v15 offset:7680
    v_cvt_pk_bf16_f32 v114, v116, v117
    v_smfmac_f32_16x16x64_bf16 v[152:155], v[200:203], a[248:255], v16
    s_waitcnt lgkmcnt(6)
    ds_read_b128 a[248:251], v12 offset:8960
    ds_read_b128 a[252:255], v15 offset:10240
    ds_read_b128 v[200:203], v22 offset:528
    v_mfma_f32_16x16x32_bf16 v[224:227], v[196:199], v[176:179], 0
    ds_read_b128 v[176:179], v9 offset:6400
    v_cvt_pkrtz_f16_f32 v128, v128, v129
    v_cvt_pkrtz_f16_f32 v129, v130, v131
    v_mfma_f32_16x16x32_bf16 v[228:231], v[196:199], v[188:191], 0
    s_waitcnt lgkmcnt(9)
    ds_read_b128 v[188:191], v9 offset:8960
    ds_read_b128 v[196:199], v22 offset:768
    v_cvt_pkrtz_f16_f32 v152, v152, v153
    v_smfmac_f32_16x16x64_bf16 v[224:227], v[204:207], v[180:187], v16
    ds_read_b128 v[180:183], v13 offset:6400
    ds_read_b128 v[184:187], v14 offset:7680
    v_cvt_pkrtz_f16_f32 v153, v154, v155
    v_smfmac_f32_16x16x64_bf16 v[228:231], v[204:207], v[232:239], v16
    s_waitcnt lgkmcnt(10)
    ds_read_b128 v[232:235], v13 offset:8960
    ds_read_b128 v[236:239], v14 offset:10240
    ds_read_b128 v[204:207], v22 offset:784
    v_mfma_f32_16x16x32_bf16 v[132:135], v[192:195], v[32:35], 0
    v_cvt_pkrtz_f16_f32 v130, v224, v225
    v_cvt_pkrtz_f16_f32 v131, v226, v227
    v_cvt_pk_bf16_f32 v90, v92, v93
    v_mfma_f32_16x16x32_bf16 v[104:107], a[176:179], v[244:247], v[104:107]
    v_cvt_pkrtz_f16_f32 v154, v228, v229
    v_cvt_pkrtz_f16_f32 v155, v230, v231
    v_cvt_pk_bf16_f32 v91, v94, v95
    v_mfma_f32_16x16x32_bf16 v[156:159], v[192:195], v[44:47], 0
    ds_read_b128 v[192:195], v22 offset:1024
    v_cvt_pk_bf16_f32 v115, v118, v119
    v_mfma_f32_16x16x32_bf16 v[108:111], a[180:183], v[244:247], v[108:111]
    s_waitcnt lgkmcnt(9)
    ds_read_b128 v[32:35], v25 offset:0
    v_cvt_pk_bf16_f32 v104, v104, v105
    v_cvt_pk_bf16_f32 v105, v106, v107
    v_smfmac_f32_16x16x64_bf16 v[132:135], v[200:203], v[36:43], v16
    v_smfmac_f32_16x16x64_bf16 v[156:159], v[200:203], v[64:71], v16
    ds_read_b128 v[200:203], v22 offset:1040
    ds_read_b128 v[36:39], v25 offset:16
    v_mfma_f32_16x16x32_f16 v[248:251], a[228:231], v[128:131], 0
    v_cvt_pk_bf16_f32 v106, v108, v109
    v_cvt_pk_bf16_f32 v107, v110, v111
    s_waitcnt vmcnt(13)
    v_mfma_f32_16x16x32_f16 v[252:255], a[228:231], v[152:155], 0
    s_waitcnt lgkmcnt(9)
    v_cvt_pkrtz_f16_f32 v132, v132, v133
    v_cvt_pkrtz_f16_f32 v156, v156, v157
    v_cvt_pkrtz_f16_f32 v133, v134, v135
    v_cvt_pkrtz_f16_f32 v157, v158, v159
    v_dot2_f32_f16 v28, v128, v128, 0
    v_dot2_f32_f16 v30, v152, v152, 0
    v_dot2_f32_f16 v28, v129, v129, v28
    v_dot2_f32_f16 v30, v153, v153, v30
    v_dot2_f32_f16 v28, v130, v130, v28
    v_dot2_f32_f16 v30, v154, v154, v30
    v_dot2_f32_f16 v28, v131, v131, v28
    v_dot2_f32_f16 v30, v155, v155, v30
    v_dot2_f32_f16 v28, v132, v132, v28
    v_dot2_f32_f16 v30, v156, v156, v30
    v_dot2_f32_f16 v28, v133, v133, v28
    v_mfma_f32_16x16x32_bf16 v[224:227], v[196:199], v[136:139], 0
    ds_read_b128 v[216:219], v20 offset:8960
    v_mfma_f32_16x16x32_bf16 v[228:231], v[196:199], v[148:151], 0
    s_waitcnt lgkmcnt(5)
    ds_read_b128 v[196:199], v22 offset:1280
    s_nop 1
    v_smfmac_f32_16x16x64_bf16 v[224:227], v[204:207], v[140:147], v16
    buffer_store_dwordx4 v[80:83], v26, s[24:27], s82 offen offset:0 sc0 sc1
    v_smfmac_f32_16x16x64_bf16 v[228:231], v[204:207], v[72:79], v16
    s_waitcnt lgkmcnt(5)
    ds_read_b128 v[204:207], v22 offset:1296
    v_mfma_f32_16x16x32_bf16 v[136:139], v[192:195], a[232:235], 0
    ds_read_b128 a[232:235], v10 offset:6400
    v_mfma_f32_16x16x32_bf16 v[120:123], a[184:187], v[244:247], v[120:123]
    s_nop 0
    v_cvt_pkrtz_f16_f32 v134, v224, v225
    v_cvt_pkrtz_f16_f32 v135, v226, v227
    v_mfma_f32_16x16x32_bf16 v[160:163], v[192:195], a[244:247], 0
    s_waitcnt lgkmcnt(6)
    ds_read_b128 a[244:247], v10 offset:8960
    ds_read_b128 v[192:195], v22 offset:1536
    v_cvt_pkrtz_f16_f32 v158, v228, v229
    v_mfma_f32_16x16x16_bf16 v[80:83], v[18:19], v[56:57], v[32:35]
    s_waitcnt lgkmcnt(7)
    v_cvt_pkrtz_f16_f32 v159, v230, v231
    v_cvt_pk_bf16_f32 v120, v120, v121
    v_cvt_pk_bf16_f32 v121, v122, v123
    v_smfmac_f32_16x16x64_bf16 v[136:139], v[200:203], a[236:243], v16
    ds_read_b128 a[236:239], v14 offset:6400
    ds_read_b128 a[240:243], v13 offset:7680
    v_mfma_f32_16x16x32_bf16 v[124:127], a[188:191], v[244:247], v[124:127]
    buffer_store_dwordx4 v[88:91], v26, s[24:27], s83 offen offset:0 sc0 sc1
    v_smfmac_f32_16x16x64_bf16 v[160:163], v[200:203], a[248:255], v16
    ds_read_b128 a[248:251], v14 offset:8960
    ds_read_b128 a[252:255], v13 offset:10240
    ds_read_b128 v[200:203], v22 offset:1552
    v_mfma_f32_16x16x32_f16 v[248:251], a[228:231], v[132:135], v[248:251]
    v_cvt_pkrtz_f16_f32 v136, v136, v137
    v_cvt_pkrtz_f16_f32 v137, v138, v139
    v_cvt_pk_bf16_f32 v122, v124, v125
    v_mfma_f32_16x16x32_f16 v[252:255], a[228:231], v[156:159], v[252:255]
    s_waitcnt lgkmcnt(9)
    v_cvt_pkrtz_f16_f32 v160, v160, v161
    v_cvt_pkrtz_f16_f32 v161, v162, v163
    v_cvt_pk_bf16_f32 v123, v126, v127
    v_mfma_f32_16x16x32_bf16 v[224:227], v[196:199], v[176:179], 0
    ds_read_b128 v[176:179], v11 offset:6400
    v_permlane16_swap_b32 v128, v132
    v_mfma_f32_16x16x16_bf16 v[84:87], v[18:19], v[58:59], v[36:39]
    v_permlane16_swap_b32 v152, v156
    v_permlane16_swap_b32 v129, v133
    v_mfma_f32_16x16x32_bf16 v[228:231], v[196:199], v[188:191], 0
    ds_read_b128 v[188:191], v11 offset:8960
    ds_read_b128 v[196:199], v22 offset:1792
    v_mfma_f32_16x16x16_bf16 v[88:91], v[18:19], v[60:61], v[32:35]
    s_waitcnt lgkmcnt(11)
    v_smfmac_f32_16x16x64_bf16 v[224:227], v[204:207], v[180:187], v16
    ds_read_b128 v[180:183], v15 offset:6400
    ds_read_b128 v[184:187], v12 offset:7680
    v_smfmac_f32_16x16x64_bf16 v[228:231], v[204:207], v[232:239], v16
    s_waitcnt lgkmcnt(11)
    ds_read_b128 v[232:235], v15 offset:8960
    ds_read_b128 v[236:239], v12 offset:10240
    ds_read_b128 v[204:207], v22 offset:1808
    v_mfma_f32_16x16x16_bf16 v[92:95], v[18:19], v[62:63], v[36:39]
    s_waitcnt lgkmcnt(13)
    v_cvt_pkrtz_f16_f32 v138, v224, v225
    v_cvt_pkrtz_f16_f32 v139, v226, v227
    v_mfma_f32_16x16x32_bf16 v[140:143], v[192:195], a[232:235], 0
    s_waitcnt vmcnt(2)
    ds_read_b128 a[232:235], v8 offset:0
    buffer_store_dwordx4 v[96:99], v26, s[24:27], s82 offen offset:64 sc0 sc1
    v_mfma_f32_16x16x16_bf16 v[40:43], v[18:19], v[52:53], v[32:35]
    v_cvt_pkrtz_f16_f32 v162, v228, v229
    v_cvt_pkrtz_f16_f32 v163, v230, v231
    v_mfma_f32_16x16x32_bf16 v[164:167], v[192:195], a[244:247], 0
    s_waitcnt lgkmcnt(9)
    ds_read_b128 a[244:247], v8 offset:2560
    ds_read_b128 v[192:195], v22 offset:2048
    buffer_store_dwordx4 v[104:107], v26, s[24:27], s83 offen offset:64 sc0 sc1
    v_smfmac_f32_16x16x64_bf16 v[140:143], v[200:203], a[236:243], v16
    ds_read_b128 a[236:239], v12 offset:0
    ds_read_b128 a[240:243], v15 offset:1280
    v_smfmac_f32_16x16x64_bf16 v[164:167], v[200:203], a[248:255], v16
    s_waitcnt lgkmcnt(11)
    ds_read_b128 a[248:251], v12 offset:2560
    ds_read_b128 a[252:255], v15 offset:3840
    ds_read_b128 v[200:203], v22 offset:2064
    v_mfma_f32_16x16x32_f16 v[248:251], a[228:231], v[136:139], v[248:251]
    v_cvt_pkrtz_f16_f32 v140, v140, v141
    v_cvt_pkrtz_f16_f32 v141, v142, v143
    v_mfma_f32_16x16x32_f16 v[252:255], a[228:231], v[160:163], v[252:255]
    s_waitcnt lgkmcnt(13)
    v_cvt_pkrtz_f16_f32 v164, v164, v165
    v_cvt_pkrtz_f16_f32 v165, v166, v167
    v_mfma_f32_16x16x32_bf16 v[224:227], v[196:199], v[176:179], 0
    ds_read_b128 v[176:179], v9 offset:0
    buffer_store_dwordx4 v[112:115], v26, s[24:27], s82 offen offset:128 sc0 sc1
    v_mfma_f32_16x16x16_bf16 v[44:47], v[18:19], v[54:55], v[36:39]
    s_waitcnt lgkmcnt(13)
    ds_read_b128 v[220:223], v21 offset:8960
    v_mfma_f32_16x16x32_bf16 v[228:231], v[196:199], v[188:191], 0
    s_waitcnt lgkmcnt(10)
    ds_read_b128 v[188:191], v9 offset:2560
    ds_read_b128 v[196:199], v22 offset:2304
    v_smfmac_f32_16x16x64_bf16 v[224:227], v[204:207], v[180:187], v16
    ds_read_b128 v[180:183], v13 offset:0
    ds_read_b128 v[184:187], v14 offset:1280
    v_smfmac_f32_16x16x64_bf16 v[228:231], v[204:207], v[232:239], v16
    s_waitcnt lgkmcnt(11)
    ds_read_b128 v[232:235], v13 offset:2560
    ds_read_b128 v[236:239], v14 offset:3840
    ds_read_b128 v[204:207], v22 offset:2320
    v_mfma_f32_16x16x16_bf16 v[32:35], v[18:19], v[48:49], v[32:35]
    s_waitcnt lgkmcnt(13)
    ds_read_b128 v[212:215], v21 offset:6400
    v_cvt_pkrtz_f16_f32 v142, v224, v225
    v_cvt_pkrtz_f16_f32 v143, v226, v227
    v_cvt_pkrtz_f16_f32 v166, v228, v229
    v_dot2_f32_f16 v30, v157, v157, v30
    v_dot2_f32_f16 v28, v134, v134, v28
    v_dot2_f32_f16 v30, v158, v158, v30
    v_dot2_f32_f16 v28, v135, v135, v28
    v_dot2_f32_f16 v30, v159, v159, v30
    v_dot2_f32_f16 v28, v136, v136, v28
    v_dot2_f32_f16 v30, v160, v160, v30
    v_dot2_f32_f16 v28, v137, v137, v28
    v_dot2_f32_f16 v30, v161, v161, v30
    v_dot2_f32_f16 v28, v138, v138, v28
    v_dot2_f32_f16 v30, v162, v162, v30
    v_dot2_f32_f16 v28, v139, v139, v28
    v_dot2_f32_f16 v30, v163, v163, v30
    v_dot2_f32_f16 v28, v140, v140, v28
    v_dot2_f32_f16 v30, v164, v164, v30
    v_dot2_f32_f16 v28, v141, v141, v28
    v_dot2_f32_f16 v30, v165, v165, v30
    v_permlane16_swap_b32 v153, v157
    v_permlane16_swap_b32 v130, v134
    v_permlane16_swap_b32 v154, v158
    v_mfma_f32_16x16x32_bf16 v[144:147], v[192:195], a[232:235], 0
    s_waitcnt lgkmcnt(13)
    ds_read_b128 a[232:235], v10 offset:0
    v_permlane16_swap_b32 v131, v135
    v_mfma_f32_16x16x32_bf16 v[168:171], v[192:195], a[244:247], 0
    s_waitcnt lgkmcnt(11)
    ds_read_b128 a[244:247], v10 offset:2560
    ds_read_b128 v[192:195], v22 offset:2560
    v_permlane16_swap_b32 v155, v159
    v_smfmac_f32_16x16x64_bf16 v[144:147], v[200:203], a[236:243], v16
    s_waitcnt lgkmcnt(12)
    ds_read_b128 a[236:239], v14 offset:0
    ds_read_b128 a[240:243], v13 offset:1280
    v_cvt_pkrtz_f16_f32 v167, v230, v231
    v_smfmac_f32_16x16x64_bf16 v[168:171], v[200:203], a[248:255], v16
    s_waitcnt lgkmcnt(11)
    ds_read_b128 a[248:251], v14 offset:2560
    ds_read_b128 a[252:255], v13 offset:3840
    ds_read_b128 v[200:203], v22 offset:2576
    v_mfma_f32_16x16x32_f16 v[248:251], a[228:231], v[140:143], v[248:251]
    v_cvt_pkrtz_f16_f32 v144, v144, v145
    v_cvt_pkrtz_f16_f32 v145, v146, v147
    v_mfma_f32_16x16x32_f16 v[252:255], a[228:231], v[164:167], v[252:255]
    v_cvt_pkrtz_f16_f32 v168, v168, v169
    v_cvt_pkrtz_f16_f32 v169, v170, v171
    v_mfma_f32_16x16x32_bf16 v[224:227], v[196:199], v[176:179], 0
    s_waitcnt lgkmcnt(13)
    ds_read_b128 v[176:179], v11 offset:0
    v_mfma_f32_16x16x32_bf16 v[228:231], v[196:199], v[188:191], 0
    s_waitcnt lgkmcnt(10)
    ds_read_b128 v[188:191], v11 offset:2560
    ds_read_b128 v[196:199], v22 offset:2816
    v_smfmac_f32_16x16x64_bf16 v[224:227], v[204:207], v[180:187], v16
    ds_read_b128 v[180:183], v15 offset:0
    ds_read_b128 v[184:187], v12 offset:1280
    v_mfma_f32_16x16x16_bf16 v[36:39], v[18:19], v[50:51], v[36:39]
    s_waitcnt lgkmcnt(12)
    ds_read_b128 v[48:51], v25 offset:128
    ds_read_b128 v[52:55], v25 offset:144
    v_smfmac_f32_16x16x64_bf16 v[228:231], v[204:207], v[232:239], v16
    s_waitcnt lgkmcnt(11)
    ds_read_b128 v[232:235], v15 offset:2560
    ds_read_b128 v[236:239], v12 offset:3840
    ds_read_b128 v[204:207], v22 offset:2832
    v_mfma_f32_16x16x32_bf16 v[148:151], v[192:195], a[232:235], 0
    v_cvt_pkrtz_f16_f32 v146, v224, v225
    v_cvt_pkrtz_f16_f32 v147, v226, v227
    v_mfma_f32_16x16x32_bf16 v[172:175], v[192:195], a[244:247], 0
    s_waitcnt lgkmcnt(10)
    buffer_store_dwordx4 v[120:123], v26, s[24:27], s83 offen offset:128 sc0 sc1
    v_cvt_pkrtz_f16_f32 v170, v228, v229
    v_cvt_pkrtz_f16_f32 v171, v230, v231
    v_smfmac_f32_16x16x64_bf16 v[148:151], v[200:203], a[236:243], v16
    ds_read_b128 v[64:67], v25 offset:256
    v_add_u32 v26, s54, v26
    v_smfmac_f32_16x16x64_bf16 v[172:175], v[200:203], a[248:255], v16
    ds_read_b128 v[68:71], v25 offset:272
    ds_read_b128 a[232:235], v23 offset:0
    ds_read_b128 a[236:239], v23 offset:1024
    v_mfma_f32_16x16x32_f16 v[248:251], a[228:231], v[144:147], v[248:251]
    s_nop 0
    v_cvt_pkrtz_f16_f32 v148, v148, v149
    v_cvt_pkrtz_f16_f32 v149, v150, v151
    v_mfma_f32_16x16x32_f16 v[252:255], a[228:231], v[168:171], v[252:255]
    s_waitcnt lgkmcnt(11)
    v_cvt_pkrtz_f16_f32 v172, v172, v173
    v_cvt_pkrtz_f16_f32 v173, v174, v175
    v_mfma_f32_16x16x32_bf16 v[224:227], v[196:199], v[176:179], 0
    s_waitcnt lgkmcnt(9)
    v_mfma_f32_16x16x32_bf16 v[228:231], v[196:199], v[188:191], 0
    s_mov_b32 s54, 786432
    ds_read_b128 a[240:243], v23 offset:2048
    ds_read_b128 a[244:247], v23 offset:3072
    s_waitcnt lgkmcnt(6)
    v_smfmac_f32_16x16x64_bf16 v[224:227], v[204:207], v[180:187], v16
    ds_read_b128 v[208:211], v20 offset:6400
    ds_read_b128 a[248:251], v23 offset:4096
    v_smfmac_f32_16x16x64_bf16 v[228:231], v[204:207], v[232:239], v16
    ds_read_b128 a[252:255], v23 offset:5120
L_mid:
    v_permlane16_swap_b32 v136, v140
    v_permlane16_swap_b32 v160, v164
    v_dot2_f32_f16 v28, v142, v142, v28
    v_dot2_f32_f16 v30, v166, v166, v30
    v_cvt_pkrtz_f16_f32 v150, v224, v225
    v_cvt_pkrtz_f16_f32 v151, v226, v227
    v_dot2_f32_f16 v28, v143, v143, v28
    v_cvt_pkrtz_f16_f32 v174, v228, v229
    v_mfma_f32_16x16x32_f16 v[248:251], a[228:231], v[148:151], v[248:251]
    v_cvt_pkrtz_f16_f32 v175, v230, v231
    v_permlane16_swap_b32 v137, v141
    v_permlane16_swap_b32 v161, v165
    v_mfma_f32_16x16x32_f16 v[252:255], a[228:231], v[172:175], v[252:255]
    s_cmp_eq_u32 s52, 3
    v_permlane16_swap_b32 v138, v142
    v_permlane16_swap_b32 v162, v166
    v_permlane16_swap_b32 v139, v143
    v_dot2_f32_f16 v30, v167, v167, v30
    v_dot2_f32_f16 v28, v144, v144, v28
    v_dot2_f32_f16 v30, v168, v168, v30
    v_dot2_f32_f16 v28, v145, v145, v28
    v_dot2_f32_f16 v30, v169, v169, v30
    v_dot2_f32_f16 v28, v146, v146, v28
    v_dot2_f32_f16 v30, v170, v170, v30
    v_dot2_f32_f16 v28, v147, v147, v28
    v_dot2_f32_f16 v30, v171, v171, v30
    v_dot2_f32_f16 v28, v148, v148, v28
    v_dot2_f32_f16 v30, v172, v172, v30
    v_dot2_f32_f16 v28, v149, v149, v28
    v_dot2_f32_f16 v30, v173, v173, v30
    v_dot2_f32_f16 v28, v150, v150, v28
    v_dot2_f32_f16 v30, v174, v174, v30
    v_dot2_f32_f16 v28, v151, v151, v28
    v_dot2_f32_f16 v30, v175, v175, v30
    v_permlane16_swap_b32 v163, v167
    v_permlane16_swap_b32 v144, v148
    v_permlane16_swap_b32 v168, v172
    v_mfma_f32_16x16x16_bf16 v[96:99], v[18:19], v[216:217], v[48:51]
    s_cselect_b32 s57, 0x40000000, 786432
    ds_read_b128 v[240:243], v20 offset:2560
    ds_read_b128 v[244:247], v21 offset:2560
    v_add_u32 v1, s57, v1
    v_mfma_f32_16x16x16_bf16 v[100:103], v[18:19], v[218:219], v[52:55]
    ds_read_b128 v[236:239], v21 offset:0
    ds_read_b128 v[232:235], v20 offset:0
    v_add_u32 v2, s57, v2
    v_mfma_f32_16x16x16_bf16 v[104:107], v[18:19], v[220:221], v[48:51]
    v_add_u32 v3, s57, v3
    v_add_u32 v4, s57, v4
    v_add_u32 v5, s57, v5
    v_mfma_f32_16x16x16_bf16 v[108:111], v[18:19], v[222:223], v[52:55]
    v_add_u32 v6, s57, v6
    v_add_u32 v7, s57, v7
    v_add_u32 v31, s57, v31
    v_mfma_f32_16x16x16_bf16 v[56:59], v[18:19], v[212:213], v[48:51]
    v_permlane16_swap_b32 v145, v149
    v_permlane16_swap_b32 v169, v173
    v_mfma_f32_16x16x16_bf16 v[60:63], v[18:19], v[214:215], v[52:55]
    s_waitcnt lgkmcnt(6)
    v_permlane16_swap_b32 v146, v150
    v_permlane16_swap_b32 v170, v174
    v_mfma_f32_16x16x16_bf16 v[48:51], v[18:19], v[208:209], v[48:51]
    v_permlane16_swap_b32 v147, v151
    v_permlane16_swap_b32 v171, v175
    v_mfma_f32_16x16x16_bf16 v[52:55], v[18:19], v[210:211], v[52:55]
    v_mov_b32 v27, v28
    v_mov_b32 v29, v30
    s_nop 0
    v_permlane32_swap_b32 v27, v28
    v_permlane32_swap_b32 v29, v30
    v_add_f32 v28, v27, v28
    v_add_f32 v30, v29, v30
    v_mul_f32 v27, 0x3c2aaaab, v248
    v_mul_f32 v29, 0x3c2aaaab, v252
    v_mul_f32 v28, 0x3c2aaaab, v28
    v_mul_f32 v30, 0x3c2aaaab, v30
    v_fma_f32 v28, -v27, v27, v28
    v_fma_f32 v30, -v29, v29, v30
    v_max_f32 v28, 0, v28
    v_max_f32 v30, 0, v30
    v_add_f32 v28, 0x3727c5ac, v28
    v_add_f32 v30, 0x3727c5ac, v30
    v_rsq_f32 v28, v28
    v_rsq_f32 v30, v30
    v_fma_mixlo_f16 v28, v28, s59, 0
    v_fma_mixlo_f16 v30, v30, s59, 0
    v_fma_mixhi_f16 v28, -v27, v28, 0 op_sel_hi:[0,1,0]
    v_fma_mixhi_f16 v30, -v29, v30, 0 op_sel_hi:[0,1,0]
    v_mov_b32 v27, v28
    v_mov_b32 v29, v30
    s_nop 0
    v_permlane16_swap_b32 v28, v27
    v_permlane16_swap_b32 v30, v29
    v_pk_fma_f16 v128, v128, v28, v28 op_sel:[0,0,1] op_sel_hi:[1,0,1]
    v_pk_fma_f16 v129, v129, v28, v28 op_sel:[0,0,1] op_sel_hi:[1,0,1]
    v_pk_fma_f16 v130, v130, v28, v28 op_sel:[0,0,1] op_sel_hi:[1,0,1]
    v_pk_fma_f16 v131, v131, v28, v28 op_sel:[0,0,1] op_sel_hi:[1,0,1]
    v_pk_fma_f16 v132, v132, v27, v27 op_sel:[0,0,1] op_sel_hi:[1,0,1]
    v_pk_fma_f16 v133, v133, v27, v27 op_sel:[0,0,1] op_sel_hi:[1,0,1]
    v_mfma_f32_16x16x32_f16 v[176:179], a[232:235], v[128:131], 0
    v_pk_fma_f16 v134, v134, v27, v27 op_sel:[0,0,1] op_sel_hi:[1,0,1]
    v_pk_fma_f16 v135, v135, v27, v27 op_sel:[0,0,1] op_sel_hi:[1,0,1]
    v_pk_fma_f16 v136, v136, v28, v28 op_sel:[0,0,1] op_sel_hi:[1,0,1]
    v_pk_fma_f16 v137, v137, v28, v28 op_sel:[0,0,1] op_sel_hi:[1,0,1]
    v_mfma_f32_16x16x32_f16 v[184:187], a[232:235], v[132:135], 0
    v_pk_fma_f16 v138, v138, v28, v28 op_sel:[0,0,1] op_sel_hi:[1,0,1]
    v_pk_fma_f16 v139, v139, v28, v28 op_sel:[0,0,1] op_sel_hi:[1,0,1]
    v_pk_fma_f16 v140, v140, v27, v27 op_sel:[0,0,1] op_sel_hi:[1,0,1]
    v_mfma_f32_16x16x32_f16 v[180:183], a[236:239], v[128:131], 0
    v_pk_fma_f16 v141, v141, v27, v27 op_sel:[0,0,1] op_sel_hi:[1,0,1]
    v_pk_fma_f16 v142, v142, v27, v27 op_sel:[0,0,1] op_sel_hi:[1,0,1]
    v_pk_fma_f16 v143, v143, v27, v27 op_sel:[0,0,1] op_sel_hi:[1,0,1]
    v_mfma_f32_16x16x32_f16 v[188:191], a[236:239], v[132:135], 0
    v_pk_fma_f16 v147, v147, v28, v28 op_sel:[0,0,1] op_sel_hi:[1,0,1]
    v_pk_fma_f16 v144, v144, v28, v28 op_sel:[0,0,1] op_sel_hi:[1,0,1]
    v_pk_fma_f16 v145, v145, v28, v28 op_sel:[0,0,1] op_sel_hi:[1,0,1]
    v_mfma_f32_16x16x32_f16 v[176:179], a[240:243], v[136:139], v[176:179]
    v_bfi_b32 v147, v17, v147, s84
    v_pk_fma_f16 v146, v146, v28, v28 op_sel:[0,0,1] op_sel_hi:[1,0,1]
    v_pk_fma_f16 v151, v151, v27, v27 op_sel:[0,0,1] op_sel_hi:[1,0,1]
    v_mfma_f32_16x16x32_f16 v[184:187], a[240:243], v[140:143], v[184:187]
    v_pk_fma_f16 v148, v148, v27, v27 op_sel:[0,0,1] op_sel_hi:[1,0,1]
    v_pk_fma_f16 v149, v149, v27, v27 op_sel:[0,0,1] op_sel_hi:[1,0,1]
    v_bfi_b32 v151, v17, v151, s84
    v_mfma_f32_16x16x32_f16 v[180:183], a[244:247], v[136:139], v[180:183]
    v_pk_fma_f16 v150, v150, v27, v27 op_sel:[0,0,1] op_sel_hi:[1,0,1]
    v_pk_fma_f16 v152, v152, v30, v30 op_sel:[0,0,1] op_sel_hi:[1,0,1]
    v_pk_fma_f16 v153, v153, v30, v30 op_sel:[0,0,1] op_sel_hi:[1,0,1]
    v_mfma_f32_16x16x32_f16 v[188:191], a[244:247], v[140:143], v[188:191]
    s_waitcnt lgkmcnt(5)
    v_pk_fma_f16 v154, v154, v30, v30 op_sel:[0,0,1] op_sel_hi:[1,0,1]
    v_pk_fma_f16 v155, v155, v30, v30 op_sel:[0,0,1] op_sel_hi:[1,0,1]
    v_pk_fma_f16 v156, v156, v29, v29 op_sel:[0,0,1] op_sel_hi:[1,0,1]
    v_mfma_f32_16x16x32_f16 v[176:179], a[248:251], v[144:147], v[176:179]
    v_pk_fma_f16 v157, v157, v29, v29 op_sel:[0,0,1] op_sel_hi:[1,0,1]
    v_pk_fma_f16 v158, v158, v29, v29 op_sel:[0,0,1] op_sel_hi:[1,0,1]
    v_pk_fma_f16 v159, v159, v29, v29 op_sel:[0,0,1] op_sel_hi:[1,0,1]
    v_mfma_f32_16x16x32_f16 v[184:187], a[248:251], v[148:151], v[184:187]
    s_waitcnt lgkmcnt(4)
    v_pk_fma_f16 v160, v160, v30, v30 op_sel:[0,0,1] op_sel_hi:[1,0,1]
    v_pk_fma_f16 v161, v161, v30, v30 op_sel:[0,0,1] op_sel_hi:[1,0,1]
    v_pk_fma_f16 v162, v162, v30, v30 op_sel:[0,0,1] op_sel_hi:[1,0,1]
    v_mfma_f32_16x16x32_f16 v[180:183], a[252:255], v[144:147], v[180:183]
    v_pk_fma_f16 v163, v163, v30, v30 op_sel:[0,0,1] op_sel_hi:[1,0,1]
    v_pk_fma_f16 v164, v164, v29, v29 op_sel:[0,0,1] op_sel_hi:[1,0,1]
    v_pk_fma_f16 v165, v165, v29, v29 op_sel:[0,0,1] op_sel_hi:[1,0,1]
    v_mfma_f32_16x16x32_f16 v[188:191], a[252:255], v[148:151], v[188:191]
    v_pk_fma_f16 v166, v166, v29, v29 op_sel:[0,0,1] op_sel_hi:[1,0,1]
    v_pk_fma_f16 v167, v167, v29, v29 op_sel:[0,0,1] op_sel_hi:[1,0,1]
    v_pk_fma_f16 v171, v171, v30, v30 op_sel:[0,0,1] op_sel_hi:[1,0,1]
    v_mfma_f32_16x16x32_f16 v[192:195], a[232:235], v[152:155], 0
    v_pk_fma_f16 v168, v168, v30, v30 op_sel:[0,0,1] op_sel_hi:[1,0,1]
    v_pk_fma_f16 v169, v169, v30, v30 op_sel:[0,0,1] op_sel_hi:[1,0,1]
    v_bfi_b32 v171, v17, v171, s84
    v_mfma_f32_16x16x32_f16 v[200:203], a[232:235], v[156:159], 0
    ds_read_b128 a[232:235], v23 offset:10240
    v_pk_fma_f16 v170, v170, v30, v30 op_sel:[0,0,1] op_sel_hi:[1,0,1]
    v_pk_fma_f16 v175, v175, v29, v29 op_sel:[0,0,1] op_sel_hi:[1,0,1]
    v_mfma_f32_16x16x32_f16 v[196:199], a[236:239], v[152:155], 0
    v_pk_fma_f16 v172, v172, v29, v29 op_sel:[0,0,1] op_sel_hi:[1,0,1]
    v_pk_fma_f16 v173, v173, v29, v29 op_sel:[0,0,1] op_sel_hi:[1,0,1]
    v_bfi_b32 v175, v17, v175, s84
    v_mfma_f32_16x16x32_f16 v[204:207], a[236:239], v[156:159], 0
    ds_read_b128 a[236:239], v23 offset:11264
    v_pk_fma_f16 v174, v174, v29, v29 op_sel:[0,0,1] op_sel_hi:[1,0,1]
    v_cvt_pkrtz_f16_f32 v208, v176, v177
    v_mfma_f32_16x16x32_f16 v[192:195], a[240:243], v[160:163], v[192:195]
    v_pk_lshrrev_b16 v208, 3, v208 op_sel_hi:[0,1]
    v_mad_u32_u16 v209, v208, 2, s85
    v_mad_u32_u16 v208, v208, 2, s85 op_sel:[1,0,0,0]
    v_mfma_f32_16x16x32_f16 v[200:203], a[240:243], v[164:167], v[200:203]
    ds_read_u16 v209, v209
    ds_read_u16_d16_hi v208, v208
    ds_read_b128 a[240:243], v23 offset:12288
    v_mfma_f32_16x16x32_f16 v[196:199], a[244:247], v[160:163], v[196:199]
    v_cvt_pkrtz_f16_f32 v210, v178, v179
    v_pk_lshrrev_b16 v210, 3, v210 op_sel_hi:[0,1]
    v_mad_u32_u16 v211, v210, 2, s85
    v_mfma_f32_16x16x32_f16 v[204:207], a[244:247], v[164:167], v[204:207]
    ds_read_u16 v211, v211
    ds_read_b128 a[244:247], v23 offset:13312
    v_mad_u32_u16 v210, v210, 2, s85 op_sel:[1,0,0,0]
    v_mfma_f32_16x16x32_f16 v[192:195], a[248:251], v[168:171], v[192:195]
    ds_read_u16_d16_hi v210, v210
    v_cvt_pkrtz_f16_f32 v212, v180, v181
    v_pk_lshrrev_b16 v212, 3, v212 op_sel_hi:[0,1]
    v_mfma_f32_16x16x32_f16 v[200:203], a[248:251], v[172:175], v[200:203]
    s_waitcnt lgkmcnt(11)
    ds_read_b128 a[248:251], v23 offset:14336
    v_mad_u32_u16 v213, v212, 2, s85
    v_mad_u32_u16 v212, v212, 2, s85 op_sel:[1,0,0,0]
    v_mfma_f32_16x16x32_f16 v[196:199], a[252:255], v[168:171], v[196:199]
    s_add_u32 m0, s56, 6336
    ds_read_u16 v213, v213
    ds_read_u16_d16_hi v212, v212
    buffer_load_dwordx4 v1, s[20:23], 0 offen offset:64 lds
    v_mfma_f32_16x16x32_f16 v[204:207], a[252:255], v[172:175], v[204:207]
    s_waitcnt lgkmcnt(13)
    ds_read_b128 a[252:255], v23 offset:15360
    v_cvt_pkrtz_f16_f32 v214, v182, v183
    v_pk_lshrrev_b16 v214, 3, v214 op_sel_hi:[0,1]
    v_mfma_f32_16x16x16_bf16 v[112:115], v[18:19], v[240:241], v[64:67]
    v_mad_u32_u16 v215, v214, 2, s85
    v_mad_u32_u16 v214, v214, 2, s85 op_sel:[1,0,0,0]
    v_cvt_pkrtz_f16_f32 v216, v184, v185
    v_mfma_f32_16x16x16_bf16 v[116:119], v[18:19], v[242:243], v[68:71]
    s_waitcnt lgkmcnt(12)
    ds_read_u16 v215, v215
    ds_read_u16_d16_hi v214, v214
    v_pk_lshrrev_b16 v216, 3, v216 op_sel_hi:[0,1]
    v_mfma_f32_16x16x16_bf16 v[120:123], v[18:19], v[244:245], v[64:67]
    v_mad_u32_u16 v217, v216, 2, s85
    v_mad_u32_u16 v216, v216, 2, s85 op_sel:[1,0,0,0]
    v_cvt_pkrtz_f16_f32 v218, v186, v187
    v_mfma_f32_16x16x16_bf16 v[124:127], v[18:19], v[246:247], v[68:71]
    s_waitcnt lgkmcnt(12)
    ds_read_u16 v217, v217
    ds_read_u16_d16_hi v216, v216
    v_pk_lshrrev_b16 v218, 3, v218 op_sel_hi:[0,1]
    v_mfma_f32_16x16x16_bf16 v[72:75], v[18:19], v[236:237], v[64:67]
    v_mad_u32_u16 v219, v218, 2, s85
    v_mad_u32_u16 v218, v218, 2, s85 op_sel:[1,0,0,0]
    v_cvt_pkrtz_f16_f32 v220, v188, v189
    v_mfma_f32_16x16x16_bf16 v[76:79], v[18:19], v[238:239], v[68:71]
    s_waitcnt lgkmcnt(12)
    ds_read_u16 v219, v219
    ds_read_u16_d16_hi v218, v218
    v_pk_lshrrev_b16 v220, 3, v220 op_sel_hi:[0,1]
    v_mfma_f32_16x16x16_bf16 v[64:67], v[18:19], v[232:233], v[64:67]
    v_mad_u32_u16 v221, v220, 2, s85
    v_mad_u32_u16 v220, v220, 2, s85 op_sel:[1,0,0,0]
    v_cvt_pkrtz_f16_f32 v222, v190, v191
    v_mfma_f32_16x16x16_bf16 v[68:71], v[18:19], v[234:235], v[68:71]
    s_waitcnt lgkmcnt(12)
    ds_read_u16 v221, v221
    ds_read_u16_d16_hi v220, v220
    v_pk_lshrrev_b16 v222, 3, v222 op_sel_hi:[0,1]
    v_mfma_f32_16x16x32_f16 v[176:179], a[232:235], v[128:131], 0
    v_mad_u32_u16 v223, v222, 2, s85
    v_mad_u32_u16 v222, v222, 2, s85 op_sel:[1,0,0,0]
    v_or_b32 v232, v209, v208
    v_mfma_f32_16x16x32_f16 v[184:187], a[232:235], v[132:135], 0
    s_waitcnt lgkmcnt(12)
    ds_read_u16 v223, v223
    ds_read_u16_d16_hi v222, v222
    v_or_b32 v233, v211, v210
    v_mfma_f32_16x16x32_f16 v[180:183], a[236:239], v[128:131], 0
    s_waitcnt lgkmcnt(8)
    v_or_b32 v234, v213, v212
    v_or_b32 v235, v215, v214
    v_cvt_pkrtz_f16_f32 v224, v192, v193
    v_mfma_f32_16x16x32_f16 v[188:191], a[236:239], v[132:135], 0
    s_waitcnt lgkmcnt(7)
    v_pk_lshrrev_b16 v224, 3, v224 op_sel_hi:[0,1]
    v_cvt_pkrtz_f16_f32 v226, v194, v195
    s_waitcnt lgkmcnt(6)
    v_or_b32 v236, v217, v216
    v_mfma_f32_16x16x32_f16 v[192:195], a[232:235], v[152:155], 0
    v_cvt_pkrtz_f16_f32 v228, v196, v197
    v_cvt_pkrtz_f16_f32 v230, v198, v199
    v_cvt_pkrtz_f16_f32 v248, v200, v201
    v_cvt_pkrtz_f16_f32 v250, v202, v203
    v_mfma_f32_16x16x32_f16 v[200:203], a[232:235], v[156:159], 0
    ds_read_b128 a[232:235], v23 offset:6144
    v_cvt_pkrtz_f16_f32 v252, v204, v205
    v_cvt_pkrtz_f16_f32 v0, v206, v207
    v_mfma_f32_16x16x32_f16 v[176:179], a[240:243], v[136:139], v[176:179]
    s_waitcnt lgkmcnt(5)
    v_or_b32 v237, v219, v218
    v_mad_u32_u16 v225, v224, 2, s85
    v_mad_u32_u16 v224, v224, 2, s85 op_sel:[1,0,0,0]
    v_mfma_f32_16x16x32_f16 v[184:187], a[240:243], v[140:143], v[184:187]
    ds_read_u16 v225, v225
    ds_read_u16_d16_hi v224, v224
    v_pk_lshrrev_b16 v226, 3, v226 op_sel_hi:[0,1]
    v_mfma_f32_16x16x32_f16 v[196:199], a[236:239], v[152:155], 0
    v_mad_u32_u16 v227, v226, 2, s85
    v_mad_u32_u16 v226, v226, 2, s85 op_sel:[1,0,0,0]
    v_pk_lshrrev_b16 v228, 3, v228 op_sel_hi:[0,1]
    v_mfma_f32_16x16x32_f16 v[204:207], a[236:239], v[156:159], 0
    ds_read_u16 v227, v227
    ds_read_u16_d16_hi v226, v226
    ds_read_b128 a[236:239], v23 offset:7168
    v_mfma_f32_16x16x32_f16 v[180:183], a[244:247], v[136:139], v[180:183]
    s_waitcnt lgkmcnt(8)
    v_or_b32 v238, v221, v220
    v_mad_u32_u16 v229, v228, 2, s85
    v_mad_u32_u16 v228, v228, 2, s85 op_sel:[1,0,0,0]
    v_mfma_f32_16x16x32_f16 v[188:191], a[244:247], v[140:143], v[188:191]
    s_waitcnt lgkmcnt(6)
    ds_read_u16 v229, v229
    ds_read_u16_d16_hi v228, v228
    v_or_b32 v239, v223, v222
    v_mfma_f32_16x16x32_f16 v[192:195], a[240:243], v[160:163], v[192:195]
    v_pk_lshrrev_b16 v230, 3, v230 op_sel_hi:[0,1]
    v_mad_u32_u16 v231, v230, 2, s85
    v_mad_u32_u16 v230, v230, 2, s85 op_sel:[1,0,0,0]
    v_mfma_f32_16x16x32_f16 v[200:203], a[240:243], v[164:167], v[200:203]
    ds_read_u16 v231, v231
    ds_read_u16_d16_hi v230, v230
    ds_read_b128 a[240:243], v23 offset:8192
    v_mfma_f32_16x16x32_f16 v[176:179], a[248:251], v[144:147], v[176:179]
    v_pk_lshrrev_b16 v248, 3, v248 op_sel_hi:[0,1]
    v_mad_u32_u16 v249, v248, 2, s85
    v_mad_u32_u16 v248, v248, 2, s85 op_sel:[1,0,0,0]
    v_mfma_f32_16x16x32_f16 v[184:187], a[248:251], v[148:151], v[184:187]
    ds_read_u16 v249, v249
    ds_read_u16_d16_hi v248, v248
    v_pk_lshrrev_b16 v250, 3, v250 op_sel_hi:[0,1]
    v_mfma_f32_16x16x32_f16 v[196:199], a[244:247], v[160:163], v[196:199]
    v_mad_u32_u16 v251, v250, 2, s85
    v_mad_u32_u16 v250, v250, 2, s85 op_sel:[1,0,0,0]
    v_pk_lshrrev_b16 v252, 3, v252 op_sel_hi:[0,1]
    v_mfma_f32_16x16x32_f16 v[204:207], a[244:247], v[164:167], v[204:207]
    s_waitcnt lgkmcnt(11)
    ds_read_u16 v251, v251
    ds_read_u16_d16_hi v250, v250
    ds_read_b128 a[244:247], v23 offset:9216
    v_mfma_f32_16x16x32_f16 v[180:183], a[252:255], v[144:147], v[180:183]
    s_add_u32 m0, s56, 7360
    v_mad_u32_u16 v253, v252, 2, s85
    v_mad_u32_u16 v252, v252, 2, s85 op_sel:[1,0,0,0]
    v_pk_lshrrev_b16 v0, 3, v0 op_sel_hi:[0,1]
    v_mfma_f32_16x16x32_f16 v[188:191], a[252:255], v[148:151], v[188:191]
    s_waitcnt lgkmcnt(12)
    ds_read_u16 v253, v253
    ds_read_u16_d16_hi v252, v252
    buffer_load_dwordx4 v2, s[20:23], 0 offen offset:64 lds
    v_mfma_f32_16x16x32_f16 v[192:195], a[248:251], v[168:171], v[192:195]
    v_mad_u32_u16 v208, v0, 2, s85
    v_mad_u32_u16 v0, v0, 2, s85 op_sel:[1,0,0,0]
    v_or_b32 v240, v225, v224
    v_mfma_f32_16x16x32_f16 v[200:203], a[248:251], v[172:175], v[200:203]
    s_waitcnt lgkmcnt(12)
    ds_read_u16 v208, v208
    ds_read_u16_d16_hi v0, v0
    v_or_b32 v241, v227, v226
    v_mfma_f32_16x16x32_f16 v[196:199], a[252:255], v[168:171], v[196:199]
    s_waitcnt lgkmcnt(12)
    ds_read_b128 a[248:251], v23 offset:20480
    v_or_b32 v242, v229, v228
    v_cvt_pkrtz_f16_f32 v209, v176, v177
    v_mfma_f32_16x16x32_f16 v[204:207], a[252:255], v[172:175], v[204:207]
    s_waitcnt lgkmcnt(11)
    v_pk_lshrrev_b16 v209, 3, v209 op_sel_hi:[0,1]
    v_or_b32 v243, v231, v230
    v_mad_u32_u16 v210, v209, 2, s85
    v_mfma_f32_16x16x32_bf16 v[32:35], a[192:195], v[232:235], v[32:35]
    ds_read_b128 a[252:255], v23 offset:21504
    ds_read_u16 v210, v210
    v_mad_u32_u16 v209, v209, 2, s85 op_sel:[1,0,0,0]
    v_mfma_f32_16x16x32_bf16 v[40:43], a[192:195], v[236:239], v[40:43]
    v_cvt_pkrtz_f16_f32 v211, v178, v179
    v_pk_lshrrev_b16 v211, 3, v211 op_sel_hi:[0,1]
    v_mad_u32_u16 v212, v211, 2, s85
    v_mfma_f32_16x16x32_bf16 v[36:39], a[196:199], v[232:235], v[36:39]
    ds_read_u16_d16_hi v209, v209
    v_mad_u32_u16 v211, v211, 2, s85 op_sel:[1,0,0,0]
    v_cvt_pkrtz_f16_f32 v213, v180, v181
    v_mfma_f32_16x16x32_bf16 v[44:47], a[196:199], v[236:239], v[44:47]
    s_waitcnt lgkmcnt(11)
    ds_read_u16 v212, v212
    v_or_b32 v244, v249, v248
    v_pk_lshrrev_b16 v213, 3, v213 op_sel_hi:[0,1]
    v_mfma_f32_16x16x32_bf16 v[80:83], a[192:195], v[240:243], v[80:83]
    s_waitcnt lgkmcnt(11)
    v_mad_u32_u16 v214, v213, 2, s85
    v_mad_u32_u16 v213, v213, 2, s85 op_sel:[1,0,0,0]
    v_cvt_pkrtz_f16_f32 v215, v182, v183
    v_pk_lshrrev_b16 v215, 3, v215 op_sel_hi:[0,1]
    v_mad_u32_u16 v216, v215, 2, s85
    v_mad_u32_u16 v215, v215, 2, s85 op_sel:[1,0,0,0]
    v_cvt_pkrtz_f16_f32 v217, v184, v185
    s_waitcnt lgkmcnt(10)
    v_or_b32 v245, v251, v250
    v_pk_lshrrev_b16 v217, 3, v217 op_sel_hi:[0,1]
    v_mad_u32_u16 v218, v217, 2, s85
    v_mad_u32_u16 v217, v217, 2, s85 op_sel:[1,0,0,0]
    v_cvt_pkrtz_f16_f32 v219, v186, v187
    v_pk_lshrrev_b16 v219, 3, v219 op_sel_hi:[0,1]
    v_mad_u32_u16 v220, v219, 2, s85
    v_mad_u32_u16 v219, v219, 2, s85 op_sel:[1,0,0,0]
    v_cvt_pkrtz_f16_f32 v221, v188, v189
    v_pk_lshrrev_b16 v221, 3, v221 op_sel_hi:[0,1]
    v_mad_u32_u16 v222, v221, 2, s85
    v_mad_u32_u16 v221, v221, 2, s85 op_sel:[1,0,0,0]
    v_cvt_pkrtz_f16_f32 v223, v190, v191
    v_pk_lshrrev_b16 v223, 3, v223 op_sel_hi:[0,1]
    v_mad_u32_u16 v224, v223, 2, s85
    v_mad_u32_u16 v223, v223, 2, s85 op_sel:[1,0,0,0]
    v_cvt_pkrtz_f16_f32 v225, v192, v193
    v_pk_lshrrev_b16 v225, 3, v225 op_sel_hi:[0,1]
    s_waitcnt lgkmcnt(7)
    v_or_b32 v246, v253, v252
    v_cvt_pkrtz_f16_f32 v227, v194, v195
    v_cvt_pkrtz_f16_f32 v229, v196, v197
    v_cvt_pkrtz_f16_f32 v231, v198, v199
    v_cvt_pkrtz_f16_f32 v249, v200, v201
    v_cvt_pkrtz_f16_f32 v251, v202, v203
    v_mad_u32_u16 v226, v225, 2, s85
    v_mad_u32_u16 v225, v225, 2, s85 op_sel:[1,0,0,0]
    v_pk_lshrrev_b16 v227, 3, v227 op_sel_hi:[0,1]
    v_mad_u32_u16 v228, v227, 2, s85
    v_mad_u32_u16 v227, v227, 2, s85 op_sel:[1,0,0,0]
    v_pk_lshrrev_b16 v229, 3, v229 op_sel_hi:[0,1]
    v_mad_u32_u16 v230, v229, 2, s85
    s_waitcnt lgkmcnt(5)
    v_or_b32 v247, v208, v0
    v_cvt_pkrtz_f16_f32 v208, v204, v205
    v_mad_u32_u16 v229, v229, 2, s85 op_sel:[1,0,0,0]
    v_mfma_f32_16x16x32_bf16 v[88:91], a[192:195], v[244:247], v[88:91]
    ds_read_u16_d16_hi v211, v211
    ds_read_u16 v214, v214
    ds_read_u16_d16_hi v213, v213
    ds_read_u16 v216, v216
    v_mfma_f32_16x16x32_bf16 v[48:51], a[232:235], v[232:235], v[48:51]
    ds_read_u16_d16_hi v215, v215
    ds_read_u16 v218, v218
    ds_read_u16_d16_hi v217, v217
    ds_read_u16 v220, v220
    v_mfma_f32_16x16x32_bf16 v[56:59], a[232:235], v[236:239], v[56:59]
    s_waitcnt lgkmcnt(12)
    ds_read_u16_d16_hi v219, v219
    ds_read_u16 v222, v222
    v_pk_lshrrev_b16 v231, 3, v231 op_sel_hi:[0,1]
    v_mfma_f32_16x16x32_bf16 v[84:87], a[196:199], v[240:243], v[84:87]
    s_waitcnt lgkmcnt(13)
    ds_read_u16_d16_hi v221, v221
    v_mad_u32_u16 v248, v231, 2, s85
    v_mad_u32_u16 v231, v231, 2, s85 op_sel:[1,0,0,0]
    v_mfma_f32_16x16x32_bf16 v[92:95], a[196:199], v[244:247], v[92:95]
    v_pk_lshrrev_b16 v249, 3, v249 op_sel_hi:[0,1]
    v_mad_u32_u16 v250, v249, 2, s85
    v_mad_u32_u16 v249, v249, 2, s85 op_sel:[1,0,0,0]
    v_mfma_f32_16x16x32_bf16 v[52:55], a[236:239], v[232:235], v[52:55]
    s_waitcnt lgkmcnt(13)
    ds_read_u16 v224, v224
    v_pk_lshrrev_b16 v251, 3, v251 op_sel_hi:[0,1]
    v_mad_u32_u16 v252, v251, 2, s85
    v_mfma_f32_16x16x32_bf16 v[60:63], a[236:239], v[236:239], v[60:63]
    s_waitcnt lgkmcnt(13)
    ds_read_u16_d16_hi v223, v223
    v_mad_u32_u16 v251, v251, 2, s85 op_sel:[1,0,0,0]
    v_pk_fma_f16 v253, v208, v208, s53
    v_mfma_f32_16x16x32_bf16 v[96:99], a[232:235], v[240:243], v[96:99]
    s_waitcnt lgkmcnt(13)
    ds_read_u16 v226, v226
    v_pk_mul_f16 v253, v253, v208 neg_lo:[1,0] neg_hi:[1,0]
    v_exp_f16 v0, v253
    v_mfma_f32_16x16x32_bf16 v[104:107], a[232:235], v[244:247], v[104:107]
    s_add_u32 m0, s56, 8384
    v_exp_f16_sdwa v0, v253 dst_sel:WORD_1 dst_unused:UNUSED_PRESERVE src0_sel:WORD_1
    v_mfma_f32_16x16x32_bf16 v[64:67], a[240:243], v[232:235], v[64:67]
    s_waitcnt lgkmcnt(12)
    ds_read_b128 a[232:235], v23 offset:22528
    buffer_load_dwordx4 v3, s[20:23], 0 offen offset:64 lds
    ds_read_u16_d16_hi v225, v225
    v_mfma_f32_16x16x32_bf16 v[72:75], a[240:243], v[236:239], v[72:75]
    v_pk_fma_f16 v0, v0, s86, s86
    v_rcp_f16 v253, v0
    v_mfma_f32_16x16x32_bf16 v[100:103], a[236:239], v[240:243], v[100:103]
    s_waitcnt lgkmcnt(13)
    ds_read_u16 v228, v228
    v_rcp_f16_sdwa v253, v0 dst_sel:WORD_1 dst_unused:UNUSED_PRESERVE src0_sel:WORD_1
    v_mfma_f32_16x16x32_bf16 v[108:111], a[236:239], v[244:247], v[108:111]
    s_waitcnt lgkmcnt(13)
    ds_read_b128 a[236:239], v23 offset:23552
    v_fma_mix_f32 v0, v253, v208, 0 op_sel_hi:[1,1,0]
    v_fma_mix_f32 v253, v253, v208, 0 op_sel:[1,1,0] op_sel_hi:[1,1,0]
    v_mfma_f32_16x16x32_bf16 v[68:71], a[244:247], v[232:235], v[68:71]
    v_or_b32 v232, v210, v209
    v_or_b32 v233, v212, v211
    v_or_b32 v234, v214, v213
    v_mfma_f32_16x16x32_bf16 v[76:79], a[244:247], v[236:239], v[76:79]
    s_waitcnt lgkmcnt(11)
    ds_read_u16_d16_hi v227, v227
    v_or_b32 v235, v216, v215
    v_or_b32 v236, v218, v217
    v_mfma_f32_16x16x32_bf16 v[112:115], a[240:243], v[240:243], v[112:115]
    ds_read_u16 v230, v230
    v_cvt_pkrtz_f16_f32 v211, v206, v207
    v_pk_fma_f16 v209, v211, v211, s53
    v_mfma_f32_16x16x32_bf16 v[120:123], a[240:243], v[244:247], v[120:123]
    s_waitcnt lgkmcnt(11)
    ds_read_b128 a[240:243], v23 offset:24576
    v_or_b32 v237, v220, v219
    v_pk_mul_f16 v209, v209, v211 neg_lo:[1,0] neg_hi:[1,0]
    v_mfma_f32_16x16x32_bf16 v[116:119], a[244:247], v[240:243], v[116:119]
    v_exp_f16 v210, v209
    v_mfma_f32_16x16x32_bf16 v[124:127], a[244:247], v[244:247], v[124:127]
    ds_read_b128 a[244:247], v23 offset:25600
    v_exp_f16_sdwa v210, v209 dst_sel:WORD_1 dst_unused:UNUSED_PRESERVE src0_sel:WORD_1
    v_mfma_f32_16x16x32_f16 v[176:179], a[248:251], v[128:131], 0
    s_waitcnt lgkmcnt(11)
    ds_read_u16_d16_hi v229, v229
    v_or_b32 v238, v222, v221
    v_pk_fma_f16 v210, v210, s86, s86
    v_mfma_f32_16x16x32_f16 v[184:187], a[248:251], v[132:135], 0
    v_rcp_f16 v209, v210
    v_cvt_pk_bf16_f32 v246, v0, v253
    v_mfma_f32_16x16x32_f16 v[180:183], a[252:255], v[128:131], 0
    ds_read_u16 v248, v248
    v_rcp_f16_sdwa v209, v210 dst_sel:WORD_1 dst_unused:UNUSED_PRESERVE src0_sel:WORD_1
    v_mfma_f32_16x16x32_f16 v[188:191], a[252:255], v[132:135], 0
    s_waitcnt lgkmcnt(11)
    ds_read_u16_d16_hi v231, v231
    v_or_b32 v239, v224, v223
    v_fma_mix_f32 v210, v209, v211, 0 op_sel_hi:[1,1,0]
    v_mfma_f32_16x16x32_f16 v[192:195], a[248:251], v[152:155], 0
    ds_read_u16 v250, v250
    v_fma_mix_f32 v209, v209, v211, 0 op_sel:[1,1,0] op_sel_hi:[1,1,0]
    v_cvt_pk_bf16_f32 v247, v210, v209
    v_mfma_f32_16x16x32_f16 v[200:203], a[248:251], v[156:159], 0
    s_waitcnt lgkmcnt(11)
    ds_read_u16_d16_hi v249, v249
    v_mfma_f32_16x16x32_f16 v[176:179], a[232:235], v[136:139], v[176:179]
    ds_read_u16 v252, v252
    v_mfma_f32_16x16x32_f16 v[184:187], a[232:235], v[140:143], v[184:187]
    s_waitcnt lgkmcnt(12)
    v_or_b32 v240, v226, v225
    v_mfma_f32_16x16x32_f16 v[196:199], a[252:255], v[152:155], 0
    ds_read_u16_d16_hi v251, v251
    v_mfma_f32_16x16x32_f16 v[204:207], a[252:255], v[156:159], 0
    s_waitcnt lgkmcnt(11)
    ds_read_b128 a[248:251], v23 offset:16384
    v_mfma_f32_16x16x32_f16 v[180:183], a[236:239], v[136:139], v[180:183]
    v_mfma_f32_16x16x32_f16 v[188:191], a[236:239], v[140:143], v[188:191]
    s_waitcnt lgkmcnt(11)
    ds_read_b128 a[252:255], v23 offset:17408
    v_or_b32 v241, v228, v227
    v_mfma_f32_16x16x32_f16 v[192:195], a[232:235], v[160:163], v[192:195]
    v_mfma_f32_16x16x32_f16 v[200:203], a[232:235], v[164:167], v[200:203]
    ds_read_b128 a[232:235], v23 offset:18432
    s_waitcnt lgkmcnt(11)
    v_mfma_f32_16x16x32_f16 v[176:179], a[240:243], v[144:147], v[176:179]
    s_add_u32 m0, s56, 10432
    v_mfma_f32_16x16x32_f16 v[184:187], a[240:243], v[148:151], v[184:187]
    buffer_load_dwordx4 v5, s[20:23], 0 offen offset:64 lds
    s_add_u32 m0, s56, 9408
    v_mfma_f32_16x16x32_f16 v[196:199], a[236:239], v[160:163], v[196:199]
    buffer_load_dwordx4 v4, s[20:23], 0 offen offset:64 lds
    v_mfma_f32_16x16x32_f16 v[204:207], a[236:239], v[164:167], v[204:207]
    s_waitcnt lgkmcnt(9)
    ds_read_b128 a[236:239], v23 offset:19456
    v_or_b32 v242, v230, v229
    v_cvt_pkrtz_f16_f32 v212, v176, v177
    v_mfma_f32_16x16x32_f16 v[180:183], a[244:247], v[144:147], v[180:183]
    s_waitcnt lgkmcnt(9)
    v_pk_lshrrev_b16 v212, 3, v212 op_sel_hi:[0,1]
    v_mad_u32_u16 v213, v212, 2, s85
    s_waitcnt lgkmcnt(8)
    v_or_b32 v243, v248, v231
    v_mfma_f32_16x16x32_f16 v[188:191], a[244:247], v[148:151], v[188:191]
    ds_read_u16 v213, v213
    v_mad_u32_u16 v212, v212, 2, s85 op_sel:[1,0,0,0]
    v_cvt_pkrtz_f16_f32 v214, v178, v179
    v_mfma_f32_16x16x32_f16 v[192:195], a[240:243], v[168:171], v[192:195]
    ds_read_u16_d16_hi v212, v212
    v_pk_lshrrev_b16 v214, 3, v214 op_sel_hi:[0,1]
    v_mad_u32_u16 v215, v214, 2, s85
    v_mfma_f32_16x16x32_f16 v[200:203], a[240:243], v[172:175], v[200:203]
    s_waitcnt lgkmcnt(8)
    ds_read_b128 a[240:243], v23 offset:30720
    ds_read_u16 v215, v215
    v_or_b32 v244, v250, v249
    v_mfma_f32_16x16x32_f16 v[196:199], a[244:247], v[168:171], v[196:199]
    v_mad_u32_u16 v214, v214, 2, s85 op_sel:[1,0,0,0]
    v_cvt_pkrtz_f16_f32 v216, v180, v181
    v_pk_lshrrev_b16 v216, 3, v216 op_sel_hi:[0,1]
    v_mfma_f32_16x16x32_f16 v[204:207], a[244:247], v[172:175], v[204:207]
    ds_read_b128 a[244:247], v23 offset:31744
    ds_read_u16_d16_hi v214, v214
    v_mad_u32_u16 v217, v216, 2, s85
    v_mfma_f32_16x16x32_bf16 v[32:35], a[200:203], v[232:235], v[32:35]
    s_waitcnt lgkmcnt(10)
    ds_read_u16 v217, v217
    v_or_b32 v245, v252, v251
    v_mad_u32_u16 v216, v216, 2, s85 op_sel:[1,0,0,0]
    v_mfma_f32_16x16x32_bf16 v[40:43], a[200:203], v[236:239], v[40:43]
    ds_read_u16_d16_hi v216, v216
    v_cvt_pkrtz_f16_f32 v218, v182, v183
    v_pk_lshrrev_b16 v218, 3, v218 op_sel_hi:[0,1]
    v_mfma_f32_16x16x32_bf16 v[36:39], a[204:207], v[232:235], v[36:39]
    v_mad_u32_u16 v219, v218, 2, s85
    v_mad_u32_u16 v218, v218, 2, s85 op_sel:[1,0,0,0]
    v_cvt_pkrtz_f16_f32 v220, v184, v185
    v_mfma_f32_16x16x32_bf16 v[44:47], a[204:207], v[236:239], v[44:47]
    ds_read_u16 v219, v219
    ds_read_u16_d16_hi v218, v218
    v_pk_lshrrev_b16 v220, 3, v220 op_sel_hi:[0,1]
    v_mfma_f32_16x16x32_bf16 v[80:83], a[200:203], v[240:243], v[80:83]
    v_mad_u32_u16 v221, v220, 2, s85
    v_mad_u32_u16 v220, v220, 2, s85 op_sel:[1,0,0,0]
    v_cvt_pkrtz_f16_f32 v222, v186, v187
    v_mfma_f32_16x16x32_bf16 v[88:91], a[200:203], v[244:247], v[88:91]
    s_waitcnt lgkmcnt(12)
    ds_read_u16 v221, v221
    ds_read_u16_d16_hi v220, v220
    v_pk_lshrrev_b16 v222, 3, v222 op_sel_hi:[0,1]
    v_mfma_f32_16x16x32_bf16 v[48:51], a[248:251], v[232:235], v[48:51]
    v_mad_u32_u16 v223, v222, 2, s85
    v_mad_u32_u16 v222, v222, 2, s85 op_sel:[1,0,0,0]
    v_cvt_pkrtz_f16_f32 v224, v188, v189
    v_mfma_f32_16x16x32_bf16 v[56:59], a[248:251], v[236:239], v[56:59]
    s_waitcnt lgkmcnt(12)
    ds_read_u16 v223, v223
    ds_read_u16_d16_hi v222, v222
    v_pk_lshrrev_b16 v224, 3, v224 op_sel_hi:[0,1]
    v_mfma_f32_16x16x32_bf16 v[84:87], a[204:207], v[240:243], v[84:87]
    v_mad_u32_u16 v225, v224, 2, s85
    v_mad_u32_u16 v224, v224, 2, s85 op_sel:[1,0,0,0]
    v_cvt_pkrtz_f16_f32 v226, v190, v191
    v_mfma_f32_16x16x32_bf16 v[92:95], a[204:207], v[244:247], v[92:95]
    s_waitcnt lgkmcnt(12)
    ds_read_u16 v225, v225
    ds_read_u16_d16_hi v224, v224
    v_pk_lshrrev_b16 v226, 3, v226 op_sel_hi:[0,1]
    v_mfma_f32_16x16x32_bf16 v[52:55], a[252:255], v[232:235], v[52:55]
    v_mad_u32_u16 v227, v226, 2, s85
    v_mad_u32_u16 v226, v226, 2, s85 op_sel:[1,0,0,0]
    v_cvt_pkrtz_f16_f32 v228, v192, v193
    v_mfma_f32_16x16x32_bf16 v[60:63], a[252:255], v[236:239], v[60:63]
    s_waitcnt lgkmcnt(12)
    ds_read_u16 v227, v227
    ds_read_u16_d16_hi v226, v226
    v_pk_lshrrev_b16 v228, 3, v228 op_sel_hi:[0,1]
    v_mfma_f32_16x16x32_bf16 v[96:99], a[248:251], v[240:243], v[96:99]
    v_cvt_pkrtz_f16_f32 v230, v194, v195
    v_cvt_pkrtz_f16_f32 v248, v196, v197
    v_cvt_pkrtz_f16_f32 v250, v198, v199
    v_mfma_f32_16x16x32_bf16 v[104:107], a[248:251], v[244:247], v[104:107]
    s_waitcnt lgkmcnt(13)
    ds_read_b128 a[248:251], v23 offset:32768
    v_cvt_pkrtz_f16_f32 v252, v200, v201
    v_cvt_pkrtz_f16_f32 v0, v202, v203
    v_mfma_f32_16x16x32_bf16 v[64:67], a[232:235], v[232:235], v[64:67]
    v_cvt_pkrtz_f16_f32 v209, v204, v205
    v_cvt_pkrtz_f16_f32 v211, v206, v207
    v_mad_u32_u16 v229, v228, 2, s85
    v_mfma_f32_16x16x32_bf16 v[72:75], a[232:235], v[236:239], v[72:75]
    s_waitcnt lgkmcnt(13)
    ds_read_u16 v229, v229
    v_mad_u32_u16 v228, v228, 2, s85 op_sel:[1,0,0,0]
    v_pk_lshrrev_b16 v230, 3, v230 op_sel_hi:[0,1]
    v_mfma_f32_16x16x32_bf16 v[100:103], a[252:255], v[240:243], v[100:103]
    s_waitcnt lgkmcnt(13)
    ds_read_u16_d16_hi v228, v228
    v_mad_u32_u16 v231, v230, 2, s85
    v_mad_u32_u16 v230, v230, 2, s85 op_sel:[1,0,0,0]
    v_mfma_f32_16x16x32_bf16 v[108:111], a[252:255], v[244:247], v[108:111]
    s_waitcnt lgkmcnt(12)
    ds_read_b128 a[252:255], v23 offset:33792
    ds_read_u16 v231, v231
    v_pk_lshrrev_b16 v248, 3, v248 op_sel_hi:[0,1]
    v_mfma_f32_16x16x32_bf16 v[68:71], a[236:239], v[232:235], v[68:71]
    s_waitcnt lgkmcnt(13)
    ds_read_u16_d16_hi v230, v230
    v_or_b32 v232, v213, v212
    v_or_b32 v233, v215, v214
    v_mfma_f32_16x16x32_bf16 v[76:79], a[236:239], v[236:239], v[76:79]
    s_waitcnt lgkmcnt(12)
    v_or_b32 v234, v217, v216
    v_or_b32 v235, v219, v218
    v_or_b32 v236, v221, v220
    v_mfma_f32_16x16x32_bf16 v[112:115], a[232:235], v[240:243], v[112:115]
    v_mad_u32_u16 v249, v248, 2, s85
    v_mad_u32_u16 v248, v248, 2, s85 op_sel:[1,0,0,0]
    v_pk_lshrrev_b16 v250, 3, v250 op_sel_hi:[0,1]
    v_mfma_f32_16x16x32_bf16 v[120:123], a[232:235], v[244:247], v[120:123]
    s_waitcnt lgkmcnt(10)
    ds_read_b128 a[232:235], v23 offset:34816
    ds_read_u16 v249, v249
    v_or_b32 v237, v223, v222
    v_mfma_f32_16x16x32_bf16 v[116:119], a[236:239], v[240:243], v[116:119]
    v_mad_u32_u16 v251, v250, 2, s85
    v_mad_u32_u16 v250, v250, 2, s85 op_sel:[1,0,0,0]
    v_pk_lshrrev_b16 v252, 3, v252 op_sel_hi:[0,1]
    v_mfma_f32_16x16x32_bf16 v[124:127], a[236:239], v[244:247], v[124:127]
    s_waitcnt lgkmcnt(11)
    ds_read_b128 a[236:239], v23 offset:35840
    v_mad_u32_u16 v253, v252, 2, s85
    s_waitcnt lgkmcnt(11)
    v_or_b32 v238, v225, v224
    v_mfma_f32_16x16x32_f16 v[176:179], a[240:243], v[128:131], 0
    ds_read_u16_d16_hi v248, v248
    v_mad_u32_u16 v252, v252, 2, s85 op_sel:[1,0,0,0]
    v_pk_lshrrev_b16 v0, 3, v0 op_sel_hi:[0,1]
    v_mfma_f32_16x16x32_f16 v[184:187], a[240:243], v[132:135], 0
    ds_read_u16 v251, v251
    v_mad_u32_u16 v208, v0, 2, s85
    v_mad_u32_u16 v0, v0, 2, s85 op_sel:[1,0,0,0]
    v_mfma_f32_16x16x32_f16 v[180:183], a[244:247], v[128:131], 0
    s_waitcnt lgkmcnt(11)
    v_pk_lshrrev_b16 v209, 3, v209 op_sel_hi:[0,1]
    v_or_b32 v239, v227, v226
    v_mad_u32_u16 v210, v209, 2, s85
    v_mfma_f32_16x16x32_f16 v[188:191], a[244:247], v[132:135], 0
    ds_read_u16_d16_hi v250, v250
    ds_read_u16 v253, v253
    v_mad_u32_u16 v209, v209, 2, s85 op_sel:[1,0,0,0]
    v_mfma_f32_16x16x32_f16 v[192:195], a[240:243], v[152:155], 0
    v_pk_lshrrev_b16 v211, 3, v211 op_sel_hi:[0,1]
    v_mad_u32_u16 v212, v211, 2, s85
    v_mad_u32_u16 v211, v211, 2, s85 op_sel:[1,0,0,0]
    v_mfma_f32_16x16x32_f16 v[200:203], a[240:243], v[156:159], 0
    s_waitcnt lgkmcnt(12)
    ds_read_u16_d16_hi v252, v252
    v_mfma_f32_16x16x32_f16 v[176:179], a[248:251], v[136:139], v[176:179]
    s_waitcnt lgkmcnt(11)
    ds_read_u16 v208, v208
    v_or_b32 v240, v229, v228
    v_mfma_f32_16x16x32_f16 v[184:187], a[248:251], v[140:143], v[184:187]
    ds_read_u16_d16_hi v0, v0
    v_mfma_f32_16x16x32_f16 v[196:199], a[244:247], v[152:155], 0
    v_mfma_f32_16x16x32_f16 v[204:207], a[244:247], v[156:159], 0
    s_waitcnt lgkmcnt(12)
    ds_read_u16 v210, v210
    v_mfma_f32_16x16x32_f16 v[180:183], a[252:255], v[136:139], v[180:183]
    s_waitcnt lgkmcnt(11)
    ds_read_u16_d16_hi v209, v209
    v_or_b32 v241, v231, v230
    v_mfma_f32_16x16x32_f16 v[188:191], a[252:255], v[140:143], v[188:191]
    ds_read_u16 v212, v212
    v_mfma_f32_16x16x32_f16 v[192:195], a[248:251], v[160:163], v[192:195]
    v_mfma_f32_16x16x32_f16 v[200:203], a[248:251], v[164:167], v[200:203]
    s_waitcnt lgkmcnt(12)
    ds_read_u16_d16_hi v211, v211
    v_mfma_f32_16x16x32_f16 v[176:179], a[232:235], v[144:147], v[176:179]
    s_add_u32 m0, s56, 11456
    ds_read_b128 a[240:243], v23 offset:26624
    buffer_load_dwordx4 v6, s[20:23], 0 offen offset:64 lds
    v_mfma_f32_16x16x32_f16 v[184:187], a[232:235], v[148:151], v[184:187]
    s_waitcnt lgkmcnt(11)
    ds_read_b128 a[244:247], v23 offset:27648
    v_or_b32 v242, v249, v248
    v_mfma_f32_16x16x32_f16 v[196:199], a[252:255], v[160:163], v[196:199]
    v_cvt_pkrtz_f16_f32 v213, v176, v177
    v_pk_lshrrev_b16 v213, 3, v213 op_sel_hi:[0,1]
    v_mad_u32_u16 v214, v213, 2, s85
    v_mfma_f32_16x16x32_f16 v[204:207], a[252:255], v[164:167], v[204:207]
    ds_read_b128 a[248:251], v23 offset:28672
    v_mad_u32_u16 v213, v213, 2, s85 op_sel:[1,0,0,0]
    v_cvt_pkrtz_f16_f32 v215, v178, v179
    v_mfma_f32_16x16x32_f16 v[180:183], a[236:239], v[144:147], v[180:183]
    s_waitcnt lgkmcnt(11)
    ds_read_b128 a[252:255], v23 offset:29696
    v_or_b32 v243, v251, v250
    v_pk_lshrrev_b16 v215, 3, v215 op_sel_hi:[0,1]
    v_mfma_f32_16x16x32_f16 v[188:191], a[236:239], v[148:151], v[188:191]
    v_mad_u32_u16 v216, v215, 2, s85
    v_mad_u32_u16 v215, v215, 2, s85 op_sel:[1,0,0,0]
    v_cvt_pkrtz_f16_f32 v221, v184, v185
    v_mfma_f32_16x16x32_f16 v[192:195], a[232:235], v[168:171], v[192:195]
    ds_read_u16 v214, v214
    v_cvt_pkrtz_f16_f32 v217, v180, v181
    v_pk_lshrrev_b16 v217, 3, v217 op_sel_hi:[0,1]
    v_mfma_f32_16x16x32_f16 v[200:203], a[232:235], v[172:175], v[200:203]
    s_waitcnt lgkmcnt(11)
    ds_read_b128 a[232:235], v24 offset:0
    v_or_b32 v244, v253, v252
    v_mad_u32_u16 v218, v217, 2, s85
    v_mfma_f32_16x16x32_f16 v[196:199], a[236:239], v[168:171], v[196:199]
    ds_read_u16_d16_hi v213, v213
    v_mad_u32_u16 v217, v217, 2, s85 op_sel:[1,0,0,0]
    v_cvt_pkrtz_f16_f32 v219, v182, v183
    v_mfma_f32_16x16x32_f16 v[204:207], a[236:239], v[172:175], v[204:207]
    s_waitcnt lgkmcnt(11)
    v_pk_lshrrev_b16 v219, 3, v219 op_sel_hi:[0,1]
    v_or_b32 v245, v208, v0
    v_mad_u32_u16 v220, v219, 2, s85
    v_mfma_f32_16x16x32_bf16 v[32:35], a[208:211], v[232:235], v[32:35]
    ds_read_b128 a[236:239], v24 offset:1024
    v_mad_u32_u16 v219, v219, 2, s85 op_sel:[1,0,0,0]
    v_pk_lshrrev_b16 v221, 3, v221 op_sel_hi:[0,1]
    v_mfma_f32_16x16x32_bf16 v[40:43], a[208:211], v[236:239], v[40:43]
    ds_read_u16 v216, v216
    v_mad_u32_u16 v222, v221, 2, s85
    v_mad_u32_u16 v221, v221, 2, s85 op_sel:[1,0,0,0]
    v_mfma_f32_16x16x32_bf16 v[36:39], a[212:215], v[232:235], v[36:39]
    s_waitcnt lgkmcnt(11)
    ds_read_u16_d16_hi v215, v215
    v_or_b32 v246, v210, v209
    v_cvt_pkrtz_f16_f32 v223, v186, v187
    v_mfma_f32_16x16x32_bf16 v[44:47], a[212:215], v[236:239], v[44:47]
    v_pk_lshrrev_b16 v223, 3, v223 op_sel_hi:[0,1]
    v_mad_u32_u16 v224, v223, 2, s85
    v_mad_u32_u16 v223, v223, 2, s85 op_sel:[1,0,0,0]
    v_mfma_f32_16x16x32_bf16 v[80:83], a[208:211], v[240:243], v[80:83]
    s_waitcnt lgkmcnt(11)
    ds_read_u16 v218, v218
    v_cvt_pkrtz_f16_f32 v225, v188, v189
    v_pk_lshrrev_b16 v225, 3, v225 op_sel_hi:[0,1]
    s_waitcnt lgkmcnt(11)
    v_or_b32 v247, v212, v211
    v_mad_u32_u16 v226, v225, 2, s85
    v_mad_u32_u16 v225, v225, 2, s85 op_sel:[1,0,0,0]
    v_mfma_f32_16x16x32_bf16 v[88:91], a[208:211], v[244:247], v[88:91]
    s_waitcnt lgkmcnt(10)
    ds_read_u16_d16_hi v217, v217
    ds_read_u16 v220, v220
    v_cvt_pkrtz_f16_f32 v227, v190, v191
    v_mfma_f32_16x16x32_bf16 v[48:51], a[240:243], v[232:235], v[48:51]
    ds_read_u16_d16_hi v219, v219
    v_pk_lshrrev_b16 v227, 3, v227 op_sel_hi:[0,1]
    v_mad_u32_u16 v228, v227, 2, s85
    v_mfma_f32_16x16x32_bf16 v[56:59], a[240:243], v[236:239], v[56:59]
    s_waitcnt lgkmcnt(12)
    ds_read_u16 v222, v222
    ds_read_u16_d16_hi v221, v221
    v_mad_u32_u16 v227, v227, 2, s85 op_sel:[1,0,0,0]
    v_mfma_f32_16x16x32_bf16 v[84:87], a[212:215], v[240:243], v[84:87]
    v_cvt_pkrtz_f16_f32 v229, v192, v193
    v_pk_lshrrev_b16 v229, 3, v229 op_sel_hi:[0,1]
    v_cvt_pkrtz_f16_f32 v231, v194, v195
    v_mfma_f32_16x16x32_bf16 v[92:95], a[212:215], v[244:247], v[92:95]
    s_waitcnt lgkmcnt(13)
    ds_read_u16 v224, v224
    v_cvt_pkrtz_f16_f32 v249, v196, v197
    v_cvt_pkrtz_f16_f32 v251, v198, v199
    v_mfma_f32_16x16x32_bf16 v[52:55], a[244:247], v[232:235], v[52:55]
    s_waitcnt lgkmcnt(13)
    ds_read_u16_d16_hi v223, v223
    v_cvt_pkrtz_f16_f32 v253, v200, v201
    v_cvt_pkrtz_f16_f32 v208, v202, v203
    v_mfma_f32_16x16x32_bf16 v[60:63], a[244:247], v[236:239], v[60:63]
    s_waitcnt lgkmcnt(13)
    ds_read_u16 v226, v226
    v_cvt_pkrtz_f16_f32 v210, v204, v205
    v_cvt_pkrtz_f16_f32 v212, v206, v207
    v_mfma_f32_16x16x32_bf16 v[96:99], a[240:243], v[240:243], v[96:99]
    s_waitcnt lgkmcnt(13)
    ds_read_u16_d16_hi v225, v225
    v_mad_u32_u16 v230, v229, 2, s85
    v_mad_u32_u16 v229, v229, 2, s85 op_sel:[1,0,0,0]
    v_mfma_f32_16x16x32_bf16 v[104:107], a[240:243], v[244:247], v[104:107]
    s_waitcnt lgkmcnt(13)
    ds_read_u16 v228, v228
    v_pk_lshrrev_b16 v231, 3, v231 op_sel_hi:[0,1]
    v_mad_u32_u16 v248, v231, 2, s85
    v_mfma_f32_16x16x32_bf16 v[64:67], a[248:251], v[232:235], v[64:67]
    v_mad_u32_u16 v231, v231, 2, s85 op_sel:[1,0,0,0]
    v_pk_lshrrev_b16 v249, 3, v249 op_sel_hi:[0,1]
    v_mad_u32_u16 v250, v249, 2, s85
    v_mfma_f32_16x16x32_bf16 v[72:75], a[248:251], v[236:239], v[72:75]
    s_waitcnt lgkmcnt(13)
    ds_read_u16_d16_hi v227, v227
    v_mad_u32_u16 v249, v249, 2, s85 op_sel:[1,0,0,0]
    v_pk_lshrrev_b16 v251, 3, v251 op_sel_hi:[0,1]
    v_mfma_f32_16x16x32_bf16 v[100:103], a[244:247], v[240:243], v[100:103]
    s_waitcnt lgkmcnt(13)
    ds_read_b128 a[240:243], v24 offset:2048
    v_mad_u32_u16 v252, v251, 2, s85
    v_mad_u32_u16 v251, v251, 2, s85 op_sel:[1,0,0,0]
    v_mfma_f32_16x16x32_bf16 v[108:111], a[244:247], v[244:247], v[108:111]
    s_waitcnt lgkmcnt(13)
    ds_read_b128 a[244:247], v24 offset:3072
    v_pk_lshrrev_b16 v253, 3, v253 op_sel_hi:[0,1]
    v_mad_u32_u16 v0, v253, 2, s85
    v_mfma_f32_16x16x32_bf16 v[68:71], a[252:255], v[232:235], v[68:71]
    s_waitcnt lgkmcnt(12)
    v_or_b32 v232, v214, v213
    v_or_b32 v233, v216, v215
    v_or_b32 v234, v218, v217
    v_mfma_f32_16x16x32_bf16 v[76:79], a[252:255], v[236:239], v[76:79]
    ds_read_u16 v230, v230
    v_mad_u32_u16 v253, v253, 2, s85 op_sel:[1,0,0,0]
    v_pk_lshrrev_b16 v208, 3, v208 op_sel_hi:[0,1]
    v_mfma_f32_16x16x32_bf16 v[112:115], a[248:251], v[240:243], v[112:115]
    s_waitcnt lgkmcnt(11)
    ds_read_u16_d16_hi v229, v229
    v_or_b32 v235, v220, v219
    v_mad_u32_u16 v209, v208, 2, s85
    v_mfma_f32_16x16x32_bf16 v[120:123], a[248:251], v[244:247], v[120:123]
    ds_read_b128 a[248:251], v24 offset:4096
    v_mad_u32_u16 v208, v208, 2, s85 op_sel:[1,0,0,0]
    v_pk_lshrrev_b16 v210, 3, v210 op_sel_hi:[0,1]
    v_mfma_f32_16x16x32_bf16 v[116:119], a[252:255], v[240:243], v[116:119]
    s_waitcnt lgkmcnt(12)
    v_mad_u32_u16 v211, v210, 2, s85
    v_mad_u32_u16 v210, v210, 2, s85 op_sel:[1,0,0,0]
    s_waitcnt lgkmcnt(11)
    v_or_b32 v236, v222, v221
    v_mfma_f32_16x16x32_bf16 v[124:127], a[252:255], v[244:247], v[124:127]
    ds_read_b128 a[252:255], v24 offset:5120
    v_pk_lshrrev_b16 v212, 3, v212 op_sel_hi:[0,1]
    v_mad_u32_u16 v213, v212, 2, s85
    v_mfma_f32_16x16x32_f16 v[176:179], a[232:235], v[128:131], 0
    ds_read_u16 v248, v248
    v_mad_u32_u16 v212, v212, 2, s85 op_sel:[1,0,0,0]
    v_mfma_f32_16x16x32_f16 v[184:187], a[232:235], v[132:135], 0
    s_waitcnt lgkmcnt(11)
    v_or_b32 v237, v224, v223
    v_mfma_f32_16x16x32_f16 v[180:183], a[236:239], v[128:131], 0
    ds_read_u16_d16_hi v231, v231
    v_mfma_f32_16x16x32_f16 v[188:191], a[236:239], v[132:135], 0
    ds_read_u16 v250, v250
    v_mfma_f32_16x16x32_f16 v[192:195], a[232:235], v[152:155], 0
    v_mfma_f32_16x16x32_f16 v[200:203], a[232:235], v[156:159], 0
    s_waitcnt lgkmcnt(11)
    ds_read_u16_d16_hi v249, v249
    v_or_b32 v238, v226, v225
    ds_read_u16 v252, v252
    s_waitcnt lgkmcnt(11)
    v_or_b32 v239, v228, v227
    s_waitcnt lgkmcnt(10)
    v_mfma_f32_16x16x32_f16 v[176:179], a[240:243], v[136:139], v[176:179]
    ds_read_u16_d16_hi v251, v251
    ds_read_u16 v0, v0
    ds_read_u16_d16_hi v253, v253
    v_mfma_f32_16x16x32_f16 v[184:187], a[240:243], v[140:143], v[184:187]
    v_mfma_f32_16x16x32_f16 v[196:199], a[236:239], v[152:155], 0
    s_waitcnt lgkmcnt(12)
    ds_read_u16 v209, v209
    v_mfma_f32_16x16x32_f16 v[204:207], a[236:239], v[156:159], 0
    s_add_u32 m0, s56, 12480
    v_mfma_f32_16x16x32_f16 v[180:183], a[244:247], v[136:139], v[180:183]
    s_waitcnt lgkmcnt(12)
    ds_read_u16_d16_hi v208, v208
    buffer_load_dword v7, s[20:23], 0 offen offset:64 lds
    ds_read_u16 v211, v211
    v_mfma_f32_16x16x32_f16 v[188:191], a[244:247], v[140:143], v[188:191]
    s_waitcnt lgkmcnt(13)
    ds_read_u16_d16_hi v210, v210
    v_or_b32 v240, v230, v229
    v_mfma_f32_16x16x32_f16 v[192:195], a[240:243], v[160:163], v[192:195]
    s_add_u32 m0, s56, 0
    v_mfma_f32_16x16x32_f16 v[200:203], a[240:243], v[164:167], v[200:203]
    s_waitcnt lgkmcnt(13)
    ds_read_u16 v213, v213
    buffer_load_dwordx4 v1, s[20:23], 0 offen offset:0 lds
    v_mfma_f32_16x16x32_f16 v[176:179], a[248:251], v[144:147], v[176:179]
    s_waitcnt lgkmcnt(11)
    ds_read_u16_d16_hi v212, v212
    v_or_b32 v241, v248, v231
    v_mfma_f32_16x16x32_f16 v[184:187], a[248:251], v[148:151], v[184:187]
    v_mfma_f32_16x16x32_f16 v[196:199], a[244:247], v[160:163], v[196:199]
    ds_read_b128 a[232:235], v23 offset:36864
    v_mfma_f32_16x16x32_f16 v[204:207], a[244:247], v[164:167], v[204:207]
    s_waitcnt lgkmcnt(11)
    ds_read_b128 a[236:239], v23 offset:37888
    v_or_b32 v242, v250, v249
    v_mfma_f32_16x16x32_f16 v[180:183], a[252:255], v[144:147], v[180:183]
    v_cvt_pkrtz_f16_f32 v214, v176, v177
    v_pk_lshrrev_b16 v214, 3, v214 op_sel_hi:[0,1]
    v_mad_u32_u16 v215, v214, 2, s85
    v_mfma_f32_16x16x32_f16 v[188:191], a[252:255], v[148:151], v[188:191]
    ds_read_b128 a[240:243], v23 offset:38912
    v_mad_u32_u16 v214, v214, 2, s85 op_sel:[1,0,0,0]
    v_cvt_pkrtz_f16_f32 v216, v178, v179
    v_mfma_f32_16x16x32_f16 v[192:195], a[248:251], v[168:171], v[192:195]
    s_waitcnt lgkmcnt(11)
    ds_read_b128 a[244:247], v23 offset:39936
    v_or_b32 v243, v252, v251
    v_pk_lshrrev_b16 v216, 3, v216 op_sel_hi:[0,1]
    v_mfma_f32_16x16x32_f16 v[200:203], a[248:251], v[172:175], v[200:203]
    v_mad_u32_u16 v217, v216, 2, s85
    v_mad_u32_u16 v216, v216, 2, s85 op_sel:[1,0,0,0]
    v_cvt_pkrtz_f16_f32 v218, v180, v181
    v_mfma_f32_16x16x32_f16 v[196:199], a[252:255], v[168:171], v[196:199]
    ds_read_b128 a[248:251], v24 offset:12288
    v_pk_lshrrev_b16 v218, 3, v218 op_sel_hi:[0,1]
    v_mad_u32_u16 v219, v218, 2, s85
    v_mfma_f32_16x16x32_f16 v[204:207], a[252:255], v[172:175], v[204:207]
    s_waitcnt lgkmcnt(11)
    ds_read_b128 a[252:255], v24 offset:13312
    v_or_b32 v244, v0, v253
    v_mad_u32_u16 v218, v218, 2, s85 op_sel:[1,0,0,0]
    v_mfma_f32_16x16x32_bf16 v[32:35], a[216:219], v[232:235], v[32:35]
    ds_read_u16 v215, v215
    v_cvt_pkrtz_f16_f32 v220, v182, v183
    v_pk_lshrrev_b16 v220, 3, v220 op_sel_hi:[0,1]
    v_mfma_f32_16x16x32_bf16 v[40:43], a[216:219], v[236:239], v[40:43]
    s_waitcnt lgkmcnt(12)
    v_mad_u32_u16 v221, v220, 2, s85
    v_mad_u32_u16 v220, v220, 2, s85 op_sel:[1,0,0,0]
    s_waitcnt lgkmcnt(11)
    v_or_b32 v245, v209, v208
    v_mfma_f32_16x16x32_bf16 v[36:39], a[220:223], v[232:235], v[36:39]
    ds_read_u16_d16_hi v214, v214
    v_cvt_pkrtz_f16_f32 v222, v184, v185
    v_pk_lshrrev_b16 v222, 3, v222 op_sel_hi:[0,1]
    v_mfma_f32_16x16x32_bf16 v[44:47], a[220:223], v[236:239], v[44:47]
    ds_read_u16 v217, v217
    v_mad_u32_u16 v223, v222, 2, s85
    v_mad_u32_u16 v222, v222, 2, s85 op_sel:[1,0,0,0]
    v_mfma_f32_16x16x32_bf16 v[80:83], a[216:219], v[240:243], v[80:83]
    s_waitcnt lgkmcnt(11)
    ds_read_u16_d16_hi v216, v216
    v_or_b32 v246, v211, v210
    v_cvt_pkrtz_f16_f32 v224, v186, v187
    v_pk_lshrrev_b16 v224, 3, v224 op_sel_hi:[0,1]
    v_mad_u32_u16 v225, v224, 2, s85
    v_mad_u32_u16 v224, v224, 2, s85 op_sel:[1,0,0,0]
    v_cvt_pkrtz_f16_f32 v228, v188, v189
    v_cvt_pkrtz_f16_f32 v231, v190, v191
    v_pk_fma_f16 v226, v228, v228, s53
    v_pk_fma_f16 v229, v231, v231, s53
    v_pk_mul_f16 v226, v226, v228 neg_lo:[1,0] neg_hi:[1,0]
    v_pk_mul_f16 v229, v229, v231 neg_lo:[1,0] neg_hi:[1,0]
    v_exp_f16 v227, v226
    s_waitcnt lgkmcnt(10)
    v_or_b32 v247, v213, v212
    v_exp_f16 v230, v229
    v_exp_f16_sdwa v227, v226 dst_sel:WORD_1 dst_unused:UNUSED_PRESERVE src0_sel:WORD_1
    v_mfma_f32_16x16x32_bf16 v[88:91], a[216:219], v[244:247], v[88:91]
    s_waitcnt lgkmcnt(9)
    ds_read_u16 v219, v219
    ds_read_u16_d16_hi v218, v218
    ds_read_u16 v221, v221
    ds_read_u16_d16_hi v220, v220
    v_mfma_f32_16x16x32_bf16 v[48:51], a[232:235], v[232:235], v[48:51]
    ds_read_u16 v223, v223
    v_exp_f16_sdwa v230, v229 dst_sel:WORD_1 dst_unused:UNUSED_PRESERVE src0_sel:WORD_1
    v_mfma_f32_16x16x32_bf16 v[56:59], a[232:235], v[236:239], v[56:59]
    s_waitcnt lgkmcnt(13)
    ds_read_u16_d16_hi v222, v222
    v_pk_fma_f16 v227, v227, s86, s86
    v_pk_fma_f16 v230, v230, s86, s86
    v_mfma_f32_16x16x32_bf16 v[84:87], a[220:223], v[240:243], v[84:87]
    s_waitcnt lgkmcnt(12)
    ds_read_u16 v225, v225
    ds_read_u16_d16_hi v224, v224
    v_rcp_f16 v226, v227
    v_mfma_f32_16x16x32_bf16 v[92:95], a[220:223], v[244:247], v[92:95]
    v_rcp_f16 v229, v230
    v_rcp_f16_sdwa v226, v227 dst_sel:WORD_1 dst_unused:UNUSED_PRESERVE src0_sel:WORD_1
    v_mfma_f32_16x16x32_bf16 v[52:55], a[236:239], v[232:235], v[52:55]
    v_rcp_f16_sdwa v229, v230 dst_sel:WORD_1 dst_unused:UNUSED_PRESERVE src0_sel:WORD_1
    v_fma_mix_f32 v227, v226, v228, 0 op_sel_hi:[1,1,0]
    v_mfma_f32_16x16x32_bf16 v[60:63], a[236:239], v[236:239], v[60:63]
    v_fma_mix_f32 v230, v229, v231, 0 op_sel_hi:[1,1,0]
    v_fma_mix_f32 v226, v226, v228, 0 op_sel:[1,1,0] op_sel_hi:[1,1,0]
    v_fma_mix_f32 v229, v229, v231, 0 op_sel:[1,1,0] op_sel_hi:[1,1,0]
    v_mfma_f32_16x16x32_bf16 v[96:99], a[232:235], v[240:243], v[96:99]
    v_cvt_pkrtz_f16_f32 v248, v192, v193
    v_pk_lshrrev_b16 v248, 3, v248 op_sel_hi:[0,1]
    v_cvt_pkrtz_f16_f32 v250, v194, v195
    v_mfma_f32_16x16x32_bf16 v[104:107], a[232:235], v[244:247], v[104:107]
    s_waitcnt lgkmcnt(13)
    ds_read_b128 a[232:235], v24 offset:14336
    v_cvt_pkrtz_f16_f32 v252, v196, v197
    v_cvt_pkrtz_f16_f32 v0, v198, v199
    v_mfma_f32_16x16x32_bf16 v[64:67], a[240:243], v[232:235], v[64:67]
    v_cvt_pkrtz_f16_f32 v209, v200, v201
    v_cvt_pkrtz_f16_f32 v211, v202, v203
    v_mad_u32_u16 v249, v248, 2, s85
    v_mfma_f32_16x16x32_bf16 v[72:75], a[240:243], v[236:239], v[72:75]
    s_waitcnt lgkmcnt(13)
    ds_read_u16 v249, v249
    v_mad_u32_u16 v248, v248, 2, s85 op_sel:[1,0,0,0]
    v_pk_lshrrev_b16 v250, 3, v250 op_sel_hi:[0,1]
    v_mfma_f32_16x16x32_bf16 v[100:103], a[236:239], v[240:243], v[100:103]
    s_waitcnt lgkmcnt(13)
    ds_read_u16_d16_hi v248, v248
    v_mad_u32_u16 v251, v250, 2, s85
    v_mad_u32_u16 v250, v250, 2, s85 op_sel:[1,0,0,0]
    v_mfma_f32_16x16x32_bf16 v[108:111], a[236:239], v[244:247], v[108:111]
    s_waitcnt lgkmcnt(11)
    ds_read_b128 a[236:239], v24 offset:15360
    ds_read_u16 v251, v251
    ds_read_u16_d16_hi v250, v250
    v_mfma_f32_16x16x32_bf16 v[68:71], a[244:247], v[232:235], v[68:71]
    s_waitcnt lgkmcnt(12)
    v_or_b32 v232, v215, v214
    v_or_b32 v233, v217, v216
    v_or_b32 v234, v219, v218
    v_mfma_f32_16x16x32_bf16 v[76:79], a[244:247], v[236:239], v[76:79]
    s_waitcnt lgkmcnt(10)
    v_or_b32 v235, v221, v220
    v_cvt_pk_bf16_f32 v238, v227, v226
    v_cvt_pk_bf16_f32 v239, v230, v229
    v_mfma_f32_16x16x32_bf16 v[112:115], a[240:243], v[240:243], v[112:115]
    v_cvt_pkrtz_f16_f32 v215, v204, v205
    v_cvt_pkrtz_f16_f32 v218, v206, v207
    v_pk_lshrrev_b16 v252, 3, v252 op_sel_hi:[0,1]
    v_mfma_f32_16x16x32_bf16 v[120:123], a[240:243], v[244:247], v[120:123]
    s_waitcnt lgkmcnt(8)
    ds_read_b128 a[240:243], v24 offset:16384
    v_or_b32 v236, v223, v222
    v_mad_u32_u16 v253, v252, 2, s85
    v_mfma_f32_16x16x32_bf16 v[116:119], a[244:247], v[240:243], v[116:119]
    ds_read_u16 v253, v253
    v_mad_u32_u16 v252, v252, 2, s85 op_sel:[1,0,0,0]
    v_pk_lshrrev_b16 v0, 3, v0 op_sel_hi:[0,1]
    v_mfma_f32_16x16x32_bf16 v[124:127], a[244:247], v[244:247], v[124:127]
    s_add_u32 m0, s56, 1024
    ds_read_b128 a[244:247], v24 offset:17408
    buffer_load_dwordx4 v2, s[20:23], 0 offen offset:0 lds
    ds_read_u16_d16_hi v252, v252
    v_mfma_f32_16x16x32_f16 v[176:179], a[248:251], v[128:131], 0
    s_waitcnt lgkmcnt(10)
    v_or_b32 v237, v225, v224
    v_mad_u32_u16 v208, v0, 2, s85
    v_mad_u32_u16 v0, v0, 2, s85 op_sel:[1,0,0,0]
    v_mfma_f32_16x16x32_f16 v[184:187], a[248:251], v[132:135], 0
    ds_read_u16 v208, v208
    ds_read_u16_d16_hi v0, v0
    v_pk_lshrrev_b16 v209, 3, v209 op_sel_hi:[0,1]
    v_mfma_f32_16x16x32_f16 v[180:183], a[252:255], v[128:131], 0
    v_mad_u32_u16 v210, v209, 2, s85
    v_mad_u32_u16 v209, v209, 2, s85 op_sel:[1,0,0,0]
    v_pk_lshrrev_b16 v211, 3, v211 op_sel_hi:[0,1]
    v_mfma_f32_16x16x32_f16 v[188:191], a[252:255], v[132:135], 0
    ds_read_u16 v210, v210
    ds_read_u16_d16_hi v209, v209
    v_mad_u32_u16 v212, v211, 2, s85
    v_mfma_f32_16x16x32_f16 v[192:195], a[248:251], v[152:155], 0
    s_waitcnt lgkmcnt(13)
    ds_read_u16 v212, v212
    v_mad_u32_u16 v211, v211, 2, s85 op_sel:[1,0,0,0]
    v_pk_fma_f16 v213, v215, v215, s53
    v_mfma_f32_16x16x32_f16 v[200:203], a[248:251], v[156:159], 0
    s_waitcnt lgkmcnt(12)
    ds_read_u16_d16_hi v211, v211
    ds_read_b128 a[248:251], v24 offset:6144
    v_pk_fma_f16 v216, v218, v218, s53
    v_mfma_f32_16x16x32_f16 v[176:179], a[232:235], v[136:139], v[176:179]
    v_pk_mul_f16 v213, v213, v215 neg_lo:[1,0] neg_hi:[1,0]
    v_pk_mul_f16 v216, v216, v218 neg_lo:[1,0] neg_hi:[1,0]
    v_exp_f16 v214, v213
    v_mfma_f32_16x16x32_f16 v[184:187], a[232:235], v[140:143], v[184:187]
    v_exp_f16 v217, v216
    v_exp_f16_sdwa v214, v213 dst_sel:WORD_1 dst_unused:UNUSED_PRESERVE src0_sel:WORD_1
    v_mfma_f32_16x16x32_f16 v[196:199], a[252:255], v[152:155], 0
    v_exp_f16_sdwa v217, v216 dst_sel:WORD_1 dst_unused:UNUSED_PRESERVE src0_sel:WORD_1
    v_pk_fma_f16 v214, v214, s86, s86
    v_mfma_f32_16x16x32_f16 v[204:207], a[252:255], v[156:159], 0
    s_waitcnt lgkmcnt(13)
    ds_read_b128 a[252:255], v24 offset:7168
    v_pk_fma_f16 v217, v217, s86, s86
    v_rcp_f16 v213, v214
    v_mfma_f32_16x16x32_f16 v[180:183], a[236:239], v[136:139], v[180:183]
    v_rcp_f16 v216, v217
    v_rcp_f16_sdwa v213, v214 dst_sel:WORD_1 dst_unused:UNUSED_PRESERVE src0_sel:WORD_1
    v_mfma_f32_16x16x32_f16 v[188:191], a[236:239], v[140:143], v[188:191]
    s_add_u32 m0, s56, 2048
    v_rcp_f16_sdwa v216, v217 dst_sel:WORD_1 dst_unused:UNUSED_PRESERVE src0_sel:WORD_1
    v_fma_mix_f32 v214, v213, v215, 0 op_sel_hi:[1,1,0]
    v_mfma_f32_16x16x32_f16 v[192:195], a[232:235], v[160:163], v[192:195]
    buffer_load_dwordx4 v3, s[20:23], 0 offen offset:0 lds
    v_mfma_f32_16x16x32_f16 v[200:203], a[232:235], v[164:167], v[200:203]
    s_waitcnt lgkmcnt(11)
    ds_read_b128 a[232:235], v24 offset:8192
    v_fma_mix_f32 v217, v216, v218, 0 op_sel_hi:[1,1,0]
    v_fma_mix_f32 v213, v213, v215, 0 op_sel:[1,1,0] op_sel_hi:[1,1,0]
    v_mfma_f32_16x16x32_f16 v[176:179], a[240:243], v[144:147], v[176:179]
    v_fma_mix_f32 v216, v216, v218, 0 op_sel:[1,1,0] op_sel_hi:[1,1,0]
    v_or_b32 v240, v249, v248
    v_or_b32 v241, v251, v250
    v_mfma_f32_16x16x32_f16 v[184:187], a[240:243], v[148:151], v[184:187]
    s_waitcnt lgkmcnt(6)
    v_or_b32 v242, v253, v252
    v_or_b32 v243, v208, v0
    s_waitcnt lgkmcnt(5)
    v_or_b32 v244, v210, v209
    v_mfma_f32_16x16x32_f16 v[196:199], a[236:239], v[160:163], v[196:199]
    v_cvt_pk_bf16_f32 v246, v214, v213
    v_cvt_pk_bf16_f32 v247, v217, v216
    v_cvt_pkrtz_f16_f32 v219, v176, v177
    v_mfma_f32_16x16x32_f16 v[204:207], a[236:239], v[164:167], v[204:207]
    ds_read_b128 a[236:239], v24 offset:9216
    v_pk_lshrrev_b16 v219, 3, v219 op_sel_hi:[0,1]
    v_mad_u32_u16 v220, v219, 2, s85
    v_mfma_f32_16x16x32_f16 v[180:183], a[244:247], v[144:147], v[180:183]
    s_waitcnt lgkmcnt(4)
    ds_read_u16 v220, v220
    v_or_b32 v245, v212, v211
    v_mad_u32_u16 v219, v219, 2, s85 op_sel:[1,0,0,0]
    v_mfma_f32_16x16x32_f16 v[188:191], a[244:247], v[148:151], v[188:191]
    ds_read_u16_d16_hi v219, v219
    v_cvt_pkrtz_f16_f32 v221, v178, v179
    v_pk_lshrrev_b16 v221, 3, v221 op_sel_hi:[0,1]
    v_mfma_f32_16x16x32_f16 v[192:195], a[240:243], v[168:171], v[192:195]
    v_mad_u32_u16 v222, v221, 2, s85
    v_mad_u32_u16 v221, v221, 2, s85 op_sel:[1,0,0,0]
    v_cvt_pkrtz_f16_f32 v223, v180, v181
    v_mfma_f32_16x16x32_f16 v[200:203], a[240:243], v[172:175], v[200:203]
    ds_read_b128 a[240:243], v24 offset:10240
    ds_read_u16 v222, v222
    ds_read_u16_d16_hi v221, v221
    v_mfma_f32_16x16x32_f16 v[196:199], a[244:247], v[168:171], v[196:199]
    v_pk_lshrrev_b16 v223, 3, v223 op_sel_hi:[0,1]
    v_mad_u32_u16 v224, v223, 2, s85
    v_mad_u32_u16 v223, v223, 2, s85 op_sel:[1,0,0,0]
    v_mfma_f32_16x16x32_f16 v[204:207], a[244:247], v[172:175], v[204:207]
    s_waitcnt lgkmcnt(8)
    ds_read_b128 a[244:247], v24 offset:11264
    ds_read_u16 v224, v224
    ds_read_u16_d16_hi v223, v223
    v_mfma_f32_16x16x32_bf16 v[32:35], a[248:251], v[232:235], v[32:35]
    v_cvt_pkrtz_f16_f32 v225, v182, v183
    v_pk_lshrrev_b16 v225, 3, v225 op_sel_hi:[0,1]
    v_mad_u32_u16 v226, v225, 2, s85
    v_mfma_f32_16x16x32_bf16 v[40:43], a[248:251], v[236:239], v[40:43]
    s_waitcnt lgkmcnt(10)
    ds_read_u16 v226, v226
    v_mad_u32_u16 v225, v225, 2, s85 op_sel:[1,0,0,0]
    v_cvt_pkrtz_f16_f32 v227, v184, v185
    v_mfma_f32_16x16x32_bf16 v[36:39], a[252:255], v[232:235], v[36:39]
    ds_read_u16_d16_hi v225, v225
    v_pk_lshrrev_b16 v227, 3, v227 op_sel_hi:[0,1]
    v_mad_u32_u16 v228, v227, 2, s85
    v_mfma_f32_16x16x32_bf16 v[44:47], a[252:255], v[236:239], v[44:47]
    ds_read_u16 v228, v228
    v_mad_u32_u16 v227, v227, 2, s85 op_sel:[1,0,0,0]
    v_cvt_pkrtz_f16_f32 v229, v186, v187
    v_mfma_f32_16x16x32_bf16 v[80:83], a[248:251], v[240:243], v[80:83]
    ds_read_u16_d16_hi v227, v227
    v_pk_lshrrev_b16 v229, 3, v229 op_sel_hi:[0,1]
    v_mad_u32_u16 v230, v229, 2, s85
    v_mfma_f32_16x16x32_bf16 v[88:91], a[248:251], v[244:247], v[88:91]
    s_waitcnt lgkmcnt(12)
    ds_read_u16 v230, v230
    ds_read_b128 a[248:251], v24 offset:24576
    v_mad_u32_u16 v229, v229, 2, s85 op_sel:[1,0,0,0]
    v_mfma_f32_16x16x32_bf16 v[48:51], a[232:235], v[232:235], v[48:51]
    s_waitcnt lgkmcnt(13)
    ds_read_u16_d16_hi v229, v229
    v_cvt_pkrtz_f16_f32 v231, v188, v189
    v_pk_lshrrev_b16 v231, 3, v231 op_sel_hi:[0,1]
    v_mfma_f32_16x16x32_bf16 v[56:59], a[232:235], v[236:239], v[56:59]
    v_mad_u32_u16 v248, v231, 2, s85
    v_mad_u32_u16 v231, v231, 2, s85 op_sel:[1,0,0,0]
    v_cvt_pkrtz_f16_f32 v249, v190, v191
    v_mfma_f32_16x16x32_bf16 v[84:87], a[252:255], v[240:243], v[84:87]
    s_waitcnt lgkmcnt(12)
    ds_read_u16 v248, v248
    ds_read_u16_d16_hi v231, v231
    v_pk_lshrrev_b16 v249, 3, v249 op_sel_hi:[0,1]
    v_mfma_f32_16x16x32_bf16 v[92:95], a[252:255], v[244:247], v[92:95]
    s_waitcnt lgkmcnt(13)
    ds_read_b128 a[252:255], v24 offset:25600
    v_mad_u32_u16 v250, v249, 2, s85
    v_mad_u32_u16 v249, v249, 2, s85 op_sel:[1,0,0,0]
    v_mfma_f32_16x16x32_bf16 v[52:55], a[236:239], v[232:235], v[52:55]
    s_waitcnt lgkmcnt(12)
    ds_read_u16 v250, v250
    ds_read_u16_d16_hi v249, v249
    v_cvt_pkrtz_f16_f32 v251, v192, v193
    v_mfma_f32_16x16x32_bf16 v[60:63], a[236:239], v[236:239], v[60:63]
    v_pk_lshrrev_b16 v251, 3, v251 op_sel_hi:[0,1]
    v_cvt_pkrtz_f16_f32 v253, v194, v195
    v_cvt_pkrtz_f16_f32 v208, v196, v197
    v_mfma_f32_16x16x32_bf16 v[96:99], a[232:235], v[240:243], v[96:99]
    v_cvt_pkrtz_f16_f32 v210, v198, v199
    v_cvt_pkrtz_f16_f32 v212, v200, v201
    v_cvt_pkrtz_f16_f32 v214, v202, v203
    v_mfma_f32_16x16x32_bf16 v[104:107], a[232:235], v[244:247], v[104:107]
    s_waitcnt lgkmcnt(13)
    ds_read_b128 a[232:235], v24 offset:26624
    v_cvt_pkrtz_f16_f32 v216, v204, v205
    v_cvt_pkrtz_f16_f32 v218, v206, v207
    v_mfma_f32_16x16x32_bf16 v[64:67], a[240:243], v[232:235], v[64:67]
    v_mad_u32_u16 v252, v251, 2, s85
    v_mad_u32_u16 v251, v251, 2, s85 op_sel:[1,0,0,0]
    v_pk_lshrrev_b16 v253, 3, v253 op_sel_hi:[0,1]
    v_mfma_f32_16x16x32_bf16 v[72:75], a[240:243], v[236:239], v[72:75]
    s_waitcnt lgkmcnt(12)
    ds_read_u16 v252, v252
    ds_read_u16_d16_hi v251, v251
    v_mad_u32_u16 v0, v253, 2, s85
    v_mfma_f32_16x16x32_bf16 v[100:103], a[236:239], v[240:243], v[100:103]
    s_waitcnt lgkmcnt(13)
    ds_read_u16 v0, v0
    v_mad_u32_u16 v253, v253, 2, s85 op_sel:[1,0,0,0]
    v_pk_lshrrev_b16 v208, 3, v208 op_sel_hi:[0,1]
    v_mfma_f32_16x16x32_bf16 v[108:111], a[236:239], v[244:247], v[108:111]
    s_waitcnt lgkmcnt(12)
    ds_read_b128 a[236:239], v24 offset:27648
    ds_read_u16_d16_hi v253, v253
    v_mad_u32_u16 v209, v208, 2, s85
    v_mfma_f32_16x16x32_bf16 v[68:71], a[244:247], v[232:235], v[68:71]
    s_waitcnt lgkmcnt(13)
    ds_read_u16 v209, v209
    v_or_b32 v232, v220, v219
    v_or_b32 v233, v222, v221
    v_mfma_f32_16x16x32_bf16 v[76:79], a[244:247], v[236:239], v[76:79]
    v_or_b32 v234, v224, v223
    v_or_b32 v235, v226, v225
    v_or_b32 v236, v228, v227
    v_mfma_f32_16x16x32_bf16 v[112:115], a[240:243], v[240:243], v[112:115]
    s_waitcnt lgkmcnt(10)
    v_or_b32 v237, v230, v229
    v_or_b32 v238, v248, v231
    v_mad_u32_u16 v208, v208, 2, s85 op_sel:[1,0,0,0]
    v_mfma_f32_16x16x32_bf16 v[120:123], a[240:243], v[244:247], v[120:123]
    ds_read_b128 a[240:243], v24 offset:28672
    ds_read_u16_d16_hi v208, v208
    v_pk_lshrrev_b16 v210, 3, v210 op_sel_hi:[0,1]
    v_mfma_f32_16x16x32_bf16 v[116:119], a[244:247], v[240:243], v[116:119]
    s_waitcnt lgkmcnt(9)
    v_mad_u32_u16 v211, v210, 2, s85
    v_or_b32 v239, v250, v249
    v_mad_u32_u16 v210, v210, 2, s85 op_sel:[1,0,0,0]
    v_mfma_f32_16x16x32_bf16 v[124:127], a[244:247], v[244:247], v[124:127]
    ds_read_b128 a[244:247], v24 offset:29696
    ds_read_u16 v211, v211
    ds_read_u16_d16_hi v210, v210
    v_mfma_f32_16x16x32_f16 v[176:179], a[248:251], v[128:131], 0
    v_pk_lshrrev_b16 v212, 3, v212 op_sel_hi:[0,1]
    v_mad_u32_u16 v213, v212, 2, s85
    v_mad_u32_u16 v212, v212, 2, s85 op_sel:[1,0,0,0]
    v_mfma_f32_16x16x32_f16 v[184:187], a[248:251], v[132:135], 0
    ds_read_u16 v213, v213
    ds_read_u16_d16_hi v212, v212
    v_pk_lshrrev_b16 v214, 3, v214 op_sel_hi:[0,1]
    v_mfma_f32_16x16x32_f16 v[180:183], a[252:255], v[128:131], 0
    s_waitcnt lgkmcnt(12)
    v_mad_u32_u16 v215, v214, 2, s85
    v_mad_u32_u16 v214, v214, 2, s85 op_sel:[1,0,0,0]
    v_pk_lshrrev_b16 v216, 3, v216 op_sel_hi:[0,1]
    v_mfma_f32_16x16x32_f16 v[188:191], a[252:255], v[132:135], 0
    s_add_u32 m0, s56, 3072
    ds_read_u16 v215, v215
    ds_read_u16_d16_hi v214, v214
    buffer_load_dwordx4 v4, s[20:23], 0 offen offset:0 lds
    v_mfma_f32_16x16x32_f16 v[192:195], a[248:251], v[152:155], 0
    v_mad_u32_u16 v217, v216, 2, s85
    v_mad_u32_u16 v216, v216, 2, s85 op_sel:[1,0,0,0]
    v_pk_lshrrev_b16 v218, 3, v218 op_sel_hi:[0,1]
    v_mfma_f32_16x16x32_f16 v[200:203], a[248:251], v[156:159], 0
    s_waitcnt lgkmcnt(12)
    ds_read_u16 v217, v217
    ds_read_u16_d16_hi v216, v216
    v_mad_u32_u16 v219, v218, 2, s85
    v_mfma_f32_16x16x32_f16 v[176:179], a[232:235], v[136:139], v[176:179]
    s_waitcnt lgkmcnt(12)
    v_mad_u32_u16 v218, v218, 2, s85 op_sel:[1,0,0,0]
    v_or_b32 v240, v252, v251
    v_or_b32 v241, v0, v253
    v_mfma_f32_16x16x32_f16 v[184:187], a[232:235], v[140:143], v[184:187]
    ds_read_u16 v219, v219
    ds_read_u16_d16_hi v218, v218
    v_mfma_f32_16x16x32_f16 v[196:199], a[252:255], v[152:155], 0
    v_mfma_f32_16x16x32_f16 v[204:207], a[252:255], v[156:159], 0
    s_waitcnt lgkmcnt(11)
    ds_read_b128 a[248:251], v24 offset:18432
    v_or_b32 v242, v209, v208
    v_mfma_f32_16x16x32_f16 v[180:183], a[236:239], v[136:139], v[180:183]
    ds_read_b128 a[252:255], v24 offset:19456
    v_mfma_f32_16x16x32_f16 v[188:191], a[236:239], v[140:143], v[188:191]
    v_mfma_f32_16x16x32_f16 v[192:195], a[232:235], v[160:163], v[192:195]
    v_mfma_f32_16x16x32_f16 v[200:203], a[232:235], v[164:167], v[200:203]
    s_waitcnt lgkmcnt(10)
    ds_read_b128 a[232:235], v24 offset:20480
    v_or_b32 v243, v211, v210
    v_mfma_f32_16x16x32_f16 v[176:179], a[240:243], v[144:147], v[176:179]
    v_mfma_f32_16x16x32_f16 v[184:187], a[240:243], v[148:151], v[184:187]
    s_add_u32 m0, s56, 4096
    v_mfma_f32_16x16x32_f16 v[196:199], a[236:239], v[160:163], v[196:199]
    buffer_load_dwordx4 v5, s[20:23], 0 offen offset:0 lds
    v_mfma_f32_16x16x32_f16 v[204:207], a[236:239], v[164:167], v[204:207]
    s_waitcnt lgkmcnt(9)
    ds_read_b128 a[236:239], v24 offset:21504
    v_or_b32 v244, v213, v212
    v_mfma_f32_16x16x32_f16 v[180:183], a[244:247], v[144:147], v[180:183]
    v_cvt_pkrtz_f16_f32 v220, v176, v177
    v_pk_lshrrev_b16 v220, 3, v220 op_sel_hi:[0,1]
    v_mad_u32_u16 v221, v220, 2, s85
    v_mfma_f32_16x16x32_f16 v[188:191], a[244:247], v[148:151], v[188:191]
    s_waitcnt lgkmcnt(8)
    ds_read_u16 v221, v221
    v_or_b32 v245, v215, v214
    v_mad_u32_u16 v220, v220, 2, s85 op_sel:[1,0,0,0]
    v_mfma_f32_16x16x32_f16 v[192:195], a[240:243], v[168:171], v[192:195]
    ds_read_u16_d16_hi v220, v220
    v_cvt_pkrtz_f16_f32 v222, v178, v179
    v_pk_lshrrev_b16 v222, 3, v222 op_sel_hi:[0,1]
    v_mfma_f32_16x16x32_f16 v[200:203], a[240:243], v[172:175], v[200:203]
    ds_read_b128 a[240:243], v24 offset:22528
    v_mad_u32_u16 v223, v222, 2, s85
    v_mad_u32_u16 v222, v222, 2, s85 op_sel:[1,0,0,0]
    v_mfma_f32_16x16x32_f16 v[196:199], a[244:247], v[168:171], v[196:199]
    s_waitcnt lgkmcnt(9)
    ds_read_u16 v223, v223
    ds_read_u16_d16_hi v222, v222
    v_or_b32 v246, v217, v216
    v_mfma_f32_16x16x32_f16 v[204:207], a[244:247], v[172:175], v[204:207]
    s_waitcnt lgkmcnt(9)
    ds_read_b128 a[244:247], v24 offset:23552
    v_cvt_pkrtz_f16_f32 v224, v180, v181
    v_pk_lshrrev_b16 v224, 3, v224 op_sel_hi:[0,1]
    v_mad_u32_u16 v225, v224, 2, s85
    v_mad_u32_u16 v224, v224, 2, s85 op_sel:[1,0,0,0]
    v_cvt_pkrtz_f16_f32 v226, v182, v183
    v_pk_lshrrev_b16 v226, 3, v226 op_sel_hi:[0,1]
    v_mad_u32_u16 v227, v226, 2, s85
    v_or_b32 v247, v219, v218
    v_mad_u32_u16 v226, v226, 2, s85 op_sel:[1,0,0,0]
    v_cvt_pkrtz_f16_f32 v228, v184, v185
    v_pk_lshrrev_b16 v228, 3, v228 op_sel_hi:[0,1]
    s_waitcnt lgkmcnt(9)
    v_mfma_f32_16x16x32_bf16 v[32:35], a[248:251], v[232:235], v[32:35]
    s_add_u32 m0, s56, 5120
    ds_read_u16 v225, v225
    ds_read_u16_d16_hi v224, v224
    ds_read_u16 v227, v227
    ds_read_u16_d16_hi v226, v226
    v_mfma_f32_16x16x32_bf16 v[40:43], a[248:251], v[236:239], v[40:43]
    s_waitcnt lgkmcnt(12)
    buffer_load_dwordx4 v6, s[20:23], 0 offen offset:0 lds
    v_mfma_f32_16x16x32_bf16 v[36:39], a[252:255], v[232:235], v[36:39]
    v_mad_u32_u16 v229, v228, 2, s85
    v_mad_u32_u16 v228, v228, 2, s85 op_sel:[1,0,0,0]
    v_cvt_pkrtz_f16_f32 v230, v186, v187
    v_mfma_f32_16x16x32_bf16 v[44:47], a[252:255], v[236:239], v[44:47]
    ds_read_u16 v229, v229
    ds_read_u16_d16_hi v228, v228
    v_pk_lshrrev_b16 v230, 3, v230 op_sel_hi:[0,1]
    v_mfma_f32_16x16x32_bf16 v[80:83], a[248:251], v[240:243], v[80:83]
    v_mad_u32_u16 v231, v230, 2, s85
    v_mad_u32_u16 v230, v230, 2, s85 op_sel:[1,0,0,0]
    v_cvt_pkrtz_f16_f32 v248, v188, v189
    v_mfma_f32_16x16x32_bf16 v[88:91], a[248:251], v[244:247], v[88:91]
    s_waitcnt lgkmcnt(11)
    ds_read_u16 v231, v231
    ds_read_u16_d16_hi v230, v230
    ds_read_b128 a[248:251], v24 offset:36864
    v_mfma_f32_16x16x32_bf16 v[48:51], a[232:235], v[232:235], v[48:51]
    v_pk_lshrrev_b16 v248, 3, v248 op_sel_hi:[0,1]
    v_mad_u32_u16 v249, v248, 2, s85
    v_mad_u32_u16 v248, v248, 2, s85 op_sel:[1,0,0,0]
    v_mfma_f32_16x16x32_bf16 v[56:59], a[232:235], v[236:239], v[56:59]
    s_waitcnt lgkmcnt(13)
    ds_read_u16 v249, v249
    v_cvt_pkrtz_f16_f32 v252, v190, v191
    v_pk_fma_f16 v250, v252, v252, s53
    v_mfma_f32_16x16x32_bf16 v[84:87], a[252:255], v[240:243], v[84:87]
    s_waitcnt lgkmcnt(13)
    ds_read_u16_d16_hi v248, v248
    v_pk_mul_f16 v250, v250, v252 neg_lo:[1,0] neg_hi:[1,0]
    v_exp_f16 v251, v250
    v_mfma_f32_16x16x32_bf16 v[92:95], a[252:255], v[244:247], v[92:95]
    s_waitcnt lgkmcnt(13)
    ds_read_b128 a[252:255], v24 offset:37888
    v_exp_f16_sdwa v251, v250 dst_sel:WORD_1 dst_unused:UNUSED_PRESERVE src0_sel:WORD_1
    v_mfma_f32_16x16x32_bf16 v[52:55], a[236:239], v[232:235], v[52:55]
    v_pk_fma_f16 v251, v251, s86, s86
    v_rcp_f16 v250, v251
    v_mfma_f32_16x16x32_bf16 v[60:63], a[236:239], v[236:239], v[60:63]
    v_rcp_f16_sdwa v250, v251 dst_sel:WORD_1 dst_unused:UNUSED_PRESERVE src0_sel:WORD_1
    v_cvt_pkrtz_f16_f32 v253, v192, v193
    v_mfma_f32_16x16x32_bf16 v[96:99], a[232:235], v[240:243], v[96:99]
    v_fma_mix_f32 v251, v250, v252, 0 op_sel_hi:[1,1,0]
    v_fma_mix_f32 v250, v250, v252, 0 op_sel:[1,1,0] op_sel_hi:[1,1,0]
    v_pk_lshrrev_b16 v253, 3, v253 op_sel_hi:[0,1]
    v_mfma_f32_16x16x32_bf16 v[104:107], a[232:235], v[244:247], v[104:107]
    s_waitcnt lgkmcnt(13)
    ds_read_b128 a[232:235], v24 offset:38912
    v_cvt_pkrtz_f16_f32 v208, v194, v195
    v_cvt_pkrtz_f16_f32 v210, v196, v197
    v_mfma_f32_16x16x32_bf16 v[64:67], a[240:243], v[232:235], v[64:67]
    v_cvt_pkrtz_f16_f32 v212, v198, v199
    v_cvt_pkrtz_f16_f32 v214, v200, v201
    v_cvt_pkrtz_f16_f32 v216, v202, v203
    v_mfma_f32_16x16x32_bf16 v[72:75], a[240:243], v[236:239], v[72:75]
    v_cvt_pkrtz_f16_f32 v218, v204, v205
    v_mad_u32_u16 v0, v253, 2, s85
    v_mad_u32_u16 v253, v253, 2, s85 op_sel:[1,0,0,0]
    v_mfma_f32_16x16x32_bf16 v[100:103], a[236:239], v[240:243], v[100:103]
    s_waitcnt lgkmcnt(12)
    ds_read_u16 v0, v0
    ds_read_u16_d16_hi v253, v253
    v_pk_lshrrev_b16 v208, 3, v208 op_sel_hi:[0,1]
    v_mfma_f32_16x16x32_bf16 v[108:111], a[236:239], v[244:247], v[108:111]
    s_waitcnt lgkmcnt(13)
    ds_read_b128 a[236:239], v24 offset:39936
    v_mad_u32_u16 v209, v208, 2, s85
    v_mad_u32_u16 v208, v208, 2, s85 op_sel:[1,0,0,0]
    v_mfma_f32_16x16x32_bf16 v[68:71], a[244:247], v[232:235], v[68:71]
    s_waitcnt lgkmcnt(12)
    ds_read_u16 v209, v209
    ds_read_u16_d16_hi v208, v208
    v_or_b32 v232, v221, v220
    v_mfma_f32_16x16x32_bf16 v[76:79], a[244:247], v[236:239], v[76:79]
    v_or_b32 v233, v223, v222
    v_or_b32 v234, v225, v224
    v_or_b32 v235, v227, v226
    v_mfma_f32_16x16x32_bf16 v[112:115], a[240:243], v[240:243], v[112:115]
    s_waitcnt lgkmcnt(10)
    v_or_b32 v236, v229, v228
    v_or_b32 v237, v231, v230
    v_cvt_pk_bf16_f32 v239, v251, v250
    v_mfma_f32_16x16x32_bf16 v[120:123], a[240:243], v[244:247], v[120:123]
    ds_read_b128 a[240:243], v24 offset:40960
    v_cvt_pkrtz_f16_f32 v220, v206, v207
    v_pk_lshrrev_b16 v210, 3, v210 op_sel_hi:[0,1]
    v_mfma_f32_16x16x32_bf16 v[116:119], a[244:247], v[240:243], v[116:119]
    v_mad_u32_u16 v211, v210, 2, s85
    v_mad_u32_u16 v210, v210, 2, s85 op_sel:[1,0,0,0]
    v_pk_lshrrev_b16 v212, 3, v212 op_sel_hi:[0,1]
    v_mfma_f32_16x16x32_bf16 v[124:127], a[244:247], v[244:247], v[124:127]
    s_waitcnt lgkmcnt(10)
    ds_read_b128 a[244:247], v24 offset:41984
    ds_read_u16 v211, v211
    ds_read_u16_d16_hi v210, v210
    v_mfma_f32_16x16x32_f16 v[176:179], a[248:251], v[128:131], 0
    s_waitcnt lgkmcnt(11)
    v_or_b32 v238, v249, v248
    v_mad_u32_u16 v213, v212, 2, s85
    v_mad_u32_u16 v212, v212, 2, s85 op_sel:[1,0,0,0]
    v_mfma_f32_16x16x32_f16 v[184:187], a[248:251], v[132:135], 0
    s_waitcnt lgkmcnt(10)
    ds_read_u16 v213, v213
    ds_read_u16_d16_hi v212, v212
    v_pk_lshrrev_b16 v214, 3, v214 op_sel_hi:[0,1]
    v_mfma_f32_16x16x32_f16 v[180:183], a[252:255], v[128:131], 0
    v_mad_u32_u16 v215, v214, 2, s85
    v_mad_u32_u16 v214, v214, 2, s85 op_sel:[1,0,0,0]
    v_pk_lshrrev_b16 v216, 3, v216 op_sel_hi:[0,1]
    v_mfma_f32_16x16x32_f16 v[188:191], a[252:255], v[132:135], 0
    s_add_u32 m0, s56, 6144
    ds_read_u16 v215, v215
    ds_read_u16_d16_hi v214, v214
    buffer_load_dword v7, s[20:23], 0 offen offset:0 lds
    v_mfma_f32_16x16x32_f16 v[192:195], a[248:251], v[152:155], 0
    v_mad_u32_u16 v217, v216, 2, s85
    v_mad_u32_u16 v216, v216, 2, s85 op_sel:[1,0,0,0]
    v_pk_lshrrev_b16 v218, 3, v218 op_sel_hi:[0,1]
    v_mfma_f32_16x16x32_f16 v[200:203], a[248:251], v[156:159], 0
    s_waitcnt lgkmcnt(11)
    ds_read_u16 v217, v217
    ds_read_u16_d16_hi v216, v216
    ds_read_b128 a[248:251], v24 offset:30720
    v_mfma_f32_16x16x32_f16 v[176:179], a[232:235], v[136:139], v[176:179]
    v_mad_u32_u16 v219, v218, 2, s85
    v_mad_u32_u16 v218, v218, 2, s85 op_sel:[1,0,0,0]
    v_pk_lshrrev_b16 v220, 3, v220 op_sel_hi:[0,1]
    v_mfma_f32_16x16x32_f16 v[184:187], a[232:235], v[140:143], v[184:187]
    s_waitcnt lgkmcnt(12)
    ds_read_u16 v219, v219
    ds_read_u16_d16_hi v218, v218
    v_mad_u32_u16 v221, v220, 2, s85
    v_mfma_f32_16x16x32_f16 v[196:199], a[252:255], v[152:155], 0
    s_waitcnt lgkmcnt(13)
    ds_read_u16 v221, v221
    v_mad_u32_u16 v220, v220, 2, s85 op_sel:[1,0,0,0]
    v_or_b32 v240, v0, v253
    v_mfma_f32_16x16x32_f16 v[204:207], a[252:255], v[156:159], 0
    v_or_b32 v241, v209, v208
    v_mfma_f32_16x16x32_f16 v[180:183], a[236:239], v[136:139], v[180:183]
    s_waitcnt lgkmcnt(13)
    ds_read_u16_d16_hi v220, v220
    v_mfma_f32_16x16x32_f16 v[188:191], a[236:239], v[140:143], v[188:191]
    s_waitcnt lgkmcnt(11)
    ds_read_b128 a[252:255], v24 offset:31744
    v_or_b32 v242, v211, v210
    v_mfma_f32_16x16x32_f16 v[192:195], a[232:235], v[160:163], v[192:195]
    v_mfma_f32_16x16x32_f16 v[200:203], a[232:235], v[164:167], v[200:203]
    ds_read_b128 a[232:235], v24 offset:32768
    v_mfma_f32_16x16x32_f16 v[176:179], a[240:243], v[144:147], v[176:179]
    s_waitcnt lgkmcnt(11)
    v_or_b32 v243, v213, v212
    v_mfma_f32_16x16x32_f16 v[184:187], a[240:243], v[148:151], v[184:187]
    v_mfma_f32_16x16x32_f16 v[196:199], a[236:239], v[160:163], v[196:199]
    v_mfma_f32_16x16x32_f16 v[204:207], a[236:239], v[164:167], v[204:207]
    ds_read_b128 a[236:239], v24 offset:33792
    v_mfma_f32_16x16x32_f16 v[180:183], a[244:247], v[144:147], v[180:183]
    s_waitcnt lgkmcnt(10)
    v_or_b32 v244, v215, v214
    v_mfma_f32_16x16x32_f16 v[188:191], a[244:247], v[148:151], v[188:191]
    v_cvt_pkrtz_f16_f32 v222, v176, v177
    v_pk_lshrrev_b16 v222, 3, v222 op_sel_hi:[0,1]
    v_mad_u32_u16 v223, v222, 2, s85
    v_mfma_f32_16x16x32_f16 v[192:195], a[240:243], v[168:171], v[192:195]
    ds_read_u16 v223, v223
    v_mad_u32_u16 v222, v222, 2, s85 op_sel:[1,0,0,0]
    v_cvt_pkrtz_f16_f32 v224, v178, v179
    v_mfma_f32_16x16x32_f16 v[200:203], a[240:243], v[172:175], v[200:203]
    s_waitcnt lgkmcnt(9)
    ds_read_b128 a[240:243], v24 offset:34816
    ds_read_u16_d16_hi v222, v222
    v_or_b32 v245, v217, v216
    v_mfma_f32_16x16x32_f16 v[196:199], a[244:247], v[168:171], v[196:199]
    v_pk_lshrrev_b16 v224, 3, v224 op_sel_hi:[0,1]
    v_mad_u32_u16 v225, v224, 2, s85
    v_mad_u32_u16 v224, v224, 2, s85 op_sel:[1,0,0,0]
    v_mfma_f32_16x16x32_f16 v[204:207], a[244:247], v[172:175], v[204:207]
    s_waitcnt lgkmcnt(10)
    ds_read_b128 a[244:247], v24 offset:35840
    ds_read_u16 v225, v225
    ds_read_u16_d16_hi v224, v224
    v_mfma_f32_16x16x32_bf16 v[32:35], a[248:251], v[232:235], v[32:35]
    s_waitcnt lgkmcnt(11)
    v_cvt_pkrtz_f16_f32 v226, v180, v181
    v_or_b32 v246, v219, v218
    v_pk_lshrrev_b16 v226, 3, v226 op_sel_hi:[0,1]
    v_mfma_f32_16x16x32_bf16 v[40:43], a[248:251], v[236:239], v[40:43]
    v_mad_u32_u16 v227, v226, 2, s85
    v_mad_u32_u16 v226, v226, 2, s85 op_sel:[1,0,0,0]
    v_cvt_pkrtz_f16_f32 v228, v182, v183
    v_pk_lshrrev_b16 v228, 3, v228 op_sel_hi:[0,1]
    v_mad_u32_u16 v229, v228, 2, s85
    v_mad_u32_u16 v228, v228, 2, s85 op_sel:[1,0,0,0]
    v_cvt_pkrtz_f16_f32 v230, v184, v185
    v_pk_lshrrev_b16 v230, 3, v230 op_sel_hi:[0,1]
    v_mad_u32_u16 v231, v230, 2, s85
    s_waitcnt lgkmcnt(9)
    v_or_b32 v247, v221, v220
    v_mad_u32_u16 v230, v230, 2, s85 op_sel:[1,0,0,0]
    v_cvt_pkrtz_f16_f32 v248, v186, v187
    v_pk_lshrrev_b16 v248, 3, v248 op_sel_hi:[0,1]
    s_waitcnt lgkmcnt(8)
    v_mfma_f32_16x16x32_bf16 v[36:39], a[252:255], v[232:235], v[36:39]
    ds_read_u16 v227, v227
    ds_read_u16_d16_hi v226, v226
    ds_read_u16 v229, v229
    ds_read_u16_d16_hi v228, v228
    v_mfma_f32_16x16x32_bf16 v[44:47], a[252:255], v[236:239], v[44:47]
    ds_read_u16 v231, v231
    ds_read_u16_d16_hi v230, v230
    v_mad_u32_u16 v249, v248, 2, s85
    v_mfma_f32_16x16x32_bf16 v[80:83], a[248:251], v[240:243], v[80:83]
    v_mad_u32_u16 v248, v248, 2, s85 op_sel:[1,0,0,0]
    v_cvt_pkrtz_f16_f32 v250, v188, v189
    v_pk_lshrrev_b16 v250, 3, v250 op_sel_hi:[0,1]
    v_mfma_f32_16x16x32_bf16 v[88:91], a[248:251], v[244:247], v[88:91]
    s_waitcnt lgkmcnt(12)
    ds_read_u16 v249, v249
    ds_read_u16_d16_hi v248, v248
    v_mad_u32_u16 v251, v250, 2, s85
    v_mfma_f32_16x16x32_bf16 v[48:51], a[232:235], v[232:235], v[48:51]
    v_mad_u32_u16 v250, v250, 2, s85 op_sel:[1,0,0,0]
    v_cvt_pkrtz_f16_f32 v252, v190, v191
    v_pk_lshrrev_b16 v252, 3, v252 op_sel_hi:[0,1]
    v_mfma_f32_16x16x32_bf16 v[56:59], a[232:235], v[236:239], v[56:59]
    s_waitcnt lgkmcnt(13)
    ds_read_u16 v251, v251
    v_mad_u32_u16 v253, v252, 2, s85
    v_mad_u32_u16 v252, v252, 2, s85 op_sel:[1,0,0,0]
    v_mfma_f32_16x16x32_bf16 v[84:87], a[252:255], v[240:243], v[84:87]
    s_waitcnt lgkmcnt(13)
    ds_read_u16_d16_hi v250, v250
    v_cvt_pkrtz_f16_f32 v0, v192, v193
    v_pk_lshrrev_b16 v0, 3, v0 op_sel_hi:[0,1]
    v_mfma_f32_16x16x32_bf16 v[92:95], a[252:255], v[244:247], v[92:95]
    s_waitcnt lgkmcnt(13)
    ds_read_u16 v253, v253
    v_cvt_pkrtz_f16_f32 v209, v194, v195
    v_cvt_pkrtz_f16_f32 v211, v196, v197
    v_mfma_f32_16x16x32_bf16 v[52:55], a[236:239], v[232:235], v[52:55]
    s_waitcnt lgkmcnt(13)
    ds_read_u16_d16_hi v252, v252
    v_cvt_pkrtz_f16_f32 v213, v198, v199
    v_cvt_pkrtz_f16_f32 v215, v200, v201
    v_mfma_f32_16x16x32_bf16 v[60:63], a[236:239], v[236:239], v[60:63]
    v_cvt_pkrtz_f16_f32 v217, v202, v203
    v_cvt_pkrtz_f16_f32 v219, v204, v205
    v_cvt_pkrtz_f16_f32 v221, v206, v207
    v_mfma_f32_16x16x32_bf16 v[96:99], a[232:235], v[240:243], v[96:99]
    s_waitcnt lgkmcnt(13)
    ds_read_b128 a[248:251], v24 offset:43008
    v_mad_u32_u16 v208, v0, 2, s85
    v_mad_u32_u16 v0, v0, 2, s85 op_sel:[1,0,0,0]
    v_mfma_f32_16x16x32_bf16 v[104:107], a[232:235], v[244:247], v[104:107]
    s_waitcnt lgkmcnt(13)
    ds_read_b128 a[252:255], v24 offset:44032
    buffer_load_dword v254, v31, s[20:23], 0 offen
    v_pk_lshrrev_b16 v209, 3, v209 op_sel_hi:[0,1]
    v_mfma_f32_16x16x32_bf16 v[64:67], a[240:243], v[232:235], v[64:67]
    v_mad_u32_u16 v210, v209, 2, s85
    v_mad_u32_u16 v209, v209, 2, s85 op_sel:[1,0,0,0]
    v_pk_lshrrev_b16 v211, 3, v211 op_sel_hi:[0,1]
    v_mfma_f32_16x16x32_bf16 v[72:75], a[240:243], v[236:239], v[72:75]
    s_waitcnt lgkmcnt(13)
    ds_read_b128 a[232:235], v24 offset:45056
    v_mad_u32_u16 v212, v211, 2, s85
    v_mad_u32_u16 v211, v211, 2, s85 op_sel:[1,0,0,0]
    v_mfma_f32_16x16x32_bf16 v[100:103], a[236:239], v[240:243], v[100:103]
    s_waitcnt lgkmcnt(13)
    ds_read_u16 v208, v208
    v_pk_lshrrev_b16 v213, 3, v213 op_sel_hi:[0,1]
    v_mad_u32_u16 v214, v213, 2, s85
    v_mfma_f32_16x16x32_bf16 v[108:111], a[236:239], v[244:247], v[108:111]
    s_waitcnt lgkmcnt(13)
    ds_read_b128 a[236:239], v24 offset:46080
    v_mad_u32_u16 v213, v213, 2, s85 op_sel:[1,0,0,0]
    v_pk_lshrrev_b16 v215, 3, v215 op_sel_hi:[0,1]
    v_mfma_f32_16x16x32_bf16 v[68:71], a[244:247], v[232:235], v[68:71]
    v_or_b32 v232, v223, v222
    v_or_b32 v233, v225, v224
    v_or_b32 v234, v227, v226
    v_mfma_f32_16x16x32_bf16 v[76:79], a[244:247], v[236:239], v[76:79]
    s_waitcnt lgkmcnt(11)
    ds_read_u16_d16_hi v0, v0
    v_or_b32 v235, v229, v228
    v_or_b32 v236, v231, v230
    v_mfma_f32_16x16x32_bf16 v[112:115], a[240:243], v[240:243], v[112:115]
    ds_read_u16 v210, v210
    v_mad_u32_u16 v216, v215, 2, s85
    v_mad_u32_u16 v215, v215, 2, s85 op_sel:[1,0,0,0]
    v_mfma_f32_16x16x32_bf16 v[120:123], a[240:243], v[244:247], v[120:123]
    s_waitcnt lgkmcnt(11)
    ds_read_b128 a[240:243], v24 offset:47104
    v_or_b32 v237, v249, v248
    v_pk_lshrrev_b16 v217, 3, v217 op_sel_hi:[0,1]
    v_mfma_f32_16x16x32_bf16 v[116:119], a[244:247], v[240:243], v[116:119]
    v_mad_u32_u16 v218, v217, 2, s85
    v_mad_u32_u16 v217, v217, 2, s85 op_sel:[1,0,0,0]
    v_pk_lshrrev_b16 v219, 3, v219 op_sel_hi:[0,1]
    v_mfma_f32_16x16x32_bf16 v[124:127], a[244:247], v[244:247], v[124:127]
    ds_read_b128 a[244:247], v24 offset:48128
    v_mad_u32_u16 v220, v219, 2, s85
    v_mad_u32_u16 v219, v219, 2, s85 op_sel:[1,0,0,0]
    v_mfma_f32_16x16x32_f16 v[176:179], a[0:3], v[128:131], 0
    s_waitcnt lgkmcnt(11)
    ds_read_u16_d16_hi v209, v209
    v_or_b32 v238, v251, v250
    v_pk_lshrrev_b16 v221, 3, v221 op_sel_hi:[0,1]
    v_mad_u32_u16 v222, v221, 2, s85
    v_mad_u32_u16 v221, v221, 2, s85 op_sel:[1,0,0,0]
    ds_read_u16 v212, v212
    s_waitcnt lgkmcnt(11)
    v_or_b32 v239, v253, v252
    s_waitcnt lgkmcnt(10)
    v_mfma_f32_16x16x32_bf16 v[32:35], a[248:251], v[232:235], v[32:35]
    ds_read_u16_d16_hi v211, v211
    ds_read_u16 v214, v214
    ds_read_u16_d16_hi v213, v213
    v_mfma_f32_16x16x32_f16 v[180:183], a[4:7], v[128:131], 0
    s_waitcnt lgkmcnt(12)
    v_mfma_f32_16x16x32_bf16 v[36:39], a[252:255], v[232:235], v[36:39]
    ds_read_u16 v216, v216
    v_mfma_f32_16x16x32_f16 v[176:179], a[8:11], v[136:139], v[176:179]
    s_waitcnt lgkmcnt(12)
    ds_read_u16_d16_hi v215, v215
    v_mfma_f32_16x16x32_bf16 v[48:51], a[232:235], v[232:235], v[48:51]
    ds_read_u16 v218, v218
    v_mfma_f32_16x16x32_f16 v[180:183], a[12:15], v[136:139], v[180:183]
    s_waitcnt lgkmcnt(12)
    v_mfma_f32_16x16x32_bf16 v[52:55], a[236:239], v[232:235], v[52:55]
    s_waitcnt lgkmcnt(11)
    ds_read_u16_d16_hi v217, v217
    v_or_b32 v240, v208, v0
    v_mfma_f32_16x16x32_f16 v[176:179], a[16:19], v[144:147], v[176:179]
    ds_read_u16 v220, v220
    s_waitcnt lgkmcnt(11)
    v_mfma_f32_16x16x32_bf16 v[64:67], a[240:243], v[232:235], v[64:67]
    ds_read_u16_d16_hi v219, v219
    v_mfma_f32_16x16x32_f16 v[180:183], a[20:23], v[144:147], v[180:183]
    s_waitcnt lgkmcnt(11)
    ds_read_u16 v222, v222
    v_mfma_f32_16x16x32_bf16 v[68:71], a[244:247], v[232:235], v[68:71]
    s_waitcnt lgkmcnt(11)
    ds_read_u16_d16_hi v221, v221
    v_or_b32 v241, v210, v209
    v_mfma_f32_16x16x32_f16 v[184:187], a[0:3], v[132:135], 0
    v_cvt_pkrtz_f16_f32 v223, v176, v177
    v_pk_lshrrev_b16 v223, 3, v223 op_sel_hi:[0,1]
    v_mad_u32_u16 v224, v223, 2, s85
    v_mfma_f32_16x16x32_bf16 v[40:43], a[248:251], v[236:239], v[40:43]
    ds_read_u16 v224, v224
    v_mad_u32_u16 v223, v223, 2, s85 op_sel:[1,0,0,0]
    v_cvt_pkrtz_f16_f32 v225, v178, v179
    v_mfma_f32_16x16x32_f16 v[188:191], a[4:7], v[132:135], 0
    s_waitcnt lgkmcnt(11)
    ds_read_u16_d16_hi v223, v223
    v_or_b32 v242, v212, v211
    v_pk_lshrrev_b16 v225, 3, v225 op_sel_hi:[0,1]
    v_mfma_f32_16x16x32_bf16 v[44:47], a[252:255], v[236:239], v[44:47]
    v_mad_u32_u16 v226, v225, 2, s85
    v_mad_u32_u16 v225, v225, 2, s85 op_sel:[1,0,0,0]
    v_cvt_pkrtz_f16_f32 v227, v180, v181
    v_mfma_f32_16x16x32_f16 v[184:187], a[8:11], v[140:143], v[184:187]
    ds_read_u16 v226, v226
    v_pk_lshrrev_b16 v227, 3, v227 op_sel_hi:[0,1]
    v_mad_u32_u16 v228, v227, 2, s85
    v_mfma_f32_16x16x32_bf16 v[56:59], a[232:235], v[236:239], v[56:59]
    s_waitcnt lgkmcnt(11)
    ds_read_u16_d16_hi v225, v225
    v_or_b32 v243, v214, v213
    v_mad_u32_u16 v227, v227, 2, s85 op_sel:[1,0,0,0]
    v_mfma_f32_16x16x32_f16 v[188:191], a[12:15], v[140:143], v[188:191]
    ds_read_u16 v228, v228
    v_cvt_pkrtz_f16_f32 v229, v182, v183
    v_pk_lshrrev_b16 v229, 3, v229 op_sel_hi:[0,1]
    v_mfma_f32_16x16x32_bf16 v[60:63], a[236:239], v[236:239], v[60:63]
    s_waitcnt lgkmcnt(12)
    v_mad_u32_u16 v230, v229, 2, s85
    v_mad_u32_u16 v229, v229, 2, s85 op_sel:[1,0,0,0]
    s_waitcnt lgkmcnt(11)
    v_or_b32 v244, v216, v215
    v_mfma_f32_16x16x32_f16 v[184:187], a[16:19], v[148:151], v[184:187]
    ds_read_u16_d16_hi v227, v227
    v_mfma_f32_16x16x32_f16 v[188:191], a[20:23], v[148:151], v[188:191]
    ds_read_u16 v230, v230
    v_mfma_f32_16x16x32_bf16 v[72:75], a[240:243], v[236:239], v[72:75]
    v_mfma_f32_16x16x32_bf16 v[76:79], a[244:247], v[236:239], v[76:79]
    s_waitcnt lgkmcnt(11)
    ds_read_u16_d16_hi v229, v229
    v_or_b32 v245, v218, v217
    v_mfma_f32_16x16x32_f16 v[176:179], a[48:51], v[128:131], 0
    v_cvt_pkrtz_f16_f32 v231, v184, v185
    v_pk_lshrrev_b16 v231, 3, v231 op_sel_hi:[0,1]
    v_mad_u32_u16 v248, v231, 2, s85
    v_mfma_f32_16x16x32_bf16 v[80:83], a[248:251], v[240:243], v[80:83]
    ds_read_u16 v248, v248
    v_mad_u32_u16 v231, v231, 2, s85 op_sel:[1,0,0,0]
    v_cvt_pkrtz_f16_f32 v249, v186, v187
    v_mfma_f32_16x16x32_f16 v[180:183], a[52:55], v[128:131], 0
    s_waitcnt lgkmcnt(11)
    ds_read_u16_d16_hi v231, v231
    v_or_b32 v246, v220, v219
    v_pk_lshrrev_b16 v249, 3, v249 op_sel_hi:[0,1]
    v_mfma_f32_16x16x32_bf16 v[84:87], a[252:255], v[240:243], v[84:87]
    v_mad_u32_u16 v250, v249, 2, s85
    v_mad_u32_u16 v249, v249, 2, s85 op_sel:[1,0,0,0]
    v_cvt_pkrtz_f16_f32 v251, v188, v189
    v_mfma_f32_16x16x32_f16 v[176:179], a[56:59], v[136:139], v[176:179]
    s_waitcnt lgkmcnt(10)
    ds_read_u16 v250, v250
    ds_read_u16_d16_hi v249, v249
    v_or_b32 v247, v222, v221
    v_mfma_f32_16x16x32_bf16 v[96:99], a[232:235], v[240:243], v[96:99]
    v_pk_lshrrev_b16 v251, 3, v251 op_sel_hi:[0,1]
    v_mad_u32_u16 v252, v251, 2, s85
    v_mad_u32_u16 v251, v251, 2, s85 op_sel:[1,0,0,0]
    v_mfma_f32_16x16x32_f16 v[180:183], a[60:63], v[136:139], v[180:183]
    ds_read_u16 v252, v252
    v_cvt_pkrtz_f16_f32 v253, v190, v191
    v_pk_lshrrev_b16 v253, 3, v253 op_sel_hi:[0,1]
    v_mfma_f32_16x16x32_bf16 v[100:103], a[236:239], v[240:243], v[100:103]
    ds_read_u16_d16_hi v251, v251
    v_mad_u32_u16 v0, v253, 2, s85
    v_mad_u32_u16 v253, v253, 2, s85 op_sel:[1,0,0,0]
    v_mfma_f32_16x16x32_f16 v[176:179], a[64:67], v[144:147], v[176:179]
    s_waitcnt lgkmcnt(12)
    v_or_b32 v232, v224, v223
    v_mfma_f32_16x16x32_bf16 v[112:115], a[240:243], v[240:243], v[112:115]
    ds_read_u16 v0, v0
    v_mfma_f32_16x16x32_f16 v[180:183], a[68:71], v[144:147], v[180:183]
    s_waitcnt lgkmcnt(11)
    ds_read_u16_d16_hi v253, v253
    v_or_b32 v233, v226, v225
    v_mfma_f32_16x16x32_bf16 v[116:119], a[244:247], v[240:243], v[116:119]
    v_cvt_pkrtz_f16_f32 v208, v176, v177
    v_pk_lshrrev_b16 v208, 3, v208 op_sel_hi:[0,1]
    v_mad_u32_u16 v209, v208, 2, s85
    v_mfma_f32_16x16x32_f16 v[184:187], a[48:51], v[132:135], 0
    ds_read_u16 v209, v209
    v_mad_u32_u16 v208, v208, 2, s85 op_sel:[1,0,0,0]
    v_cvt_pkrtz_f16_f32 v210, v178, v179
    v_mfma_f32_16x16x32_bf16 v[88:91], a[248:251], v[244:247], v[88:91]
    s_waitcnt lgkmcnt(11)
    ds_read_u16_d16_hi v208, v208
    v_or_b32 v234, v228, v227
    v_pk_lshrrev_b16 v210, 3, v210 op_sel_hi:[0,1]
    v_mfma_f32_16x16x32_f16 v[188:191], a[52:55], v[132:135], 0
    v_mad_u32_u16 v211, v210, 2, s85
    v_mad_u32_u16 v210, v210, 2, s85 op_sel:[1,0,0,0]
    v_cvt_pkrtz_f16_f32 v212, v180, v181
    v_mfma_f32_16x16x32_bf16 v[92:95], a[252:255], v[244:247], v[92:95]
    ds_read_u16 v211, v211
    v_pk_lshrrev_b16 v212, 3, v212 op_sel_hi:[0,1]
    v_mad_u32_u16 v213, v212, 2, s85
    v_mfma_f32_16x16x32_f16 v[184:187], a[56:59], v[140:143], v[184:187]
    s_waitcnt lgkmcnt(11)
    ds_read_u16_d16_hi v210, v210
    v_or_b32 v235, v230, v229
    v_mad_u32_u16 v212, v212, 2, s85 op_sel:[1,0,0,0]
    v_mfma_f32_16x16x32_bf16 v[104:107], a[232:235], v[244:247], v[104:107]
    ds_read_u16 v213, v213
    v_cvt_pkrtz_f16_f32 v214, v182, v183
    v_pk_lshrrev_b16 v214, 3, v214 op_sel_hi:[0,1]
    v_mfma_f32_16x16x32_f16 v[188:191], a[60:63], v[140:143], v[188:191]
    s_waitcnt lgkmcnt(12)
    v_mad_u32_u16 v215, v214, 2, s85
    v_mad_u32_u16 v214, v214, 2, s85 op_sel:[1,0,0,0]
    s_waitcnt lgkmcnt(11)
    v_or_b32 v236, v248, v231
    v_mfma_f32_16x16x32_bf16 v[108:111], a[236:239], v[244:247], v[108:111]
    ds_read_u16_d16_hi v212, v212
    v_mfma_f32_16x16x32_f16 v[184:187], a[64:67], v[148:151], v[184:187]
    ds_read_u16 v215, v215
    v_mfma_f32_16x16x32_f16 v[188:191], a[68:71], v[148:151], v[188:191]
    v_mfma_f32_16x16x32_bf16 v[120:123], a[240:243], v[244:247], v[120:123]
    s_waitcnt lgkmcnt(11)
    ds_read_u16_d16_hi v214, v214
    v_or_b32 v237, v250, v249
    v_mfma_f32_16x16x32_bf16 v[124:127], a[244:247], v[244:247], v[124:127]
    s_nop 0
    v_cvt_pkrtz_f16_f32 v216, v184, v185
    v_pk_lshrrev_b16 v216, 3, v216 op_sel_hi:[0,1]
    v_mfma_f32_16x16x32_f16 v[176:179], a[96:99], v[128:131], 0
    v_mad_u32_u16 v217, v216, 2, s85
    v_mad_u32_u16 v216, v216, 2, s85 op_sel:[1,0,0,0]
    v_cvt_pkrtz_f16_f32 v218, v186, v187
    v_mfma_f32_16x16x32_bf16 v[32:35], a[24:27], v[232:235], v[32:35]
    s_waitcnt lgkmcnt(10)
    ds_read_u16 v217, v217
    ds_read_u16_d16_hi v216, v216
    v_or_b32 v238, v252, v251
    v_mfma_f32_16x16x32_f16 v[180:183], a[100:103], v[128:131], 0
    v_pk_lshrrev_b16 v218, 3, v218 op_sel_hi:[0,1]
    v_mad_u32_u16 v219, v218, 2, s85
    v_mad_u32_u16 v218, v218, 2, s85 op_sel:[1,0,0,0]
    v_mfma_f32_16x16x32_bf16 v[36:39], a[28:31], v[232:235], v[36:39]
    s_waitcnt lgkmcnt(10)
    ds_read_u16 v219, v219
    ds_read_u16_d16_hi v218, v218
    v_or_b32 v239, v0, v253
    v_mfma_f32_16x16x32_f16 v[176:179], a[104:107], v[136:139], v[176:179]
    v_cvt_pkrtz_f16_f32 v220, v188, v189
    v_pk_lshrrev_b16 v220, 3, v220 op_sel_hi:[0,1]
    v_mad_u32_u16 v221, v220, 2, s85
    v_mfma_f32_16x16x32_bf16 v[48:51], a[32:35], v[232:235], v[48:51]
    ds_read_u16 v221, v221
    v_mad_u32_u16 v220, v220, 2, s85 op_sel:[1,0,0,0]
    v_cvt_pkrtz_f16_f32 v222, v190, v191
    v_mfma_f32_16x16x32_f16 v[180:183], a[108:111], v[136:139], v[180:183]
    ds_read_u16_d16_hi v220, v220
    v_pk_lshrrev_b16 v222, 3, v222 op_sel_hi:[0,1]
    v_mad_u32_u16 v223, v222, 2, s85
    v_mfma_f32_16x16x32_bf16 v[52:55], a[36:39], v[232:235], v[52:55]
    v_mad_u32_u16 v222, v222, 2, s85 op_sel:[1,0,0,0]
    v_mfma_f32_16x16x32_f16 v[176:179], a[112:115], v[144:147], v[176:179]
    s_waitcnt lgkmcnt(13)
    ds_read_u16 v223, v223
    v_mfma_f32_16x16x32_bf16 v[64:67], a[40:43], v[232:235], v[64:67]
    s_waitcnt lgkmcnt(13)
    ds_read_u16_d16_hi v222, v222
    v_mfma_f32_16x16x32_f16 v[180:183], a[116:119], v[144:147], v[180:183]
    v_mfma_f32_16x16x32_bf16 v[68:71], a[44:47], v[232:235], v[68:71]
    s_waitcnt lgkmcnt(12)
    v_or_b32 v232, v209, v208
    v_or_b32 v233, v211, v210
    v_mfma_f32_16x16x32_f16 v[184:187], a[96:99], v[132:135], 0
    s_waitcnt lgkmcnt(11)
    v_cvt_pkrtz_f16_f32 v224, v176, v177
    v_pk_lshrrev_b16 v224, 3, v224 op_sel_hi:[0,1]
    s_waitcnt lgkmcnt(10)
    v_or_b32 v234, v213, v212
    v_mfma_f32_16x16x32_bf16 v[40:43], a[24:27], v[236:239], v[40:43]
    v_mad_u32_u16 v225, v224, 2, s85
    v_mad_u32_u16 v224, v224, 2, s85 op_sel:[1,0,0,0]
    v_cvt_pkrtz_f16_f32 v226, v178, v179
    v_mfma_f32_16x16x32_f16 v[188:191], a[100:103], v[132:135], 0
    ds_read_u16 v225, v225
    ds_read_u16_d16_hi v224, v224
    v_pk_lshrrev_b16 v226, 3, v226 op_sel_hi:[0,1]
    v_mfma_f32_16x16x32_bf16 v[44:47], a[28:31], v[236:239], v[44:47]
    s_waitcnt lgkmcnt(10)
    v_or_b32 v235, v215, v214
    v_mad_u32_u16 v227, v226, 2, s85
    v_mad_u32_u16 v226, v226, 2, s85 op_sel:[1,0,0,0]
    v_mfma_f32_16x16x32_f16 v[184:187], a[104:107], v[140:143], v[184:187]
    ds_read_u16 v227, v227
    ds_read_u16_d16_hi v226, v226
    v_cvt_pkrtz_f16_f32 v228, v180, v181
    v_mfma_f32_16x16x32_bf16 v[56:59], a[32:35], v[236:239], v[56:59]
    v_pk_lshrrev_b16 v228, 3, v228 op_sel_hi:[0,1]
    v_mad_u32_u16 v229, v228, 2, s85
    v_mad_u32_u16 v228, v228, 2, s85 op_sel:[1,0,0,0]
    v_mfma_f32_16x16x32_f16 v[188:191], a[108:111], v[140:143], v[188:191]
    ds_read_u16 v229, v229
    ds_read_u16_d16_hi v228, v228
    v_cvt_pkrtz_f16_f32 v230, v182, v183
    v_mfma_f32_16x16x32_bf16 v[60:63], a[36:39], v[236:239], v[60:63]
    v_pk_lshrrev_b16 v230, 3, v230 op_sel_hi:[0,1]
    v_mad_u32_u16 v231, v230, 2, s85
    v_mad_u32_u16 v230, v230, 2, s85 op_sel:[1,0,0,0]
    v_mfma_f32_16x16x32_f16 v[184:187], a[112:115], v[148:151], v[184:187]
    s_waitcnt lgkmcnt(13)
    ds_read_u16 v231, v231
    v_mfma_f32_16x16x32_f16 v[188:191], a[116:119], v[148:151], v[188:191]
    s_waitcnt lgkmcnt(13)
    ds_read_u16_d16_hi v230, v230
    v_mfma_f32_16x16x32_bf16 v[72:75], a[40:43], v[236:239], v[72:75]
    v_mfma_f32_16x16x32_bf16 v[76:79], a[44:47], v[236:239], v[76:79]
    s_waitcnt lgkmcnt(12)
    v_or_b32 v236, v217, v216
    v_or_b32 v237, v219, v218
    v_mfma_f32_16x16x32_f16 v[176:179], a[144:147], v[128:131], 0
    s_waitcnt lgkmcnt(10)
    v_or_b32 v238, v221, v220
    v_cvt_pkrtz_f16_f32 v248, v184, v185
    v_pk_lshrrev_b16 v248, 3, v248 op_sel_hi:[0,1]
    v_mfma_f32_16x16x32_bf16 v[32:35], a[72:75], v[232:235], v[32:35]
    v_mad_u32_u16 v249, v248, 2, s85
    v_mad_u32_u16 v248, v248, 2, s85 op_sel:[1,0,0,0]
    v_cvt_pkrtz_f16_f32 v250, v186, v187
    v_mfma_f32_16x16x32_f16 v[180:183], a[148:151], v[128:131], 0
    ds_read_u16 v249, v249
    ds_read_u16_d16_hi v248, v248
    v_pk_lshrrev_b16 v250, 3, v250 op_sel_hi:[0,1]
    v_mfma_f32_16x16x32_bf16 v[36:39], a[76:79], v[232:235], v[36:39]
    s_waitcnt lgkmcnt(10)
    v_or_b32 v239, v223, v222
    v_mad_u32_u16 v251, v250, 2, s85
    v_mad_u32_u16 v250, v250, 2, s85 op_sel:[1,0,0,0]
    v_mfma_f32_16x16x32_f16 v[176:179], a[152:155], v[136:139], v[176:179]
    ds_read_u16 v251, v251
    ds_read_u16_d16_hi v250, v250
    v_cvt_pkrtz_f16_f32 v252, v188, v189
    v_mfma_f32_16x16x32_bf16 v[48:51], a[80:83], v[232:235], v[48:51]
    v_pk_lshrrev_b16 v252, 3, v252 op_sel_hi:[0,1]
    v_mad_u32_u16 v253, v252, 2, s85
    v_mad_u32_u16 v252, v252, 2, s85 op_sel:[1,0,0,0]
    v_mfma_f32_16x16x32_f16 v[180:183], a[156:159], v[136:139], v[180:183]
    ds_read_u16 v253, v253
    ds_read_u16_d16_hi v252, v252
    v_cvt_pkrtz_f16_f32 v209, v190, v191
    v_mfma_f32_16x16x32_bf16 v[52:55], a[84:87], v[232:235], v[52:55]
    v_pk_fma_f16 v0, v209, v209, s53
    v_pk_mul_f16 v0, v0, v209 neg_lo:[1,0] neg_hi:[1,0]
    v_exp_f16 v208, v0
    v_mfma_f32_16x16x32_f16 v[176:179], a[160:163], v[144:147], v[176:179]
    v_exp_f16_sdwa v208, v0 dst_sel:WORD_1 dst_unused:UNUSED_PRESERVE src0_sel:WORD_1
    v_mfma_f32_16x16x32_bf16 v[64:67], a[88:91], v[232:235], v[64:67]
    v_pk_fma_f16 v208, v208, s86, s86
    v_rcp_f16 v0, v208
    v_mfma_f32_16x16x32_f16 v[180:183], a[164:167], v[144:147], v[180:183]
    v_rcp_f16_sdwa v0, v208 dst_sel:WORD_1 dst_unused:UNUSED_PRESERVE src0_sel:WORD_1
    v_mfma_f32_16x16x32_bf16 v[68:71], a[92:95], v[232:235], v[68:71]
    s_waitcnt lgkmcnt(12)
    v_fma_mix_f32 v208, v0, v209, 0 op_sel_hi:[1,1,0]
    v_fma_mix_f32 v0, v0, v209, 0 op_sel:[1,1,0] op_sel_hi:[1,1,0]
    v_or_b32 v232, v225, v224
    v_mfma_f32_16x16x32_f16 v[184:187], a[144:147], v[132:135], 0
    s_waitcnt lgkmcnt(8)
    v_or_b32 v233, v227, v226
    v_or_b32 v234, v229, v228
    v_cvt_pkrtz_f16_f32 v210, v176, v177
    v_mfma_f32_16x16x32_bf16 v[40:43], a[72:75], v[236:239], v[40:43]
    v_pk_lshrrev_b16 v210, 3, v210 op_sel_hi:[0,1]
    v_mad_u32_u16 v211, v210, 2, s85
    v_mad_u32_u16 v210, v210, 2, s85 op_sel:[1,0,0,0]
    v_mfma_f32_16x16x32_f16 v[188:191], a[148:151], v[132:135], 0
    s_waitcnt lgkmcnt(6)
    ds_read_u16 v211, v211
    ds_read_u16_d16_hi v210, v210
    v_or_b32 v235, v231, v230
    v_mfma_f32_16x16x32_bf16 v[44:47], a[76:79], v[236:239], v[44:47]
    s_waitcnt vmcnt(1)
    ds_read_b128 a[232:235], v8 offset:0
    v_cvt_pkrtz_f16_f32 v212, v178, v179
    v_pk_lshrrev_b16 v212, 3, v212 op_sel_hi:[0,1]
    v_mfma_f32_16x16x32_f16 v[184:187], a[152:155], v[140:143], v[184:187]
    v_mad_u32_u16 v213, v212, 2, s85
    v_mad_u32_u16 v212, v212, 2, s85 op_sel:[1,0,0,0]
    v_cvt_pkrtz_f16_f32 v214, v180, v181
    v_mfma_f32_16x16x32_bf16 v[56:59], a[80:83], v[236:239], v[56:59]
    ds_read_u16 v213, v213
    ds_read_u16_d16_hi v212, v212
    v_pk_lshrrev_b16 v214, 3, v214 op_sel_hi:[0,1]
    v_mfma_f32_16x16x32_f16 v[188:191], a[156:159], v[140:143], v[188:191]
    v_mad_u32_u16 v215, v214, 2, s85
    v_mad_u32_u16 v214, v214, 2, s85 op_sel:[1,0,0,0]
    v_cvt_pkrtz_f16_f32 v216, v182, v183
    v_mfma_f32_16x16x32_bf16 v[60:63], a[84:87], v[236:239], v[60:63]
    ds_read_u16 v215, v215
    ds_read_u16_d16_hi v214, v214
    v_pk_lshrrev_b16 v216, 3, v216 op_sel_hi:[0,1]
    v_mfma_f32_16x16x32_f16 v[184:187], a[160:163], v[148:151], v[184:187]
    v_mad_u32_u16 v217, v216, 2, s85
    v_mad_u32_u16 v216, v216, 2, s85 op_sel:[1,0,0,0]
    v_mfma_f32_16x16x32_f16 v[188:191], a[164:167], v[148:151], v[188:191]
    s_waitcnt lgkmcnt(12)
    ds_read_u16 v217, v217
    ds_read_u16_d16_hi v216, v216
    v_mfma_f32_16x16x32_bf16 v[72:75], a[88:91], v[236:239], v[72:75]
    s_nop 0
    v_cvt_pkrtz_f16_f32 v218, v184, v185
    v_pk_lshrrev_b16 v218, 3, v218 op_sel_hi:[0,1]
    v_mfma_f32_16x16x32_bf16 v[76:79], a[92:95], v[236:239], v[76:79]
    s_waitcnt lgkmcnt(9)
    v_or_b32 v236, v249, v248
    v_or_b32 v237, v251, v250
    v_or_b32 v238, v253, v252
    v_mfma_f32_16x16x32_f16 v[192:195], a[0:3], v[152:155], 0
    v_cvt_pk_bf16_f32 v239, v208, v0
    v_mad_u32_u16 v219, v218, 2, s85
    v_mad_u32_u16 v218, v218, 2, s85 op_sel:[1,0,0,0]
    v_mfma_f32_16x16x32_bf16 v[32:35], a[120:123], v[232:235], v[32:35]
    ds_read_u16 v219, v219
    ds_read_u16_d16_hi v218, v218
    v_cvt_pkrtz_f16_f32 v220, v186, v187
    v_mfma_f32_16x16x32_f16 v[196:199], a[4:7], v[152:155], 0
    ds_read_b128 a[248:251], v12 offset:2560
    v_pk_lshrrev_b16 v220, 3, v220 op_sel_hi:[0,1]
    v_mad_u32_u16 v221, v220, 2, s85
    v_mfma_f32_16x16x32_bf16 v[36:39], a[124:127], v[232:235], v[36:39]
    ds_read_u16 v221, v221
    v_mad_u32_u16 v220, v220, 2, s85 op_sel:[1,0,0,0]
    v_cvt_pkrtz_f16_f32 v222, v188, v189
    v_mfma_f32_16x16x32_f16 v[192:195], a[8:11], v[160:163], v[192:195]
    ds_read_u16_d16_hi v220, v220
    v_pk_lshrrev_b16 v222, 3, v222 op_sel_hi:[0,1]
    v_mad_u32_u16 v223, v222, 2, s85
    v_mfma_f32_16x16x32_bf16 v[48:51], a[128:131], v[232:235], v[48:51]
    s_waitcnt lgkmcnt(12)
    ds_read_u16 v223, v223
    ds_read_b128 a[240:243], v15 offset:1280
    v_mad_u32_u16 v222, v222, 2, s85 op_sel:[1,0,0,0]
    v_mfma_f32_16x16x32_f16 v[196:199], a[12:15], v[160:163], v[196:199]
    s_waitcnt lgkmcnt(13)
    ds_read_u16_d16_hi v222, v222
    v_cvt_pkrtz_f16_f32 v224, v190, v191
    v_pk_lshrrev_b16 v224, 3, v224 op_sel_hi:[0,1]
    v_mfma_f32_16x16x32_bf16 v[52:55], a[132:135], v[232:235], v[52:55]
    v_mad_u32_u16 v225, v224, 2, s85
    v_mad_u32_u16 v224, v224, 2, s85 op_sel:[1,0,0,0]
    v_mfma_f32_16x16x32_f16 v[192:195], a[16:19], v[168:171], v[192:195]
    s_waitcnt lgkmcnt(12)
    ds_read_u16 v225, v225
    ds_read_u16_d16_hi v224, v224
    v_mfma_f32_16x16x32_bf16 v[64:67], a[136:139], v[232:235], v[64:67]
    v_mfma_f32_16x16x32_f16 v[196:199], a[20:23], v[168:171], v[196:199]
    v_mfma_f32_16x16x32_bf16 v[68:71], a[140:143], v[232:235], v[68:71]
    s_waitcnt lgkmcnt(13)
    ds_read_b128 a[244:247], v8 offset:2560
    v_or_b32 v232, v211, v210
    v_or_b32 v233, v213, v212
    v_mfma_f32_16x16x32_f16 v[200:203], a[0:3], v[156:159], 0
    s_waitcnt lgkmcnt(11)
    v_or_b32 v234, v215, v214
    v_or_b32 v235, v217, v216
    v_cvt_pkrtz_f16_f32 v226, v192, v193
    v_mfma_f32_16x16x32_bf16 v[40:43], a[120:123], v[236:239], v[40:43]
    ds_read_b128 a[252:255], v15 offset:3840
    v_pk_lshrrev_b16 v226, 3, v226 op_sel_hi:[0,1]
    v_cvt_pkrtz_f16_f32 v228, v194, v195
    v_mfma_f32_16x16x32_f16 v[204:207], a[4:7], v[156:159], 0
    v_cvt_pkrtz_f16_f32 v230, v196, v197
    v_cvt_pkrtz_f16_f32 v248, v198, v199
    v_mad_u32_u16 v227, v226, 2, s85
    v_mfma_f32_16x16x32_bf16 v[44:47], a[124:127], v[236:239], v[44:47]
    ds_read_u16 v227, v227
    v_mad_u32_u16 v226, v226, 2, s85 op_sel:[1,0,0,0]
    v_pk_lshrrev_b16 v228, 3, v228 op_sel_hi:[0,1]
    v_mfma_f32_16x16x32_f16 v[200:203], a[8:11], v[164:167], v[200:203]
    ds_read_u16_d16_hi v226, v226
    v_mad_u32_u16 v229, v228, 2, s85
    v_mad_u32_u16 v228, v228, 2, s85 op_sel:[1,0,0,0]
    v_mfma_f32_16x16x32_bf16 v[56:59], a[128:131], v[236:239], v[56:59]
    s_waitcnt lgkmcnt(12)
    ds_read_u16 v229, v229
    ds_read_u16_d16_hi v228, v228
    v_pk_lshrrev_b16 v230, 3, v230 op_sel_hi:[0,1]
    v_mfma_f32_16x16x32_f16 v[204:207], a[12:15], v[164:167], v[204:207]
    s_waitcnt lgkmcnt(13)
    ds_read_b128 v[136:139], v11 offset:0
    v_mad_u32_u16 v231, v230, 2, s85
    v_mad_u32_u16 v230, v230, 2, s85 op_sel:[1,0,0,0]
    v_mfma_f32_16x16x32_bf16 v[60:63], a[132:135], v[236:239], v[60:63]
    s_waitcnt lgkmcnt(12)
    ds_read_u16 v231, v231
    ds_read_u16_d16_hi v230, v230
    v_pk_lshrrev_b16 v248, 3, v248 op_sel_hi:[0,1]
    v_mfma_f32_16x16x32_f16 v[200:203], a[16:19], v[172:175], v[200:203]
    v_mad_u32_u16 v249, v248, 2, s85
    v_mad_u32_u16 v248, v248, 2, s85 op_sel:[1,0,0,0]
    v_mfma_f32_16x16x32_f16 v[204:207], a[20:23], v[172:175], v[204:207]
    s_waitcnt lgkmcnt(13)
    ds_read_u16 v249, v249
    v_mfma_f32_16x16x32_bf16 v[72:75], a[136:139], v[236:239], v[72:75]
    s_waitcnt lgkmcnt(13)
    ds_read_u16_d16_hi v248, v248
    v_mfma_f32_16x16x32_bf16 v[76:79], a[140:143], v[236:239], v[76:79]
    s_waitcnt lgkmcnt(13)
    v_or_b32 v236, v219, v218
    v_or_b32 v237, v221, v220
    v_or_b32 v238, v223, v222
    v_mfma_f32_16x16x32_f16 v[192:195], a[48:51], v[152:155], 0
    s_waitcnt lgkmcnt(11)
    ds_read_b128 a[236:239], v12 offset:0
    v_or_b32 v239, v225, v224
    v_cvt_pkrtz_f16_f32 v250, v200, v201
    v_mfma_f32_16x16x32_bf16 v[32:35], a[168:171], v[232:235], v[32:35]
    v_cvt_pkrtz_f16_f32 v252, v202, v203
    v_cvt_pkrtz_f16_f32 v0, v204, v205
    v_cvt_pkrtz_f16_f32 v209, v206, v207
    v_mfma_f32_16x16x32_f16 v[196:199], a[52:55], v[152:155], 0
    v_pk_lshrrev_b16 v250, 3, v250 op_sel_hi:[0,1]
    v_mad_u32_u16 v251, v250, 2, s85
    v_mad_u32_u16 v250, v250, 2, s85 op_sel:[1,0,0,0]
    v_mfma_f32_16x16x32_bf16 v[36:39], a[172:175], v[232:235], v[36:39]
    s_waitcnt lgkmcnt(11)
    ds_read_u16 v251, v251
    ds_read_u16_d16_hi v250, v250
    ds_read_b128 v[140:143], v15 offset:0
    v_mfma_f32_16x16x32_f16 v[192:195], a[56:59], v[160:163], v[192:195]
    v_pk_lshrrev_b16 v252, 3, v252 op_sel_hi:[0,1]
    v_mad_u32_u16 v253, v252, 2, s85
    v_mad_u32_u16 v252, v252, 2, s85 op_sel:[1,0,0,0]
    v_mfma_f32_16x16x32_bf16 v[48:51], a[176:179], v[232:235], v[48:51]
    s_waitcnt lgkmcnt(12)
    ds_read_u16 v253, v253
    ds_read_u16_d16_hi v252, v252
    v_pk_lshrrev_b16 v0, 3, v0 op_sel_hi:[0,1]
    v_mfma_f32_16x16x32_f16 v[196:199], a[60:63], v[160:163], v[196:199]
    v_mad_u32_u16 v208, v0, 2, s85
    v_mad_u32_u16 v0, v0, 2, s85 op_sel:[1,0,0,0]
    v_pk_lshrrev_b16 v209, 3, v209 op_sel_hi:[0,1]
    v_mfma_f32_16x16x32_bf16 v[52:55], a[180:183], v[232:235], v[52:55]
    s_waitcnt lgkmcnt(13)
    ds_read_u16 v208, v208
    v_mad_u32_u16 v210, v209, 2, s85
    v_mad_u32_u16 v209, v209, 2, s85 op_sel:[1,0,0,0]
    v_mfma_f32_16x16x32_f16 v[192:195], a[64:67], v[168:171], v[192:195]
    s_waitcnt lgkmcnt(12)
    ds_read_u16_d16_hi v0, v0
    v_or_b32 v240, v227, v226
    v_or_b32 v241, v229, v228
    v_mfma_f32_16x16x32_bf16 v[64:67], a[184:187], v[232:235], v[64:67]
    ds_read_u16 v210, v210
    v_cvt_pk_bf16_f32 v32, v32, v33
    v_cvt_pk_bf16_f32 v33, v34, v35
    v_mfma_f32_16x16x32_f16 v[196:199], a[68:71], v[168:171], v[196:199]
    s_waitcnt lgkmcnt(11)
    ds_read_u16_d16_hi v209, v209
    v_or_b32 v242, v231, v230
    v_cvt_pkrtz_f16_f32 v211, v192, v193
    v_mfma_f32_16x16x32_bf16 v[68:71], a[188:191], v[232:235], v[68:71]
    v_pk_lshrrev_b16 v211, 3, v211 op_sel_hi:[0,1]
    v_cvt_pkrtz_f16_f32 v213, v194, v195
    v_mad_u32_u16 v212, v211, 2, s85
    v_mfma_f32_16x16x32_f16 v[200:203], a[48:51], v[156:159], 0
    ds_read_b128 v[148:151], v11 offset:2560
    v_cvt_pkrtz_f16_f32 v215, v196, v197
    v_cvt_pkrtz_f16_f32 v217, v198, v199
    v_mfma_f32_16x16x32_bf16 v[40:43], a[168:171], v[236:239], v[40:43]
    s_waitcnt lgkmcnt(11)
    ds_read_u16 v212, v212
    v_or_b32 v243, v249, v248
    v_mad_u32_u16 v211, v211, 2, s85 op_sel:[1,0,0,0]
    v_mfma_f32_16x16x32_f16 v[204:207], a[52:55], v[156:159], 0
    ds_read_b128 v[144:147], v12 offset:1280
    v_pk_lshrrev_b16 v213, 3, v213 op_sel_hi:[0,1]
    v_mad_u32_u16 v214, v213, 2, s85
    v_mfma_f32_16x16x32_bf16 v[44:47], a[172:175], v[236:239], v[44:47]
    ds_read_u16_d16_hi v211, v211
    v_mad_u32_u16 v213, v213, 2, s85 op_sel:[1,0,0,0]
    v_pk_lshrrev_b16 v215, 3, v215 op_sel_hi:[0,1]
    v_mfma_f32_16x16x32_f16 v[200:203], a[56:59], v[164:167], v[200:203]
    s_waitcnt lgkmcnt(11)
    v_mad_u32_u16 v216, v215, 2, s85
    v_or_b32 v244, v251, v250
    v_mad_u32_u16 v215, v215, 2, s85 op_sel:[1,0,0,0]
    v_mfma_f32_16x16x32_bf16 v[56:59], a[176:179], v[236:239], v[56:59]
    ds_read_b128 v[180:183], v13 offset:0
    ds_read_u16 v214, v214
    v_pk_lshrrev_b16 v217, 3, v217 op_sel_hi:[0,1]
    v_mfma_f32_16x16x32_f16 v[204:207], a[60:63], v[164:167], v[204:207]
    v_mad_u32_u16 v218, v217, 2, s85
    v_mad_u32_u16 v217, v217, 2, s85 op_sel:[1,0,0,0]
    v_cvt_pk_bf16_f32 v34, v36, v37
    v_mfma_f32_16x16x32_bf16 v[60:63], a[180:183], v[236:239], v[60:63]
    ds_read_u16_d16_hi v213, v213
    v_cvt_pk_bf16_f32 v35, v38, v39
    v_cvt_pk_bf16_f32 v40, v40, v41
    v_mfma_f32_16x16x32_f16 v[200:203], a[64:67], v[172:175], v[200:203]
    s_waitcnt lgkmcnt(11)
    ds_read_b128 v[188:191], v9 offset:2560
    v_or_b32 v245, v253, v252
    v_cvt_pk_bf16_f32 v41, v42, v43
    v_mfma_f32_16x16x32_f16 v[204:207], a[68:71], v[172:175], v[204:207]
    v_cvt_pk_bf16_f32 v42, v44, v45
    v_cvt_pk_bf16_f32 v43, v46, v47
    v_cvt_pk_bf16_f32 v48, v48, v49
    v_mfma_f32_16x16x32_bf16 v[72:75], a[184:187], v[236:239], v[72:75]
    s_waitcnt lgkmcnt(11)
    ds_read_u16 v216, v216
    v_cvt_pkrtz_f16_f32 v219, v200, v201
    s_waitcnt lgkmcnt(11)
    v_or_b32 v246, v208, v0
    v_mfma_f32_16x16x32_bf16 v[76:79], a[188:191], v[236:239], v[76:79]
    ds_read_u16_d16_hi v215, v215
    v_cvt_pkrtz_f16_f32 v221, v202, v203
    v_cvt_pkrtz_f16_f32 v223, v204, v205
    v_mfma_f32_16x16x32_f16 v[192:195], a[96:99], v[152:155], 0
    ds_read_u16 v218, v218
    v_cvt_pkrtz_f16_f32 v225, v206, v207
    v_pk_lshrrev_b16 v219, 3, v219 op_sel_hi:[0,1]
    v_mfma_f32_16x16x32_bf16 v[80:83], a[24:27], v[240:243], v[80:83]
    s_waitcnt lgkmcnt(11)
    v_mad_u32_u16 v220, v219, 2, s85
    v_or_b32 v247, v210, v209
    v_mad_u32_u16 v219, v219, 2, s85 op_sel:[1,0,0,0]
    v_mfma_f32_16x16x32_f16 v[196:199], a[100:103], v[152:155], 0
    ds_read_u16_d16_hi v217, v217
    ds_read_u16 v220, v220
    buffer_store_dwordx4 v[40:43], v26, s[24:27], s81 offen offset:0 sc0 sc1
    v_mfma_f32_16x16x32_bf16 v[84:87], a[28:31], v[240:243], v[84:87]
    ds_read_u16_d16_hi v219, v219
    v_pk_lshrrev_b16 v221, 3, v221 op_sel_hi:[0,1]
    v_mad_u32_u16 v222, v221, 2, s85
    v_mfma_f32_16x16x32_f16 v[192:195], a[104:107], v[160:163], v[192:195]
    s_waitcnt lgkmcnt(13)
    ds_read_u16 v222, v222
    buffer_store_dwordx4 v[32:35], v26, s[24:27], s80 offen offset:0 sc0 sc1
    v_mfma_f32_16x16x32_bf16 v[96:99], a[32:35], v[240:243], v[96:99]
    v_mad_u32_u16 v221, v221, 2, s85 op_sel:[1,0,0,0]
    v_pk_lshrrev_b16 v223, 3, v223 op_sel_hi:[0,1]
    v_mad_u32_u16 v224, v223, 2, s85
    v_mfma_f32_16x16x32_f16 v[196:199], a[108:111], v[160:163], v[196:199]
    s_waitcnt lgkmcnt(12)
    ds_read_u16_d16_hi v221, v221
    ds_read_u16 v224, v224
    v_mad_u32_u16 v223, v223, 2, s85 op_sel:[1,0,0,0]
    v_mfma_f32_16x16x32_bf16 v[100:103], a[36:39], v[240:243], v[100:103]
    s_waitcnt lgkmcnt(13)
    ds_read_u16_d16_hi v223, v223
    v_pk_lshrrev_b16 v225, 3, v225 op_sel_hi:[0,1]
    v_mad_u32_u16 v226, v225, 2, s85
    v_mfma_f32_16x16x32_f16 v[192:195], a[112:115], v[168:171], v[192:195]
    s_waitcnt lgkmcnt(13)
    ds_read_u16 v226, v226
    v_mad_u32_u16 v225, v225, 2, s85 op_sel:[1,0,0,0]
    v_cvt_pk_bf16_f32 v49, v50, v51
    v_mfma_f32_16x16x32_bf16 v[112:115], a[40:43], v[240:243], v[112:115]
    s_waitcnt lgkmcnt(13)
    ds_read_u16_d16_hi v225, v225
    v_cvt_pk_bf16_f32 v50, v52, v53
    v_cvt_pk_bf16_f32 v51, v54, v55
    v_mfma_f32_16x16x32_f16 v[196:199], a[116:119], v[168:171], v[196:199]
    v_cvt_pk_bf16_f32 v56, v56, v57
    v_cvt_pk_bf16_f32 v57, v58, v59
    v_cvt_pk_bf16_f32 v58, v60, v61
    v_mfma_f32_16x16x32_bf16 v[116:119], a[44:47], v[240:243], v[116:119]
    s_waitcnt lgkmcnt(13)
    ds_read_b128 v[232:235], v13 offset:2560
    v_cvt_pk_bf16_f32 v59, v62, v63
    v_cvt_pk_bf16_f32 v64, v64, v65
    v_mfma_f32_16x16x32_f16 v[200:203], a[96:99], v[156:159], 0
    s_waitcnt lgkmcnt(12)
    buffer_store_dwordx4 v[56:59], v26, s[24:27], s81 offen offset:64 sc0 sc1
    ds_read_b128 v[32:35], v10 offset:0
    buffer_store_dwordx4 v[48:51], v26, s[24:27], s80 offen offset:64 sc0 sc1
    ds_read_b128 v[176:179], v9 offset:0
    v_mfma_f32_16x16x32_bf16 v[88:91], a[24:27], v[244:247], v[88:91]
    v_cvt_pk_bf16_f32 v65, v66, v67
    v_cvt_pk_bf16_f32 v66, v68, v69
    v_cvt_pk_bf16_f32 v67, v70, v71
    v_mfma_f32_16x16x32_f16 v[204:207], a[100:103], v[156:159], 0
    v_cvt_pk_bf16_f32 v72, v72, v73
    v_cvt_pk_bf16_f32 v73, v74, v75
    v_cvt_pk_bf16_f32 v74, v76, v77
    v_mfma_f32_16x16x32_bf16 v[92:95], a[28:31], v[244:247], v[92:95]
    v_cvt_pk_bf16_f32 v75, v78, v79
    v_or_b32 v240, v212, v211
    v_or_b32 v241, v214, v213
    v_mfma_f32_16x16x32_f16 v[200:203], a[104:107], v[164:167], v[200:203]
    s_waitcnt lgkmcnt(11)
    ds_read_b128 v[184:187], v14 offset:1280
    v_or_b32 v242, v216, v215
    v_or_b32 v243, v218, v217
    v_mfma_f32_16x16x32_bf16 v[104:107], a[32:35], v[244:247], v[104:107]
    ds_read_b128 v[44:47], v10 offset:2560
    v_cvt_pkrtz_f16_f32 v227, v192, v193
    v_pk_lshrrev_b16 v227, 3, v227 op_sel_hi:[0,1]
    v_mfma_f32_16x16x32_f16 v[204:207], a[108:111], v[164:167], v[204:207]
    ds_read_b128 v[36:39], v14 offset:0
    v_cvt_pkrtz_f16_f32 v229, v194, v195
    v_cvt_pkrtz_f16_f32 v231, v196, v197
    v_mfma_f32_16x16x32_bf16 v[108:111], a[36:39], v[244:247], v[108:111]
    v_cvt_pkrtz_f16_f32 v249, v198, v199
    v_mad_u32_u16 v228, v227, 2, s85
    v_mad_u32_u16 v227, v227, 2, s85 op_sel:[1,0,0,0]
    v_mfma_f32_16x16x32_f16 v[200:203], a[112:115], v[172:175], v[200:203]
    s_waitcnt lgkmcnt(12)
    ds_read_u16 v228, v228
    ds_read_u16_d16_hi v227, v227
    v_pk_lshrrev_b16 v229, 3, v229 op_sel_hi:[0,1]
    v_mfma_f32_16x16x32_f16 v[204:207], a[116:119], v[172:175], v[204:207]
    buffer_store_dwordx4 v[72:75], v26, s[24:27], s81 offen offset:128 sc0 sc1
    v_mfma_f32_16x16x32_bf16 v[120:123], a[40:43], v[244:247], v[120:123]
    v_mad_u32_u16 v230, v229, 2, s85
    v_mad_u32_u16 v229, v229, 2, s85 op_sel:[1,0,0,0]
    v_cvt_pkrtz_f16_f32 v251, v200, v201
    v_mfma_f32_16x16x32_bf16 v[124:127], a[44:47], v[244:247], v[124:127]
    s_waitcnt lgkmcnt(12)
    ds_read_u16 v230, v230
    ds_read_u16_d16_hi v229, v229
    v_or_b32 v244, v220, v219
    v_mfma_f32_16x16x32_f16 v[192:195], a[144:147], v[152:155], 0
    s_waitcnt lgkmcnt(12)
    ds_read_b128 v[56:59], v20 offset:2560
    v_or_b32 v245, v222, v221
    v_or_b32 v246, v224, v223
    v_mfma_f32_16x16x32_bf16 v[80:83], a[72:75], v[240:243], v[80:83]
    s_waitcnt lgkmcnt(11)
    v_or_b32 v247, v226, v225
    v_cvt_pkrtz_f16_f32 v253, v202, v203
    v_cvt_pkrtz_f16_f32 v208, v204, v205
    v_mfma_f32_16x16x32_f16 v[196:199], a[148:151], v[152:155], 0
    ds_read_b128 v[60:63], v21 offset:2560
    v_cvt_pkrtz_f16_f32 v210, v206, v207
    v_pk_lshrrev_b16 v231, 3, v231 op_sel_hi:[0,1]
    v_mfma_f32_16x16x32_bf16 v[84:87], a[76:79], v[240:243], v[84:87]
    buffer_store_dwordx4 v[64:67], v26, s[24:27], s80 offen offset:128 sc0 sc1
    v_mfma_f32_16x16x32_f16 v[192:195], a[152:155], v[160:163], v[192:195]
    ds_read_b128 v[52:55], v21 offset:0
    v_mad_u32_u16 v248, v231, 2, s85
    v_mad_u32_u16 v231, v231, 2, s85 op_sel:[1,0,0,0]
    v_mfma_f32_16x16x32_bf16 v[96:99], a[80:83], v[240:243], v[96:99]
    s_waitcnt lgkmcnt(12)
    ds_read_u16 v248, v248
    ds_read_u16_d16_hi v231, v231
    v_pk_lshrrev_b16 v249, 3, v249 op_sel_hi:[0,1]
    v_mfma_f32_16x16x32_f16 v[196:199], a[156:159], v[160:163], v[196:199]
    s_waitcnt lgkmcnt(11)
    ds_read_b128 v[236:239], v14 offset:3840
    ds_read_b128 v[48:51], v20 offset:0
    ds_read_b128 v[40:43], v13 offset:1280
    v_mfma_f32_16x16x32_bf16 v[100:103], a[84:87], v[240:243], v[100:103]
    v_mad_u32_u16 v250, v249, 2, s85
    v_mad_u32_u16 v249, v249, 2, s85 op_sel:[1,0,0,0]
    v_pk_lshrrev_b16 v251, 3, v251 op_sel_hi:[0,1]
    v_mfma_f32_16x16x32_f16 v[192:195], a[160:163], v[168:171], v[192:195]
    s_waitcnt lgkmcnt(12)
    ds_read_u16 v250, v250
    ds_read_u16_d16_hi v249, v249
    v_mad_u32_u16 v252, v251, 2, s85
    v_mfma_f32_16x16x32_bf16 v[112:115], a[88:91], v[240:243], v[112:115]
    s_waitcnt lgkmcnt(13)
    ds_read_u16 v252, v252
    v_mad_u32_u16 v251, v251, 2, s85 op_sel:[1,0,0,0]
    v_pk_lshrrev_b16 v253, 3, v253 op_sel_hi:[0,1]
    v_mfma_f32_16x16x32_f16 v[196:199], a[164:167], v[168:171], v[196:199]
    s_waitcnt lgkmcnt(12)
    ds_read_u16_d16_hi v251, v251
    ds_read_b128 v[64:67], v14 offset:2560
    v_mad_u32_u16 v0, v253, 2, s85
    v_mfma_f32_16x16x32_bf16 v[116:119], a[92:95], v[240:243], v[116:119]
    s_waitcnt lgkmcnt(13)
    ds_read_u16 v0, v0
    v_mad_u32_u16 v253, v253, 2, s85 op_sel:[1,0,0,0]
    v_pk_lshrrev_b16 v208, 3, v208 op_sel_hi:[0,1]
    v_mfma_f32_16x16x32_f16 v[200:203], a[144:147], v[156:159], 0
    s_waitcnt lgkmcnt(13)
    ds_read_u16_d16_hi v253, v253
    v_mad_u32_u16 v209, v208, 2, s85
    v_mad_u32_u16 v208, v208, 2, s85 op_sel:[1,0,0,0]
    v_mfma_f32_16x16x32_bf16 v[88:91], a[72:75], v[244:247], v[88:91]
    v_pk_lshrrev_b16 v210, 3, v210 op_sel_hi:[0,1]
    v_mad_u32_u16 v211, v210, 2, s85
    v_mad_u32_u16 v210, v210, 2, s85 op_sel:[1,0,0,0]
    v_mfma_f32_16x16x32_f16 v[204:207], a[148:151], v[156:159], 0
    s_waitcnt lgkmcnt(13)
    ds_read_u16 v209, v209
    v_or_b32 v240, v228, v227
    v_or_b32 v241, v230, v229
    v_mfma_f32_16x16x32_bf16 v[92:95], a[76:79], v[244:247], v[92:95]
    s_waitcnt lgkmcnt(11)
    ds_read_u16_d16_hi v208, v208
    ds_read_u16 v211, v211
    v_or_b32 v242, v248, v231
    v_mfma_f32_16x16x32_f16 v[200:203], a[152:155], v[164:167], v[200:203]
    ds_read_u16_d16_hi v210, v210
    v_cvt_pkrtz_f16_f32 v212, v192, v193
    v_pk_lshrrev_b16 v212, 3, v212 op_sel_hi:[0,1]
    v_mfma_f32_16x16x32_bf16 v[104:107], a[80:83], v[244:247], v[104:107]
    s_waitcnt lgkmcnt(13)
    ds_read_b128 v[68:71], v13 offset:3840
    v_cvt_pkrtz_f16_f32 v214, v194, v195
    v_cvt_pkrtz_f16_f32 v216, v196, v197
    v_mfma_f32_16x16x32_f16 v[204:207], a[156:159], v[164:167], v[204:207]
    v_cvt_pkrtz_f16_f32 v218, v198, v199
    v_mad_u32_u16 v213, v212, 2, s85
    v_mad_u32_u16 v212, v212, 2, s85 op_sel:[1,0,0,0]
    v_mfma_f32_16x16x32_bf16 v[108:111], a[84:87], v[244:247], v[108:111]
    s_waitcnt lgkmcnt(13)
    ds_read_b128 v[72:75], v15 offset:2560
    v_pk_lshrrev_b16 v214, 3, v214 op_sel_hi:[0,1]
    v_mad_u32_u16 v215, v214, 2, s85
    v_mfma_f32_16x16x32_f16 v[200:203], a[160:163], v[172:175], v[200:203]
    s_waitcnt lgkmcnt(11)
    ds_read_b128 v[76:79], v12 offset:3840
    v_or_b32 v243, v250, v249
    v_mad_u32_u16 v214, v214, 2, s85 op_sel:[1,0,0,0]
    v_mfma_f32_16x16x32_f16 v[204:207], a[164:167], v[172:175], v[204:207]
    ds_read_u16 v213, v213
    v_pk_lshrrev_b16 v216, 3, v216 op_sel_hi:[0,1]
    v_mad_u32_u16 v217, v216, 2, s85
    v_mfma_f32_16x16x32_bf16 v[120:123], a[88:91], v[244:247], v[120:123]
    v_cvt_pkrtz_f16_f32 v220, v200, v201
    v_cvt_pkrtz_f16_f32 v222, v202, v203
    v_mad_u32_u16 v216, v216, 2, s85 op_sel:[1,0,0,0]
    v_mfma_f32_16x16x32_bf16 v[124:127], a[92:95], v[244:247], v[124:127]
    s_waitcnt lgkmcnt(11)
    ds_read_u16_d16_hi v212, v212
    ds_read_u16 v215, v215
    v_or_b32 v244, v252, v251
    v_mfma_f32_16x16x32_bf16 v[80:83], a[120:123], v[240:243], v[80:83]
    v_cvt_pkrtz_f16_f32 v224, v204, v205
    v_cvt_pkrtz_f16_f32 v226, v206, v207
    v_pk_lshrrev_b16 v218, 3, v218 op_sel_hi:[0,1]
    v_mfma_f32_16x16x32_bf16 v[84:87], a[124:127], v[240:243], v[84:87]
    s_add_u32 m0, s56, -128
    ds_read_u16_d16_hi v214, v214
    v_mad_u32_u16 v219, v218, 2, s85
    v_mad_u32_u16 v218, v218, 2, s85 op_sel:[1,0,0,0]
    v_mfma_f32_16x16x32_bf16 v[96:99], a[128:131], v[240:243], v[96:99]
    s_waitcnt lgkmcnt(11)
    ds_read_u16 v217, v217
    v_or_b32 v245, v0, v253
    v_pk_lshrrev_b16 v220, 3, v220 op_sel_hi:[0,1]
    v_mfma_f32_16x16x32_bf16 v[100:103], a[132:135], v[240:243], v[100:103]
    v_mad_u32_u16 v221, v220, 2, s85
    v_mad_u32_u16 v220, v220, 2, s85 op_sel:[1,0,0,0]
    v_pk_lshrrev_b16 v222, 3, v222 op_sel_hi:[0,1]
    v_mfma_f32_16x16x32_bf16 v[112:115], a[136:139], v[240:243], v[112:115]
    s_waitcnt lgkmcnt(11)
    ds_read_u16_d16_hi v216, v216
    v_mad_u32_u16 v223, v222, 2, s85
    s_waitcnt lgkmcnt(11)
    v_or_b32 v246, v209, v208
    v_mfma_f32_16x16x32_bf16 v[116:119], a[140:143], v[240:243], v[116:119]
    ds_read_u16 v219, v219
    v_mad_u32_u16 v222, v222, 2, s85 op_sel:[1,0,0,0]
    v_pk_lshrrev_b16 v224, 3, v224 op_sel_hi:[0,1]
    v_mad_u32_u16 v225, v224, 2, s85
    v_mad_u32_u16 v224, v224, 2, s85 op_sel:[1,0,0,0]
    v_pk_lshrrev_b16 v226, 3, v226 op_sel_hi:[0,1]
    v_mad_u32_u16 v227, v226, 2, s85
    v_mad_u32_u16 v226, v226, 2, s85 op_sel:[1,0,0,0]
    ds_read_u16_d16_hi v218, v218
    s_waitcnt lgkmcnt(11)
    v_or_b32 v247, v211, v210
    s_nop 1
    v_mfma_f32_16x16x32_bf16 v[88:91], a[120:123], v[244:247], v[88:91]
    ds_read_u16 v221, v221
    ds_read_u16_d16_hi v220, v220
    v_mfma_f32_16x16x32_bf16 v[92:95], a[124:127], v[244:247], v[92:95]
    ds_read_u16 v223, v223
    v_mfma_f32_16x16x32_bf16 v[104:107], a[128:131], v[244:247], v[104:107]
    s_waitcnt lgkmcnt(11)
    ds_read_u16_d16_hi v222, v222
    buffer_load_dwordx4 v1, s[20:23], 0 offen offset:128 lds
    s_add_u32 m0, s56, 896
    v_mfma_f32_16x16x32_bf16 v[108:111], a[132:135], v[244:247], v[108:111]
    s_waitcnt lgkmcnt(11)
    ds_read_u16 v225, v225
    buffer_load_dwordx4 v2, s[20:23], 0 offen offset:128 lds
    s_add_u32 m0, s56, 1920
    ds_read_u16_d16_hi v224, v224
    buffer_load_dwordx4 v3, s[20:23], 0 offen offset:128 lds
    v_mfma_f32_16x16x32_bf16 v[120:123], a[136:139], v[244:247], v[120:123]
    s_add_u32 m0, s56, 2944
    s_waitcnt lgkmcnt(12)
    v_or_b32 v240, v213, v212
    v_mfma_f32_16x16x32_bf16 v[124:127], a[140:143], v[244:247], v[124:127]
    s_waitcnt lgkmcnt(9)
    ds_read_u16 v227, v227
    buffer_load_dwordx4 v4, s[20:23], 0 offen offset:128 lds
    ds_read_u16_d16_hi v226, v226
    v_or_b32 v241, v215, v214
    s_add_u32 m0, s56, 3968
    s_nop 0
    buffer_load_dwordx4 v5, s[20:23], 0 offen offset:128 lds
    ds_read_b128 v[192:195], v22 offset:0
    s_add_u32 m0, s56, 4992
    s_nop 0
    buffer_load_dwordx4 v6, s[20:23], 0 offen offset:128 lds
    s_waitcnt lgkmcnt(11)
    v_or_b32 v242, v217, v216
    s_add_u32 m0, s56, 6016
    ds_read_b128 v[196:199], v22 offset:256
    buffer_load_dword v7, s[20:23], 0 offen offset:128 lds
    ds_read_b128 v[204:207], v22 offset:272
    s_waitcnt lgkmcnt(11)
    v_or_b32 v243, v219, v218
    s_nop 1
    v_mfma_f32_16x16x32_bf16 v[80:83], a[168:171], v[240:243], v[80:83]
    v_mfma_f32_16x16x32_bf16 v[84:87], a[172:175], v[240:243], v[84:87]
    v_mfma_f32_16x16x32_bf16 v[96:99], a[176:179], v[240:243], v[96:99]
    s_waitcnt lgkmcnt(9)
    ds_read_b128 v[200:203], v22 offset:16
    v_or_b32 v244, v221, v220
    v_mfma_f32_16x16x32_bf16 v[100:103], a[180:183], v[240:243], v[100:103]
    v_mfma_f32_16x16x32_bf16 v[112:115], a[184:187], v[240:243], v[112:115]
    s_waitcnt lgkmcnt(9)
    v_mfma_f32_16x16x32_bf16 v[116:119], a[188:191], v[240:243], v[116:119]
    s_add_u32 s52, s52, 1
    s_cmp_eq_u32 s52, 4
    s_waitcnt lgkmcnt(8)
    v_or_b32 v245, v223, v222
    s_waitcnt lgkmcnt(6)
    v_or_b32 v246, v225, v224
    s_waitcnt lgkmcnt(4)
    v_or_b32 v247, v227, v226
    s_cbranch_scc0 L_conv
L_final:
    s_nop 0
    v_mfma_f32_16x16x32_bf16 v[88:91], a[168:171], v[244:247], v[88:91]
    v_cvt_pk_bf16_f32 v80, v80, v81
    v_cvt_pk_bf16_f32 v81, v82, v83
    v_cvt_pk_bf16_f32 v82, v84, v85
    v_mfma_f32_16x16x32_bf16 v[92:95], a[172:175], v[244:247], v[92:95]
    v_cvt_pk_bf16_f32 v83, v86, v87
    v_cvt_pk_bf16_f32 v96, v96, v97
    v_cvt_pk_bf16_f32 v97, v98, v99
    v_mfma_f32_16x16x32_bf16 v[104:107], a[176:179], v[244:247], v[104:107]
    buffer_store_dwordx4 v[80:83], v26, s[24:27], s82 offen offset:0 sc0 sc1
    v_mfma_f32_16x16x32_bf16 v[108:111], a[180:183], v[244:247], v[108:111]
    v_cvt_pk_bf16_f32 v98, v100, v101
    v_cvt_pk_bf16_f32 v99, v102, v103
    v_cvt_pk_bf16_f32 v112, v112, v113
    v_mfma_f32_16x16x32_bf16 v[120:123], a[184:187], v[244:247], v[120:123]
    buffer_store_dwordx4 v[96:99], v26, s[24:27], s82 offen offset:64 sc0 sc1
    v_mfma_f32_16x16x32_bf16 v[124:127], a[188:191], v[244:247], v[124:127]
    v_cvt_pk_bf16_f32 v113, v114, v115
    v_cvt_pk_bf16_f32 v114, v116, v117
    v_cvt_pk_bf16_f32 v115, v118, v119
    v_cvt_pk_bf16_f32 v88, v88, v89
    v_cvt_pk_bf16_f32 v89, v90, v91
    v_cvt_pk_bf16_f32 v90, v92, v93
    v_cvt_pk_bf16_f32 v91, v94, v95
    v_cvt_pk_bf16_f32 v104, v104, v105
    v_cvt_pk_bf16_f32 v105, v106, v107
    v_cvt_pk_bf16_f32 v106, v108, v109
    v_cvt_pk_bf16_f32 v107, v110, v111
    v_cvt_pk_bf16_f32 v120, v120, v121
    v_cvt_pk_bf16_f32 v121, v122, v123
    v_cvt_pk_bf16_f32 v122, v124, v125
    v_cvt_pk_bf16_f32 v123, v126, v127
    buffer_store_dwordx4 v[112:115], v26, s[24:27], s82 offen offset:128 sc0 sc1
    buffer_store_dwordx4 v[88:91], v26, s[24:27], s83 offen offset:0 sc0 sc1
    buffer_store_dwordx4 v[104:107], v26, s[24:27], s83 offen offset:64 sc0 sc1
    buffer_store_dwordx4 v[120:123], v26, s[24:27], s83 offen offset:128 sc0 sc1
L_end:
L_last:
    s_endpgm
.section .rodata,"a"
.p2align 6
.amdhsa_kernel standalone__modern_conv_block_convnext__vision_kernel
  .amdhsa_next_free_vgpr 512
  .amdhsa_next_free_sgpr 102
  .amdhsa_accum_offset 256
  .amdhsa_group_segment_fixed_size 0
  .amdhsa_kernarg_size 80
  .amdhsa_user_sgpr_count 2
  .amdhsa_user_sgpr_kernarg_segment_ptr 1
  .amdhsa_system_sgpr_workgroup_id_x 1
.end_amdhsa_kernel
```

```asm
; @launch grid=(256,1,1) block=(256,1,1) lds=163840
.amdgcn_target "amdgcn-amd-amdhsa--gfx950"
.text
.globl standalone__modern_conv_block_convnext__vision_kernel
.p2align 8
.type standalone__modern_conv_block_convnext__vision_kernel,@function
standalone__modern_conv_block_convnext__vision_kernel:
    s_cmp_ge_u32 s2, 256
    s_cbranch_scc1 L_end
    s_load_dwordx16 s[4:19], s[0:1], 0
    v_readfirstlane_b32 s3, v0
    v_and_b32 v129, 63, v0
    s_and_b32 s60, s2, 7
    s_lshr_b32 s61, s2, 7
    s_lshl1_add_u32 s60, s60, s61
    s_lshr_b32 s3, s3, 6
    s_getpc_b64 s[62:63]
L_pc:
    v_min_u32 v18, 2, v129
    s_lshr_b32 s71, s2, 3
    s_lshl2_add_u32 s71, s71, s3
    v_mad_u32_u24 v18, s71, 3, v18
    v_min_u32 v18, (L_last-L_pc)/128, v18
    v_lshlrev_b32 v18, 1, v18
    v_mad_u64_u32 v[18:19], vcc, v18, 64, s[62:63]
    global_load_dword v251, v[18:19], off
    s_bfe_u32 s61, s2, 0x40003
    s_lshl2_add_u32 s55, s61, s3
    s_mul_i32 s60, s60, 3145728
    s_mul_i32 s61, s55, 1536
    s_add_u32 s63, s60, s61
    s_sub_u32 s64, s63, 98496
    s_movk_i32 s65, 0
    s_movk_i32 s66, 2048
    s_cmp_eq_u32 s55, 0
    s_cmovk_i32 s65, 100
    s_cmovk_i32 s66, 1948
    s_cmp_eq_u32 s55, 63
    s_cmovk_i32 s66, 1800
    s_mul_i32 s56, s3, 12800
    s_add_u32 s56, s56, 90112
    s_mov_b32 s68, 96384
    v_lshrrev_b32 v131, 2, v129
    v_mul_u32_u24 v130, 205, v131
    v_mul_u32_u24 v131, 192, v131
    v_add_u32 v131, s64, v131
    v_lshlrev_b32 v132, 4, v0
    v_and_b32 v133, 16, v0
    v_bitop3_b32 v132, v132, v133, 48 bitop3:0x28
    v_bfrev_b32 v136, 1
    s_waitcnt lgkmcnt(0)
    s_mov_b32 s20, s4
    s_mov_b32 s21, s5
    s_mov_b32 s22, 50331648
    s_mov_b32 s23, 0x20000
    s_mulk_i32 s71, 640
    v_lshlrev_b32 v141, 7, v129
    v_cmp_gt_u32 vcc, 5, v129
    s_nop 1
    v_cndmask_b32 v141, v136, v141, vcc
    s_mov_b32 s44, s8
    s_mov_b32 s45, s9
    s_mov_b32 s46, 73728
    s_mov_b32 s47, 0x20000
    s_mov_b32 s48, s12
    s_mov_b32 s49, s13
    s_mov_b32 s50, 73728
    s_mov_b32 s51, 0x20000
    buffer_load_dword v142, v141, s[44:47], s71 offen
    buffer_load_dword v143, v141, s[48:51], s71 offen
    v_lshrrev_b32 v138, 5, v129
    s_movk_i32 s69, 192
    v_mul_u32_u24 v139, 1366, v0
    v_lshrrev_b32 v139, 16, v139
    v_mul_u32_u24 v139, 384, v139
    v_lshl_add_u32 v139, v0, 2, v139
    v_lshlrev_b32 v140, 3, v0
    s_mov_b32 s28, s6
    s_mov_b32 s29, s7
    s_mov_b32 s30, 1728
    s_mov_b32 s31, 0x20000
    s_mov_b32 s36, s14
    s_mov_b32 s37, s15
    s_mov_b32 s38, 192
    s_mov_b32 s39, 0x20000
    s_mov_b32 s40, s16
    s_mov_b32 s41, s17
    s_mov_b32 s42, 192
    s_mov_b32 s43, 0x20000
    s_mov_b32 s32, s10
    s_mov_b32 s33, s11
    s_mov_b32 s34, 768
    s_mov_b32 s35, 0x20000
    buffer_load_dword v144, v139, s[28:31], 0 offen
    buffer_load_dword v145, v139, s[28:31], 0 offen offset:192
    buffer_load_dword v146, v139, s[28:31], 0 offen offset:384
    buffer_load_dwordx2 v[148:149], v140, s[36:39], 0 offen
    buffer_load_dwordx2 v[150:151], v140, s[40:43], 0 offen
    s_cmp_ge_u32 s3, 2
    s_cbranch_scc1 L_prep1
L_prep0:
    v_bfe_u32 v158, v129, 2, 1
    v_bfe_u32 v159, v129, 3, 2
    v_lshl_add_u32 v159, v158, 2, v159
    v_and_b32 v160, 3, v129
    v_lshl_add_u32 v236, v138, 2, v160
    s_lshl_b32 s60, s3, 7
    v_lshl_add_u32 v236, v236, 4, s60
    v_mul_u32_u24 v159, 768, v159
    v_add_u32 v232, v159, v236
    v_add_u32 v233, 6144, v232
    v_and_b32 v159, 0x1c, v129
    v_cmp_eq_u32 vcc, 0x1c, v159
    s_mov_b32 s72, 72960
    s_mul_i32 s60, s3, 24576
    s_add_u32 s60, s60, 40960
    v_cndmask_b32 v237, v136, v236, vcc
    v_lshl_add_u32 v234, v129, 4, s60
    s_lshl_b32 s60, s3, 12
    s_add_u32 s60, s60, 40960
    v_mov_b32 v238, s60
    buffer_load_dwordx4 v[176:179], v236, s[44:47], s72 offen offset:0
    buffer_load_dwordx4 a[232:235], v237, s[32:35], 0 offen offset:0
    buffer_load_dwordx4 v[180:183], v236, s[44:47], s72 offen offset:256
    buffer_load_dwordx4 a[236:239], v237, s[32:35], 0 offen offset:256
    buffer_load_dwordx4 v[184:187], v236, s[44:47], s72 offen offset:512
    buffer_load_dwordx4 a[240:243], v237, s[32:35], 0 offen offset:512
    s_mov_b32 m0, s56
    s_movk_i32 s70, 5
L_xl0:
    v_lshrrev_b32 v134, 11, v130
    v_subrev_u32 v135, s65, v130
    v_mad_u32_u24 v134, v134, s68, v131
    v_and_b32 v135, 0x7ff, v135
    v_cmp_gt_u32 vcc, s66, v135
    v_lshrrev_b32 v135, 7, v130
    v_and_b32 v135, 32, v135
    v_xad_u32 v134, v132, v135, v134
    v_cndmask_b32 v134, v136, v134, vcc
    v_add_u32 v130, 3280, v130
    v_add_u32 v131, 3072, v131
    buffer_load_dwordx4 v134, s[20:23], 0 offen lds
    s_add_u32 m0, m0, 1024
    s_sub_u32 s70, s70, 1
    s_cbranch_scc0 L_xl0
    s_branch L_prb0
L_prep1:
    v_bfe_u32 v158, v129, 2, 1
    v_bfe_u32 v159, v129, 3, 2
    v_lshl_add_u32 v159, v158, 2, v159
    v_and_b32 v160, 3, v129
    v_lshl_add_u32 v159, v138, 4, v159
    s_lshl_b32 s60, s3, 6
    s_sub_u32 s60, s60, 128
    v_add_u32 v159, s60, v159
    v_xor_b32 v236, v138, v160
    v_lshlrev_b32 v236, 4, v236
    v_mad_u32_u24 v232, v159, s69, v236
    s_lshl_b32 s60, s3, 1
    s_sub_u32 s60, s60, 4
    v_add_u32 v159, s60, v158
    v_lshlrev_b32 v238, 11, v159
    v_add_u32 v238, 43008, v238
    v_mul_u32_u24 v159, 768, v159
    v_lshl_add_u32 v159, v158, 2, v159
    v_add_u32 v159, v160, v159
    v_bfe_u32 v160, v129, 3, 1
    v_lshl_add_u32 v159, v160, 6, v159
    v_lshrrev_b32 v160, 4, v129
    v_lshl_add_u32 v159, v160, 4, v159
    v_lshlrev_b32 v159, 4, v159
    v_add_u32 v234, 40960, v159
    v_xor_b32 v235, 64, v234
    buffer_load_dwordx4 v[208:211], v236, s[40:43], 0 offen offset:0
    buffer_load_dwordx4 v[212:215], v236, s[40:43], 0 offen offset:64
    buffer_load_dwordx4 v[216:219], v236, s[40:43], 0 offen offset:128
    s_mov_b32 m0, s56
    s_movk_i32 s70, 5
L_xl1:
    v_lshrrev_b32 v134, 11, v130
    v_subrev_u32 v135, s65, v130
    v_mad_u32_u24 v134, v134, s68, v131
    v_and_b32 v135, 0x7ff, v135
    v_cmp_gt_u32 vcc, s66, v135
    v_lshrrev_b32 v135, 7, v130
    v_and_b32 v135, 32, v135
    v_xad_u32 v134, v132, v135, v134
    v_cndmask_b32 v134, v136, v134, vcc
    v_add_u32 v130, 3280, v130
    v_add_u32 v131, 3072, v131
    buffer_load_dwordx4 v134, s[20:23], 0 offen lds
    s_add_u32 m0, m0, 1024
    s_sub_u32 s70, s70, 1
    s_cbranch_scc0 L_xl1
L_prb1:
    v_lshrrev_b32 v131, 4, v129
    v_add_u32 v131, 96, v131
    v_mul_u32_u24 v130, 205, v131
    v_mul_u32_u24 v131, 192, v131
    v_add_u32 v131, s64, v131
    v_lshlrev_b32 v133, 2, v129
    v_and_b32 v133, 63, v133
    v_lshrrev_b32 v134, 11, v130
    v_subrev_u32 v135, s65, v130
    v_mad_u32_u24 v134, v134, s68, v131
    v_and_b32 v135, 0x7ff, v135
    v_cmp_gt_u32 vcc, s66, v135
    v_lshrrev_b32 v135, 7, v130
    v_and_b32 v135, 32, v135
    v_xad_u32 v134, v133, v135, v134
    v_cndmask_b32 v7, v136, v134, vcc
    s_add_u32 m0, s56, 6144
    s_nop 0
    buffer_load_dword v7, s[20:23], 0 offen offset:0 lds
    v_lshrrev_b32 v131, 2, v129
    v_mul_u32_u24 v130, 205, v131
    v_mul_u32_u24 v131, 192, v131
    v_add_u32 v131, s64, v131
    v_lshrrev_b32 v134, 11, v130
    v_subrev_u32 v135, s65, v130
    v_mad_u32_u24 v134, v134, s68, v131
    v_and_b32 v135, 0x7ff, v135
    v_cmp_gt_u32 vcc, s66, v135
    v_lshrrev_b32 v135, 7, v130
    v_and_b32 v135, 32, v135
    v_xad_u32 v134, v132, v135, v134
    v_cndmask_b32 v1, v136, v134, vcc
    v_add_u32 v130, 3280, v130
    v_add_u32 v131, 3072, v131
    v_lshrrev_b32 v134, 11, v130
    v_subrev_u32 v135, s65, v130
    v_mad_u32_u24 v134, v134, s68, v131
    v_and_b32 v135, 0x7ff, v135
    v_cmp_gt_u32 vcc, s66, v135
    v_lshrrev_b32 v135, 7, v130
    v_and_b32 v135, 32, v135
    v_xad_u32 v134, v132, v135, v134
    v_cndmask_b32 v2, v136, v134, vcc
    v_add_u32 v130, 3280, v130
    v_add_u32 v131, 3072, v131
    v_lshrrev_b32 v134, 11, v130
    v_subrev_u32 v135, s65, v130
    v_mad_u32_u24 v134, v134, s68, v131
    v_and_b32 v135, 0x7ff, v135
    v_cmp_gt_u32 vcc, s66, v135
    v_lshrrev_b32 v135, 7, v130
    v_and_b32 v135, 32, v135
    v_xad_u32 v134, v132, v135, v134
    v_cndmask_b32 v3, v136, v134, vcc
    v_add_u32 v130, 3280, v130
    v_add_u32 v131, 3072, v131
    v_lshrrev_b32 v134, 11, v130
    v_subrev_u32 v135, s65, v130
    v_mad_u32_u24 v134, v134, s68, v131
    v_and_b32 v135, 0x7ff, v135
    v_cmp_gt_u32 vcc, s66, v135
    v_lshrrev_b32 v135, 7, v130
    v_and_b32 v135, 32, v135
    v_xad_u32 v134, v132, v135, v134
    v_cndmask_b32 v4, v136, v134, vcc
    v_add_u32 v130, 3280, v130
    v_add_u32 v131, 3072, v131
    v_lshrrev_b32 v134, 11, v130
    v_subrev_u32 v135, s65, v130
    v_mad_u32_u24 v134, v134, s68, v131
    v_and_b32 v135, 0x7ff, v135
    v_cmp_gt_u32 vcc, s66, v135
    v_lshrrev_b32 v135, 7, v130
    v_and_b32 v135, 32, v135
    v_xad_u32 v134, v132, v135, v134
    v_cndmask_b32 v5, v136, v134, vcc
    v_add_u32 v130, 3280, v130
    v_add_u32 v131, 3072, v131
    v_lshrrev_b32 v134, 11, v130
    v_subrev_u32 v135, s65, v130
    v_mad_u32_u24 v134, v134, s68, v131
    v_and_b32 v135, 0x7ff, v135
    v_cmp_gt_u32 vcc, s66, v135
    v_lshrrev_b32 v135, 7, v130
    v_and_b32 v135, 32, v135
    v_xad_u32 v134, v132, v135, v134
    v_cndmask_b32 v6, v136, v134, vcc
    s_cmp_lt_u32 s55, 63
    s_cselect_b32 s66, 10, 0
    s_add_u32 s64, s64, 1856
    v_mul_u32_u24 v134, 98304, v129
    v_add_u32 v134, s64, v134
    v_cmp_gt_u32 vcc, s66, v129
    s_nop 1
    v_cndmask_b32 v31, v136, v134, vcc
    v_mov_b32 v157, 268435456
    v_and_b32 v152, 15, v129
    v_lshrrev_b32 v153, 4, v129
    v_add_u32 v154, 4, v152
    v_lshrrev_b32 v154, 3, v154
    v_mad_i32_i24 v155, v154, -4, v152
    v_and_b32 v154, 1, v154
    v_and_b32 v156, 1, v153
    v_lshlrev_b32 v158, 1, v154
    v_mul_u32_u24 v159, 98304, v158
    v_mad_u32_u24 v159, v155, s69, v159
    v_lshl_add_u32 v159, v153, 4, v159
    v_add_u32 v26, s63, v159
    v_xor_b32 v26, 0x80000000, v26
    s_mov_b32 s54, 2147483648
    v_xor_b32 v161, v154, v138
    v_add_u32 v159, v153, v158
    v_add_u32 v160, 0, v155
    v_mad_u32_u24 v159, v159, 10, v160
    v_bfe_u32 v160, v159, 2, 1
    v_lshl_or_b32 v160, v161, 1, v160
    v_lshl_add_u32 v160, v159, 2, v160
    v_lshl_add_u32 v8, v160, 4, s56
    v_add_u32 v162, 1, v156
    v_add_u32 v159, v138, v158
    v_add_u32 v160, v162, v155
    v_mad_u32_u24 v159, v159, 10, v160
    v_bfe_u32 v160, v159, 2, 1
    v_lshl_or_b32 v160, v154, 1, v160
    v_lshl_add_u32 v160, v159, 2, v160
    v_lshl_add_u32 v12, v160, 4, s56
    v_xor_b32 v9, 16, v8
    v_xor_b32 v10, 32, v8
    v_xor_b32 v11, 48, v8
    v_xor_b32 v13, 16, v12
    v_xor_b32 v14, 32, v12
    v_xor_b32 v15, 48, v12
    v_add_u32 v159, 1, v158
    v_add_u32 v160, 1, v155
    v_mad_u32_u24 v159, v159, 10, v160
    v_bfe_u32 v160, v159, 2, 1
    v_lshl_or_b32 v160, v154, 1, v160
    v_xor_b32 v160, v153, v160
    v_lshl_add_u32 v160, v159, 2, v160
    v_lshl_add_u32 v20, v160, 4, s56
    v_xor_b32 v161, 1, v154
    v_add_u32 v159, 2, v158
    v_add_u32 v160, 1, v155
    v_mad_u32_u24 v159, v159, 10, v160
    v_bfe_u32 v160, v159, 2, 1
    v_lshl_or_b32 v160, v161, 1, v160
    v_xor_b32 v160, v153, v160
    v_lshl_add_u32 v160, v159, 2, v160
    v_lshl_add_u32 v21, v160, 4, s56
    v_bfe_u32 v158, v152, 2, 1
    v_sub_u32 v158, v153, v158
    v_and_b32 v159, 3, v152
    v_mul_u32_u24 v16, 0x1111, v159
    v_lshrrev_b32 v160, 3, v152
    v_lshl_add_u32 v159, v160, 2, v159
    v_lshlrev_b32 v159, 5, v159
    v_add_u32 v159, 141312, v159
    s_movk_i32 s70, 3072
    v_cmp_gt_u32 vcc, 3, v158
    v_mad_u32_u24 v159, v158, s70, v159
    s_nop 0
    v_cndmask_b32 v22, v157, v159, vcc
    v_lshlrev_b32 v23, 4, v129
    v_add_u32 v24, 40960, v23
    v_lshlrev_b32 v25, 5, v153
    v_add_u32 v25, 150528, v25
    v_and_b32 v160, 1, v129
    v_lshlrev_b32 v160, 4, v160
    v_mov_b32 v161, 0x3f80
    v_lshlrev_b32 v160, v160, v161
    v_bfe_u32 v158, v129, 1, 1
    v_bfe_u32 v159, v129, 3, 2
    v_lshl_add_u32 v159, v159, 1, v158
    v_bfe_u32 v161, v129, 2, 1
    v_xor_b32 v161, v161, v138
    v_lshl_add_u32 v159, v161, 3, v159
    v_lshlrev_b32 v159, v159, 1
    v_lshrrev_b32 v161, 2, v152
    v_xor_b32 v161, v161, v153
    v_lshl_add_u32 v158, v161, 1, v158
    v_lshlrev_b32 v158, v158, 1
    v_bfe_i32 v240, v159, 0, 1
    v_bfe_i32 v241, v159, 1, 1
    v_bfe_i32 v242, v159, 2, 1
    v_bfe_i32 v243, v159, 3, 1
    v_bfe_i32 v244, v159, 4, 1
    v_bfe_i32 v245, v159, 5, 1
    v_bfe_i32 v246, v159, 6, 1
    v_bfe_i32 v247, v159, 7, 1
    v_bfe_i32 v18, v158, 0, 1
    v_bfe_i32 v19, v158, 1, 1
    v_and_b32 v240, v160, v240
    v_and_b32 v241, v160, v241
    v_and_b32 v242, v160, v242
    v_and_b32 v243, v160, v243
    v_and_b32 v244, v160, v244
    v_and_b32 v245, v160, v245
    v_and_b32 v246, v160, v246
    v_and_b32 v247, v160, v247
    v_and_b32 v18, v160, v18
    v_and_b32 v19, v160, v19
    s_mov_b32 s24, s18
    s_mov_b32 s25, s19
    s_mov_b32 s26, 50331648
    s_mov_b32 s27, 0x20000
    s_mov_b32 s52, 0
    s_mov_b32 s80, 0
    s_mov_b32 s81, 98304
    s_mov_b32 s82, 393216
    s_mov_b32 s83, 491520
    s_mov_b32 s53, 1156138217
    s_mov_b32 s58, 0x3c003c00
    s_mov_b32 s85, 150912
    s_mov_b32 s86, 0x37803780
    s_mov_b32 s87, 0xffffffff
    s_mov_b32 s84, 0x37800000
    v_lshrrev_b32 v158, 2, v152
    v_xor_b32 v158, v158, v153
    v_bfe_i32 v158, v158, 0, 1
    v_bfi_b32 v158, v158, 0, s58
    v_accvgpr_write_b32 a228, v158
    v_accvgpr_write_b32 a229, v158
    v_accvgpr_write_b32 a230, v158
    v_accvgpr_write_b32 a231, v158
    v_and_b32 v17, v138, v153
    v_lshlrev_b32 v17, 4, v17
    v_lshrrev_b32 v17, v17, -1
    s_mov_b32 s73, 0x409d2a01
    s_mov_b32 s59, 0x3ef00000
    v_mul_u32_u24 v252, 0x100010, v0
    v_add_u32 v252, 0xc0004, v252
    v_lshlrev_b32 v253, 2, v0
    v_add_u32 v253, 150912, v253
    v_add_u32 v160, 0x0, v252
    v_add_u32 v168, 0x10001000, v252
    v_cvt_f32_f16 v161, v160
    v_cvt_f32_f16 v169, v168
    v_cvt_f32_f16_sdwa v162, v160 dst_sel:DWORD dst_unused:UNUSED_PAD src0_sel:WORD_1
    v_cvt_f32_f16_sdwa v170, v168 dst_sel:DWORD dst_unused:UNUSED_PAD src0_sel:WORD_1
    v_mul_f32 v163, 0x3f7fdde7, v161
    v_mul_f32 v171, 0x3f7fdde7, v169
    v_mul_f32 v164, 0x3f7fdde7, v162
    v_mul_f32 v172, 0x3f7fdde7, v170
    v_fma_f32 v163, v163, v161, s73
    v_fma_f32 v171, v171, v169, s73
    v_fma_f32 v164, v164, v162, s73
    v_fma_f32 v172, v172, v170, s73
    v_mul_f32 v163, -v161, v163
    v_mul_f32 v171, -v169, v171
    v_mul_f32 v164, -v162, v164
    v_mul_f32 v172, -v170, v172
    v_exp_f32 v165, v163
    v_exp_f32 v173, v171
    v_exp_f32 v166, v164
    v_exp_f32 v174, v172
    v_fma_f32 v163, v165, s59, s59
    v_fma_f32 v171, v173, s59, s59
    v_fma_f32 v164, v166, s59, s59
    v_fma_f32 v172, v174, s59, s59
    v_rcp_f32 v163, v163
    v_rcp_f32 v171, v171
    v_rcp_f32 v164, v164
    v_rcp_f32 v172, v172
    v_mul_f32 v163, v161, v163
    v_mul_f32 v171, v169, v171
    v_mul_f32 v164, v162, v164
    v_mul_f32 v172, v170, v172
    v_mul_f32 v165, -v165, v163
    v_mul_f32 v173, -v173, v171
    v_mul_f32 v166, -v166, v164
    v_mul_f32 v174, -v174, v172
    v_cvt_pk_bf16_f32 v167, v165, v166
    v_cvt_pk_bf16_f32 v175, v173, v174
    v_cvt_pk_bf16_f32 v160, v163, v164
    v_cvt_pk_bf16_f32 v168, v171, v172
    ds_write_b32 v253, v167 offset:8192
    ds_write_b32 v253, v160 offset:0
    ds_write_b32 v253, v175 offset:9216
    ds_write_b32 v253, v168 offset:1024
    v_add_u32 v160, 0x20002000, v252
    s_nop 0
    v_add_u32 v168, 0x30003000, v252
    v_cvt_f32_f16 v161, v160
    v_cvt_f32_f16 v169, v168
    v_cvt_f32_f16_sdwa v162, v160 dst_sel:DWORD dst_unused:UNUSED_PAD src0_sel:WORD_1
    v_cvt_f32_f16_sdwa v170, v168 dst_sel:DWORD dst_unused:UNUSED_PAD src0_sel:WORD_1
    v_mul_f32 v163, 0x3f7fdde7, v161
    v_mul_f32 v171, 0x3f7fdde7, v169
    v_mul_f32 v164, 0x3f7fdde7, v162
    v_mul_f32 v172, 0x3f7fdde7, v170
    v_fma_f32 v163, v163, v161, s73
    v_fma_f32 v171, v171, v169, s73
    v_fma_f32 v164, v164, v162, s73
    v_fma_f32 v172, v172, v170, s73
    v_mul_f32 v163, -v161, v163
    v_mul_f32 v171, -v169, v171
    v_mul_f32 v164, -v162, v164
    v_mul_f32 v172, -v170, v172
    v_exp_f32 v165, v163
    v_exp_f32 v173, v171
    v_exp_f32 v166, v164
    v_exp_f32 v174, v172
    v_fma_f32 v163, v165, s59, s59
    v_fma_f32 v171, v173, s59, s59
    v_fma_f32 v164, v166, s59, s59
    v_fma_f32 v172, v174, s59, s59
    v_rcp_f32 v163, v163
    v_rcp_f32 v171, v171
    v_rcp_f32 v164, v164
    v_rcp_f32 v172, v172
    v_mul_f32 v163, v161, v163
    v_mul_f32 v171, v169, v171
    v_mul_f32 v164, v162, v164
    v_mul_f32 v172, v170, v172
    v_mul_f32 v165, -v165, v163
    v_mul_f32 v173, -v173, v171
    v_mul_f32 v166, -v166, v164
    v_mul_f32 v174, -v174, v172
    v_cvt_pk_bf16_f32 v167, v165, v166
    v_cvt_pk_bf16_f32 v175, v173, v174
    v_cvt_pk_bf16_f32 v160, v163, v164
    v_cvt_pk_bf16_f32 v168, v171, v172
    ds_write_b32 v253, v167 offset:10240
    ds_write_b32 v253, v160 offset:2048
    ds_write_b32 v253, v175 offset:11264
    ds_write_b32 v253, v168 offset:3072
    v_add_u32 v160, 0x40004000, v252
    s_nop 0
    v_add_u32 v168, 0x50005000, v252
    v_cvt_f32_f16 v161, v160
    v_cvt_f32_f16 v169, v168
    v_cvt_f32_f16_sdwa v162, v160 dst_sel:DWORD dst_unused:UNUSED_PAD src0_sel:WORD_1
    v_cvt_f32_f16_sdwa v170, v168 dst_sel:DWORD dst_unused:UNUSED_PAD src0_sel:WORD_1
    v_mul_f32 v163, 0x3f7fdde7, v161
    v_mul_f32 v171, 0x40088889, v169
    v_mul_f32 v164, 0x3f7fdde7, v162
    v_mul_f32 v172, 0x40088889, v170
    v_fma_f32 v163, v163, v161, s73
    v_cvt_pk_bf16_f32 v168, v171, v172
    v_fma_f32 v164, v164, v162, s73
    v_mul_f32 v163, -v161, v163
    v_mul_f32 v164, -v162, v164
    v_exp_f32 v165, v163
    v_exp_f32 v166, v164
    v_fma_f32 v163, v165, s59, s59
    v_fma_f32 v164, v166, s59, s59
    v_rcp_f32 v163, v163
    v_rcp_f32 v164, v164
    v_mul_f32 v163, v161, v163
    v_mul_f32 v164, v162, v164
    v_mul_f32 v165, -v165, v163
    v_mul_f32 v166, -v166, v164
    v_cvt_pk_bf16_f32 v167, v165, v166
    v_cvt_pk_bf16_f32 v160, v163, v164
    ds_write_b32 v253, v167 offset:12288
    ds_write_b32 v253, v160 offset:4096
    ds_write_b32 v253, v168 offset:5120
    s_nop 0
    v_add_u32 v160, 0x60006000, v252
    v_add_u32 v168, 0x70007000, v252
    v_cvt_f32_f16 v161, v160
    v_cvt_f32_f16 v169, v168
    v_cvt_f32_f16_sdwa v162, v160 dst_sel:DWORD dst_unused:UNUSED_PAD src0_sel:WORD_1
    v_cvt_f32_f16_sdwa v170, v168 dst_sel:DWORD dst_unused:UNUSED_PAD src0_sel:WORD_1
    v_mul_f32 v163, 0x40088889, v161
    v_mul_f32 v171, 0x40088889, v169
    v_mul_f32 v164, 0x40088889, v162
    v_mul_f32 v172, 0x40088889, v170
    v_cvt_pk_bf16_f32 v160, v163, v164
    v_cvt_pk_bf16_f32 v168, v171, v172
    ds_write_b32 v253, v160 offset:6144
    ds_write_b32 v253, v168 offset:7168
    v_lshlrev_b32 v158, 6, v0
    v_add_u32 v158, 141312, v158
    v_cmp_gt_u32 vcc, 144, v0
    s_nop 1
    v_cndmask_b32 v158, v157, v158, vcc
    v_and_b32 v159, 3, v0
    v_lshl_add_u32 v160, v159, 2, v158
    v_lshrrev_b32 v159, 1, v159
    v_lshl_add_u32 v159, v159, 2, v158
    v_lshlrev_b32 v161, 4, v0
    v_add_u32 v161, 150528, v161
    v_cmp_gt_u32 vcc, 24, v0
    s_nop 1
    v_cndmask_b32 v161, v157, v161, vcc
    v_mov_b32 v164, 0
    v_mov_b32 v165, 0
    v_mov_b32 v166, 0
    v_mov_b32 v167, 0
    ds_write_b128 v158, v[164:167]
    ds_write_b128 v158, v[164:167] offset:16
    s_waitcnt lgkmcnt(9)
    ds_write_b128 v158, v[164:167] offset:32
    ds_write_b128 v158, v[164:167] offset:48
    s_waitcnt vmcnt(14)
    ds_write_b16 v160, v144
    ds_write_b16_d16_hi v160, v144 offset:34
    s_waitcnt vmcnt(13)
    ds_write_b16 v159, v145 offset:16
    ds_write_b16_d16_hi v159, v145 offset:48
    s_waitcnt vmcnt(12) lgkmcnt(13)
    ds_write_b16 v159, v146 offset:24
    ds_write_b16_d16_hi v159, v146 offset:56
    s_waitcnt vmcnt(11)
    v_lshlrev_b32 v168, 16, v148
    v_and_b32 v169, 0xffff0000, v148
    v_lshlrev_b32 v170, 16, v149
    v_and_b32 v171, 0xffff0000, v149
    s_waitcnt vmcnt(10)
    v_lshlrev_b32 v172, 16, v150
    v_and_b32 v173, 0xffff0000, v150
    v_lshlrev_b32 v174, 16, v151
    v_and_b32 v175, 0xffff0000, v151
    v_mul_f32 v168, v168, v172
    v_mul_f32 v169, v169, v173
    v_mul_f32 v170, v170, v174
    v_mul_f32 v171, v171, v175
    s_waitcnt lgkmcnt(14)
    ds_write_b128 v161, v[168:171]
    s_waitcnt vmcnt(9)
    v_mfma_f32_32x32x16_bf16 v[176:191], v[208:211], v[240:243], 0
    v_mfma_f32_32x32x16_bf16 v[176:191], v[208:211], v[244:247], v[176:191]
    s_waitcnt vmcnt(8)
    s_nop 10
    v_mfma_f32_32x32x16_bf16 v[180:195], v[212:215], v[240:243], 0
    v_mfma_f32_32x32x16_bf16 v[180:195], v[212:215], v[244:247], v[180:195]
    s_waitcnt vmcnt(7)
    s_nop 10
    v_mfma_f32_32x32x16_bf16 v[184:199], v[216:219], v[240:243], 0
    v_mfma_f32_32x32x16_bf16 v[184:199], v[216:219], v[244:247], v[184:199]
    s_mov_b32 s74, 0
    s_mov_b32 s75, 6144
    buffer_load_dwordx4 a[0:3], v232, s[48:51], s74 offen offset:0
    buffer_load_dwordx4 a[4:7], v232, s[48:51], s75 offen offset:0
    buffer_load_dwordx4 a[8:11], v232, s[48:51], s74 offen offset:1536
    buffer_load_dwordx4 a[12:15], v232, s[48:51], s75 offen offset:1536
    buffer_load_dwordx4 a[16:19], v232, s[48:51], s74 offen offset:64
    buffer_load_dwordx4 a[20:23], v232, s[48:51], s75 offen offset:64
    buffer_load_dwordx4 a[24:27], v232, s[48:51], s74 offen offset:1600
    buffer_load_dwordx4 a[28:31], v232, s[48:51], s75 offen offset:1600
    buffer_load_dwordx4 a[32:35], v232, s[48:51], s74 offen offset:128
    buffer_load_dwordx4 a[36:39], v232, s[48:51], s75 offen offset:128
    buffer_load_dwordx4 a[40:43], v232, s[48:51], s74 offen offset:1664
    buffer_load_dwordx4 a[44:47], v232, s[48:51], s75 offen offset:1664
    s_mov_b32 s74, 24576
    s_mov_b32 s75, 30720
    buffer_load_dwordx4 a[48:51], v232, s[48:51], s74 offen offset:0
    buffer_load_dwordx4 a[52:55], v232, s[48:51], s75 offen offset:0
    buffer_load_dwordx4 a[56:59], v232, s[48:51], s74 offen offset:1536
    buffer_load_dwordx4 a[60:63], v232, s[48:51], s75 offen offset:1536
    buffer_load_dwordx4 a[64:67], v232, s[48:51], s74 offen offset:64
    buffer_load_dwordx4 a[68:71], v232, s[48:51], s75 offen offset:64
    buffer_load_dwordx4 a[72:75], v232, s[48:51], s74 offen offset:1600
    buffer_load_dwordx4 a[76:79], v232, s[48:51], s75 offen offset:1600
    buffer_load_dwordx4 a[80:83], v232, s[48:51], s74 offen offset:128
    buffer_load_dwordx4 a[84:87], v232, s[48:51], s75 offen offset:128
    buffer_load_dwordx4 a[88:91], v232, s[48:51], s74 offen offset:1664
    buffer_load_dwordx4 a[92:95], v232, s[48:51], s75 offen offset:1664
    s_waitcnt vmcnt(23)
    v_mfma_f32_32x32x16_bf16 v[80:95], a[0:3], v[240:243], 0
    s_waitcnt vmcnt(21)
    v_mfma_f32_32x32x16_bf16 v[96:111], a[8:11], v[240:243], 0
    v_mfma_f32_32x32x16_bf16 v[80:95], a[4:7], v[244:247], v[80:95]
    s_waitcnt vmcnt(20)
    v_mfma_f32_32x32x16_bf16 v[96:111], a[12:15], v[244:247], v[96:111]
    s_waitcnt vmcnt(19)
    v_mfma_f32_32x32x16_bf16 v[112:127], a[16:19], v[240:243], 0
    s_waitcnt vmcnt(17)
    v_mfma_f32_32x32x16_bf16 v[128:143], a[24:27], v[240:243], 0
    v_mfma_f32_32x32x16_bf16 v[112:127], a[20:23], v[244:247], v[112:127]
    s_waitcnt vmcnt(16)
    v_mfma_f32_32x32x16_bf16 v[128:143], a[28:31], v[244:247], v[128:143]
    s_nop 2
    v_pk_mul_f32 v[80:81], v[80:81], v[176:177]
    v_pk_mul_f32 v[84:85], v[84:85], v[176:177]
    v_pk_mul_f32 v[88:89], v[88:89], v[176:177]
    v_pk_mul_f32 v[92:93], v[92:93], v[176:177]
    v_pk_mul_f32 v[96:97], v[96:97], v[176:177]
    v_pk_mul_f32 v[100:101], v[100:101], v[176:177]
    v_pk_mul_f32 v[104:105], v[104:105], v[176:177]
    v_pk_mul_f32 v[108:109], v[108:109], v[176:177]
    v_cvt_pk_bf16_f32 v224, v80, v84
    v_cvt_pk_bf16_f32 v225, v88, v92
    v_cvt_pk_bf16_f32 v226, v96, v100
    v_cvt_pk_bf16_f32 v227, v104, v108
    s_waitcnt vmcnt(15)
    v_mfma_f32_32x32x16_bf16 v[144:159], a[32:35], v[240:243], 0
    s_waitcnt lgkmcnt(14)
    ds_write_b128 v234, v[224:227] offset:6144
    s_mov_b32 s74, 49152
    v_cvt_pk_bf16_f32 v228, v81, v85
    v_cvt_pk_bf16_f32 v229, v89, v93
    v_cvt_pk_bf16_f32 v230, v97, v101
    v_cvt_pk_bf16_f32 v231, v105, v109
    s_waitcnt vmcnt(13)
    v_mfma_f32_32x32x16_bf16 v[160:175], a[40:43], v[240:243], 0
    s_waitcnt lgkmcnt(14)
    ds_write_b128 v235, v[228:231] offset:6144
    s_mov_b32 s75, 55296
    buffer_load_dwordx4 v[32:35], v232, s[48:51], s74 offen offset:0
    v_pk_mul_f32 v[82:83], v[82:83], v[178:179]
    v_pk_mul_f32 v[86:87], v[86:87], v[178:179]
    v_pk_mul_f32 v[90:91], v[90:91], v[178:179]
    v_pk_mul_f32 v[94:95], v[94:95], v[178:179]
    v_pk_mul_f32 v[98:99], v[98:99], v[178:179]
    v_pk_mul_f32 v[102:103], v[102:103], v[178:179]
    v_pk_mul_f32 v[106:107], v[106:107], v[178:179]
    v_pk_mul_f32 v[110:111], v[110:111], v[178:179]
    v_cvt_pk_bf16_f32 v224, v82, v86
    v_cvt_pk_bf16_f32 v225, v90, v94
    v_cvt_pk_bf16_f32 v226, v98, v102
    v_cvt_pk_bf16_f32 v227, v106, v110
    v_mfma_f32_32x32x16_bf16 v[144:159], a[36:39], v[244:247], v[144:159]
    s_waitcnt lgkmcnt(14)
    ds_write_b128 v234, v[224:227] offset:6272
    buffer_load_dwordx4 v[36:39], v232, s[48:51], s75 offen offset:0
    v_cvt_pk_bf16_f32 v228, v83, v87
    v_cvt_pk_bf16_f32 v229, v91, v95
    v_cvt_pk_bf16_f32 v230, v99, v103
    v_cvt_pk_bf16_f32 v231, v107, v111
    s_waitcnt vmcnt(14)
    v_mfma_f32_32x32x16_bf16 v[160:175], a[44:47], v[244:247], v[160:175]
    s_waitcnt vmcnt(10)
    s_waitcnt lgkmcnt(14)
    ds_write_b128 v235, v[228:231] offset:6272
    buffer_load_dwordx4 v[40:43], v232, s[48:51], s74 offen offset:1536
    buffer_load_dwordx4 v[44:47], v232, s[48:51], s75 offen offset:1536
    v_pk_mul_f32 v[112:113], v[112:113], v[180:181]
    v_pk_mul_f32 v[116:117], v[116:117], v[180:181]
    v_pk_mul_f32 v[120:121], v[120:121], v[180:181]
    v_pk_mul_f32 v[124:125], v[124:125], v[180:181]
    v_pk_mul_f32 v[128:129], v[128:129], v[180:181]
    v_pk_mul_f32 v[132:133], v[132:133], v[180:181]
    v_pk_mul_f32 v[136:137], v[136:137], v[180:181]
    v_pk_mul_f32 v[140:141], v[140:141], v[180:181]
    v_cvt_pk_bf16_f32 v224, v112, v116
    v_cvt_pk_bf16_f32 v225, v120, v124
    v_cvt_pk_bf16_f32 v226, v128, v132
    v_cvt_pk_bf16_f32 v227, v136, v140
    v_mfma_f32_32x32x16_bf16 v[80:95], a[48:51], v[240:243], 0
    s_waitcnt lgkmcnt(14)
    ds_write_b128 v234, v[224:227] offset:8192
    buffer_load_dwordx4 v[48:51], v232, s[48:51], s74 offen offset:64
    v_cvt_pk_bf16_f32 v228, v113, v117
    v_cvt_pk_bf16_f32 v229, v121, v125
    v_cvt_pk_bf16_f32 v230, v129, v133
    v_cvt_pk_bf16_f32 v231, v137, v141
    v_mfma_f32_32x32x16_bf16 v[96:111], a[56:59], v[240:243], 0
    s_waitcnt lgkmcnt(14)
    ds_write_b128 v235, v[228:231] offset:8192
    buffer_load_dwordx4 v[52:55], v232, s[48:51], s75 offen offset:64
    v_pk_mul_f32 v[114:115], v[114:115], v[182:183]
    v_pk_mul_f32 v[118:119], v[118:119], v[182:183]
    v_pk_mul_f32 v[122:123], v[122:123], v[182:183]
    v_pk_mul_f32 v[126:127], v[126:127], v[182:183]
    v_pk_mul_f32 v[130:131], v[130:131], v[182:183]
    v_pk_mul_f32 v[134:135], v[134:135], v[182:183]
    v_pk_mul_f32 v[138:139], v[138:139], v[182:183]
    v_pk_mul_f32 v[142:143], v[142:143], v[182:183]
    v_cvt_pk_bf16_f32 v224, v114, v118
    v_cvt_pk_bf16_f32 v225, v122, v126
    v_cvt_pk_bf16_f32 v226, v130, v134
    v_cvt_pk_bf16_f32 v227, v138, v142
    v_mfma_f32_32x32x16_bf16 v[80:95], a[52:55], v[244:247], v[80:95]
    s_waitcnt lgkmcnt(14)
    ds_write_b128 v234, v[224:227] offset:8320
    buffer_load_dwordx4 v[56:59], v232, s[48:51], s74 offen offset:1600
    v_cvt_pk_bf16_f32 v228, v115, v119
    v_cvt_pk_bf16_f32 v229, v123, v127
    v_cvt_pk_bf16_f32 v230, v131, v135
    v_cvt_pk_bf16_f32 v231, v139, v143
    v_mfma_f32_32x32x16_bf16 v[96:111], a[60:63], v[244:247], v[96:111]
    s_waitcnt vmcnt(11)
    s_waitcnt lgkmcnt(14)
    ds_write_b128 v235, v[228:231] offset:8320
    buffer_load_dwordx4 v[60:63], v232, s[48:51], s75 offen offset:1600
    v_pk_mul_f32 v[144:145], v[144:145], v[184:185]
    v_pk_mul_f32 v[148:149], v[148:149], v[184:185]
    v_pk_mul_f32 v[152:153], v[152:153], v[184:185]
    v_pk_mul_f32 v[156:157], v[156:157], v[184:185]
    v_pk_mul_f32 v[160:161], v[160:161], v[184:185]
    v_pk_mul_f32 v[164:165], v[164:165], v[184:185]
    v_pk_mul_f32 v[168:169], v[168:169], v[184:185]
    v_pk_mul_f32 v[172:173], v[172:173], v[184:185]
    v_cvt_pk_bf16_f32 v224, v144, v148
    v_cvt_pk_bf16_f32 v225, v152, v156
    v_cvt_pk_bf16_f32 v226, v160, v164
    v_cvt_pk_bf16_f32 v227, v168, v172
    v_mfma_f32_32x32x16_bf16 v[112:127], a[64:67], v[240:243], 0
    s_waitcnt lgkmcnt(14)
    ds_write_b128 v234, v[224:227] offset:10240
    buffer_load_dwordx4 v[64:67], v232, s[48:51], s74 offen offset:128
    v_cvt_pk_bf16_f32 v228, v145, v149
    v_cvt_pk_bf16_f32 v229, v153, v157
    v_cvt_pk_bf16_f32 v230, v161, v165
    v_cvt_pk_bf16_f32 v231, v169, v173
    v_mfma_f32_32x32x16_bf16 v[128:143], a[72:75], v[240:243], 0
    s_waitcnt lgkmcnt(14)
    ds_write_b128 v235, v[228:231] offset:10240
    buffer_load_dwordx4 v[68:71], v232, s[48:51], s75 offen offset:128
    v_pk_mul_f32 v[146:147], v[146:147], v[186:187]
    v_pk_mul_f32 v[150:151], v[150:151], v[186:187]
    v_pk_mul_f32 v[154:155], v[154:155], v[186:187]
    v_pk_mul_f32 v[158:159], v[158:159], v[186:187]
    v_pk_mul_f32 v[162:163], v[162:163], v[186:187]
    v_pk_mul_f32 v[166:167], v[166:167], v[186:187]
    v_pk_mul_f32 v[170:171], v[170:171], v[186:187]
    v_pk_mul_f32 v[174:175], v[174:175], v[186:187]
    v_cvt_pk_bf16_f32 v224, v146, v150
    v_cvt_pk_bf16_f32 v225, v154, v158
    v_cvt_pk_bf16_f32 v226, v162, v166
    v_cvt_pk_bf16_f32 v227, v170, v174
    v_mfma_f32_32x32x16_bf16 v[112:127], a[68:71], v[244:247], v[112:127]
    s_waitcnt lgkmcnt(14)
    ds_write_b128 v234, v[224:227] offset:10368
    buffer_load_dwordx4 v[72:75], v232, s[48:51], s74 offen offset:1664
    v_cvt_pk_bf16_f32 v228, v147, v151
    v_cvt_pk_bf16_f32 v229, v155, v159
    v_cvt_pk_bf16_f32 v230, v163, v167
    v_cvt_pk_bf16_f32 v231, v171, v175
    v_mfma_f32_32x32x16_bf16 v[128:143], a[76:79], v[244:247], v[128:143]
    s_waitcnt vmcnt(11)
    s_waitcnt lgkmcnt(14)
    ds_write_b128 v235, v[228:231] offset:10368
    buffer_load_dwordx4 v[76:79], v232, s[48:51], s75 offen offset:1664
    v_sub_u32 v234, v234, v238
    v_sub_u32 v235, v235, v238
    v_pk_mul_f32 v[80:81], v[80:81], v[176:177]
    v_pk_mul_f32 v[84:85], v[84:85], v[176:177]
    v_pk_mul_f32 v[88:89], v[88:89], v[176:177]
    v_pk_mul_f32 v[92:93], v[92:93], v[176:177]
    v_pk_mul_f32 v[96:97], v[96:97], v[176:177]
    v_pk_mul_f32 v[100:101], v[100:101], v[176:177]
    v_pk_mul_f32 v[104:105], v[104:105], v[176:177]
    v_pk_mul_f32 v[108:109], v[108:109], v[176:177]
    v_cvt_pk_bf16_f32 v224, v80, v84
    v_cvt_pk_bf16_f32 v225, v88, v92
    v_cvt_pk_bf16_f32 v226, v96, v100
    v_cvt_pk_bf16_f32 v227, v104, v108
    v_mfma_f32_32x32x16_bf16 v[144:159], a[80:83], v[240:243], 0
    s_waitcnt lgkmcnt(14)
    ds_write_b128 v234, v[224:227] offset:6144
    s_add_u32 m0, s56, 6336
    s_nop 0
    buffer_load_dwordx4 v1, s[20:23], 0 offen offset:64 lds
    v_cvt_pk_bf16_f32 v228, v81, v85
    v_cvt_pk_bf16_f32 v229, v89, v93
    v_cvt_pk_bf16_f32 v230, v97, v101
    v_cvt_pk_bf16_f32 v231, v105, v109
    v_mfma_f32_32x32x16_bf16 v[160:175], a[88:91], v[240:243], 0
    s_waitcnt lgkmcnt(14)
    ds_write_b128 v235, v[228:231] offset:6144
    s_add_u32 m0, s56, 7360
    s_nop 0
    buffer_load_dwordx4 v2, s[20:23], 0 offen offset:64 lds
    v_pk_mul_f32 v[82:83], v[82:83], v[178:179]
    v_pk_mul_f32 v[86:87], v[86:87], v[178:179]
    v_pk_mul_f32 v[90:91], v[90:91], v[178:179]
    v_pk_mul_f32 v[94:95], v[94:95], v[178:179]
    v_pk_mul_f32 v[98:99], v[98:99], v[178:179]
    v_pk_mul_f32 v[102:103], v[102:103], v[178:179]
    v_pk_mul_f32 v[106:107], v[106:107], v[178:179]
    v_pk_mul_f32 v[110:111], v[110:111], v[178:179]
    v_cvt_pk_bf16_f32 v224, v82, v86
    v_cvt_pk_bf16_f32 v225, v90, v94
    v_cvt_pk_bf16_f32 v226, v98, v102
    v_cvt_pk_bf16_f32 v227, v106, v110
    v_mfma_f32_32x32x16_bf16 v[144:159], a[84:87], v[244:247], v[144:159]
    s_waitcnt lgkmcnt(14)
    ds_write_b128 v234, v[224:227] offset:6272
    s_add_u32 m0, s56, 8384
    s_nop 0
    buffer_load_dwordx4 v3, s[20:23], 0 offen offset:64 lds
    v_cvt_pk_bf16_f32 v228, v83, v87
    v_cvt_pk_bf16_f32 v229, v91, v95
    v_cvt_pk_bf16_f32 v230, v99, v103
    v_cvt_pk_bf16_f32 v231, v107, v111
    v_mfma_f32_32x32x16_bf16 v[160:175], a[92:95], v[244:247], v[160:175]
    s_waitcnt vmcnt(11)
    s_waitcnt lgkmcnt(14)
    ds_write_b128 v235, v[228:231] offset:6272
    s_add_u32 m0, s56, 9408
    s_nop 0
    buffer_load_dwordx4 v4, s[20:23], 0 offen offset:64 lds
    v_pk_mul_f32 v[112:113], v[112:113], v[180:181]
    v_pk_mul_f32 v[116:117], v[116:117], v[180:181]
    v_pk_mul_f32 v[120:121], v[120:121], v[180:181]
    v_pk_mul_f32 v[124:125], v[124:125], v[180:181]
    v_pk_mul_f32 v[128:129], v[128:129], v[180:181]
    v_pk_mul_f32 v[132:133], v[132:133], v[180:181]
    v_pk_mul_f32 v[136:137], v[136:137], v[180:181]
    v_pk_mul_f32 v[140:141], v[140:141], v[180:181]
    v_cvt_pk_bf16_f32 v224, v112, v116
    v_cvt_pk_bf16_f32 v225, v120, v124
    v_cvt_pk_bf16_f32 v226, v128, v132
    v_cvt_pk_bf16_f32 v227, v136, v140
    v_mfma_f32_32x32x16_bf16 v[80:95], v[32:35], v[240:243], 0
    s_waitcnt lgkmcnt(0)
    s_barrier
    ds_write_b128 v234, v[224:227] offset:8192
    ds_read_b128 a[192:195], v23 offset:4096
    ds_read_b128 a[196:199], v23 offset:5120
    ds_read_b128 a[200:203], v23 offset:14336
    ds_read_b128 a[204:207], v23 offset:15360
    ds_read_b128 a[208:211], v23 offset:24576
    ds_read_b128 a[212:215], v23 offset:25600
    ds_read_b128 a[216:219], v23 offset:34816
    s_add_u32 m0, s56, 10432
    v_cvt_pk_bf16_f32 v228, v113, v117
    v_cvt_pk_bf16_f32 v229, v121, v125
    v_cvt_pk_bf16_f32 v230, v129, v133
    v_cvt_pk_bf16_f32 v231, v137, v141
    v_mfma_f32_32x32x16_bf16 v[96:111], v[40:43], v[240:243], 0
    ds_write_b128 v235, v[228:231] offset:8192
    ds_read_b128 a[220:223], v23 offset:35840
    ds_read_b128 a[0:3], v24 offset:0
    ds_read_b128 a[4:7], v24 offset:1024
    ds_read_b128 a[24:27], v24 offset:6144
    ds_read_b128 a[28:31], v24 offset:7168
    ds_read_b128 a[96:99], v24 offset:24576
    s_waitcnt lgkmcnt(14)
    ds_read_b128 a[100:103], v24 offset:25600
    buffer_load_dwordx4 v5, s[20:23], 0 offen offset:64 lds
    s_add_u32 m0, s56, 11456
    v_pk_mul_f32 v[114:115], v[114:115], v[182:183]
    v_pk_mul_f32 v[118:119], v[118:119], v[182:183]
    v_pk_mul_f32 v[122:123], v[122:123], v[182:183]
    v_pk_mul_f32 v[126:127], v[126:127], v[182:183]
    v_pk_mul_f32 v[130:131], v[130:131], v[182:183]
    v_pk_mul_f32 v[134:135], v[134:135], v[182:183]
    v_pk_mul_f32 v[138:139], v[138:139], v[182:183]
    v_pk_mul_f32 v[142:143], v[142:143], v[182:183]
    v_cvt_pk_bf16_f32 v224, v114, v118
    v_cvt_pk_bf16_f32 v225, v122, v126
    v_cvt_pk_bf16_f32 v226, v130, v134
    v_cvt_pk_bf16_f32 v227, v138, v142
    v_mfma_f32_32x32x16_bf16 v[80:95], v[36:39], v[244:247], v[80:95]
    s_waitcnt lgkmcnt(9)
    ds_write_b128 v234, v[224:227] offset:8320
    ds_read_b128 a[120:123], v24 offset:30720
    ds_read_b128 a[124:127], v24 offset:31744
    ds_read_b128 a[144:147], v24 offset:36864
    ds_read_b128 a[148:151], v24 offset:37888
    ds_read_b128 a[168:171], v24 offset:43008
    s_waitcnt lgkmcnt(13)
    ds_read_b128 a[172:175], v24 offset:44032
    ds_read_b128 a[48:51], v24 offset:12288
    buffer_load_dwordx4 v6, s[20:23], 0 offen offset:64 lds
    s_add_u32 m0, s56, 12480
    v_cvt_pk_bf16_f32 v228, v115, v119
    v_cvt_pk_bf16_f32 v229, v123, v127
    v_cvt_pk_bf16_f32 v230, v131, v135
    v_cvt_pk_bf16_f32 v231, v139, v143
    v_mfma_f32_32x32x16_bf16 v[96:111], v[44:47], v[244:247], v[96:111]
    s_waitcnt vmcnt(10)
    s_waitcnt lgkmcnt(9)
    ds_write_b128 v235, v[228:231] offset:8320
    ds_read_b128 a[52:55], v24 offset:13312
    ds_read_b128 a[72:75], v24 offset:18432
    ds_read_b128 a[76:79], v24 offset:19456
    ds_read_b128 a[8:11], v24 offset:2048
    ds_read_b128 a[12:15], v24 offset:3072
    s_waitcnt lgkmcnt(13)
    ds_read_b128 a[32:35], v24 offset:8192
    ds_read_b128 a[36:39], v24 offset:9216
    buffer_load_dword v7, s[20:23], 0 offen offset:64 lds
    buffer_load_dword v254, v31, s[20:23], 0 offen
    v_pk_mul_f32 v[144:145], v[144:145], v[184:185]
    v_pk_mul_f32 v[148:149], v[148:149], v[184:185]
    v_pk_mul_f32 v[152:153], v[152:153], v[184:185]
    v_pk_mul_f32 v[156:157], v[156:157], v[184:185]
    v_pk_mul_f32 v[160:161], v[160:161], v[184:185]
    v_pk_mul_f32 v[164:165], v[164:165], v[184:185]
    v_pk_mul_f32 v[168:169], v[168:169], v[184:185]
    v_pk_mul_f32 v[172:173], v[172:173], v[184:185]
    v_cvt_pk_bf16_f32 v224, v144, v148
    v_cvt_pk_bf16_f32 v225, v152, v156
    v_cvt_pk_bf16_f32 v226, v160, v164
    v_cvt_pk_bf16_f32 v227, v168, v172
    v_mfma_f32_32x32x16_bf16 v[112:127], v[48:51], v[240:243], 0
    s_waitcnt lgkmcnt(9)
    ds_write_b128 v234, v[224:227] offset:10240
    ds_read_b128 a[104:107], v24 offset:26624
    ds_read_b128 a[108:111], v24 offset:27648
    ds_read_b128 a[128:131], v24 offset:32768
    ds_read_b128 a[132:135], v24 offset:33792
    ds_read_b128 a[152:155], v24 offset:38912
    s_waitcnt lgkmcnt(13)
    ds_read_b128 a[156:159], v24 offset:39936
    ds_read_b128 a[176:179], v24 offset:45056
    v_cvt_pk_bf16_f32 v228, v145, v149
    v_cvt_pk_bf16_f32 v229, v153, v157
    v_cvt_pk_bf16_f32 v230, v161, v165
    v_cvt_pk_bf16_f32 v231, v169, v173
    v_mfma_f32_32x32x16_bf16 v[128:143], v[56:59], v[240:243], 0
    s_waitcnt lgkmcnt(9)
    ds_write_b128 v235, v[228:231] offset:10240
    ds_read_b128 a[180:183], v24 offset:46080
    ds_read_b128 a[56:59], v24 offset:14336
    ds_read_b128 a[60:63], v24 offset:15360
    ds_read_b128 a[80:83], v24 offset:20480
    ds_read_b128 a[84:87], v24 offset:21504
    s_waitcnt lgkmcnt(13)
    ds_read_b128 a[16:19], v24 offset:4096
    ds_read_b128 a[20:23], v24 offset:5120
    v_pk_mul_f32 v[146:147], v[146:147], v[186:187]
    v_pk_mul_f32 v[150:151], v[150:151], v[186:187]
    v_pk_mul_f32 v[154:155], v[154:155], v[186:187]
    v_pk_mul_f32 v[158:159], v[158:159], v[186:187]
    v_pk_mul_f32 v[162:163], v[162:163], v[186:187]
    v_pk_mul_f32 v[166:167], v[166:167], v[186:187]
    v_pk_mul_f32 v[170:171], v[170:171], v[186:187]
    v_pk_mul_f32 v[174:175], v[174:175], v[186:187]
    v_cvt_pk_bf16_f32 v224, v146, v150
    v_cvt_pk_bf16_f32 v225, v154, v158
    v_cvt_pk_bf16_f32 v226, v162, v166
    v_cvt_pk_bf16_f32 v227, v170, v174
    v_mfma_f32_32x32x16_bf16 v[112:127], v[52:55], v[244:247], v[112:127]
    s_waitcnt lgkmcnt(9)
    ds_write_b128 v234, v[224:227] offset:10368
    ds_read_b128 a[40:43], v24 offset:10240
    ds_read_b128 a[44:47], v24 offset:11264
    ds_read_b128 a[112:115], v24 offset:28672
    ds_read_b128 a[116:119], v24 offset:29696
    ds_read_b128 a[136:139], v24 offset:34816
    s_waitcnt lgkmcnt(13)
    ds_read_b128 a[140:143], v24 offset:35840
    ds_read_b128 a[160:163], v24 offset:40960
    v_cvt_pk_bf16_f32 v228, v147, v151
    v_cvt_pk_bf16_f32 v229, v155, v159
    v_cvt_pk_bf16_f32 v230, v163, v167
    v_cvt_pk_bf16_f32 v231, v171, v175
    v_mfma_f32_32x32x16_bf16 v[128:143], v[60:63], v[244:247], v[128:143]
    s_waitcnt vmcnt(8)
    s_waitcnt lgkmcnt(9)
    ds_write_b128 v235, v[228:231] offset:10368
    ds_read_b128 a[164:167], v24 offset:41984
    ds_read_b128 a[184:187], v24 offset:47104
    ds_read_b128 a[188:191], v24 offset:48128
    ds_read_b128 a[64:67], v24 offset:16384
    ds_read_b128 a[68:71], v24 offset:17408
    s_waitcnt lgkmcnt(13)
    ds_read_b128 a[88:91], v24 offset:22528
    ds_read_b128 a[92:95], v24 offset:23552
    v_add_u32 v234, v234, v238
    v_add_u32 v235, v235, v238
    v_pk_mul_f32 v[80:81], v[80:81], v[176:177]
    v_pk_mul_f32 v[84:85], v[84:85], v[176:177]
    v_pk_mul_f32 v[88:89], v[88:89], v[176:177]
    v_pk_mul_f32 v[92:93], v[92:93], v[176:177]
    v_pk_mul_f32 v[96:97], v[96:97], v[176:177]
    v_pk_mul_f32 v[100:101], v[100:101], v[176:177]
    v_pk_mul_f32 v[104:105], v[104:105], v[176:177]
    v_pk_mul_f32 v[108:109], v[108:109], v[176:177]
    v_cvt_pk_bf16_f32 v224, v80, v84
    v_cvt_pk_bf16_f32 v225, v88, v92
    v_cvt_pk_bf16_f32 v226, v96, v100
    v_cvt_pk_bf16_f32 v227, v104, v108
    v_mfma_f32_32x32x16_bf16 v[144:159], v[64:67], v[240:243], 0
    s_waitcnt lgkmcnt(0)
    s_barrier
    ds_write_b128 v234, v[224:227] offset:6144
    v_cvt_pk_bf16_f32 v228, v81, v85
    v_cvt_pk_bf16_f32 v229, v89, v93
    v_cvt_pk_bf16_f32 v230, v97, v101
    v_cvt_pk_bf16_f32 v231, v105, v109
    v_mfma_f32_32x32x16_bf16 v[160:175], v[72:75], v[240:243], 0
    ds_write_b128 v235, v[228:231] offset:6144
    v_pk_mul_f32 v[82:83], v[82:83], v[178:179]
    v_pk_mul_f32 v[86:87], v[86:87], v[178:179]
    v_pk_mul_f32 v[90:91], v[90:91], v[178:179]
    v_pk_mul_f32 v[94:95], v[94:95], v[178:179]
    v_pk_mul_f32 v[98:99], v[98:99], v[178:179]
    v_pk_mul_f32 v[102:103], v[102:103], v[178:179]
    v_pk_mul_f32 v[106:107], v[106:107], v[178:179]
    v_pk_mul_f32 v[110:111], v[110:111], v[178:179]
    v_cvt_pk_bf16_f32 v224, v82, v86
    v_cvt_pk_bf16_f32 v225, v90, v94
    v_cvt_pk_bf16_f32 v226, v98, v102
    v_cvt_pk_bf16_f32 v227, v106, v110
    v_mfma_f32_32x32x16_bf16 v[144:159], v[68:71], v[244:247], v[144:159]
    ds_write_b128 v234, v[224:227] offset:6272
    v_cvt_pk_bf16_f32 v228, v83, v87
    v_cvt_pk_bf16_f32 v229, v91, v95
    v_cvt_pk_bf16_f32 v230, v99, v103
    v_cvt_pk_bf16_f32 v231, v107, v111
    v_mfma_f32_32x32x16_bf16 v[160:175], v[76:79], v[244:247], v[160:175]
    ds_write_b128 v235, v[228:231] offset:6272
    v_pk_mul_f32 v[112:113], v[112:113], v[180:181]
    v_pk_mul_f32 v[116:117], v[116:117], v[180:181]
    v_pk_mul_f32 v[120:121], v[120:121], v[180:181]
    v_pk_mul_f32 v[124:125], v[124:125], v[180:181]
    v_pk_mul_f32 v[128:129], v[128:129], v[180:181]
    v_pk_mul_f32 v[132:133], v[132:133], v[180:181]
    v_pk_mul_f32 v[136:137], v[136:137], v[180:181]
    v_pk_mul_f32 v[140:141], v[140:141], v[180:181]
    v_cvt_pk_bf16_f32 v224, v112, v116
    v_cvt_pk_bf16_f32 v225, v120, v124
    v_cvt_pk_bf16_f32 v226, v128, v132
    v_cvt_pk_bf16_f32 v227, v136, v140
    ds_write_b128 v234, v[224:227] offset:8192
    v_cvt_pk_bf16_f32 v228, v113, v117
    v_cvt_pk_bf16_f32 v229, v121, v125
    v_cvt_pk_bf16_f32 v230, v129, v133
    v_cvt_pk_bf16_f32 v231, v137, v141
    ds_write_b128 v235, v[228:231] offset:8192
    v_pk_mul_f32 v[114:115], v[114:115], v[182:183]
    v_pk_mul_f32 v[118:119], v[118:119], v[182:183]
    v_pk_mul_f32 v[122:123], v[122:123], v[182:183]
    v_pk_mul_f32 v[126:127], v[126:127], v[182:183]
    v_pk_mul_f32 v[130:131], v[130:131], v[182:183]
    v_pk_mul_f32 v[134:135], v[134:135], v[182:183]
    v_pk_mul_f32 v[138:139], v[138:139], v[182:183]
    v_pk_mul_f32 v[142:143], v[142:143], v[182:183]
    v_cvt_pk_bf16_f32 v224, v114, v118
    v_cvt_pk_bf16_f32 v225, v122, v126
    v_cvt_pk_bf16_f32 v226, v130, v134
    v_cvt_pk_bf16_f32 v227, v138, v142
    ds_write_b128 v234, v[224:227] offset:8320
    v_cvt_pk_bf16_f32 v228, v115, v119
    v_cvt_pk_bf16_f32 v229, v123, v127
    v_cvt_pk_bf16_f32 v230, v131, v135
    v_cvt_pk_bf16_f32 v231, v139, v143
    ds_write_b128 v235, v[228:231] offset:8320
    v_pk_mul_f32 v[144:145], v[144:145], v[184:185]
    v_pk_mul_f32 v[148:149], v[148:149], v[184:185]
    v_pk_mul_f32 v[152:153], v[152:153], v[184:185]
    v_pk_mul_f32 v[156:157], v[156:157], v[184:185]
    v_pk_mul_f32 v[160:161], v[160:161], v[184:185]
    v_pk_mul_f32 v[164:165], v[164:165], v[184:185]
    v_pk_mul_f32 v[168:169], v[168:169], v[184:185]
    v_pk_mul_f32 v[172:173], v[172:173], v[184:185]
    v_cvt_pk_bf16_f32 v224, v144, v148
    v_cvt_pk_bf16_f32 v225, v152, v156
    v_cvt_pk_bf16_f32 v226, v160, v164
    v_cvt_pk_bf16_f32 v227, v168, v172
    ds_write_b128 v234, v[224:227] offset:10240
    v_cvt_pk_bf16_f32 v228, v145, v149
    v_cvt_pk_bf16_f32 v229, v153, v157
    v_cvt_pk_bf16_f32 v230, v161, v165
    v_cvt_pk_bf16_f32 v231, v169, v173
    ds_write_b128 v235, v[228:231] offset:10240
    v_pk_mul_f32 v[146:147], v[146:147], v[186:187]
    v_pk_mul_f32 v[150:151], v[150:151], v[186:187]
    v_pk_mul_f32 v[154:155], v[154:155], v[186:187]
    v_pk_mul_f32 v[158:159], v[158:159], v[186:187]
    v_pk_mul_f32 v[162:163], v[162:163], v[186:187]
    v_pk_mul_f32 v[166:167], v[166:167], v[186:187]
    v_pk_mul_f32 v[170:171], v[170:171], v[186:187]
    v_pk_mul_f32 v[174:175], v[174:175], v[186:187]
    v_cvt_pk_bf16_f32 v224, v146, v150
    v_cvt_pk_bf16_f32 v225, v154, v158
    v_cvt_pk_bf16_f32 v226, v162, v166
    v_cvt_pk_bf16_f32 v227, v170, v174
    ds_write_b128 v234, v[224:227] offset:10368
    v_cvt_pk_bf16_f32 v228, v147, v151
    v_cvt_pk_bf16_f32 v229, v155, v159
    v_cvt_pk_bf16_f32 v230, v163, v167
    v_cvt_pk_bf16_f32 v231, v171, v175
    ds_write_b128 v235, v[228:231] offset:10368
    s_branch L_conv0
L_prb0:
    v_lshrrev_b32 v131, 4, v129
    v_add_u32 v131, 96, v131
    v_mul_u32_u24 v130, 205, v131
    v_mul_u32_u24 v131, 192, v131
    v_add_u32 v131, s64, v131
    v_lshlrev_b32 v133, 2, v129
    v_and_b32 v133, 63, v133
    v_lshrrev_b32 v134, 11, v130
    v_subrev_u32 v135, s65, v130
    v_mad_u32_u24 v134, v134, s68, v131
    v_and_b32 v135, 0x7ff, v135
    v_cmp_gt_u32 vcc, s66, v135
    v_lshrrev_b32 v135, 7, v130
    v_and_b32 v135, 32, v135
    v_xad_u32 v134, v133, v135, v134
    v_cndmask_b32 v7, v136, v134, vcc
    s_add_u32 m0, s56, 6144
    s_nop 0
    buffer_load_dword v7, s[20:23], 0 offen offset:0 lds
    v_lshrrev_b32 v131, 2, v129
    v_mul_u32_u24 v130, 205, v131
    v_mul_u32_u24 v131, 192, v131
    v_add_u32 v131, s64, v131
    v_lshrrev_b32 v134, 11, v130
    v_subrev_u32 v135, s65, v130
    v_mad_u32_u24 v134, v134, s68, v131
    v_and_b32 v135, 0x7ff, v135
    v_cmp_gt_u32 vcc, s66, v135
    v_lshrrev_b32 v135, 7, v130
    v_and_b32 v135, 32, v135
    v_xad_u32 v134, v132, v135, v134
    v_cndmask_b32 v1, v136, v134, vcc
    v_add_u32 v130, 3280, v130
    v_add_u32 v131, 3072, v131
    v_lshrrev_b32 v134, 11, v130
    v_subrev_u32 v135, s65, v130
    v_mad_u32_u24 v134, v134, s68, v131
    v_and_b32 v135, 0x7ff, v135
    v_cmp_gt_u32 vcc, s66, v135
    v_lshrrev_b32 v135, 7, v130
    v_and_b32 v135, 32, v135
    v_xad_u32 v134, v132, v135, v134
    v_cndmask_b32 v2, v136, v134, vcc
    v_add_u32 v130, 3280, v130
    v_add_u32 v131, 3072, v131
    v_lshrrev_b32 v134, 11, v130
    v_subrev_u32 v135, s65, v130
    v_mad_u32_u24 v134, v134, s68, v131
    v_and_b32 v135, 0x7ff, v135
    v_cmp_gt_u32 vcc, s66, v135
    v_lshrrev_b32 v135, 7, v130
    v_and_b32 v135, 32, v135
    v_xad_u32 v134, v132, v135, v134
    v_cndmask_b32 v3, v136, v134, vcc
    v_add_u32 v130, 3280, v130
    v_add_u32 v131, 3072, v131
    v_lshrrev_b32 v134, 11, v130
    v_subrev_u32 v135, s65, v130
    v_mad_u32_u24 v134, v134, s68, v131
    v_and_b32 v135, 0x7ff, v135
    v_cmp_gt_u32 vcc, s66, v135
    v_lshrrev_b32 v135, 7, v130
    v_and_b32 v135, 32, v135
    v_xad_u32 v134, v132, v135, v134
    v_cndmask_b32 v4, v136, v134, vcc
    v_add_u32 v130, 3280, v130
    v_add_u32 v131, 3072, v131
    v_lshrrev_b32 v134, 11, v130
    v_subrev_u32 v135, s65, v130
    v_mad_u32_u24 v134, v134, s68, v131
    v_and_b32 v135, 0x7ff, v135
    v_cmp_gt_u32 vcc, s66, v135
    v_lshrrev_b32 v135, 7, v130
    v_and_b32 v135, 32, v135
    v_xad_u32 v134, v132, v135, v134
    v_cndmask_b32 v5, v136, v134, vcc
    v_add_u32 v130, 3280, v130
    v_add_u32 v131, 3072, v131
    v_lshrrev_b32 v134, 11, v130
    v_subrev_u32 v135, s65, v130
    v_mad_u32_u24 v134, v134, s68, v131
    v_and_b32 v135, 0x7ff, v135
    v_cmp_gt_u32 vcc, s66, v135
    v_lshrrev_b32 v135, 7, v130
    v_and_b32 v135, 32, v135
    v_xad_u32 v134, v132, v135, v134
    v_cndmask_b32 v6, v136, v134, vcc
    s_cmp_lt_u32 s55, 63
    s_cselect_b32 s66, 10, 0
    s_add_u32 s64, s64, 1856
    v_mul_u32_u24 v134, 98304, v129
    v_add_u32 v134, s64, v134
    v_cmp_gt_u32 vcc, s66, v129
    s_nop 1
    v_cndmask_b32 v31, v136, v134, vcc
    v_mov_b32 v157, 268435456
    v_and_b32 v152, 15, v129
    v_lshrrev_b32 v153, 4, v129
    v_add_u32 v154, 4, v152
    v_lshrrev_b32 v154, 3, v154
    v_mad_i32_i24 v155, v154, -4, v152
    v_and_b32 v154, 1, v154
    v_and_b32 v156, 1, v153
    v_lshlrev_b32 v158, 1, v154
    v_mul_u32_u24 v159, 98304, v158
    v_mad_u32_u24 v159, v155, s69, v159
    v_lshl_add_u32 v159, v153, 4, v159
    v_add_u32 v26, s63, v159
    v_xor_b32 v26, 0x80000000, v26
    s_mov_b32 s54, 2147483648
    v_xor_b32 v161, v154, v138
    v_add_u32 v159, v153, v158
    v_add_u32 v160, 0, v155
    v_mad_u32_u24 v159, v159, 10, v160
    v_bfe_u32 v160, v159, 2, 1
    v_lshl_or_b32 v160, v161, 1, v160
    v_lshl_add_u32 v160, v159, 2, v160
    v_lshl_add_u32 v8, v160, 4, s56
    v_add_u32 v162, 1, v156
    v_add_u32 v159, v138, v158
    v_add_u32 v160, v162, v155
    v_mad_u32_u24 v159, v159, 10, v160
    v_bfe_u32 v160, v159, 2, 1
    v_lshl_or_b32 v160, v154, 1, v160
    v_lshl_add_u32 v160, v159, 2, v160
    v_lshl_add_u32 v12, v160, 4, s56
    v_xor_b32 v9, 16, v8
    v_xor_b32 v10, 32, v8
    v_xor_b32 v11, 48, v8
    v_xor_b32 v13, 16, v12
    v_xor_b32 v14, 32, v12
    v_xor_b32 v15, 48, v12
    v_add_u32 v159, 1, v158
    v_add_u32 v160, 1, v155
    v_mad_u32_u24 v159, v159, 10, v160
    v_bfe_u32 v160, v159, 2, 1
    v_lshl_or_b32 v160, v154, 1, v160
    v_xor_b32 v160, v153, v160
    v_lshl_add_u32 v160, v159, 2, v160
    v_lshl_add_u32 v20, v160, 4, s56
    v_xor_b32 v161, 1, v154
    v_add_u32 v159, 2, v158
    v_add_u32 v160, 1, v155
    v_mad_u32_u24 v159, v159, 10, v160
    v_bfe_u32 v160, v159, 2, 1
    v_lshl_or_b32 v160, v161, 1, v160
    v_xor_b32 v160, v153, v160
    v_lshl_add_u32 v160, v159, 2, v160
    v_lshl_add_u32 v21, v160, 4, s56
    v_bfe_u32 v158, v152, 2, 1
    v_sub_u32 v158, v153, v158
    v_and_b32 v159, 3, v152
    v_mul_u32_u24 v16, 0x1111, v159
    v_lshrrev_b32 v160, 3, v152
    v_lshl_add_u32 v159, v160, 2, v159
    v_lshlrev_b32 v159, 5, v159
    v_add_u32 v159, 141312, v159
    s_movk_i32 s70, 3072
    v_cmp_gt_u32 vcc, 3, v158
    v_mad_u32_u24 v159, v158, s70, v159
    s_nop 0
    v_cndmask_b32 v22, v157, v159, vcc
    v_lshlrev_b32 v23, 4, v129
    v_add_u32 v24, 40960, v23
    v_lshlrev_b32 v25, 5, v153
    v_add_u32 v25, 150528, v25
    v_and_b32 v160, 1, v129
    v_lshlrev_b32 v160, 4, v160
    v_mov_b32 v161, 0x3f80
    v_lshlrev_b32 v160, v160, v161
    v_bfe_u32 v158, v129, 1, 1
    v_bfe_u32 v159, v129, 3, 2
    v_lshl_add_u32 v159, v159, 1, v158
    v_bfe_u32 v161, v129, 2, 1
    v_xor_b32 v161, v161, v138
    v_lshl_add_u32 v159, v161, 3, v159
    v_lshlrev_b32 v159, v159, 1
    v_lshrrev_b32 v161, 2, v152
    v_xor_b32 v161, v161, v153
    v_lshl_add_u32 v158, v161, 1, v158
    v_lshlrev_b32 v158, v158, 1
    v_bfe_i32 v240, v159, 0, 1
    v_bfe_i32 v241, v159, 1, 1
    v_bfe_i32 v242, v159, 2, 1
    v_bfe_i32 v243, v159, 3, 1
    v_bfe_i32 v244, v159, 4, 1
    v_bfe_i32 v245, v159, 5, 1
    v_bfe_i32 v246, v159, 6, 1
    v_bfe_i32 v247, v159, 7, 1
    v_bfe_i32 v18, v158, 0, 1
    v_bfe_i32 v19, v158, 1, 1
    v_and_b32 v240, v160, v240
    v_and_b32 v241, v160, v241
    v_and_b32 v242, v160, v242
    v_and_b32 v243, v160, v243
    v_and_b32 v244, v160, v244
    v_and_b32 v245, v160, v245
    v_and_b32 v246, v160, v246
    v_and_b32 v247, v160, v247
    v_and_b32 v18, v160, v18
    v_and_b32 v19, v160, v19
    s_mov_b32 s24, s18
    s_mov_b32 s25, s19
    s_mov_b32 s26, 50331648
    s_mov_b32 s27, 0x20000
    s_mov_b32 s52, 0
    s_mov_b32 s80, 0
    s_mov_b32 s81, 98304
    s_mov_b32 s82, 393216
    s_mov_b32 s83, 491520
    s_mov_b32 s53, 1156138217
    s_mov_b32 s58, 0x3c003c00
    s_mov_b32 s85, 150912
    s_mov_b32 s86, 0x37803780
    s_mov_b32 s87, 0xffffffff
    s_mov_b32 s84, 0x37800000
    v_lshrrev_b32 v158, 2, v152
    v_xor_b32 v158, v158, v153
    v_bfe_i32 v158, v158, 0, 1
    v_bfi_b32 v158, v158, 0, s58
    v_accvgpr_write_b32 a228, v158
    v_accvgpr_write_b32 a229, v158
    v_accvgpr_write_b32 a230, v158
    v_accvgpr_write_b32 a231, v158
    v_and_b32 v17, v138, v153
    v_lshlrev_b32 v17, 4, v17
    v_lshrrev_b32 v17, v17, -1
    s_mov_b32 s73, 0x409d2a01
    s_mov_b32 s59, 0x3ef00000
    v_mul_u32_u24 v252, 0x100010, v0
    v_add_u32 v252, 0xc0004, v252
    v_lshlrev_b32 v253, 2, v0
    v_add_u32 v253, 150912, v253
    v_add_u32 v160, 0x0, v252
    v_add_u32 v168, 0x10001000, v252
    v_cvt_f32_f16 v161, v160
    v_cvt_f32_f16 v169, v168
    v_cvt_f32_f16_sdwa v162, v160 dst_sel:DWORD dst_unused:UNUSED_PAD src0_sel:WORD_1
    v_cvt_f32_f16_sdwa v170, v168 dst_sel:DWORD dst_unused:UNUSED_PAD src0_sel:WORD_1
    v_mul_f32 v163, 0x3f7fdde7, v161
    v_mul_f32 v171, 0x3f7fdde7, v169
    v_mul_f32 v164, 0x3f7fdde7, v162
    v_mul_f32 v172, 0x3f7fdde7, v170
    v_fma_f32 v163, v163, v161, s73
    v_fma_f32 v171, v171, v169, s73
    v_fma_f32 v164, v164, v162, s73
    v_fma_f32 v172, v172, v170, s73
    v_mul_f32 v163, -v161, v163
    v_mul_f32 v171, -v169, v171
    v_mul_f32 v164, -v162, v164
    v_mul_f32 v172, -v170, v172
    v_exp_f32 v165, v163
    v_exp_f32 v173, v171
    v_exp_f32 v166, v164
    v_exp_f32 v174, v172
    v_fma_f32 v163, v165, s59, s59
    v_fma_f32 v171, v173, s59, s59
    v_fma_f32 v164, v166, s59, s59
    v_fma_f32 v172, v174, s59, s59
    v_rcp_f32 v163, v163
    v_rcp_f32 v171, v171
    v_rcp_f32 v164, v164
    v_rcp_f32 v172, v172
    v_mul_f32 v163, v161, v163
    v_mul_f32 v171, v169, v171
    v_mul_f32 v164, v162, v164
    v_mul_f32 v172, v170, v172
    v_mul_f32 v165, -v165, v163
    v_mul_f32 v173, -v173, v171
    v_mul_f32 v166, -v166, v164
    v_mul_f32 v174, -v174, v172
    v_cvt_pk_bf16_f32 v167, v165, v166
    v_cvt_pk_bf16_f32 v175, v173, v174
    v_cvt_pk_bf16_f32 v160, v163, v164
    v_cvt_pk_bf16_f32 v168, v171, v172
    ds_write_b32 v253, v167 offset:8192
    ds_write_b32 v253, v160 offset:0
    ds_write_b32 v253, v175 offset:9216
    ds_write_b32 v253, v168 offset:1024
    v_add_u32 v160, 0x20002000, v252
    s_nop 0
    v_add_u32 v168, 0x30003000, v252
    v_cvt_f32_f16 v161, v160
    v_cvt_f32_f16 v169, v168
    v_cvt_f32_f16_sdwa v162, v160 dst_sel:DWORD dst_unused:UNUSED_PAD src0_sel:WORD_1
    v_cvt_f32_f16_sdwa v170, v168 dst_sel:DWORD dst_unused:UNUSED_PAD src0_sel:WORD_1
    v_mul_f32 v163, 0x3f7fdde7, v161
    v_mul_f32 v171, 0x3f7fdde7, v169
    v_mul_f32 v164, 0x3f7fdde7, v162
    v_mul_f32 v172, 0x3f7fdde7, v170
    v_fma_f32 v163, v163, v161, s73
    v_fma_f32 v171, v171, v169, s73
    v_fma_f32 v164, v164, v162, s73
    v_fma_f32 v172, v172, v170, s73
    v_mul_f32 v163, -v161, v163
    v_mul_f32 v171, -v169, v171
    v_mul_f32 v164, -v162, v164
    v_mul_f32 v172, -v170, v172
    v_exp_f32 v165, v163
    v_exp_f32 v173, v171
    v_exp_f32 v166, v164
    v_exp_f32 v174, v172
    v_fma_f32 v163, v165, s59, s59
    v_fma_f32 v171, v173, s59, s59
    v_fma_f32 v164, v166, s59, s59
    v_fma_f32 v172, v174, s59, s59
    v_rcp_f32 v163, v163
    v_rcp_f32 v171, v171
    v_rcp_f32 v164, v164
    v_rcp_f32 v172, v172
    v_mul_f32 v163, v161, v163
    v_mul_f32 v171, v169, v171
    v_mul_f32 v164, v162, v164
    v_mul_f32 v172, v170, v172
    v_mul_f32 v165, -v165, v163
    v_mul_f32 v173, -v173, v171
    v_mul_f32 v166, -v166, v164
    v_mul_f32 v174, -v174, v172
    v_cvt_pk_bf16_f32 v167, v165, v166
    v_cvt_pk_bf16_f32 v175, v173, v174
    v_cvt_pk_bf16_f32 v160, v163, v164
    v_cvt_pk_bf16_f32 v168, v171, v172
    ds_write_b32 v253, v167 offset:10240
    ds_write_b32 v253, v160 offset:2048
    ds_write_b32 v253, v175 offset:11264
    ds_write_b32 v253, v168 offset:3072
    v_add_u32 v160, 0x40004000, v252
    s_nop 0
    v_add_u32 v168, 0x50005000, v252
    v_cvt_f32_f16 v161, v160
    v_cvt_f32_f16 v169, v168
    v_cvt_f32_f16_sdwa v162, v160 dst_sel:DWORD dst_unused:UNUSED_PAD src0_sel:WORD_1
    v_cvt_f32_f16_sdwa v170, v168 dst_sel:DWORD dst_unused:UNUSED_PAD src0_sel:WORD_1
    v_mul_f32 v163, 0x3f7fdde7, v161
    v_mul_f32 v171, 0x40088889, v169
    v_mul_f32 v164, 0x3f7fdde7, v162
    v_mul_f32 v172, 0x40088889, v170
    v_fma_f32 v163, v163, v161, s73
    v_cvt_pk_bf16_f32 v168, v171, v172
    v_fma_f32 v164, v164, v162, s73
    v_mul_f32 v163, -v161, v163
    v_mul_f32 v164, -v162, v164
    v_exp_f32 v165, v163
    v_exp_f32 v166, v164
    v_fma_f32 v163, v165, s59, s59
    v_fma_f32 v164, v166, s59, s59
    v_rcp_f32 v163, v163
    v_rcp_f32 v164, v164
    v_mul_f32 v163, v161, v163
    v_mul_f32 v164, v162, v164
    v_mul_f32 v165, -v165, v163
    v_mul_f32 v166, -v166, v164
    v_cvt_pk_bf16_f32 v167, v165, v166
    v_cvt_pk_bf16_f32 v160, v163, v164
    ds_write_b32 v253, v167 offset:12288
    ds_write_b32 v253, v160 offset:4096
    ds_write_b32 v253, v168 offset:5120
    s_nop 0
    v_add_u32 v160, 0x60006000, v252
    v_add_u32 v168, 0x70007000, v252
    v_cvt_f32_f16 v161, v160
    v_cvt_f32_f16 v169, v168
    v_cvt_f32_f16_sdwa v162, v160 dst_sel:DWORD dst_unused:UNUSED_PAD src0_sel:WORD_1
    v_cvt_f32_f16_sdwa v170, v168 dst_sel:DWORD dst_unused:UNUSED_PAD src0_sel:WORD_1
    v_mul_f32 v163, 0x40088889, v161
    v_mul_f32 v171, 0x40088889, v169
    v_mul_f32 v164, 0x40088889, v162
    v_mul_f32 v172, 0x40088889, v170
    v_cvt_pk_bf16_f32 v160, v163, v164
    v_cvt_pk_bf16_f32 v168, v171, v172
    ds_write_b32 v253, v160 offset:6144
    ds_write_b32 v253, v168 offset:7168
    v_lshlrev_b32 v158, 6, v0
    v_add_u32 v158, 141312, v158
    v_cmp_gt_u32 vcc, 144, v0
    s_nop 1
    v_cndmask_b32 v158, v157, v158, vcc
    v_and_b32 v159, 3, v0
    v_lshl_add_u32 v160, v159, 2, v158
    v_lshrrev_b32 v159, 1, v159
    v_lshl_add_u32 v159, v159, 2, v158
    v_lshlrev_b32 v161, 4, v0
    v_add_u32 v161, 150528, v161
    v_cmp_gt_u32 vcc, 24, v0
    s_nop 1
    v_cndmask_b32 v161, v157, v161, vcc
    v_mov_b32 v164, 0
    v_mov_b32 v165, 0
    v_mov_b32 v166, 0
    v_mov_b32 v167, 0
    ds_write_b128 v158, v[164:167]
    ds_write_b128 v158, v[164:167] offset:16
    s_waitcnt lgkmcnt(9)
    ds_write_b128 v158, v[164:167] offset:32
    ds_write_b128 v158, v[164:167] offset:48
    s_waitcnt vmcnt(17)
    ds_write_b16 v160, v144
    ds_write_b16_d16_hi v160, v144 offset:34
    s_waitcnt vmcnt(16)
    ds_write_b16 v159, v145 offset:16
    ds_write_b16_d16_hi v159, v145 offset:48
    s_waitcnt vmcnt(15) lgkmcnt(13)
    ds_write_b16 v159, v146 offset:24
    ds_write_b16_d16_hi v159, v146 offset:56
    s_waitcnt vmcnt(14)
    v_lshlrev_b32 v168, 16, v148
    v_and_b32 v169, 0xffff0000, v148
    v_lshlrev_b32 v170, 16, v149
    v_and_b32 v171, 0xffff0000, v149
    s_waitcnt vmcnt(13)
    v_lshlrev_b32 v172, 16, v150
    v_and_b32 v173, 0xffff0000, v150
    v_lshlrev_b32 v174, 16, v151
    v_and_b32 v175, 0xffff0000, v151
    v_mul_f32 v168, v168, v172
    v_mul_f32 v169, v169, v173
    v_mul_f32 v170, v170, v174
    v_mul_f32 v171, v171, v175
    s_waitcnt lgkmcnt(14)
    ds_write_b128 v161, v[168:171]
    s_waitcnt vmcnt(12)
    v_xor_b32 v176, 0x80008000, v176
    v_xor_b32 v177, 0x80008000, v177
    v_xor_b32 v178, 0x80008000, v178
    v_xor_b32 v179, 0x80008000, v179
    s_nop 1
    v_mfma_f32_32x32x16_bf16 v[208:223], v[176:179], v[240:243], 0
    v_mfma_f32_32x32x16_bf16 v[208:223], v[176:179], v[244:247], v[208:223]
    s_waitcnt vmcnt(10)
    v_xor_b32 v180, 0x80008000, v180
    v_xor_b32 v181, 0x80008000, v181
    v_xor_b32 v182, 0x80008000, v182
    v_xor_b32 v183, 0x80008000, v183
    s_nop 1
    v_mfma_f32_32x32x16_bf16 v[192:207], v[180:183], v[240:243], 0
    v_mfma_f32_32x32x16_bf16 v[192:207], v[180:183], v[244:247], v[192:207]
    s_mov_b32 s74, 0
    s_mov_b32 s75, 12288
    buffer_load_dwordx4 a[0:3], v232, s[44:47], s74 offen offset:0
    buffer_load_dwordx4 a[4:7], v232, s[44:47], s75 offen offset:0
    buffer_load_dwordx4 a[8:11], v233, s[44:47], s74 offen offset:0
    buffer_load_dwordx4 a[12:15], v233, s[44:47], s75 offen offset:0
    s_mov_b32 s74, 24576
    s_mov_b32 s75, 36864
    buffer_load_dwordx4 a[16:19], v232, s[44:47], s74 offen offset:0
    buffer_load_dwordx4 a[20:23], v232, s[44:47], s75 offen offset:0
    buffer_load_dwordx4 a[24:27], v233, s[44:47], s74 offen offset:0
    buffer_load_dwordx4 a[28:31], v233, s[44:47], s75 offen offset:0
    s_mov_b32 s74, 49152
    s_mov_b32 s75, 61440
    buffer_load_dwordx4 a[32:35], v232, s[44:47], s74 offen offset:0
    buffer_load_dwordx4 a[36:39], v232, s[44:47], s75 offen offset:0
    buffer_load_dwordx4 a[40:43], v233, s[44:47], s74 offen offset:0
    buffer_load_dwordx4 a[44:47], v233, s[44:47], s75 offen offset:0
    s_mov_b32 s74, 0
    s_mov_b32 s75, 12288
    buffer_load_dwordx4 a[48:51], v232, s[44:47], s74 offen offset:256
    buffer_load_dwordx4 a[52:55], v232, s[44:47], s75 offen offset:256
    buffer_load_dwordx4 a[56:59], v233, s[44:47], s74 offen offset:256
    buffer_load_dwordx4 a[60:63], v233, s[44:47], s75 offen offset:256
    s_mov_b32 s74, 24576
    s_mov_b32 s75, 36864
    buffer_load_dwordx4 a[64:67], v232, s[44:47], s74 offen offset:256
    buffer_load_dwordx4 a[68:71], v232, s[44:47], s75 offen offset:256
    buffer_load_dwordx4 a[72:75], v233, s[44:47], s74 offen offset:256
    buffer_load_dwordx4 a[76:79], v233, s[44:47], s75 offen offset:256
    s_mov_b32 s74, 49152
    s_mov_b32 s75, 61440
    buffer_load_dwordx4 a[80:83], v232, s[44:47], s74 offen offset:256
    buffer_load_dwordx4 a[84:87], v232, s[44:47], s75 offen offset:256
    buffer_load_dwordx4 a[88:91], v233, s[44:47], s74 offen offset:256
    buffer_load_dwordx4 a[92:95], v233, s[44:47], s75 offen offset:256
    s_waitcnt vmcnt(23)
    v_mfma_f32_32x32x16_bf16 v[80:95], a[0:3], v[240:243], v[208:223]
    s_waitcnt vmcnt(21)
    v_mfma_f32_32x32x16_bf16 v[96:111], a[8:11], v[240:243], v[208:223]
    v_mfma_f32_32x32x16_bf16 v[80:95], a[4:7], v[244:247], v[80:95]
    s_waitcnt vmcnt(20)
    v_mfma_f32_32x32x16_bf16 v[96:111], a[12:15], v[244:247], v[96:111]
    s_waitcnt vmcnt(19)
    v_mfma_f32_32x32x16_bf16 v[112:127], a[16:19], v[240:243], v[208:223]
    s_waitcnt vmcnt(17)
    v_mfma_f32_32x32x16_bf16 v[128:143], a[24:27], v[240:243], v[208:223]
    v_mfma_f32_32x32x16_bf16 v[112:127], a[20:23], v[244:247], v[112:127]
    s_waitcnt vmcnt(16)
    v_mfma_f32_32x32x16_bf16 v[128:143], a[28:31], v[244:247], v[128:143]
    s_nop 2
    v_cvt_pk_f16_f32 v224, v80, v84
    v_cvt_pk_f16_f32 v225, v88, v92
    v_cvt_pk_f16_f32 v226, v96, v100
    v_cvt_pk_f16_f32 v227, v104, v108
    s_waitcnt vmcnt(15)
    v_mfma_f32_32x32x16_bf16 v[144:159], a[32:35], v[240:243], v[208:223]
    s_waitcnt lgkmcnt(14)
    ds_write_b128 v234, v[224:227] offset:0
    s_mov_b32 s74, 0
    v_cvt_pk_f16_f32 v228, v81, v85
    v_cvt_pk_f16_f32 v229, v89, v93
    v_cvt_pk_f16_f32 v230, v97, v101
    v_cvt_pk_f16_f32 v231, v105, v109
    s_waitcnt vmcnt(13)
    v_mfma_f32_32x32x16_bf16 v[160:175], a[40:43], v[240:243], v[208:223]
    s_waitcnt lgkmcnt(14)
    ds_write_b128 v234, v[228:231] offset:1024
    s_mov_b32 s75, 12288
    buffer_load_dwordx4 v[32:35], v232, s[44:47], s74 offen offset:512
    v_cvt_pk_f16_f32 v224, v82, v86
    v_cvt_pk_f16_f32 v225, v90, v94
    v_cvt_pk_f16_f32 v226, v98, v102
    v_cvt_pk_f16_f32 v227, v106, v110
    v_mfma_f32_32x32x16_bf16 v[144:159], a[36:39], v[244:247], v[144:159]
    s_waitcnt lgkmcnt(14)
    ds_write_b128 v234, v[224:227] offset:12288
    buffer_load_dwordx4 v[36:39], v232, s[44:47], s75 offen offset:512
    v_cvt_pk_f16_f32 v228, v83, v87
    v_cvt_pk_f16_f32 v229, v91, v95
    v_cvt_pk_f16_f32 v230, v99, v103
    v_cvt_pk_f16_f32 v231, v107, v111
    s_waitcnt vmcnt(14)
    v_mfma_f32_32x32x16_bf16 v[160:175], a[44:47], v[244:247], v[160:175]
    s_waitcnt vmcnt(10)
    s_waitcnt lgkmcnt(14)
    ds_write_b128 v234, v[228:231] offset:13312
    buffer_load_dwordx4 v[40:43], v233, s[44:47], s74 offen offset:512
    buffer_load_dwordx4 v[44:47], v233, s[44:47], s75 offen offset:512
    v_mfma_f32_32x32x16_bf16 v[160:175], a[232:235], v[244:247], v[160:175]
    v_cvt_pk_f16_f32 v224, v112, v116
    v_cvt_pk_f16_f32 v225, v120, v124
    v_cvt_pk_f16_f32 v226, v128, v132
    v_cvt_pk_f16_f32 v227, v136, v140
    v_mfma_f32_32x32x16_bf16 v[80:95], a[48:51], v[240:243], v[192:207]
    s_waitcnt lgkmcnt(14)
    ds_write_b128 v234, v[224:227] offset:2048
    s_mov_b32 s74, 24576
    v_cvt_pk_f16_f32 v228, v113, v117
    v_cvt_pk_f16_f32 v229, v121, v125
    v_cvt_pk_f16_f32 v230, v129, v133
    v_cvt_pk_f16_f32 v231, v137, v141
    v_mfma_f32_32x32x16_bf16 v[96:111], a[56:59], v[240:243], v[192:207]
    s_waitcnt lgkmcnt(14)
    ds_write_b128 v234, v[228:231] offset:3072
    s_mov_b32 s75, 36864
    buffer_load_dwordx4 v[48:51], v232, s[44:47], s74 offen offset:512
    v_cvt_pk_f16_f32 v224, v114, v118
    v_cvt_pk_f16_f32 v225, v122, v126
    v_cvt_pk_f16_f32 v226, v130, v134
    v_cvt_pk_f16_f32 v227, v138, v142
    v_mfma_f32_32x32x16_bf16 v[80:95], a[52:55], v[244:247], v[80:95]
    s_waitcnt lgkmcnt(14)
    ds_write_b128 v234, v[224:227] offset:14336
    buffer_load_dwordx4 v[52:55], v232, s[44:47], s75 offen offset:512
    v_cvt_pk_f16_f32 v228, v115, v119
    v_cvt_pk_f16_f32 v229, v123, v127
    v_cvt_pk_f16_f32 v230, v131, v135
    v_cvt_pk_f16_f32 v231, v139, v143
    v_mfma_f32_32x32x16_bf16 v[96:111], a[60:63], v[244:247], v[96:111]
    s_waitcnt vmcnt(10)
    s_waitcnt lgkmcnt(14)
    ds_write_b128 v234, v[228:231] offset:15360
    buffer_load_dwordx4 v[56:59], v233, s[44:47], s74 offen offset:512
    buffer_load_dwordx4 v[60:63], v233, s[44:47], s75 offen offset:512
    v_xor_b32 v184, 0x80008000, v184
    v_xor_b32 v185, 0x80008000, v185
    v_xor_b32 v186, 0x80008000, v186
    v_xor_b32 v187, 0x80008000, v187
    v_cvt_pk_f16_f32 v224, v144, v148
    v_cvt_pk_f16_f32 v225, v152, v156
    v_cvt_pk_f16_f32 v226, v160, v164
    v_cvt_pk_f16_f32 v227, v168, v172
    v_mfma_f32_32x32x16_bf16 v[112:127], a[64:67], v[240:243], v[192:207]
    s_waitcnt lgkmcnt(14)
    ds_write_b128 v234, v[224:227] offset:4096
    s_mov_b32 s74, 49152
    v_cvt_pk_f16_f32 v228, v145, v149
    v_cvt_pk_f16_f32 v229, v153, v157
    v_cvt_pk_f16_f32 v230, v161, v165
    v_cvt_pk_f16_f32 v231, v169, v173
    v_mfma_f32_32x32x16_bf16 v[128:143], a[72:75], v[240:243], v[192:207]
    s_waitcnt lgkmcnt(14)
    ds_write_b128 v234, v[228:231] offset:5120
    s_mov_b32 s75, 61440
    buffer_load_dwordx4 v[64:67], v232, s[44:47], s74 offen offset:512
    v_cvt_pk_f16_f32 v224, v146, v150
    v_cvt_pk_f16_f32 v225, v154, v158
    v_cvt_pk_f16_f32 v226, v162, v166
    v_cvt_pk_f16_f32 v227, v170, v174
    v_mfma_f32_32x32x16_bf16 v[112:127], a[68:71], v[244:247], v[112:127]
    s_waitcnt lgkmcnt(14)
    ds_write_b128 v234, v[224:227] offset:16384
    buffer_load_dwordx4 v[68:71], v232, s[44:47], s75 offen offset:512
    v_cvt_pk_f16_f32 v228, v147, v151
    v_cvt_pk_f16_f32 v229, v155, v159
    v_cvt_pk_f16_f32 v230, v163, v167
    v_cvt_pk_f16_f32 v231, v171, v175
    v_mfma_f32_32x32x16_bf16 v[128:143], a[76:79], v[244:247], v[128:143]
    s_waitcnt vmcnt(10)
    s_waitcnt lgkmcnt(14)
    ds_write_b128 v234, v[228:231] offset:17408
    buffer_load_dwordx4 v[72:75], v233, s[44:47], s74 offen offset:512
    buffer_load_dwordx4 v[76:79], v233, s[44:47], s75 offen offset:512
    v_sub_u32 v234, v234, v238
    v_mfma_f32_32x32x16_bf16 v[208:223], v[184:187], v[240:243], 0
    v_mfma_f32_32x32x16_bf16 v[208:223], v[184:187], v[244:247], v[208:223]
    v_cvt_pk_f16_f32 v224, v80, v84
    v_cvt_pk_f16_f32 v225, v88, v92
    v_cvt_pk_f16_f32 v226, v96, v100
    v_cvt_pk_f16_f32 v227, v104, v108
    v_mfma_f32_32x32x16_bf16 v[144:159], a[80:83], v[240:243], v[192:207]
    s_waitcnt lgkmcnt(0)
    s_barrier
    ds_write_b128 v234, v[224:227] offset:0
    ds_read_b128 a[192:195], v23 offset:4096
    ds_read_b128 a[196:199], v23 offset:5120
    ds_read_b128 a[200:203], v23 offset:14336
    ds_read_b128 a[204:207], v23 offset:15360
    ds_read_b128 a[208:211], v23 offset:24576
    ds_read_b128 a[212:215], v23 offset:25600
    ds_read_b128 a[216:219], v23 offset:34816
    s_add_u32 m0, s56, 6336
    s_nop 0
    buffer_load_dwordx4 v1, s[20:23], 0 offen offset:64 lds
    v_cvt_pk_f16_f32 v228, v81, v85
    v_cvt_pk_f16_f32 v229, v89, v93
    v_cvt_pk_f16_f32 v230, v97, v101
    v_cvt_pk_f16_f32 v231, v105, v109
    v_mfma_f32_32x32x16_bf16 v[160:175], a[88:91], v[240:243], v[192:207]
    ds_write_b128 v234, v[228:231] offset:1024
    ds_read_b128 a[220:223], v23 offset:35840
    ds_read_b128 a[0:3], v24 offset:0
    ds_read_b128 a[4:7], v24 offset:1024
    ds_read_b128 a[24:27], v24 offset:6144
    ds_read_b128 a[28:31], v24 offset:7168
    ds_read_b128 a[96:99], v24 offset:24576
    s_waitcnt lgkmcnt(14)
    ds_read_b128 a[100:103], v24 offset:25600
    s_add_u32 m0, s56, 7360
    s_nop 0
    buffer_load_dwordx4 v2, s[20:23], 0 offen offset:64 lds
    v_cvt_pk_f16_f32 v224, v82, v86
    v_cvt_pk_f16_f32 v225, v90, v94
    v_cvt_pk_f16_f32 v226, v98, v102
    v_cvt_pk_f16_f32 v227, v106, v110
    v_mfma_f32_32x32x16_bf16 v[144:159], a[84:87], v[244:247], v[144:159]
    s_waitcnt lgkmcnt(9)
    ds_write_b128 v234, v[224:227] offset:10240
    ds_read_b128 a[120:123], v24 offset:30720
    ds_read_b128 a[124:127], v24 offset:31744
    ds_read_b128 a[144:147], v24 offset:36864
    ds_read_b128 a[148:151], v24 offset:37888
    ds_read_b128 a[168:171], v24 offset:43008
    s_waitcnt lgkmcnt(13)
    ds_read_b128 a[172:175], v24 offset:44032
    ds_read_b128 a[48:51], v24 offset:12288
    s_add_u32 m0, s56, 8384
    s_nop 0
    buffer_load_dwordx4 v3, s[20:23], 0 offen offset:64 lds
    v_cvt_pk_f16_f32 v228, v83, v87
    v_cvt_pk_f16_f32 v229, v91, v95
    v_cvt_pk_f16_f32 v230, v99, v103
    v_cvt_pk_f16_f32 v231, v107, v111
    v_mfma_f32_32x32x16_bf16 v[160:175], a[92:95], v[244:247], v[160:175]
    s_waitcnt vmcnt(11)
    s_waitcnt lgkmcnt(9)
    ds_write_b128 v234, v[228:231] offset:11264
    ds_read_b128 a[52:55], v24 offset:13312
    ds_read_b128 a[72:75], v24 offset:18432
    ds_read_b128 a[76:79], v24 offset:19456
    ds_read_b128 a[8:11], v24 offset:2048
    ds_read_b128 a[12:15], v24 offset:3072
    s_waitcnt lgkmcnt(13)
    ds_read_b128 a[32:35], v24 offset:8192
    ds_read_b128 a[36:39], v24 offset:9216
    s_add_u32 m0, s56, 9408
    s_nop 0
    buffer_load_dwordx4 v4, s[20:23], 0 offen offset:64 lds
    v_mfma_f32_32x32x16_bf16 v[160:175], a[236:239], v[244:247], v[160:175]
    v_cvt_pk_f16_f32 v224, v112, v116
    v_cvt_pk_f16_f32 v225, v120, v124
    v_cvt_pk_f16_f32 v226, v128, v132
    v_cvt_pk_f16_f32 v227, v136, v140
    v_mfma_f32_32x32x16_bf16 v[80:95], v[32:35], v[240:243], v[208:223]
    s_waitcnt lgkmcnt(9)
    ds_write_b128 v234, v[224:227] offset:2048
    ds_read_b128 a[104:107], v24 offset:26624
    ds_read_b128 a[108:111], v24 offset:27648
    ds_read_b128 a[128:131], v24 offset:32768
    ds_read_b128 a[132:135], v24 offset:33792
    ds_read_b128 a[152:155], v24 offset:38912
    s_waitcnt lgkmcnt(13)
    ds_read_b128 a[156:159], v24 offset:39936
    ds_read_b128 a[176:179], v24 offset:45056
    s_add_u32 m0, s56, 10432
    v_cvt_pk_f16_f32 v228, v113, v117
    v_cvt_pk_f16_f32 v229, v121, v125
    v_cvt_pk_f16_f32 v230, v129, v133
    v_cvt_pk_f16_f32 v231, v137, v141
    v_mfma_f32_32x32x16_bf16 v[96:111], v[40:43], v[240:243], v[208:223]
    s_waitcnt lgkmcnt(9)
    ds_write_b128 v234, v[228:231] offset:3072
    ds_read_b128 a[180:183], v24 offset:46080
    ds_read_b128 a[56:59], v24 offset:14336
    ds_read_b128 a[60:63], v24 offset:15360
    ds_read_b128 a[80:83], v24 offset:20480
    ds_read_b128 a[84:87], v24 offset:21504
    s_waitcnt lgkmcnt(13)
    ds_read_b128 a[16:19], v24 offset:4096
    ds_read_b128 a[20:23], v24 offset:5120
    buffer_load_dwordx4 v5, s[20:23], 0 offen offset:64 lds
    s_add_u32 m0, s56, 11456
    v_cvt_pk_f16_f32 v224, v114, v118
    v_cvt_pk_f16_f32 v225, v122, v126
    v_cvt_pk_f16_f32 v226, v130, v134
    v_cvt_pk_f16_f32 v227, v138, v142
    v_mfma_f32_32x32x16_bf16 v[80:95], v[36:39], v[244:247], v[80:95]
    s_waitcnt lgkmcnt(9)
    ds_write_b128 v234, v[224:227] offset:12288
    ds_read_b128 a[40:43], v24 offset:10240
    ds_read_b128 a[44:47], v24 offset:11264
    ds_read_b128 a[112:115], v24 offset:28672
    ds_read_b128 a[116:119], v24 offset:29696
    ds_read_b128 a[136:139], v24 offset:34816
    s_waitcnt lgkmcnt(13)
    ds_read_b128 a[140:143], v24 offset:35840
    ds_read_b128 a[160:163], v24 offset:40960
    buffer_load_dwordx4 v6, s[20:23], 0 offen offset:64 lds
    s_add_u32 m0, s56, 12480
    v_cvt_pk_f16_f32 v228, v115, v119
    v_cvt_pk_f16_f32 v229, v123, v127
    v_cvt_pk_f16_f32 v230, v131, v135
    v_cvt_pk_f16_f32 v231, v139, v143
    v_mfma_f32_32x32x16_bf16 v[96:111], v[44:47], v[244:247], v[96:111]
    s_waitcnt vmcnt(10)
    s_waitcnt lgkmcnt(9)
    ds_write_b128 v234, v[228:231] offset:13312
    ds_read_b128 a[164:167], v24 offset:41984
    ds_read_b128 a[184:187], v24 offset:47104
    ds_read_b128 a[188:191], v24 offset:48128
    ds_read_b128 a[64:67], v24 offset:16384
    ds_read_b128 a[68:71], v24 offset:17408
    s_waitcnt lgkmcnt(13)
    ds_read_b128 a[88:91], v24 offset:22528
    ds_read_b128 a[92:95], v24 offset:23552
    buffer_load_dword v7, s[20:23], 0 offen offset:64 lds
    buffer_load_dword v254, v31, s[20:23], 0 offen
    v_cvt_pk_f16_f32 v224, v144, v148
    v_cvt_pk_f16_f32 v225, v152, v156
    v_cvt_pk_f16_f32 v226, v160, v164
    v_cvt_pk_f16_f32 v227, v168, v172
    v_mfma_f32_32x32x16_bf16 v[112:127], v[48:51], v[240:243], v[208:223]
    s_waitcnt lgkmcnt(0)
    s_barrier
    ds_write_b128 v234, v[224:227] offset:4096
    v_cvt_pk_f16_f32 v228, v145, v149
    v_cvt_pk_f16_f32 v229, v153, v157
    v_cvt_pk_f16_f32 v230, v161, v165
    v_cvt_pk_f16_f32 v231, v169, v173
    v_mfma_f32_32x32x16_bf16 v[128:143], v[56:59], v[240:243], v[208:223]
    ds_write_b128 v234, v[228:231] offset:5120
    v_cvt_pk_f16_f32 v224, v146, v150
    v_cvt_pk_f16_f32 v225, v154, v158
    v_cvt_pk_f16_f32 v226, v162, v166
    v_cvt_pk_f16_f32 v227, v170, v174
    v_mfma_f32_32x32x16_bf16 v[112:127], v[52:55], v[244:247], v[112:127]
    ds_write_b128 v234, v[224:227] offset:14336
    v_cvt_pk_f16_f32 v228, v147, v151
    v_cvt_pk_f16_f32 v229, v155, v159
    v_cvt_pk_f16_f32 v230, v163, v167
    v_cvt_pk_f16_f32 v231, v171, v175
    v_mfma_f32_32x32x16_bf16 v[128:143], v[60:63], v[244:247], v[128:143]
    s_waitcnt vmcnt(8)
    ds_write_b128 v234, v[228:231] offset:15360
    v_add_u32 v234, v234, v238
    v_cvt_pk_f16_f32 v224, v80, v84
    v_cvt_pk_f16_f32 v225, v88, v92
    v_cvt_pk_f16_f32 v226, v96, v100
    v_cvt_pk_f16_f32 v227, v104, v108
    v_mfma_f32_32x32x16_bf16 v[144:159], v[64:67], v[240:243], v[208:223]
    ds_write_b128 v234, v[224:227] offset:0
    v_cvt_pk_f16_f32 v228, v81, v85
    v_cvt_pk_f16_f32 v229, v89, v93
    v_cvt_pk_f16_f32 v230, v97, v101
    v_cvt_pk_f16_f32 v231, v105, v109
    v_mfma_f32_32x32x16_bf16 v[160:175], v[72:75], v[240:243], v[208:223]
    ds_write_b128 v234, v[228:231] offset:1024
    v_cvt_pk_f16_f32 v224, v82, v86
    v_cvt_pk_f16_f32 v225, v90, v94
    v_cvt_pk_f16_f32 v226, v98, v102
    v_cvt_pk_f16_f32 v227, v106, v110
    v_mfma_f32_32x32x16_bf16 v[144:159], v[68:71], v[244:247], v[144:159]
    ds_write_b128 v234, v[224:227] offset:12288
    v_cvt_pk_f16_f32 v228, v83, v87
    v_cvt_pk_f16_f32 v229, v91, v95
    v_cvt_pk_f16_f32 v230, v99, v103
    v_cvt_pk_f16_f32 v231, v107, v111
    v_mfma_f32_32x32x16_bf16 v[160:175], v[76:79], v[244:247], v[160:175]
    ds_write_b128 v234, v[228:231] offset:13312
    v_mfma_f32_32x32x16_bf16 v[160:175], a[240:243], v[244:247], v[160:175]
    v_cvt_pk_f16_f32 v224, v112, v116
    v_cvt_pk_f16_f32 v225, v120, v124
    v_cvt_pk_f16_f32 v226, v128, v132
    v_cvt_pk_f16_f32 v227, v136, v140
    ds_write_b128 v234, v[224:227] offset:2048
    v_cvt_pk_f16_f32 v228, v113, v117
    v_cvt_pk_f16_f32 v229, v121, v125
    v_cvt_pk_f16_f32 v230, v129, v133
    v_cvt_pk_f16_f32 v231, v137, v141
    ds_write_b128 v234, v[228:231] offset:3072
    v_cvt_pk_f16_f32 v224, v114, v118
    v_cvt_pk_f16_f32 v225, v122, v126
    v_cvt_pk_f16_f32 v226, v130, v134
    v_cvt_pk_f16_f32 v227, v138, v142
    ds_write_b128 v234, v[224:227] offset:14336
    v_cvt_pk_f16_f32 v228, v115, v119
    v_cvt_pk_f16_f32 v229, v123, v127
    v_cvt_pk_f16_f32 v230, v131, v135
    v_cvt_pk_f16_f32 v231, v139, v143
    ds_write_b128 v234, v[228:231] offset:15360
    v_cvt_pk_f16_f32 v224, v144, v148
    v_cvt_pk_f16_f32 v225, v152, v156
    v_cvt_pk_f16_f32 v226, v160, v164
    v_cvt_pk_f16_f32 v227, v168, v172
    ds_write_b128 v234, v[224:227] offset:4096
    v_cvt_pk_f16_f32 v228, v145, v149
    v_cvt_pk_f16_f32 v229, v153, v157
    v_cvt_pk_f16_f32 v230, v161, v165
    v_cvt_pk_f16_f32 v231, v169, v173
    ds_write_b128 v234, v[228:231] offset:5120
    v_cvt_pk_f16_f32 v224, v146, v150
    v_cvt_pk_f16_f32 v225, v154, v158
    v_cvt_pk_f16_f32 v226, v162, v166
    v_cvt_pk_f16_f32 v227, v170, v174
    ds_write_b128 v234, v[224:227] offset:16384
    v_cvt_pk_f16_f32 v228, v147, v151
    v_cvt_pk_f16_f32 v229, v155, v159
    v_cvt_pk_f16_f32 v230, v163, v167
    v_cvt_pk_f16_f32 v231, v171, v175
    s_waitcnt lgkmcnt(14)
    ds_write_b128 v234, v[228:231] offset:17408
L_conv0:
    s_waitcnt lgkmcnt(0)
    s_barrier
    ds_read_b128 a[232:235], v8 offset:0
    ds_read_b128 a[244:247], v8 offset:2560
    ds_read_b128 a[236:239], v12 offset:0
    ds_read_b128 a[248:251], v12 offset:2560
    ds_read_b128 a[240:243], v15 offset:1280
    ds_read_b128 a[252:255], v15 offset:3840
    ds_read_b128 v[176:179], v9 offset:0
    ds_read_b128 v[188:191], v9 offset:2560
    ds_read_b128 v[180:183], v13 offset:0
    ds_read_b128 v[232:235], v13 offset:2560
    ds_read_b128 v[184:187], v14 offset:1280
    ds_read_b128 v[236:239], v14 offset:3840
    ds_read_b128 v[32:35], v10 offset:0
    ds_read_b128 v[44:47], v10 offset:2560
    ds_read_b128 v[36:39], v14 offset:0
    s_waitcnt lgkmcnt(9)
    ds_read_b128 v[64:67], v14 offset:2560
    ds_read_b128 v[40:43], v13 offset:1280
    ds_read_b128 v[68:71], v13 offset:3840
    ds_read_b128 v[136:139], v11 offset:0
    ds_read_b128 v[148:151], v11 offset:2560
    ds_read_b128 v[140:143], v15 offset:0
    s_waitcnt lgkmcnt(9)
    ds_read_b128 v[72:75], v15 offset:2560
    ds_read_b128 v[144:147], v12 offset:1280
    ds_read_b128 v[76:79], v12 offset:3840
    ds_read_b128 v[56:59], v20 offset:2560
    ds_read_b128 v[60:63], v21 offset:2560
    ds_read_b128 v[52:55], v21 offset:0
    s_waitcnt lgkmcnt(13)
    ds_read_b128 v[48:51], v20 offset:0
    s_add_u32 m0, s56, -128
    ds_read_b128 v[192:195], v22 offset:0
    s_waitcnt lgkmcnt(1)
    buffer_load_dwordx4 v1, s[20:23], 0 offen offset:128 lds
    s_add_u32 m0, s56, 896
    ds_read_b128 v[200:203], v22 offset:16
    buffer_load_dwordx4 v2, s[20:23], 0 offen offset:128 lds
    s_add_u32 m0, s56, 1920
    ds_read_b128 v[196:199], v22 offset:256
    buffer_load_dwordx4 v3, s[20:23], 0 offen offset:128 lds
    s_add_u32 m0, s56, 2944
    ds_read_b128 v[204:207], v22 offset:272
    buffer_load_dwordx4 v4, s[20:23], 0 offen offset:128 lds
    s_add_u32 m0, s56, 3968
    s_nop 0
    buffer_load_dwordx4 v5, s[20:23], 0 offen offset:128 lds
    s_add_u32 m0, s56, 4992
    s_nop 0
    buffer_load_dwordx4 v6, s[20:23], 0 offen offset:128 lds
    s_add_u32 m0, s56, 6016
    s_nop 0
    buffer_load_dword v7, s[20:23], 0 offen offset:128 lds
    s_waitcnt vmcnt(7)
    s_branch L_conv
.p2alignl 12, 0xbf800000
.fill 648, 4, 0xbf800000
L_conv:
    v_cvt_pk_bf16_f32 v80, v80, v81
    v_cvt_pk_bf16_f32 v81, v82, v83
    v_cvt_pk_bf16_f32 v82, v84, v85
    s_waitcnt lgkmcnt(3)
    v_mfma_f32_16x16x32_bf16 v[128:131], v[192:195], a[232:235], 0
    ds_read_b128 a[232:235], v8 offset:6400
    v_cvt_pk_bf16_f32 v83, v86, v87
    v_cvt_pk_bf16_f32 v96, v96, v97
    v_mfma_f32_16x16x32_bf16 v[88:91], a[168:171], v[244:247], v[88:91]
    v_cvt_pk_bf16_f32 v97, v98, v99
    v_cvt_pk_bf16_f32 v98, v100, v101
    v_cvt_pk_bf16_f32 v99, v102, v103
    v_mfma_f32_16x16x32_bf16 v[152:155], v[192:195], a[244:247], 0
    ds_read_b128 a[244:247], v8 offset:8960
    ds_read_b128 v[192:195], v22 offset:512
    v_cvt_pk_bf16_f32 v112, v112, v113
    v_mfma_f32_16x16x32_bf16 v[92:95], a[172:175], v[244:247], v[92:95]
    s_waitcnt lgkmcnt(3)
    v_cvt_pk_bf16_f32 v88, v88, v89
    v_cvt_pk_bf16_f32 v89, v90, v91
    v_cvt_pk_bf16_f32 v113, v114, v115
    v_smfmac_f32_16x16x64_bf16 v[128:131], v[200:203], a[236:243], v16
    ds_read_b128 a[236:239], v12 offset:6400
    ds_read_b128 a[240:243], v15 offset:7680
    v_cvt_pk_bf16_f32 v114, v116, v117
    v_smfmac_f32_16x16x64_bf16 v[152:155], v[200:203], a[248:255], v16
    s_waitcnt lgkmcnt(6)
    ds_read_b128 a[248:251], v12 offset:8960
    ds_read_b128 a[252:255], v15 offset:10240
    ds_read_b128 v[200:203], v22 offset:528
    v_mfma_f32_16x16x32_bf16 v[224:227], v[196:199], v[176:179], 0
    ds_read_b128 v[176:179], v9 offset:6400
    v_cvt_pkrtz_f16_f32 v128, v128, v129
    v_cvt_pkrtz_f16_f32 v129, v130, v131
    v_mfma_f32_16x16x32_bf16 v[228:231], v[196:199], v[188:191], 0
    s_waitcnt lgkmcnt(9)
    ds_read_b128 v[188:191], v9 offset:8960
    ds_read_b128 v[196:199], v22 offset:768
    v_cvt_pkrtz_f16_f32 v152, v152, v153
    v_smfmac_f32_16x16x64_bf16 v[224:227], v[204:207], v[180:187], v16
    ds_read_b128 v[180:183], v13 offset:6400
    ds_read_b128 v[184:187], v14 offset:7680
    v_cvt_pkrtz_f16_f32 v153, v154, v155
    v_smfmac_f32_16x16x64_bf16 v[228:231], v[204:207], v[232:239], v16
    s_waitcnt lgkmcnt(10)
    ds_read_b128 v[232:235], v13 offset:8960
    ds_read_b128 v[236:239], v14 offset:10240
    ds_read_b128 v[204:207], v22 offset:784
    v_mfma_f32_16x16x32_bf16 v[132:135], v[192:195], v[32:35], 0
    v_cvt_pkrtz_f16_f32 v130, v224, v225
    v_cvt_pkrtz_f16_f32 v131, v226, v227
    v_cvt_pk_bf16_f32 v90, v92, v93
    v_mfma_f32_16x16x32_bf16 v[104:107], a[176:179], v[244:247], v[104:107]
    v_cvt_pkrtz_f16_f32 v154, v228, v229
    v_cvt_pkrtz_f16_f32 v155, v230, v231
    v_cvt_pk_bf16_f32 v91, v94, v95
    v_mfma_f32_16x16x32_bf16 v[156:159], v[192:195], v[44:47], 0
    ds_read_b128 v[192:195], v22 offset:1024
    v_cvt_pk_bf16_f32 v115, v118, v119
    v_mfma_f32_16x16x32_bf16 v[108:111], a[180:183], v[244:247], v[108:111]
    s_waitcnt lgkmcnt(9)
    ds_read_b128 v[32:35], v25 offset:0
    v_cvt_pk_bf16_f32 v104, v104, v105
    v_cvt_pk_bf16_f32 v105, v106, v107
    v_smfmac_f32_16x16x64_bf16 v[132:135], v[200:203], v[36:43], v16
    v_smfmac_f32_16x16x64_bf16 v[156:159], v[200:203], v[64:71], v16
    ds_read_b128 v[200:203], v22 offset:1040
    ds_read_b128 v[36:39], v25 offset:16
    v_mfma_f32_16x16x32_f16 v[248:251], a[228:231], v[128:131], 0
    v_cvt_pk_bf16_f32 v106, v108, v109
    v_cvt_pk_bf16_f32 v107, v110, v111
    s_waitcnt vmcnt(13)
    v_mfma_f32_16x16x32_f16 v[252:255], a[228:231], v[152:155], 0
    s_waitcnt lgkmcnt(9)
    v_cvt_pkrtz_f16_f32 v132, v132, v133
    v_cvt_pkrtz_f16_f32 v156, v156, v157
    v_cvt_pkrtz_f16_f32 v133, v134, v135
    v_cvt_pkrtz_f16_f32 v157, v158, v159
    v_dot2_f32_f16 v28, v128, v128, 0
    v_dot2_f32_f16 v30, v152, v152, 0
    v_dot2_f32_f16 v28, v129, v129, v28
    v_dot2_f32_f16 v30, v153, v153, v30
    v_dot2_f32_f16 v28, v130, v130, v28
    v_dot2_f32_f16 v30, v154, v154, v30
    v_dot2_f32_f16 v28, v131, v131, v28
    v_dot2_f32_f16 v30, v155, v155, v30
    v_dot2_f32_f16 v28, v132, v132, v28
    v_dot2_f32_f16 v30, v156, v156, v30
    v_dot2_f32_f16 v28, v133, v133, v28
    v_mfma_f32_16x16x32_bf16 v[224:227], v[196:199], v[136:139], 0
    ds_read_b128 v[216:219], v20 offset:8960
    v_mfma_f32_16x16x32_bf16 v[228:231], v[196:199], v[148:151], 0
    s_waitcnt lgkmcnt(5)
    ds_read_b128 v[196:199], v22 offset:1280
    s_nop 1
    v_smfmac_f32_16x16x64_bf16 v[224:227], v[204:207], v[140:147], v16
    buffer_store_dwordx4 v[80:83], v26, s[24:27], s82 offen offset:0 sc0 sc1
    v_smfmac_f32_16x16x64_bf16 v[228:231], v[204:207], v[72:79], v16
    s_waitcnt lgkmcnt(5)
    ds_read_b128 v[204:207], v22 offset:1296
    v_mfma_f32_16x16x32_bf16 v[136:139], v[192:195], a[232:235], 0
    ds_read_b128 a[232:235], v10 offset:6400
    v_mfma_f32_16x16x32_bf16 v[120:123], a[184:187], v[244:247], v[120:123]
    s_nop 0
    v_cvt_pkrtz_f16_f32 v134, v224, v225
    v_cvt_pkrtz_f16_f32 v135, v226, v227
    v_mfma_f32_16x16x32_bf16 v[160:163], v[192:195], a[244:247], 0
    s_waitcnt lgkmcnt(6)
    ds_read_b128 a[244:247], v10 offset:8960
    ds_read_b128 v[192:195], v22 offset:1536
    v_cvt_pkrtz_f16_f32 v158, v228, v229
    v_mfma_f32_16x16x16_bf16 v[80:83], v[18:19], v[56:57], v[32:35]
    s_waitcnt lgkmcnt(7)
    v_cvt_pkrtz_f16_f32 v159, v230, v231
    v_cvt_pk_bf16_f32 v120, v120, v121
    v_cvt_pk_bf16_f32 v121, v122, v123
    v_smfmac_f32_16x16x64_bf16 v[136:139], v[200:203], a[236:243], v16
    ds_read_b128 a[236:239], v14 offset:6400
    ds_read_b128 a[240:243], v13 offset:7680
    v_mfma_f32_16x16x32_bf16 v[124:127], a[188:191], v[244:247], v[124:127]
    buffer_store_dwordx4 v[88:91], v26, s[24:27], s83 offen offset:0 sc0 sc1
    v_smfmac_f32_16x16x64_bf16 v[160:163], v[200:203], a[248:255], v16
    ds_read_b128 a[248:251], v14 offset:8960
    ds_read_b128 a[252:255], v13 offset:10240
    ds_read_b128 v[200:203], v22 offset:1552
    v_mfma_f32_16x16x32_f16 v[248:251], a[228:231], v[132:135], v[248:251]
    v_cvt_pkrtz_f16_f32 v136, v136, v137
    v_cvt_pkrtz_f16_f32 v137, v138, v139
    v_cvt_pk_bf16_f32 v122, v124, v125
    v_mfma_f32_16x16x32_f16 v[252:255], a[228:231], v[156:159], v[252:255]
    s_waitcnt lgkmcnt(9)
    v_cvt_pkrtz_f16_f32 v160, v160, v161
    v_cvt_pkrtz_f16_f32 v161, v162, v163
    v_cvt_pk_bf16_f32 v123, v126, v127
    v_mfma_f32_16x16x32_bf16 v[224:227], v[196:199], v[176:179], 0
    ds_read_b128 v[176:179], v11 offset:6400
    v_permlane16_swap_b32 v128, v132
    v_mfma_f32_16x16x16_bf16 v[84:87], v[18:19], v[58:59], v[36:39]
    v_permlane16_swap_b32 v152, v156
    v_permlane16_swap_b32 v129, v133
    v_mfma_f32_16x16x32_bf16 v[228:231], v[196:199], v[188:191], 0
    ds_read_b128 v[188:191], v11 offset:8960
    ds_read_b128 v[196:199], v22 offset:1792
    v_mfma_f32_16x16x16_bf16 v[88:91], v[18:19], v[60:61], v[32:35]
    s_waitcnt lgkmcnt(11)
    v_smfmac_f32_16x16x64_bf16 v[224:227], v[204:207], v[180:187], v16
    ds_read_b128 v[180:183], v15 offset:6400
    ds_read_b128 v[184:187], v12 offset:7680
    v_smfmac_f32_16x16x64_bf16 v[228:231], v[204:207], v[232:239], v16
    s_waitcnt lgkmcnt(11)
    ds_read_b128 v[232:235], v15 offset:8960
    ds_read_b128 v[236:239], v12 offset:10240
    ds_read_b128 v[204:207], v22 offset:1808
    v_mfma_f32_16x16x16_bf16 v[92:95], v[18:19], v[62:63], v[36:39]
    s_waitcnt lgkmcnt(13)
    v_cvt_pkrtz_f16_f32 v138, v224, v225
    v_cvt_pkrtz_f16_f32 v139, v226, v227
    v_mfma_f32_16x16x32_bf16 v[140:143], v[192:195], a[232:235], 0
    s_waitcnt vmcnt(2)
    ds_read_b128 a[232:235], v8 offset:0
    buffer_store_dwordx4 v[96:99], v26, s[24:27], s82 offen offset:64 sc0 sc1
    v_mfma_f32_16x16x16_bf16 v[40:43], v[18:19], v[52:53], v[32:35]
    v_cvt_pkrtz_f16_f32 v162, v228, v229
    v_cvt_pkrtz_f16_f32 v163, v230, v231
    v_mfma_f32_16x16x32_bf16 v[164:167], v[192:195], a[244:247], 0
    s_waitcnt lgkmcnt(9)
    ds_read_b128 a[244:247], v8 offset:2560
    ds_read_b128 v[192:195], v22 offset:2048
    buffer_store_dwordx4 v[104:107], v26, s[24:27], s83 offen offset:64 sc0 sc1
    v_smfmac_f32_16x16x64_bf16 v[140:143], v[200:203], a[236:243], v16
    ds_read_b128 a[236:239], v12 offset:0
    ds_read_b128 a[240:243], v15 offset:1280
    v_smfmac_f32_16x16x64_bf16 v[164:167], v[200:203], a[248:255], v16
    s_waitcnt lgkmcnt(11)
    ds_read_b128 a[248:251], v12 offset:2560
    ds_read_b128 a[252:255], v15 offset:3840
    ds_read_b128 v[200:203], v22 offset:2064
    v_mfma_f32_16x16x32_f16 v[248:251], a[228:231], v[136:139], v[248:251]
    v_cvt_pkrtz_f16_f32 v140, v140, v141
    v_cvt_pkrtz_f16_f32 v141, v142, v143
    v_mfma_f32_16x16x32_f16 v[252:255], a[228:231], v[160:163], v[252:255]
    s_waitcnt lgkmcnt(13)
    v_cvt_pkrtz_f16_f32 v164, v164, v165
    v_cvt_pkrtz_f16_f32 v165, v166, v167
    v_mfma_f32_16x16x32_bf16 v[224:227], v[196:199], v[176:179], 0
    ds_read_b128 v[176:179], v9 offset:0
    buffer_store_dwordx4 v[112:115], v26, s[24:27], s82 offen offset:128 sc0 sc1
    v_mfma_f32_16x16x16_bf16 v[44:47], v[18:19], v[54:55], v[36:39]
    s_waitcnt lgkmcnt(13)
    ds_read_b128 v[220:223], v21 offset:8960
    v_mfma_f32_16x16x32_bf16 v[228:231], v[196:199], v[188:191], 0
    s_waitcnt lgkmcnt(10)
    ds_read_b128 v[188:191], v9 offset:2560
    ds_read_b128 v[196:199], v22 offset:2304
    v_smfmac_f32_16x16x64_bf16 v[224:227], v[204:207], v[180:187], v16
    ds_read_b128 v[180:183], v13 offset:0
    ds_read_b128 v[184:187], v14 offset:1280
    v_smfmac_f32_16x16x64_bf16 v[228:231], v[204:207], v[232:239], v16
    s_waitcnt lgkmcnt(11)
    ds_read_b128 v[232:235], v13 offset:2560
    ds_read_b128 v[236:239], v14 offset:3840
    ds_read_b128 v[204:207], v22 offset:2320
    v_mfma_f32_16x16x16_bf16 v[32:35], v[18:19], v[48:49], v[32:35]
    s_waitcnt lgkmcnt(13)
    ds_read_b128 v[212:215], v21 offset:6400
    v_cvt_pkrtz_f16_f32 v142, v224, v225
    v_cvt_pkrtz_f16_f32 v143, v226, v227
    v_cvt_pkrtz_f16_f32 v166, v228, v229
    v_dot2_f32_f16 v30, v157, v157, v30
    v_dot2_f32_f16 v28, v134, v134, v28
    v_dot2_f32_f16 v30, v158, v158, v30
    v_dot2_f32_f16 v28, v135, v135, v28
    v_dot2_f32_f16 v30, v159, v159, v30
    v_dot2_f32_f16 v28, v136, v136, v28
    v_dot2_f32_f16 v30, v160, v160, v30
    v_dot2_f32_f16 v28, v137, v137, v28
    v_dot2_f32_f16 v30, v161, v161, v30
    v_dot2_f32_f16 v28, v138, v138, v28
    v_dot2_f32_f16 v30, v162, v162, v30
    v_dot2_f32_f16 v28, v139, v139, v28
    v_dot2_f32_f16 v30, v163, v163, v30
    v_dot2_f32_f16 v28, v140, v140, v28
    v_dot2_f32_f16 v30, v164, v164, v30
    v_dot2_f32_f16 v28, v141, v141, v28
    v_dot2_f32_f16 v30, v165, v165, v30
    v_permlane16_swap_b32 v153, v157
    v_permlane16_swap_b32 v130, v134
    v_permlane16_swap_b32 v154, v158
    v_mfma_f32_16x16x32_bf16 v[144:147], v[192:195], a[232:235], 0
    s_waitcnt lgkmcnt(13)
    ds_read_b128 a[232:235], v10 offset:0
    v_permlane16_swap_b32 v131, v135
    v_mfma_f32_16x16x32_bf16 v[168:171], v[192:195], a[244:247], 0
    s_waitcnt lgkmcnt(11)
    ds_read_b128 a[244:247], v10 offset:2560
    ds_read_b128 v[192:195], v22 offset:2560
    v_permlane16_swap_b32 v155, v159
    v_smfmac_f32_16x16x64_bf16 v[144:147], v[200:203], a[236:243], v16
    s_waitcnt lgkmcnt(12)
    ds_read_b128 a[236:239], v14 offset:0
    ds_read_b128 a[240:243], v13 offset:1280
    v_cvt_pkrtz_f16_f32 v167, v230, v231
    v_smfmac_f32_16x16x64_bf16 v[168:171], v[200:203], a[248:255], v16
    s_waitcnt lgkmcnt(11)
    ds_read_b128 a[248:251], v14 offset:2560
    ds_read_b128 a[252:255], v13 offset:3840
    ds_read_b128 v[200:203], v22 offset:2576
    v_mfma_f32_16x16x32_f16 v[248:251], a[228:231], v[140:143], v[248:251]
    v_cvt_pkrtz_f16_f32 v144, v144, v145
    v_cvt_pkrtz_f16_f32 v145, v146, v147
    v_mfma_f32_16x16x32_f16 v[252:255], a[228:231], v[164:167], v[252:255]
    v_cvt_pkrtz_f16_f32 v168, v168, v169
    v_cvt_pkrtz_f16_f32 v169, v170, v171
    v_mfma_f32_16x16x32_bf16 v[224:227], v[196:199], v[176:179], 0
    s_waitcnt lgkmcnt(13)
    ds_read_b128 v[176:179], v11 offset:0
    v_mfma_f32_16x16x32_bf16 v[228:231], v[196:199], v[188:191], 0
    s_waitcnt lgkmcnt(10)
    ds_read_b128 v[188:191], v11 offset:2560
    ds_read_b128 v[196:199], v22 offset:2816
    v_smfmac_f32_16x16x64_bf16 v[224:227], v[204:207], v[180:187], v16
    ds_read_b128 v[180:183], v15 offset:0
    ds_read_b128 v[184:187], v12 offset:1280
    v_mfma_f32_16x16x16_bf16 v[36:39], v[18:19], v[50:51], v[36:39]
    s_waitcnt lgkmcnt(12)
    ds_read_b128 v[48:51], v25 offset:128
    ds_read_b128 v[52:55], v25 offset:144
    v_smfmac_f32_16x16x64_bf16 v[228:231], v[204:207], v[232:239], v16
    s_waitcnt lgkmcnt(11)
    ds_read_b128 v[232:235], v15 offset:2560
    ds_read_b128 v[236:239], v12 offset:3840
    ds_read_b128 v[204:207], v22 offset:2832
    v_mfma_f32_16x16x32_bf16 v[148:151], v[192:195], a[232:235], 0
    v_cvt_pkrtz_f16_f32 v146, v224, v225
    v_cvt_pkrtz_f16_f32 v147, v226, v227
    v_mfma_f32_16x16x32_bf16 v[172:175], v[192:195], a[244:247], 0
    s_waitcnt lgkmcnt(10)
    buffer_store_dwordx4 v[120:123], v26, s[24:27], s83 offen offset:128 sc0 sc1
    v_cvt_pkrtz_f16_f32 v170, v228, v229
    v_cvt_pkrtz_f16_f32 v171, v230, v231
    v_smfmac_f32_16x16x64_bf16 v[148:151], v[200:203], a[236:243], v16
    ds_read_b128 v[64:67], v25 offset:256
    v_add_u32 v26, s54, v26
    v_smfmac_f32_16x16x64_bf16 v[172:175], v[200:203], a[248:255], v16
    ds_read_b128 v[68:71], v25 offset:272
    ds_read_b128 a[232:235], v23 offset:0
    ds_read_b128 a[236:239], v23 offset:1024
    v_mfma_f32_16x16x32_f16 v[248:251], a[228:231], v[144:147], v[248:251]
    s_nop 0
    v_cvt_pkrtz_f16_f32 v148, v148, v149
    v_cvt_pkrtz_f16_f32 v149, v150, v151
    v_mfma_f32_16x16x32_f16 v[252:255], a[228:231], v[168:171], v[252:255]
    s_waitcnt lgkmcnt(11)
    v_cvt_pkrtz_f16_f32 v172, v172, v173
    v_cvt_pkrtz_f16_f32 v173, v174, v175
    v_mfma_f32_16x16x32_bf16 v[224:227], v[196:199], v[176:179], 0
    s_waitcnt lgkmcnt(9)
    v_mfma_f32_16x16x32_bf16 v[228:231], v[196:199], v[188:191], 0
    s_mov_b32 s54, 786432
    ds_read_b128 a[240:243], v23 offset:2048
    ds_read_b128 a[244:247], v23 offset:3072
    s_waitcnt lgkmcnt(6)
    v_smfmac_f32_16x16x64_bf16 v[224:227], v[204:207], v[180:187], v16
    ds_read_b128 v[208:211], v20 offset:6400
    ds_read_b128 a[248:251], v23 offset:4096
    v_smfmac_f32_16x16x64_bf16 v[228:231], v[204:207], v[232:239], v16
    ds_read_b128 a[252:255], v23 offset:5120
L_mid:
    v_permlane16_swap_b32 v136, v140
    v_permlane16_swap_b32 v137, v141
    v_dot2_f32_f16 v28, v142, v142, v28
    v_dot2_f32_f16 v30, v166, v166, v30
    v_cvt_pkrtz_f16_f32 v150, v224, v225
    v_cvt_pkrtz_f16_f32 v151, v226, v227
    v_dot2_f32_f16 v28, v143, v143, v28
    v_cvt_pkrtz_f16_f32 v174, v228, v229
    v_mfma_f32_16x16x32_f16 v[248:251], a[228:231], v[148:151], v[248:251]
    v_cvt_pkrtz_f16_f32 v175, v230, v231
    v_permlane16_swap_b32 v138, v142
    v_permlane16_swap_b32 v139, v143
    v_mfma_f32_16x16x32_f16 v[252:255], a[228:231], v[172:175], v[252:255]
    v_permlane16_swap_b32 v160, v164
    v_permlane16_swap_b32 v161, v165
    v_permlane16_swap_b32 v162, v166
    v_dot2_f32_f16 v30, v167, v167, v30
    v_dot2_f32_f16 v28, v144, v144, v28
    v_dot2_f32_f16 v30, v168, v168, v30
    v_dot2_f32_f16 v28, v145, v145, v28
    v_dot2_f32_f16 v30, v169, v169, v30
    v_dot2_f32_f16 v28, v146, v146, v28
    v_dot2_f32_f16 v30, v170, v170, v30
    v_dot2_f32_f16 v28, v147, v147, v28
    v_dot2_f32_f16 v30, v171, v171, v30
    v_dot2_f32_f16 v28, v148, v148, v28
    v_dot2_f32_f16 v30, v172, v172, v30
    v_dot2_f32_f16 v28, v149, v149, v28
    v_dot2_f32_f16 v30, v173, v173, v30
    v_dot2_f32_f16 v28, v150, v150, v28
    v_dot2_f32_f16 v30, v174, v174, v30
    v_dot2_f32_f16 v28, v151, v151, v28
    v_dot2_f32_f16 v30, v175, v175, v30
    v_permlane16_swap_b32 v144, v148
    v_permlane16_swap_b32 v145, v149
    v_mov_b32 v27, v28
    v_mfma_f32_16x16x16_bf16 v[96:99], v[18:19], v[216:217], v[48:51]
    ds_read_b128 v[240:243], v20 offset:2560
    ds_read_b128 v[244:247], v21 offset:2560
    v_permlane32_swap_b32 v27, v28
    v_mfma_f32_16x16x16_bf16 v[100:103], v[18:19], v[218:219], v[52:55]
    ds_read_b128 v[236:239], v21 offset:0
    ds_read_b128 v[232:235], v20 offset:0
    v_add_f32 v28, v27, v28
    v_mfma_f32_16x16x16_bf16 v[104:107], v[18:19], v[220:221], v[48:51]
    v_mul_f32 v27, 0x3c2aaaab, v248
    v_mul_f32 v28, 0x3c2aaaab, v28
    v_fma_f32 v28, -v27, v27, v28
    v_mfma_f32_16x16x16_bf16 v[108:111], v[18:19], v[222:223], v[52:55]
    v_max_f32 v28, 0, v28
    v_permlane16_swap_b32 v146, v150
    v_mfma_f32_16x16x16_bf16 v[56:59], v[18:19], v[212:213], v[48:51]
    v_add_f32 v28, 0x3727c5ac, v28
    v_permlane16_swap_b32 v147, v151
    v_mfma_f32_16x16x16_bf16 v[60:63], v[18:19], v[214:215], v[52:55]
    s_waitcnt lgkmcnt(6)
    v_rsq_f32 v28, v28
    v_permlane16_swap_b32 v163, v167
    v_mfma_f32_16x16x16_bf16 v[48:51], v[18:19], v[208:209], v[48:51]
    v_fma_mixlo_f16 v28, v28, s59, 0
    v_permlane16_swap_b32 v168, v172
    v_mfma_f32_16x16x16_bf16 v[52:55], v[18:19], v[210:211], v[52:55]
    v_fma_mixhi_f16 v28, -v27, v28, 0 op_sel_hi:[0,1,0]
    v_permlane16_swap_b32 v169, v173
    v_mov_b32 v27, v28
    v_permlane16_swap_b32 v170, v174
    v_permlane16_swap_b32 v171, v175
    v_permlane16_swap_b32 v28, v27
    v_pk_fma_f16 v128, v128, v28, v28 op_sel:[0,0,1] op_sel_hi:[1,0,1]
    v_pk_fma_f16 v129, v129, v28, v28 op_sel:[0,0,1] op_sel_hi:[1,0,1]
    v_pk_fma_f16 v130, v130, v28, v28 op_sel:[0,0,1] op_sel_hi:[1,0,1]
    v_pk_fma_f16 v131, v131, v28, v28 op_sel:[0,0,1] op_sel_hi:[1,0,1]
    v_pk_fma_f16 v132, v132, v27, v27 op_sel:[0,0,1] op_sel_hi:[1,0,1]
    v_pk_fma_f16 v133, v133, v27, v27 op_sel:[0,0,1] op_sel_hi:[1,0,1]
    v_mfma_f32_16x16x32_f16 v[176:179], a[232:235], v[128:131], 0
    v_pk_fma_f16 v134, v134, v27, v27 op_sel:[0,0,1] op_sel_hi:[1,0,1]
    v_pk_fma_f16 v135, v135, v27, v27 op_sel:[0,0,1] op_sel_hi:[1,0,1]
    v_pk_fma_f16 v136, v136, v28, v28 op_sel:[0,0,1] op_sel_hi:[1,0,1]
    v_pk_fma_f16 v137, v137, v28, v28 op_sel:[0,0,1] op_sel_hi:[1,0,1]
    v_mfma_f32_16x16x32_f16 v[184:187], a[232:235], v[132:135], 0
    v_pk_fma_f16 v138, v138, v28, v28 op_sel:[0,0,1] op_sel_hi:[1,0,1]
    v_pk_fma_f16 v139, v139, v28, v28 op_sel:[0,0,1] op_sel_hi:[1,0,1]
    v_pk_fma_f16 v140, v140, v27, v27 op_sel:[0,0,1] op_sel_hi:[1,0,1]
    v_mfma_f32_16x16x32_f16 v[180:183], a[236:239], v[128:131], 0
    v_pk_fma_f16 v141, v141, v27, v27 op_sel:[0,0,1] op_sel_hi:[1,0,1]
    v_pk_fma_f16 v142, v142, v27, v27 op_sel:[0,0,1] op_sel_hi:[1,0,1]
    v_pk_fma_f16 v143, v143, v27, v27 op_sel:[0,0,1] op_sel_hi:[1,0,1]
    v_mfma_f32_16x16x32_f16 v[188:191], a[236:239], v[132:135], 0
    v_pk_fma_f16 v147, v147, v28, v28 op_sel:[0,0,1] op_sel_hi:[1,0,1]
    v_pk_fma_f16 v144, v144, v28, v28 op_sel:[0,0,1] op_sel_hi:[1,0,1]
    v_pk_fma_f16 v145, v145, v28, v28 op_sel:[0,0,1] op_sel_hi:[1,0,1]
    v_mfma_f32_16x16x32_f16 v[176:179], a[240:243], v[136:139], v[176:179]
    v_bfi_b32 v147, v17, v147, s84
    v_pk_fma_f16 v146, v146, v28, v28 op_sel:[0,0,1] op_sel_hi:[1,0,1]
    v_pk_fma_f16 v151, v151, v27, v27 op_sel:[0,0,1] op_sel_hi:[1,0,1]
    v_mfma_f32_16x16x32_f16 v[184:187], a[240:243], v[140:143], v[184:187]
    v_pk_fma_f16 v148, v148, v27, v27 op_sel:[0,0,1] op_sel_hi:[1,0,1]
    v_pk_fma_f16 v149, v149, v27, v27 op_sel:[0,0,1] op_sel_hi:[1,0,1]
    v_bfi_b32 v151, v17, v151, s84
    v_mfma_f32_16x16x32_f16 v[180:183], a[244:247], v[136:139], v[180:183]
    v_pk_fma_f16 v150, v150, v27, v27 op_sel:[0,0,1] op_sel_hi:[1,0,1]
    v_mov_b32 v29, v30
    v_mfma_f32_16x16x32_f16 v[188:191], a[244:247], v[140:143], v[188:191]
    s_waitcnt lgkmcnt(5)
    v_permlane32_swap_b32 v29, v30
    v_add_f32 v30, v29, v30
    v_mfma_f32_16x16x32_f16 v[176:179], a[248:251], v[144:147], v[176:179]
    v_mul_f32 v29, 0x3c2aaaab, v252
    v_mul_f32 v30, 0x3c2aaaab, v30
    v_fma_f32 v30, -v29, v29, v30
    v_mfma_f32_16x16x32_f16 v[184:187], a[248:251], v[148:151], v[184:187]
    s_waitcnt lgkmcnt(4)
    v_max_f32 v30, 0, v30
    v_add_f32 v30, 0x3727c5ac, v30
    v_rsq_f32 v30, v30
    v_mfma_f32_16x16x32_f16 v[180:183], a[252:255], v[144:147], v[180:183]
    v_fma_mixlo_f16 v30, v30, s59, 0
    v_cvt_pkrtz_f16_f32 v208, v176, v177
    v_mfma_f32_16x16x32_f16 v[188:191], a[252:255], v[148:151], v[188:191]
    s_cmp_eq_u32 s52, 3
    v_fma_mixhi_f16 v30, -v29, v30, 0 op_sel_hi:[0,1,0]
    v_pk_lshrrev_b16 v208, 3, v208 op_sel_hi:[0,1]
    v_mov_b32 v29, v30
    v_mad_u32_u16 v209, v208, 2, s85
    v_mad_u32_u16 v208, v208, 2, s85 op_sel:[1,0,0,0]
    v_permlane16_swap_b32 v30, v29
    v_pk_fma_f16 v152, v152, v30, v30 op_sel:[0,0,1] op_sel_hi:[1,0,1]
    v_pk_fma_f16 v153, v153, v30, v30 op_sel:[0,0,1] op_sel_hi:[1,0,1]
    v_pk_fma_f16 v154, v154, v30, v30 op_sel:[0,0,1] op_sel_hi:[1,0,1]
    v_pk_fma_f16 v155, v155, v30, v30 op_sel:[0,0,1] op_sel_hi:[1,0,1]
    v_pk_fma_f16 v156, v156, v29, v29 op_sel:[0,0,1] op_sel_hi:[1,0,1]
    v_pk_fma_f16 v157, v157, v29, v29 op_sel:[0,0,1] op_sel_hi:[1,0,1]
    v_mfma_f32_16x16x32_f16 v[192:195], a[232:235], v[152:155], 0
    s_cselect_b32 s57, 0x40000000, 786432
    ds_read_u16 v209, v209
    ds_read_u16_d16_hi v208, v208
    v_pk_fma_f16 v158, v158, v29, v29 op_sel:[0,0,1] op_sel_hi:[1,0,1]
    v_pk_fma_f16 v159, v159, v29, v29 op_sel:[0,0,1] op_sel_hi:[1,0,1]
    v_pk_fma_f16 v160, v160, v30, v30 op_sel:[0,0,1] op_sel_hi:[1,0,1]
    v_pk_fma_f16 v161, v161, v30, v30 op_sel:[0,0,1] op_sel_hi:[1,0,1]
    v_mfma_f32_16x16x32_f16 v[200:203], a[232:235], v[156:159], 0
    ds_read_b128 a[232:235], v23 offset:10240
    v_pk_fma_f16 v162, v162, v30, v30 op_sel:[0,0,1] op_sel_hi:[1,0,1]
    v_pk_fma_f16 v163, v163, v30, v30 op_sel:[0,0,1] op_sel_hi:[1,0,1]
    v_mfma_f32_16x16x32_f16 v[196:199], a[236:239], v[152:155], 0
    v_pk_fma_f16 v164, v164, v29, v29 op_sel:[0,0,1] op_sel_hi:[1,0,1]
    v_pk_fma_f16 v165, v165, v29, v29 op_sel:[0,0,1] op_sel_hi:[1,0,1]
    v_pk_fma_f16 v166, v166, v29, v29 op_sel:[0,0,1] op_sel_hi:[1,0,1]
    v_mfma_f32_16x16x32_f16 v[204:207], a[236:239], v[156:159], 0
    ds_read_b128 a[236:239], v23 offset:11264
    v_pk_fma_f16 v167, v167, v29, v29 op_sel:[0,0,1] op_sel_hi:[1,0,1]
    v_cvt_pkrtz_f16_f32 v210, v178, v179
    v_mfma_f32_16x16x32_f16 v[192:195], a[240:243], v[160:163], v[192:195]
    v_pk_lshrrev_b16 v210, 3, v210 op_sel_hi:[0,1]
    v_mad_u32_u16 v211, v210, 2, s85
    v_mad_u32_u16 v210, v210, 2, s85 op_sel:[1,0,0,0]
    v_mfma_f32_16x16x32_f16 v[200:203], a[240:243], v[164:167], v[200:203]
    ds_read_u16 v211, v211
    ds_read_u16_d16_hi v210, v210
    ds_read_b128 a[240:243], v23 offset:12288
    v_mfma_f32_16x16x32_f16 v[196:199], a[244:247], v[160:163], v[196:199]
    v_cvt_pkrtz_f16_f32 v212, v180, v181
    v_pk_lshrrev_b16 v212, 3, v212 op_sel_hi:[0,1]
    v_mad_u32_u16 v213, v212, 2, s85
    v_mfma_f32_16x16x32_f16 v[204:207], a[244:247], v[164:167], v[204:207]
    s_waitcnt lgkmcnt(7)
    ds_read_u16 v213, v213
    ds_read_b128 a[244:247], v23 offset:13312
    v_mad_u32_u16 v212, v212, 2, s85 op_sel:[1,0,0,0]
    v_cvt_pkrtz_f16_f32 v214, v182, v183
    v_pk_lshrrev_b16 v214, 3, v214 op_sel_hi:[0,1]
    v_mad_u32_u16 v215, v214, 2, s85
    v_mad_u32_u16 v214, v214, 2, s85 op_sel:[1,0,0,0]
    v_cvt_pkrtz_f16_f32 v216, v184, v185
    v_pk_lshrrev_b16 v216, 3, v216 op_sel_hi:[0,1]
    v_mad_u32_u16 v217, v216, 2, s85
    v_mad_u32_u16 v216, v216, 2, s85 op_sel:[1,0,0,0]
    v_cvt_pkrtz_f16_f32 v218, v186, v187
    ds_read_u16_d16_hi v212, v212
    ds_read_u16 v215, v215
    ds_read_u16_d16_hi v214, v214
    ds_read_u16 v217, v217
    ds_read_u16_d16_hi v216, v216
    v_pk_lshrrev_b16 v218, 3, v218 op_sel_hi:[0,1]
    v_mad_u32_u16 v219, v218, 2, s85
    v_mad_u32_u16 v218, v218, 2, s85 op_sel:[1,0,0,0]
    v_cvt_pkrtz_f16_f32 v220, v188, v189
    v_pk_lshrrev_b16 v220, 3, v220 op_sel_hi:[0,1]
    v_mad_u32_u16 v221, v220, 2, s85
    v_mad_u32_u16 v220, v220, 2, s85 op_sel:[1,0,0,0]
    v_cvt_pkrtz_f16_f32 v222, v190, v191
    v_pk_lshrrev_b16 v222, 3, v222 op_sel_hi:[0,1]
    v_mad_u32_u16 v223, v222, 2, s85
    v_mad_u32_u16 v222, v222, 2, s85 op_sel:[1,0,0,0]
    v_pk_fma_f16 v171, v171, v30, v30 op_sel:[0,0,1] op_sel_hi:[1,0,1]
    v_pk_fma_f16 v168, v168, v30, v30 op_sel:[0,0,1] op_sel_hi:[1,0,1]
    v_pk_fma_f16 v169, v169, v30, v30 op_sel:[0,0,1] op_sel_hi:[1,0,1]
    v_bfi_b32 v171, v17, v171, s84
    v_pk_fma_f16 v170, v170, v30, v30 op_sel:[0,0,1] op_sel_hi:[1,0,1]
    v_pk_fma_f16 v175, v175, v29, v29 op_sel:[0,0,1] op_sel_hi:[1,0,1]
    v_pk_fma_f16 v172, v172, v29, v29 op_sel:[0,0,1] op_sel_hi:[1,0,1]
    v_mfma_f32_16x16x32_f16 v[192:195], a[248:251], v[168:171], v[192:195]
    s_waitcnt lgkmcnt(10)
    ds_read_u16 v219, v219
    ds_read_u16_d16_hi v218, v218
    ds_read_u16 v221, v221
    ds_read_u16_d16_hi v220, v220
    v_pk_fma_f16 v173, v173, v29, v29 op_sel:[0,0,1] op_sel_hi:[1,0,1]
    v_bfi_b32 v175, v17, v175, s84
    v_pk_fma_f16 v174, v174, v29, v29 op_sel:[0,0,1] op_sel_hi:[1,0,1]
    v_add_u32 v1, s57, v1
    v_add_u32 v2, s57, v2
    v_mfma_f32_16x16x32_f16 v[200:203], a[248:251], v[172:175], v[200:203]
    s_waitcnt lgkmcnt(11)
    ds_read_u16 v223, v223
    ds_read_u16_d16_hi v222, v222
    ds_read_b128 a[248:251], v23 offset:14336
    v_mfma_f32_16x16x32_f16 v[196:199], a[252:255], v[168:171], v[196:199]
    s_add_u32 m0, s56, 6336
    v_add_u32 v3, s57, v3
    v_add_u32 v4, s57, v4
    v_add_u32 v5, s57, v5
    v_mfma_f32_16x16x32_f16 v[204:207], a[252:255], v[172:175], v[204:207]
    s_waitcnt lgkmcnt(13)
    buffer_load_dwordx4 v1, s[20:23], 0 offen offset:64 lds
    ds_read_b128 a[252:255], v23 offset:15360
    v_mfma_f32_16x16x16_bf16 v[112:115], v[18:19], v[240:241], v[64:67]
    v_add_u32 v6, s57, v6
    v_add_u32 v7, s57, v7
    v_add_u32 v31, s57, v31
    v_mfma_f32_16x16x16_bf16 v[116:119], v[18:19], v[242:243], v[68:71]
    v_cvt_pkrtz_f16_f32 v224, v192, v193
    v_pk_lshrrev_b16 v224, 3, v224 op_sel_hi:[0,1]
    v_cvt_pkrtz_f16_f32 v226, v194, v195
    v_mfma_f32_16x16x16_bf16 v[120:123], v[18:19], v[244:245], v[64:67]
    v_cvt_pkrtz_f16_f32 v228, v196, v197
    v_cvt_pkrtz_f16_f32 v230, v198, v199
    v_cvt_pkrtz_f16_f32 v248, v200, v201
    v_mfma_f32_16x16x16_bf16 v[124:127], v[18:19], v[246:247], v[68:71]
    v_cvt_pkrtz_f16_f32 v250, v202, v203
    v_cvt_pkrtz_f16_f32 v252, v204, v205
    v_cvt_pkrtz_f16_f32 v0, v206, v207
    v_mfma_f32_16x16x16_bf16 v[72:75], v[18:19], v[236:237], v[64:67]
    s_waitcnt lgkmcnt(6)
    v_or_b32 v236, v217, v216
    v_or_b32 v237, v219, v218
    v_mad_u32_u16 v225, v224, 2, s85
    v_mfma_f32_16x16x16_bf16 v[76:79], v[18:19], v[238:239], v[68:71]
    s_waitcnt lgkmcnt(4)
    ds_read_u16 v225, v225
    v_or_b32 v238, v221, v220
    v_mad_u32_u16 v224, v224, 2, s85 op_sel:[1,0,0,0]
    v_mfma_f32_16x16x16_bf16 v[64:67], v[18:19], v[232:233], v[64:67]
    ds_read_u16_d16_hi v224, v224
    v_or_b32 v232, v209, v208
    v_or_b32 v233, v211, v210
    v_mfma_f32_16x16x16_bf16 v[68:71], v[18:19], v[234:235], v[68:71]
    s_waitcnt lgkmcnt(5)
    v_or_b32 v234, v213, v212
    v_or_b32 v235, v215, v214
    s_waitcnt lgkmcnt(4)
    v_or_b32 v239, v223, v222
    v_mfma_f32_16x16x32_f16 v[176:179], a[232:235], v[128:131], 0
    v_pk_lshrrev_b16 v226, 3, v226 op_sel_hi:[0,1]
    v_mad_u32_u16 v227, v226, 2, s85
    v_mad_u32_u16 v226, v226, 2, s85 op_sel:[1,0,0,0]
    v_mfma_f32_16x16x32_f16 v[184:187], a[232:235], v[132:135], 0
    ds_read_u16 v227, v227
    ds_read_u16_d16_hi v226, v226
    v_pk_lshrrev_b16 v228, 3, v228 op_sel_hi:[0,1]
    v_mfma_f32_16x16x32_f16 v[180:183], a[236:239], v[128:131], 0
    v_mad_u32_u16 v229, v228, 2, s85
    v_mad_u32_u16 v228, v228, 2, s85 op_sel:[1,0,0,0]
    v_pk_lshrrev_b16 v230, 3, v230 op_sel_hi:[0,1]
    v_mfma_f32_16x16x32_f16 v[188:191], a[236:239], v[132:135], 0
    ds_read_u16 v229, v229
    ds_read_u16_d16_hi v228, v228
    v_mad_u32_u16 v231, v230, 2, s85
    v_mfma_f32_16x16x32_f16 v[192:195], a[232:235], v[152:155], 0
    ds_read_u16 v231, v231
    v_mad_u32_u16 v230, v230, 2, s85 op_sel:[1,0,0,0]
    v_pk_lshrrev_b16 v248, 3, v248 op_sel_hi:[0,1]
    v_mfma_f32_16x16x32_f16 v[200:203], a[232:235], v[156:159], 0
    ds_read_u16_d16_hi v230, v230
    ds_read_b128 a[232:235], v23 offset:6144
    v_mad_u32_u16 v249, v248, 2, s85
    v_mfma_f32_16x16x32_f16 v[176:179], a[240:243], v[136:139], v[176:179]
    ds_read_u16 v249, v249
    v_mad_u32_u16 v248, v248, 2, s85 op_sel:[1,0,0,0]
    v_pk_lshrrev_b16 v250, 3, v250 op_sel_hi:[0,1]
    v_mfma_f32_16x16x32_f16 v[184:187], a[240:243], v[140:143], v[184:187]
    ds_read_u16_d16_hi v248, v248
    v_mad_u32_u16 v251, v250, 2, s85
    v_mad_u32_u16 v250, v250, 2, s85 op_sel:[1,0,0,0]
    v_mfma_f32_16x16x32_f16 v[196:199], a[236:239], v[152:155], 0
    s_waitcnt lgkmcnt(12)
    ds_read_u16 v251, v251
    ds_read_u16_d16_hi v250, v250
    v_pk_lshrrev_b16 v252, 3, v252 op_sel_hi:[0,1]
    v_mfma_f32_16x16x32_f16 v[204:207], a[236:239], v[156:159], 0
    s_waitcnt lgkmcnt(13)
    ds_read_b128 a[236:239], v23 offset:7168
    v_mad_u32_u16 v253, v252, 2, s85
    v_mad_u32_u16 v252, v252, 2, s85 op_sel:[1,0,0,0]
    v_mfma_f32_16x16x32_f16 v[180:183], a[244:247], v[136:139], v[180:183]
    s_waitcnt lgkmcnt(12)
    ds_read_u16 v253, v253
    ds_read_u16_d16_hi v252, v252
    v_pk_lshrrev_b16 v0, 3, v0 op_sel_hi:[0,1]
    v_mfma_f32_16x16x32_f16 v[188:191], a[244:247], v[140:143], v[188:191]
    v_mad_u32_u16 v208, v0, 2, s85
    v_mad_u32_u16 v0, v0, 2, s85 op_sel:[1,0,0,0]
    v_or_b32 v240, v225, v224
    v_mfma_f32_16x16x32_f16 v[192:195], a[240:243], v[160:163], v[192:195]
    s_waitcnt lgkmcnt(12)
    ds_read_u16 v208, v208
    ds_read_u16_d16_hi v0, v0
    v_or_b32 v241, v227, v226
    v_mfma_f32_16x16x32_f16 v[200:203], a[240:243], v[164:167], v[200:203]
    s_waitcnt lgkmcnt(10)
    ds_read_b128 a[240:243], v23 offset:8192
    v_or_b32 v242, v229, v228
    v_or_b32 v243, v231, v230
    v_mfma_f32_16x16x32_f16 v[176:179], a[248:251], v[144:147], v[176:179]
    v_mfma_f32_16x16x32_f16 v[184:187], a[248:251], v[148:151], v[184:187]
    v_mfma_f32_16x16x32_f16 v[196:199], a[244:247], v[160:163], v[196:199]
    s_waitcnt lgkmcnt(8)
    v_or_b32 v244, v249, v248
    v_mfma_f32_16x16x32_f16 v[204:207], a[244:247], v[164:167], v[204:207]
    ds_read_b128 a[244:247], v23 offset:9216
    v_mfma_f32_16x16x32_f16 v[180:183], a[252:255], v[144:147], v[180:183]
    s_add_u32 m0, s56, 7360
    s_nop 0
    buffer_load_dwordx4 v2, s[20:23], 0 offen offset:64 lds
    v_mfma_f32_16x16x32_f16 v[188:191], a[252:255], v[148:151], v[188:191]
    s_waitcnt lgkmcnt(7)
    v_or_b32 v245, v251, v250
    v_cvt_pkrtz_f16_f32 v209, v176, v177
    v_pk_lshrrev_b16 v209, 3, v209 op_sel_hi:[0,1]
    v_mfma_f32_16x16x32_f16 v[192:195], a[248:251], v[168:171], v[192:195]
    v_mad_u32_u16 v210, v209, 2, s85
    v_mad_u32_u16 v209, v209, 2, s85 op_sel:[1,0,0,0]
    v_cvt_pkrtz_f16_f32 v211, v178, v179
    v_mfma_f32_16x16x32_f16 v[200:203], a[248:251], v[172:175], v[200:203]
    ds_read_b128 a[248:251], v23 offset:20480
    ds_read_u16 v210, v210
    ds_read_u16_d16_hi v209, v209
    v_mfma_f32_16x16x32_f16 v[196:199], a[252:255], v[168:171], v[196:199]
    s_waitcnt lgkmcnt(7)
    v_or_b32 v246, v253, v252
    v_pk_lshrrev_b16 v211, 3, v211 op_sel_hi:[0,1]
    v_mad_u32_u16 v212, v211, 2, s85
    v_mfma_f32_16x16x32_f16 v[204:207], a[252:255], v[172:175], v[204:207]
    ds_read_b128 a[252:255], v23 offset:21504
    ds_read_u16 v212, v212
    v_mad_u32_u16 v211, v211, 2, s85 op_sel:[1,0,0,0]
    v_mfma_f32_16x16x32_bf16 v[32:35], a[192:195], v[232:235], v[32:35]
    ds_read_u16_d16_hi v211, v211
    v_cvt_pkrtz_f16_f32 v213, v180, v181
    v_pk_lshrrev_b16 v213, 3, v213 op_sel_hi:[0,1]
    v_mfma_f32_16x16x32_bf16 v[40:43], a[192:195], v[236:239], v[40:43]
    s_waitcnt lgkmcnt(8)
    v_or_b32 v247, v208, v0
    v_mad_u32_u16 v214, v213, 2, s85
    v_mad_u32_u16 v213, v213, 2, s85 op_sel:[1,0,0,0]
    v_mfma_f32_16x16x32_bf16 v[36:39], a[196:199], v[232:235], v[36:39]
    ds_read_u16 v214, v214
    ds_read_u16_d16_hi v213, v213
    v_cvt_pkrtz_f16_f32 v215, v182, v183
    v_mfma_f32_16x16x32_bf16 v[44:47], a[196:199], v[236:239], v[44:47]
    v_pk_lshrrev_b16 v215, 3, v215 op_sel_hi:[0,1]
    v_mad_u32_u16 v216, v215, 2, s85
    v_mad_u32_u16 v215, v215, 2, s85 op_sel:[1,0,0,0]
    v_mfma_f32_16x16x32_bf16 v[80:83], a[192:195], v[240:243], v[80:83]
    ds_read_u16 v216, v216
    ds_read_u16_d16_hi v215, v215
    v_cvt_pkrtz_f16_f32 v217, v184, v185
    v_mfma_f32_16x16x32_bf16 v[88:91], a[192:195], v[244:247], v[88:91]
    v_pk_lshrrev_b16 v217, 3, v217 op_sel_hi:[0,1]
    v_mad_u32_u16 v218, v217, 2, s85
    v_mad_u32_u16 v217, v217, 2, s85 op_sel:[1,0,0,0]
    v_mfma_f32_16x16x32_bf16 v[48:51], a[232:235], v[232:235], v[48:51]
    ds_read_u16 v218, v218
    ds_read_u16_d16_hi v217, v217
    v_cvt_pkrtz_f16_f32 v219, v186, v187
    v_mfma_f32_16x16x32_bf16 v[56:59], a[232:235], v[236:239], v[56:59]
    v_pk_lshrrev_b16 v219, 3, v219 op_sel_hi:[0,1]
    v_mad_u32_u16 v220, v219, 2, s85
    v_mad_u32_u16 v219, v219, 2, s85 op_sel:[1,0,0,0]
    v_mfma_f32_16x16x32_bf16 v[84:87], a[196:199], v[240:243], v[84:87]
    s_waitcnt lgkmcnt(12)
    ds_read_u16 v220, v220
    ds_read_u16_d16_hi v219, v219
    v_cvt_pkrtz_f16_f32 v221, v188, v189
    v_mfma_f32_16x16x32_bf16 v[92:95], a[196:199], v[244:247], v[92:95]
    v_pk_lshrrev_b16 v221, 3, v221 op_sel_hi:[0,1]
    v_mad_u32_u16 v222, v221, 2, s85
    v_mad_u32_u16 v221, v221, 2, s85 op_sel:[1,0,0,0]
    v_mfma_f32_16x16x32_bf16 v[52:55], a[236:239], v[232:235], v[52:55]
    s_waitcnt lgkmcnt(12)
    ds_read_u16 v222, v222
    ds_read_u16_d16_hi v221, v221
    v_cvt_pkrtz_f16_f32 v223, v190, v191
    v_mfma_f32_16x16x32_bf16 v[60:63], a[236:239], v[236:239], v[60:63]
    v_pk_lshrrev_b16 v223, 3, v223 op_sel_hi:[0,1]
    v_mad_u32_u16 v224, v223, 2, s85
    v_mad_u32_u16 v223, v223, 2, s85 op_sel:[1,0,0,0]
    v_mfma_f32_16x16x32_bf16 v[96:99], a[232:235], v[240:243], v[96:99]
    s_waitcnt lgkmcnt(11)
    ds_read_u16 v224, v224
    ds_read_u16_d16_hi v223, v223
    v_cvt_pkrtz_f16_f32 v225, v192, v193
    v_mfma_f32_16x16x32_bf16 v[104:107], a[232:235], v[244:247], v[104:107]
    s_add_u32 m0, s56, 8384
    ds_read_b128 a[232:235], v23 offset:22528
    buffer_load_dwordx4 v3, s[20:23], 0 offen offset:64 lds
    v_mfma_f32_16x16x32_bf16 v[64:67], a[240:243], v[232:235], v[64:67]
    v_pk_lshrrev_b16 v225, 3, v225 op_sel_hi:[0,1]
    v_cvt_pkrtz_f16_f32 v227, v194, v195
    v_cvt_pkrtz_f16_f32 v229, v196, v197
    v_mfma_f32_16x16x32_bf16 v[72:75], a[240:243], v[236:239], v[72:75]
    v_cvt_pkrtz_f16_f32 v231, v198, v199
    v_cvt_pkrtz_f16_f32 v249, v200, v201
    v_cvt_pkrtz_f16_f32 v251, v202, v203
    v_mfma_f32_16x16x32_bf16 v[100:103], a[236:239], v[240:243], v[100:103]
    v_cvt_pkrtz_f16_f32 v208, v204, v205
    v_mad_u32_u16 v226, v225, 2, s85
    v_mad_u32_u16 v225, v225, 2, s85 op_sel:[1,0,0,0]
    v_mfma_f32_16x16x32_bf16 v[108:111], a[236:239], v[244:247], v[108:111]
    s_waitcnt lgkmcnt(11)
    ds_read_b128 a[236:239], v23 offset:23552
    ds_read_u16 v226, v226
    ds_read_u16_d16_hi v225, v225
    v_mfma_f32_16x16x32_bf16 v[68:71], a[244:247], v[232:235], v[68:71]
    v_or_b32 v232, v210, v209
    v_or_b32 v233, v212, v211
    v_or_b32 v234, v214, v213
    v_mfma_f32_16x16x32_bf16 v[76:79], a[244:247], v[236:239], v[76:79]
    s_waitcnt lgkmcnt(10)
    v_or_b32 v235, v216, v215
    v_or_b32 v236, v218, v217
    v_cvt_pkrtz_f16_f32 v211, v206, v207
    v_mfma_f32_16x16x32_bf16 v[112:115], a[240:243], v[240:243], v[112:115]
    s_waitcnt lgkmcnt(8)
    v_or_b32 v237, v220, v219
    v_pk_lshrrev_b16 v227, 3, v227 op_sel_hi:[0,1]
    v_mad_u32_u16 v228, v227, 2, s85
    v_mfma_f32_16x16x32_bf16 v[120:123], a[240:243], v[244:247], v[120:123]
    ds_read_b128 a[240:243], v23 offset:24576
    ds_read_u16 v228, v228
    v_mad_u32_u16 v227, v227, 2, s85 op_sel:[1,0,0,0]
    v_mfma_f32_16x16x32_bf16 v[116:119], a[244:247], v[240:243], v[116:119]
    ds_read_u16_d16_hi v227, v227
    v_pk_lshrrev_b16 v229, 3, v229 op_sel_hi:[0,1]
    v_mad_u32_u16 v230, v229, 2, s85
    v_mfma_f32_16x16x32_bf16 v[124:127], a[244:247], v[244:247], v[124:127]
    s_waitcnt lgkmcnt(9)
    ds_read_b128 a[244:247], v23 offset:25600
    ds_read_u16 v230, v230
    v_or_b32 v238, v222, v221
    v_mfma_f32_16x16x32_f16 v[176:179], a[248:251], v[128:131], 0
    v_mad_u32_u16 v229, v229, 2, s85 op_sel:[1,0,0,0]
    v_pk_lshrrev_b16 v231, 3, v231 op_sel_hi:[0,1]
    v_mad_u32_u16 v248, v231, 2, s85
    v_mfma_f32_16x16x32_f16 v[184:187], a[248:251], v[132:135], 0
    s_waitcnt lgkmcnt(10)
    ds_read_u16_d16_hi v229, v229
    ds_read_u16 v248, v248
    s_waitcnt lgkmcnt(11)
    v_or_b32 v239, v224, v223
    v_mfma_f32_16x16x32_f16 v[180:183], a[252:255], v[128:131], 0
    v_mad_u32_u16 v231, v231, 2, s85 op_sel:[1,0,0,0]
    v_pk_lshrrev_b16 v249, 3, v249 op_sel_hi:[0,1]
    v_mad_u32_u16 v250, v249, 2, s85
    v_mfma_f32_16x16x32_f16 v[188:191], a[252:255], v[132:135], 0
    ds_read_u16_d16_hi v231, v231
    ds_read_u16 v250, v250
    v_mad_u32_u16 v249, v249, 2, s85 op_sel:[1,0,0,0]
    v_mfma_f32_16x16x32_f16 v[192:195], a[248:251], v[152:155], 0
    ds_read_u16_d16_hi v249, v249
    v_pk_lshrrev_b16 v251, 3, v251 op_sel_hi:[0,1]
    v_mad_u32_u16 v252, v251, 2, s85
    v_mfma_f32_16x16x32_f16 v[200:203], a[248:251], v[156:159], 0
    s_waitcnt lgkmcnt(13)
    ds_read_u16 v252, v252
    v_mad_u32_u16 v251, v251, 2, s85 op_sel:[1,0,0,0]
    v_pk_fma_f16 v253, v208, v208, s53
    v_mfma_f32_16x16x32_f16 v[176:179], a[232:235], v[136:139], v[176:179]
    s_waitcnt lgkmcnt(13)
    ds_read_u16_d16_hi v251, v251
    v_pk_fma_f16 v209, v211, v211, s53
    v_pk_mul_f16 v253, v253, v208 neg_lo:[1,0] neg_hi:[1,0]
    v_mfma_f32_16x16x32_f16 v[184:187], a[232:235], v[140:143], v[184:187]
    s_waitcnt lgkmcnt(13)
    ds_read_b128 a[248:251], v23 offset:16384
    v_pk_mul_f16 v209, v209, v211 neg_lo:[1,0] neg_hi:[1,0]
    v_exp_f16 v0, v253
    v_mfma_f32_16x16x32_f16 v[196:199], a[252:255], v[152:155], 0
    v_exp_f16 v210, v209
    v_exp_f16_sdwa v0, v253 dst_sel:WORD_1 dst_unused:UNUSED_PRESERVE src0_sel:WORD_1
    v_mfma_f32_16x16x32_f16 v[204:207], a[252:255], v[156:159], 0
    s_waitcnt lgkmcnt(13)
    ds_read_b128 a[252:255], v23 offset:17408
    v_exp_f16_sdwa v210, v209 dst_sel:WORD_1 dst_unused:UNUSED_PRESERVE src0_sel:WORD_1
    v_mfma_f32_16x16x32_f16 v[180:183], a[236:239], v[136:139], v[180:183]
    v_pk_fma_f16 v0, v0, s86, s86
    v_pk_fma_f16 v210, v210, s86, s86
    v_rcp_f16 v253, v0
    v_mfma_f32_16x16x32_f16 v[188:191], a[236:239], v[140:143], v[188:191]
    v_rcp_f16 v209, v210
    v_rcp_f16_sdwa v253, v0 dst_sel:WORD_1 dst_unused:UNUSED_PRESERVE src0_sel:WORD_1
    v_mfma_f32_16x16x32_f16 v[192:195], a[232:235], v[160:163], v[192:195]
    v_rcp_f16_sdwa v209, v210 dst_sel:WORD_1 dst_unused:UNUSED_PRESERVE src0_sel:WORD_1
    v_fma_mix_f32 v0, v253, v208, 0 op_sel_hi:[1,1,0]
    v_mfma_f32_16x16x32_f16 v[200:203], a[232:235], v[164:167], v[200:203]
    s_waitcnt lgkmcnt(11)
    ds_read_b128 a[232:235], v23 offset:18432
    v_fma_mix_f32 v210, v209, v211, 0 op_sel_hi:[1,1,0]
    v_fma_mix_f32 v253, v253, v208, 0 op_sel:[1,1,0] op_sel_hi:[1,1,0]
    v_mfma_f32_16x16x32_f16 v[176:179], a[240:243], v[144:147], v[176:179]
    s_add_u32 m0, s56, 10432
    v_fma_mix_f32 v209, v209, v211, 0 op_sel:[1,1,0] op_sel_hi:[1,1,0]
    v_or_b32 v240, v226, v225
    v_or_b32 v241, v228, v227
    v_mfma_f32_16x16x32_f16 v[184:187], a[240:243], v[148:151], v[184:187]
    s_waitcnt lgkmcnt(7)
    buffer_load_dwordx4 v5, s[20:23], 0 offen offset:64 lds
    v_mfma_f32_16x16x32_f16 v[196:199], a[236:239], v[160:163], v[196:199]
    s_add_u32 m0, s56, 9408
    v_or_b32 v242, v230, v229
    v_or_b32 v243, v248, v231
    v_cvt_pk_bf16_f32 v246, v0, v253
    v_mfma_f32_16x16x32_f16 v[204:207], a[236:239], v[164:167], v[204:207]
    buffer_load_dwordx4 v4, s[20:23], 0 offen offset:64 lds
    ds_read_b128 a[236:239], v23 offset:19456
    v_mfma_f32_16x16x32_f16 v[180:183], a[244:247], v[144:147], v[180:183]
    s_waitcnt lgkmcnt(6)
    v_or_b32 v244, v250, v249
    v_cvt_pk_bf16_f32 v247, v210, v209
    v_cvt_pkrtz_f16_f32 v212, v176, v177
    v_mfma_f32_16x16x32_f16 v[188:191], a[244:247], v[148:151], v[188:191]
    v_pk_lshrrev_b16 v212, 3, v212 op_sel_hi:[0,1]
    v_mad_u32_u16 v213, v212, 2, s85
    v_mad_u32_u16 v212, v212, 2, s85 op_sel:[1,0,0,0]
    v_mfma_f32_16x16x32_f16 v[192:195], a[240:243], v[168:171], v[192:195]
    s_waitcnt lgkmcnt(4)
    ds_read_u16 v213, v213
    ds_read_u16_d16_hi v212, v212
    v_or_b32 v245, v252, v251
    v_mfma_f32_16x16x32_f16 v[200:203], a[240:243], v[172:175], v[200:203]
    ds_read_b128 a[240:243], v23 offset:30720
    v_cvt_pkrtz_f16_f32 v214, v178, v179
    v_pk_lshrrev_b16 v214, 3, v214 op_sel_hi:[0,1]
    v_mfma_f32_16x16x32_f16 v[196:199], a[244:247], v[168:171], v[196:199]
    v_mad_u32_u16 v215, v214, 2, s85
    v_mad_u32_u16 v214, v214, 2, s85 op_sel:[1,0,0,0]
    v_cvt_pkrtz_f16_f32 v216, v180, v181
    v_mfma_f32_16x16x32_f16 v[204:207], a[244:247], v[172:175], v[204:207]
    ds_read_b128 a[244:247], v23 offset:31744
    ds_read_u16 v215, v215
    ds_read_u16_d16_hi v214, v214
    v_mfma_f32_16x16x32_bf16 v[32:35], a[200:203], v[232:235], v[32:35]
    v_pk_lshrrev_b16 v216, 3, v216 op_sel_hi:[0,1]
    v_mad_u32_u16 v217, v216, 2, s85
    v_mad_u32_u16 v216, v216, 2, s85 op_sel:[1,0,0,0]
    v_mfma_f32_16x16x32_bf16 v[40:43], a[200:203], v[236:239], v[40:43]
    ds_read_u16 v217, v217
    ds_read_u16_d16_hi v216, v216
    v_cvt_pkrtz_f16_f32 v218, v182, v183
    v_mfma_f32_16x16x32_bf16 v[36:39], a[204:207], v[232:235], v[36:39]
    v_pk_lshrrev_b16 v218, 3, v218 op_sel_hi:[0,1]
    v_mad_u32_u16 v219, v218, 2, s85
    v_mad_u32_u16 v218, v218, 2, s85 op_sel:[1,0,0,0]
    v_mfma_f32_16x16x32_bf16 v[44:47], a[204:207], v[236:239], v[44:47]
    ds_read_u16 v219, v219
    ds_read_u16_d16_hi v218, v218
    v_cvt_pkrtz_f16_f32 v220, v184, v185
    v_mfma_f32_16x16x32_bf16 v[80:83], a[200:203], v[240:243], v[80:83]
    v_pk_lshrrev_b16 v220, 3, v220 op_sel_hi:[0,1]
    v_mad_u32_u16 v221, v220, 2, s85
    v_mad_u32_u16 v220, v220, 2, s85 op_sel:[1,0,0,0]
    v_mfma_f32_16x16x32_bf16 v[88:91], a[200:203], v[244:247], v[88:91]
    s_waitcnt lgkmcnt(12)
    ds_read_u16 v221, v221
    ds_read_u16_d16_hi v220, v220
    v_cvt_pkrtz_f16_f32 v222, v186, v187
    v_mfma_f32_16x16x32_bf16 v[48:51], a[248:251], v[232:235], v[48:51]
    v_pk_lshrrev_b16 v222, 3, v222 op_sel_hi:[0,1]
    v_mad_u32_u16 v223, v222, 2, s85
    v_mad_u32_u16 v222, v222, 2, s85 op_sel:[1,0,0,0]
    v_mfma_f32_16x16x32_bf16 v[56:59], a[248:251], v[236:239], v[56:59]
    s_waitcnt lgkmcnt(12)
    ds_read_u16 v223, v223
    ds_read_u16_d16_hi v222, v222
    v_cvt_pkrtz_f16_f32 v224, v188, v189
    v_mfma_f32_16x16x32_bf16 v[84:87], a[204:207], v[240:243], v[84:87]
    v_pk_lshrrev_b16 v224, 3, v224 op_sel_hi:[0,1]
    v_mad_u32_u16 v225, v224, 2, s85
    v_mad_u32_u16 v224, v224, 2, s85 op_sel:[1,0,0,0]
    v_mfma_f32_16x16x32_bf16 v[92:95], a[204:207], v[244:247], v[92:95]
    s_waitcnt lgkmcnt(12)
    ds_read_u16 v225, v225
    ds_read_u16_d16_hi v224, v224
    v_cvt_pkrtz_f16_f32 v226, v190, v191
    v_mfma_f32_16x16x32_bf16 v[52:55], a[252:255], v[232:235], v[52:55]
    v_pk_lshrrev_b16 v226, 3, v226 op_sel_hi:[0,1]
    v_mad_u32_u16 v227, v226, 2, s85
    v_mad_u32_u16 v226, v226, 2, s85 op_sel:[1,0,0,0]
    v_mfma_f32_16x16x32_bf16 v[60:63], a[252:255], v[236:239], v[60:63]
    s_waitcnt lgkmcnt(12)
    ds_read_u16 v227, v227
    ds_read_u16_d16_hi v226, v226
    v_cvt_pkrtz_f16_f32 v228, v192, v193
    v_mfma_f32_16x16x32_bf16 v[96:99], a[248:251], v[240:243], v[96:99]
    v_pk_lshrrev_b16 v228, 3, v228 op_sel_hi:[0,1]
    v_cvt_pkrtz_f16_f32 v230, v194, v195
    v_cvt_pkrtz_f16_f32 v248, v196, v197
    v_mfma_f32_16x16x32_bf16 v[104:107], a[248:251], v[244:247], v[104:107]
    s_waitcnt lgkmcnt(13)
    ds_read_b128 a[248:251], v23 offset:32768
    v_cvt_pkrtz_f16_f32 v250, v198, v199
    v_cvt_pkrtz_f16_f32 v252, v200, v201
    v_mfma_f32_16x16x32_bf16 v[64:67], a[232:235], v[232:235], v[64:67]
    v_cvt_pkrtz_f16_f32 v0, v202, v203
    v_cvt_pkrtz_f16_f32 v209, v204, v205
    v_cvt_pkrtz_f16_f32 v211, v206, v207
    v_mfma_f32_16x16x32_bf16 v[72:75], a[232:235], v[236:239], v[72:75]
    v_mad_u32_u16 v229, v228, 2, s85
    v_mad_u32_u16 v228, v228, 2, s85 op_sel:[1,0,0,0]
    v_pk_lshrrev_b16 v230, 3, v230 op_sel_hi:[0,1]
    v_mfma_f32_16x16x32_bf16 v[100:103], a[252:255], v[240:243], v[100:103]
    s_waitcnt lgkmcnt(12)
    ds_read_u16 v229, v229
    ds_read_u16_d16_hi v228, v228
    v_mad_u32_u16 v231, v230, 2, s85
    v_mfma_f32_16x16x32_bf16 v[108:111], a[252:255], v[244:247], v[108:111]
    s_waitcnt lgkmcnt(12)
    ds_read_b128 a[252:255], v23 offset:33792
    ds_read_u16 v231, v231
    v_mad_u32_u16 v230, v230, 2, s85 op_sel:[1,0,0,0]
    v_mfma_f32_16x16x32_bf16 v[68:71], a[236:239], v[232:235], v[68:71]
    s_waitcnt lgkmcnt(13)
    ds_read_u16_d16_hi v230, v230
    v_or_b32 v232, v213, v212
    v_or_b32 v233, v215, v214
    v_mfma_f32_16x16x32_bf16 v[76:79], a[236:239], v[236:239], v[76:79]
    s_waitcnt lgkmcnt(12)
    v_or_b32 v234, v217, v216
    v_or_b32 v235, v219, v218
    v_or_b32 v236, v221, v220
    v_mfma_f32_16x16x32_bf16 v[112:115], a[232:235], v[240:243], v[112:115]
    s_waitcnt lgkmcnt(8)
    v_or_b32 v237, v223, v222
    v_or_b32 v238, v225, v224
    v_pk_lshrrev_b16 v248, 3, v248 op_sel_hi:[0,1]
    v_mfma_f32_16x16x32_bf16 v[120:123], a[232:235], v[244:247], v[120:123]
    ds_read_b128 a[232:235], v23 offset:34816
    v_mad_u32_u16 v249, v248, 2, s85
    v_mad_u32_u16 v248, v248, 2, s85 op_sel:[1,0,0,0]
    v_mfma_f32_16x16x32_bf16 v[116:119], a[236:239], v[240:243], v[116:119]
    s_waitcnt lgkmcnt(7)
    ds_read_u16 v249, v249
    ds_read_u16_d16_hi v248, v248
    v_or_b32 v239, v227, v226
    v_mfma_f32_16x16x32_bf16 v[124:127], a[236:239], v[244:247], v[124:127]
    ds_read_b128 a[236:239], v23 offset:35840
    v_pk_lshrrev_b16 v250, 3, v250 op_sel_hi:[0,1]
    v_mad_u32_u16 v251, v250, 2, s85
    v_mfma_f32_16x16x32_f16 v[176:179], a[240:243], v[128:131], 0
    ds_read_u16 v251, v251
    v_mad_u32_u16 v250, v250, 2, s85 op_sel:[1,0,0,0]
    v_pk_lshrrev_b16 v252, 3, v252 op_sel_hi:[0,1]
    v_mfma_f32_16x16x32_f16 v[184:187], a[240:243], v[132:135], 0
    ds_read_u16_d16_hi v250, v250
    v_mad_u32_u16 v253, v252, 2, s85
    v_mad_u32_u16 v252, v252, 2, s85 op_sel:[1,0,0,0]
    v_mfma_f32_16x16x32_f16 v[180:183], a[244:247], v[128:131], 0
    ds_read_u16 v253, v253
    ds_read_u16_d16_hi v252, v252
    v_pk_lshrrev_b16 v0, 3, v0 op_sel_hi:[0,1]
    v_mfma_f32_16x16x32_f16 v[188:191], a[244:247], v[132:135], 0
    v_mad_u32_u16 v208, v0, 2, s85
    v_mad_u32_u16 v0, v0, 2, s85 op_sel:[1,0,0,0]
    v_pk_lshrrev_b16 v209, 3, v209 op_sel_hi:[0,1]
    v_mfma_f32_16x16x32_f16 v[192:195], a[240:243], v[152:155], 0
    s_waitcnt lgkmcnt(12)
    ds_read_u16 v208, v208
    ds_read_u16_d16_hi v0, v0
    v_mad_u32_u16 v210, v209, 2, s85
    v_mfma_f32_16x16x32_f16 v[200:203], a[240:243], v[156:159], 0
    s_waitcnt lgkmcnt(12)
    ds_read_u16 v210, v210
    ds_read_b128 a[240:243], v23 offset:26624
    v_mad_u32_u16 v209, v209, 2, s85 op_sel:[1,0,0,0]
    v_mfma_f32_16x16x32_f16 v[176:179], a[248:251], v[136:139], v[176:179]
    s_waitcnt lgkmcnt(13)
    ds_read_u16_d16_hi v209, v209
    v_pk_lshrrev_b16 v211, 3, v211 op_sel_hi:[0,1]
    v_mad_u32_u16 v212, v211, 2, s85
    v_mfma_f32_16x16x32_f16 v[184:187], a[248:251], v[140:143], v[184:187]
    s_waitcnt lgkmcnt(13)
    v_mad_u32_u16 v211, v211, 2, s85 op_sel:[1,0,0,0]
    v_or_b32 v240, v229, v228
    v_or_b32 v241, v231, v230
    v_mfma_f32_16x16x32_f16 v[196:199], a[244:247], v[152:155], 0
    ds_read_u16 v212, v212
    v_mfma_f32_16x16x32_f16 v[204:207], a[244:247], v[156:159], 0
    s_waitcnt lgkmcnt(11)
    ds_read_u16_d16_hi v211, v211
    v_or_b32 v242, v249, v248
    v_mfma_f32_16x16x32_f16 v[180:183], a[252:255], v[136:139], v[180:183]
    ds_read_b128 a[244:247], v23 offset:27648
    v_mfma_f32_16x16x32_f16 v[188:191], a[252:255], v[140:143], v[188:191]
    v_mfma_f32_16x16x32_f16 v[192:195], a[248:251], v[160:163], v[192:195]
    v_mfma_f32_16x16x32_f16 v[200:203], a[248:251], v[164:167], v[200:203]
    s_waitcnt lgkmcnt(10)
    ds_read_b128 a[248:251], v23 offset:28672
    v_or_b32 v243, v251, v250
    v_mfma_f32_16x16x32_f16 v[176:179], a[232:235], v[144:147], v[176:179]
    s_add_u32 m0, s56, 11456
    v_mfma_f32_16x16x32_f16 v[184:187], a[232:235], v[148:151], v[184:187]
    buffer_load_dwordx4 v6, s[20:23], 0 offen offset:64 lds
    v_mfma_f32_16x16x32_f16 v[196:199], a[252:255], v[160:163], v[196:199]
    s_waitcnt lgkmcnt(9)
    v_or_b32 v244, v253, v252
    v_mfma_f32_16x16x32_f16 v[204:207], a[252:255], v[164:167], v[204:207]
    ds_read_b128 a[252:255], v23 offset:29696
    v_mfma_f32_16x16x32_f16 v[180:183], a[236:239], v[144:147], v[180:183]
    v_cvt_pkrtz_f16_f32 v213, v176, v177
    v_pk_lshrrev_b16 v213, 3, v213 op_sel_hi:[0,1]
    v_mad_u32_u16 v214, v213, 2, s85
    v_mfma_f32_16x16x32_f16 v[188:191], a[236:239], v[148:151], v[188:191]
    s_waitcnt lgkmcnt(9)
    ds_read_u16 v214, v214
    v_mad_u32_u16 v213, v213, 2, s85 op_sel:[1,0,0,0]
    s_waitcnt lgkmcnt(9)
    v_or_b32 v245, v208, v0
    v_mfma_f32_16x16x32_f16 v[192:195], a[232:235], v[168:171], v[192:195]
    ds_read_u16_d16_hi v213, v213
    v_cvt_pkrtz_f16_f32 v215, v178, v179
    v_pk_lshrrev_b16 v215, 3, v215 op_sel_hi:[0,1]
    v_mfma_f32_16x16x32_f16 v[200:203], a[232:235], v[172:175], v[200:203]
    ds_read_b128 a[232:235], v24 offset:0
    v_mad_u32_u16 v216, v215, 2, s85
    v_mad_u32_u16 v215, v215, 2, s85 op_sel:[1,0,0,0]
    v_mfma_f32_16x16x32_f16 v[196:199], a[236:239], v[168:171], v[196:199]
    ds_read_u16 v216, v216
    ds_read_u16_d16_hi v215, v215
    v_cvt_pkrtz_f16_f32 v217, v180, v181
    v_mfma_f32_16x16x32_f16 v[204:207], a[236:239], v[172:175], v[204:207]
    s_waitcnt lgkmcnt(10)
    ds_read_b128 a[236:239], v24 offset:1024
    v_or_b32 v246, v210, v209
    v_pk_lshrrev_b16 v217, 3, v217 op_sel_hi:[0,1]
    v_mfma_f32_16x16x32_bf16 v[32:35], a[208:211], v[232:235], v[32:35]
    v_mad_u32_u16 v218, v217, 2, s85
    v_mad_u32_u16 v217, v217, 2, s85 op_sel:[1,0,0,0]
    v_cvt_pkrtz_f16_f32 v219, v182, v183
    v_mfma_f32_16x16x32_bf16 v[40:43], a[208:211], v[236:239], v[40:43]
    ds_read_u16 v218, v218
    ds_read_u16_d16_hi v217, v217
    v_pk_lshrrev_b16 v219, 3, v219 op_sel_hi:[0,1]
    v_mfma_f32_16x16x32_bf16 v[36:39], a[212:215], v[232:235], v[36:39]
    s_waitcnt lgkmcnt(11)
    v_or_b32 v247, v212, v211
    v_mad_u32_u16 v220, v219, 2, s85
    v_mad_u32_u16 v219, v219, 2, s85 op_sel:[1,0,0,0]
    v_mfma_f32_16x16x32_bf16 v[44:47], a[212:215], v[236:239], v[44:47]
    ds_read_u16 v220, v220
    ds_read_u16_d16_hi v219, v219
    v_cvt_pkrtz_f16_f32 v221, v184, v185
    v_mfma_f32_16x16x32_bf16 v[80:83], a[208:211], v[240:243], v[80:83]
    v_pk_lshrrev_b16 v221, 3, v221 op_sel_hi:[0,1]
    v_mad_u32_u16 v222, v221, 2, s85
    v_mad_u32_u16 v221, v221, 2, s85 op_sel:[1,0,0,0]
    v_mfma_f32_16x16x32_bf16 v[88:91], a[208:211], v[244:247], v[88:91]
    s_waitcnt lgkmcnt(12)
    ds_read_u16 v222, v222
    ds_read_u16_d16_hi v221, v221
    v_cvt_pkrtz_f16_f32 v223, v186, v187
    v_mfma_f32_16x16x32_bf16 v[48:51], a[240:243], v[232:235], v[48:51]
    v_pk_lshrrev_b16 v223, 3, v223 op_sel_hi:[0,1]
    v_mad_u32_u16 v224, v223, 2, s85
    v_mad_u32_u16 v223, v223, 2, s85 op_sel:[1,0,0,0]
    v_mfma_f32_16x16x32_bf16 v[56:59], a[240:243], v[236:239], v[56:59]
    s_waitcnt lgkmcnt(12)
    ds_read_u16 v224, v224
    ds_read_u16_d16_hi v223, v223
    v_cvt_pkrtz_f16_f32 v225, v188, v189
    v_mfma_f32_16x16x32_bf16 v[84:87], a[212:215], v[240:243], v[84:87]
    v_pk_lshrrev_b16 v225, 3, v225 op_sel_hi:[0,1]
    v_mad_u32_u16 v226, v225, 2, s85
    v_mad_u32_u16 v225, v225, 2, s85 op_sel:[1,0,0,0]
    v_mfma_f32_16x16x32_bf16 v[92:95], a[212:215], v[244:247], v[92:95]
    s_waitcnt lgkmcnt(12)
    ds_read_u16 v226, v226
    ds_read_u16_d16_hi v225, v225
    v_cvt_pkrtz_f16_f32 v227, v190, v191
    v_mfma_f32_16x16x32_bf16 v[52:55], a[244:247], v[232:235], v[52:55]
    v_pk_lshrrev_b16 v227, 3, v227 op_sel_hi:[0,1]
    v_mad_u32_u16 v228, v227, 2, s85
    v_mad_u32_u16 v227, v227, 2, s85 op_sel:[1,0,0,0]
    v_mfma_f32_16x16x32_bf16 v[60:63], a[244:247], v[236:239], v[60:63]
    s_waitcnt lgkmcnt(12)
    ds_read_u16 v228, v228
    ds_read_u16_d16_hi v227, v227
    v_cvt_pkrtz_f16_f32 v229, v192, v193
    v_mfma_f32_16x16x32_bf16 v[96:99], a[240:243], v[240:243], v[96:99]
    v_pk_lshrrev_b16 v229, 3, v229 op_sel_hi:[0,1]
    v_cvt_pkrtz_f16_f32 v231, v194, v195
    v_cvt_pkrtz_f16_f32 v249, v196, v197
    v_mfma_f32_16x16x32_bf16 v[104:107], a[240:243], v[244:247], v[104:107]
    s_waitcnt lgkmcnt(13)
    ds_read_b128 a[240:243], v24 offset:2048
    v_cvt_pkrtz_f16_f32 v251, v198, v199
    v_cvt_pkrtz_f16_f32 v253, v200, v201
    v_mfma_f32_16x16x32_bf16 v[64:67], a[248:251], v[232:235], v[64:67]
    v_cvt_pkrtz_f16_f32 v208, v202, v203
    v_cvt_pkrtz_f16_f32 v210, v204, v205
    v_cvt_pkrtz_f16_f32 v212, v206, v207
    v_mfma_f32_16x16x32_bf16 v[72:75], a[248:251], v[236:239], v[72:75]
    v_mad_u32_u16 v230, v229, 2, s85
    v_mad_u32_u16 v229, v229, 2, s85 op_sel:[1,0,0,0]
    v_pk_lshrrev_b16 v231, 3, v231 op_sel_hi:[0,1]
    v_mfma_f32_16x16x32_bf16 v[100:103], a[244:247], v[240:243], v[100:103]
    s_waitcnt lgkmcnt(12)
    ds_read_u16 v230, v230
    ds_read_u16_d16_hi v229, v229
    v_mad_u32_u16 v248, v231, 2, s85
    v_mfma_f32_16x16x32_bf16 v[108:111], a[244:247], v[244:247], v[108:111]
    s_waitcnt lgkmcnt(13)
    ds_read_b128 a[244:247], v24 offset:3072
    v_mad_u32_u16 v231, v231, 2, s85 op_sel:[1,0,0,0]
    v_pk_lshrrev_b16 v249, 3, v249 op_sel_hi:[0,1]
    v_mfma_f32_16x16x32_bf16 v[68:71], a[252:255], v[232:235], v[68:71]
    s_waitcnt lgkmcnt(13)
    ds_read_u16 v248, v248
    v_or_b32 v232, v214, v213
    v_or_b32 v233, v216, v215
    v_mfma_f32_16x16x32_bf16 v[76:79], a[252:255], v[236:239], v[76:79]
    s_waitcnt lgkmcnt(13)
    ds_read_u16_d16_hi v231, v231
    v_or_b32 v234, v218, v217
    v_or_b32 v235, v220, v219
    v_mfma_f32_16x16x32_bf16 v[112:115], a[248:251], v[240:243], v[112:115]
    s_waitcnt lgkmcnt(12)
    v_or_b32 v236, v222, v221
    v_mad_u32_u16 v250, v249, 2, s85
    v_mad_u32_u16 v249, v249, 2, s85 op_sel:[1,0,0,0]
    v_mfma_f32_16x16x32_bf16 v[120:123], a[248:251], v[244:247], v[120:123]
    ds_read_b128 a[248:251], v24 offset:4096
    v_pk_lshrrev_b16 v251, 3, v251 op_sel_hi:[0,1]
    v_mad_u32_u16 v252, v251, 2, s85
    v_mfma_f32_16x16x32_bf16 v[116:119], a[252:255], v[240:243], v[116:119]
    s_waitcnt lgkmcnt(11)
    ds_read_u16 v250, v250
    v_or_b32 v237, v224, v223
    v_mad_u32_u16 v251, v251, 2, s85 op_sel:[1,0,0,0]
    v_mfma_f32_16x16x32_bf16 v[124:127], a[252:255], v[244:247], v[124:127]
    v_pk_lshrrev_b16 v253, 3, v253 op_sel_hi:[0,1]
    v_mad_u32_u16 v0, v253, 2, s85
    v_mad_u32_u16 v253, v253, 2, s85 op_sel:[1,0,0,0]
    v_mfma_f32_16x16x32_f16 v[176:179], a[232:235], v[128:131], 0
    s_waitcnt lgkmcnt(11)
    ds_read_b128 a[252:255], v24 offset:5120
    v_pk_lshrrev_b16 v208, 3, v208 op_sel_hi:[0,1]
    s_waitcnt lgkmcnt(11)
    v_or_b32 v238, v226, v225
    v_mfma_f32_16x16x32_f16 v[184:187], a[232:235], v[132:135], 0
    ds_read_u16_d16_hi v249, v249
    v_mad_u32_u16 v209, v208, 2, s85
    v_mad_u32_u16 v208, v208, 2, s85 op_sel:[1,0,0,0]
    v_mfma_f32_16x16x32_f16 v[180:183], a[236:239], v[128:131], 0
    ds_read_u16 v252, v252
    v_pk_lshrrev_b16 v210, 3, v210 op_sel_hi:[0,1]
    v_mad_u32_u16 v211, v210, 2, s85
    v_mfma_f32_16x16x32_f16 v[188:191], a[236:239], v[132:135], 0
    s_waitcnt lgkmcnt(11)
    v_mad_u32_u16 v210, v210, 2, s85 op_sel:[1,0,0,0]
    v_or_b32 v239, v228, v227
    v_pk_lshrrev_b16 v212, 3, v212 op_sel_hi:[0,1]
    v_mfma_f32_16x16x32_f16 v[192:195], a[232:235], v[152:155], 0
    ds_read_u16_d16_hi v251, v251
    ds_read_u16 v0, v0
    v_mad_u32_u16 v213, v212, 2, s85
    v_mfma_f32_16x16x32_f16 v[200:203], a[232:235], v[156:159], 0
    s_waitcnt lgkmcnt(12)
    v_mad_u32_u16 v212, v212, 2, s85 op_sel:[1,0,0,0]
    v_mfma_f32_16x16x32_f16 v[176:179], a[240:243], v[136:139], v[176:179]
    ds_read_u16_d16_hi v253, v253
    v_mfma_f32_16x16x32_f16 v[184:187], a[240:243], v[140:143], v[184:187]
    s_waitcnt lgkmcnt(11)
    ds_read_u16 v209, v209
    v_or_b32 v240, v230, v229
    v_mfma_f32_16x16x32_f16 v[196:199], a[236:239], v[152:155], 0
    s_waitcnt lgkmcnt(11)
    ds_read_u16_d16_hi v208, v208
    v_mfma_f32_16x16x32_f16 v[204:207], a[236:239], v[156:159], 0
    s_add_u32 m0, s56, 12480
    v_mfma_f32_16x16x32_f16 v[180:183], a[244:247], v[136:139], v[180:183]
    ds_read_u16 v211, v211
    buffer_load_dword v7, s[20:23], 0 offen offset:64 lds
    v_mfma_f32_16x16x32_f16 v[188:191], a[244:247], v[140:143], v[188:191]
    s_waitcnt lgkmcnt(11)
    ds_read_u16_d16_hi v210, v210
    v_or_b32 v241, v248, v231
    v_mfma_f32_16x16x32_f16 v[192:195], a[240:243], v[160:163], v[192:195]
    s_add_u32 m0, s56, 0
    ds_read_u16 v213, v213
    buffer_load_dwordx4 v1, s[20:23], 0 offen offset:0 lds
    v_mfma_f32_16x16x32_f16 v[200:203], a[240:243], v[164:167], v[200:203]
    s_waitcnt lgkmcnt(12)
    v_mfma_f32_16x16x32_f16 v[176:179], a[248:251], v[144:147], v[176:179]
    ds_read_u16_d16_hi v212, v212
    ds_read_b128 a[232:235], v23 offset:36864
    v_mfma_f32_16x16x32_f16 v[184:187], a[248:251], v[148:151], v[184:187]
    v_mfma_f32_16x16x32_f16 v[196:199], a[244:247], v[160:163], v[196:199]
    s_waitcnt lgkmcnt(11)
    ds_read_b128 a[236:239], v23 offset:37888
    v_or_b32 v242, v250, v249
    v_mfma_f32_16x16x32_f16 v[204:207], a[244:247], v[164:167], v[204:207]
    v_cvt_pkrtz_f16_f32 v214, v176, v177
    v_pk_lshrrev_b16 v214, 3, v214 op_sel_hi:[0,1]
    v_mad_u32_u16 v215, v214, 2, s85
    v_mfma_f32_16x16x32_f16 v[180:183], a[252:255], v[144:147], v[180:183]
    ds_read_b128 a[240:243], v23 offset:38912
    v_mad_u32_u16 v214, v214, 2, s85 op_sel:[1,0,0,0]
    v_cvt_pkrtz_f16_f32 v216, v178, v179
    v_mfma_f32_16x16x32_f16 v[188:191], a[252:255], v[148:151], v[188:191]
    s_waitcnt lgkmcnt(11)
    ds_read_b128 a[244:247], v23 offset:39936
    v_or_b32 v243, v252, v251
    v_pk_lshrrev_b16 v216, 3, v216 op_sel_hi:[0,1]
    v_mfma_f32_16x16x32_f16 v[192:195], a[248:251], v[168:171], v[192:195]
    v_mad_u32_u16 v217, v216, 2, s85
    v_mad_u32_u16 v216, v216, 2, s85 op_sel:[1,0,0,0]
    v_cvt_pkrtz_f16_f32 v218, v180, v181
    v_mfma_f32_16x16x32_f16 v[200:203], a[248:251], v[172:175], v[200:203]
    s_waitcnt lgkmcnt(11)
    ds_read_b128 a[248:251], v24 offset:12288
    v_pk_lshrrev_b16 v218, 3, v218 op_sel_hi:[0,1]
    s_waitcnt lgkmcnt(11)
    v_or_b32 v244, v0, v253
    v_mfma_f32_16x16x32_f16 v[196:199], a[252:255], v[168:171], v[196:199]
    ds_read_u16 v215, v215
    v_mad_u32_u16 v219, v218, 2, s85
    v_mad_u32_u16 v218, v218, 2, s85 op_sel:[1,0,0,0]
    v_mfma_f32_16x16x32_f16 v[204:207], a[252:255], v[172:175], v[204:207]
    ds_read_b128 a[252:255], v24 offset:13312
    v_cvt_pkrtz_f16_f32 v220, v182, v183
    v_pk_lshrrev_b16 v220, 3, v220 op_sel_hi:[0,1]
    v_mfma_f32_16x16x32_bf16 v[32:35], a[216:219], v[232:235], v[32:35]
    s_waitcnt lgkmcnt(11)
    v_mad_u32_u16 v221, v220, 2, s85
    v_or_b32 v245, v209, v208
    v_mad_u32_u16 v220, v220, 2, s85 op_sel:[1,0,0,0]
    v_mfma_f32_16x16x32_bf16 v[40:43], a[216:219], v[236:239], v[40:43]
    ds_read_u16_d16_hi v214, v214
    v_cvt_pkrtz_f16_f32 v222, v184, v185
    v_pk_lshrrev_b16 v222, 3, v222 op_sel_hi:[0,1]
    v_mfma_f32_16x16x32_bf16 v[36:39], a[220:223], v[232:235], v[36:39]
    ds_read_u16 v217, v217
    v_mad_u32_u16 v223, v222, 2, s85
    v_mad_u32_u16 v222, v222, 2, s85 op_sel:[1,0,0,0]
    v_mfma_f32_16x16x32_bf16 v[44:47], a[220:223], v[236:239], v[44:47]
    s_waitcnt lgkmcnt(11)
    ds_read_u16_d16_hi v216, v216
    v_or_b32 v246, v211, v210
    v_cvt_pkrtz_f16_f32 v224, v186, v187
    v_mfma_f32_16x16x32_bf16 v[80:83], a[216:219], v[240:243], v[80:83]
    s_waitcnt lgkmcnt(11)
    v_pk_lshrrev_b16 v224, 3, v224 op_sel_hi:[0,1]
    v_mad_u32_u16 v225, v224, 2, s85
    v_mad_u32_u16 v224, v224, 2, s85 op_sel:[1,0,0,0]
    v_cvt_pkrtz_f16_f32 v228, v188, v189
    v_cvt_pkrtz_f16_f32 v231, v190, v191
    v_pk_fma_f16 v226, v228, v228, s53
    v_pk_fma_f16 v229, v231, v231, s53
    v_pk_mul_f16 v226, v226, v228 neg_lo:[1,0] neg_hi:[1,0]
    s_waitcnt lgkmcnt(10)
    v_or_b32 v247, v213, v212
    v_pk_mul_f16 v229, v229, v231 neg_lo:[1,0] neg_hi:[1,0]
    v_exp_f16 v227, v226
    v_mfma_f32_16x16x32_bf16 v[88:91], a[216:219], v[244:247], v[88:91]
    s_waitcnt lgkmcnt(9)
    ds_read_u16 v219, v219
    ds_read_u16_d16_hi v218, v218
    ds_read_u16 v221, v221
    ds_read_u16_d16_hi v220, v220
    v_mfma_f32_16x16x32_bf16 v[48:51], a[232:235], v[232:235], v[48:51]
    ds_read_u16 v223, v223
    v_exp_f16 v230, v229
    v_mfma_f32_16x16x32_bf16 v[56:59], a[232:235], v[236:239], v[56:59]
    s_waitcnt lgkmcnt(13)
    ds_read_u16_d16_hi v222, v222
    v_exp_f16_sdwa v227, v226 dst_sel:WORD_1 dst_unused:UNUSED_PRESERVE src0_sel:WORD_1
    v_mfma_f32_16x16x32_bf16 v[84:87], a[220:223], v[240:243], v[84:87]
    s_waitcnt lgkmcnt(13)
    ds_read_u16 v225, v225
    v_exp_f16_sdwa v230, v229 dst_sel:WORD_1 dst_unused:UNUSED_PRESERVE src0_sel:WORD_1
    v_mfma_f32_16x16x32_bf16 v[92:95], a[220:223], v[244:247], v[92:95]
    s_waitcnt lgkmcnt(13)
    ds_read_u16_d16_hi v224, v224
    v_pk_fma_f16 v227, v227, s86, s86
    v_pk_fma_f16 v230, v230, s86, s86
    v_mfma_f32_16x16x32_bf16 v[52:55], a[236:239], v[232:235], v[52:55]
    v_rcp_f16 v226, v227
    v_rcp_f16 v229, v230
    v_mfma_f32_16x16x32_bf16 v[60:63], a[236:239], v[236:239], v[60:63]
    v_rcp_f16_sdwa v226, v227 dst_sel:WORD_1 dst_unused:UNUSED_PRESERVE src0_sel:WORD_1
    v_rcp_f16_sdwa v229, v230 dst_sel:WORD_1 dst_unused:UNUSED_PRESERVE src0_sel:WORD_1
    v_mfma_f32_16x16x32_bf16 v[96:99], a[232:235], v[240:243], v[96:99]
    v_fma_mix_f32 v227, v226, v228, 0 op_sel_hi:[1,1,0]
    v_fma_mix_f32 v230, v229, v231, 0 op_sel_hi:[1,1,0]
    v_fma_mix_f32 v226, v226, v228, 0 op_sel:[1,1,0] op_sel_hi:[1,1,0]
    v_mfma_f32_16x16x32_bf16 v[104:107], a[232:235], v[244:247], v[104:107]
    s_waitcnt lgkmcnt(13)
    ds_read_b128 a[232:235], v24 offset:14336
    v_fma_mix_f32 v229, v229, v231, 0 op_sel:[1,1,0] op_sel_hi:[1,1,0]
    v_cvt_pkrtz_f16_f32 v248, v192, v193
    v_mfma_f32_16x16x32_bf16 v[64:67], a[240:243], v[232:235], v[64:67]
    v_pk_lshrrev_b16 v248, 3, v248 op_sel_hi:[0,1]
    v_cvt_pkrtz_f16_f32 v250, v194, v195
    v_cvt_pkrtz_f16_f32 v252, v196, v197
    v_mfma_f32_16x16x32_bf16 v[72:75], a[240:243], v[236:239], v[72:75]
    v_cvt_pkrtz_f16_f32 v0, v198, v199
    v_cvt_pkrtz_f16_f32 v209, v200, v201
    v_cvt_pkrtz_f16_f32 v211, v202, v203
    v_mfma_f32_16x16x32_bf16 v[100:103], a[236:239], v[240:243], v[100:103]
    v_mad_u32_u16 v249, v248, 2, s85
    v_mad_u32_u16 v248, v248, 2, s85 op_sel:[1,0,0,0]
    v_pk_lshrrev_b16 v250, 3, v250 op_sel_hi:[0,1]
    v_mfma_f32_16x16x32_bf16 v[108:111], a[236:239], v[244:247], v[108:111]
    s_waitcnt lgkmcnt(11)
    ds_read_b128 a[236:239], v24 offset:15360
    ds_read_u16 v249, v249
    ds_read_u16_d16_hi v248, v248
    v_mfma_f32_16x16x32_bf16 v[68:71], a[244:247], v[232:235], v[68:71]
    s_waitcnt lgkmcnt(10)
    v_or_b32 v232, v215, v214
    v_or_b32 v233, v217, v216
    v_or_b32 v234, v219, v218
    v_mfma_f32_16x16x32_bf16 v[76:79], a[244:247], v[236:239], v[76:79]
    s_waitcnt lgkmcnt(8)
    v_or_b32 v235, v221, v220
    v_cvt_pk_bf16_f32 v238, v227, v226
    v_cvt_pk_bf16_f32 v239, v230, v229
    v_mfma_f32_16x16x32_bf16 v[112:115], a[240:243], v[240:243], v[112:115]
    v_cvt_pkrtz_f16_f32 v215, v204, v205
    v_cvt_pkrtz_f16_f32 v218, v206, v207
    v_mad_u32_u16 v251, v250, 2, s85
    v_mfma_f32_16x16x32_bf16 v[120:123], a[240:243], v[244:247], v[120:123]
    s_waitcnt lgkmcnt(7)
    ds_read_b128 a[240:243], v24 offset:16384
    ds_read_u16 v251, v251
    s_waitcnt lgkmcnt(8)
    v_or_b32 v236, v223, v222
    v_mfma_f32_16x16x32_bf16 v[116:119], a[244:247], v[240:243], v[116:119]
    v_mad_u32_u16 v250, v250, 2, s85 op_sel:[1,0,0,0]
    v_pk_lshrrev_b16 v252, 3, v252 op_sel_hi:[0,1]
    v_mad_u32_u16 v253, v252, 2, s85
    v_mfma_f32_16x16x32_bf16 v[124:127], a[244:247], v[244:247], v[124:127]
    s_add_u32 m0, s56, 1024
    ds_read_b128 a[244:247], v24 offset:17408
    buffer_load_dwordx4 v2, s[20:23], 0 offen offset:0 lds
    ds_read_u16_d16_hi v250, v250
    ds_read_u16 v253, v253
    v_mfma_f32_16x16x32_f16 v[176:179], a[248:251], v[128:131], 0
    s_waitcnt lgkmcnt(9)
    v_or_b32 v237, v225, v224
    v_mad_u32_u16 v252, v252, 2, s85 op_sel:[1,0,0,0]
    v_pk_lshrrev_b16 v0, 3, v0 op_sel_hi:[0,1]
    v_mfma_f32_16x16x32_f16 v[184:187], a[248:251], v[132:135], 0
    ds_read_u16_d16_hi v252, v252
    v_mad_u32_u16 v208, v0, 2, s85
    v_mad_u32_u16 v0, v0, 2, s85 op_sel:[1,0,0,0]
    v_mfma_f32_16x16x32_f16 v[180:183], a[252:255], v[128:131], 0
    ds_read_u16 v208, v208
    ds_read_u16_d16_hi v0, v0
    v_pk_lshrrev_b16 v209, 3, v209 op_sel_hi:[0,1]
    v_mfma_f32_16x16x32_f16 v[188:191], a[252:255], v[132:135], 0
    v_mad_u32_u16 v210, v209, 2, s85
    v_mad_u32_u16 v209, v209, 2, s85 op_sel:[1,0,0,0]
    v_pk_lshrrev_b16 v211, 3, v211 op_sel_hi:[0,1]
    v_mfma_f32_16x16x32_f16 v[192:195], a[248:251], v[152:155], 0
    ds_read_u16 v210, v210
    ds_read_u16_d16_hi v209, v209
    v_mad_u32_u16 v212, v211, 2, s85
    v_mfma_f32_16x16x32_f16 v[200:203], a[248:251], v[156:159], 0
    s_waitcnt lgkmcnt(12)
    ds_read_u16 v212, v212
    ds_read_b128 a[248:251], v24 offset:6144
    v_mad_u32_u16 v211, v211, 2, s85 op_sel:[1,0,0,0]
    v_mfma_f32_16x16x32_f16 v[176:179], a[232:235], v[136:139], v[176:179]
    s_waitcnt lgkmcnt(13)
    ds_read_u16_d16_hi v211, v211
    v_pk_fma_f16 v213, v215, v215, s53
    v_pk_fma_f16 v216, v218, v218, s53
    v_mfma_f32_16x16x32_f16 v[184:187], a[232:235], v[140:143], v[184:187]
    v_pk_mul_f16 v213, v213, v215 neg_lo:[1,0] neg_hi:[1,0]
    v_pk_mul_f16 v216, v216, v218 neg_lo:[1,0] neg_hi:[1,0]
    v_exp_f16 v214, v213
    v_mfma_f32_16x16x32_f16 v[196:199], a[252:255], v[152:155], 0
    v_exp_f16 v217, v216
    v_exp_f16_sdwa v214, v213 dst_sel:WORD_1 dst_unused:UNUSED_PRESERVE src0_sel:WORD_1
    v_mfma_f32_16x16x32_f16 v[204:207], a[252:255], v[156:159], 0
    s_waitcnt lgkmcnt(13)
    ds_read_b128 a[252:255], v24 offset:7168
    v_exp_f16_sdwa v217, v216 dst_sel:WORD_1 dst_unused:UNUSED_PRESERVE src0_sel:WORD_1
    v_mfma_f32_16x16x32_f16 v[180:183], a[236:239], v[136:139], v[180:183]
    v_pk_fma_f16 v214, v214, s86, s86
    v_pk_fma_f16 v217, v217, s86, s86
    v_rcp_f16 v213, v214
    v_mfma_f32_16x16x32_f16 v[188:191], a[236:239], v[140:143], v[188:191]
    s_add_u32 m0, s56, 2048
    v_rcp_f16 v216, v217
    v_rcp_f16_sdwa v213, v214 dst_sel:WORD_1 dst_unused:UNUSED_PRESERVE src0_sel:WORD_1
    v_mfma_f32_16x16x32_f16 v[192:195], a[232:235], v[160:163], v[192:195]
    buffer_load_dwordx4 v3, s[20:23], 0 offen offset:0 lds
    v_mfma_f32_16x16x32_f16 v[200:203], a[232:235], v[164:167], v[200:203]
    s_waitcnt lgkmcnt(13)
    ds_read_b128 a[232:235], v24 offset:8192
    v_rcp_f16_sdwa v216, v217 dst_sel:WORD_1 dst_unused:UNUSED_PRESERVE src0_sel:WORD_1
    v_mfma_f32_16x16x32_f16 v[176:179], a[240:243], v[144:147], v[176:179]
    v_fma_mix_f32 v214, v213, v215, 0 op_sel_hi:[1,1,0]
    v_fma_mix_f32 v217, v216, v218, 0 op_sel_hi:[1,1,0]
    v_fma_mix_f32 v213, v213, v215, 0 op_sel:[1,1,0] op_sel_hi:[1,1,0]
    v_mfma_f32_16x16x32_f16 v[184:187], a[240:243], v[148:151], v[184:187]
    s_waitcnt lgkmcnt(11)
    v_fma_mix_f32 v216, v216, v218, 0 op_sel:[1,1,0] op_sel_hi:[1,1,0]
    v_or_b32 v240, v249, v248
    v_or_b32 v241, v251, v250
    v_mfma_f32_16x16x32_f16 v[196:199], a[236:239], v[160:163], v[196:199]
    s_waitcnt lgkmcnt(5)
    v_or_b32 v242, v253, v252
    v_or_b32 v243, v208, v0
    v_or_b32 v244, v210, v209
    v_mfma_f32_16x16x32_f16 v[204:207], a[236:239], v[164:167], v[204:207]
    ds_read_b128 a[236:239], v24 offset:9216
    v_cvt_pk_bf16_f32 v246, v214, v213
    v_cvt_pk_bf16_f32 v247, v217, v216
    v_mfma_f32_16x16x32_f16 v[180:183], a[244:247], v[144:147], v[180:183]
    v_cvt_pkrtz_f16_f32 v219, v176, v177
    v_pk_lshrrev_b16 v219, 3, v219 op_sel_hi:[0,1]
    v_mad_u32_u16 v220, v219, 2, s85
    v_mfma_f32_16x16x32_f16 v[188:191], a[244:247], v[148:151], v[188:191]
    s_waitcnt lgkmcnt(3)
    ds_read_u16 v220, v220
    v_or_b32 v245, v212, v211
    v_mad_u32_u16 v219, v219, 2, s85 op_sel:[1,0,0,0]
    v_mfma_f32_16x16x32_f16 v[192:195], a[240:243], v[168:171], v[192:195]
    ds_read_u16_d16_hi v219, v219
    v_cvt_pkrtz_f16_f32 v221, v178, v179
    v_pk_lshrrev_b16 v221, 3, v221 op_sel_hi:[0,1]
    v_mfma_f32_16x16x32_f16 v[200:203], a[240:243], v[172:175], v[200:203]
    ds_read_b128 a[240:243], v24 offset:10240
    v_mad_u32_u16 v222, v221, 2, s85
    v_mad_u32_u16 v221, v221, 2, s85 op_sel:[1,0,0,0]
    v_mfma_f32_16x16x32_f16 v[196:199], a[244:247], v[168:171], v[196:199]
    ds_read_u16 v222, v222
    ds_read_u16_d16_hi v221, v221
    v_cvt_pkrtz_f16_f32 v223, v180, v181
    v_mfma_f32_16x16x32_f16 v[204:207], a[244:247], v[172:175], v[204:207]
    ds_read_b128 a[244:247], v24 offset:11264
    v_pk_lshrrev_b16 v223, 3, v223 op_sel_hi:[0,1]
    v_mad_u32_u16 v224, v223, 2, s85
    v_mfma_f32_16x16x32_bf16 v[32:35], a[248:251], v[232:235], v[32:35]
    ds_read_u16 v224, v224
    v_mad_u32_u16 v223, v223, 2, s85 op_sel:[1,0,0,0]
    v_cvt_pkrtz_f16_f32 v225, v182, v183
    v_mfma_f32_16x16x32_bf16 v[40:43], a[248:251], v[236:239], v[40:43]
    s_waitcnt lgkmcnt(9)
    ds_read_u16_d16_hi v223, v223
    v_pk_lshrrev_b16 v225, 3, v225 op_sel_hi:[0,1]
    v_mad_u32_u16 v226, v225, 2, s85
    v_mfma_f32_16x16x32_bf16 v[36:39], a[252:255], v[232:235], v[36:39]
    ds_read_u16 v226, v226
    v_mad_u32_u16 v225, v225, 2, s85 op_sel:[1,0,0,0]
    v_cvt_pkrtz_f16_f32 v227, v184, v185
    v_mfma_f32_16x16x32_bf16 v[44:47], a[252:255], v[236:239], v[44:47]
    ds_read_u16_d16_hi v225, v225
    v_pk_lshrrev_b16 v227, 3, v227 op_sel_hi:[0,1]
    v_mad_u32_u16 v228, v227, 2, s85
    v_mfma_f32_16x16x32_bf16 v[80:83], a[248:251], v[240:243], v[80:83]
    ds_read_u16 v228, v228
    v_mad_u32_u16 v227, v227, 2, s85 op_sel:[1,0,0,0]
    v_cvt_pkrtz_f16_f32 v229, v186, v187
    v_mfma_f32_16x16x32_bf16 v[88:91], a[248:251], v[244:247], v[88:91]
    s_waitcnt lgkmcnt(12)
    ds_read_u16_d16_hi v227, v227
    ds_read_b128 a[248:251], v24 offset:24576
    v_pk_lshrrev_b16 v229, 3, v229 op_sel_hi:[0,1]
    v_mfma_f32_16x16x32_bf16 v[48:51], a[232:235], v[232:235], v[48:51]
    v_mad_u32_u16 v230, v229, 2, s85
    v_mad_u32_u16 v229, v229, 2, s85 op_sel:[1,0,0,0]
    v_cvt_pkrtz_f16_f32 v231, v188, v189
    v_mfma_f32_16x16x32_bf16 v[56:59], a[232:235], v[236:239], v[56:59]
    s_waitcnt lgkmcnt(12)
    ds_read_u16 v230, v230
    ds_read_u16_d16_hi v229, v229
    v_pk_lshrrev_b16 v231, 3, v231 op_sel_hi:[0,1]
    v_mfma_f32_16x16x32_bf16 v[84:87], a[252:255], v[240:243], v[84:87]
    v_mad_u32_u16 v248, v231, 2, s85
    v_mad_u32_u16 v231, v231, 2, s85 op_sel:[1,0,0,0]
    v_cvt_pkrtz_f16_f32 v249, v190, v191
    v_mfma_f32_16x16x32_bf16 v[92:95], a[252:255], v[244:247], v[92:95]
    s_waitcnt lgkmcnt(11)
    ds_read_u16 v248, v248
    ds_read_u16_d16_hi v231, v231
    ds_read_b128 a[252:255], v24 offset:25600
    v_mfma_f32_16x16x32_bf16 v[52:55], a[236:239], v[232:235], v[52:55]
    v_pk_lshrrev_b16 v249, 3, v249 op_sel_hi:[0,1]
    v_mad_u32_u16 v250, v249, 2, s85
    v_mad_u32_u16 v249, v249, 2, s85 op_sel:[1,0,0,0]
    v_mfma_f32_16x16x32_bf16 v[60:63], a[236:239], v[236:239], v[60:63]
    s_waitcnt lgkmcnt(12)
    ds_read_u16 v250, v250
    ds_read_u16_d16_hi v249, v249
    v_cvt_pkrtz_f16_f32 v251, v192, v193
    v_mfma_f32_16x16x32_bf16 v[96:99], a[232:235], v[240:243], v[96:99]
    v_pk_lshrrev_b16 v251, 3, v251 op_sel_hi:[0,1]
    v_cvt_pkrtz_f16_f32 v253, v194, v195
    v_cvt_pkrtz_f16_f32 v208, v196, v197
    v_mfma_f32_16x16x32_bf16 v[104:107], a[232:235], v[244:247], v[104:107]
    s_waitcnt lgkmcnt(13)
    ds_read_b128 a[232:235], v24 offset:26624
    v_cvt_pkrtz_f16_f32 v210, v198, v199
    v_cvt_pkrtz_f16_f32 v212, v200, v201
    v_mfma_f32_16x16x32_bf16 v[64:67], a[240:243], v[232:235], v[64:67]
    v_cvt_pkrtz_f16_f32 v214, v202, v203
    v_cvt_pkrtz_f16_f32 v216, v204, v205
    v_cvt_pkrtz_f16_f32 v218, v206, v207
    v_mfma_f32_16x16x32_bf16 v[72:75], a[240:243], v[236:239], v[72:75]
    v_mad_u32_u16 v252, v251, 2, s85
    v_mad_u32_u16 v251, v251, 2, s85 op_sel:[1,0,0,0]
    v_pk_lshrrev_b16 v253, 3, v253 op_sel_hi:[0,1]
    v_mfma_f32_16x16x32_bf16 v[100:103], a[236:239], v[240:243], v[100:103]
    s_waitcnt lgkmcnt(12)
    ds_read_u16 v252, v252
    ds_read_u16_d16_hi v251, v251
    v_mad_u32_u16 v0, v253, 2, s85
    v_mfma_f32_16x16x32_bf16 v[108:111], a[236:239], v[244:247], v[108:111]
    s_waitcnt lgkmcnt(12)
    ds_read_b128 a[236:239], v24 offset:27648
    ds_read_u16 v0, v0
    v_mad_u32_u16 v253, v253, 2, s85 op_sel:[1,0,0,0]
    v_mfma_f32_16x16x32_bf16 v[68:71], a[244:247], v[232:235], v[68:71]
    s_waitcnt lgkmcnt(13)
    ds_read_u16_d16_hi v253, v253
    v_or_b32 v232, v220, v219
    v_or_b32 v233, v222, v221
    v_mfma_f32_16x16x32_bf16 v[76:79], a[244:247], v[236:239], v[76:79]
    v_or_b32 v234, v224, v223
    v_or_b32 v235, v226, v225
    v_or_b32 v236, v228, v227
    v_mfma_f32_16x16x32_bf16 v[112:115], a[240:243], v[240:243], v[112:115]
    s_waitcnt lgkmcnt(9)
    v_or_b32 v237, v230, v229
    v_or_b32 v238, v248, v231
    v_pk_lshrrev_b16 v208, 3, v208 op_sel_hi:[0,1]
    v_mfma_f32_16x16x32_bf16 v[120:123], a[240:243], v[244:247], v[120:123]
    ds_read_b128 a[240:243], v24 offset:28672
    v_mad_u32_u16 v209, v208, 2, s85
    v_mad_u32_u16 v208, v208, 2, s85 op_sel:[1,0,0,0]
    v_mfma_f32_16x16x32_bf16 v[116:119], a[244:247], v[240:243], v[116:119]
    s_waitcnt lgkmcnt(7)
    ds_read_u16 v209, v209
    ds_read_u16_d16_hi v208, v208
    v_or_b32 v239, v250, v249
    v_mfma_f32_16x16x32_bf16 v[124:127], a[244:247], v[244:247], v[124:127]
    ds_read_b128 a[244:247], v24 offset:29696
    v_pk_lshrrev_b16 v210, 3, v210 op_sel_hi:[0,1]
    v_mad_u32_u16 v211, v210, 2, s85
    v_mfma_f32_16x16x32_f16 v[176:179], a[248:251], v[128:131], 0
    ds_read_u16 v211, v211
    v_mad_u32_u16 v210, v210, 2, s85 op_sel:[1,0,0,0]
    v_pk_lshrrev_b16 v212, 3, v212 op_sel_hi:[0,1]
    v_mfma_f32_16x16x32_f16 v[184:187], a[248:251], v[132:135], 0
    ds_read_u16_d16_hi v210, v210
    v_mad_u32_u16 v213, v212, 2, s85
    v_mad_u32_u16 v212, v212, 2, s85 op_sel:[1,0,0,0]
    v_mfma_f32_16x16x32_f16 v[180:183], a[252:255], v[128:131], 0
    ds_read_u16 v213, v213
    ds_read_u16_d16_hi v212, v212
    v_pk_lshrrev_b16 v214, 3, v214 op_sel_hi:[0,1]
    v_mfma_f32_16x16x32_f16 v[188:191], a[252:255], v[132:135], 0
    s_add_u32 m0, s56, 3072
    v_mad_u32_u16 v215, v214, 2, s85
    v_mad_u32_u16 v214, v214, 2, s85 op_sel:[1,0,0,0]
    v_pk_lshrrev_b16 v216, 3, v216 op_sel_hi:[0,1]
    v_mfma_f32_16x16x32_f16 v[192:195], a[248:251], v[152:155], 0
    s_waitcnt lgkmcnt(12)
    ds_read_u16 v215, v215
    ds_read_u16_d16_hi v214, v214
    buffer_load_dwordx4 v4, s[20:23], 0 offen offset:0 lds
    v_mfma_f32_16x16x32_f16 v[200:203], a[248:251], v[156:159], 0
    s_waitcnt lgkmcnt(13)
    ds_read_b128 a[248:251], v24 offset:18432
    v_mad_u32_u16 v217, v216, 2, s85
    v_mad_u32_u16 v216, v216, 2, s85 op_sel:[1,0,0,0]
    v_mfma_f32_16x16x32_f16 v[176:179], a[232:235], v[136:139], v[176:179]
    s_waitcnt lgkmcnt(12)
    ds_read_u16 v217, v217
    ds_read_u16_d16_hi v216, v216
    v_pk_lshrrev_b16 v218, 3, v218 op_sel_hi:[0,1]
    v_mfma_f32_16x16x32_f16 v[184:187], a[232:235], v[140:143], v[184:187]
    v_mad_u32_u16 v219, v218, 2, s85
    v_mad_u32_u16 v218, v218, 2, s85 op_sel:[1,0,0,0]
    v_or_b32 v240, v252, v251
    v_mfma_f32_16x16x32_f16 v[196:199], a[252:255], v[152:155], 0
    s_waitcnt lgkmcnt(12)
    ds_read_u16 v219, v219
    ds_read_u16_d16_hi v218, v218
    v_or_b32 v241, v0, v253
    v_mfma_f32_16x16x32_f16 v[204:207], a[252:255], v[156:159], 0
    s_waitcnt lgkmcnt(12)
    ds_read_b128 a[252:255], v24 offset:19456
    v_or_b32 v242, v209, v208
    v_mfma_f32_16x16x32_f16 v[180:183], a[236:239], v[136:139], v[180:183]
    v_mfma_f32_16x16x32_f16 v[188:191], a[236:239], v[140:143], v[188:191]
    v_mfma_f32_16x16x32_f16 v[192:195], a[232:235], v[160:163], v[192:195]
    s_waitcnt lgkmcnt(11)
    s_waitcnt lgkmcnt(10)
    v_or_b32 v243, v211, v210
    v_mfma_f32_16x16x32_f16 v[200:203], a[232:235], v[164:167], v[200:203]
    ds_read_b128 a[232:235], v24 offset:20480
    v_mfma_f32_16x16x32_f16 v[176:179], a[240:243], v[144:147], v[176:179]
    v_mfma_f32_16x16x32_f16 v[184:187], a[240:243], v[148:151], v[184:187]
    s_add_u32 m0, s56, 4096
    v_mfma_f32_16x16x32_f16 v[196:199], a[236:239], v[160:163], v[196:199]
    buffer_load_dwordx4 v5, s[20:23], 0 offen offset:0 lds
    v_mfma_f32_16x16x32_f16 v[204:207], a[236:239], v[164:167], v[204:207]
    s_waitcnt lgkmcnt(9)
    ds_read_b128 a[236:239], v24 offset:21504
    v_or_b32 v244, v213, v212
    v_mfma_f32_16x16x32_f16 v[180:183], a[244:247], v[144:147], v[180:183]
    v_cvt_pkrtz_f16_f32 v220, v176, v177
    v_pk_lshrrev_b16 v220, 3, v220 op_sel_hi:[0,1]
    v_mad_u32_u16 v221, v220, 2, s85
    v_mfma_f32_16x16x32_f16 v[188:191], a[244:247], v[148:151], v[188:191]
    s_waitcnt lgkmcnt(8)
    ds_read_u16 v221, v221
    v_or_b32 v245, v215, v214
    v_mad_u32_u16 v220, v220, 2, s85 op_sel:[1,0,0,0]
    v_mfma_f32_16x16x32_f16 v[192:195], a[240:243], v[168:171], v[192:195]
    ds_read_u16_d16_hi v220, v220
    v_cvt_pkrtz_f16_f32 v222, v178, v179
    v_pk_lshrrev_b16 v222, 3, v222 op_sel_hi:[0,1]
    v_mfma_f32_16x16x32_f16 v[200:203], a[240:243], v[172:175], v[200:203]
    ds_read_b128 a[240:243], v24 offset:22528
    v_mad_u32_u16 v223, v222, 2, s85
    v_mad_u32_u16 v222, v222, 2, s85 op_sel:[1,0,0,0]
    v_mfma_f32_16x16x32_f16 v[196:199], a[244:247], v[168:171], v[196:199]
    s_waitcnt lgkmcnt(8)
    ds_read_u16 v223, v223
    ds_read_u16_d16_hi v222, v222
    v_or_b32 v246, v217, v216
    v_mfma_f32_16x16x32_f16 v[204:207], a[244:247], v[172:175], v[204:207]
    ds_read_b128 a[244:247], v24 offset:23552
    v_cvt_pkrtz_f16_f32 v224, v180, v181
    v_pk_lshrrev_b16 v224, 3, v224 op_sel_hi:[0,1]
    v_mfma_f32_16x16x32_bf16 v[32:35], a[248:251], v[232:235], v[32:35]
    s_add_u32 m0, s56, 5120
    v_mad_u32_u16 v225, v224, 2, s85
    v_mad_u32_u16 v224, v224, 2, s85 op_sel:[1,0,0,0]
    v_cvt_pkrtz_f16_f32 v226, v182, v183
    v_mfma_f32_16x16x32_bf16 v[40:43], a[248:251], v[236:239], v[40:43]
    ds_read_u16 v225, v225
    ds_read_u16_d16_hi v224, v224
    buffer_load_dwordx4 v6, s[20:23], 0 offen offset:0 lds
    s_waitcnt lgkmcnt(10)
    v_mfma_f32_16x16x32_bf16 v[36:39], a[252:255], v[232:235], v[36:39]
    v_or_b32 v247, v219, v218
    v_pk_lshrrev_b16 v226, 3, v226 op_sel_hi:[0,1]
    v_mad_u32_u16 v227, v226, 2, s85
    v_mfma_f32_16x16x32_bf16 v[44:47], a[252:255], v[236:239], v[44:47]
    ds_read_u16 v227, v227
    v_mad_u32_u16 v226, v226, 2, s85 op_sel:[1,0,0,0]
    v_cvt_pkrtz_f16_f32 v228, v184, v185
    v_mfma_f32_16x16x32_bf16 v[80:83], a[248:251], v[240:243], v[80:83]
    ds_read_u16_d16_hi v226, v226
    v_pk_lshrrev_b16 v228, 3, v228 op_sel_hi:[0,1]
    v_mad_u32_u16 v229, v228, 2, s85
    v_mfma_f32_16x16x32_bf16 v[88:91], a[248:251], v[244:247], v[88:91]
    s_waitcnt lgkmcnt(11)
    ds_read_u16 v229, v229
    ds_read_b128 a[248:251], v24 offset:36864
    v_mad_u32_u16 v228, v228, 2, s85 op_sel:[1,0,0,0]
    v_mfma_f32_16x16x32_bf16 v[48:51], a[232:235], v[232:235], v[48:51]
    ds_read_u16_d16_hi v228, v228
    v_cvt_pkrtz_f16_f32 v230, v186, v187
    v_pk_lshrrev_b16 v230, 3, v230 op_sel_hi:[0,1]
    v_mfma_f32_16x16x32_bf16 v[56:59], a[232:235], v[236:239], v[56:59]
    v_mad_u32_u16 v231, v230, 2, s85
    v_mad_u32_u16 v230, v230, 2, s85 op_sel:[1,0,0,0]
    v_cvt_pkrtz_f16_f32 v248, v188, v189
    v_mfma_f32_16x16x32_bf16 v[84:87], a[252:255], v[240:243], v[84:87]
    s_waitcnt lgkmcnt(12)
    ds_read_u16 v231, v231
    ds_read_u16_d16_hi v230, v230
    v_pk_lshrrev_b16 v248, 3, v248 op_sel_hi:[0,1]
    v_mfma_f32_16x16x32_bf16 v[92:95], a[252:255], v[244:247], v[92:95]
    s_waitcnt lgkmcnt(13)
    ds_read_b128 a[252:255], v24 offset:37888
    v_mad_u32_u16 v249, v248, 2, s85
    v_mad_u32_u16 v248, v248, 2, s85 op_sel:[1,0,0,0]
    v_mfma_f32_16x16x32_bf16 v[52:55], a[236:239], v[232:235], v[52:55]
    s_waitcnt lgkmcnt(12)
    ds_read_u16 v249, v249
    ds_read_u16_d16_hi v248, v248
    v_cvt_pkrtz_f16_f32 v252, v190, v191
    v_mfma_f32_16x16x32_bf16 v[60:63], a[236:239], v[236:239], v[60:63]
    v_pk_fma_f16 v250, v252, v252, s53
    v_pk_mul_f16 v250, v250, v252 neg_lo:[1,0] neg_hi:[1,0]
    v_exp_f16 v251, v250
    v_mfma_f32_16x16x32_bf16 v[96:99], a[232:235], v[240:243], v[96:99]
    v_exp_f16_sdwa v251, v250 dst_sel:WORD_1 dst_unused:UNUSED_PRESERVE src0_sel:WORD_1
    v_cvt_pkrtz_f16_f32 v253, v192, v193
    v_mfma_f32_16x16x32_bf16 v[104:107], a[232:235], v[244:247], v[104:107]
    s_waitcnt lgkmcnt(13)
    ds_read_b128 a[232:235], v24 offset:38912
    v_pk_fma_f16 v251, v251, s86, s86
    v_rcp_f16 v250, v251
    v_mfma_f32_16x16x32_bf16 v[64:67], a[240:243], v[232:235], v[64:67]
    v_rcp_f16_sdwa v250, v251 dst_sel:WORD_1 dst_unused:UNUSED_PRESERVE src0_sel:WORD_1
    v_pk_lshrrev_b16 v253, 3, v253 op_sel_hi:[0,1]
    v_mfma_f32_16x16x32_bf16 v[72:75], a[240:243], v[236:239], v[72:75]
    v_fma_mix_f32 v251, v250, v252, 0 op_sel_hi:[1,1,0]
    v_fma_mix_f32 v250, v250, v252, 0 op_sel:[1,1,0] op_sel_hi:[1,1,0]
    v_cvt_pkrtz_f16_f32 v208, v194, v195
    v_mfma_f32_16x16x32_bf16 v[100:103], a[236:239], v[240:243], v[100:103]
    v_cvt_pkrtz_f16_f32 v210, v196, v197
    v_cvt_pkrtz_f16_f32 v212, v198, v199
    v_cvt_pkrtz_f16_f32 v214, v200, v201
    v_mfma_f32_16x16x32_bf16 v[108:111], a[236:239], v[244:247], v[108:111]
    s_waitcnt lgkmcnt(13)
    ds_read_b128 a[236:239], v24 offset:39936
    v_cvt_pkrtz_f16_f32 v216, v202, v203
    v_cvt_pkrtz_f16_f32 v218, v204, v205
    v_mfma_f32_16x16x32_bf16 v[68:71], a[244:247], v[232:235], v[68:71]
    s_waitcnt lgkmcnt(12)
    v_or_b32 v232, v221, v220
    v_or_b32 v233, v223, v222
    v_or_b32 v234, v225, v224
    v_mfma_f32_16x16x32_bf16 v[76:79], a[244:247], v[236:239], v[76:79]
    s_waitcnt lgkmcnt(7)
    v_or_b32 v235, v227, v226
    v_or_b32 v236, v229, v228
    v_cvt_pk_bf16_f32 v239, v251, v250
    v_mfma_f32_16x16x32_bf16 v[112:115], a[240:243], v[240:243], v[112:115]
    v_cvt_pkrtz_f16_f32 v220, v206, v207
    v_mad_u32_u16 v0, v253, 2, s85
    v_mad_u32_u16 v253, v253, 2, s85 op_sel:[1,0,0,0]
    v_mfma_f32_16x16x32_bf16 v[120:123], a[240:243], v[244:247], v[120:123]
    ds_read_b128 a[240:243], v24 offset:40960
    ds_read_u16 v0, v0
    ds_read_u16_d16_hi v253, v253
    v_mfma_f32_16x16x32_bf16 v[116:119], a[244:247], v[240:243], v[116:119]
    s_waitcnt lgkmcnt(8)
    v_or_b32 v237, v231, v230
    v_pk_lshrrev_b16 v208, 3, v208 op_sel_hi:[0,1]
    v_mad_u32_u16 v209, v208, 2, s85
    v_mfma_f32_16x16x32_bf16 v[124:127], a[244:247], v[244:247], v[124:127]
    ds_read_b128 a[244:247], v24 offset:41984
    ds_read_u16 v209, v209
    v_mad_u32_u16 v208, v208, 2, s85 op_sel:[1,0,0,0]
    v_mfma_f32_16x16x32_f16 v[176:179], a[248:251], v[128:131], 0
    ds_read_u16_d16_hi v208, v208
    v_pk_lshrrev_b16 v210, 3, v210 op_sel_hi:[0,1]
    v_mad_u32_u16 v211, v210, 2, s85
    v_mfma_f32_16x16x32_f16 v[184:187], a[248:251], v[132:135], 0
    s_waitcnt lgkmcnt(8)
    ds_read_u16 v211, v211
    v_or_b32 v238, v249, v248
    v_mad_u32_u16 v210, v210, 2, s85 op_sel:[1,0,0,0]
    v_mfma_f32_16x16x32_f16 v[180:183], a[252:255], v[128:131], 0
    ds_read_u16_d16_hi v210, v210
    v_pk_lshrrev_b16 v212, 3, v212 op_sel_hi:[0,1]
    v_mad_u32_u16 v213, v212, 2, s85
    v_mfma_f32_16x16x32_f16 v[188:191], a[252:255], v[132:135], 0
    s_add_u32 m0, s56, 6144
    ds_read_u16 v213, v213
    buffer_load_dword v7, s[20:23], 0 offen offset:0 lds
    v_mfma_f32_16x16x32_f16 v[192:195], a[248:251], v[152:155], 0
    v_mad_u32_u16 v212, v212, 2, s85 op_sel:[1,0,0,0]
    v_pk_lshrrev_b16 v214, 3, v214 op_sel_hi:[0,1]
    v_mad_u32_u16 v215, v214, 2, s85
    v_mfma_f32_16x16x32_f16 v[200:203], a[248:251], v[156:159], 0
    s_waitcnt lgkmcnt(10)
    ds_read_u16_d16_hi v212, v212
    ds_read_u16 v215, v215
    ds_read_b128 a[248:251], v24 offset:30720
    v_mfma_f32_16x16x32_f16 v[176:179], a[232:235], v[136:139], v[176:179]
    v_mad_u32_u16 v214, v214, 2, s85 op_sel:[1,0,0,0]
    v_pk_lshrrev_b16 v216, 3, v216 op_sel_hi:[0,1]
    v_mad_u32_u16 v217, v216, 2, s85
    v_mfma_f32_16x16x32_f16 v[184:187], a[232:235], v[140:143], v[184:187]
    s_waitcnt lgkmcnt(12)
    ds_read_u16_d16_hi v214, v214
    ds_read_u16 v217, v217
    v_mad_u32_u16 v216, v216, 2, s85 op_sel:[1,0,0,0]
    v_mfma_f32_16x16x32_f16 v[196:199], a[252:255], v[152:155], 0
    s_waitcnt lgkmcnt(13)
    ds_read_u16_d16_hi v216, v216
    v_pk_lshrrev_b16 v218, 3, v218 op_sel_hi:[0,1]
    v_mad_u32_u16 v219, v218, 2, s85
    v_mfma_f32_16x16x32_f16 v[204:207], a[252:255], v[156:159], 0
    s_waitcnt lgkmcnt(12)
    ds_read_u16 v219, v219
    ds_read_b128 a[252:255], v24 offset:31744
    v_mad_u32_u16 v218, v218, 2, s85 op_sel:[1,0,0,0]
    v_mfma_f32_16x16x32_f16 v[180:183], a[236:239], v[136:139], v[180:183]
    s_waitcnt lgkmcnt(13)
    ds_read_u16_d16_hi v218, v218
    v_pk_lshrrev_b16 v220, 3, v220 op_sel_hi:[0,1]
    v_mad_u32_u16 v221, v220, 2, s85
    v_mfma_f32_16x16x32_f16 v[188:191], a[236:239], v[140:143], v[188:191]
    s_waitcnt lgkmcnt(13)
    ds_read_u16 v221, v221
    v_mad_u32_u16 v220, v220, 2, s85 op_sel:[1,0,0,0]
    v_or_b32 v240, v0, v253
    v_mfma_f32_16x16x32_f16 v[192:195], a[232:235], v[160:163], v[192:195]
    s_waitcnt lgkmcnt(11)
    ds_read_u16_d16_hi v220, v220
    v_or_b32 v241, v209, v208
    v_or_b32 v242, v211, v210
    v_mfma_f32_16x16x32_f16 v[200:203], a[232:235], v[164:167], v[200:203]
    ds_read_b128 a[232:235], v24 offset:32768
    v_mfma_f32_16x16x32_f16 v[176:179], a[240:243], v[144:147], v[176:179]
    v_mfma_f32_16x16x32_f16 v[184:187], a[240:243], v[148:151], v[184:187]
    s_waitcnt lgkmcnt(11)
    v_or_b32 v243, v213, v212
    v_mfma_f32_16x16x32_f16 v[196:199], a[236:239], v[160:163], v[196:199]
    v_mfma_f32_16x16x32_f16 v[204:207], a[236:239], v[164:167], v[204:207]
    ds_read_b128 a[236:239], v24 offset:33792
    v_mfma_f32_16x16x32_f16 v[180:183], a[244:247], v[144:147], v[180:183]
    s_nop 0
    v_cvt_pkrtz_f16_f32 v222, v176, v177
    v_pk_lshrrev_b16 v222, 3, v222 op_sel_hi:[0,1]
    v_mfma_f32_16x16x32_f16 v[188:191], a[244:247], v[148:151], v[188:191]
    s_waitcnt lgkmcnt(9)
    v_or_b32 v244, v215, v214
    v_mad_u32_u16 v223, v222, 2, s85
    v_mad_u32_u16 v222, v222, 2, s85 op_sel:[1,0,0,0]
    v_mfma_f32_16x16x32_f16 v[192:195], a[240:243], v[168:171], v[192:195]
    ds_read_u16 v223, v223
    ds_read_u16_d16_hi v222, v222
    v_cvt_pkrtz_f16_f32 v224, v178, v179
    v_mfma_f32_16x16x32_f16 v[200:203], a[240:243], v[172:175], v[200:203]
    ds_read_b128 a[240:243], v24 offset:34816
    v_pk_lshrrev_b16 v224, 3, v224 op_sel_hi:[0,1]
    v_mad_u32_u16 v225, v224, 2, s85
    v_mfma_f32_16x16x32_f16 v[196:199], a[244:247], v[168:171], v[196:199]
    s_waitcnt lgkmcnt(10)
    ds_read_u16 v225, v225
    v_or_b32 v245, v217, v216
    v_mad_u32_u16 v224, v224, 2, s85 op_sel:[1,0,0,0]
    v_mfma_f32_16x16x32_f16 v[204:207], a[244:247], v[172:175], v[204:207]
    ds_read_b128 a[244:247], v24 offset:35840
    ds_read_u16_d16_hi v224, v224
    v_cvt_pkrtz_f16_f32 v226, v180, v181
    v_mfma_f32_16x16x32_bf16 v[32:35], a[248:251], v[232:235], v[32:35]
    v_pk_lshrrev_b16 v226, 3, v226 op_sel_hi:[0,1]
    v_mad_u32_u16 v227, v226, 2, s85
    v_mad_u32_u16 v226, v226, 2, s85 op_sel:[1,0,0,0]
    v_mfma_f32_16x16x32_bf16 v[40:43], a[248:251], v[236:239], v[40:43]
    s_waitcnt lgkmcnt(10)
    ds_read_u16 v227, v227
    ds_read_u16_d16_hi v226, v226
    v_or_b32 v246, v219, v218
    v_mfma_f32_16x16x32_bf16 v[36:39], a[252:255], v[232:235], v[36:39]
    v_cvt_pkrtz_f16_f32 v228, v182, v183
    v_pk_lshrrev_b16 v228, 3, v228 op_sel_hi:[0,1]
    v_mad_u32_u16 v229, v228, 2, s85
    v_mfma_f32_16x16x32_bf16 v[44:47], a[252:255], v[236:239], v[44:47]
    ds_read_u16 v229, v229
    v_mad_u32_u16 v228, v228, 2, s85 op_sel:[1,0,0,0]
    v_cvt_pkrtz_f16_f32 v230, v184, v185
    v_mfma_f32_16x16x32_bf16 v[80:83], a[248:251], v[240:243], v[80:83]
    s_waitcnt lgkmcnt(11)
    ds_read_u16_d16_hi v228, v228
    v_or_b32 v247, v221, v220
    v_pk_lshrrev_b16 v230, 3, v230 op_sel_hi:[0,1]
    v_mad_u32_u16 v231, v230, 2, s85
    v_mfma_f32_16x16x32_bf16 v[88:91], a[248:251], v[244:247], v[88:91]
    s_waitcnt lgkmcnt(11)
    ds_read_u16 v231, v231
    ds_read_b128 a[248:251], v24 offset:43008
    v_mad_u32_u16 v230, v230, 2, s85 op_sel:[1,0,0,0]
    v_mfma_f32_16x16x32_bf16 v[48:51], a[232:235], v[232:235], v[48:51]
    v_cvt_pkrtz_f16_f32 v248, v186, v187
    v_pk_lshrrev_b16 v248, 3, v248 op_sel_hi:[0,1]
    v_mad_u32_u16 v249, v248, 2, s85
    v_mfma_f32_16x16x32_bf16 v[56:59], a[232:235], v[236:239], v[56:59]
    ds_read_u16_d16_hi v230, v230
    v_mad_u32_u16 v248, v248, 2, s85 op_sel:[1,0,0,0]
    v_cvt_pkrtz_f16_f32 v250, v188, v189
    v_mfma_f32_16x16x32_bf16 v[84:87], a[252:255], v[240:243], v[84:87]
    s_waitcnt lgkmcnt(13)
    ds_read_u16 v249, v249
    v_pk_lshrrev_b16 v250, 3, v250 op_sel_hi:[0,1]
    v_mad_u32_u16 v251, v250, 2, s85
    v_mfma_f32_16x16x32_bf16 v[92:95], a[252:255], v[244:247], v[92:95]
    s_waitcnt lgkmcnt(13)
    ds_read_u16_d16_hi v248, v248
    v_mad_u32_u16 v250, v250, 2, s85 op_sel:[1,0,0,0]
    v_cvt_pkrtz_f16_f32 v252, v190, v191
    v_mfma_f32_16x16x32_bf16 v[52:55], a[236:239], v[232:235], v[52:55]
    s_waitcnt lgkmcnt(13)
    ds_read_u16 v251, v251
    v_pk_lshrrev_b16 v252, 3, v252 op_sel_hi:[0,1]
    v_mad_u32_u16 v253, v252, 2, s85
    v_mfma_f32_16x16x32_bf16 v[60:63], a[236:239], v[236:239], v[60:63]
    s_waitcnt lgkmcnt(13)
    ds_read_u16_d16_hi v250, v250
    v_mad_u32_u16 v252, v252, 2, s85 op_sel:[1,0,0,0]
    v_cvt_pkrtz_f16_f32 v0, v192, v193
    v_mfma_f32_16x16x32_bf16 v[96:99], a[232:235], v[240:243], v[96:99]
    v_pk_lshrrev_b16 v0, 3, v0 op_sel_hi:[0,1]
    v_cvt_pkrtz_f16_f32 v209, v194, v195
    v_cvt_pkrtz_f16_f32 v211, v196, v197
    v_mfma_f32_16x16x32_bf16 v[104:107], a[232:235], v[244:247], v[104:107]
    s_waitcnt lgkmcnt(13)
    ds_read_u16 v253, v253
    buffer_load_dword v254, v31, s[20:23], 0 offen
    v_cvt_pkrtz_f16_f32 v213, v198, v199
    v_mfma_f32_16x16x32_bf16 v[64:67], a[240:243], v[232:235], v[64:67]
    s_waitcnt lgkmcnt(13)
    ds_read_u16_d16_hi v252, v252
    v_cvt_pkrtz_f16_f32 v215, v200, v201
    v_cvt_pkrtz_f16_f32 v217, v202, v203
    v_mfma_f32_16x16x32_bf16 v[72:75], a[240:243], v[236:239], v[72:75]
    s_waitcnt lgkmcnt(13)
    ds_read_b128 a[252:255], v24 offset:44032
    v_cvt_pkrtz_f16_f32 v219, v204, v205
    v_cvt_pkrtz_f16_f32 v221, v206, v207
    v_mfma_f32_16x16x32_bf16 v[100:103], a[236:239], v[240:243], v[100:103]
    v_mad_u32_u16 v208, v0, 2, s85
    v_mad_u32_u16 v0, v0, 2, s85 op_sel:[1,0,0,0]
    v_pk_lshrrev_b16 v209, 3, v209 op_sel_hi:[0,1]
    v_mfma_f32_16x16x32_bf16 v[108:111], a[236:239], v[244:247], v[108:111]
    s_waitcnt lgkmcnt(13)
    ds_read_b128 a[232:235], v24 offset:45056
    v_mad_u32_u16 v210, v209, 2, s85
    v_mad_u32_u16 v209, v209, 2, s85 op_sel:[1,0,0,0]
    v_mfma_f32_16x16x32_bf16 v[68:71], a[244:247], v[232:235], v[68:71]
    s_waitcnt lgkmcnt(13)
    ds_read_b128 a[236:239], v24 offset:46080
    v_or_b32 v232, v223, v222
    v_or_b32 v233, v225, v224
    v_mfma_f32_16x16x32_bf16 v[76:79], a[244:247], v[236:239], v[76:79]
    s_waitcnt lgkmcnt(12)
    ds_read_u16 v208, v208
    v_or_b32 v234, v227, v226
    v_or_b32 v235, v229, v228
    v_mfma_f32_16x16x32_bf16 v[112:115], a[240:243], v[240:243], v[112:115]
    ds_read_u16_d16_hi v0, v0
    v_pk_lshrrev_b16 v211, 3, v211 op_sel_hi:[0,1]
    v_mad_u32_u16 v212, v211, 2, s85
    v_mfma_f32_16x16x32_bf16 v[120:123], a[240:243], v[244:247], v[120:123]
    s_waitcnt lgkmcnt(11)
    ds_read_b128 a[240:243], v24 offset:47104
    v_or_b32 v236, v231, v230
    v_mad_u32_u16 v211, v211, 2, s85 op_sel:[1,0,0,0]
    v_mfma_f32_16x16x32_bf16 v[116:119], a[244:247], v[240:243], v[116:119]
    v_pk_lshrrev_b16 v213, 3, v213 op_sel_hi:[0,1]
    v_mad_u32_u16 v214, v213, 2, s85
    v_mad_u32_u16 v213, v213, 2, s85 op_sel:[1,0,0,0]
    v_mfma_f32_16x16x32_bf16 v[124:127], a[244:247], v[244:247], v[124:127]
    ds_read_b128 a[244:247], v24 offset:48128
    v_pk_lshrrev_b16 v215, 3, v215 op_sel_hi:[0,1]
    v_mad_u32_u16 v216, v215, 2, s85
    v_mfma_f32_16x16x32_f16 v[176:179], a[0:3], v[128:131], 0
    s_waitcnt lgkmcnt(11)
    ds_read_u16 v210, v210
    v_or_b32 v237, v249, v248
    v_mad_u32_u16 v215, v215, 2, s85 op_sel:[1,0,0,0]
    v_mfma_f32_16x16x32_bf16 v[32:35], a[248:251], v[232:235], v[32:35]
    v_pk_lshrrev_b16 v217, 3, v217 op_sel_hi:[0,1]
    v_mad_u32_u16 v218, v217, 2, s85
    v_mad_u32_u16 v217, v217, 2, s85 op_sel:[1,0,0,0]
    v_mfma_f32_16x16x32_f16 v[180:183], a[4:7], v[128:131], 0
    s_waitcnt lgkmcnt(11)
    ds_read_u16_d16_hi v209, v209
    v_pk_lshrrev_b16 v219, 3, v219 op_sel_hi:[0,1]
    s_waitcnt lgkmcnt(11)
    v_or_b32 v238, v251, v250
    v_mad_u32_u16 v220, v219, 2, s85
    v_mad_u32_u16 v219, v219, 2, s85 op_sel:[1,0,0,0]
    v_pk_lshrrev_b16 v221, 3, v221 op_sel_hi:[0,1]
    v_mad_u32_u16 v222, v221, 2, s85
    v_mad_u32_u16 v221, v221, 2, s85 op_sel:[1,0,0,0]
    ds_read_u16 v212, v212
    ds_read_u16_d16_hi v211, v211
    s_waitcnt lgkmcnt(11)
    v_or_b32 v239, v253, v252
    s_waitcnt lgkmcnt(10)
    v_mfma_f32_16x16x32_bf16 v[36:39], a[252:255], v[232:235], v[36:39]
    ds_read_u16 v214, v214
    ds_read_u16_d16_hi v213, v213
    ds_read_u16 v216, v216
    v_mfma_f32_16x16x32_f16 v[176:179], a[8:11], v[136:139], v[176:179]
    s_waitcnt lgkmcnt(12)
    v_mfma_f32_16x16x32_bf16 v[48:51], a[232:235], v[232:235], v[48:51]
    ds_read_u16_d16_hi v215, v215
    v_mfma_f32_16x16x32_f16 v[180:183], a[12:15], v[136:139], v[180:183]
    s_waitcnt lgkmcnt(12)
    ds_read_u16 v218, v218
    v_mfma_f32_16x16x32_bf16 v[52:55], a[236:239], v[232:235], v[52:55]
    v_mfma_f32_16x16x32_f16 v[176:179], a[16:19], v[144:147], v[176:179]
    s_waitcnt lgkmcnt(11)
    ds_read_u16_d16_hi v217, v217
    v_or_b32 v240, v208, v0
    s_waitcnt lgkmcnt(11)
    v_mfma_f32_16x16x32_bf16 v[64:67], a[240:243], v[232:235], v[64:67]
    ds_read_u16 v220, v220
    v_mfma_f32_16x16x32_f16 v[180:183], a[20:23], v[144:147], v[180:183]
    s_waitcnt lgkmcnt(11)
    ds_read_u16_d16_hi v219, v219
    v_mfma_f32_16x16x32_bf16 v[68:71], a[244:247], v[232:235], v[68:71]
    v_cvt_pkrtz_f16_f32 v223, v176, v177
    v_pk_lshrrev_b16 v223, 3, v223 op_sel_hi:[0,1]
    v_mad_u32_u16 v224, v223, 2, s85
    v_mfma_f32_16x16x32_f16 v[184:187], a[0:3], v[132:135], 0
    ds_read_u16 v222, v222
    v_mad_u32_u16 v223, v223, 2, s85 op_sel:[1,0,0,0]
    v_cvt_pkrtz_f16_f32 v225, v178, v179
    v_mfma_f32_16x16x32_bf16 v[40:43], a[248:251], v[236:239], v[40:43]
    s_waitcnt lgkmcnt(11)
    ds_read_u16_d16_hi v221, v221
    v_or_b32 v241, v210, v209
    v_pk_lshrrev_b16 v225, 3, v225 op_sel_hi:[0,1]
    v_mfma_f32_16x16x32_f16 v[188:191], a[4:7], v[132:135], 0
    ds_read_u16 v224, v224
    v_mad_u32_u16 v226, v225, 2, s85
    v_mad_u32_u16 v225, v225, 2, s85 op_sel:[1,0,0,0]
    v_mfma_f32_16x16x32_bf16 v[44:47], a[252:255], v[236:239], v[44:47]
    s_waitcnt lgkmcnt(11)
    v_cvt_pkrtz_f16_f32 v227, v180, v181
    v_or_b32 v242, v212, v211
    v_pk_lshrrev_b16 v227, 3, v227 op_sel_hi:[0,1]
    v_mfma_f32_16x16x32_f16 v[184:187], a[8:11], v[140:143], v[184:187]
    ds_read_u16_d16_hi v223, v223
    v_mad_u32_u16 v228, v227, 2, s85
    v_mad_u32_u16 v227, v227, 2, s85 op_sel:[1,0,0,0]
    v_mfma_f32_16x16x32_bf16 v[56:59], a[232:235], v[236:239], v[56:59]
    ds_read_u16 v226, v226
    v_cvt_pkrtz_f16_f32 v229, v182, v183
    v_pk_lshrrev_b16 v229, 3, v229 op_sel_hi:[0,1]
    v_mfma_f32_16x16x32_f16 v[188:191], a[12:15], v[140:143], v[188:191]
    s_waitcnt lgkmcnt(11)
    ds_read_u16_d16_hi v225, v225
    v_or_b32 v243, v214, v213
    v_mad_u32_u16 v230, v229, 2, s85
    v_mfma_f32_16x16x32_bf16 v[60:63], a[236:239], v[236:239], v[60:63]
    v_mad_u32_u16 v229, v229, 2, s85 op_sel:[1,0,0,0]
    v_mfma_f32_16x16x32_f16 v[184:187], a[16:19], v[148:151], v[184:187]
    ds_read_u16 v228, v228
    v_mfma_f32_16x16x32_f16 v[188:191], a[20:23], v[148:151], v[188:191]
    s_waitcnt lgkmcnt(11)
    ds_read_u16_d16_hi v227, v227
    v_or_b32 v244, v216, v215
    v_mfma_f32_16x16x32_bf16 v[72:75], a[240:243], v[236:239], v[72:75]
    v_mfma_f32_16x16x32_bf16 v[76:79], a[244:247], v[236:239], v[76:79]
    ds_read_u16 v230, v230
    v_mfma_f32_16x16x32_f16 v[176:179], a[48:51], v[128:131], 0
    s_waitcnt lgkmcnt(12)
    v_cvt_pkrtz_f16_f32 v231, v184, v185
    v_pk_lshrrev_b16 v231, 3, v231 op_sel_hi:[0,1]
    s_waitcnt lgkmcnt(11)
    v_or_b32 v245, v218, v217
    v_mfma_f32_16x16x32_bf16 v[80:83], a[248:251], v[240:243], v[80:83]
    ds_read_u16_d16_hi v229, v229
    v_mad_u32_u16 v248, v231, 2, s85
    v_mad_u32_u16 v231, v231, 2, s85 op_sel:[1,0,0,0]
    v_mfma_f32_16x16x32_f16 v[180:183], a[52:55], v[128:131], 0
    ds_read_u16 v248, v248
    v_cvt_pkrtz_f16_f32 v249, v186, v187
    v_pk_lshrrev_b16 v249, 3, v249 op_sel_hi:[0,1]
    v_mfma_f32_16x16x32_bf16 v[84:87], a[252:255], v[240:243], v[84:87]
    s_waitcnt lgkmcnt(11)
    ds_read_u16_d16_hi v231, v231
    v_or_b32 v246, v220, v219
    v_mad_u32_u16 v250, v249, 2, s85
    v_mfma_f32_16x16x32_f16 v[176:179], a[56:59], v[136:139], v[176:179]
    v_mad_u32_u16 v249, v249, 2, s85 op_sel:[1,0,0,0]
    v_cvt_pkrtz_f16_f32 v251, v188, v189
    v_pk_lshrrev_b16 v251, 3, v251 op_sel_hi:[0,1]
    v_mfma_f32_16x16x32_bf16 v[96:99], a[232:235], v[240:243], v[96:99]
    ds_read_u16 v250, v250
    v_mad_u32_u16 v252, v251, 2, s85
    v_mad_u32_u16 v251, v251, 2, s85 op_sel:[1,0,0,0]
    v_mfma_f32_16x16x32_f16 v[180:183], a[60:63], v[136:139], v[180:183]
    s_waitcnt lgkmcnt(11)
    ds_read_u16_d16_hi v249, v249
    v_or_b32 v247, v222, v221
    v_cvt_pkrtz_f16_f32 v253, v190, v191
    v_mfma_f32_16x16x32_bf16 v[100:103], a[236:239], v[240:243], v[100:103]
    v_pk_lshrrev_b16 v253, 3, v253 op_sel_hi:[0,1]
    v_mad_u32_u16 v0, v253, 2, s85
    v_mad_u32_u16 v253, v253, 2, s85 op_sel:[1,0,0,0]
    v_mfma_f32_16x16x32_f16 v[176:179], a[64:67], v[144:147], v[176:179]
    ds_read_u16 v252, v252
    v_mfma_f32_16x16x32_bf16 v[112:115], a[240:243], v[240:243], v[112:115]
    s_waitcnt lgkmcnt(11)
    ds_read_u16_d16_hi v251, v251
    v_or_b32 v232, v224, v223
    v_mfma_f32_16x16x32_f16 v[180:183], a[68:71], v[144:147], v[180:183]
    v_mfma_f32_16x16x32_bf16 v[116:119], a[244:247], v[240:243], v[116:119]
    ds_read_u16 v0, v0
    v_mfma_f32_16x16x32_f16 v[184:187], a[48:51], v[132:135], 0
    s_waitcnt lgkmcnt(11)
    ds_read_u16_d16_hi v253, v253
    v_or_b32 v233, v226, v225
    v_cvt_pkrtz_f16_f32 v208, v176, v177
    v_mfma_f32_16x16x32_bf16 v[88:91], a[248:251], v[244:247], v[88:91]
    v_pk_lshrrev_b16 v208, 3, v208 op_sel_hi:[0,1]
    v_mad_u32_u16 v209, v208, 2, s85
    v_mad_u32_u16 v208, v208, 2, s85 op_sel:[1,0,0,0]
    v_mfma_f32_16x16x32_f16 v[188:191], a[52:55], v[132:135], 0
    ds_read_u16 v209, v209
    v_cvt_pkrtz_f16_f32 v210, v178, v179
    v_pk_lshrrev_b16 v210, 3, v210 op_sel_hi:[0,1]
    v_mfma_f32_16x16x32_bf16 v[92:95], a[252:255], v[244:247], v[92:95]
    s_waitcnt lgkmcnt(11)
    ds_read_u16_d16_hi v208, v208
    v_or_b32 v234, v228, v227
    v_mad_u32_u16 v211, v210, 2, s85
    v_mfma_f32_16x16x32_f16 v[184:187], a[56:59], v[140:143], v[184:187]
    ds_read_u16 v211, v211
    v_mad_u32_u16 v210, v210, 2, s85 op_sel:[1,0,0,0]
    v_cvt_pkrtz_f16_f32 v212, v180, v181
    v_mfma_f32_16x16x32_bf16 v[104:107], a[232:235], v[244:247], v[104:107]
    s_waitcnt lgkmcnt(12)
    v_pk_lshrrev_b16 v212, 3, v212 op_sel_hi:[0,1]
    v_mad_u32_u16 v213, v212, 2, s85
    s_waitcnt lgkmcnt(11)
    v_or_b32 v235, v230, v229
    v_mfma_f32_16x16x32_f16 v[188:191], a[60:63], v[140:143], v[188:191]
    ds_read_u16_d16_hi v210, v210
    v_mad_u32_u16 v212, v212, 2, s85 op_sel:[1,0,0,0]
    v_cvt_pkrtz_f16_f32 v214, v182, v183
    v_mfma_f32_16x16x32_bf16 v[108:111], a[236:239], v[244:247], v[108:111]
    ds_read_u16 v213, v213
    v_pk_lshrrev_b16 v214, 3, v214 op_sel_hi:[0,1]
    v_mad_u32_u16 v215, v214, 2, s85
    v_mfma_f32_16x16x32_f16 v[184:187], a[64:67], v[148:151], v[184:187]
    s_waitcnt lgkmcnt(11)
    ds_read_u16_d16_hi v212, v212
    v_or_b32 v236, v248, v231
    v_mad_u32_u16 v214, v214, 2, s85 op_sel:[1,0,0,0]
    v_mfma_f32_16x16x32_f16 v[188:191], a[68:71], v[148:151], v[188:191]
    v_mfma_f32_16x16x32_bf16 v[120:123], a[240:243], v[244:247], v[120:123]
    ds_read_u16 v215, v215
    v_mfma_f32_16x16x32_bf16 v[124:127], a[244:247], v[244:247], v[124:127]
    s_waitcnt lgkmcnt(11)
    v_cvt_pkrtz_f16_f32 v216, v184, v185
    v_or_b32 v237, v250, v249
    v_pk_lshrrev_b16 v216, 3, v216 op_sel_hi:[0,1]
    v_mfma_f32_16x16x32_f16 v[176:179], a[96:99], v[128:131], 0
    ds_read_u16_d16_hi v214, v214
    v_mad_u32_u16 v217, v216, 2, s85
    v_mad_u32_u16 v216, v216, 2, s85 op_sel:[1,0,0,0]
    v_mfma_f32_16x16x32_bf16 v[32:35], a[24:27], v[232:235], v[32:35]
    ds_read_u16 v217, v217
    v_cvt_pkrtz_f16_f32 v218, v186, v187
    v_pk_lshrrev_b16 v218, 3, v218 op_sel_hi:[0,1]
    v_mfma_f32_16x16x32_f16 v[180:183], a[100:103], v[128:131], 0
    s_waitcnt lgkmcnt(11)
    ds_read_u16_d16_hi v216, v216
    v_or_b32 v238, v252, v251
    v_mad_u32_u16 v219, v218, 2, s85
    v_mfma_f32_16x16x32_bf16 v[36:39], a[28:31], v[232:235], v[36:39]
    v_mad_u32_u16 v218, v218, 2, s85 op_sel:[1,0,0,0]
    v_cvt_pkrtz_f16_f32 v220, v188, v189
    v_pk_lshrrev_b16 v220, 3, v220 op_sel_hi:[0,1]
    v_mfma_f32_16x16x32_f16 v[176:179], a[104:107], v[136:139], v[176:179]
    ds_read_u16 v219, v219
    v_mad_u32_u16 v221, v220, 2, s85
    v_mad_u32_u16 v220, v220, 2, s85 op_sel:[1,0,0,0]
    v_mfma_f32_16x16x32_bf16 v[48:51], a[32:35], v[232:235], v[48:51]
    s_waitcnt lgkmcnt(11)
    ds_read_u16_d16_hi v218, v218
    v_or_b32 v239, v0, v253
    v_cvt_pkrtz_f16_f32 v222, v190, v191
    v_mfma_f32_16x16x32_f16 v[180:183], a[108:111], v[136:139], v[180:183]
    ds_read_u16 v221, v221
    v_pk_lshrrev_b16 v222, 3, v222 op_sel_hi:[0,1]
    v_mad_u32_u16 v223, v222, 2, s85
    v_mfma_f32_16x16x32_bf16 v[52:55], a[36:39], v[232:235], v[52:55]
    v_mad_u32_u16 v222, v222, 2, s85 op_sel:[1,0,0,0]
    v_mfma_f32_16x16x32_f16 v[176:179], a[112:115], v[144:147], v[176:179]
    ds_read_u16_d16_hi v220, v220
    v_mfma_f32_16x16x32_bf16 v[64:67], a[40:43], v[232:235], v[64:67]
    s_waitcnt lgkmcnt(13)
    ds_read_u16 v223, v223
    v_mfma_f32_16x16x32_f16 v[180:183], a[116:119], v[144:147], v[180:183]
    v_mfma_f32_16x16x32_bf16 v[68:71], a[44:47], v[232:235], v[68:71]
    s_waitcnt lgkmcnt(11)
    ds_read_u16_d16_hi v222, v222
    v_or_b32 v232, v209, v208
    v_or_b32 v233, v211, v210
    v_mfma_f32_16x16x32_f16 v[184:187], a[96:99], v[132:135], 0
    v_cvt_pkrtz_f16_f32 v224, v176, v177
    v_pk_lshrrev_b16 v224, 3, v224 op_sel_hi:[0,1]
    v_mad_u32_u16 v225, v224, 2, s85
    v_mfma_f32_16x16x32_bf16 v[40:43], a[24:27], v[236:239], v[40:43]
    s_waitcnt lgkmcnt(11)
    ds_read_u16 v225, v225
    v_mad_u32_u16 v224, v224, 2, s85 op_sel:[1,0,0,0]
    s_waitcnt lgkmcnt(11)
    v_or_b32 v234, v213, v212
    v_mfma_f32_16x16x32_f16 v[188:191], a[100:103], v[132:135], 0
    ds_read_u16_d16_hi v224, v224
    v_cvt_pkrtz_f16_f32 v226, v178, v179
    v_pk_lshrrev_b16 v226, 3, v226 op_sel_hi:[0,1]
    v_mfma_f32_16x16x32_bf16 v[44:47], a[28:31], v[236:239], v[44:47]
    v_mad_u32_u16 v227, v226, 2, s85
    v_mad_u32_u16 v226, v226, 2, s85 op_sel:[1,0,0,0]
    v_cvt_pkrtz_f16_f32 v228, v180, v181
    v_mfma_f32_16x16x32_f16 v[184:187], a[104:107], v[140:143], v[184:187]
    s_waitcnt lgkmcnt(10)
    ds_read_u16 v227, v227
    ds_read_u16_d16_hi v226, v226
    v_or_b32 v235, v215, v214
    v_mfma_f32_16x16x32_bf16 v[56:59], a[32:35], v[236:239], v[56:59]
    v_pk_lshrrev_b16 v228, 3, v228 op_sel_hi:[0,1]
    v_mad_u32_u16 v229, v228, 2, s85
    v_mad_u32_u16 v228, v228, 2, s85 op_sel:[1,0,0,0]
    v_mfma_f32_16x16x32_f16 v[188:191], a[108:111], v[140:143], v[188:191]
    ds_read_u16 v229, v229
    v_cvt_pkrtz_f16_f32 v230, v182, v183
    v_pk_lshrrev_b16 v230, 3, v230 op_sel_hi:[0,1]
    v_mfma_f32_16x16x32_bf16 v[60:63], a[36:39], v[236:239], v[60:63]
    ds_read_u16_d16_hi v228, v228
    v_mad_u32_u16 v231, v230, 2, s85
    v_mad_u32_u16 v230, v230, 2, s85 op_sel:[1,0,0,0]
    v_mfma_f32_16x16x32_f16 v[184:187], a[112:115], v[148:151], v[184:187]
    v_mfma_f32_16x16x32_f16 v[188:191], a[116:119], v[148:151], v[188:191]
    s_waitcnt lgkmcnt(13)
    ds_read_u16 v231, v231
    v_mfma_f32_16x16x32_bf16 v[72:75], a[40:43], v[236:239], v[72:75]
    s_waitcnt lgkmcnt(13)
    ds_read_u16_d16_hi v230, v230
    v_mfma_f32_16x16x32_bf16 v[76:79], a[44:47], v[236:239], v[76:79]
    s_waitcnt lgkmcnt(12)
    v_or_b32 v236, v217, v216
    v_or_b32 v237, v219, v218
    v_mfma_f32_16x16x32_f16 v[176:179], a[144:147], v[128:131], 0
    v_cvt_pkrtz_f16_f32 v248, v184, v185
    v_pk_lshrrev_b16 v248, 3, v248 op_sel_hi:[0,1]
    v_mad_u32_u16 v249, v248, 2, s85
    v_mfma_f32_16x16x32_bf16 v[32:35], a[72:75], v[232:235], v[32:35]
    s_waitcnt lgkmcnt(10)
    ds_read_u16 v249, v249
    v_or_b32 v238, v221, v220
    v_mad_u32_u16 v248, v248, 2, s85 op_sel:[1,0,0,0]
    v_mfma_f32_16x16x32_f16 v[180:183], a[148:151], v[128:131], 0
    ds_read_u16_d16_hi v248, v248
    v_cvt_pkrtz_f16_f32 v250, v186, v187
    v_pk_lshrrev_b16 v250, 3, v250 op_sel_hi:[0,1]
    v_mfma_f32_16x16x32_bf16 v[36:39], a[76:79], v[232:235], v[36:39]
    v_mad_u32_u16 v251, v250, 2, s85
    v_mad_u32_u16 v250, v250, 2, s85 op_sel:[1,0,0,0]
    v_cvt_pkrtz_f16_f32 v252, v188, v189
    v_mfma_f32_16x16x32_f16 v[176:179], a[152:155], v[136:139], v[176:179]
    s_waitcnt lgkmcnt(10)
    ds_read_u16 v251, v251
    ds_read_u16_d16_hi v250, v250
    v_or_b32 v239, v223, v222
    v_mfma_f32_16x16x32_bf16 v[48:51], a[80:83], v[232:235], v[48:51]
    v_pk_lshrrev_b16 v252, 3, v252 op_sel_hi:[0,1]
    v_mad_u32_u16 v253, v252, 2, s85
    v_mad_u32_u16 v252, v252, 2, s85 op_sel:[1,0,0,0]
    v_mfma_f32_16x16x32_f16 v[180:183], a[156:159], v[136:139], v[180:183]
    ds_read_u16 v253, v253
    v_cvt_pkrtz_f16_f32 v209, v190, v191
    v_pk_fma_f16 v0, v209, v209, s53
    v_mfma_f32_16x16x32_bf16 v[52:55], a[84:87], v[232:235], v[52:55]
    ds_read_u16_d16_hi v252, v252
    v_pk_mul_f16 v0, v0, v209 neg_lo:[1,0] neg_hi:[1,0]
    v_exp_f16 v208, v0
    v_mfma_f32_16x16x32_f16 v[176:179], a[160:163], v[144:147], v[176:179]
    v_exp_f16_sdwa v208, v0 dst_sel:WORD_1 dst_unused:UNUSED_PRESERVE src0_sel:WORD_1
    v_mfma_f32_16x16x32_bf16 v[64:67], a[88:91], v[232:235], v[64:67]
    v_pk_fma_f16 v208, v208, s86, s86
    v_rcp_f16 v0, v208
    v_mfma_f32_16x16x32_f16 v[180:183], a[164:167], v[144:147], v[180:183]
    v_rcp_f16_sdwa v0, v208 dst_sel:WORD_1 dst_unused:UNUSED_PRESERVE src0_sel:WORD_1
    v_mfma_f32_16x16x32_bf16 v[68:71], a[92:95], v[232:235], v[68:71]
    s_waitcnt lgkmcnt(12)
    v_fma_mix_f32 v208, v0, v209, 0 op_sel_hi:[1,1,0]
    v_fma_mix_f32 v0, v0, v209, 0 op_sel:[1,1,0] op_sel_hi:[1,1,0]
    v_or_b32 v232, v225, v224
    v_mfma_f32_16x16x32_f16 v[184:187], a[144:147], v[132:135], 0
    s_waitcnt lgkmcnt(8)
    v_or_b32 v233, v227, v226
    v_or_b32 v234, v229, v228
    v_cvt_pkrtz_f16_f32 v210, v176, v177
    v_mfma_f32_16x16x32_bf16 v[40:43], a[72:75], v[236:239], v[40:43]
    v_pk_lshrrev_b16 v210, 3, v210 op_sel_hi:[0,1]
    v_mad_u32_u16 v211, v210, 2, s85
    v_mad_u32_u16 v210, v210, 2, s85 op_sel:[1,0,0,0]
    v_mfma_f32_16x16x32_f16 v[188:191], a[148:151], v[132:135], 0
    ds_read_u16 v211, v211
    ds_read_u16_d16_hi v210, v210
    v_cvt_pkrtz_f16_f32 v212, v178, v179
    v_mfma_f32_16x16x32_bf16 v[44:47], a[76:79], v[236:239], v[44:47]
    s_waitcnt vmcnt(1) lgkmcnt(8)
    ds_read_b128 a[232:235], v8 offset:0
    v_or_b32 v235, v231, v230
    v_pk_lshrrev_b16 v212, 3, v212 op_sel_hi:[0,1]
    v_mfma_f32_16x16x32_f16 v[184:187], a[152:155], v[140:143], v[184:187]
    v_mad_u32_u16 v213, v212, 2, s85
    v_mad_u32_u16 v212, v212, 2, s85 op_sel:[1,0,0,0]
    v_cvt_pkrtz_f16_f32 v214, v180, v181
    v_mfma_f32_16x16x32_bf16 v[56:59], a[80:83], v[236:239], v[56:59]
    ds_read_u16 v213, v213
    ds_read_u16_d16_hi v212, v212
    v_pk_lshrrev_b16 v214, 3, v214 op_sel_hi:[0,1]
    v_mfma_f32_16x16x32_f16 v[188:191], a[156:159], v[140:143], v[188:191]
    v_mad_u32_u16 v215, v214, 2, s85
    v_mad_u32_u16 v214, v214, 2, s85 op_sel:[1,0,0,0]
    v_cvt_pkrtz_f16_f32 v216, v182, v183
    v_mfma_f32_16x16x32_bf16 v[60:63], a[84:87], v[236:239], v[60:63]
    ds_read_u16 v215, v215
    ds_read_u16_d16_hi v214, v214
    v_pk_lshrrev_b16 v216, 3, v216 op_sel_hi:[0,1]
    v_mfma_f32_16x16x32_f16 v[184:187], a[160:163], v[148:151], v[184:187]
    v_mad_u32_u16 v217, v216, 2, s85
    v_mad_u32_u16 v216, v216, 2, s85 op_sel:[1,0,0,0]
    v_mfma_f32_16x16x32_f16 v[188:191], a[164:167], v[148:151], v[188:191]
    s_waitcnt lgkmcnt(12)
    ds_read_u16 v217, v217
    ds_read_u16_d16_hi v216, v216
    v_mfma_f32_16x16x32_bf16 v[72:75], a[88:91], v[236:239], v[72:75]
    s_nop 0
    v_cvt_pkrtz_f16_f32 v218, v184, v185
    v_pk_lshrrev_b16 v218, 3, v218 op_sel_hi:[0,1]
    v_mfma_f32_16x16x32_bf16 v[76:79], a[92:95], v[236:239], v[76:79]
    s_waitcnt lgkmcnt(9)
    v_or_b32 v236, v249, v248
    v_or_b32 v237, v251, v250
    v_or_b32 v238, v253, v252
    v_mfma_f32_16x16x32_f16 v[192:195], a[0:3], v[152:155], 0
    v_cvt_pk_bf16_f32 v239, v208, v0
    v_mad_u32_u16 v219, v218, 2, s85
    v_mad_u32_u16 v218, v218, 2, s85 op_sel:[1,0,0,0]
    v_mfma_f32_16x16x32_bf16 v[32:35], a[120:123], v[232:235], v[32:35]
    ds_read_u16 v219, v219
    ds_read_u16_d16_hi v218, v218
    v_cvt_pkrtz_f16_f32 v220, v186, v187
    v_mfma_f32_16x16x32_f16 v[196:199], a[4:7], v[152:155], 0
    ds_read_b128 a[248:251], v12 offset:2560
    v_pk_lshrrev_b16 v220, 3, v220 op_sel_hi:[0,1]
    v_mad_u32_u16 v221, v220, 2, s85
    v_mfma_f32_16x16x32_bf16 v[36:39], a[124:127], v[232:235], v[36:39]
    ds_read_u16 v221, v221
    v_mad_u32_u16 v220, v220, 2, s85 op_sel:[1,0,0,0]
    v_cvt_pkrtz_f16_f32 v222, v188, v189
    v_mfma_f32_16x16x32_f16 v[192:195], a[8:11], v[160:163], v[192:195]
    ds_read_u16_d16_hi v220, v220
    v_pk_lshrrev_b16 v222, 3, v222 op_sel_hi:[0,1]
    v_mad_u32_u16 v223, v222, 2, s85
    v_mfma_f32_16x16x32_bf16 v[48:51], a[128:131], v[232:235], v[48:51]
    s_waitcnt lgkmcnt(12)
    ds_read_u16 v223, v223
    ds_read_b128 a[240:243], v15 offset:1280
    v_mad_u32_u16 v222, v222, 2, s85 op_sel:[1,0,0,0]
    v_mfma_f32_16x16x32_f16 v[196:199], a[12:15], v[160:163], v[196:199]
    s_waitcnt lgkmcnt(13)
    ds_read_u16_d16_hi v222, v222
    v_cvt_pkrtz_f16_f32 v224, v190, v191
    v_pk_lshrrev_b16 v224, 3, v224 op_sel_hi:[0,1]
    v_mfma_f32_16x16x32_bf16 v[52:55], a[132:135], v[232:235], v[52:55]
    v_mad_u32_u16 v225, v224, 2, s85
    v_mad_u32_u16 v224, v224, 2, s85 op_sel:[1,0,0,0]
    v_mfma_f32_16x16x32_f16 v[192:195], a[16:19], v[168:171], v[192:195]
    s_waitcnt lgkmcnt(13)
    ds_read_u16 v225, v225
    v_mfma_f32_16x16x32_bf16 v[64:67], a[136:139], v[232:235], v[64:67]
    s_waitcnt lgkmcnt(13)
    ds_read_u16_d16_hi v224, v224
    v_mfma_f32_16x16x32_f16 v[196:199], a[20:23], v[168:171], v[196:199]
    v_mfma_f32_16x16x32_bf16 v[68:71], a[140:143], v[232:235], v[68:71]
    s_waitcnt lgkmcnt(13)
    ds_read_b128 a[244:247], v8 offset:2560
    v_or_b32 v232, v211, v210
    v_or_b32 v233, v213, v212
    v_mfma_f32_16x16x32_f16 v[200:203], a[0:3], v[156:159], 0
    s_waitcnt lgkmcnt(11)
    v_or_b32 v234, v215, v214
    v_or_b32 v235, v217, v216
    v_cvt_pkrtz_f16_f32 v226, v192, v193
    v_mfma_f32_16x16x32_bf16 v[40:43], a[120:123], v[236:239], v[40:43]
    ds_read_b128 a[252:255], v15 offset:3840
    v_pk_lshrrev_b16 v226, 3, v226 op_sel_hi:[0,1]
    v_cvt_pkrtz_f16_f32 v228, v194, v195
    v_mfma_f32_16x16x32_f16 v[204:207], a[4:7], v[156:159], 0
    v_cvt_pkrtz_f16_f32 v230, v196, v197
    v_cvt_pkrtz_f16_f32 v248, v198, v199
    v_mad_u32_u16 v227, v226, 2, s85
    v_mfma_f32_16x16x32_bf16 v[44:47], a[124:127], v[236:239], v[44:47]
    ds_read_u16 v227, v227
    v_mad_u32_u16 v226, v226, 2, s85 op_sel:[1,0,0,0]
    v_pk_lshrrev_b16 v228, 3, v228 op_sel_hi:[0,1]
    v_mfma_f32_16x16x32_f16 v[200:203], a[8:11], v[164:167], v[200:203]
    ds_read_u16_d16_hi v226, v226
    v_mad_u32_u16 v229, v228, 2, s85
    v_mad_u32_u16 v228, v228, 2, s85 op_sel:[1,0,0,0]
    v_mfma_f32_16x16x32_bf16 v[56:59], a[128:131], v[236:239], v[56:59]
    s_waitcnt lgkmcnt(12)
    ds_read_u16 v229, v229
    ds_read_u16_d16_hi v228, v228
    v_pk_lshrrev_b16 v230, 3, v230 op_sel_hi:[0,1]
    v_mfma_f32_16x16x32_f16 v[204:207], a[12:15], v[164:167], v[204:207]
    s_waitcnt lgkmcnt(13)
    ds_read_b128 v[136:139], v11 offset:0
    v_mad_u32_u16 v231, v230, 2, s85
    v_mad_u32_u16 v230, v230, 2, s85 op_sel:[1,0,0,0]
    v_mfma_f32_16x16x32_bf16 v[60:63], a[132:135], v[236:239], v[60:63]
    v_pk_lshrrev_b16 v248, 3, v248 op_sel_hi:[0,1]
    v_mad_u32_u16 v249, v248, 2, s85
    v_mad_u32_u16 v248, v248, 2, s85 op_sel:[1,0,0,0]
    v_mfma_f32_16x16x32_f16 v[200:203], a[16:19], v[172:175], v[200:203]
    s_waitcnt lgkmcnt(12)
    ds_read_u16 v231, v231
    ds_read_u16_d16_hi v230, v230
    v_mfma_f32_16x16x32_f16 v[204:207], a[20:23], v[172:175], v[204:207]
    v_mfma_f32_16x16x32_bf16 v[72:75], a[136:139], v[236:239], v[72:75]
    s_waitcnt lgkmcnt(13)
    ds_read_u16 v249, v249
    v_mfma_f32_16x16x32_bf16 v[76:79], a[140:143], v[236:239], v[76:79]
    s_waitcnt lgkmcnt(12)
    v_or_b32 v236, v219, v218
    v_or_b32 v237, v221, v220
    v_or_b32 v238, v223, v222
    v_mfma_f32_16x16x32_f16 v[192:195], a[48:51], v[152:155], 0
    ds_read_b128 a[236:239], v12 offset:0
    v_cvt_pkrtz_f16_f32 v250, v200, v201
    v_cvt_pkrtz_f16_f32 v252, v202, v203
    v_mfma_f32_16x16x32_bf16 v[32:35], a[168:171], v[232:235], v[32:35]
    s_waitcnt lgkmcnt(11)
    ds_read_u16_d16_hi v248, v248
    v_or_b32 v239, v225, v224
    v_cvt_pkrtz_f16_f32 v0, v204, v205
    v_mfma_f32_16x16x32_f16 v[196:199], a[52:55], v[152:155], 0
    v_cvt_pkrtz_f16_f32 v209, v206, v207
    v_pk_lshrrev_b16 v250, 3, v250 op_sel_hi:[0,1]
    v_mad_u32_u16 v251, v250, 2, s85
    v_mfma_f32_16x16x32_bf16 v[36:39], a[172:175], v[232:235], v[36:39]
    ds_read_u16 v251, v251
    ds_read_b128 v[140:143], v15 offset:0
    v_mad_u32_u16 v250, v250, 2, s85 op_sel:[1,0,0,0]
    v_mfma_f32_16x16x32_f16 v[192:195], a[56:59], v[160:163], v[192:195]
    s_waitcnt lgkmcnt(13)
    ds_read_u16_d16_hi v250, v250
    v_pk_lshrrev_b16 v252, 3, v252 op_sel_hi:[0,1]
    v_mad_u32_u16 v253, v252, 2, s85
    v_mfma_f32_16x16x32_bf16 v[48:51], a[176:179], v[232:235], v[48:51]
    s_waitcnt lgkmcnt(13)
    ds_read_u16 v253, v253
    v_mad_u32_u16 v252, v252, 2, s85 op_sel:[1,0,0,0]
    v_pk_lshrrev_b16 v0, 3, v0 op_sel_hi:[0,1]
    v_mfma_f32_16x16x32_f16 v[196:199], a[60:63], v[160:163], v[196:199]
    v_mad_u32_u16 v208, v0, 2, s85
    v_mad_u32_u16 v0, v0, 2, s85 op_sel:[1,0,0,0]
    v_pk_lshrrev_b16 v209, 3, v209 op_sel_hi:[0,1]
    v_mfma_f32_16x16x32_bf16 v[52:55], a[180:183], v[232:235], v[52:55]
    s_waitcnt lgkmcnt(13)
    ds_read_u16_d16_hi v252, v252
    v_mad_u32_u16 v210, v209, 2, s85
    v_mad_u32_u16 v209, v209, 2, s85 op_sel:[1,0,0,0]
    v_mfma_f32_16x16x32_f16 v[192:195], a[64:67], v[168:171], v[192:195]
    s_waitcnt lgkmcnt(11)
    ds_read_u16 v208, v208
    v_or_b32 v240, v227, v226
    v_or_b32 v241, v229, v228
    v_mfma_f32_16x16x32_bf16 v[64:67], a[184:187], v[232:235], v[64:67]
    ds_read_u16_d16_hi v0, v0
    v_cvt_pk_bf16_f32 v32, v32, v33
    v_cvt_pk_bf16_f32 v33, v34, v35
    v_mfma_f32_16x16x32_f16 v[196:199], a[68:71], v[168:171], v[196:199]
    ds_read_u16 v210, v210
    v_cvt_pkrtz_f16_f32 v211, v192, v193
    v_pk_lshrrev_b16 v211, 3, v211 op_sel_hi:[0,1]
    v_mfma_f32_16x16x32_bf16 v[68:71], a[188:191], v[232:235], v[68:71]
    s_waitcnt lgkmcnt(11)
    v_cvt_pkrtz_f16_f32 v213, v194, v195
    v_or_b32 v242, v231, v230
    v_mad_u32_u16 v212, v211, 2, s85
    v_mfma_f32_16x16x32_f16 v[200:203], a[48:51], v[156:159], 0
    ds_read_u16_d16_hi v209, v209
    v_cvt_pkrtz_f16_f32 v215, v196, v197
    v_cvt_pkrtz_f16_f32 v217, v198, v199
    v_mfma_f32_16x16x32_bf16 v[40:43], a[168:171], v[236:239], v[40:43]
    ds_read_b128 v[148:151], v11 offset:2560
    v_mad_u32_u16 v211, v211, 2, s85 op_sel:[1,0,0,0]
    v_pk_lshrrev_b16 v213, 3, v213 op_sel_hi:[0,1]
    v_mfma_f32_16x16x32_f16 v[204:207], a[52:55], v[156:159], 0
    ds_read_b128 v[144:147], v12 offset:1280
    v_mad_u32_u16 v214, v213, 2, s85
    v_mad_u32_u16 v213, v213, 2, s85 op_sel:[1,0,0,0]
    v_mfma_f32_16x16x32_bf16 v[44:47], a[172:175], v[236:239], v[44:47]
    s_waitcnt lgkmcnt(11)
    ds_read_u16 v212, v212
    v_or_b32 v243, v249, v248
    v_pk_lshrrev_b16 v215, 3, v215 op_sel_hi:[0,1]
    v_mfma_f32_16x16x32_f16 v[200:203], a[56:59], v[164:167], v[200:203]
    ds_read_b128 v[180:183], v13 offset:0
    v_mad_u32_u16 v216, v215, 2, s85
    v_mad_u32_u16 v215, v215, 2, s85 op_sel:[1,0,0,0]
    v_mfma_f32_16x16x32_bf16 v[56:59], a[176:179], v[236:239], v[56:59]
    ds_read_u16_d16_hi v211, v211
    v_pk_lshrrev_b16 v217, 3, v217 op_sel_hi:[0,1]
    v_mad_u32_u16 v218, v217, 2, s85
    v_mfma_f32_16x16x32_f16 v[204:207], a[60:63], v[164:167], v[204:207]
    s_waitcnt lgkmcnt(11)
    v_mad_u32_u16 v217, v217, 2, s85 op_sel:[1,0,0,0]
    v_or_b32 v244, v251, v250
    v_cvt_pk_bf16_f32 v34, v36, v37
    v_mfma_f32_16x16x32_bf16 v[60:63], a[180:183], v[236:239], v[60:63]
    ds_read_u16 v214, v214
    v_cvt_pk_bf16_f32 v35, v38, v39
    v_cvt_pk_bf16_f32 v40, v40, v41
    v_mfma_f32_16x16x32_f16 v[200:203], a[64:67], v[172:175], v[200:203]
    ds_read_b128 v[188:191], v9 offset:2560
    v_cvt_pk_bf16_f32 v41, v42, v43
    v_cvt_pk_bf16_f32 v42, v44, v45
    v_mfma_f32_16x16x32_f16 v[204:207], a[68:71], v[172:175], v[204:207]
    s_waitcnt lgkmcnt(11)
    ds_read_u16_d16_hi v213, v213
    v_or_b32 v245, v253, v252
    v_cvt_pk_bf16_f32 v43, v46, v47
    v_mfma_f32_16x16x32_bf16 v[72:75], a[184:187], v[236:239], v[72:75]
    v_cvt_pkrtz_f16_f32 v219, v200, v201
    v_cvt_pkrtz_f16_f32 v221, v202, v203
    v_pk_lshrrev_b16 v219, 3, v219 op_sel_hi:[0,1]
    v_mfma_f32_16x16x32_bf16 v[76:79], a[188:191], v[236:239], v[76:79]
    ds_read_u16 v216, v216
    v_cvt_pkrtz_f16_f32 v223, v204, v205
    v_cvt_pkrtz_f16_f32 v225, v206, v207
    v_mfma_f32_16x16x32_f16 v[192:195], a[96:99], v[152:155], 0
    s_waitcnt lgkmcnt(11)
    ds_read_u16_d16_hi v215, v215
    v_or_b32 v246, v208, v0
    v_mad_u32_u16 v220, v219, 2, s85
    v_mfma_f32_16x16x32_bf16 v[80:83], a[24:27], v[240:243], v[80:83]
    ds_read_u16 v218, v218
    v_mad_u32_u16 v219, v219, 2, s85 op_sel:[1,0,0,0]
    v_pk_lshrrev_b16 v221, 3, v221 op_sel_hi:[0,1]
    v_mfma_f32_16x16x32_f16 v[196:199], a[100:103], v[152:155], 0
    s_waitcnt lgkmcnt(12)
    buffer_store_dwordx4 v[40:43], v26, s[24:27], s81 offen offset:0 sc0 sc1
    ds_read_u16_d16_hi v217, v217
    ds_read_u16 v220, v220
    v_mfma_f32_16x16x32_bf16 v[84:87], a[28:31], v[240:243], v[84:87]
    s_waitcnt lgkmcnt(13)
    v_or_b32 v247, v210, v209
    v_mad_u32_u16 v222, v221, 2, s85
    v_mad_u32_u16 v221, v221, 2, s85 op_sel:[1,0,0,0]
    v_mfma_f32_16x16x32_f16 v[192:195], a[104:107], v[160:163], v[192:195]
    s_waitcnt lgkmcnt(12)
    ds_read_u16_d16_hi v219, v219
    buffer_store_dwordx4 v[32:35], v26, s[24:27], s80 offen offset:0 sc0 sc1
    ds_read_u16 v222, v222
    v_mfma_f32_16x16x32_bf16 v[96:99], a[32:35], v[240:243], v[96:99]
    s_waitcnt lgkmcnt(13)
    ds_read_u16_d16_hi v221, v221
    v_pk_lshrrev_b16 v223, 3, v223 op_sel_hi:[0,1]
    v_mad_u32_u16 v224, v223, 2, s85
    v_mfma_f32_16x16x32_f16 v[196:199], a[108:111], v[160:163], v[196:199]
    v_mad_u32_u16 v223, v223, 2, s85 op_sel:[1,0,0,0]
    v_pk_lshrrev_b16 v225, 3, v225 op_sel_hi:[0,1]
    v_mad_u32_u16 v226, v225, 2, s85
    v_mfma_f32_16x16x32_bf16 v[100:103], a[36:39], v[240:243], v[100:103]
    s_waitcnt lgkmcnt(13)
    ds_read_u16 v224, v224
    v_mad_u32_u16 v225, v225, 2, s85 op_sel:[1,0,0,0]
    v_cvt_pk_bf16_f32 v48, v48, v49
    v_mfma_f32_16x16x32_f16 v[192:195], a[112:115], v[168:171], v[192:195]
    s_waitcnt lgkmcnt(13)
    ds_read_u16_d16_hi v223, v223
    v_cvt_pk_bf16_f32 v49, v50, v51
    v_cvt_pk_bf16_f32 v50, v52, v53
    v_mfma_f32_16x16x32_bf16 v[112:115], a[40:43], v[240:243], v[112:115]
    s_waitcnt lgkmcnt(13)
    ds_read_u16 v226, v226
    v_cvt_pk_bf16_f32 v51, v54, v55
    v_cvt_pk_bf16_f32 v56, v56, v57
    v_mfma_f32_16x16x32_f16 v[196:199], a[116:119], v[168:171], v[196:199]
    s_waitcnt lgkmcnt(13)
    ds_read_u16_d16_hi v225, v225
    v_cvt_pk_bf16_f32 v57, v58, v59
    v_cvt_pk_bf16_f32 v58, v60, v61
    v_mfma_f32_16x16x32_bf16 v[116:119], a[44:47], v[240:243], v[116:119]
    s_waitcnt lgkmcnt(13)
    ds_read_b128 v[232:235], v13 offset:2560
    v_cvt_pk_bf16_f32 v59, v62, v63
    v_cvt_pk_bf16_f32 v64, v64, v65
    v_mfma_f32_16x16x32_f16 v[200:203], a[96:99], v[156:159], 0
    s_waitcnt lgkmcnt(12)
    buffer_store_dwordx4 v[56:59], v26, s[24:27], s81 offen offset:64 sc0 sc1
    ds_read_b128 v[32:35], v10 offset:0
    buffer_store_dwordx4 v[48:51], v26, s[24:27], s80 offen offset:64 sc0 sc1
    ds_read_b128 v[176:179], v9 offset:0
    v_mfma_f32_16x16x32_bf16 v[88:91], a[24:27], v[244:247], v[88:91]
    v_cvt_pk_bf16_f32 v65, v66, v67
    v_cvt_pk_bf16_f32 v66, v68, v69
    v_cvt_pk_bf16_f32 v67, v70, v71
    v_mfma_f32_16x16x32_f16 v[204:207], a[100:103], v[156:159], 0
    v_cvt_pk_bf16_f32 v72, v72, v73
    v_cvt_pk_bf16_f32 v73, v74, v75
    v_cvt_pk_bf16_f32 v74, v76, v77
    v_mfma_f32_16x16x32_bf16 v[92:95], a[28:31], v[244:247], v[92:95]
    v_cvt_pk_bf16_f32 v75, v78, v79
    v_or_b32 v240, v212, v211
    v_or_b32 v241, v214, v213
    v_mfma_f32_16x16x32_f16 v[200:203], a[104:107], v[164:167], v[200:203]
    s_waitcnt lgkmcnt(11)
    ds_read_b128 v[184:187], v14 offset:1280
    v_or_b32 v242, v216, v215
    v_or_b32 v243, v218, v217
    v_mfma_f32_16x16x32_bf16 v[104:107], a[32:35], v[244:247], v[104:107]
    ds_read_b128 v[44:47], v10 offset:2560
    v_cvt_pkrtz_f16_f32 v227, v192, v193
    v_pk_lshrrev_b16 v227, 3, v227 op_sel_hi:[0,1]
    v_mfma_f32_16x16x32_f16 v[204:207], a[108:111], v[164:167], v[204:207]
    ds_read_b128 v[36:39], v14 offset:0
    v_cvt_pkrtz_f16_f32 v229, v194, v195
    v_cvt_pkrtz_f16_f32 v231, v196, v197
    v_mfma_f32_16x16x32_bf16 v[108:111], a[36:39], v[244:247], v[108:111]
    v_cvt_pkrtz_f16_f32 v249, v198, v199
    v_mad_u32_u16 v228, v227, 2, s85
    v_mad_u32_u16 v227, v227, 2, s85 op_sel:[1,0,0,0]
    v_mfma_f32_16x16x32_f16 v[200:203], a[112:115], v[172:175], v[200:203]
    s_waitcnt lgkmcnt(12)
    ds_read_u16 v228, v228
    ds_read_u16_d16_hi v227, v227
    v_pk_lshrrev_b16 v229, 3, v229 op_sel_hi:[0,1]
    v_mfma_f32_16x16x32_f16 v[204:207], a[116:119], v[172:175], v[204:207]
    buffer_store_dwordx4 v[72:75], v26, s[24:27], s81 offen offset:128 sc0 sc1
    v_mfma_f32_16x16x32_bf16 v[120:123], a[40:43], v[244:247], v[120:123]
    v_mad_u32_u16 v230, v229, 2, s85
    v_mad_u32_u16 v229, v229, 2, s85 op_sel:[1,0,0,0]
    v_cvt_pkrtz_f16_f32 v251, v200, v201
    v_mfma_f32_16x16x32_bf16 v[124:127], a[44:47], v[244:247], v[124:127]
    s_waitcnt lgkmcnt(12)
    ds_read_u16 v230, v230
    ds_read_u16_d16_hi v229, v229
    v_or_b32 v244, v220, v219
    v_mfma_f32_16x16x32_f16 v[192:195], a[144:147], v[152:155], 0
    s_waitcnt lgkmcnt(12)
    ds_read_b128 v[56:59], v20 offset:2560
    v_or_b32 v245, v222, v221
    v_or_b32 v246, v224, v223
    v_mfma_f32_16x16x32_bf16 v[80:83], a[72:75], v[240:243], v[80:83]
    s_waitcnt lgkmcnt(11)
    v_or_b32 v247, v226, v225
    v_cvt_pkrtz_f16_f32 v253, v202, v203
    v_cvt_pkrtz_f16_f32 v208, v204, v205
    v_mfma_f32_16x16x32_f16 v[196:199], a[148:151], v[152:155], 0
    ds_read_b128 v[60:63], v21 offset:2560
    v_cvt_pkrtz_f16_f32 v210, v206, v207
    v_pk_lshrrev_b16 v231, 3, v231 op_sel_hi:[0,1]
    v_mfma_f32_16x16x32_bf16 v[84:87], a[76:79], v[240:243], v[84:87]
    buffer_store_dwordx4 v[64:67], v26, s[24:27], s80 offen offset:128 sc0 sc1
    v_mfma_f32_16x16x32_f16 v[192:195], a[152:155], v[160:163], v[192:195]
    ds_read_b128 v[52:55], v21 offset:0
    v_mad_u32_u16 v248, v231, 2, s85
    v_mad_u32_u16 v231, v231, 2, s85 op_sel:[1,0,0,0]
    v_mfma_f32_16x16x32_bf16 v[96:99], a[80:83], v[240:243], v[96:99]
    s_waitcnt lgkmcnt(12)
    ds_read_u16 v248, v248
    ds_read_u16_d16_hi v231, v231
    v_pk_lshrrev_b16 v249, 3, v249 op_sel_hi:[0,1]
    v_mfma_f32_16x16x32_f16 v[196:199], a[156:159], v[160:163], v[196:199]
    s_waitcnt lgkmcnt(11)
    ds_read_b128 v[236:239], v14 offset:3840
    ds_read_b128 v[48:51], v20 offset:0
    ds_read_b128 v[40:43], v13 offset:1280
    v_mfma_f32_16x16x32_bf16 v[100:103], a[84:87], v[240:243], v[100:103]
    v_mad_u32_u16 v250, v249, 2, s85
    v_mad_u32_u16 v249, v249, 2, s85 op_sel:[1,0,0,0]
    v_pk_lshrrev_b16 v251, 3, v251 op_sel_hi:[0,1]
    v_mfma_f32_16x16x32_f16 v[192:195], a[160:163], v[168:171], v[192:195]
    s_waitcnt lgkmcnt(12)
    ds_read_u16 v250, v250
    ds_read_u16_d16_hi v249, v249
    v_mad_u32_u16 v252, v251, 2, s85
    v_mfma_f32_16x16x32_bf16 v[112:115], a[88:91], v[240:243], v[112:115]
    s_waitcnt lgkmcnt(13)
    ds_read_u16 v252, v252
    v_mad_u32_u16 v251, v251, 2, s85 op_sel:[1,0,0,0]
    v_pk_lshrrev_b16 v253, 3, v253 op_sel_hi:[0,1]
    v_mfma_f32_16x16x32_f16 v[196:199], a[164:167], v[168:171], v[196:199]
    v_mad_u32_u16 v0, v253, 2, s85
    v_mad_u32_u16 v253, v253, 2, s85 op_sel:[1,0,0,0]
    v_pk_lshrrev_b16 v208, 3, v208 op_sel_hi:[0,1]
    v_mfma_f32_16x16x32_bf16 v[116:119], a[92:95], v[240:243], v[116:119]
    s_waitcnt lgkmcnt(12)
    ds_read_u16_d16_hi v251, v251
    ds_read_u16 v0, v0
    v_mad_u32_u16 v209, v208, 2, s85
    v_mfma_f32_16x16x32_f16 v[200:203], a[144:147], v[156:159], 0
    s_waitcnt lgkmcnt(13)
    ds_read_u16_d16_hi v253, v253
    v_mad_u32_u16 v208, v208, 2, s85 op_sel:[1,0,0,0]
    v_pk_lshrrev_b16 v210, 3, v210 op_sel_hi:[0,1]
    v_mfma_f32_16x16x32_bf16 v[88:91], a[72:75], v[244:247], v[88:91]
    s_waitcnt lgkmcnt(13)
    ds_read_u16 v209, v209
    v_mad_u32_u16 v211, v210, 2, s85
    v_mad_u32_u16 v210, v210, 2, s85 op_sel:[1,0,0,0]
    v_mfma_f32_16x16x32_f16 v[204:207], a[148:151], v[156:159], 0
    s_waitcnt lgkmcnt(13)
    ds_read_u16_d16_hi v208, v208
    v_or_b32 v240, v228, v227
    v_or_b32 v241, v230, v229
    v_mfma_f32_16x16x32_bf16 v[92:95], a[76:79], v[244:247], v[92:95]
    s_waitcnt lgkmcnt(12)
    v_cvt_pkrtz_f16_f32 v212, v192, v193
    v_pk_lshrrev_b16 v212, 3, v212 op_sel_hi:[0,1]
    s_waitcnt lgkmcnt(11)
    v_or_b32 v242, v248, v231
    v_mfma_f32_16x16x32_f16 v[200:203], a[152:155], v[164:167], v[200:203]
    ds_read_u16 v211, v211
    ds_read_u16_d16_hi v210, v210
    v_cvt_pkrtz_f16_f32 v214, v194, v195
    v_mfma_f32_16x16x32_bf16 v[104:107], a[80:83], v[244:247], v[104:107]
    ds_read_b128 v[64:67], v14 offset:2560
    v_cvt_pkrtz_f16_f32 v216, v196, v197
    v_cvt_pkrtz_f16_f32 v218, v198, v199
    v_mfma_f32_16x16x32_f16 v[204:207], a[156:159], v[164:167], v[204:207]
    s_waitcnt lgkmcnt(13)
    ds_read_b128 v[68:71], v13 offset:3840
    v_mad_u32_u16 v213, v212, 2, s85
    v_mad_u32_u16 v212, v212, 2, s85 op_sel:[1,0,0,0]
    v_mfma_f32_16x16x32_bf16 v[108:111], a[84:87], v[244:247], v[108:111]
    v_pk_lshrrev_b16 v214, 3, v214 op_sel_hi:[0,1]
    v_mad_u32_u16 v215, v214, 2, s85
    v_mad_u32_u16 v214, v214, 2, s85 op_sel:[1,0,0,0]
    v_mfma_f32_16x16x32_f16 v[200:203], a[160:163], v[172:175], v[200:203]
    s_waitcnt lgkmcnt(11)
    ds_read_b128 v[72:75], v15 offset:2560
    v_pk_lshrrev_b16 v216, 3, v216 op_sel_hi:[0,1]
    s_waitcnt lgkmcnt(11)
    v_or_b32 v243, v250, v249
    v_mfma_f32_16x16x32_f16 v[204:207], a[164:167], v[172:175], v[204:207]
    ds_read_b128 v[76:79], v12 offset:3840
    v_mad_u32_u16 v217, v216, 2, s85
    v_mad_u32_u16 v216, v216, 2, s85 op_sel:[1,0,0,0]
    v_mfma_f32_16x16x32_bf16 v[120:123], a[88:91], v[244:247], v[120:123]
    ds_read_u16 v213, v213
    v_cvt_pkrtz_f16_f32 v220, v200, v201
    v_cvt_pkrtz_f16_f32 v222, v202, v203
    v_mfma_f32_16x16x32_bf16 v[124:127], a[92:95], v[244:247], v[124:127]
    s_waitcnt lgkmcnt(11)
    v_cvt_pkrtz_f16_f32 v224, v204, v205
    v_or_b32 v244, v252, v251
    v_cvt_pkrtz_f16_f32 v226, v206, v207
    v_mfma_f32_16x16x32_bf16 v[80:83], a[120:123], v[240:243], v[80:83]
    ds_read_u16_d16_hi v212, v212
    v_pk_lshrrev_b16 v218, 3, v218 op_sel_hi:[0,1]
    v_mad_u32_u16 v219, v218, 2, s85
    v_mfma_f32_16x16x32_bf16 v[84:87], a[124:127], v[240:243], v[84:87]
    s_add_u32 m0, s56, -128
    ds_read_u16 v215, v215
    v_mad_u32_u16 v218, v218, 2, s85 op_sel:[1,0,0,0]
    v_pk_lshrrev_b16 v220, 3, v220 op_sel_hi:[0,1]
    v_mfma_f32_16x16x32_bf16 v[96:99], a[128:131], v[240:243], v[96:99]
    s_waitcnt lgkmcnt(11)
    ds_read_u16_d16_hi v214, v214
    v_or_b32 v245, v0, v253
    v_mad_u32_u16 v221, v220, 2, s85
    v_mfma_f32_16x16x32_bf16 v[100:103], a[132:135], v[240:243], v[100:103]
    v_mad_u32_u16 v220, v220, 2, s85 op_sel:[1,0,0,0]
    v_pk_lshrrev_b16 v222, 3, v222 op_sel_hi:[0,1]
    v_mad_u32_u16 v223, v222, 2, s85
    v_mfma_f32_16x16x32_bf16 v[112:115], a[136:139], v[240:243], v[112:115]
    ds_read_u16 v217, v217
    v_mad_u32_u16 v222, v222, 2, s85 op_sel:[1,0,0,0]
    v_pk_lshrrev_b16 v224, 3, v224 op_sel_hi:[0,1]
    v_mfma_f32_16x16x32_bf16 v[116:119], a[140:143], v[240:243], v[116:119]
    s_waitcnt lgkmcnt(11)
    ds_read_u16_d16_hi v216, v216
    v_or_b32 v246, v209, v208
    v_mad_u32_u16 v225, v224, 2, s85
    v_mad_u32_u16 v224, v224, 2, s85 op_sel:[1,0,0,0]
    v_pk_lshrrev_b16 v226, 3, v226 op_sel_hi:[0,1]
    v_mad_u32_u16 v227, v226, 2, s85
    v_mad_u32_u16 v226, v226, 2, s85 op_sel:[1,0,0,0]
    ds_read_u16 v219, v219
    s_waitcnt lgkmcnt(11)
    v_or_b32 v247, v211, v210
    s_nop 1
    v_mfma_f32_16x16x32_bf16 v[88:91], a[120:123], v[244:247], v[88:91]
    ds_read_u16_d16_hi v218, v218
    ds_read_u16 v221, v221
    v_mfma_f32_16x16x32_bf16 v[92:95], a[124:127], v[244:247], v[92:95]
    ds_read_u16_d16_hi v220, v220
    v_mfma_f32_16x16x32_bf16 v[104:107], a[128:131], v[244:247], v[104:107]
    s_waitcnt lgkmcnt(13)
    ds_read_u16 v223, v223
    v_mfma_f32_16x16x32_bf16 v[108:111], a[132:135], v[244:247], v[108:111]
    s_waitcnt lgkmcnt(11)
    ds_read_u16_d16_hi v222, v222
    buffer_load_dwordx4 v1, s[20:23], 0 offen offset:128 lds
    s_add_u32 m0, s56, 896
    v_mfma_f32_16x16x32_bf16 v[120:123], a[136:139], v[244:247], v[120:123]
    ds_read_u16 v225, v225
    buffer_load_dwordx4 v2, s[20:23], 0 offen offset:128 lds
    s_add_u32 m0, s56, 1920
    v_mfma_f32_16x16x32_bf16 v[124:127], a[140:143], v[244:247], v[124:127]
    s_waitcnt lgkmcnt(8)
    ds_read_u16_d16_hi v224, v224
    buffer_load_dwordx4 v3, s[20:23], 0 offen offset:128 lds
    v_or_b32 v240, v213, v212
    s_add_u32 m0, s56, 2944
    ds_read_u16 v227, v227
    buffer_load_dwordx4 v4, s[20:23], 0 offen offset:128 lds
    s_add_u32 m0, s56, 3968
    v_or_b32 v241, v215, v214
    ds_read_u16_d16_hi v226, v226
    buffer_load_dwordx4 v5, s[20:23], 0 offen offset:128 lds
    ds_read_b128 v[192:195], v22 offset:0
    s_add_u32 m0, s56, 4992
    s_nop 0
    buffer_load_dwordx4 v6, s[20:23], 0 offen offset:128 lds
    s_add_u32 m0, s56, 6016
    s_waitcnt lgkmcnt(11)
    v_or_b32 v242, v217, v216
    ds_read_b128 v[196:199], v22 offset:256
    buffer_load_dword v7, s[20:23], 0 offen offset:128 lds
    ds_read_b128 v[204:207], v22 offset:272
    s_waitcnt lgkmcnt(11)
    v_or_b32 v243, v219, v218
    s_nop 1
    v_mfma_f32_16x16x32_bf16 v[80:83], a[168:171], v[240:243], v[80:83]
    v_mfma_f32_16x16x32_bf16 v[84:87], a[172:175], v[240:243], v[84:87]
    v_mfma_f32_16x16x32_bf16 v[96:99], a[176:179], v[240:243], v[96:99]
    s_waitcnt lgkmcnt(9)
    ds_read_b128 v[200:203], v22 offset:16
    v_or_b32 v244, v221, v220
    v_mfma_f32_16x16x32_bf16 v[100:103], a[180:183], v[240:243], v[100:103]
    v_mfma_f32_16x16x32_bf16 v[112:115], a[184:187], v[240:243], v[112:115]
    s_waitcnt lgkmcnt(9)
    v_mfma_f32_16x16x32_bf16 v[116:119], a[188:191], v[240:243], v[116:119]
    s_add_u32 s52, s52, 1
    s_cmp_eq_u32 s52, 4
    s_waitcnt lgkmcnt(8)
    v_or_b32 v245, v223, v222
    s_waitcnt lgkmcnt(6)
    v_or_b32 v246, v225, v224
    s_waitcnt lgkmcnt(4)
    v_or_b32 v247, v227, v226
    s_cbranch_scc0 L_conv
L_final:
    s_nop 0
    v_mfma_f32_16x16x32_bf16 v[88:91], a[168:171], v[244:247], v[88:91]
    v_cvt_pk_bf16_f32 v80, v80, v81
    v_cvt_pk_bf16_f32 v81, v82, v83
    v_cvt_pk_bf16_f32 v82, v84, v85
    v_mfma_f32_16x16x32_bf16 v[92:95], a[172:175], v[244:247], v[92:95]
    v_cvt_pk_bf16_f32 v83, v86, v87
    v_cvt_pk_bf16_f32 v96, v96, v97
    v_cvt_pk_bf16_f32 v97, v98, v99
    v_mfma_f32_16x16x32_bf16 v[104:107], a[176:179], v[244:247], v[104:107]
    buffer_store_dwordx4 v[80:83], v26, s[24:27], s82 offen offset:0 sc0 sc1
    v_mfma_f32_16x16x32_bf16 v[108:111], a[180:183], v[244:247], v[108:111]
    v_cvt_pk_bf16_f32 v98, v100, v101
    v_cvt_pk_bf16_f32 v99, v102, v103
    v_cvt_pk_bf16_f32 v112, v112, v113
    v_mfma_f32_16x16x32_bf16 v[120:123], a[184:187], v[244:247], v[120:123]
    buffer_store_dwordx4 v[96:99], v26, s[24:27], s82 offen offset:64 sc0 sc1
    v_mfma_f32_16x16x32_bf16 v[124:127], a[188:191], v[244:247], v[124:127]
    v_cvt_pk_bf16_f32 v113, v114, v115
    v_cvt_pk_bf16_f32 v114, v116, v117
    v_cvt_pk_bf16_f32 v115, v118, v119
    v_cvt_pk_bf16_f32 v88, v88, v89
    v_cvt_pk_bf16_f32 v89, v90, v91
    v_cvt_pk_bf16_f32 v90, v92, v93
    v_cvt_pk_bf16_f32 v91, v94, v95
    v_cvt_pk_bf16_f32 v104, v104, v105
    v_cvt_pk_bf16_f32 v105, v106, v107
    v_cvt_pk_bf16_f32 v106, v108, v109
    v_cvt_pk_bf16_f32 v107, v110, v111
    v_cvt_pk_bf16_f32 v120, v120, v121
    v_cvt_pk_bf16_f32 v121, v122, v123
    v_cvt_pk_bf16_f32 v122, v124, v125
    v_cvt_pk_bf16_f32 v123, v126, v127
    buffer_store_dwordx4 v[112:115], v26, s[24:27], s82 offen offset:128 sc0 sc1
    buffer_store_dwordx4 v[88:91], v26, s[24:27], s83 offen offset:0 sc0 sc1
    buffer_store_dwordx4 v[104:107], v26, s[24:27], s83 offen offset:64 sc0 sc1
    buffer_store_dwordx4 v[120:123], v26, s[24:27], s83 offen offset:128 sc0 sc1
L_end:
L_last:
    s_endpgm
.section .rodata,"a"
.p2align 6
.amdhsa_kernel standalone__modern_conv_block_convnext__vision_kernel
  .amdhsa_next_free_vgpr 512
  .amdhsa_next_free_sgpr 102
  .amdhsa_accum_offset 256
  .amdhsa_group_segment_fixed_size 0
  .amdhsa_kernarg_size 80
  .amdhsa_user_sgpr_count 2
  .amdhsa_user_sgpr_kernarg_segment_ptr 1
  .amdhsa_system_sgpr_workgroup_id_x 1
.end_amdhsa_kernel
```

```asm
; @launch grid=(256,1,1) block=(256,1,1) lds=163840
.amdgcn_target "amdgcn-amd-amdhsa--gfx950"
.text
.globl standalone__modern_conv_block_convnext__vision_kernel
.p2align 8
.type standalone__modern_conv_block_convnext__vision_kernel,@function
standalone__modern_conv_block_convnext__vision_kernel:
    s_cmp_ge_u32 s2, 256
    s_cbranch_scc1 L_end
    s_load_dwordx16 s[4:19], s[0:1], 0
    v_readfirstlane_b32 s3, v0
    v_and_b32 v129, 63, v0
    s_and_b32 s60, s2, 7
    s_lshr_b32 s61, s2, 7
    s_lshl1_add_u32 s60, s60, s61
    s_lshr_b32 s3, s3, 6
    s_getpc_b64 s[62:63]
L_pc:
    v_min_u32 v18, 2, v129
    s_lshr_b32 s71, s2, 3
    s_lshl2_add_u32 s71, s71, s3
    v_mad_u32_u24 v18, s71, 3, v18
    v_min_u32 v18, (L_last-L_pc)/128, v18
    v_lshlrev_b32 v18, 1, v18
    v_mad_u64_u32 v[18:19], vcc, v18, 64, s[62:63]
    global_load_dword v251, v[18:19], off
    s_bfe_u32 s61, s2, 0x40003
    s_lshl2_add_u32 s55, s61, s3
    s_mul_i32 s60, s60, 3145728
    s_mul_i32 s61, s55, 1536
    s_add_u32 s63, s60, s61
    s_bitcmp1_b32 s2, 7
    s_cselect_b32 s87, 1, -1
    s_cselect_b32 s61, 0, 2359296
    s_mul_i32 s87, s87, 786432
    s_add_u32 s63, s63, s61
    s_sub_u32 s64, s63, 98496
    s_movk_i32 s65, 0
    s_movk_i32 s66, 2048
    s_cmp_eq_u32 s55, 0
    s_cmovk_i32 s65, 100
    s_cmovk_i32 s66, 1948
    s_cmp_eq_u32 s55, 63
    s_cmovk_i32 s66, 1800
    s_mul_i32 s56, s3, 12800
    s_add_u32 s56, s56, 90112
    s_mov_b32 s68, 96384
    v_lshrrev_b32 v131, 2, v129
    v_mul_u32_u24 v130, 205, v131
    v_mul_u32_u24 v131, 192, v131
    v_add_u32 v131, s64, v131
    v_lshlrev_b32 v132, 4, v0
    v_and_b32 v133, 16, v0
    v_bitop3_b32 v132, v132, v133, 48 bitop3:0x28
    v_bfrev_b32 v136, 1
    s_waitcnt lgkmcnt(0)
    s_mov_b32 s20, s4
    s_mov_b32 s21, s5
    s_mov_b32 s22, 50331648
    s_mov_b32 s23, 0x20000
    s_mulk_i32 s71, 640
    v_lshlrev_b32 v141, 7, v129
    v_cmp_gt_u32 vcc, 5, v129
    s_nop 1
    v_cndmask_b32 v141, v136, v141, vcc
    s_mov_b32 s44, s8
    s_mov_b32 s45, s9
    s_mov_b32 s46, 73728
    s_mov_b32 s47, 0x20000
    s_mov_b32 s48, s12
    s_mov_b32 s49, s13
    s_mov_b32 s50, 73728
    s_mov_b32 s51, 0x20000
    buffer_load_dword v142, v141, s[44:47], s71 offen
    buffer_load_dword v143, v141, s[48:51], s71 offen
    v_lshrrev_b32 v138, 5, v129
    s_movk_i32 s69, 192
    v_mul_u32_u24 v139, 1366, v0
    v_lshrrev_b32 v139, 16, v139
    v_mul_u32_u24 v139, 384, v139
    v_lshl_add_u32 v139, v0, 2, v139
    v_lshlrev_b32 v140, 3, v0
    s_mov_b32 s28, s6
    s_mov_b32 s29, s7
    s_mov_b32 s30, 1728
    s_mov_b32 s31, 0x20000
    s_mov_b32 s36, s14
    s_mov_b32 s37, s15
    s_mov_b32 s38, 192
    s_mov_b32 s39, 0x20000
    s_mov_b32 s40, s16
    s_mov_b32 s41, s17
    s_mov_b32 s42, 192
    s_mov_b32 s43, 0x20000
    s_mov_b32 s32, s10
    s_mov_b32 s33, s11
    s_mov_b32 s34, 768
    s_mov_b32 s35, 0x20000
    buffer_load_dword v144, v139, s[28:31], 0 offen
    buffer_load_dword v145, v139, s[28:31], 0 offen offset:192
    buffer_load_dword v146, v139, s[28:31], 0 offen offset:384
    buffer_load_dwordx2 v[148:149], v140, s[36:39], 0 offen
    buffer_load_dwordx2 v[150:151], v140, s[40:43], 0 offen
    s_cmp_ge_u32 s3, 2
    s_cbranch_scc1 L_prep1
L_prep0:
    v_bfe_u32 v158, v129, 2, 1
    v_bfe_u32 v159, v129, 3, 2
    v_lshl_add_u32 v159, v158, 2, v159
    v_and_b32 v160, 3, v129
    v_lshl_add_u32 v236, v138, 2, v160
    s_lshl_b32 s60, s3, 7
    v_lshl_add_u32 v236, v236, 4, s60
    v_mul_u32_u24 v159, 768, v159
    v_add_u32 v232, v159, v236
    v_add_u32 v233, 6144, v232
    v_and_b32 v159, 0x1c, v129
    v_cmp_eq_u32 vcc, 0x1c, v159
    s_mov_b32 s72, 72960
    s_mul_i32 s60, s3, 24576
    s_add_u32 s60, s60, 40960
    v_cndmask_b32 v237, v136, v236, vcc
    v_lshl_add_u32 v234, v129, 4, s60
    s_lshl_b32 s60, s3, 12
    s_add_u32 s60, s60, 40960
    v_mov_b32 v238, s60
    buffer_load_dwordx4 v[176:179], v236, s[44:47], s72 offen offset:0
    buffer_load_dwordx4 a[232:235], v237, s[32:35], 0 offen offset:0
    buffer_load_dwordx4 v[180:183], v236, s[44:47], s72 offen offset:256
    buffer_load_dwordx4 a[236:239], v237, s[32:35], 0 offen offset:256
    buffer_load_dwordx4 v[184:187], v236, s[44:47], s72 offen offset:512
    buffer_load_dwordx4 a[240:243], v237, s[32:35], 0 offen offset:512
    s_mov_b32 m0, s56
    s_movk_i32 s70, 5
L_xl0:
    v_lshrrev_b32 v134, 11, v130
    v_subrev_u32 v135, s65, v130
    v_mad_u32_u24 v134, v134, s68, v131
    v_and_b32 v135, 0x7ff, v135
    v_cmp_gt_u32 vcc, s66, v135
    v_lshrrev_b32 v135, 7, v130
    v_and_b32 v135, 32, v135
    v_xad_u32 v134, v132, v135, v134
    v_cndmask_b32 v134, v136, v134, vcc
    v_add_u32 v130, 3280, v130
    v_add_u32 v131, 3072, v131
    buffer_load_dwordx4 v134, s[20:23], 0 offen lds
    s_add_u32 m0, m0, 1024
    s_sub_u32 s70, s70, 1
    s_cbranch_scc0 L_xl0
    s_branch L_prb0
L_prep1:
    v_bfe_u32 v158, v129, 2, 1
    v_bfe_u32 v159, v129, 3, 2
    v_lshl_add_u32 v159, v158, 2, v159
    v_and_b32 v160, 3, v129
    v_lshl_add_u32 v159, v138, 4, v159
    s_lshl_b32 s60, s3, 6
    s_sub_u32 s60, s60, 128
    v_add_u32 v159, s60, v159
    v_xor_b32 v236, v138, v160
    v_lshlrev_b32 v236, 4, v236
    v_mad_u32_u24 v232, v159, s69, v236
    s_lshl_b32 s60, s3, 1
    s_sub_u32 s60, s60, 4
    v_add_u32 v159, s60, v158
    v_lshlrev_b32 v238, 11, v159
    v_add_u32 v238, 43008, v238
    v_mul_u32_u24 v159, 768, v159
    v_lshl_add_u32 v159, v158, 2, v159
    v_add_u32 v159, v160, v159
    v_bfe_u32 v160, v129, 3, 1
    v_lshl_add_u32 v159, v160, 6, v159
    v_lshrrev_b32 v160, 4, v129
    v_lshl_add_u32 v159, v160, 4, v159
    v_lshlrev_b32 v159, 4, v159
    v_add_u32 v234, 40960, v159
    v_xor_b32 v235, 64, v234
    buffer_load_dwordx4 v[208:211], v236, s[40:43], 0 offen offset:0
    buffer_load_dwordx4 v[212:215], v236, s[40:43], 0 offen offset:64
    buffer_load_dwordx4 v[216:219], v236, s[40:43], 0 offen offset:128
    s_mov_b32 m0, s56
    s_movk_i32 s70, 5
L_xl1:
    v_lshrrev_b32 v134, 11, v130
    v_subrev_u32 v135, s65, v130
    v_mad_u32_u24 v134, v134, s68, v131
    v_and_b32 v135, 0x7ff, v135
    v_cmp_gt_u32 vcc, s66, v135
    v_lshrrev_b32 v135, 7, v130
    v_and_b32 v135, 32, v135
    v_xad_u32 v134, v132, v135, v134
    v_cndmask_b32 v134, v136, v134, vcc
    v_add_u32 v130, 3280, v130
    v_add_u32 v131, 3072, v131
    buffer_load_dwordx4 v134, s[20:23], 0 offen lds
    s_add_u32 m0, m0, 1024
    s_sub_u32 s70, s70, 1
    s_cbranch_scc0 L_xl1
L_prb1:
    v_lshrrev_b32 v131, 4, v129
    v_add_u32 v131, 96, v131
    v_mul_u32_u24 v130, 205, v131
    v_mul_u32_u24 v131, 192, v131
    v_add_u32 v131, s64, v131
    v_lshlrev_b32 v133, 2, v129
    v_and_b32 v133, 63, v133
    v_lshrrev_b32 v134, 11, v130
    v_subrev_u32 v135, s65, v130
    v_mad_u32_u24 v134, v134, s68, v131
    v_and_b32 v135, 0x7ff, v135
    v_cmp_gt_u32 vcc, s66, v135
    v_lshrrev_b32 v135, 7, v130
    v_and_b32 v135, 32, v135
    v_xad_u32 v134, v133, v135, v134
    v_cndmask_b32 v7, v136, v134, vcc
    s_add_u32 m0, s56, 6144
    s_nop 0
    buffer_load_dword v7, s[20:23], 0 offen offset:0 lds
    v_lshrrev_b32 v131, 2, v129
    v_mul_u32_u24 v130, 205, v131
    v_mul_u32_u24 v131, 192, v131
    v_add_u32 v131, s64, v131
    v_lshrrev_b32 v134, 11, v130
    v_subrev_u32 v135, s65, v130
    v_mad_u32_u24 v134, v134, s68, v131
    v_and_b32 v135, 0x7ff, v135
    v_cmp_gt_u32 vcc, s66, v135
    v_lshrrev_b32 v135, 7, v130
    v_and_b32 v135, 32, v135
    v_xad_u32 v134, v132, v135, v134
    v_cndmask_b32 v1, v136, v134, vcc
    v_add_u32 v130, 3280, v130
    v_add_u32 v131, 3072, v131
    v_lshrrev_b32 v134, 11, v130
    v_subrev_u32 v135, s65, v130
    v_mad_u32_u24 v134, v134, s68, v131
    v_and_b32 v135, 0x7ff, v135
    v_cmp_gt_u32 vcc, s66, v135
    v_lshrrev_b32 v135, 7, v130
    v_and_b32 v135, 32, v135
    v_xad_u32 v134, v132, v135, v134
    v_cndmask_b32 v2, v136, v134, vcc
    v_add_u32 v130, 3280, v130
    v_add_u32 v131, 3072, v131
    v_lshrrev_b32 v134, 11, v130
    v_subrev_u32 v135, s65, v130
    v_mad_u32_u24 v134, v134, s68, v131
    v_and_b32 v135, 0x7ff, v135
    v_cmp_gt_u32 vcc, s66, v135
    v_lshrrev_b32 v135, 7, v130
    v_and_b32 v135, 32, v135
    v_xad_u32 v134, v132, v135, v134
    v_cndmask_b32 v3, v136, v134, vcc
    v_add_u32 v130, 3280, v130
    v_add_u32 v131, 3072, v131
    v_lshrrev_b32 v134, 11, v130
    v_subrev_u32 v135, s65, v130
    v_mad_u32_u24 v134, v134, s68, v131
    v_and_b32 v135, 0x7ff, v135
    v_cmp_gt_u32 vcc, s66, v135
    v_lshrrev_b32 v135, 7, v130
    v_and_b32 v135, 32, v135
    v_xad_u32 v134, v132, v135, v134
    v_cndmask_b32 v4, v136, v134, vcc
    v_add_u32 v130, 3280, v130
    v_add_u32 v131, 3072, v131
    v_lshrrev_b32 v134, 11, v130
    v_subrev_u32 v135, s65, v130
    v_mad_u32_u24 v134, v134, s68, v131
    v_and_b32 v135, 0x7ff, v135
    v_cmp_gt_u32 vcc, s66, v135
    v_lshrrev_b32 v135, 7, v130
    v_and_b32 v135, 32, v135
    v_xad_u32 v134, v132, v135, v134
    v_cndmask_b32 v5, v136, v134, vcc
    v_add_u32 v130, 3280, v130
    v_add_u32 v131, 3072, v131
    v_lshrrev_b32 v134, 11, v130
    v_subrev_u32 v135, s65, v130
    v_mad_u32_u24 v134, v134, s68, v131
    v_and_b32 v135, 0x7ff, v135
    v_cmp_gt_u32 vcc, s66, v135
    v_lshrrev_b32 v135, 7, v130
    v_and_b32 v135, 32, v135
    v_xad_u32 v134, v132, v135, v134
    v_cndmask_b32 v6, v136, v134, vcc
    s_cmp_lt_u32 s55, 63
    s_cselect_b32 s66, 10, 0
    s_add_u32 s64, s64, 1856
    v_mul_u32_u24 v134, 98304, v129
    v_add_u32 v134, s64, v134
    v_cmp_gt_u32 vcc, s66, v129
    s_nop 1
    v_cndmask_b32 v31, v136, v134, vcc
    v_mov_b32 v157, 268435456
    v_and_b32 v152, 15, v129
    v_lshrrev_b32 v153, 4, v129
    v_add_u32 v154, 4, v152
    v_lshrrev_b32 v154, 3, v154
    v_mad_i32_i24 v155, v154, -4, v152
    v_and_b32 v154, 1, v154
    v_and_b32 v156, 1, v153
    v_lshlrev_b32 v158, 1, v154
    v_mul_u32_u24 v159, 98304, v158
    v_mad_u32_u24 v159, v155, s69, v159
    v_lshl_add_u32 v159, v153, 4, v159
    v_add_u32 v26, s63, v159
    v_xor_b32 v26, 0x80000000, v26
    s_mov_b32 s54, 2147483648
    v_xor_b32 v161, v154, v138
    v_add_u32 v159, v153, v158
    v_add_u32 v160, 0, v155
    v_mad_u32_u24 v159, v159, 10, v160
    v_bfe_u32 v160, v159, 2, 1
    v_lshl_or_b32 v160, v161, 1, v160
    v_lshl_add_u32 v160, v159, 2, v160
    v_lshl_add_u32 v8, v160, 4, s56
    v_add_u32 v162, 1, v156
    v_add_u32 v159, v138, v158
    v_add_u32 v160, v162, v155
    v_mad_u32_u24 v159, v159, 10, v160
    v_bfe_u32 v160, v159, 2, 1
    v_lshl_or_b32 v160, v154, 1, v160
    v_lshl_add_u32 v160, v159, 2, v160
    v_lshl_add_u32 v12, v160, 4, s56
    v_xor_b32 v9, 16, v8
    v_xor_b32 v10, 32, v8
    v_xor_b32 v11, 48, v8
    v_xor_b32 v13, 16, v12
    v_xor_b32 v14, 32, v12
    v_xor_b32 v15, 48, v12
    v_add_u32 v159, 1, v158
    v_add_u32 v160, 1, v155
    v_mad_u32_u24 v159, v159, 10, v160
    v_bfe_u32 v160, v159, 2, 1
    v_lshl_or_b32 v160, v154, 1, v160
    v_xor_b32 v160, v153, v160
    v_lshl_add_u32 v160, v159, 2, v160
    v_lshl_add_u32 v20, v160, 4, s56
    v_xor_b32 v161, 1, v154
    v_add_u32 v159, 2, v158
    v_add_u32 v160, 1, v155
    v_mad_u32_u24 v159, v159, 10, v160
    v_bfe_u32 v160, v159, 2, 1
    v_lshl_or_b32 v160, v161, 1, v160
    v_xor_b32 v160, v153, v160
    v_lshl_add_u32 v160, v159, 2, v160
    v_lshl_add_u32 v21, v160, 4, s56
    v_bfe_u32 v158, v152, 2, 1
    v_sub_u32 v158, v153, v158
    v_and_b32 v159, 3, v152
    v_mul_u32_u24 v16, 0x1111, v159
    v_lshrrev_b32 v160, 3, v152
    v_lshl_add_u32 v159, v160, 2, v159
    v_lshlrev_b32 v159, 5, v159
    v_add_u32 v159, 141312, v159
    s_movk_i32 s70, 3072
    v_cmp_gt_u32 vcc, 3, v158
    v_mad_u32_u24 v159, v158, s70, v159
    s_nop 0
    v_cndmask_b32 v22, v157, v159, vcc
    v_lshlrev_b32 v23, 4, v129
    v_add_u32 v24, 40960, v23
    v_lshlrev_b32 v25, 5, v153
    v_add_u32 v25, 150528, v25
    v_and_b32 v160, 1, v129
    v_lshlrev_b32 v160, 4, v160
    v_mov_b32 v161, 0x3f80
    v_lshlrev_b32 v160, v160, v161
    v_bfe_u32 v158, v129, 1, 1
    v_bfe_u32 v159, v129, 3, 2
    v_lshl_add_u32 v159, v159, 1, v158
    v_bfe_u32 v161, v129, 2, 1
    v_xor_b32 v161, v161, v138
    v_lshl_add_u32 v159, v161, 3, v159
    v_lshlrev_b32 v159, v159, 1
    v_lshrrev_b32 v161, 2, v152
    v_xor_b32 v161, v161, v153
    v_lshl_add_u32 v158, v161, 1, v158
    v_lshlrev_b32 v158, v158, 1
    v_bfe_i32 v240, v159, 0, 1
    v_bfe_i32 v241, v159, 1, 1
    v_bfe_i32 v242, v159, 2, 1
    v_bfe_i32 v243, v159, 3, 1
    v_bfe_i32 v244, v159, 4, 1
    v_bfe_i32 v245, v159, 5, 1
    v_bfe_i32 v246, v159, 6, 1
    v_bfe_i32 v247, v159, 7, 1
    v_bfe_i32 v18, v158, 0, 1
    v_bfe_i32 v19, v158, 1, 1
    v_and_b32 v240, v160, v240
    v_and_b32 v241, v160, v241
    v_and_b32 v242, v160, v242
    v_and_b32 v243, v160, v243
    v_and_b32 v244, v160, v244
    v_and_b32 v245, v160, v245
    v_and_b32 v246, v160, v246
    v_and_b32 v247, v160, v247
    v_and_b32 v18, v160, v18
    v_and_b32 v19, v160, v19
    s_mov_b32 s24, s18
    s_mov_b32 s25, s19
    s_mov_b32 s26, 50331648
    s_mov_b32 s27, 0x20000
    s_mov_b32 s52, 0
    s_mov_b32 s80, 0
    s_mov_b32 s81, 98304
    s_mov_b32 s82, 393216
    s_mov_b32 s83, 491520
    s_mov_b32 s53, 1156138217
    s_mov_b32 s58, 0x3c003c00
    s_mov_b32 s85, 150912
    s_mov_b32 s86, 0x37803780
    s_mov_b32 s84, 0x37800000
    v_lshrrev_b32 v158, 2, v152
    v_xor_b32 v158, v158, v153
    v_bfe_i32 v158, v158, 0, 1
    v_bfi_b32 v158, v158, 0, s58
    v_accvgpr_write_b32 a228, v158
    v_accvgpr_write_b32 a229, v158
    v_accvgpr_write_b32 a230, v158
    v_accvgpr_write_b32 a231, v158
    v_and_b32 v17, v138, v153
    v_lshlrev_b32 v17, 4, v17
    v_lshrrev_b32 v17, v17, -1
    s_mov_b32 s73, 0x409d2a01
    s_mov_b32 s59, 0x3ef00000
    v_mul_u32_u24 v252, 0x100010, v0
    v_add_u32 v252, 0xc0004, v252
    v_lshlrev_b32 v253, 2, v0
    v_add_u32 v253, 150912, v253
    v_add_u32 v160, 0x0, v252
    v_add_u32 v168, 0x10001000, v252
    v_cvt_f32_f16 v161, v160
    v_cvt_f32_f16 v169, v168
    v_cvt_f32_f16_sdwa v162, v160 dst_sel:DWORD dst_unused:UNUSED_PAD src0_sel:WORD_1
    v_cvt_f32_f16_sdwa v170, v168 dst_sel:DWORD dst_unused:UNUSED_PAD src0_sel:WORD_1
    v_mul_f32 v163, 0x3f7fdde7, v161
    v_mul_f32 v171, 0x3f7fdde7, v169
    v_mul_f32 v164, 0x3f7fdde7, v162
    v_mul_f32 v172, 0x3f7fdde7, v170
    v_fma_f32 v163, v163, v161, s73
    v_fma_f32 v171, v171, v169, s73
    v_fma_f32 v164, v164, v162, s73
    v_fma_f32 v172, v172, v170, s73
    v_mul_f32 v163, -v161, v163
    v_mul_f32 v171, -v169, v171
    v_mul_f32 v164, -v162, v164
    v_mul_f32 v172, -v170, v172
    v_exp_f32 v165, v163
    v_exp_f32 v173, v171
    v_exp_f32 v166, v164
    v_exp_f32 v174, v172
    v_fma_f32 v163, v165, s59, s59
    v_fma_f32 v171, v173, s59, s59
    v_fma_f32 v164, v166, s59, s59
    v_fma_f32 v172, v174, s59, s59
    v_rcp_f32 v163, v163
    v_rcp_f32 v171, v171
    v_rcp_f32 v164, v164
    v_rcp_f32 v172, v172
    v_mul_f32 v163, v161, v163
    v_mul_f32 v171, v169, v171
    v_mul_f32 v164, v162, v164
    v_mul_f32 v172, v170, v172
    v_mul_f32 v165, -v165, v163
    v_mul_f32 v173, -v173, v171
    v_mul_f32 v166, -v166, v164
    v_mul_f32 v174, -v174, v172
    v_cvt_pk_bf16_f32 v167, v165, v166
    v_cvt_pk_bf16_f32 v175, v173, v174
    v_cvt_pk_bf16_f32 v160, v163, v164
    v_cvt_pk_bf16_f32 v168, v171, v172
    ds_write_b32 v253, v167 offset:8192
    ds_write_b32 v253, v160 offset:0
    ds_write_b32 v253, v175 offset:9216
    ds_write_b32 v253, v168 offset:1024
    v_add_u32 v160, 0x20002000, v252
    s_nop 0
    v_add_u32 v168, 0x30003000, v252
    v_cvt_f32_f16 v161, v160
    v_cvt_f32_f16 v169, v168
    v_cvt_f32_f16_sdwa v162, v160 dst_sel:DWORD dst_unused:UNUSED_PAD src0_sel:WORD_1
    v_cvt_f32_f16_sdwa v170, v168 dst_sel:DWORD dst_unused:UNUSED_PAD src0_sel:WORD_1
    v_mul_f32 v163, 0x3f7fdde7, v161
    v_mul_f32 v171, 0x3f7fdde7, v169
    v_mul_f32 v164, 0x3f7fdde7, v162
    v_mul_f32 v172, 0x3f7fdde7, v170
    v_fma_f32 v163, v163, v161, s73
    v_fma_f32 v171, v171, v169, s73
    v_fma_f32 v164, v164, v162, s73
    v_fma_f32 v172, v172, v170, s73
    v_mul_f32 v163, -v161, v163
    v_mul_f32 v171, -v169, v171
    v_mul_f32 v164, -v162, v164
    v_mul_f32 v172, -v170, v172
    v_exp_f32 v165, v163
    v_exp_f32 v173, v171
    v_exp_f32 v166, v164
    v_exp_f32 v174, v172
    v_fma_f32 v163, v165, s59, s59
    v_fma_f32 v171, v173, s59, s59
    v_fma_f32 v164, v166, s59, s59
    v_fma_f32 v172, v174, s59, s59
    v_rcp_f32 v163, v163
    v_rcp_f32 v171, v171
    v_rcp_f32 v164, v164
    v_rcp_f32 v172, v172
    v_mul_f32 v163, v161, v163
    v_mul_f32 v171, v169, v171
    v_mul_f32 v164, v162, v164
    v_mul_f32 v172, v170, v172
    v_mul_f32 v165, -v165, v163
    v_mul_f32 v173, -v173, v171
    v_mul_f32 v166, -v166, v164
    v_mul_f32 v174, -v174, v172
    v_cvt_pk_bf16_f32 v167, v165, v166
    v_cvt_pk_bf16_f32 v175, v173, v174
    v_cvt_pk_bf16_f32 v160, v163, v164
    v_cvt_pk_bf16_f32 v168, v171, v172
    ds_write_b32 v253, v167 offset:10240
    ds_write_b32 v253, v160 offset:2048
    ds_write_b32 v253, v175 offset:11264
    ds_write_b32 v253, v168 offset:3072
    v_add_u32 v160, 0x40004000, v252
    s_nop 0
    v_add_u32 v168, 0x50005000, v252
    v_cvt_f32_f16 v161, v160
    v_cvt_f32_f16 v169, v168
    v_cvt_f32_f16_sdwa v162, v160 dst_sel:DWORD dst_unused:UNUSED_PAD src0_sel:WORD_1
    v_cvt_f32_f16_sdwa v170, v168 dst_sel:DWORD dst_unused:UNUSED_PAD src0_sel:WORD_1
    v_mul_f32 v163, 0x3f7fdde7, v161
    v_mul_f32 v171, 0x40088889, v169
    v_mul_f32 v164, 0x3f7fdde7, v162
    v_mul_f32 v172, 0x40088889, v170
    v_fma_f32 v163, v163, v161, s73
    v_cvt_pk_bf16_f32 v168, v171, v172
    v_fma_f32 v164, v164, v162, s73
    v_mul_f32 v163, -v161, v163
    v_mul_f32 v164, -v162, v164
    v_exp_f32 v165, v163
    v_exp_f32 v166, v164
    v_fma_f32 v163, v165, s59, s59
    v_fma_f32 v164, v166, s59, s59
    v_rcp_f32 v163, v163
    v_rcp_f32 v164, v164
    v_mul_f32 v163, v161, v163
    v_mul_f32 v164, v162, v164
    v_mul_f32 v165, -v165, v163
    v_mul_f32 v166, -v166, v164
    v_cvt_pk_bf16_f32 v167, v165, v166
    v_cvt_pk_bf16_f32 v160, v163, v164
    ds_write_b32 v253, v167 offset:12288
    ds_write_b32 v253, v160 offset:4096
    ds_write_b32 v253, v168 offset:5120
    s_nop 0
    v_add_u32 v160, 0x60006000, v252
    v_add_u32 v168, 0x70007000, v252
    v_cvt_f32_f16 v161, v160
    v_cvt_f32_f16 v169, v168
    v_cvt_f32_f16_sdwa v162, v160 dst_sel:DWORD dst_unused:UNUSED_PAD src0_sel:WORD_1
    v_cvt_f32_f16_sdwa v170, v168 dst_sel:DWORD dst_unused:UNUSED_PAD src0_sel:WORD_1
    v_mul_f32 v163, 0x40088889, v161
    v_mul_f32 v171, 0x40088889, v169
    v_mul_f32 v164, 0x40088889, v162
    v_mul_f32 v172, 0x40088889, v170
    v_cvt_pk_bf16_f32 v160, v163, v164
    v_cvt_pk_bf16_f32 v168, v171, v172
    ds_write_b32 v253, v160 offset:6144
    ds_write_b32 v253, v168 offset:7168
    v_lshlrev_b32 v158, 6, v0
    v_add_u32 v158, 141312, v158
    v_cmp_gt_u32 vcc, 144, v0
    s_nop 1
    v_cndmask_b32 v158, v157, v158, vcc
    v_and_b32 v159, 3, v0
    v_lshl_add_u32 v160, v159, 2, v158
    v_lshrrev_b32 v159, 1, v159
    v_lshl_add_u32 v159, v159, 2, v158
    v_lshlrev_b32 v161, 4, v0
    v_add_u32 v161, 150528, v161
    v_cmp_gt_u32 vcc, 24, v0
    s_nop 1
    v_cndmask_b32 v161, v157, v161, vcc
    v_mov_b32 v164, 0
    v_mov_b32 v165, 0
    v_mov_b32 v166, 0
    v_mov_b32 v167, 0
    ds_write_b128 v158, v[164:167]
    ds_write_b128 v158, v[164:167] offset:16
    s_waitcnt lgkmcnt(9)
    ds_write_b128 v158, v[164:167] offset:32
    ds_write_b128 v158, v[164:167] offset:48
    s_waitcnt vmcnt(14)
    ds_write_b16 v160, v144
    ds_write_b16_d16_hi v160, v144 offset:34
    s_waitcnt vmcnt(13)
    ds_write_b16 v159, v145 offset:16
    ds_write_b16_d16_hi v159, v145 offset:48
    s_waitcnt vmcnt(12) lgkmcnt(13)
    ds_write_b16 v159, v146 offset:24
    ds_write_b16_d16_hi v159, v146 offset:56
    s_waitcnt vmcnt(11)
    v_lshlrev_b32 v168, 16, v148
    v_and_b32 v169, 0xffff0000, v148
    v_lshlrev_b32 v170, 16, v149
    v_and_b32 v171, 0xffff0000, v149
    s_waitcnt vmcnt(10)
    v_lshlrev_b32 v172, 16, v150
    v_and_b32 v173, 0xffff0000, v150
    v_lshlrev_b32 v174, 16, v151
    v_and_b32 v175, 0xffff0000, v151
    v_mul_f32 v168, v168, v172
    v_mul_f32 v169, v169, v173
    v_mul_f32 v170, v170, v174
    v_mul_f32 v171, v171, v175
    s_waitcnt lgkmcnt(14)
    ds_write_b128 v161, v[168:171]
    s_waitcnt vmcnt(9)
    v_mfma_f32_32x32x16_bf16 v[176:191], v[208:211], v[240:243], 0
    v_mfma_f32_32x32x16_bf16 v[176:191], v[208:211], v[244:247], v[176:191]
    s_waitcnt vmcnt(8)
    s_nop 10
    v_mfma_f32_32x32x16_bf16 v[180:195], v[212:215], v[240:243], 0
    v_mfma_f32_32x32x16_bf16 v[180:195], v[212:215], v[244:247], v[180:195]
    s_waitcnt vmcnt(7)
    s_nop 10
    v_mfma_f32_32x32x16_bf16 v[184:199], v[216:219], v[240:243], 0
    v_mfma_f32_32x32x16_bf16 v[184:199], v[216:219], v[244:247], v[184:199]
    s_mov_b32 s74, 0
    s_mov_b32 s75, 6144
    buffer_load_dwordx4 a[0:3], v232, s[48:51], s74 offen offset:0
    buffer_load_dwordx4 a[4:7], v232, s[48:51], s75 offen offset:0
    buffer_load_dwordx4 a[8:11], v232, s[48:51], s74 offen offset:1536
    buffer_load_dwordx4 a[12:15], v232, s[48:51], s75 offen offset:1536
    buffer_load_dwordx4 a[16:19], v232, s[48:51], s74 offen offset:64
    buffer_load_dwordx4 a[20:23], v232, s[48:51], s75 offen offset:64
    buffer_load_dwordx4 a[24:27], v232, s[48:51], s74 offen offset:1600
    buffer_load_dwordx4 a[28:31], v232, s[48:51], s75 offen offset:1600
    buffer_load_dwordx4 a[32:35], v232, s[48:51], s74 offen offset:128
    buffer_load_dwordx4 a[36:39], v232, s[48:51], s75 offen offset:128
    buffer_load_dwordx4 a[40:43], v232, s[48:51], s74 offen offset:1664
    buffer_load_dwordx4 a[44:47], v232, s[48:51], s75 offen offset:1664
    s_mov_b32 s74, 24576
    s_mov_b32 s75, 30720
    buffer_load_dwordx4 a[48:51], v232, s[48:51], s74 offen offset:0
    buffer_load_dwordx4 a[52:55], v232, s[48:51], s75 offen offset:0
    buffer_load_dwordx4 a[56:59], v232, s[48:51], s74 offen offset:1536
    buffer_load_dwordx4 a[60:63], v232, s[48:51], s75 offen offset:1536
    buffer_load_dwordx4 a[64:67], v232, s[48:51], s74 offen offset:64
    buffer_load_dwordx4 a[68:71], v232, s[48:51], s75 offen offset:64
    buffer_load_dwordx4 a[72:75], v232, s[48:51], s74 offen offset:1600
    buffer_load_dwordx4 a[76:79], v232, s[48:51], s75 offen offset:1600
    buffer_load_dwordx4 a[80:83], v232, s[48:51], s74 offen offset:128
    buffer_load_dwordx4 a[84:87], v232, s[48:51], s75 offen offset:128
    buffer_load_dwordx4 a[88:91], v232, s[48:51], s74 offen offset:1664
    buffer_load_dwordx4 a[92:95], v232, s[48:51], s75 offen offset:1664
    s_waitcnt vmcnt(23)
    v_mfma_f32_32x32x16_bf16 v[80:95], a[0:3], v[240:243], 0
    s_waitcnt vmcnt(21)
    v_mfma_f32_32x32x16_bf16 v[96:111], a[8:11], v[240:243], 0
    v_mfma_f32_32x32x16_bf16 v[80:95], a[4:7], v[244:247], v[80:95]
    s_waitcnt vmcnt(20)
    v_mfma_f32_32x32x16_bf16 v[96:111], a[12:15], v[244:247], v[96:111]
    s_waitcnt vmcnt(19)
    v_mfma_f32_32x32x16_bf16 v[112:127], a[16:19], v[240:243], 0
    s_waitcnt vmcnt(17)
    v_mfma_f32_32x32x16_bf16 v[128:143], a[24:27], v[240:243], 0
    v_mfma_f32_32x32x16_bf16 v[112:127], a[20:23], v[244:247], v[112:127]
    s_waitcnt vmcnt(16)
    v_mfma_f32_32x32x16_bf16 v[128:143], a[28:31], v[244:247], v[128:143]
    s_nop 2
    v_pk_mul_f32 v[80:81], v[80:81], v[176:177]
    v_pk_mul_f32 v[84:85], v[84:85], v[176:177]
    v_pk_mul_f32 v[88:89], v[88:89], v[176:177]
    v_pk_mul_f32 v[92:93], v[92:93], v[176:177]
    v_pk_mul_f32 v[96:97], v[96:97], v[176:177]
    v_pk_mul_f32 v[100:101], v[100:101], v[176:177]
    v_pk_mul_f32 v[104:105], v[104:105], v[176:177]
    v_pk_mul_f32 v[108:109], v[108:109], v[176:177]
    v_cvt_pk_bf16_f32 v224, v80, v84
    v_cvt_pk_bf16_f32 v225, v88, v92
    v_cvt_pk_bf16_f32 v226, v96, v100
    v_cvt_pk_bf16_f32 v227, v104, v108
    s_waitcnt vmcnt(15)
    v_mfma_f32_32x32x16_bf16 v[144:159], a[32:35], v[240:243], 0
    s_waitcnt lgkmcnt(14)
    ds_write_b128 v234, v[224:227] offset:6144
    s_mov_b32 s74, 49152
    v_cvt_pk_bf16_f32 v228, v81, v85
    v_cvt_pk_bf16_f32 v229, v89, v93
    v_cvt_pk_bf16_f32 v230, v97, v101
    v_cvt_pk_bf16_f32 v231, v105, v109
    s_waitcnt vmcnt(13)
    v_mfma_f32_32x32x16_bf16 v[160:175], a[40:43], v[240:243], 0
    s_waitcnt lgkmcnt(14)
    ds_write_b128 v235, v[228:231] offset:6144
    s_mov_b32 s75, 55296
    buffer_load_dwordx4 v[32:35], v232, s[48:51], s74 offen offset:0
    v_pk_mul_f32 v[82:83], v[82:83], v[178:179]
    v_pk_mul_f32 v[86:87], v[86:87], v[178:179]
    v_pk_mul_f32 v[90:91], v[90:91], v[178:179]
    v_pk_mul_f32 v[94:95], v[94:95], v[178:179]
    v_pk_mul_f32 v[98:99], v[98:99], v[178:179]
    v_pk_mul_f32 v[102:103], v[102:103], v[178:179]
    v_pk_mul_f32 v[106:107], v[106:107], v[178:179]
    v_pk_mul_f32 v[110:111], v[110:111], v[178:179]
    v_cvt_pk_bf16_f32 v224, v82, v86
    v_cvt_pk_bf16_f32 v225, v90, v94
    v_cvt_pk_bf16_f32 v226, v98, v102
    v_cvt_pk_bf16_f32 v227, v106, v110
    v_mfma_f32_32x32x16_bf16 v[144:159], a[36:39], v[244:247], v[144:159]
    s_waitcnt lgkmcnt(14)
    ds_write_b128 v234, v[224:227] offset:6272
    buffer_load_dwordx4 v[36:39], v232, s[48:51], s75 offen offset:0
    v_cvt_pk_bf16_f32 v228, v83, v87
    v_cvt_pk_bf16_f32 v229, v91, v95
    v_cvt_pk_bf16_f32 v230, v99, v103
    v_cvt_pk_bf16_f32 v231, v107, v111
    s_waitcnt vmcnt(14)
    v_mfma_f32_32x32x16_bf16 v[160:175], a[44:47], v[244:247], v[160:175]
    s_waitcnt vmcnt(10)
    s_waitcnt lgkmcnt(14)
    ds_write_b128 v235, v[228:231] offset:6272
    buffer_load_dwordx4 v[40:43], v232, s[48:51], s74 offen offset:1536
    buffer_load_dwordx4 v[44:47], v232, s[48:51], s75 offen offset:1536
    v_pk_mul_f32 v[112:113], v[112:113], v[180:181]
    v_pk_mul_f32 v[116:117], v[116:117], v[180:181]
    v_pk_mul_f32 v[120:121], v[120:121], v[180:181]
    v_pk_mul_f32 v[124:125], v[124:125], v[180:181]
    v_pk_mul_f32 v[128:129], v[128:129], v[180:181]
    v_pk_mul_f32 v[132:133], v[132:133], v[180:181]
    v_pk_mul_f32 v[136:137], v[136:137], v[180:181]
    v_pk_mul_f32 v[140:141], v[140:141], v[180:181]
    v_cvt_pk_bf16_f32 v224, v112, v116
    v_cvt_pk_bf16_f32 v225, v120, v124
    v_cvt_pk_bf16_f32 v226, v128, v132
    v_cvt_pk_bf16_f32 v227, v136, v140
    v_mfma_f32_32x32x16_bf16 v[80:95], a[48:51], v[240:243], 0
    s_waitcnt lgkmcnt(14)
    ds_write_b128 v234, v[224:227] offset:8192
    buffer_load_dwordx4 v[48:51], v232, s[48:51], s74 offen offset:64
    v_cvt_pk_bf16_f32 v228, v113, v117
    v_cvt_pk_bf16_f32 v229, v121, v125
    v_cvt_pk_bf16_f32 v230, v129, v133
    v_cvt_pk_bf16_f32 v231, v137, v141
    v_mfma_f32_32x32x16_bf16 v[96:111], a[56:59], v[240:243], 0
    s_waitcnt lgkmcnt(14)
    ds_write_b128 v235, v[228:231] offset:8192
    buffer_load_dwordx4 v[52:55], v232, s[48:51], s75 offen offset:64
    v_pk_mul_f32 v[114:115], v[114:115], v[182:183]
    v_pk_mul_f32 v[118:119], v[118:119], v[182:183]
    v_pk_mul_f32 v[122:123], v[122:123], v[182:183]
    v_pk_mul_f32 v[126:127], v[126:127], v[182:183]
    v_pk_mul_f32 v[130:131], v[130:131], v[182:183]
    v_pk_mul_f32 v[134:135], v[134:135], v[182:183]
    v_pk_mul_f32 v[138:139], v[138:139], v[182:183]
    v_pk_mul_f32 v[142:143], v[142:143], v[182:183]
    v_cvt_pk_bf16_f32 v224, v114, v118
    v_cvt_pk_bf16_f32 v225, v122, v126
    v_cvt_pk_bf16_f32 v226, v130, v134
    v_cvt_pk_bf16_f32 v227, v138, v142
    v_mfma_f32_32x32x16_bf16 v[80:95], a[52:55], v[244:247], v[80:95]
    s_waitcnt lgkmcnt(14)
    ds_write_b128 v234, v[224:227] offset:8320
    buffer_load_dwordx4 v[56:59], v232, s[48:51], s74 offen offset:1600
    v_cvt_pk_bf16_f32 v228, v115, v119
    v_cvt_pk_bf16_f32 v229, v123, v127
    v_cvt_pk_bf16_f32 v230, v131, v135
    v_cvt_pk_bf16_f32 v231, v139, v143
    v_mfma_f32_32x32x16_bf16 v[96:111], a[60:63], v[244:247], v[96:111]
    s_waitcnt vmcnt(11)
    s_waitcnt lgkmcnt(14)
    ds_write_b128 v235, v[228:231] offset:8320
    buffer_load_dwordx4 v[60:63], v232, s[48:51], s75 offen offset:1600
    v_pk_mul_f32 v[144:145], v[144:145], v[184:185]
    v_pk_mul_f32 v[148:149], v[148:149], v[184:185]
    v_pk_mul_f32 v[152:153], v[152:153], v[184:185]
    v_pk_mul_f32 v[156:157], v[156:157], v[184:185]
    v_pk_mul_f32 v[160:161], v[160:161], v[184:185]
    v_pk_mul_f32 v[164:165], v[164:165], v[184:185]
    v_pk_mul_f32 v[168:169], v[168:169], v[184:185]
    v_pk_mul_f32 v[172:173], v[172:173], v[184:185]
    v_cvt_pk_bf16_f32 v224, v144, v148
    v_cvt_pk_bf16_f32 v225, v152, v156
    v_cvt_pk_bf16_f32 v226, v160, v164
    v_cvt_pk_bf16_f32 v227, v168, v172
    v_mfma_f32_32x32x16_bf16 v[112:127], a[64:67], v[240:243], 0
    s_waitcnt lgkmcnt(14)
    ds_write_b128 v234, v[224:227] offset:10240
    buffer_load_dwordx4 v[64:67], v232, s[48:51], s74 offen offset:128
    v_cvt_pk_bf16_f32 v228, v145, v149
    v_cvt_pk_bf16_f32 v229, v153, v157
    v_cvt_pk_bf16_f32 v230, v161, v165
    v_cvt_pk_bf16_f32 v231, v169, v173
    v_mfma_f32_32x32x16_bf16 v[128:143], a[72:75], v[240:243], 0
    s_waitcnt lgkmcnt(14)
    ds_write_b128 v235, v[228:231] offset:10240
    buffer_load_dwordx4 v[68:71], v232, s[48:51], s75 offen offset:128
    v_pk_mul_f32 v[146:147], v[146:147], v[186:187]
    v_pk_mul_f32 v[150:151], v[150:151], v[186:187]
    v_pk_mul_f32 v[154:155], v[154:155], v[186:187]
    v_pk_mul_f32 v[158:159], v[158:159], v[186:187]
    v_pk_mul_f32 v[162:163], v[162:163], v[186:187]
    v_pk_mul_f32 v[166:167], v[166:167], v[186:187]
    v_pk_mul_f32 v[170:171], v[170:171], v[186:187]
    v_pk_mul_f32 v[174:175], v[174:175], v[186:187]
    v_cvt_pk_bf16_f32 v224, v146, v150
    v_cvt_pk_bf16_f32 v225, v154, v158
    v_cvt_pk_bf16_f32 v226, v162, v166
    v_cvt_pk_bf16_f32 v227, v170, v174
    v_mfma_f32_32x32x16_bf16 v[112:127], a[68:71], v[244:247], v[112:127]
    s_waitcnt lgkmcnt(14)
    ds_write_b128 v234, v[224:227] offset:10368
    buffer_load_dwordx4 v[72:75], v232, s[48:51], s74 offen offset:1664
    v_cvt_pk_bf16_f32 v228, v147, v151
    v_cvt_pk_bf16_f32 v229, v155, v159
    v_cvt_pk_bf16_f32 v230, v163, v167
    v_cvt_pk_bf16_f32 v231, v171, v175
    v_mfma_f32_32x32x16_bf16 v[128:143], a[76:79], v[244:247], v[128:143]
    s_waitcnt vmcnt(11)
    s_waitcnt lgkmcnt(14)
    ds_write_b128 v235, v[228:231] offset:10368
    buffer_load_dwordx4 v[76:79], v232, s[48:51], s75 offen offset:1664
    v_sub_u32 v234, v234, v238
    v_sub_u32 v235, v235, v238
    v_pk_mul_f32 v[80:81], v[80:81], v[176:177]
    v_pk_mul_f32 v[84:85], v[84:85], v[176:177]
    v_pk_mul_f32 v[88:89], v[88:89], v[176:177]
    v_pk_mul_f32 v[92:93], v[92:93], v[176:177]
    v_pk_mul_f32 v[96:97], v[96:97], v[176:177]
    v_pk_mul_f32 v[100:101], v[100:101], v[176:177]
    v_pk_mul_f32 v[104:105], v[104:105], v[176:177]
    v_pk_mul_f32 v[108:109], v[108:109], v[176:177]
    v_cvt_pk_bf16_f32 v224, v80, v84
    v_cvt_pk_bf16_f32 v225, v88, v92
    v_cvt_pk_bf16_f32 v226, v96, v100
    v_cvt_pk_bf16_f32 v227, v104, v108
    v_mfma_f32_32x32x16_bf16 v[144:159], a[80:83], v[240:243], 0
    s_waitcnt lgkmcnt(14)
    ds_write_b128 v234, v[224:227] offset:6144
    s_add_u32 m0, s56, 6336
    s_nop 0
    buffer_load_dwordx4 v1, s[20:23], 0 offen offset:64 lds
    v_cvt_pk_bf16_f32 v228, v81, v85
    v_cvt_pk_bf16_f32 v229, v89, v93
    v_cvt_pk_bf16_f32 v230, v97, v101
    v_cvt_pk_bf16_f32 v231, v105, v109
    v_mfma_f32_32x32x16_bf16 v[160:175], a[88:91], v[240:243], 0
    s_waitcnt lgkmcnt(14)
    ds_write_b128 v235, v[228:231] offset:6144
    s_add_u32 m0, s56, 7360
    s_nop 0
    buffer_load_dwordx4 v2, s[20:23], 0 offen offset:64 lds
    v_pk_mul_f32 v[82:83], v[82:83], v[178:179]
    v_pk_mul_f32 v[86:87], v[86:87], v[178:179]
    v_pk_mul_f32 v[90:91], v[90:91], v[178:179]
    v_pk_mul_f32 v[94:95], v[94:95], v[178:179]
    v_pk_mul_f32 v[98:99], v[98:99], v[178:179]
    v_pk_mul_f32 v[102:103], v[102:103], v[178:179]
    v_pk_mul_f32 v[106:107], v[106:107], v[178:179]
    v_pk_mul_f32 v[110:111], v[110:111], v[178:179]
    v_cvt_pk_bf16_f32 v224, v82, v86
    v_cvt_pk_bf16_f32 v225, v90, v94
    v_cvt_pk_bf16_f32 v226, v98, v102
    v_cvt_pk_bf16_f32 v227, v106, v110
    v_mfma_f32_32x32x16_bf16 v[144:159], a[84:87], v[244:247], v[144:159]
    s_waitcnt lgkmcnt(14)
    ds_write_b128 v234, v[224:227] offset:6272
    s_add_u32 m0, s56, 8384
    s_nop 0
    buffer_load_dwordx4 v3, s[20:23], 0 offen offset:64 lds
    v_cvt_pk_bf16_f32 v228, v83, v87
    v_cvt_pk_bf16_f32 v229, v91, v95
    v_cvt_pk_bf16_f32 v230, v99, v103
    v_cvt_pk_bf16_f32 v231, v107, v111
    v_mfma_f32_32x32x16_bf16 v[160:175], a[92:95], v[244:247], v[160:175]
    s_waitcnt vmcnt(11)
    s_waitcnt lgkmcnt(14)
    ds_write_b128 v235, v[228:231] offset:6272
    s_add_u32 m0, s56, 9408
    s_nop 0
    buffer_load_dwordx4 v4, s[20:23], 0 offen offset:64 lds
    v_pk_mul_f32 v[112:113], v[112:113], v[180:181]
    v_pk_mul_f32 v[116:117], v[116:117], v[180:181]
    v_pk_mul_f32 v[120:121], v[120:121], v[180:181]
    v_pk_mul_f32 v[124:125], v[124:125], v[180:181]
    v_pk_mul_f32 v[128:129], v[128:129], v[180:181]
    v_pk_mul_f32 v[132:133], v[132:133], v[180:181]
    v_pk_mul_f32 v[136:137], v[136:137], v[180:181]
    v_pk_mul_f32 v[140:141], v[140:141], v[180:181]
    v_cvt_pk_bf16_f32 v224, v112, v116
    v_cvt_pk_bf16_f32 v225, v120, v124
    v_cvt_pk_bf16_f32 v226, v128, v132
    v_cvt_pk_bf16_f32 v227, v136, v140
    v_mfma_f32_32x32x16_bf16 v[80:95], v[32:35], v[240:243], 0
    s_waitcnt lgkmcnt(0)
    s_barrier
    ds_write_b128 v234, v[224:227] offset:8192
    ds_read_b128 a[192:195], v23 offset:4096
    ds_read_b128 a[196:199], v23 offset:5120
    ds_read_b128 a[200:203], v23 offset:14336
    ds_read_b128 a[204:207], v23 offset:15360
    ds_read_b128 a[208:211], v23 offset:24576
    ds_read_b128 a[212:215], v23 offset:25600
    ds_read_b128 a[216:219], v23 offset:34816
    s_add_u32 m0, s56, 10432
    v_cvt_pk_bf16_f32 v228, v113, v117
    v_cvt_pk_bf16_f32 v229, v121, v125
    v_cvt_pk_bf16_f32 v230, v129, v133
    v_cvt_pk_bf16_f32 v231, v137, v141
    v_mfma_f32_32x32x16_bf16 v[96:111], v[40:43], v[240:243], 0
    ds_write_b128 v235, v[228:231] offset:8192
    ds_read_b128 a[220:223], v23 offset:35840
    ds_read_b128 a[0:3], v24 offset:0
    ds_read_b128 a[4:7], v24 offset:1024
    ds_read_b128 a[24:27], v24 offset:6144
    ds_read_b128 a[28:31], v24 offset:7168
    ds_read_b128 a[96:99], v24 offset:24576
    s_waitcnt lgkmcnt(14)
    ds_read_b128 a[100:103], v24 offset:25600
    buffer_load_dwordx4 v5, s[20:23], 0 offen offset:64 lds
    s_add_u32 m0, s56, 11456
    v_pk_mul_f32 v[114:115], v[114:115], v[182:183]
    v_pk_mul_f32 v[118:119], v[118:119], v[182:183]
    v_pk_mul_f32 v[122:123], v[122:123], v[182:183]
    v_pk_mul_f32 v[126:127], v[126:127], v[182:183]
    v_pk_mul_f32 v[130:131], v[130:131], v[182:183]
    v_pk_mul_f32 v[134:135], v[134:135], v[182:183]
    v_pk_mul_f32 v[138:139], v[138:139], v[182:183]
    v_pk_mul_f32 v[142:143], v[142:143], v[182:183]
    v_cvt_pk_bf16_f32 v224, v114, v118
    v_cvt_pk_bf16_f32 v225, v122, v126
    v_cvt_pk_bf16_f32 v226, v130, v134
    v_cvt_pk_bf16_f32 v227, v138, v142
    v_mfma_f32_32x32x16_bf16 v[80:95], v[36:39], v[244:247], v[80:95]
    s_waitcnt lgkmcnt(9)
    ds_write_b128 v234, v[224:227] offset:8320
    ds_read_b128 a[120:123], v24 offset:30720
    ds_read_b128 a[124:127], v24 offset:31744
    ds_read_b128 a[144:147], v24 offset:36864
    ds_read_b128 a[148:151], v24 offset:37888
    ds_read_b128 a[168:171], v24 offset:43008
    s_waitcnt lgkmcnt(13)
    ds_read_b128 a[172:175], v24 offset:44032
    ds_read_b128 a[48:51], v24 offset:12288
    buffer_load_dwordx4 v6, s[20:23], 0 offen offset:64 lds
    s_add_u32 m0, s56, 12480
    v_cvt_pk_bf16_f32 v228, v115, v119
    v_cvt_pk_bf16_f32 v229, v123, v127
    v_cvt_pk_bf16_f32 v230, v131, v135
    v_cvt_pk_bf16_f32 v231, v139, v143
    v_mfma_f32_32x32x16_bf16 v[96:111], v[44:47], v[244:247], v[96:111]
    s_waitcnt vmcnt(10)
    s_waitcnt lgkmcnt(9)
    ds_write_b128 v235, v[228:231] offset:8320
    ds_read_b128 a[52:55], v24 offset:13312
    ds_read_b128 a[72:75], v24 offset:18432
    ds_read_b128 a[76:79], v24 offset:19456
    ds_read_b128 a[8:11], v24 offset:2048
    ds_read_b128 a[12:15], v24 offset:3072
    s_waitcnt lgkmcnt(13)
    ds_read_b128 a[32:35], v24 offset:8192
    ds_read_b128 a[36:39], v24 offset:9216
    buffer_load_dword v7, s[20:23], 0 offen offset:64 lds
    buffer_load_dword v254, v31, s[20:23], 0 offen
    v_pk_mul_f32 v[144:145], v[144:145], v[184:185]
    v_pk_mul_f32 v[148:149], v[148:149], v[184:185]
    v_pk_mul_f32 v[152:153], v[152:153], v[184:185]
    v_pk_mul_f32 v[156:157], v[156:157], v[184:185]
    v_pk_mul_f32 v[160:161], v[160:161], v[184:185]
    v_pk_mul_f32 v[164:165], v[164:165], v[184:185]
    v_pk_mul_f32 v[168:169], v[168:169], v[184:185]
    v_pk_mul_f32 v[172:173], v[172:173], v[184:185]
    v_cvt_pk_bf16_f32 v224, v144, v148
    v_cvt_pk_bf16_f32 v225, v152, v156
    v_cvt_pk_bf16_f32 v226, v160, v164
    v_cvt_pk_bf16_f32 v227, v168, v172
    v_mfma_f32_32x32x16_bf16 v[112:127], v[48:51], v[240:243], 0
    s_waitcnt lgkmcnt(9)
    ds_write_b128 v234, v[224:227] offset:10240
    ds_read_b128 a[104:107], v24 offset:26624
    ds_read_b128 a[108:111], v24 offset:27648
    ds_read_b128 a[128:131], v24 offset:32768
    ds_read_b128 a[132:135], v24 offset:33792
    ds_read_b128 a[152:155], v24 offset:38912
    s_waitcnt lgkmcnt(13)
    ds_read_b128 a[156:159], v24 offset:39936
    ds_read_b128 a[176:179], v24 offset:45056
    v_cvt_pk_bf16_f32 v228, v145, v149
    v_cvt_pk_bf16_f32 v229, v153, v157
    v_cvt_pk_bf16_f32 v230, v161, v165
    v_cvt_pk_bf16_f32 v231, v169, v173
    v_mfma_f32_32x32x16_bf16 v[128:143], v[56:59], v[240:243], 0
    s_waitcnt lgkmcnt(9)
    ds_write_b128 v235, v[228:231] offset:10240
    ds_read_b128 a[180:183], v24 offset:46080
    ds_read_b128 a[56:59], v24 offset:14336
    ds_read_b128 a[60:63], v24 offset:15360
    ds_read_b128 a[80:83], v24 offset:20480
    ds_read_b128 a[84:87], v24 offset:21504
    s_waitcnt lgkmcnt(13)
    ds_read_b128 a[16:19], v24 offset:4096
    ds_read_b128 a[20:23], v24 offset:5120
    v_pk_mul_f32 v[146:147], v[146:147], v[186:187]
    v_pk_mul_f32 v[150:151], v[150:151], v[186:187]
    v_pk_mul_f32 v[154:155], v[154:155], v[186:187]
    v_pk_mul_f32 v[158:159], v[158:159], v[186:187]
    v_pk_mul_f32 v[162:163], v[162:163], v[186:187]
    v_pk_mul_f32 v[166:167], v[166:167], v[186:187]
    v_pk_mul_f32 v[170:171], v[170:171], v[186:187]
    v_pk_mul_f32 v[174:175], v[174:175], v[186:187]
    v_cvt_pk_bf16_f32 v224, v146, v150
    v_cvt_pk_bf16_f32 v225, v154, v158
    v_cvt_pk_bf16_f32 v226, v162, v166
    v_cvt_pk_bf16_f32 v227, v170, v174
    v_mfma_f32_32x32x16_bf16 v[112:127], v[52:55], v[244:247], v[112:127]
    s_waitcnt lgkmcnt(9)
    ds_write_b128 v234, v[224:227] offset:10368
    ds_read_b128 a[40:43], v24 offset:10240
    ds_read_b128 a[44:47], v24 offset:11264
    ds_read_b128 a[112:115], v24 offset:28672
    ds_read_b128 a[116:119], v24 offset:29696
    ds_read_b128 a[136:139], v24 offset:34816
    s_waitcnt lgkmcnt(13)
    ds_read_b128 a[140:143], v24 offset:35840
    ds_read_b128 a[160:163], v24 offset:40960
    v_cvt_pk_bf16_f32 v228, v147, v151
    v_cvt_pk_bf16_f32 v229, v155, v159
    v_cvt_pk_bf16_f32 v230, v163, v167
    v_cvt_pk_bf16_f32 v231, v171, v175
    v_mfma_f32_32x32x16_bf16 v[128:143], v[60:63], v[244:247], v[128:143]
    s_waitcnt vmcnt(8)
    s_waitcnt lgkmcnt(9)
    ds_write_b128 v235, v[228:231] offset:10368
    ds_read_b128 a[164:167], v24 offset:41984
    ds_read_b128 a[184:187], v24 offset:47104
    ds_read_b128 a[188:191], v24 offset:48128
    ds_read_b128 a[64:67], v24 offset:16384
    ds_read_b128 a[68:71], v24 offset:17408
    s_waitcnt lgkmcnt(13)
    ds_read_b128 a[88:91], v24 offset:22528
    ds_read_b128 a[92:95], v24 offset:23552
    v_add_u32 v234, v234, v238
    v_add_u32 v235, v235, v238
    v_pk_mul_f32 v[80:81], v[80:81], v[176:177]
    v_pk_mul_f32 v[84:85], v[84:85], v[176:177]
    v_pk_mul_f32 v[88:89], v[88:89], v[176:177]
    v_pk_mul_f32 v[92:93], v[92:93], v[176:177]
    v_pk_mul_f32 v[96:97], v[96:97], v[176:177]
    v_pk_mul_f32 v[100:101], v[100:101], v[176:177]
    v_pk_mul_f32 v[104:105], v[104:105], v[176:177]
    v_pk_mul_f32 v[108:109], v[108:109], v[176:177]
    v_cvt_pk_bf16_f32 v224, v80, v84
    v_cvt_pk_bf16_f32 v225, v88, v92
    v_cvt_pk_bf16_f32 v226, v96, v100
    v_cvt_pk_bf16_f32 v227, v104, v108
    v_mfma_f32_32x32x16_bf16 v[144:159], v[64:67], v[240:243], 0
    s_waitcnt lgkmcnt(0)
    s_barrier
    ds_write_b128 v234, v[224:227] offset:6144
    v_cvt_pk_bf16_f32 v228, v81, v85
    v_cvt_pk_bf16_f32 v229, v89, v93
    v_cvt_pk_bf16_f32 v230, v97, v101
    v_cvt_pk_bf16_f32 v231, v105, v109
    v_mfma_f32_32x32x16_bf16 v[160:175], v[72:75], v[240:243], 0
    ds_write_b128 v235, v[228:231] offset:6144
    v_pk_mul_f32 v[82:83], v[82:83], v[178:179]
    v_pk_mul_f32 v[86:87], v[86:87], v[178:179]
    v_pk_mul_f32 v[90:91], v[90:91], v[178:179]
    v_pk_mul_f32 v[94:95], v[94:95], v[178:179]
    v_pk_mul_f32 v[98:99], v[98:99], v[178:179]
    v_pk_mul_f32 v[102:103], v[102:103], v[178:179]
    v_pk_mul_f32 v[106:107], v[106:107], v[178:179]
    v_pk_mul_f32 v[110:111], v[110:111], v[178:179]
    v_cvt_pk_bf16_f32 v224, v82, v86
    v_cvt_pk_bf16_f32 v225, v90, v94
    v_cvt_pk_bf16_f32 v226, v98, v102
    v_cvt_pk_bf16_f32 v227, v106, v110
    v_mfma_f32_32x32x16_bf16 v[144:159], v[68:71], v[244:247], v[144:159]
    ds_write_b128 v234, v[224:227] offset:6272
    v_cvt_pk_bf16_f32 v228, v83, v87
    v_cvt_pk_bf16_f32 v229, v91, v95
    v_cvt_pk_bf16_f32 v230, v99, v103
    v_cvt_pk_bf16_f32 v231, v107, v111
    v_mfma_f32_32x32x16_bf16 v[160:175], v[76:79], v[244:247], v[160:175]
    ds_write_b128 v235, v[228:231] offset:6272
    v_pk_mul_f32 v[112:113], v[112:113], v[180:181]
    v_pk_mul_f32 v[116:117], v[116:117], v[180:181]
    v_pk_mul_f32 v[120:121], v[120:121], v[180:181]
    v_pk_mul_f32 v[124:125], v[124:125], v[180:181]
    v_pk_mul_f32 v[128:129], v[128:129], v[180:181]
    v_pk_mul_f32 v[132:133], v[132:133], v[180:181]
    v_pk_mul_f32 v[136:137], v[136:137], v[180:181]
    v_pk_mul_f32 v[140:141], v[140:141], v[180:181]
    v_cvt_pk_bf16_f32 v224, v112, v116
    v_cvt_pk_bf16_f32 v225, v120, v124
    v_cvt_pk_bf16_f32 v226, v128, v132
    v_cvt_pk_bf16_f32 v227, v136, v140
    ds_write_b128 v234, v[224:227] offset:8192
    v_cvt_pk_bf16_f32 v228, v113, v117
    v_cvt_pk_bf16_f32 v229, v121, v125
    v_cvt_pk_bf16_f32 v230, v129, v133
    v_cvt_pk_bf16_f32 v231, v137, v141
    ds_write_b128 v235, v[228:231] offset:8192
    v_pk_mul_f32 v[114:115], v[114:115], v[182:183]
    v_pk_mul_f32 v[118:119], v[118:119], v[182:183]
    v_pk_mul_f32 v[122:123], v[122:123], v[182:183]
    v_pk_mul_f32 v[126:127], v[126:127], v[182:183]
    v_pk_mul_f32 v[130:131], v[130:131], v[182:183]
    v_pk_mul_f32 v[134:135], v[134:135], v[182:183]
    v_pk_mul_f32 v[138:139], v[138:139], v[182:183]
    v_pk_mul_f32 v[142:143], v[142:143], v[182:183]
    v_cvt_pk_bf16_f32 v224, v114, v118
    v_cvt_pk_bf16_f32 v225, v122, v126
    v_cvt_pk_bf16_f32 v226, v130, v134
    v_cvt_pk_bf16_f32 v227, v138, v142
    ds_write_b128 v234, v[224:227] offset:8320
    v_cvt_pk_bf16_f32 v228, v115, v119
    v_cvt_pk_bf16_f32 v229, v123, v127
    v_cvt_pk_bf16_f32 v230, v131, v135
    v_cvt_pk_bf16_f32 v231, v139, v143
    ds_write_b128 v235, v[228:231] offset:8320
    v_pk_mul_f32 v[144:145], v[144:145], v[184:185]
    v_pk_mul_f32 v[148:149], v[148:149], v[184:185]
    v_pk_mul_f32 v[152:153], v[152:153], v[184:185]
    v_pk_mul_f32 v[156:157], v[156:157], v[184:185]
    v_pk_mul_f32 v[160:161], v[160:161], v[184:185]
    v_pk_mul_f32 v[164:165], v[164:165], v[184:185]
    v_pk_mul_f32 v[168:169], v[168:169], v[184:185]
    v_pk_mul_f32 v[172:173], v[172:173], v[184:185]
    v_cvt_pk_bf16_f32 v224, v144, v148
    v_cvt_pk_bf16_f32 v225, v152, v156
    v_cvt_pk_bf16_f32 v226, v160, v164
    v_cvt_pk_bf16_f32 v227, v168, v172
    ds_write_b128 v234, v[224:227] offset:10240
    v_cvt_pk_bf16_f32 v228, v145, v149
    v_cvt_pk_bf16_f32 v229, v153, v157
    v_cvt_pk_bf16_f32 v230, v161, v165
    v_cvt_pk_bf16_f32 v231, v169, v173
    ds_write_b128 v235, v[228:231] offset:10240
    v_pk_mul_f32 v[146:147], v[146:147], v[186:187]
    v_pk_mul_f32 v[150:151], v[150:151], v[186:187]
    v_pk_mul_f32 v[154:155], v[154:155], v[186:187]
    v_pk_mul_f32 v[158:159], v[158:159], v[186:187]
    v_pk_mul_f32 v[162:163], v[162:163], v[186:187]
    v_pk_mul_f32 v[166:167], v[166:167], v[186:187]
    v_pk_mul_f32 v[170:171], v[170:171], v[186:187]
    v_pk_mul_f32 v[174:175], v[174:175], v[186:187]
    v_cvt_pk_bf16_f32 v224, v146, v150
    v_cvt_pk_bf16_f32 v225, v154, v158
    v_cvt_pk_bf16_f32 v226, v162, v166
    v_cvt_pk_bf16_f32 v227, v170, v174
    ds_write_b128 v234, v[224:227] offset:10368
    v_cvt_pk_bf16_f32 v228, v147, v151
    v_cvt_pk_bf16_f32 v229, v155, v159
    v_cvt_pk_bf16_f32 v230, v163, v167
    v_cvt_pk_bf16_f32 v231, v171, v175
    ds_write_b128 v235, v[228:231] offset:10368
    s_branch L_conv0
L_prb0:
    v_lshrrev_b32 v131, 4, v129
    v_add_u32 v131, 96, v131
    v_mul_u32_u24 v130, 205, v131
    v_mul_u32_u24 v131, 192, v131
    v_add_u32 v131, s64, v131
    v_lshlrev_b32 v133, 2, v129
    v_and_b32 v133, 63, v133
    v_lshrrev_b32 v134, 11, v130
    v_subrev_u32 v135, s65, v130
    v_mad_u32_u24 v134, v134, s68, v131
    v_and_b32 v135, 0x7ff, v135
    v_cmp_gt_u32 vcc, s66, v135
    v_lshrrev_b32 v135, 7, v130
    v_and_b32 v135, 32, v135
    v_xad_u32 v134, v133, v135, v134
    v_cndmask_b32 v7, v136, v134, vcc
    s_add_u32 m0, s56, 6144
    s_nop 0
    buffer_load_dword v7, s[20:23], 0 offen offset:0 lds
    v_lshrrev_b32 v131, 2, v129
    v_mul_u32_u24 v130, 205, v131
    v_mul_u32_u24 v131, 192, v131
    v_add_u32 v131, s64, v131
    v_lshrrev_b32 v134, 11, v130
    v_subrev_u32 v135, s65, v130
    v_mad_u32_u24 v134, v134, s68, v131
    v_and_b32 v135, 0x7ff, v135
    v_cmp_gt_u32 vcc, s66, v135
    v_lshrrev_b32 v135, 7, v130
    v_and_b32 v135, 32, v135
    v_xad_u32 v134, v132, v135, v134
    v_cndmask_b32 v1, v136, v134, vcc
    v_add_u32 v130, 3280, v130
    v_add_u32 v131, 3072, v131
    v_lshrrev_b32 v134, 11, v130
    v_subrev_u32 v135, s65, v130
    v_mad_u32_u24 v134, v134, s68, v131
    v_and_b32 v135, 0x7ff, v135
    v_cmp_gt_u32 vcc, s66, v135
    v_lshrrev_b32 v135, 7, v130
    v_and_b32 v135, 32, v135
    v_xad_u32 v134, v132, v135, v134
    v_cndmask_b32 v2, v136, v134, vcc
    v_add_u32 v130, 3280, v130
    v_add_u32 v131, 3072, v131
    v_lshrrev_b32 v134, 11, v130
    v_subrev_u32 v135, s65, v130
    v_mad_u32_u24 v134, v134, s68, v131
    v_and_b32 v135, 0x7ff, v135
    v_cmp_gt_u32 vcc, s66, v135
    v_lshrrev_b32 v135, 7, v130
    v_and_b32 v135, 32, v135
    v_xad_u32 v134, v132, v135, v134
    v_cndmask_b32 v3, v136, v134, vcc
    v_add_u32 v130, 3280, v130
    v_add_u32 v131, 3072, v131
    v_lshrrev_b32 v134, 11, v130
    v_subrev_u32 v135, s65, v130
    v_mad_u32_u24 v134, v134, s68, v131
    v_and_b32 v135, 0x7ff, v135
    v_cmp_gt_u32 vcc, s66, v135
    v_lshrrev_b32 v135, 7, v130
    v_and_b32 v135, 32, v135
    v_xad_u32 v134, v132, v135, v134
    v_cndmask_b32 v4, v136, v134, vcc
    v_add_u32 v130, 3280, v130
    v_add_u32 v131, 3072, v131
    v_lshrrev_b32 v134, 11, v130
    v_subrev_u32 v135, s65, v130
    v_mad_u32_u24 v134, v134, s68, v131
    v_and_b32 v135, 0x7ff, v135
    v_cmp_gt_u32 vcc, s66, v135
    v_lshrrev_b32 v135, 7, v130
    v_and_b32 v135, 32, v135
    v_xad_u32 v134, v132, v135, v134
    v_cndmask_b32 v5, v136, v134, vcc
    v_add_u32 v130, 3280, v130
    v_add_u32 v131, 3072, v131
    v_lshrrev_b32 v134, 11, v130
    v_subrev_u32 v135, s65, v130
    v_mad_u32_u24 v134, v134, s68, v131
    v_and_b32 v135, 0x7ff, v135
    v_cmp_gt_u32 vcc, s66, v135
    v_lshrrev_b32 v135, 7, v130
    v_and_b32 v135, 32, v135
    v_xad_u32 v134, v132, v135, v134
    v_cndmask_b32 v6, v136, v134, vcc
    s_cmp_lt_u32 s55, 63
    s_cselect_b32 s66, 10, 0
    s_add_u32 s64, s64, 1856
    v_mul_u32_u24 v134, 98304, v129
    v_add_u32 v134, s64, v134
    v_cmp_gt_u32 vcc, s66, v129
    s_nop 1
    v_cndmask_b32 v31, v136, v134, vcc
    v_mov_b32 v157, 268435456
    v_and_b32 v152, 15, v129
    v_lshrrev_b32 v153, 4, v129
    v_add_u32 v154, 4, v152
    v_lshrrev_b32 v154, 3, v154
    v_mad_i32_i24 v155, v154, -4, v152
    v_and_b32 v154, 1, v154
    v_and_b32 v156, 1, v153
    v_lshlrev_b32 v158, 1, v154
    v_mul_u32_u24 v159, 98304, v158
    v_mad_u32_u24 v159, v155, s69, v159
    v_lshl_add_u32 v159, v153, 4, v159
    v_add_u32 v26, s63, v159
    v_xor_b32 v26, 0x80000000, v26
    s_mov_b32 s54, 2147483648
    v_xor_b32 v161, v154, v138
    v_add_u32 v159, v153, v158
    v_add_u32 v160, 0, v155
    v_mad_u32_u24 v159, v159, 10, v160
    v_bfe_u32 v160, v159, 2, 1
    v_lshl_or_b32 v160, v161, 1, v160
    v_lshl_add_u32 v160, v159, 2, v160
    v_lshl_add_u32 v8, v160, 4, s56
    v_add_u32 v162, 1, v156
    v_add_u32 v159, v138, v158
    v_add_u32 v160, v162, v155
    v_mad_u32_u24 v159, v159, 10, v160
    v_bfe_u32 v160, v159, 2, 1
    v_lshl_or_b32 v160, v154, 1, v160
    v_lshl_add_u32 v160, v159, 2, v160
    v_lshl_add_u32 v12, v160, 4, s56
    v_xor_b32 v9, 16, v8
    v_xor_b32 v10, 32, v8
    v_xor_b32 v11, 48, v8
    v_xor_b32 v13, 16, v12
    v_xor_b32 v14, 32, v12
    v_xor_b32 v15, 48, v12
    v_add_u32 v159, 1, v158
    v_add_u32 v160, 1, v155
    v_mad_u32_u24 v159, v159, 10, v160
    v_bfe_u32 v160, v159, 2, 1
    v_lshl_or_b32 v160, v154, 1, v160
    v_xor_b32 v160, v153, v160
    v_lshl_add_u32 v160, v159, 2, v160
    v_lshl_add_u32 v20, v160, 4, s56
    v_xor_b32 v161, 1, v154
    v_add_u32 v159, 2, v158
    v_add_u32 v160, 1, v155
    v_mad_u32_u24 v159, v159, 10, v160
    v_bfe_u32 v160, v159, 2, 1
    v_lshl_or_b32 v160, v161, 1, v160
    v_xor_b32 v160, v153, v160
    v_lshl_add_u32 v160, v159, 2, v160
    v_lshl_add_u32 v21, v160, 4, s56
    v_bfe_u32 v158, v152, 2, 1
    v_sub_u32 v158, v153, v158
    v_and_b32 v159, 3, v152
    v_mul_u32_u24 v16, 0x1111, v159
    v_lshrrev_b32 v160, 3, v152
    v_lshl_add_u32 v159, v160, 2, v159
    v_lshlrev_b32 v159, 5, v159
    v_add_u32 v159, 141312, v159
    s_movk_i32 s70, 3072
    v_cmp_gt_u32 vcc, 3, v158
    v_mad_u32_u24 v159, v158, s70, v159
    s_nop 0
    v_cndmask_b32 v22, v157, v159, vcc
    v_lshlrev_b32 v23, 4, v129
    v_add_u32 v24, 40960, v23
    v_lshlrev_b32 v25, 5, v153
    v_add_u32 v25, 150528, v25
    v_and_b32 v160, 1, v129
    v_lshlrev_b32 v160, 4, v160
    v_mov_b32 v161, 0x3f80
    v_lshlrev_b32 v160, v160, v161
    v_bfe_u32 v158, v129, 1, 1
    v_bfe_u32 v159, v129, 3, 2
    v_lshl_add_u32 v159, v159, 1, v158
    v_bfe_u32 v161, v129, 2, 1
    v_xor_b32 v161, v161, v138
    v_lshl_add_u32 v159, v161, 3, v159
    v_lshlrev_b32 v159, v159, 1
    v_lshrrev_b32 v161, 2, v152
    v_xor_b32 v161, v161, v153
    v_lshl_add_u32 v158, v161, 1, v158
    v_lshlrev_b32 v158, v158, 1
    v_bfe_i32 v240, v159, 0, 1
    v_bfe_i32 v241, v159, 1, 1
    v_bfe_i32 v242, v159, 2, 1
    v_bfe_i32 v243, v159, 3, 1
    v_bfe_i32 v244, v159, 4, 1
    v_bfe_i32 v245, v159, 5, 1
    v_bfe_i32 v246, v159, 6, 1
    v_bfe_i32 v247, v159, 7, 1
    v_bfe_i32 v18, v158, 0, 1
    v_bfe_i32 v19, v158, 1, 1
    v_and_b32 v240, v160, v240
    v_and_b32 v241, v160, v241
    v_and_b32 v242, v160, v242
    v_and_b32 v243, v160, v243
    v_and_b32 v244, v160, v244
    v_and_b32 v245, v160, v245
    v_and_b32 v246, v160, v246
    v_and_b32 v247, v160, v247
    v_and_b32 v18, v160, v18
    v_and_b32 v19, v160, v19
    s_mov_b32 s24, s18
    s_mov_b32 s25, s19
    s_mov_b32 s26, 50331648
    s_mov_b32 s27, 0x20000
    s_mov_b32 s52, 0
    s_mov_b32 s80, 0
    s_mov_b32 s81, 98304
    s_mov_b32 s82, 393216
    s_mov_b32 s83, 491520
    s_mov_b32 s53, 1156138217
    s_mov_b32 s58, 0x3c003c00
    s_mov_b32 s85, 150912
    s_mov_b32 s86, 0x37803780
    s_mov_b32 s84, 0x37800000
    v_lshrrev_b32 v158, 2, v152
    v_xor_b32 v158, v158, v153
    v_bfe_i32 v158, v158, 0, 1
    v_bfi_b32 v158, v158, 0, s58
    v_accvgpr_write_b32 a228, v158
    v_accvgpr_write_b32 a229, v158
    v_accvgpr_write_b32 a230, v158
    v_accvgpr_write_b32 a231, v158
    v_and_b32 v17, v138, v153
    v_lshlrev_b32 v17, 4, v17
    v_lshrrev_b32 v17, v17, -1
    s_mov_b32 s73, 0x409d2a01
    s_mov_b32 s59, 0x3ef00000
    v_mul_u32_u24 v252, 0x100010, v0
    v_add_u32 v252, 0xc0004, v252
    v_lshlrev_b32 v253, 2, v0
    v_add_u32 v253, 150912, v253
    v_add_u32 v160, 0x0, v252
    v_add_u32 v168, 0x10001000, v252
    v_cvt_f32_f16 v161, v160
    v_cvt_f32_f16 v169, v168
    v_cvt_f32_f16_sdwa v162, v160 dst_sel:DWORD dst_unused:UNUSED_PAD src0_sel:WORD_1
    v_cvt_f32_f16_sdwa v170, v168 dst_sel:DWORD dst_unused:UNUSED_PAD src0_sel:WORD_1
    v_mul_f32 v163, 0x3f7fdde7, v161
    v_mul_f32 v171, 0x3f7fdde7, v169
    v_mul_f32 v164, 0x3f7fdde7, v162
    v_mul_f32 v172, 0x3f7fdde7, v170
    v_fma_f32 v163, v163, v161, s73
    v_fma_f32 v171, v171, v169, s73
    v_fma_f32 v164, v164, v162, s73
    v_fma_f32 v172, v172, v170, s73
    v_mul_f32 v163, -v161, v163
    v_mul_f32 v171, -v169, v171
    v_mul_f32 v164, -v162, v164
    v_mul_f32 v172, -v170, v172
    v_exp_f32 v165, v163
    v_exp_f32 v173, v171
    v_exp_f32 v166, v164
    v_exp_f32 v174, v172
    v_fma_f32 v163, v165, s59, s59
    v_fma_f32 v171, v173, s59, s59
    v_fma_f32 v164, v166, s59, s59
    v_fma_f32 v172, v174, s59, s59
    v_rcp_f32 v163, v163
    v_rcp_f32 v171, v171
    v_rcp_f32 v164, v164
    v_rcp_f32 v172, v172
    v_mul_f32 v163, v161, v163
    v_mul_f32 v171, v169, v171
    v_mul_f32 v164, v162, v164
    v_mul_f32 v172, v170, v172
    v_mul_f32 v165, -v165, v163
    v_mul_f32 v173, -v173, v171
    v_mul_f32 v166, -v166, v164
    v_mul_f32 v174, -v174, v172
    v_cvt_pk_bf16_f32 v167, v165, v166
    v_cvt_pk_bf16_f32 v175, v173, v174
    v_cvt_pk_bf16_f32 v160, v163, v164
    v_cvt_pk_bf16_f32 v168, v171, v172
    ds_write_b32 v253, v167 offset:8192
    ds_write_b32 v253, v160 offset:0
    ds_write_b32 v253, v175 offset:9216
    ds_write_b32 v253, v168 offset:1024
    v_add_u32 v160, 0x20002000, v252
    s_nop 0
    v_add_u32 v168, 0x30003000, v252
    v_cvt_f32_f16 v161, v160
    v_cvt_f32_f16 v169, v168
    v_cvt_f32_f16_sdwa v162, v160 dst_sel:DWORD dst_unused:UNUSED_PAD src0_sel:WORD_1
    v_cvt_f32_f16_sdwa v170, v168 dst_sel:DWORD dst_unused:UNUSED_PAD src0_sel:WORD_1
    v_mul_f32 v163, 0x3f7fdde7, v161
    v_mul_f32 v171, 0x3f7fdde7, v169
    v_mul_f32 v164, 0x3f7fdde7, v162
    v_mul_f32 v172, 0x3f7fdde7, v170
    v_fma_f32 v163, v163, v161, s73
    v_fma_f32 v171, v171, v169, s73
    v_fma_f32 v164, v164, v162, s73
    v_fma_f32 v172, v172, v170, s73
    v_mul_f32 v163, -v161, v163
    v_mul_f32 v171, -v169, v171
    v_mul_f32 v164, -v162, v164
    v_mul_f32 v172, -v170, v172
    v_exp_f32 v165, v163
    v_exp_f32 v173, v171
    v_exp_f32 v166, v164
    v_exp_f32 v174, v172
    v_fma_f32 v163, v165, s59, s59
    v_fma_f32 v171, v173, s59, s59
    v_fma_f32 v164, v166, s59, s59
    v_fma_f32 v172, v174, s59, s59
    v_rcp_f32 v163, v163
    v_rcp_f32 v171, v171
    v_rcp_f32 v164, v164
    v_rcp_f32 v172, v172
    v_mul_f32 v163, v161, v163
    v_mul_f32 v171, v169, v171
    v_mul_f32 v164, v162, v164
    v_mul_f32 v172, v170, v172
    v_mul_f32 v165, -v165, v163
    v_mul_f32 v173, -v173, v171
    v_mul_f32 v166, -v166, v164
    v_mul_f32 v174, -v174, v172
    v_cvt_pk_bf16_f32 v167, v165, v166
    v_cvt_pk_bf16_f32 v175, v173, v174
    v_cvt_pk_bf16_f32 v160, v163, v164
    v_cvt_pk_bf16_f32 v168, v171, v172
    ds_write_b32 v253, v167 offset:10240
    ds_write_b32 v253, v160 offset:2048
    ds_write_b32 v253, v175 offset:11264
    ds_write_b32 v253, v168 offset:3072
    v_add_u32 v160, 0x40004000, v252
    s_nop 0
    v_add_u32 v168, 0x50005000, v252
    v_cvt_f32_f16 v161, v160
    v_cvt_f32_f16 v169, v168
    v_cvt_f32_f16_sdwa v162, v160 dst_sel:DWORD dst_unused:UNUSED_PAD src0_sel:WORD_1
    v_cvt_f32_f16_sdwa v170, v168 dst_sel:DWORD dst_unused:UNUSED_PAD src0_sel:WORD_1
    v_mul_f32 v163, 0x3f7fdde7, v161
    v_mul_f32 v171, 0x40088889, v169
    v_mul_f32 v164, 0x3f7fdde7, v162
    v_mul_f32 v172, 0x40088889, v170
    v_fma_f32 v163, v163, v161, s73
    v_cvt_pk_bf16_f32 v168, v171, v172
    v_fma_f32 v164, v164, v162, s73
    v_mul_f32 v163, -v161, v163
    v_mul_f32 v164, -v162, v164
    v_exp_f32 v165, v163
    v_exp_f32 v166, v164
    v_fma_f32 v163, v165, s59, s59
    v_fma_f32 v164, v166, s59, s59
    v_rcp_f32 v163, v163
    v_rcp_f32 v164, v164
    v_mul_f32 v163, v161, v163
    v_mul_f32 v164, v162, v164
    v_mul_f32 v165, -v165, v163
    v_mul_f32 v166, -v166, v164
    v_cvt_pk_bf16_f32 v167, v165, v166
    v_cvt_pk_bf16_f32 v160, v163, v164
    ds_write_b32 v253, v167 offset:12288
    ds_write_b32 v253, v160 offset:4096
    ds_write_b32 v253, v168 offset:5120
    s_nop 0
    v_add_u32 v160, 0x60006000, v252
    v_add_u32 v168, 0x70007000, v252
    v_cvt_f32_f16 v161, v160
    v_cvt_f32_f16 v169, v168
    v_cvt_f32_f16_sdwa v162, v160 dst_sel:DWORD dst_unused:UNUSED_PAD src0_sel:WORD_1
    v_cvt_f32_f16_sdwa v170, v168 dst_sel:DWORD dst_unused:UNUSED_PAD src0_sel:WORD_1
    v_mul_f32 v163, 0x40088889, v161
    v_mul_f32 v171, 0x40088889, v169
    v_mul_f32 v164, 0x40088889, v162
    v_mul_f32 v172, 0x40088889, v170
    v_cvt_pk_bf16_f32 v160, v163, v164
    v_cvt_pk_bf16_f32 v168, v171, v172
    ds_write_b32 v253, v160 offset:6144
    ds_write_b32 v253, v168 offset:7168
    v_lshlrev_b32 v158, 6, v0
    v_add_u32 v158, 141312, v158
    v_cmp_gt_u32 vcc, 144, v0
    s_nop 1
    v_cndmask_b32 v158, v157, v158, vcc
    v_and_b32 v159, 3, v0
    v_lshl_add_u32 v160, v159, 2, v158
    v_lshrrev_b32 v159, 1, v159
    v_lshl_add_u32 v159, v159, 2, v158
    v_lshlrev_b32 v161, 4, v0
    v_add_u32 v161, 150528, v161
    v_cmp_gt_u32 vcc, 24, v0
    s_nop 1
    v_cndmask_b32 v161, v157, v161, vcc
    v_mov_b32 v164, 0
    v_mov_b32 v165, 0
    v_mov_b32 v166, 0
    v_mov_b32 v167, 0
    ds_write_b128 v158, v[164:167]
    ds_write_b128 v158, v[164:167] offset:16
    s_waitcnt lgkmcnt(9)
    ds_write_b128 v158, v[164:167] offset:32
    ds_write_b128 v158, v[164:167] offset:48
    s_waitcnt vmcnt(17)
    ds_write_b16 v160, v144
    ds_write_b16_d16_hi v160, v144 offset:34
    s_waitcnt vmcnt(16)
    ds_write_b16 v159, v145 offset:16
    ds_write_b16_d16_hi v159, v145 offset:48
    s_waitcnt vmcnt(15) lgkmcnt(13)
    ds_write_b16 v159, v146 offset:24
    ds_write_b16_d16_hi v159, v146 offset:56
    s_waitcnt vmcnt(14)
    v_lshlrev_b32 v168, 16, v148
    v_and_b32 v169, 0xffff0000, v148
    v_lshlrev_b32 v170, 16, v149
    v_and_b32 v171, 0xffff0000, v149
    s_waitcnt vmcnt(13)
    v_lshlrev_b32 v172, 16, v150
    v_and_b32 v173, 0xffff0000, v150
    v_lshlrev_b32 v174, 16, v151
    v_and_b32 v175, 0xffff0000, v151
    v_mul_f32 v168, v168, v172
    v_mul_f32 v169, v169, v173
    v_mul_f32 v170, v170, v174
    v_mul_f32 v171, v171, v175
    s_waitcnt lgkmcnt(14)
    ds_write_b128 v161, v[168:171]
    s_waitcnt vmcnt(12)
    v_xor_b32 v176, 0x80008000, v176
    v_xor_b32 v177, 0x80008000, v177
    v_xor_b32 v178, 0x80008000, v178
    v_xor_b32 v179, 0x80008000, v179
    s_nop 1
    v_mfma_f32_32x32x16_bf16 v[208:223], v[176:179], v[240:243], 0
    v_mfma_f32_32x32x16_bf16 v[208:223], v[176:179], v[244:247], v[208:223]
    s_waitcnt vmcnt(10)
    v_xor_b32 v180, 0x80008000, v180
    v_xor_b32 v181, 0x80008000, v181
    v_xor_b32 v182, 0x80008000, v182
    v_xor_b32 v183, 0x80008000, v183
    s_nop 1
    v_mfma_f32_32x32x16_bf16 v[192:207], v[180:183], v[240:243], 0
    v_mfma_f32_32x32x16_bf16 v[192:207], v[180:183], v[244:247], v[192:207]
    s_mov_b32 s74, 0
    s_mov_b32 s75, 12288
    buffer_load_dwordx4 a[0:3], v232, s[44:47], s74 offen offset:0
    buffer_load_dwordx4 a[4:7], v232, s[44:47], s75 offen offset:0
    buffer_load_dwordx4 a[8:11], v233, s[44:47], s74 offen offset:0
    buffer_load_dwordx4 a[12:15], v233, s[44:47], s75 offen offset:0
    s_mov_b32 s74, 24576
    s_mov_b32 s75, 36864
    buffer_load_dwordx4 a[16:19], v232, s[44:47], s74 offen offset:0
    buffer_load_dwordx4 a[20:23], v232, s[44:47], s75 offen offset:0
    buffer_load_dwordx4 a[24:27], v233, s[44:47], s74 offen offset:0
    buffer_load_dwordx4 a[28:31], v233, s[44:47], s75 offen offset:0
    s_mov_b32 s74, 49152
    s_mov_b32 s75, 61440
    buffer_load_dwordx4 a[32:35], v232, s[44:47], s74 offen offset:0
    buffer_load_dwordx4 a[36:39], v232, s[44:47], s75 offen offset:0
    buffer_load_dwordx4 a[40:43], v233, s[44:47], s74 offen offset:0
    buffer_load_dwordx4 a[44:47], v233, s[44:47], s75 offen offset:0
    s_mov_b32 s74, 0
    s_mov_b32 s75, 12288
    buffer_load_dwordx4 a[48:51], v232, s[44:47], s74 offen offset:256
    buffer_load_dwordx4 a[52:55], v232, s[44:47], s75 offen offset:256
    buffer_load_dwordx4 a[56:59], v233, s[44:47], s74 offen offset:256
    buffer_load_dwordx4 a[60:63], v233, s[44:47], s75 offen offset:256
    s_mov_b32 s74, 24576
    s_mov_b32 s75, 36864
    buffer_load_dwordx4 a[64:67], v232, s[44:47], s74 offen offset:256
    buffer_load_dwordx4 a[68:71], v232, s[44:47], s75 offen offset:256
    buffer_load_dwordx4 a[72:75], v233, s[44:47], s74 offen offset:256
    buffer_load_dwordx4 a[76:79], v233, s[44:47], s75 offen offset:256
    s_mov_b32 s74, 49152
    s_mov_b32 s75, 61440
    buffer_load_dwordx4 a[80:83], v232, s[44:47], s74 offen offset:256
    buffer_load_dwordx4 a[84:87], v232, s[44:47], s75 offen offset:256
    buffer_load_dwordx4 a[88:91], v233, s[44:47], s74 offen offset:256
    buffer_load_dwordx4 a[92:95], v233, s[44:47], s75 offen offset:256
    s_waitcnt vmcnt(23)
    v_mfma_f32_32x32x16_bf16 v[80:95], a[0:3], v[240:243], v[208:223]
    s_waitcnt vmcnt(21)
    v_mfma_f32_32x32x16_bf16 v[96:111], a[8:11], v[240:243], v[208:223]
    v_mfma_f32_32x32x16_bf16 v[80:95], a[4:7], v[244:247], v[80:95]
    s_waitcnt vmcnt(20)
    v_mfma_f32_32x32x16_bf16 v[96:111], a[12:15], v[244:247], v[96:111]
    s_waitcnt vmcnt(19)
    v_mfma_f32_32x32x16_bf16 v[112:127], a[16:19], v[240:243], v[208:223]
    s_waitcnt vmcnt(17)
    v_mfma_f32_32x32x16_bf16 v[128:143], a[24:27], v[240:243], v[208:223]
    v_mfma_f32_32x32x16_bf16 v[112:127], a[20:23], v[244:247], v[112:127]
    s_waitcnt vmcnt(16)
    v_mfma_f32_32x32x16_bf16 v[128:143], a[28:31], v[244:247], v[128:143]
    s_nop 2
    v_cvt_pk_f16_f32 v224, v80, v84
    v_cvt_pk_f16_f32 v225, v88, v92
    v_cvt_pk_f16_f32 v226, v96, v100
    v_cvt_pk_f16_f32 v227, v104, v108
    s_waitcnt vmcnt(15)
    v_mfma_f32_32x32x16_bf16 v[144:159], a[32:35], v[240:243], v[208:223]
    s_waitcnt lgkmcnt(14)
    ds_write_b128 v234, v[224:227] offset:0
    s_mov_b32 s74, 0
    v_cvt_pk_f16_f32 v228, v81, v85
    v_cvt_pk_f16_f32 v229, v89, v93
    v_cvt_pk_f16_f32 v230, v97, v101
    v_cvt_pk_f16_f32 v231, v105, v109
    s_waitcnt vmcnt(13)
    v_mfma_f32_32x32x16_bf16 v[160:175], a[40:43], v[240:243], v[208:223]
    s_waitcnt lgkmcnt(14)
    ds_write_b128 v234, v[228:231] offset:1024
    s_mov_b32 s75, 12288
    buffer_load_dwordx4 v[32:35], v232, s[44:47], s74 offen offset:512
    v_cvt_pk_f16_f32 v224, v82, v86
    v_cvt_pk_f16_f32 v225, v90, v94
    v_cvt_pk_f16_f32 v226, v98, v102
    v_cvt_pk_f16_f32 v227, v106, v110
    v_mfma_f32_32x32x16_bf16 v[144:159], a[36:39], v[244:247], v[144:159]
    s_waitcnt lgkmcnt(14)
    ds_write_b128 v234, v[224:227] offset:12288
    buffer_load_dwordx4 v[36:39], v232, s[44:47], s75 offen offset:512
    v_cvt_pk_f16_f32 v228, v83, v87
    v_cvt_pk_f16_f32 v229, v91, v95
    v_cvt_pk_f16_f32 v230, v99, v103
    v_cvt_pk_f16_f32 v231, v107, v111
    s_waitcnt vmcnt(14)
    v_mfma_f32_32x32x16_bf16 v[160:175], a[44:47], v[244:247], v[160:175]
    s_waitcnt vmcnt(10)
    s_waitcnt lgkmcnt(14)
    ds_write_b128 v234, v[228:231] offset:13312
    buffer_load_dwordx4 v[40:43], v233, s[44:47], s74 offen offset:512
    buffer_load_dwordx4 v[44:47], v233, s[44:47], s75 offen offset:512
    v_mfma_f32_32x32x16_bf16 v[160:175], a[232:235], v[244:247], v[160:175]
    v_cvt_pk_f16_f32 v224, v112, v116
    v_cvt_pk_f16_f32 v225, v120, v124
    v_cvt_pk_f16_f32 v226, v128, v132
    v_cvt_pk_f16_f32 v227, v136, v140
    v_mfma_f32_32x32x16_bf16 v[80:95], a[48:51], v[240:243], v[192:207]
    s_waitcnt lgkmcnt(14)
    ds_write_b128 v234, v[224:227] offset:2048
    s_mov_b32 s74, 24576
    v_cvt_pk_f16_f32 v228, v113, v117
    v_cvt_pk_f16_f32 v229, v121, v125
    v_cvt_pk_f16_f32 v230, v129, v133
    v_cvt_pk_f16_f32 v231, v137, v141
    v_mfma_f32_32x32x16_bf16 v[96:111], a[56:59], v[240:243], v[192:207]
    s_waitcnt lgkmcnt(14)
    ds_write_b128 v234, v[228:231] offset:3072
    s_mov_b32 s75, 36864
    buffer_load_dwordx4 v[48:51], v232, s[44:47], s74 offen offset:512
    v_cvt_pk_f16_f32 v224, v114, v118
    v_cvt_pk_f16_f32 v225, v122, v126
    v_cvt_pk_f16_f32 v226, v130, v134
    v_cvt_pk_f16_f32 v227, v138, v142
    v_mfma_f32_32x32x16_bf16 v[80:95], a[52:55], v[244:247], v[80:95]
    s_waitcnt lgkmcnt(14)
    ds_write_b128 v234, v[224:227] offset:14336
    buffer_load_dwordx4 v[52:55], v232, s[44:47], s75 offen offset:512
    v_cvt_pk_f16_f32 v228, v115, v119
    v_cvt_pk_f16_f32 v229, v123, v127
    v_cvt_pk_f16_f32 v230, v131, v135
    v_cvt_pk_f16_f32 v231, v139, v143
    v_mfma_f32_32x32x16_bf16 v[96:111], a[60:63], v[244:247], v[96:111]
    s_waitcnt vmcnt(10)
    s_waitcnt lgkmcnt(14)
    ds_write_b128 v234, v[228:231] offset:15360
    buffer_load_dwordx4 v[56:59], v233, s[44:47], s74 offen offset:512
    buffer_load_dwordx4 v[60:63], v233, s[44:47], s75 offen offset:512
    v_xor_b32 v184, 0x80008000, v184
    v_xor_b32 v185, 0x80008000, v185
    v_xor_b32 v186, 0x80008000, v186
    v_xor_b32 v187, 0x80008000, v187
    v_cvt_pk_f16_f32 v224, v144, v148
    v_cvt_pk_f16_f32 v225, v152, v156
    v_cvt_pk_f16_f32 v226, v160, v164
    v_cvt_pk_f16_f32 v227, v168, v172
    v_mfma_f32_32x32x16_bf16 v[112:127], a[64:67], v[240:243], v[192:207]
    s_waitcnt lgkmcnt(14)
    ds_write_b128 v234, v[224:227] offset:4096
    s_mov_b32 s74, 49152
    v_cvt_pk_f16_f32 v228, v145, v149
    v_cvt_pk_f16_f32 v229, v153, v157
    v_cvt_pk_f16_f32 v230, v161, v165
    v_cvt_pk_f16_f32 v231, v169, v173
    v_mfma_f32_32x32x16_bf16 v[128:143], a[72:75], v[240:243], v[192:207]
    s_waitcnt lgkmcnt(14)
    ds_write_b128 v234, v[228:231] offset:5120
    s_mov_b32 s75, 61440
    buffer_load_dwordx4 v[64:67], v232, s[44:47], s74 offen offset:512
    v_cvt_pk_f16_f32 v224, v146, v150
    v_cvt_pk_f16_f32 v225, v154, v158
    v_cvt_pk_f16_f32 v226, v162, v166
    v_cvt_pk_f16_f32 v227, v170, v174
    v_mfma_f32_32x32x16_bf16 v[112:127], a[68:71], v[244:247], v[112:127]
    s_waitcnt lgkmcnt(14)
    ds_write_b128 v234, v[224:227] offset:16384
    buffer_load_dwordx4 v[68:71], v232, s[44:47], s75 offen offset:512
    v_cvt_pk_f16_f32 v228, v147, v151
    v_cvt_pk_f16_f32 v229, v155, v159
    v_cvt_pk_f16_f32 v230, v163, v167
    v_cvt_pk_f16_f32 v231, v171, v175
    v_mfma_f32_32x32x16_bf16 v[128:143], a[76:79], v[244:247], v[128:143]
    s_waitcnt vmcnt(10)
    s_waitcnt lgkmcnt(14)
    ds_write_b128 v234, v[228:231] offset:17408
    buffer_load_dwordx4 v[72:75], v233, s[44:47], s74 offen offset:512
    buffer_load_dwordx4 v[76:79], v233, s[44:47], s75 offen offset:512
    v_sub_u32 v234, v234, v238
    v_mfma_f32_32x32x16_bf16 v[208:223], v[184:187], v[240:243], 0
    v_mfma_f32_32x32x16_bf16 v[208:223], v[184:187], v[244:247], v[208:223]
    v_cvt_pk_f16_f32 v224, v80, v84
    v_cvt_pk_f16_f32 v225, v88, v92
    v_cvt_pk_f16_f32 v226, v96, v100
    v_cvt_pk_f16_f32 v227, v104, v108
    v_mfma_f32_32x32x16_bf16 v[144:159], a[80:83], v[240:243], v[192:207]
    s_waitcnt lgkmcnt(0)
    s_barrier
    ds_write_b128 v234, v[224:227] offset:0
    ds_read_b128 a[192:195], v23 offset:4096
    ds_read_b128 a[196:199], v23 offset:5120
    ds_read_b128 a[200:203], v23 offset:14336
    ds_read_b128 a[204:207], v23 offset:15360
    ds_read_b128 a[208:211], v23 offset:24576
    ds_read_b128 a[212:215], v23 offset:25600
    ds_read_b128 a[216:219], v23 offset:34816
    s_add_u32 m0, s56, 6336
    s_nop 0
    buffer_load_dwordx4 v1, s[20:23], 0 offen offset:64 lds
    v_cvt_pk_f16_f32 v228, v81, v85
    v_cvt_pk_f16_f32 v229, v89, v93
    v_cvt_pk_f16_f32 v230, v97, v101
    v_cvt_pk_f16_f32 v231, v105, v109
    v_mfma_f32_32x32x16_bf16 v[160:175], a[88:91], v[240:243], v[192:207]
    ds_write_b128 v234, v[228:231] offset:1024
    ds_read_b128 a[220:223], v23 offset:35840
    ds_read_b128 a[0:3], v24 offset:0
    ds_read_b128 a[4:7], v24 offset:1024
    ds_read_b128 a[24:27], v24 offset:6144
    ds_read_b128 a[28:31], v24 offset:7168
    ds_read_b128 a[96:99], v24 offset:24576
    s_waitcnt lgkmcnt(14)
    ds_read_b128 a[100:103], v24 offset:25600
    s_add_u32 m0, s56, 7360
    s_nop 0
    buffer_load_dwordx4 v2, s[20:23], 0 offen offset:64 lds
    v_cvt_pk_f16_f32 v224, v82, v86
    v_cvt_pk_f16_f32 v225, v90, v94
    v_cvt_pk_f16_f32 v226, v98, v102
    v_cvt_pk_f16_f32 v227, v106, v110
    v_mfma_f32_32x32x16_bf16 v[144:159], a[84:87], v[244:247], v[144:159]
    s_waitcnt lgkmcnt(9)
    ds_write_b128 v234, v[224:227] offset:10240
    ds_read_b128 a[120:123], v24 offset:30720
    ds_read_b128 a[124:127], v24 offset:31744
    ds_read_b128 a[144:147], v24 offset:36864
    ds_read_b128 a[148:151], v24 offset:37888
    ds_read_b128 a[168:171], v24 offset:43008
    s_waitcnt lgkmcnt(13)
    ds_read_b128 a[172:175], v24 offset:44032
    ds_read_b128 a[48:51], v24 offset:12288
    s_add_u32 m0, s56, 8384
    s_nop 0
    buffer_load_dwordx4 v3, s[20:23], 0 offen offset:64 lds
    v_cvt_pk_f16_f32 v228, v83, v87
    v_cvt_pk_f16_f32 v229, v91, v95
    v_cvt_pk_f16_f32 v230, v99, v103
    v_cvt_pk_f16_f32 v231, v107, v111
    v_mfma_f32_32x32x16_bf16 v[160:175], a[92:95], v[244:247], v[160:175]
    s_waitcnt vmcnt(11)
    s_waitcnt lgkmcnt(9)
    ds_write_b128 v234, v[228:231] offset:11264
    ds_read_b128 a[52:55], v24 offset:13312
    ds_read_b128 a[72:75], v24 offset:18432
    ds_read_b128 a[76:79], v24 offset:19456
    ds_read_b128 a[8:11], v24 offset:2048
    ds_read_b128 a[12:15], v24 offset:3072
    s_waitcnt lgkmcnt(13)
    ds_read_b128 a[32:35], v24 offset:8192
    ds_read_b128 a[36:39], v24 offset:9216
    s_add_u32 m0, s56, 9408
    s_nop 0
    buffer_load_dwordx4 v4, s[20:23], 0 offen offset:64 lds
    v_mfma_f32_32x32x16_bf16 v[160:175], a[236:239], v[244:247], v[160:175]
    v_cvt_pk_f16_f32 v224, v112, v116
    v_cvt_pk_f16_f32 v225, v120, v124
    v_cvt_pk_f16_f32 v226, v128, v132
    v_cvt_pk_f16_f32 v227, v136, v140
    v_mfma_f32_32x32x16_bf16 v[80:95], v[32:35], v[240:243], v[208:223]
    s_waitcnt lgkmcnt(9)
    ds_write_b128 v234, v[224:227] offset:2048
    ds_read_b128 a[104:107], v24 offset:26624
    ds_read_b128 a[108:111], v24 offset:27648
    ds_read_b128 a[128:131], v24 offset:32768
    ds_read_b128 a[132:135], v24 offset:33792
    ds_read_b128 a[152:155], v24 offset:38912
    s_waitcnt lgkmcnt(13)
    ds_read_b128 a[156:159], v24 offset:39936
    ds_read_b128 a[176:179], v24 offset:45056
    s_add_u32 m0, s56, 10432
    v_cvt_pk_f16_f32 v228, v113, v117
    v_cvt_pk_f16_f32 v229, v121, v125
    v_cvt_pk_f16_f32 v230, v129, v133
    v_cvt_pk_f16_f32 v231, v137, v141
    v_mfma_f32_32x32x16_bf16 v[96:111], v[40:43], v[240:243], v[208:223]
    s_waitcnt lgkmcnt(9)
    ds_write_b128 v234, v[228:231] offset:3072
    ds_read_b128 a[180:183], v24 offset:46080
    ds_read_b128 a[56:59], v24 offset:14336
    ds_read_b128 a[60:63], v24 offset:15360
    ds_read_b128 a[80:83], v24 offset:20480
    ds_read_b128 a[84:87], v24 offset:21504
    s_waitcnt lgkmcnt(13)
    ds_read_b128 a[16:19], v24 offset:4096
    ds_read_b128 a[20:23], v24 offset:5120
    buffer_load_dwordx4 v5, s[20:23], 0 offen offset:64 lds
    s_add_u32 m0, s56, 11456
    v_cvt_pk_f16_f32 v224, v114, v118
    v_cvt_pk_f16_f32 v225, v122, v126
    v_cvt_pk_f16_f32 v226, v130, v134
    v_cvt_pk_f16_f32 v227, v138, v142
    v_mfma_f32_32x32x16_bf16 v[80:95], v[36:39], v[244:247], v[80:95]
    s_waitcnt lgkmcnt(9)
    ds_write_b128 v234, v[224:227] offset:12288
    ds_read_b128 a[40:43], v24 offset:10240
    ds_read_b128 a[44:47], v24 offset:11264
    ds_read_b128 a[112:115], v24 offset:28672
    ds_read_b128 a[116:119], v24 offset:29696
    ds_read_b128 a[136:139], v24 offset:34816
    s_waitcnt lgkmcnt(13)
    ds_read_b128 a[140:143], v24 offset:35840
    ds_read_b128 a[160:163], v24 offset:40960
    buffer_load_dwordx4 v6, s[20:23], 0 offen offset:64 lds
    s_add_u32 m0, s56, 12480
    v_cvt_pk_f16_f32 v228, v115, v119
    v_cvt_pk_f16_f32 v229, v123, v127
    v_cvt_pk_f16_f32 v230, v131, v135
    v_cvt_pk_f16_f32 v231, v139, v143
    v_mfma_f32_32x32x16_bf16 v[96:111], v[44:47], v[244:247], v[96:111]
    s_waitcnt vmcnt(10)
    s_waitcnt lgkmcnt(9)
    ds_write_b128 v234, v[228:231] offset:13312
    ds_read_b128 a[164:167], v24 offset:41984
    ds_read_b128 a[184:187], v24 offset:47104
    ds_read_b128 a[188:191], v24 offset:48128
    ds_read_b128 a[64:67], v24 offset:16384
    ds_read_b128 a[68:71], v24 offset:17408
    s_waitcnt lgkmcnt(13)
    ds_read_b128 a[88:91], v24 offset:22528
    ds_read_b128 a[92:95], v24 offset:23552
    buffer_load_dword v7, s[20:23], 0 offen offset:64 lds
    buffer_load_dword v254, v31, s[20:23], 0 offen
    v_cvt_pk_f16_f32 v224, v144, v148
    v_cvt_pk_f16_f32 v225, v152, v156
    v_cvt_pk_f16_f32 v226, v160, v164
    v_cvt_pk_f16_f32 v227, v168, v172
    v_mfma_f32_32x32x16_bf16 v[112:127], v[48:51], v[240:243], v[208:223]
    s_waitcnt lgkmcnt(0)
    s_barrier
    ds_write_b128 v234, v[224:227] offset:4096
    v_cvt_pk_f16_f32 v228, v145, v149
    v_cvt_pk_f16_f32 v229, v153, v157
    v_cvt_pk_f16_f32 v230, v161, v165
    v_cvt_pk_f16_f32 v231, v169, v173
    v_mfma_f32_32x32x16_bf16 v[128:143], v[56:59], v[240:243], v[208:223]
    ds_write_b128 v234, v[228:231] offset:5120
    v_cvt_pk_f16_f32 v224, v146, v150
    v_cvt_pk_f16_f32 v225, v154, v158
    v_cvt_pk_f16_f32 v226, v162, v166
    v_cvt_pk_f16_f32 v227, v170, v174
    v_mfma_f32_32x32x16_bf16 v[112:127], v[52:55], v[244:247], v[112:127]
    ds_write_b128 v234, v[224:227] offset:14336
    v_cvt_pk_f16_f32 v228, v147, v151
    v_cvt_pk_f16_f32 v229, v155, v159
    v_cvt_pk_f16_f32 v230, v163, v167
    v_cvt_pk_f16_f32 v231, v171, v175
    v_mfma_f32_32x32x16_bf16 v[128:143], v[60:63], v[244:247], v[128:143]
    s_waitcnt vmcnt(8)
    ds_write_b128 v234, v[228:231] offset:15360
    v_add_u32 v234, v234, v238
    v_cvt_pk_f16_f32 v224, v80, v84
    v_cvt_pk_f16_f32 v225, v88, v92
    v_cvt_pk_f16_f32 v226, v96, v100
    v_cvt_pk_f16_f32 v227, v104, v108
    v_mfma_f32_32x32x16_bf16 v[144:159], v[64:67], v[240:243], v[208:223]
    ds_write_b128 v234, v[224:227] offset:0
    v_cvt_pk_f16_f32 v228, v81, v85
    v_cvt_pk_f16_f32 v229, v89, v93
    v_cvt_pk_f16_f32 v230, v97, v101
    v_cvt_pk_f16_f32 v231, v105, v109
    v_mfma_f32_32x32x16_bf16 v[160:175], v[72:75], v[240:243], v[208:223]
    ds_write_b128 v234, v[228:231] offset:1024
    v_cvt_pk_f16_f32 v224, v82, v86
    v_cvt_pk_f16_f32 v225, v90, v94
    v_cvt_pk_f16_f32 v226, v98, v102
    v_cvt_pk_f16_f32 v227, v106, v110
    v_mfma_f32_32x32x16_bf16 v[144:159], v[68:71], v[244:247], v[144:159]
    ds_write_b128 v234, v[224:227] offset:12288
    v_cvt_pk_f16_f32 v228, v83, v87
    v_cvt_pk_f16_f32 v229, v91, v95
    v_cvt_pk_f16_f32 v230, v99, v103
    v_cvt_pk_f16_f32 v231, v107, v111
    v_mfma_f32_32x32x16_bf16 v[160:175], v[76:79], v[244:247], v[160:175]
    ds_write_b128 v234, v[228:231] offset:13312
    v_mfma_f32_32x32x16_bf16 v[160:175], a[240:243], v[244:247], v[160:175]
    v_cvt_pk_f16_f32 v224, v112, v116
    v_cvt_pk_f16_f32 v225, v120, v124
    v_cvt_pk_f16_f32 v226, v128, v132
    v_cvt_pk_f16_f32 v227, v136, v140
    ds_write_b128 v234, v[224:227] offset:2048
    v_cvt_pk_f16_f32 v228, v113, v117
    v_cvt_pk_f16_f32 v229, v121, v125
    v_cvt_pk_f16_f32 v230, v129, v133
    v_cvt_pk_f16_f32 v231, v137, v141
    ds_write_b128 v234, v[228:231] offset:3072
    v_cvt_pk_f16_f32 v224, v114, v118
    v_cvt_pk_f16_f32 v225, v122, v126
    v_cvt_pk_f16_f32 v226, v130, v134
    v_cvt_pk_f16_f32 v227, v138, v142
    ds_write_b128 v234, v[224:227] offset:14336
    v_cvt_pk_f16_f32 v228, v115, v119
    v_cvt_pk_f16_f32 v229, v123, v127
    v_cvt_pk_f16_f32 v230, v131, v135
    v_cvt_pk_f16_f32 v231, v139, v143
    ds_write_b128 v234, v[228:231] offset:15360
    v_cvt_pk_f16_f32 v224, v144, v148
    v_cvt_pk_f16_f32 v225, v152, v156
    v_cvt_pk_f16_f32 v226, v160, v164
    v_cvt_pk_f16_f32 v227, v168, v172
    ds_write_b128 v234, v[224:227] offset:4096
    v_cvt_pk_f16_f32 v228, v145, v149
    v_cvt_pk_f16_f32 v229, v153, v157
    v_cvt_pk_f16_f32 v230, v161, v165
    v_cvt_pk_f16_f32 v231, v169, v173
    ds_write_b128 v234, v[228:231] offset:5120
    v_cvt_pk_f16_f32 v224, v146, v150
    v_cvt_pk_f16_f32 v225, v154, v158
    v_cvt_pk_f16_f32 v226, v162, v166
    v_cvt_pk_f16_f32 v227, v170, v174
    ds_write_b128 v234, v[224:227] offset:16384
    v_cvt_pk_f16_f32 v228, v147, v151
    v_cvt_pk_f16_f32 v229, v155, v159
    v_cvt_pk_f16_f32 v230, v163, v167
    v_cvt_pk_f16_f32 v231, v171, v175
    s_waitcnt lgkmcnt(14)
    ds_write_b128 v234, v[228:231] offset:17408
L_conv0:
    s_waitcnt lgkmcnt(0)
    s_barrier
    ds_read_b128 a[232:235], v8 offset:0
    ds_read_b128 a[244:247], v8 offset:2560
    ds_read_b128 a[236:239], v12 offset:0
    ds_read_b128 a[248:251], v12 offset:2560
    ds_read_b128 a[240:243], v15 offset:1280
    ds_read_b128 a[252:255], v15 offset:3840
    ds_read_b128 v[176:179], v9 offset:0
    ds_read_b128 v[188:191], v9 offset:2560
    ds_read_b128 v[180:183], v13 offset:0
    ds_read_b128 v[232:235], v13 offset:2560
    ds_read_b128 v[184:187], v14 offset:1280
    ds_read_b128 v[236:239], v14 offset:3840
    ds_read_b128 v[32:35], v10 offset:0
    ds_read_b128 v[44:47], v10 offset:2560
    ds_read_b128 v[36:39], v14 offset:0
    s_waitcnt lgkmcnt(9)
    ds_read_b128 v[64:67], v14 offset:2560
    ds_read_b128 v[40:43], v13 offset:1280
    ds_read_b128 v[68:71], v13 offset:3840
    ds_read_b128 v[136:139], v11 offset:0
    ds_read_b128 v[148:151], v11 offset:2560
    ds_read_b128 v[140:143], v15 offset:0
    s_waitcnt lgkmcnt(9)
    ds_read_b128 v[72:75], v15 offset:2560
    ds_read_b128 v[144:147], v12 offset:1280
    ds_read_b128 v[76:79], v12 offset:3840
    ds_read_b128 v[56:59], v20 offset:2560
    ds_read_b128 v[60:63], v21 offset:2560
    ds_read_b128 v[52:55], v21 offset:0
    s_waitcnt lgkmcnt(13)
    ds_read_b128 v[48:51], v20 offset:0
    s_add_u32 m0, s56, -128
    ds_read_b128 v[192:195], v22 offset:0
    s_waitcnt lgkmcnt(1)
    buffer_load_dwordx4 v1, s[20:23], 0 offen offset:128 lds
    s_add_u32 m0, s56, 896
    ds_read_b128 v[200:203], v22 offset:16
    buffer_load_dwordx4 v2, s[20:23], 0 offen offset:128 lds
    s_add_u32 m0, s56, 1920
    ds_read_b128 v[196:199], v22 offset:256
    buffer_load_dwordx4 v3, s[20:23], 0 offen offset:128 lds
    s_add_u32 m0, s56, 2944
    ds_read_b128 v[204:207], v22 offset:272
    buffer_load_dwordx4 v4, s[20:23], 0 offen offset:128 lds
    s_add_u32 m0, s56, 3968
    s_nop 0
    buffer_load_dwordx4 v5, s[20:23], 0 offen offset:128 lds
    s_add_u32 m0, s56, 4992
    s_nop 0
    buffer_load_dwordx4 v6, s[20:23], 0 offen offset:128 lds
    s_add_u32 m0, s56, 6016
    s_nop 0
    buffer_load_dword v7, s[20:23], 0 offen offset:128 lds
    s_waitcnt vmcnt(7)
    s_branch L_conv
.p2alignl 12, 0xbf810000
.fill 650, 4, 0xbf810000
L_conv:
    v_cvt_pk_bf16_f32 v80, v80, v81
    v_cvt_pk_bf16_f32 v81, v82, v83
    v_cvt_pk_bf16_f32 v82, v84, v85
    s_waitcnt lgkmcnt(3)
    v_mfma_f32_16x16x32_bf16 v[128:131], v[192:195], a[232:235], 0
    ds_read_b128 a[232:235], v8 offset:6400
    v_cvt_pk_bf16_f32 v83, v86, v87
    v_cvt_pk_bf16_f32 v96, v96, v97
    v_mfma_f32_16x16x32_bf16 v[88:91], a[168:171], v[244:247], v[88:91]
    v_cvt_pk_bf16_f32 v97, v98, v99
    v_cvt_pk_bf16_f32 v98, v100, v101
    v_cvt_pk_bf16_f32 v99, v102, v103
    v_mfma_f32_16x16x32_bf16 v[152:155], v[192:195], a[244:247], 0
    ds_read_b128 a[244:247], v8 offset:8960
    ds_read_b128 v[192:195], v22 offset:512
    v_cvt_pk_bf16_f32 v112, v112, v113
    v_mfma_f32_16x16x32_bf16 v[92:95], a[172:175], v[244:247], v[92:95]
    s_waitcnt lgkmcnt(3)
    v_cvt_pk_bf16_f32 v88, v88, v89
    v_cvt_pk_bf16_f32 v89, v90, v91
    v_cvt_pk_bf16_f32 v113, v114, v115
    v_smfmac_f32_16x16x64_bf16 v[128:131], v[200:203], a[236:243], v16
    ds_read_b128 a[236:239], v12 offset:6400
    ds_read_b128 a[240:243], v15 offset:7680
    v_cvt_pk_bf16_f32 v114, v116, v117
    v_smfmac_f32_16x16x64_bf16 v[152:155], v[200:203], a[248:255], v16
    s_waitcnt lgkmcnt(6)
    ds_read_b128 a[248:251], v12 offset:8960
    ds_read_b128 a[252:255], v15 offset:10240
    ds_read_b128 v[200:203], v22 offset:528
    v_mfma_f32_16x16x32_bf16 v[224:227], v[196:199], v[176:179], 0
    ds_read_b128 v[176:179], v9 offset:6400
    v_cvt_pkrtz_f16_f32 v128, v128, v129
    v_cvt_pkrtz_f16_f32 v129, v130, v131
    v_mfma_f32_16x16x32_bf16 v[228:231], v[196:199], v[188:191], 0
    s_waitcnt lgkmcnt(9)
    ds_read_b128 v[188:191], v9 offset:8960
    ds_read_b128 v[196:199], v22 offset:768
    v_cvt_pkrtz_f16_f32 v152, v152, v153
    v_smfmac_f32_16x16x64_bf16 v[224:227], v[204:207], v[180:187], v16
    ds_read_b128 v[180:183], v13 offset:6400
    ds_read_b128 v[184:187], v14 offset:7680
    v_cvt_pkrtz_f16_f32 v153, v154, v155
    v_smfmac_f32_16x16x64_bf16 v[228:231], v[204:207], v[232:239], v16
    s_waitcnt lgkmcnt(10)
    ds_read_b128 v[232:235], v13 offset:8960
    ds_read_b128 v[236:239], v14 offset:10240
    ds_read_b128 v[204:207], v22 offset:784
    v_mfma_f32_16x16x32_bf16 v[132:135], v[192:195], v[32:35], 0
    v_cvt_pkrtz_f16_f32 v130, v224, v225
    v_cvt_pkrtz_f16_f32 v131, v226, v227
    v_cvt_pk_bf16_f32 v90, v92, v93
    v_mfma_f32_16x16x32_bf16 v[104:107], a[176:179], v[244:247], v[104:107]
    v_cvt_pkrtz_f16_f32 v154, v228, v229
    v_cvt_pkrtz_f16_f32 v155, v230, v231
    v_cvt_pk_bf16_f32 v91, v94, v95
    v_mfma_f32_16x16x32_bf16 v[156:159], v[192:195], v[44:47], 0
    ds_read_b128 v[192:195], v22 offset:1024
    v_cvt_pk_bf16_f32 v115, v118, v119
    v_mfma_f32_16x16x32_bf16 v[108:111], a[180:183], v[244:247], v[108:111]
    s_waitcnt lgkmcnt(9)
    ds_read_b128 v[32:35], v25 offset:0
    v_cvt_pk_bf16_f32 v104, v104, v105
    v_cvt_pk_bf16_f32 v105, v106, v107
    v_smfmac_f32_16x16x64_bf16 v[132:135], v[200:203], v[36:43], v16
    v_smfmac_f32_16x16x64_bf16 v[156:159], v[200:203], v[64:71], v16
    ds_read_b128 v[200:203], v22 offset:1040
    ds_read_b128 v[36:39], v25 offset:16
    v_mfma_f32_16x16x32_f16 v[248:251], a[228:231], v[128:131], 0
    v_cvt_pk_bf16_f32 v106, v108, v109
    v_cvt_pk_bf16_f32 v107, v110, v111
    s_waitcnt vmcnt(13)
    v_mfma_f32_16x16x32_f16 v[252:255], a[228:231], v[152:155], 0
    s_waitcnt lgkmcnt(9)
    v_cvt_pkrtz_f16_f32 v132, v132, v133
    v_cvt_pkrtz_f16_f32 v156, v156, v157
    v_cvt_pkrtz_f16_f32 v133, v134, v135
    v_cvt_pkrtz_f16_f32 v157, v158, v159
    v_dot2_f32_f16 v28, v128, v128, 0
    v_dot2_f32_f16 v30, v152, v152, 0
    v_dot2_f32_f16 v28, v129, v129, v28
    v_dot2_f32_f16 v30, v153, v153, v30
    v_dot2_f32_f16 v28, v130, v130, v28
    v_dot2_f32_f16 v30, v154, v154, v30
    v_dot2_f32_f16 v28, v131, v131, v28
    v_dot2_f32_f16 v30, v155, v155, v30
    v_dot2_f32_f16 v28, v132, v132, v28
    v_dot2_f32_f16 v30, v156, v156, v30
    v_dot2_f32_f16 v28, v133, v133, v28
    v_mfma_f32_16x16x32_bf16 v[224:227], v[196:199], v[136:139], 0
    ds_read_b128 v[216:219], v20 offset:8960
    v_mfma_f32_16x16x32_bf16 v[228:231], v[196:199], v[148:151], 0
    s_waitcnt lgkmcnt(5)
    ds_read_b128 v[196:199], v22 offset:1280
    s_nop 1
    v_smfmac_f32_16x16x64_bf16 v[224:227], v[204:207], v[140:147], v16
    buffer_store_dwordx4 v[80:83], v26, s[24:27], s82 offen offset:0 sc0 sc1
    v_smfmac_f32_16x16x64_bf16 v[228:231], v[204:207], v[72:79], v16
    s_waitcnt lgkmcnt(5)
    ds_read_b128 v[204:207], v22 offset:1296
    v_mfma_f32_16x16x32_bf16 v[136:139], v[192:195], a[232:235], 0
    ds_read_b128 a[232:235], v10 offset:6400
    v_mfma_f32_16x16x32_bf16 v[120:123], a[184:187], v[244:247], v[120:123]
    s_nop 0
    v_cvt_pkrtz_f16_f32 v134, v224, v225
    v_cvt_pkrtz_f16_f32 v135, v226, v227
    v_mfma_f32_16x16x32_bf16 v[160:163], v[192:195], a[244:247], 0
    s_waitcnt lgkmcnt(6)
    ds_read_b128 a[244:247], v10 offset:8960
    ds_read_b128 v[192:195], v22 offset:1536
    v_cvt_pkrtz_f16_f32 v158, v228, v229
    v_mfma_f32_16x16x16_bf16 v[80:83], v[18:19], v[56:57], v[32:35]
    s_waitcnt lgkmcnt(7)
    v_cvt_pkrtz_f16_f32 v159, v230, v231
    v_cvt_pk_bf16_f32 v120, v120, v121
    v_cvt_pk_bf16_f32 v121, v122, v123
    v_smfmac_f32_16x16x64_bf16 v[136:139], v[200:203], a[236:243], v16
    ds_read_b128 a[236:239], v14 offset:6400
    ds_read_b128 a[240:243], v13 offset:7680
    v_mfma_f32_16x16x32_bf16 v[124:127], a[188:191], v[244:247], v[124:127]
    buffer_store_dwordx4 v[88:91], v26, s[24:27], s83 offen offset:0 sc0 sc1
    v_smfmac_f32_16x16x64_bf16 v[160:163], v[200:203], a[248:255], v16
    ds_read_b128 a[248:251], v14 offset:8960
    ds_read_b128 a[252:255], v13 offset:10240
    ds_read_b128 v[200:203], v22 offset:1552
    v_mfma_f32_16x16x32_f16 v[248:251], a[228:231], v[132:135], v[248:251]
    v_cvt_pkrtz_f16_f32 v136, v136, v137
    v_cvt_pkrtz_f16_f32 v137, v138, v139
    v_cvt_pk_bf16_f32 v122, v124, v125
    v_mfma_f32_16x16x32_f16 v[252:255], a[228:231], v[156:159], v[252:255]
    s_waitcnt lgkmcnt(9)
    v_cvt_pkrtz_f16_f32 v160, v160, v161
    v_cvt_pkrtz_f16_f32 v161, v162, v163
    v_cvt_pk_bf16_f32 v123, v126, v127
    v_mfma_f32_16x16x32_bf16 v[224:227], v[196:199], v[176:179], 0
    ds_read_b128 v[176:179], v11 offset:6400
    v_permlane16_swap_b32 v128, v132
    v_mfma_f32_16x16x16_bf16 v[84:87], v[18:19], v[58:59], v[36:39]
    v_permlane16_swap_b32 v152, v156
    v_permlane16_swap_b32 v129, v133
    v_mfma_f32_16x16x32_bf16 v[228:231], v[196:199], v[188:191], 0
    ds_read_b128 v[188:191], v11 offset:8960
    ds_read_b128 v[196:199], v22 offset:1792
    v_mfma_f32_16x16x16_bf16 v[88:91], v[18:19], v[60:61], v[32:35]
    s_waitcnt lgkmcnt(11)
    v_smfmac_f32_16x16x64_bf16 v[224:227], v[204:207], v[180:187], v16
    ds_read_b128 v[180:183], v15 offset:6400
    ds_read_b128 v[184:187], v12 offset:7680
    v_smfmac_f32_16x16x64_bf16 v[228:231], v[204:207], v[232:239], v16
    s_waitcnt lgkmcnt(11)
    ds_read_b128 v[232:235], v15 offset:8960
    ds_read_b128 v[236:239], v12 offset:10240
    ds_read_b128 v[204:207], v22 offset:1808
    v_mfma_f32_16x16x16_bf16 v[92:95], v[18:19], v[62:63], v[36:39]
    s_waitcnt lgkmcnt(13)
    v_cvt_pkrtz_f16_f32 v138, v224, v225
    v_cvt_pkrtz_f16_f32 v139, v226, v227
    v_mfma_f32_16x16x32_bf16 v[140:143], v[192:195], a[232:235], 0
    s_waitcnt vmcnt(2)
    ds_read_b128 a[232:235], v8 offset:0
    buffer_store_dwordx4 v[96:99], v26, s[24:27], s82 offen offset:64 sc0 sc1
    v_mfma_f32_16x16x16_bf16 v[40:43], v[18:19], v[52:53], v[32:35]
    v_cvt_pkrtz_f16_f32 v162, v228, v229
    v_cvt_pkrtz_f16_f32 v163, v230, v231
    v_mfma_f32_16x16x32_bf16 v[164:167], v[192:195], a[244:247], 0
    s_waitcnt lgkmcnt(9)
    ds_read_b128 a[244:247], v8 offset:2560
    ds_read_b128 v[192:195], v22 offset:2048
    buffer_store_dwordx4 v[104:107], v26, s[24:27], s83 offen offset:64 sc0 sc1
    v_smfmac_f32_16x16x64_bf16 v[140:143], v[200:203], a[236:243], v16
    ds_read_b128 a[236:239], v12 offset:0
    ds_read_b128 a[240:243], v15 offset:1280
    v_smfmac_f32_16x16x64_bf16 v[164:167], v[200:203], a[248:255], v16
    s_waitcnt lgkmcnt(11)
    ds_read_b128 a[248:251], v12 offset:2560
    ds_read_b128 a[252:255], v15 offset:3840
    ds_read_b128 v[200:203], v22 offset:2064
    v_mfma_f32_16x16x32_f16 v[248:251], a[228:231], v[136:139], v[248:251]
    v_cvt_pkrtz_f16_f32 v140, v140, v141
    v_cvt_pkrtz_f16_f32 v141, v142, v143
    v_mfma_f32_16x16x32_f16 v[252:255], a[228:231], v[160:163], v[252:255]
    s_waitcnt lgkmcnt(13)
    v_cvt_pkrtz_f16_f32 v164, v164, v165
    v_cvt_pkrtz_f16_f32 v165, v166, v167
    v_mfma_f32_16x16x32_bf16 v[224:227], v[196:199], v[176:179], 0
    ds_read_b128 v[176:179], v9 offset:0
    buffer_store_dwordx4 v[112:115], v26, s[24:27], s82 offen offset:128 sc0 sc1
    v_mfma_f32_16x16x16_bf16 v[44:47], v[18:19], v[54:55], v[36:39]
    s_waitcnt lgkmcnt(13)
    ds_read_b128 v[220:223], v21 offset:8960
    v_mfma_f32_16x16x32_bf16 v[228:231], v[196:199], v[188:191], 0
    s_waitcnt lgkmcnt(10)
    ds_read_b128 v[188:191], v9 offset:2560
    ds_read_b128 v[196:199], v22 offset:2304
    v_smfmac_f32_16x16x64_bf16 v[224:227], v[204:207], v[180:187], v16
    ds_read_b128 v[180:183], v13 offset:0
    ds_read_b128 v[184:187], v14 offset:1280
    v_smfmac_f32_16x16x64_bf16 v[228:231], v[204:207], v[232:239], v16
    s_waitcnt lgkmcnt(11)
    ds_read_b128 v[232:235], v13 offset:2560
    ds_read_b128 v[236:239], v14 offset:3840
    ds_read_b128 v[204:207], v22 offset:2320
    v_mfma_f32_16x16x16_bf16 v[32:35], v[18:19], v[48:49], v[32:35]
    s_waitcnt lgkmcnt(13)
    ds_read_b128 v[212:215], v21 offset:6400
    v_cvt_pkrtz_f16_f32 v142, v224, v225
    v_cvt_pkrtz_f16_f32 v143, v226, v227
    v_cvt_pkrtz_f16_f32 v166, v228, v229
    v_dot2_f32_f16 v30, v157, v157, v30
    v_dot2_f32_f16 v28, v134, v134, v28
    v_dot2_f32_f16 v30, v158, v158, v30
    v_dot2_f32_f16 v28, v135, v135, v28
    v_dot2_f32_f16 v30, v159, v159, v30
    v_dot2_f32_f16 v28, v136, v136, v28
    v_dot2_f32_f16 v30, v160, v160, v30
    v_dot2_f32_f16 v28, v137, v137, v28
    v_dot2_f32_f16 v30, v161, v161, v30
    v_dot2_f32_f16 v28, v138, v138, v28
    v_dot2_f32_f16 v30, v162, v162, v30
    v_dot2_f32_f16 v28, v139, v139, v28
    v_dot2_f32_f16 v30, v163, v163, v30
    v_dot2_f32_f16 v28, v140, v140, v28
    v_dot2_f32_f16 v30, v164, v164, v30
    v_dot2_f32_f16 v28, v141, v141, v28
    v_dot2_f32_f16 v30, v165, v165, v30
    v_permlane16_swap_b32 v153, v157
    v_permlane16_swap_b32 v130, v134
    v_permlane16_swap_b32 v154, v158
    v_mfma_f32_16x16x32_bf16 v[144:147], v[192:195], a[232:235], 0
    s_waitcnt lgkmcnt(13)
    ds_read_b128 a[232:235], v10 offset:0
    v_permlane16_swap_b32 v131, v135
    v_mfma_f32_16x16x32_bf16 v[168:171], v[192:195], a[244:247], 0
    s_waitcnt lgkmcnt(11)
    ds_read_b128 a[244:247], v10 offset:2560
    ds_read_b128 v[192:195], v22 offset:2560
    v_permlane16_swap_b32 v155, v159
    v_smfmac_f32_16x16x64_bf16 v[144:147], v[200:203], a[236:243], v16
    s_waitcnt lgkmcnt(12)
    ds_read_b128 a[236:239], v14 offset:0
    ds_read_b128 a[240:243], v13 offset:1280
    v_cvt_pkrtz_f16_f32 v167, v230, v231
    v_smfmac_f32_16x16x64_bf16 v[168:171], v[200:203], a[248:255], v16
    s_waitcnt lgkmcnt(11)
    ds_read_b128 a[248:251], v14 offset:2560
    ds_read_b128 a[252:255], v13 offset:3840
    ds_read_b128 v[200:203], v22 offset:2576
    v_mfma_f32_16x16x32_f16 v[248:251], a[228:231], v[140:143], v[248:251]
    v_cvt_pkrtz_f16_f32 v144, v144, v145
    v_cvt_pkrtz_f16_f32 v145, v146, v147
    v_mfma_f32_16x16x32_f16 v[252:255], a[228:231], v[164:167], v[252:255]
    v_cvt_pkrtz_f16_f32 v168, v168, v169
    v_cvt_pkrtz_f16_f32 v169, v170, v171
    v_mfma_f32_16x16x32_bf16 v[224:227], v[196:199], v[176:179], 0
    s_waitcnt lgkmcnt(13)
    ds_read_b128 v[176:179], v11 offset:0
    v_mfma_f32_16x16x32_bf16 v[228:231], v[196:199], v[188:191], 0
    s_waitcnt lgkmcnt(10)
    ds_read_b128 v[188:191], v11 offset:2560
    ds_read_b128 v[196:199], v22 offset:2816
    v_smfmac_f32_16x16x64_bf16 v[224:227], v[204:207], v[180:187], v16
    ds_read_b128 v[180:183], v15 offset:0
    ds_read_b128 v[184:187], v12 offset:1280
    v_mfma_f32_16x16x16_bf16 v[36:39], v[18:19], v[50:51], v[36:39]
    s_waitcnt lgkmcnt(12)
    ds_read_b128 v[48:51], v25 offset:128
    ds_read_b128 v[52:55], v25 offset:144
    v_smfmac_f32_16x16x64_bf16 v[228:231], v[204:207], v[232:239], v16
    s_waitcnt lgkmcnt(11)
    ds_read_b128 v[232:235], v15 offset:2560
    ds_read_b128 v[236:239], v12 offset:3840
    ds_read_b128 v[204:207], v22 offset:2832
    v_mfma_f32_16x16x32_bf16 v[148:151], v[192:195], a[232:235], 0
    v_cvt_pkrtz_f16_f32 v146, v224, v225
    v_cvt_pkrtz_f16_f32 v147, v226, v227
    v_mfma_f32_16x16x32_bf16 v[172:175], v[192:195], a[244:247], 0
    s_waitcnt lgkmcnt(10)
    buffer_store_dwordx4 v[120:123], v26, s[24:27], s83 offen offset:128 sc0 sc1
    v_cvt_pkrtz_f16_f32 v170, v228, v229
    v_cvt_pkrtz_f16_f32 v171, v230, v231
    v_smfmac_f32_16x16x64_bf16 v[148:151], v[200:203], a[236:243], v16
    ds_read_b128 v[64:67], v25 offset:256
    v_add_u32 v26, s54, v26
    v_smfmac_f32_16x16x64_bf16 v[172:175], v[200:203], a[248:255], v16
    ds_read_b128 v[68:71], v25 offset:272
    ds_read_b128 a[232:235], v23 offset:0
    ds_read_b128 a[236:239], v23 offset:1024
    v_mfma_f32_16x16x32_f16 v[248:251], a[228:231], v[144:147], v[248:251]
    s_nop 0
    v_cvt_pkrtz_f16_f32 v148, v148, v149
    v_cvt_pkrtz_f16_f32 v149, v150, v151
    v_mfma_f32_16x16x32_f16 v[252:255], a[228:231], v[168:171], v[252:255]
    s_waitcnt lgkmcnt(11)
    v_cvt_pkrtz_f16_f32 v172, v172, v173
    v_cvt_pkrtz_f16_f32 v173, v174, v175
    v_mfma_f32_16x16x32_bf16 v[224:227], v[196:199], v[176:179], 0
    s_waitcnt lgkmcnt(9)
    v_mfma_f32_16x16x32_bf16 v[228:231], v[196:199], v[188:191], 0
    s_mov_b32 s54, s87
    ds_read_b128 a[240:243], v23 offset:2048
    ds_read_b128 a[244:247], v23 offset:3072
    s_waitcnt lgkmcnt(6)
    v_smfmac_f32_16x16x64_bf16 v[224:227], v[204:207], v[180:187], v16
    ds_read_b128 v[208:211], v20 offset:6400
    ds_read_b128 a[248:251], v23 offset:4096
    v_smfmac_f32_16x16x64_bf16 v[228:231], v[204:207], v[232:239], v16
    ds_read_b128 a[252:255], v23 offset:5120
L_mid:
    v_permlane16_swap_b32 v136, v140
    v_permlane16_swap_b32 v137, v141
    v_dot2_f32_f16 v28, v142, v142, v28
    v_dot2_f32_f16 v30, v166, v166, v30
    v_cvt_pkrtz_f16_f32 v150, v224, v225
    v_cvt_pkrtz_f16_f32 v151, v226, v227
    v_dot2_f32_f16 v28, v143, v143, v28
    v_cvt_pkrtz_f16_f32 v174, v228, v229
    v_mfma_f32_16x16x32_f16 v[248:251], a[228:231], v[148:151], v[248:251]
    v_cvt_pkrtz_f16_f32 v175, v230, v231
    v_permlane16_swap_b32 v138, v142
    v_permlane16_swap_b32 v139, v143
    v_mfma_f32_16x16x32_f16 v[252:255], a[228:231], v[172:175], v[252:255]
    v_permlane16_swap_b32 v160, v164
    v_permlane16_swap_b32 v161, v165
    v_permlane16_swap_b32 v162, v166
    v_dot2_f32_f16 v30, v167, v167, v30
    v_dot2_f32_f16 v28, v144, v144, v28
    v_dot2_f32_f16 v30, v168, v168, v30
    v_dot2_f32_f16 v28, v145, v145, v28
    v_dot2_f32_f16 v30, v169, v169, v30
    v_dot2_f32_f16 v28, v146, v146, v28
    v_dot2_f32_f16 v30, v170, v170, v30
    v_dot2_f32_f16 v28, v147, v147, v28
    v_dot2_f32_f16 v30, v171, v171, v30
    v_dot2_f32_f16 v28, v148, v148, v28
    v_dot2_f32_f16 v30, v172, v172, v30
    v_dot2_f32_f16 v28, v149, v149, v28
    v_dot2_f32_f16 v30, v173, v173, v30
    v_dot2_f32_f16 v28, v150, v150, v28
    v_dot2_f32_f16 v30, v174, v174, v30
    v_dot2_f32_f16 v28, v151, v151, v28
    v_dot2_f32_f16 v30, v175, v175, v30
    v_permlane16_swap_b32 v144, v148
    v_permlane16_swap_b32 v145, v149
    v_mov_b32 v27, v28
    v_mfma_f32_16x16x16_bf16 v[96:99], v[18:19], v[216:217], v[48:51]
    ds_read_b128 v[240:243], v20 offset:2560
    ds_read_b128 v[244:247], v21 offset:2560
    v_permlane32_swap_b32 v27, v28
    v_mfma_f32_16x16x16_bf16 v[100:103], v[18:19], v[218:219], v[52:55]
    ds_read_b128 v[236:239], v21 offset:0
    ds_read_b128 v[232:235], v20 offset:0
    v_add_f32 v28, v27, v28
    v_mfma_f32_16x16x16_bf16 v[104:107], v[18:19], v[220:221], v[48:51]
    v_mul_f32 v27, 0x3c2aaaab, v248
    v_mul_f32 v28, 0x3c2aaaab, v28
    v_fma_f32 v28, -v27, v27, v28
    v_mfma_f32_16x16x16_bf16 v[108:111], v[18:19], v[222:223], v[52:55]
    v_max_f32 v28, 0, v28
    v_permlane16_swap_b32 v146, v150
    v_mfma_f32_16x16x16_bf16 v[56:59], v[18:19], v[212:213], v[48:51]
    v_add_f32 v28, 0x3727c5ac, v28
    v_permlane16_swap_b32 v147, v151
    v_mfma_f32_16x16x16_bf16 v[60:63], v[18:19], v[214:215], v[52:55]
    s_waitcnt lgkmcnt(6)
    v_rsq_f32 v28, v28
    v_permlane16_swap_b32 v163, v167
    v_mfma_f32_16x16x16_bf16 v[48:51], v[18:19], v[208:209], v[48:51]
    v_fma_mixlo_f16 v28, v28, s59, 0
    v_permlane16_swap_b32 v168, v172
    v_mfma_f32_16x16x16_bf16 v[52:55], v[18:19], v[210:211], v[52:55]
    v_fma_mixhi_f16 v28, -v27, v28, 0 op_sel_hi:[0,1,0]
    v_permlane16_swap_b32 v169, v173
    v_mov_b32 v27, v28
    v_permlane16_swap_b32 v170, v174
    v_permlane16_swap_b32 v171, v175
    v_permlane16_swap_b32 v28, v27
    v_pk_fma_f16 v128, v128, v28, v28 op_sel:[0,0,1] op_sel_hi:[1,0,1]
    v_pk_fma_f16 v129, v129, v28, v28 op_sel:[0,0,1] op_sel_hi:[1,0,1]
    v_pk_fma_f16 v130, v130, v28, v28 op_sel:[0,0,1] op_sel_hi:[1,0,1]
    v_pk_fma_f16 v131, v131, v28, v28 op_sel:[0,0,1] op_sel_hi:[1,0,1]
    v_pk_fma_f16 v132, v132, v27, v27 op_sel:[0,0,1] op_sel_hi:[1,0,1]
    v_pk_fma_f16 v133, v133, v27, v27 op_sel:[0,0,1] op_sel_hi:[1,0,1]
    v_mfma_f32_16x16x32_f16 v[176:179], a[232:235], v[128:131], 0
    v_pk_fma_f16 v134, v134, v27, v27 op_sel:[0,0,1] op_sel_hi:[1,0,1]
    v_pk_fma_f16 v135, v135, v27, v27 op_sel:[0,0,1] op_sel_hi:[1,0,1]
    v_pk_fma_f16 v136, v136, v28, v28 op_sel:[0,0,1] op_sel_hi:[1,0,1]
    v_pk_fma_f16 v137, v137, v28, v28 op_sel:[0,0,1] op_sel_hi:[1,0,1]
    v_mfma_f32_16x16x32_f16 v[184:187], a[232:235], v[132:135], 0
    v_pk_fma_f16 v138, v138, v28, v28 op_sel:[0,0,1] op_sel_hi:[1,0,1]
    v_pk_fma_f16 v139, v139, v28, v28 op_sel:[0,0,1] op_sel_hi:[1,0,1]
    v_pk_fma_f16 v140, v140, v27, v27 op_sel:[0,0,1] op_sel_hi:[1,0,1]
    v_mfma_f32_16x16x32_f16 v[180:183], a[236:239], v[128:131], 0
    v_pk_fma_f16 v141, v141, v27, v27 op_sel:[0,0,1] op_sel_hi:[1,0,1]
    v_pk_fma_f16 v142, v142, v27, v27 op_sel:[0,0,1] op_sel_hi:[1,0,1]
    v_pk_fma_f16 v143, v143, v27, v27 op_sel:[0,0,1] op_sel_hi:[1,0,1]
    v_mfma_f32_16x16x32_f16 v[188:191], a[236:239], v[132:135], 0
    v_pk_fma_f16 v147, v147, v28, v28 op_sel:[0,0,1] op_sel_hi:[1,0,1]
    v_pk_fma_f16 v144, v144, v28, v28 op_sel:[0,0,1] op_sel_hi:[1,0,1]
    v_pk_fma_f16 v145, v145, v28, v28 op_sel:[0,0,1] op_sel_hi:[1,0,1]
    v_mfma_f32_16x16x32_f16 v[176:179], a[240:243], v[136:139], v[176:179]
    v_bfi_b32 v147, v17, v147, s84
    v_pk_fma_f16 v146, v146, v28, v28 op_sel:[0,0,1] op_sel_hi:[1,0,1]
    v_pk_fma_f16 v151, v151, v27, v27 op_sel:[0,0,1] op_sel_hi:[1,0,1]
    v_mfma_f32_16x16x32_f16 v[184:187], a[240:243], v[140:143], v[184:187]
    v_pk_fma_f16 v148, v148, v27, v27 op_sel:[0,0,1] op_sel_hi:[1,0,1]
    v_pk_fma_f16 v149, v149, v27, v27 op_sel:[0,0,1] op_sel_hi:[1,0,1]
    v_bfi_b32 v151, v17, v151, s84
    v_mfma_f32_16x16x32_f16 v[180:183], a[244:247], v[136:139], v[180:183]
    v_pk_fma_f16 v150, v150, v27, v27 op_sel:[0,0,1] op_sel_hi:[1,0,1]
    v_mov_b32 v29, v30
    v_mfma_f32_16x16x32_f16 v[188:191], a[244:247], v[140:143], v[188:191]
    s_waitcnt lgkmcnt(5)
    v_permlane32_swap_b32 v29, v30
    v_add_f32 v30, v29, v30
    v_mfma_f32_16x16x32_f16 v[176:179], a[248:251], v[144:147], v[176:179]
    v_mul_f32 v29, 0x3c2aaaab, v252
    v_mul_f32 v30, 0x3c2aaaab, v30
    v_fma_f32 v30, -v29, v29, v30
    v_mfma_f32_16x16x32_f16 v[184:187], a[248:251], v[148:151], v[184:187]
    s_waitcnt lgkmcnt(4)
    v_max_f32 v30, 0, v30
    v_add_f32 v30, 0x3727c5ac, v30
    v_rsq_f32 v30, v30
    v_mfma_f32_16x16x32_f16 v[180:183], a[252:255], v[144:147], v[180:183]
    v_fma_mixlo_f16 v30, v30, s59, 0
    v_cvt_pkrtz_f16_f32 v208, v176, v177
    v_mfma_f32_16x16x32_f16 v[188:191], a[252:255], v[148:151], v[188:191]
    s_cmp_eq_u32 s52, 3
    v_fma_mixhi_f16 v30, -v29, v30, 0 op_sel_hi:[0,1,0]
    v_pk_lshrrev_b16 v208, 3, v208 op_sel_hi:[0,1]
    v_mov_b32 v29, v30
    v_mad_u32_u16 v209, v208, 2, s85
    v_mad_u32_u16 v208, v208, 2, s85 op_sel:[1,0,0,0]
    v_permlane16_swap_b32 v30, v29
    v_pk_fma_f16 v152, v152, v30, v30 op_sel:[0,0,1] op_sel_hi:[1,0,1]
    v_pk_fma_f16 v153, v153, v30, v30 op_sel:[0,0,1] op_sel_hi:[1,0,1]
    v_pk_fma_f16 v154, v154, v30, v30 op_sel:[0,0,1] op_sel_hi:[1,0,1]
    v_pk_fma_f16 v155, v155, v30, v30 op_sel:[0,0,1] op_sel_hi:[1,0,1]
    v_pk_fma_f16 v156, v156, v29, v29 op_sel:[0,0,1] op_sel_hi:[1,0,1]
    v_pk_fma_f16 v157, v157, v29, v29 op_sel:[0,0,1] op_sel_hi:[1,0,1]
    v_mfma_f32_16x16x32_f16 v[192:195], a[232:235], v[152:155], 0
    s_cselect_b32 s57, 0x40000000, s87
    ds_read_u16 v209, v209
    ds_read_u16_d16_hi v208, v208
    v_pk_fma_f16 v158, v158, v29, v29 op_sel:[0,0,1] op_sel_hi:[1,0,1]
    v_pk_fma_f16 v159, v159, v29, v29 op_sel:[0,0,1] op_sel_hi:[1,0,1]
    v_pk_fma_f16 v160, v160, v30, v30 op_sel:[0,0,1] op_sel_hi:[1,0,1]
    v_pk_fma_f16 v161, v161, v30, v30 op_sel:[0,0,1] op_sel_hi:[1,0,1]
    v_mfma_f32_16x16x32_f16 v[200:203], a[232:235], v[156:159], 0
    ds_read_b128 a[232:235], v23 offset:10240
    v_pk_fma_f16 v162, v162, v30, v30 op_sel:[0,0,1] op_sel_hi:[1,0,1]
    v_pk_fma_f16 v163, v163, v30, v30 op_sel:[0,0,1] op_sel_hi:[1,0,1]
    v_mfma_f32_16x16x32_f16 v[196:199], a[236:239], v[152:155], 0
    v_pk_fma_f16 v164, v164, v29, v29 op_sel:[0,0,1] op_sel_hi:[1,0,1]
    v_pk_fma_f16 v165, v165, v29, v29 op_sel:[0,0,1] op_sel_hi:[1,0,1]
    v_pk_fma_f16 v166, v166, v29, v29 op_sel:[0,0,1] op_sel_hi:[1,0,1]
    v_mfma_f32_16x16x32_f16 v[204:207], a[236:239], v[156:159], 0
    ds_read_b128 a[236:239], v23 offset:11264
    v_pk_fma_f16 v167, v167, v29, v29 op_sel:[0,0,1] op_sel_hi:[1,0,1]
    v_cvt_pkrtz_f16_f32 v210, v178, v179
    v_mfma_f32_16x16x32_f16 v[192:195], a[240:243], v[160:163], v[192:195]
    v_pk_lshrrev_b16 v210, 3, v210 op_sel_hi:[0,1]
    v_mad_u32_u16 v211, v210, 2, s85
    v_mad_u32_u16 v210, v210, 2, s85 op_sel:[1,0,0,0]
    v_mfma_f32_16x16x32_f16 v[200:203], a[240:243], v[164:167], v[200:203]
    ds_read_u16 v211, v211
    ds_read_u16_d16_hi v210, v210
    ds_read_b128 a[240:243], v23 offset:12288
    v_mfma_f32_16x16x32_f16 v[196:199], a[244:247], v[160:163], v[196:199]
    v_cvt_pkrtz_f16_f32 v212, v180, v181
    v_pk_lshrrev_b16 v212, 3, v212 op_sel_hi:[0,1]
    v_mad_u32_u16 v213, v212, 2, s85
    v_mfma_f32_16x16x32_f16 v[204:207], a[244:247], v[164:167], v[204:207]
    s_waitcnt lgkmcnt(7)
    ds_read_u16 v213, v213
    ds_read_b128 a[244:247], v23 offset:13312
    v_mad_u32_u16 v212, v212, 2, s85 op_sel:[1,0,0,0]
    v_cvt_pkrtz_f16_f32 v214, v182, v183
    v_pk_lshrrev_b16 v214, 3, v214 op_sel_hi:[0,1]
    v_mad_u32_u16 v215, v214, 2, s85
    v_mad_u32_u16 v214, v214, 2, s85 op_sel:[1,0,0,0]
    v_cvt_pkrtz_f16_f32 v216, v184, v185
    v_pk_lshrrev_b16 v216, 3, v216 op_sel_hi:[0,1]
    v_mad_u32_u16 v217, v216, 2, s85
    v_mad_u32_u16 v216, v216, 2, s85 op_sel:[1,0,0,0]
    v_cvt_pkrtz_f16_f32 v218, v186, v187
    ds_read_u16_d16_hi v212, v212
    ds_read_u16 v215, v215
    ds_read_u16_d16_hi v214, v214
    ds_read_u16 v217, v217
    ds_read_u16_d16_hi v216, v216
    v_pk_lshrrev_b16 v218, 3, v218 op_sel_hi:[0,1]
    v_mad_u32_u16 v219, v218, 2, s85
    v_mad_u32_u16 v218, v218, 2, s85 op_sel:[1,0,0,0]
    v_cvt_pkrtz_f16_f32 v220, v188, v189
    v_pk_lshrrev_b16 v220, 3, v220 op_sel_hi:[0,1]
    v_mad_u32_u16 v221, v220, 2, s85
    v_mad_u32_u16 v220, v220, 2, s85 op_sel:[1,0,0,0]
    v_cvt_pkrtz_f16_f32 v222, v190, v191
    v_pk_lshrrev_b16 v222, 3, v222 op_sel_hi:[0,1]
    v_mad_u32_u16 v223, v222, 2, s85
    v_mad_u32_u16 v222, v222, 2, s85 op_sel:[1,0,0,0]
    v_pk_fma_f16 v171, v171, v30, v30 op_sel:[0,0,1] op_sel_hi:[1,0,1]
    v_pk_fma_f16 v168, v168, v30, v30 op_sel:[0,0,1] op_sel_hi:[1,0,1]
    v_pk_fma_f16 v169, v169, v30, v30 op_sel:[0,0,1] op_sel_hi:[1,0,1]
    v_bfi_b32 v171, v17, v171, s84
    v_pk_fma_f16 v170, v170, v30, v30 op_sel:[0,0,1] op_sel_hi:[1,0,1]
    v_pk_fma_f16 v175, v175, v29, v29 op_sel:[0,0,1] op_sel_hi:[1,0,1]
    v_pk_fma_f16 v172, v172, v29, v29 op_sel:[0,0,1] op_sel_hi:[1,0,1]
    v_mfma_f32_16x16x32_f16 v[192:195], a[248:251], v[168:171], v[192:195]
    s_waitcnt lgkmcnt(10)
    ds_read_u16 v219, v219
    ds_read_u16_d16_hi v218, v218
    ds_read_u16 v221, v221
    ds_read_u16_d16_hi v220, v220
    v_pk_fma_f16 v173, v173, v29, v29 op_sel:[0,0,1] op_sel_hi:[1,0,1]
    v_bfi_b32 v175, v17, v175, s84
    v_pk_fma_f16 v174, v174, v29, v29 op_sel:[0,0,1] op_sel_hi:[1,0,1]
    v_add_u32 v1, s57, v1
    v_add_u32 v2, s57, v2
    v_mfma_f32_16x16x32_f16 v[200:203], a[248:251], v[172:175], v[200:203]
    s_waitcnt lgkmcnt(11)
    ds_read_u16 v223, v223
    ds_read_u16_d16_hi v222, v222
    ds_read_b128 a[248:251], v23 offset:14336
    v_mfma_f32_16x16x32_f16 v[196:199], a[252:255], v[168:171], v[196:199]
    s_add_u32 m0, s56, 6336
    v_add_u32 v3, s57, v3
    v_add_u32 v4, s57, v4
    v_add_u32 v5, s57, v5
    v_mfma_f32_16x16x32_f16 v[204:207], a[252:255], v[172:175], v[204:207]
    s_waitcnt lgkmcnt(13)
    buffer_load_dwordx4 v1, s[20:23], 0 offen offset:64 lds
    ds_read_b128 a[252:255], v23 offset:15360
    v_mfma_f32_16x16x16_bf16 v[112:115], v[18:19], v[240:241], v[64:67]
    v_add_u32 v6, s57, v6
    v_add_u32 v7, s57, v7
    v_add_u32 v31, s57, v31
    v_mfma_f32_16x16x16_bf16 v[116:119], v[18:19], v[242:243], v[68:71]
    v_cvt_pkrtz_f16_f32 v224, v192, v193
    v_pk_lshrrev_b16 v224, 3, v224 op_sel_hi:[0,1]
    v_cvt_pkrtz_f16_f32 v226, v194, v195
    v_mfma_f32_16x16x16_bf16 v[120:123], v[18:19], v[244:245], v[64:67]
    v_cvt_pkrtz_f16_f32 v228, v196, v197
    v_cvt_pkrtz_f16_f32 v230, v198, v199
    v_cvt_pkrtz_f16_f32 v248, v200, v201
    v_mfma_f32_16x16x16_bf16 v[124:127], v[18:19], v[246:247], v[68:71]
    v_cvt_pkrtz_f16_f32 v250, v202, v203
    v_cvt_pkrtz_f16_f32 v252, v204, v205
    v_cvt_pkrtz_f16_f32 v0, v206, v207
    v_mfma_f32_16x16x16_bf16 v[72:75], v[18:19], v[236:237], v[64:67]
    s_waitcnt lgkmcnt(6)
    v_or_b32 v236, v217, v216
    v_or_b32 v237, v219, v218
    v_mad_u32_u16 v225, v224, 2, s85
    v_mfma_f32_16x16x16_bf16 v[76:79], v[18:19], v[238:239], v[68:71]
    s_waitcnt lgkmcnt(4)
    ds_read_u16 v225, v225
    v_or_b32 v238, v221, v220
    v_mad_u32_u16 v224, v224, 2, s85 op_sel:[1,0,0,0]
    v_mfma_f32_16x16x16_bf16 v[64:67], v[18:19], v[232:233], v[64:67]
    ds_read_u16_d16_hi v224, v224
    v_or_b32 v232, v209, v208
    v_or_b32 v233, v211, v210
    v_mfma_f32_16x16x16_bf16 v[68:71], v[18:19], v[234:235], v[68:71]
    s_waitcnt lgkmcnt(5)
    v_or_b32 v234, v213, v212
    v_or_b32 v235, v215, v214
    s_waitcnt lgkmcnt(4)
    v_or_b32 v239, v223, v222
    v_mfma_f32_16x16x32_f16 v[176:179], a[232:235], v[128:131], 0
    v_pk_lshrrev_b16 v226, 3, v226 op_sel_hi:[0,1]
    v_mad_u32_u16 v227, v226, 2, s85
    v_mad_u32_u16 v226, v226, 2, s85 op_sel:[1,0,0,0]
    v_mfma_f32_16x16x32_f16 v[184:187], a[232:235], v[132:135], 0
    ds_read_u16 v227, v227
    ds_read_u16_d16_hi v226, v226
    v_pk_lshrrev_b16 v228, 3, v228 op_sel_hi:[0,1]
    v_mfma_f32_16x16x32_f16 v[180:183], a[236:239], v[128:131], 0
    v_mad_u32_u16 v229, v228, 2, s85
    v_mad_u32_u16 v228, v228, 2, s85 op_sel:[1,0,0,0]
    v_pk_lshrrev_b16 v230, 3, v230 op_sel_hi:[0,1]
    v_mfma_f32_16x16x32_f16 v[188:191], a[236:239], v[132:135], 0
    ds_read_u16 v229, v229
    ds_read_u16_d16_hi v228, v228
    v_mad_u32_u16 v231, v230, 2, s85
    v_mfma_f32_16x16x32_f16 v[192:195], a[232:235], v[152:155], 0
    ds_read_u16 v231, v231
    v_mad_u32_u16 v230, v230, 2, s85 op_sel:[1,0,0,0]
    v_pk_lshrrev_b16 v248, 3, v248 op_sel_hi:[0,1]
    v_mfma_f32_16x16x32_f16 v[200:203], a[232:235], v[156:159], 0
    ds_read_u16_d16_hi v230, v230
    ds_read_b128 a[232:235], v23 offset:6144
    v_mad_u32_u16 v249, v248, 2, s85
    v_mfma_f32_16x16x32_f16 v[176:179], a[240:243], v[136:139], v[176:179]
    ds_read_u16 v249, v249
    v_mad_u32_u16 v248, v248, 2, s85 op_sel:[1,0,0,0]
    v_pk_lshrrev_b16 v250, 3, v250 op_sel_hi:[0,1]
    v_mfma_f32_16x16x32_f16 v[184:187], a[240:243], v[140:143], v[184:187]
    ds_read_u16_d16_hi v248, v248
    v_mad_u32_u16 v251, v250, 2, s85
    v_mad_u32_u16 v250, v250, 2, s85 op_sel:[1,0,0,0]
    v_mfma_f32_16x16x32_f16 v[196:199], a[236:239], v[152:155], 0
    s_waitcnt lgkmcnt(12)
    ds_read_u16 v251, v251
    ds_read_u16_d16_hi v250, v250
    v_pk_lshrrev_b16 v252, 3, v252 op_sel_hi:[0,1]
    v_mfma_f32_16x16x32_f16 v[204:207], a[236:239], v[156:159], 0
    s_waitcnt lgkmcnt(13)
    ds_read_b128 a[236:239], v23 offset:7168
    v_mad_u32_u16 v253, v252, 2, s85
    v_mad_u32_u16 v252, v252, 2, s85 op_sel:[1,0,0,0]
    v_mfma_f32_16x16x32_f16 v[180:183], a[244:247], v[136:139], v[180:183]
    s_waitcnt lgkmcnt(12)
    ds_read_u16 v253, v253
    ds_read_u16_d16_hi v252, v252
    v_pk_lshrrev_b16 v0, 3, v0 op_sel_hi:[0,1]
    v_mfma_f32_16x16x32_f16 v[188:191], a[244:247], v[140:143], v[188:191]
    v_mad_u32_u16 v208, v0, 2, s85
    v_mad_u32_u16 v0, v0, 2, s85 op_sel:[1,0,0,0]
    v_or_b32 v240, v225, v224
    v_mfma_f32_16x16x32_f16 v[192:195], a[240:243], v[160:163], v[192:195]
    s_waitcnt lgkmcnt(12)
    ds_read_u16 v208, v208
    ds_read_u16_d16_hi v0, v0
    v_or_b32 v241, v227, v226
    v_mfma_f32_16x16x32_f16 v[200:203], a[240:243], v[164:167], v[200:203]
    s_waitcnt lgkmcnt(10)
    ds_read_b128 a[240:243], v23 offset:8192
    v_or_b32 v242, v229, v228
    v_or_b32 v243, v231, v230
    v_mfma_f32_16x16x32_f16 v[176:179], a[248:251], v[144:147], v[176:179]
    v_mfma_f32_16x16x32_f16 v[184:187], a[248:251], v[148:151], v[184:187]
    v_mfma_f32_16x16x32_f16 v[196:199], a[244:247], v[160:163], v[196:199]
    s_waitcnt lgkmcnt(8)
    v_or_b32 v244, v249, v248
    v_mfma_f32_16x16x32_f16 v[204:207], a[244:247], v[164:167], v[204:207]
    ds_read_b128 a[244:247], v23 offset:9216
    v_mfma_f32_16x16x32_f16 v[180:183], a[252:255], v[144:147], v[180:183]
    s_add_u32 m0, s56, 7360
    s_nop 0
    buffer_load_dwordx4 v2, s[20:23], 0 offen offset:64 lds
    v_mfma_f32_16x16x32_f16 v[188:191], a[252:255], v[148:151], v[188:191]
    s_waitcnt lgkmcnt(7)
    v_or_b32 v245, v251, v250
    v_cvt_pkrtz_f16_f32 v209, v176, v177
    v_pk_lshrrev_b16 v209, 3, v209 op_sel_hi:[0,1]
    v_mfma_f32_16x16x32_f16 v[192:195], a[248:251], v[168:171], v[192:195]
    v_mad_u32_u16 v210, v209, 2, s85
    v_mad_u32_u16 v209, v209, 2, s85 op_sel:[1,0,0,0]
    v_cvt_pkrtz_f16_f32 v211, v178, v179
    v_mfma_f32_16x16x32_f16 v[200:203], a[248:251], v[172:175], v[200:203]
    ds_read_b128 a[248:251], v23 offset:20480
    ds_read_u16 v210, v210
    ds_read_u16_d16_hi v209, v209
    v_mfma_f32_16x16x32_f16 v[196:199], a[252:255], v[168:171], v[196:199]
    s_waitcnt lgkmcnt(7)
    v_or_b32 v246, v253, v252
    v_pk_lshrrev_b16 v211, 3, v211 op_sel_hi:[0,1]
    v_mad_u32_u16 v212, v211, 2, s85
    v_mfma_f32_16x16x32_f16 v[204:207], a[252:255], v[172:175], v[204:207]
    ds_read_b128 a[252:255], v23 offset:21504
    ds_read_u16 v212, v212
    v_mad_u32_u16 v211, v211, 2, s85 op_sel:[1,0,0,0]
    v_mfma_f32_16x16x32_bf16 v[32:35], a[192:195], v[232:235], v[32:35]
    ds_read_u16_d16_hi v211, v211
    v_cvt_pkrtz_f16_f32 v213, v180, v181
    v_pk_lshrrev_b16 v213, 3, v213 op_sel_hi:[0,1]
    v_mfma_f32_16x16x32_bf16 v[40:43], a[192:195], v[236:239], v[40:43]
    s_waitcnt lgkmcnt(8)
    v_or_b32 v247, v208, v0
    v_mad_u32_u16 v214, v213, 2, s85
    v_mad_u32_u16 v213, v213, 2, s85 op_sel:[1,0,0,0]
    v_mfma_f32_16x16x32_bf16 v[36:39], a[196:199], v[232:235], v[36:39]
    ds_read_u16 v214, v214
    ds_read_u16_d16_hi v213, v213
    v_cvt_pkrtz_f16_f32 v215, v182, v183
    v_mfma_f32_16x16x32_bf16 v[44:47], a[196:199], v[236:239], v[44:47]
    v_pk_lshrrev_b16 v215, 3, v215 op_sel_hi:[0,1]
    v_mad_u32_u16 v216, v215, 2, s85
    v_mad_u32_u16 v215, v215, 2, s85 op_sel:[1,0,0,0]
    v_mfma_f32_16x16x32_bf16 v[80:83], a[192:195], v[240:243], v[80:83]
    ds_read_u16 v216, v216
    ds_read_u16_d16_hi v215, v215
    v_cvt_pkrtz_f16_f32 v217, v184, v185
    v_mfma_f32_16x16x32_bf16 v[88:91], a[192:195], v[244:247], v[88:91]
    v_pk_lshrrev_b16 v217, 3, v217 op_sel_hi:[0,1]
    v_mad_u32_u16 v218, v217, 2, s85
    v_mad_u32_u16 v217, v217, 2, s85 op_sel:[1,0,0,0]
    v_mfma_f32_16x16x32_bf16 v[48:51], a[232:235], v[232:235], v[48:51]
    ds_read_u16 v218, v218
    ds_read_u16_d16_hi v217, v217
    v_cvt_pkrtz_f16_f32 v219, v186, v187
    v_mfma_f32_16x16x32_bf16 v[56:59], a[232:235], v[236:239], v[56:59]
    v_pk_lshrrev_b16 v219, 3, v219 op_sel_hi:[0,1]
    v_mad_u32_u16 v220, v219, 2, s85
    v_mad_u32_u16 v219, v219, 2, s85 op_sel:[1,0,0,0]
    v_mfma_f32_16x16x32_bf16 v[84:87], a[196:199], v[240:243], v[84:87]
    s_waitcnt lgkmcnt(12)
    ds_read_u16 v220, v220
    ds_read_u16_d16_hi v219, v219
    v_cvt_pkrtz_f16_f32 v221, v188, v189
    v_mfma_f32_16x16x32_bf16 v[92:95], a[196:199], v[244:247], v[92:95]
    v_pk_lshrrev_b16 v221, 3, v221 op_sel_hi:[0,1]
    v_mad_u32_u16 v222, v221, 2, s85
    v_mad_u32_u16 v221, v221, 2, s85 op_sel:[1,0,0,0]
    v_mfma_f32_16x16x32_bf16 v[52:55], a[236:239], v[232:235], v[52:55]
    s_waitcnt lgkmcnt(12)
    ds_read_u16 v222, v222
    ds_read_u16_d16_hi v221, v221
    v_cvt_pkrtz_f16_f32 v223, v190, v191
    v_mfma_f32_16x16x32_bf16 v[60:63], a[236:239], v[236:239], v[60:63]
    v_pk_lshrrev_b16 v223, 3, v223 op_sel_hi:[0,1]
    v_mad_u32_u16 v224, v223, 2, s85
    v_mad_u32_u16 v223, v223, 2, s85 op_sel:[1,0,0,0]
    v_mfma_f32_16x16x32_bf16 v[96:99], a[232:235], v[240:243], v[96:99]
    s_waitcnt lgkmcnt(11)
    ds_read_u16 v224, v224
    ds_read_u16_d16_hi v223, v223
    v_cvt_pkrtz_f16_f32 v225, v192, v193
    v_mfma_f32_16x16x32_bf16 v[104:107], a[232:235], v[244:247], v[104:107]
    s_add_u32 m0, s56, 8384
    ds_read_b128 a[232:235], v23 offset:22528
    buffer_load_dwordx4 v3, s[20:23], 0 offen offset:64 lds
    v_mfma_f32_16x16x32_bf16 v[64:67], a[240:243], v[232:235], v[64:67]
    v_pk_lshrrev_b16 v225, 3, v225 op_sel_hi:[0,1]
    v_cvt_pkrtz_f16_f32 v227, v194, v195
    v_cvt_pkrtz_f16_f32 v229, v196, v197
    v_mfma_f32_16x16x32_bf16 v[72:75], a[240:243], v[236:239], v[72:75]
    v_cvt_pkrtz_f16_f32 v231, v198, v199
    v_cvt_pkrtz_f16_f32 v249, v200, v201
    v_cvt_pkrtz_f16_f32 v251, v202, v203
    v_mfma_f32_16x16x32_bf16 v[100:103], a[236:239], v[240:243], v[100:103]
    v_cvt_pkrtz_f16_f32 v208, v204, v205
    v_mad_u32_u16 v226, v225, 2, s85
    v_mad_u32_u16 v225, v225, 2, s85 op_sel:[1,0,0,0]
    v_mfma_f32_16x16x32_bf16 v[108:111], a[236:239], v[244:247], v[108:111]
    s_waitcnt lgkmcnt(11)
    ds_read_b128 a[236:239], v23 offset:23552
    ds_read_u16 v226, v226
    ds_read_u16_d16_hi v225, v225
    v_mfma_f32_16x16x32_bf16 v[68:71], a[244:247], v[232:235], v[68:71]
    v_or_b32 v232, v210, v209
    v_or_b32 v233, v212, v211
    v_or_b32 v234, v214, v213
    v_mfma_f32_16x16x32_bf16 v[76:79], a[244:247], v[236:239], v[76:79]
    s_waitcnt lgkmcnt(10)
    v_or_b32 v235, v216, v215
    v_or_b32 v236, v218, v217
    v_cvt_pkrtz_f16_f32 v211, v206, v207
    v_mfma_f32_16x16x32_bf16 v[112:115], a[240:243], v[240:243], v[112:115]
    s_waitcnt lgkmcnt(8)
    v_or_b32 v237, v220, v219
    v_pk_lshrrev_b16 v227, 3, v227 op_sel_hi:[0,1]
    v_mad_u32_u16 v228, v227, 2, s85
    v_mfma_f32_16x16x32_bf16 v[120:123], a[240:243], v[244:247], v[120:123]
    ds_read_b128 a[240:243], v23 offset:24576
    ds_read_u16 v228, v228
    v_mad_u32_u16 v227, v227, 2, s85 op_sel:[1,0,0,0]
    v_mfma_f32_16x16x32_bf16 v[116:119], a[244:247], v[240:243], v[116:119]
    ds_read_u16_d16_hi v227, v227
    v_pk_lshrrev_b16 v229, 3, v229 op_sel_hi:[0,1]
    v_mad_u32_u16 v230, v229, 2, s85
    v_mfma_f32_16x16x32_bf16 v[124:127], a[244:247], v[244:247], v[124:127]
    s_waitcnt lgkmcnt(9)
    ds_read_b128 a[244:247], v23 offset:25600
    ds_read_u16 v230, v230
    v_or_b32 v238, v222, v221
    v_mfma_f32_16x16x32_f16 v[176:179], a[248:251], v[128:131], 0
    v_mad_u32_u16 v229, v229, 2, s85 op_sel:[1,0,0,0]
    v_pk_lshrrev_b16 v231, 3, v231 op_sel_hi:[0,1]
    v_mad_u32_u16 v248, v231, 2, s85
    v_mfma_f32_16x16x32_f16 v[184:187], a[248:251], v[132:135], 0
    s_waitcnt lgkmcnt(10)
    ds_read_u16_d16_hi v229, v229
    ds_read_u16 v248, v248
    s_waitcnt lgkmcnt(11)
    v_or_b32 v239, v224, v223
    v_mfma_f32_16x16x32_f16 v[180:183], a[252:255], v[128:131], 0
    v_mad_u32_u16 v231, v231, 2, s85 op_sel:[1,0,0,0]
    v_pk_lshrrev_b16 v249, 3, v249 op_sel_hi:[0,1]
    v_mad_u32_u16 v250, v249, 2, s85
    v_mfma_f32_16x16x32_f16 v[188:191], a[252:255], v[132:135], 0
    ds_read_u16_d16_hi v231, v231
    ds_read_u16 v250, v250
    v_mad_u32_u16 v249, v249, 2, s85 op_sel:[1,0,0,0]
    v_mfma_f32_16x16x32_f16 v[192:195], a[248:251], v[152:155], 0
    ds_read_u16_d16_hi v249, v249
    v_pk_lshrrev_b16 v251, 3, v251 op_sel_hi:[0,1]
    v_mad_u32_u16 v252, v251, 2, s85
    v_mfma_f32_16x16x32_f16 v[200:203], a[248:251], v[156:159], 0
    s_waitcnt lgkmcnt(13)
    ds_read_u16 v252, v252
    v_mad_u32_u16 v251, v251, 2, s85 op_sel:[1,0,0,0]
    v_pk_fma_f16 v253, v208, v208, s53
    v_mfma_f32_16x16x32_f16 v[176:179], a[232:235], v[136:139], v[176:179]
    s_waitcnt lgkmcnt(13)
    ds_read_u16_d16_hi v251, v251
    v_pk_fma_f16 v209, v211, v211, s53
    v_pk_mul_f16 v253, v253, v208 neg_lo:[1,0] neg_hi:[1,0]
    v_mfma_f32_16x16x32_f16 v[184:187], a[232:235], v[140:143], v[184:187]
    s_waitcnt lgkmcnt(13)
    ds_read_b128 a[248:251], v23 offset:16384
    v_pk_mul_f16 v209, v209, v211 neg_lo:[1,0] neg_hi:[1,0]
    v_exp_f16 v0, v253
    v_mfma_f32_16x16x32_f16 v[196:199], a[252:255], v[152:155], 0
    v_exp_f16 v210, v209
    v_exp_f16_sdwa v0, v253 dst_sel:WORD_1 dst_unused:UNUSED_PRESERVE src0_sel:WORD_1
    v_mfma_f32_16x16x32_f16 v[204:207], a[252:255], v[156:159], 0
    s_waitcnt lgkmcnt(13)
    ds_read_b128 a[252:255], v23 offset:17408
    v_exp_f16_sdwa v210, v209 dst_sel:WORD_1 dst_unused:UNUSED_PRESERVE src0_sel:WORD_1
    v_mfma_f32_16x16x32_f16 v[180:183], a[236:239], v[136:139], v[180:183]
    v_pk_fma_f16 v0, v0, s86, s86
    v_pk_fma_f16 v210, v210, s86, s86
    v_rcp_f16 v253, v0
    v_mfma_f32_16x16x32_f16 v[188:191], a[236:239], v[140:143], v[188:191]
    v_rcp_f16 v209, v210
    v_rcp_f16_sdwa v253, v0 dst_sel:WORD_1 dst_unused:UNUSED_PRESERVE src0_sel:WORD_1
    v_mfma_f32_16x16x32_f16 v[192:195], a[232:235], v[160:163], v[192:195]
    v_rcp_f16_sdwa v209, v210 dst_sel:WORD_1 dst_unused:UNUSED_PRESERVE src0_sel:WORD_1
    v_fma_mix_f32 v0, v253, v208, 0 op_sel_hi:[1,1,0]
    v_mfma_f32_16x16x32_f16 v[200:203], a[232:235], v[164:167], v[200:203]
    s_waitcnt lgkmcnt(11)
    ds_read_b128 a[232:235], v23 offset:18432
    v_fma_mix_f32 v210, v209, v211, 0 op_sel_hi:[1,1,0]
    v_fma_mix_f32 v253, v253, v208, 0 op_sel:[1,1,0] op_sel_hi:[1,1,0]
    v_mfma_f32_16x16x32_f16 v[176:179], a[240:243], v[144:147], v[176:179]
    s_add_u32 m0, s56, 10432
    v_fma_mix_f32 v209, v209, v211, 0 op_sel:[1,1,0] op_sel_hi:[1,1,0]
    v_or_b32 v240, v226, v225
    v_or_b32 v241, v228, v227
    v_mfma_f32_16x16x32_f16 v[184:187], a[240:243], v[148:151], v[184:187]
    s_waitcnt lgkmcnt(7)
    buffer_load_dwordx4 v5, s[20:23], 0 offen offset:64 lds
    v_mfma_f32_16x16x32_f16 v[196:199], a[236:239], v[160:163], v[196:199]
    s_add_u32 m0, s56, 9408
    v_or_b32 v242, v230, v229
    v_or_b32 v243, v248, v231
    v_cvt_pk_bf16_f32 v246, v0, v253
    v_mfma_f32_16x16x32_f16 v[204:207], a[236:239], v[164:167], v[204:207]
    buffer_load_dwordx4 v4, s[20:23], 0 offen offset:64 lds
    ds_read_b128 a[236:239], v23 offset:19456
    v_mfma_f32_16x16x32_f16 v[180:183], a[244:247], v[144:147], v[180:183]
    s_waitcnt lgkmcnt(6)
    v_or_b32 v244, v250, v249
    v_cvt_pk_bf16_f32 v247, v210, v209
    v_cvt_pkrtz_f16_f32 v212, v176, v177
    v_mfma_f32_16x16x32_f16 v[188:191], a[244:247], v[148:151], v[188:191]
    v_pk_lshrrev_b16 v212, 3, v212 op_sel_hi:[0,1]
    v_mad_u32_u16 v213, v212, 2, s85
    v_mad_u32_u16 v212, v212, 2, s85 op_sel:[1,0,0,0]
    v_mfma_f32_16x16x32_f16 v[192:195], a[240:243], v[168:171], v[192:195]
    s_waitcnt lgkmcnt(4)
    ds_read_u16 v213, v213
    ds_read_u16_d16_hi v212, v212
    v_or_b32 v245, v252, v251
    v_mfma_f32_16x16x32_f16 v[200:203], a[240:243], v[172:175], v[200:203]
    ds_read_b128 a[240:243], v23 offset:30720
    v_cvt_pkrtz_f16_f32 v214, v178, v179
    v_pk_lshrrev_b16 v214, 3, v214 op_sel_hi:[0,1]
    v_mfma_f32_16x16x32_f16 v[196:199], a[244:247], v[168:171], v[196:199]
    v_mad_u32_u16 v215, v214, 2, s85
    v_mad_u32_u16 v214, v214, 2, s85 op_sel:[1,0,0,0]
    v_cvt_pkrtz_f16_f32 v216, v180, v181
    v_mfma_f32_16x16x32_f16 v[204:207], a[244:247], v[172:175], v[204:207]
    ds_read_b128 a[244:247], v23 offset:31744
    ds_read_u16 v215, v215
    ds_read_u16_d16_hi v214, v214
    v_mfma_f32_16x16x32_bf16 v[32:35], a[200:203], v[232:235], v[32:35]
    v_pk_lshrrev_b16 v216, 3, v216 op_sel_hi:[0,1]
    v_mad_u32_u16 v217, v216, 2, s85
    v_mad_u32_u16 v216, v216, 2, s85 op_sel:[1,0,0,0]
    v_mfma_f32_16x16x32_bf16 v[40:43], a[200:203], v[236:239], v[40:43]
    ds_read_u16 v217, v217
    ds_read_u16_d16_hi v216, v216
    v_cvt_pkrtz_f16_f32 v218, v182, v183
    v_mfma_f32_16x16x32_bf16 v[36:39], a[204:207], v[232:235], v[36:39]
    v_pk_lshrrev_b16 v218, 3, v218 op_sel_hi:[0,1]
    v_mad_u32_u16 v219, v218, 2, s85
    v_mad_u32_u16 v218, v218, 2, s85 op_sel:[1,0,0,0]
    v_mfma_f32_16x16x32_bf16 v[44:47], a[204:207], v[236:239], v[44:47]
    ds_read_u16 v219, v219
    ds_read_u16_d16_hi v218, v218
    v_cvt_pkrtz_f16_f32 v220, v184, v185
    v_mfma_f32_16x16x32_bf16 v[80:83], a[200:203], v[240:243], v[80:83]
    v_pk_lshrrev_b16 v220, 3, v220 op_sel_hi:[0,1]
    v_mad_u32_u16 v221, v220, 2, s85
    v_mad_u32_u16 v220, v220, 2, s85 op_sel:[1,0,0,0]
    v_mfma_f32_16x16x32_bf16 v[88:91], a[200:203], v[244:247], v[88:91]
    s_waitcnt lgkmcnt(12)
    ds_read_u16 v221, v221
    ds_read_u16_d16_hi v220, v220
    v_cvt_pkrtz_f16_f32 v222, v186, v187
    v_mfma_f32_16x16x32_bf16 v[48:51], a[248:251], v[232:235], v[48:51]
    v_pk_lshrrev_b16 v222, 3, v222 op_sel_hi:[0,1]
    v_mad_u32_u16 v223, v222, 2, s85
    v_mad_u32_u16 v222, v222, 2, s85 op_sel:[1,0,0,0]
    v_mfma_f32_16x16x32_bf16 v[56:59], a[248:251], v[236:239], v[56:59]
    s_waitcnt lgkmcnt(12)
    ds_read_u16 v223, v223
    ds_read_u16_d16_hi v222, v222
    v_cvt_pkrtz_f16_f32 v224, v188, v189
    v_mfma_f32_16x16x32_bf16 v[84:87], a[204:207], v[240:243], v[84:87]
    v_pk_lshrrev_b16 v224, 3, v224 op_sel_hi:[0,1]
    v_mad_u32_u16 v225, v224, 2, s85
    v_mad_u32_u16 v224, v224, 2, s85 op_sel:[1,0,0,0]
    v_mfma_f32_16x16x32_bf16 v[92:95], a[204:207], v[244:247], v[92:95]
    s_waitcnt lgkmcnt(12)
    ds_read_u16 v225, v225
    ds_read_u16_d16_hi v224, v224
    v_cvt_pkrtz_f16_f32 v226, v190, v191
    v_mfma_f32_16x16x32_bf16 v[52:55], a[252:255], v[232:235], v[52:55]
    v_pk_lshrrev_b16 v226, 3, v226 op_sel_hi:[0,1]
    v_mad_u32_u16 v227, v226, 2, s85
    v_mad_u32_u16 v226, v226, 2, s85 op_sel:[1,0,0,0]
    v_mfma_f32_16x16x32_bf16 v[60:63], a[252:255], v[236:239], v[60:63]
    s_waitcnt lgkmcnt(12)
    ds_read_u16 v227, v227
    ds_read_u16_d16_hi v226, v226
    v_cvt_pkrtz_f16_f32 v228, v192, v193
    v_mfma_f32_16x16x32_bf16 v[96:99], a[248:251], v[240:243], v[96:99]
    v_pk_lshrrev_b16 v228, 3, v228 op_sel_hi:[0,1]
    v_cvt_pkrtz_f16_f32 v230, v194, v195
    v_cvt_pkrtz_f16_f32 v248, v196, v197
    v_mfma_f32_16x16x32_bf16 v[104:107], a[248:251], v[244:247], v[104:107]
    s_waitcnt lgkmcnt(13)
    ds_read_b128 a[248:251], v23 offset:32768
    v_cvt_pkrtz_f16_f32 v250, v198, v199
    v_cvt_pkrtz_f16_f32 v252, v200, v201
    v_mfma_f32_16x16x32_bf16 v[64:67], a[232:235], v[232:235], v[64:67]
    v_cvt_pkrtz_f16_f32 v0, v202, v203
    v_cvt_pkrtz_f16_f32 v209, v204, v205
    v_cvt_pkrtz_f16_f32 v211, v206, v207
    v_mfma_f32_16x16x32_bf16 v[72:75], a[232:235], v[236:239], v[72:75]
    v_mad_u32_u16 v229, v228, 2, s85
    v_mad_u32_u16 v228, v228, 2, s85 op_sel:[1,0,0,0]
    v_pk_lshrrev_b16 v230, 3, v230 op_sel_hi:[0,1]
    v_mfma_f32_16x16x32_bf16 v[100:103], a[252:255], v[240:243], v[100:103]
    s_waitcnt lgkmcnt(12)
    ds_read_u16 v229, v229
    ds_read_u16_d16_hi v228, v228
    v_mad_u32_u16 v231, v230, 2, s85
    v_mfma_f32_16x16x32_bf16 v[108:111], a[252:255], v[244:247], v[108:111]
    s_waitcnt lgkmcnt(12)
    ds_read_b128 a[252:255], v23 offset:33792
    ds_read_u16 v231, v231
    v_mad_u32_u16 v230, v230, 2, s85 op_sel:[1,0,0,0]
    v_mfma_f32_16x16x32_bf16 v[68:71], a[236:239], v[232:235], v[68:71]
    s_waitcnt lgkmcnt(13)
    ds_read_u16_d16_hi v230, v230
    v_or_b32 v232, v213, v212
    v_or_b32 v233, v215, v214
    v_mfma_f32_16x16x32_bf16 v[76:79], a[236:239], v[236:239], v[76:79]
    s_waitcnt lgkmcnt(12)
    v_or_b32 v234, v217, v216
    v_or_b32 v235, v219, v218
    v_or_b32 v236, v221, v220
    v_mfma_f32_16x16x32_bf16 v[112:115], a[232:235], v[240:243], v[112:115]
    s_waitcnt lgkmcnt(8)
    v_or_b32 v237, v223, v222
    v_or_b32 v238, v225, v224
    v_pk_lshrrev_b16 v248, 3, v248 op_sel_hi:[0,1]
    v_mfma_f32_16x16x32_bf16 v[120:123], a[232:235], v[244:247], v[120:123]
    ds_read_b128 a[232:235], v23 offset:34816
    v_mad_u32_u16 v249, v248, 2, s85
    v_mad_u32_u16 v248, v248, 2, s85 op_sel:[1,0,0,0]
    v_mfma_f32_16x16x32_bf16 v[116:119], a[236:239], v[240:243], v[116:119]
    s_waitcnt lgkmcnt(7)
    ds_read_u16 v249, v249
    ds_read_u16_d16_hi v248, v248
    v_or_b32 v239, v227, v226
    v_mfma_f32_16x16x32_bf16 v[124:127], a[236:239], v[244:247], v[124:127]
    ds_read_b128 a[236:239], v23 offset:35840
    v_pk_lshrrev_b16 v250, 3, v250 op_sel_hi:[0,1]
    v_mad_u32_u16 v251, v250, 2, s85
    v_mfma_f32_16x16x32_f16 v[176:179], a[240:243], v[128:131], 0
    ds_read_u16 v251, v251
    v_mad_u32_u16 v250, v250, 2, s85 op_sel:[1,0,0,0]
    v_pk_lshrrev_b16 v252, 3, v252 op_sel_hi:[0,1]
    v_mfma_f32_16x16x32_f16 v[184:187], a[240:243], v[132:135], 0
    ds_read_u16_d16_hi v250, v250
    v_mad_u32_u16 v253, v252, 2, s85
    v_mad_u32_u16 v252, v252, 2, s85 op_sel:[1,0,0,0]
    v_mfma_f32_16x16x32_f16 v[180:183], a[244:247], v[128:131], 0
    ds_read_u16 v253, v253
    ds_read_u16_d16_hi v252, v252
    v_pk_lshrrev_b16 v0, 3, v0 op_sel_hi:[0,1]
    v_mfma_f32_16x16x32_f16 v[188:191], a[244:247], v[132:135], 0
    v_mad_u32_u16 v208, v0, 2, s85
    v_mad_u32_u16 v0, v0, 2, s85 op_sel:[1,0,0,0]
    v_pk_lshrrev_b16 v209, 3, v209 op_sel_hi:[0,1]
    v_mfma_f32_16x16x32_f16 v[192:195], a[240:243], v[152:155], 0
    s_waitcnt lgkmcnt(12)
    ds_read_u16 v208, v208
    ds_read_u16_d16_hi v0, v0
    v_mad_u32_u16 v210, v209, 2, s85
    v_mfma_f32_16x16x32_f16 v[200:203], a[240:243], v[156:159], 0
    s_waitcnt lgkmcnt(12)
    ds_read_u16 v210, v210
    ds_read_b128 a[240:243], v23 offset:26624
    v_mad_u32_u16 v209, v209, 2, s85 op_sel:[1,0,0,0]
    v_mfma_f32_16x16x32_f16 v[176:179], a[248:251], v[136:139], v[176:179]
    s_waitcnt lgkmcnt(13)
    ds_read_u16_d16_hi v209, v209
    v_pk_lshrrev_b16 v211, 3, v211 op_sel_hi:[0,1]
    v_mad_u32_u16 v212, v211, 2, s85
    v_mfma_f32_16x16x32_f16 v[184:187], a[248:251], v[140:143], v[184:187]
    s_waitcnt lgkmcnt(13)
    v_mad_u32_u16 v211, v211, 2, s85 op_sel:[1,0,0,0]
    v_or_b32 v240, v229, v228
    v_or_b32 v241, v231, v230
    v_mfma_f32_16x16x32_f16 v[196:199], a[244:247], v[152:155], 0
    ds_read_u16 v212, v212
    v_mfma_f32_16x16x32_f16 v[204:207], a[244:247], v[156:159], 0
    s_waitcnt lgkmcnt(11)
    ds_read_u16_d16_hi v211, v211
    v_or_b32 v242, v249, v248
    v_mfma_f32_16x16x32_f16 v[180:183], a[252:255], v[136:139], v[180:183]
    ds_read_b128 a[244:247], v23 offset:27648
    v_mfma_f32_16x16x32_f16 v[188:191], a[252:255], v[140:143], v[188:191]
    v_mfma_f32_16x16x32_f16 v[192:195], a[248:251], v[160:163], v[192:195]
    v_mfma_f32_16x16x32_f16 v[200:203], a[248:251], v[164:167], v[200:203]
    s_waitcnt lgkmcnt(10)
    ds_read_b128 a[248:251], v23 offset:28672
    v_or_b32 v243, v251, v250
    v_mfma_f32_16x16x32_f16 v[176:179], a[232:235], v[144:147], v[176:179]
    s_add_u32 m0, s56, 11456
    v_mfma_f32_16x16x32_f16 v[184:187], a[232:235], v[148:151], v[184:187]
    buffer_load_dwordx4 v6, s[20:23], 0 offen offset:64 lds
    v_mfma_f32_16x16x32_f16 v[196:199], a[252:255], v[160:163], v[196:199]
    s_waitcnt lgkmcnt(9)
    v_or_b32 v244, v253, v252
    v_mfma_f32_16x16x32_f16 v[204:207], a[252:255], v[164:167], v[204:207]
    ds_read_b128 a[252:255], v23 offset:29696
    v_mfma_f32_16x16x32_f16 v[180:183], a[236:239], v[144:147], v[180:183]
    v_cvt_pkrtz_f16_f32 v213, v176, v177
    v_pk_lshrrev_b16 v213, 3, v213 op_sel_hi:[0,1]
    v_mad_u32_u16 v214, v213, 2, s85
    v_mfma_f32_16x16x32_f16 v[188:191], a[236:239], v[148:151], v[188:191]
    s_waitcnt lgkmcnt(9)
    ds_read_u16 v214, v214
    v_mad_u32_u16 v213, v213, 2, s85 op_sel:[1,0,0,0]
    s_waitcnt lgkmcnt(9)
    v_or_b32 v245, v208, v0
    v_mfma_f32_16x16x32_f16 v[192:195], a[232:235], v[168:171], v[192:195]
    ds_read_u16_d16_hi v213, v213
    v_cvt_pkrtz_f16_f32 v215, v178, v179
    v_pk_lshrrev_b16 v215, 3, v215 op_sel_hi:[0,1]
    v_mfma_f32_16x16x32_f16 v[200:203], a[232:235], v[172:175], v[200:203]
    ds_read_b128 a[232:235], v24 offset:0
    v_mad_u32_u16 v216, v215, 2, s85
    v_mad_u32_u16 v215, v215, 2, s85 op_sel:[1,0,0,0]
    v_mfma_f32_16x16x32_f16 v[196:199], a[236:239], v[168:171], v[196:199]
    ds_read_u16 v216, v216
    ds_read_u16_d16_hi v215, v215
    v_cvt_pkrtz_f16_f32 v217, v180, v181
    v_mfma_f32_16x16x32_f16 v[204:207], a[236:239], v[172:175], v[204:207]
    s_waitcnt lgkmcnt(10)
    ds_read_b128 a[236:239], v24 offset:1024
    v_or_b32 v246, v210, v209
    v_pk_lshrrev_b16 v217, 3, v217 op_sel_hi:[0,1]
    v_mfma_f32_16x16x32_bf16 v[32:35], a[208:211], v[232:235], v[32:35]
    v_mad_u32_u16 v218, v217, 2, s85
    v_mad_u32_u16 v217, v217, 2, s85 op_sel:[1,0,0,0]
    v_cvt_pkrtz_f16_f32 v219, v182, v183
    v_mfma_f32_16x16x32_bf16 v[40:43], a[208:211], v[236:239], v[40:43]
    ds_read_u16 v218, v218
    ds_read_u16_d16_hi v217, v217
    v_pk_lshrrev_b16 v219, 3, v219 op_sel_hi:[0,1]
    v_mfma_f32_16x16x32_bf16 v[36:39], a[212:215], v[232:235], v[36:39]
    s_waitcnt lgkmcnt(11)
    v_or_b32 v247, v212, v211
    v_mad_u32_u16 v220, v219, 2, s85
    v_mad_u32_u16 v219, v219, 2, s85 op_sel:[1,0,0,0]
    v_mfma_f32_16x16x32_bf16 v[44:47], a[212:215], v[236:239], v[44:47]
    ds_read_u16 v220, v220
    ds_read_u16_d16_hi v219, v219
    v_cvt_pkrtz_f16_f32 v221, v184, v185
    v_mfma_f32_16x16x32_bf16 v[80:83], a[208:211], v[240:243], v[80:83]
    v_pk_lshrrev_b16 v221, 3, v221 op_sel_hi:[0,1]
    v_mad_u32_u16 v222, v221, 2, s85
    v_mad_u32_u16 v221, v221, 2, s85 op_sel:[1,0,0,0]
    v_mfma_f32_16x16x32_bf16 v[88:91], a[208:211], v[244:247], v[88:91]
    s_waitcnt lgkmcnt(12)
    ds_read_u16 v222, v222
    ds_read_u16_d16_hi v221, v221
    v_cvt_pkrtz_f16_f32 v223, v186, v187
    v_mfma_f32_16x16x32_bf16 v[48:51], a[240:243], v[232:235], v[48:51]
    v_pk_lshrrev_b16 v223, 3, v223 op_sel_hi:[0,1]
    v_mad_u32_u16 v224, v223, 2, s85
    v_mad_u32_u16 v223, v223, 2, s85 op_sel:[1,0,0,0]
    v_mfma_f32_16x16x32_bf16 v[56:59], a[240:243], v[236:239], v[56:59]
    s_waitcnt lgkmcnt(12)
    ds_read_u16 v224, v224
    ds_read_u16_d16_hi v223, v223
    v_cvt_pkrtz_f16_f32 v225, v188, v189
    v_mfma_f32_16x16x32_bf16 v[84:87], a[212:215], v[240:243], v[84:87]
    v_pk_lshrrev_b16 v225, 3, v225 op_sel_hi:[0,1]
    v_mad_u32_u16 v226, v225, 2, s85
    v_mad_u32_u16 v225, v225, 2, s85 op_sel:[1,0,0,0]
    v_mfma_f32_16x16x32_bf16 v[92:95], a[212:215], v[244:247], v[92:95]
    s_waitcnt lgkmcnt(12)
    ds_read_u16 v226, v226
    ds_read_u16_d16_hi v225, v225
    v_cvt_pkrtz_f16_f32 v227, v190, v191
    v_mfma_f32_16x16x32_bf16 v[52:55], a[244:247], v[232:235], v[52:55]
    v_pk_lshrrev_b16 v227, 3, v227 op_sel_hi:[0,1]
    v_mad_u32_u16 v228, v227, 2, s85
    v_mad_u32_u16 v227, v227, 2, s85 op_sel:[1,0,0,0]
    v_mfma_f32_16x16x32_bf16 v[60:63], a[244:247], v[236:239], v[60:63]
    s_waitcnt lgkmcnt(12)
    ds_read_u16 v228, v228
    ds_read_u16_d16_hi v227, v227
    v_cvt_pkrtz_f16_f32 v229, v192, v193
    v_mfma_f32_16x16x32_bf16 v[96:99], a[240:243], v[240:243], v[96:99]
    v_pk_lshrrev_b16 v229, 3, v229 op_sel_hi:[0,1]
    v_cvt_pkrtz_f16_f32 v231, v194, v195
    v_cvt_pkrtz_f16_f32 v249, v196, v197
    v_mfma_f32_16x16x32_bf16 v[104:107], a[240:243], v[244:247], v[104:107]
    s_waitcnt lgkmcnt(13)
    ds_read_b128 a[240:243], v24 offset:2048
    v_cvt_pkrtz_f16_f32 v251, v198, v199
    v_cvt_pkrtz_f16_f32 v253, v200, v201
    v_mfma_f32_16x16x32_bf16 v[64:67], a[248:251], v[232:235], v[64:67]
    v_cvt_pkrtz_f16_f32 v208, v202, v203
    v_cvt_pkrtz_f16_f32 v210, v204, v205
    v_cvt_pkrtz_f16_f32 v212, v206, v207
    v_mfma_f32_16x16x32_bf16 v[72:75], a[248:251], v[236:239], v[72:75]
    v_mad_u32_u16 v230, v229, 2, s85
    v_mad_u32_u16 v229, v229, 2, s85 op_sel:[1,0,0,0]
    v_pk_lshrrev_b16 v231, 3, v231 op_sel_hi:[0,1]
    v_mfma_f32_16x16x32_bf16 v[100:103], a[244:247], v[240:243], v[100:103]
    s_waitcnt lgkmcnt(12)
    ds_read_u16 v230, v230
    ds_read_u16_d16_hi v229, v229
    v_mad_u32_u16 v248, v231, 2, s85
    v_mfma_f32_16x16x32_bf16 v[108:111], a[244:247], v[244:247], v[108:111]
    s_waitcnt lgkmcnt(13)
    ds_read_b128 a[244:247], v24 offset:3072
    v_mad_u32_u16 v231, v231, 2, s85 op_sel:[1,0,0,0]
    v_pk_lshrrev_b16 v249, 3, v249 op_sel_hi:[0,1]
    v_mfma_f32_16x16x32_bf16 v[68:71], a[252:255], v[232:235], v[68:71]
    s_waitcnt lgkmcnt(13)
    ds_read_u16 v248, v248
    v_or_b32 v232, v214, v213
    v_or_b32 v233, v216, v215
    v_mfma_f32_16x16x32_bf16 v[76:79], a[252:255], v[236:239], v[76:79]
    s_waitcnt lgkmcnt(13)
    ds_read_u16_d16_hi v231, v231
    v_or_b32 v234, v218, v217
    v_or_b32 v235, v220, v219
    v_mfma_f32_16x16x32_bf16 v[112:115], a[248:251], v[240:243], v[112:115]
    s_waitcnt lgkmcnt(12)
    v_or_b32 v236, v222, v221
    v_mad_u32_u16 v250, v249, 2, s85
    v_mad_u32_u16 v249, v249, 2, s85 op_sel:[1,0,0,0]
    v_mfma_f32_16x16x32_bf16 v[120:123], a[248:251], v[244:247], v[120:123]
    ds_read_b128 a[248:251], v24 offset:4096
    v_pk_lshrrev_b16 v251, 3, v251 op_sel_hi:[0,1]
    v_mad_u32_u16 v252, v251, 2, s85
    v_mfma_f32_16x16x32_bf16 v[116:119], a[252:255], v[240:243], v[116:119]
    s_waitcnt lgkmcnt(11)
    ds_read_u16 v250, v250
    v_or_b32 v237, v224, v223
    v_mad_u32_u16 v251, v251, 2, s85 op_sel:[1,0,0,0]
    v_mfma_f32_16x16x32_bf16 v[124:127], a[252:255], v[244:247], v[124:127]
    v_pk_lshrrev_b16 v253, 3, v253 op_sel_hi:[0,1]
    v_mad_u32_u16 v0, v253, 2, s85
    v_mad_u32_u16 v253, v253, 2, s85 op_sel:[1,0,0,0]
    v_mfma_f32_16x16x32_f16 v[176:179], a[232:235], v[128:131], 0
    s_waitcnt lgkmcnt(11)
    ds_read_b128 a[252:255], v24 offset:5120
    v_pk_lshrrev_b16 v208, 3, v208 op_sel_hi:[0,1]
    s_waitcnt lgkmcnt(11)
    v_or_b32 v238, v226, v225
    v_mfma_f32_16x16x32_f16 v[184:187], a[232:235], v[132:135], 0
    ds_read_u16_d16_hi v249, v249
    v_mad_u32_u16 v209, v208, 2, s85
    v_mad_u32_u16 v208, v208, 2, s85 op_sel:[1,0,0,0]
    v_mfma_f32_16x16x32_f16 v[180:183], a[236:239], v[128:131], 0
    ds_read_u16 v252, v252
    v_pk_lshrrev_b16 v210, 3, v210 op_sel_hi:[0,1]
    v_mad_u32_u16 v211, v210, 2, s85
    v_mfma_f32_16x16x32_f16 v[188:191], a[236:239], v[132:135], 0
    s_waitcnt lgkmcnt(11)
    v_mad_u32_u16 v210, v210, 2, s85 op_sel:[1,0,0,0]
    v_or_b32 v239, v228, v227
    v_pk_lshrrev_b16 v212, 3, v212 op_sel_hi:[0,1]
    v_mfma_f32_16x16x32_f16 v[192:195], a[232:235], v[152:155], 0
    ds_read_u16_d16_hi v251, v251
    ds_read_u16 v0, v0
    v_mad_u32_u16 v213, v212, 2, s85
    v_mfma_f32_16x16x32_f16 v[200:203], a[232:235], v[156:159], 0
    s_waitcnt lgkmcnt(12)
    v_mad_u32_u16 v212, v212, 2, s85 op_sel:[1,0,0,0]
    v_mfma_f32_16x16x32_f16 v[176:179], a[240:243], v[136:139], v[176:179]
    ds_read_u16_d16_hi v253, v253
    v_mfma_f32_16x16x32_f16 v[184:187], a[240:243], v[140:143], v[184:187]
    s_waitcnt lgkmcnt(11)
    ds_read_u16 v209, v209
    v_or_b32 v240, v230, v229
    v_mfma_f32_16x16x32_f16 v[196:199], a[236:239], v[152:155], 0
    s_waitcnt lgkmcnt(11)
    ds_read_u16_d16_hi v208, v208
    v_mfma_f32_16x16x32_f16 v[204:207], a[236:239], v[156:159], 0
    s_add_u32 m0, s56, 12480
    v_mfma_f32_16x16x32_f16 v[180:183], a[244:247], v[136:139], v[180:183]
    ds_read_u16 v211, v211
    buffer_load_dword v7, s[20:23], 0 offen offset:64 lds
    v_mfma_f32_16x16x32_f16 v[188:191], a[244:247], v[140:143], v[188:191]
    s_waitcnt lgkmcnt(11)
    ds_read_u16_d16_hi v210, v210
    v_or_b32 v241, v248, v231
    v_mfma_f32_16x16x32_f16 v[192:195], a[240:243], v[160:163], v[192:195]
    s_add_u32 m0, s56, 0
    ds_read_u16 v213, v213
    buffer_load_dwordx4 v1, s[20:23], 0 offen offset:0 lds
    v_mfma_f32_16x16x32_f16 v[200:203], a[240:243], v[164:167], v[200:203]
    s_waitcnt lgkmcnt(12)
    v_mfma_f32_16x16x32_f16 v[176:179], a[248:251], v[144:147], v[176:179]
    ds_read_u16_d16_hi v212, v212
    ds_read_b128 a[232:235], v23 offset:36864
    v_mfma_f32_16x16x32_f16 v[184:187], a[248:251], v[148:151], v[184:187]
    v_mfma_f32_16x16x32_f16 v[196:199], a[244:247], v[160:163], v[196:199]
    s_waitcnt lgkmcnt(11)
    ds_read_b128 a[236:239], v23 offset:37888
    v_or_b32 v242, v250, v249
    v_mfma_f32_16x16x32_f16 v[204:207], a[244:247], v[164:167], v[204:207]
    v_cvt_pkrtz_f16_f32 v214, v176, v177
    v_pk_lshrrev_b16 v214, 3, v214 op_sel_hi:[0,1]
    v_mad_u32_u16 v215, v214, 2, s85
    v_mfma_f32_16x16x32_f16 v[180:183], a[252:255], v[144:147], v[180:183]
    ds_read_b128 a[240:243], v23 offset:38912
    v_mad_u32_u16 v214, v214, 2, s85 op_sel:[1,0,0,0]
    v_cvt_pkrtz_f16_f32 v216, v178, v179
    v_mfma_f32_16x16x32_f16 v[188:191], a[252:255], v[148:151], v[188:191]
    s_waitcnt lgkmcnt(11)
    ds_read_b128 a[244:247], v23 offset:39936
    v_or_b32 v243, v252, v251
    v_pk_lshrrev_b16 v216, 3, v216 op_sel_hi:[0,1]
    v_mfma_f32_16x16x32_f16 v[192:195], a[248:251], v[168:171], v[192:195]
    v_mad_u32_u16 v217, v216, 2, s85
    v_mad_u32_u16 v216, v216, 2, s85 op_sel:[1,0,0,0]
    v_cvt_pkrtz_f16_f32 v218, v180, v181
    v_mfma_f32_16x16x32_f16 v[200:203], a[248:251], v[172:175], v[200:203]
    s_waitcnt lgkmcnt(11)
    ds_read_b128 a[248:251], v24 offset:12288
    v_pk_lshrrev_b16 v218, 3, v218 op_sel_hi:[0,1]
    s_waitcnt lgkmcnt(11)
    v_or_b32 v244, v0, v253
    v_mfma_f32_16x16x32_f16 v[196:199], a[252:255], v[168:171], v[196:199]
    ds_read_u16 v215, v215
    v_mad_u32_u16 v219, v218, 2, s85
    v_mad_u32_u16 v218, v218, 2, s85 op_sel:[1,0,0,0]
    v_mfma_f32_16x16x32_f16 v[204:207], a[252:255], v[172:175], v[204:207]
    ds_read_b128 a[252:255], v24 offset:13312
    v_cvt_pkrtz_f16_f32 v220, v182, v183
    v_pk_lshrrev_b16 v220, 3, v220 op_sel_hi:[0,1]
    v_mfma_f32_16x16x32_bf16 v[32:35], a[216:219], v[232:235], v[32:35]
    s_waitcnt lgkmcnt(11)
    v_mad_u32_u16 v221, v220, 2, s85
    v_or_b32 v245, v209, v208
    v_mad_u32_u16 v220, v220, 2, s85 op_sel:[1,0,0,0]
    v_mfma_f32_16x16x32_bf16 v[40:43], a[216:219], v[236:239], v[40:43]
    ds_read_u16_d16_hi v214, v214
    v_cvt_pkrtz_f16_f32 v222, v184, v185
    v_pk_lshrrev_b16 v222, 3, v222 op_sel_hi:[0,1]
    v_mfma_f32_16x16x32_bf16 v[36:39], a[220:223], v[232:235], v[36:39]
    ds_read_u16 v217, v217
    v_mad_u32_u16 v223, v222, 2, s85
    v_mad_u32_u16 v222, v222, 2, s85 op_sel:[1,0,0,0]
    v_mfma_f32_16x16x32_bf16 v[44:47], a[220:223], v[236:239], v[44:47]
    s_waitcnt lgkmcnt(11)
    ds_read_u16_d16_hi v216, v216
    v_or_b32 v246, v211, v210
    v_cvt_pkrtz_f16_f32 v224, v186, v187
    v_mfma_f32_16x16x32_bf16 v[80:83], a[216:219], v[240:243], v[80:83]
    s_waitcnt lgkmcnt(11)
    v_pk_lshrrev_b16 v224, 3, v224 op_sel_hi:[0,1]
    v_mad_u32_u16 v225, v224, 2, s85
    v_mad_u32_u16 v224, v224, 2, s85 op_sel:[1,0,0,0]
    v_cvt_pkrtz_f16_f32 v228, v188, v189
    v_cvt_pkrtz_f16_f32 v231, v190, v191
    v_pk_fma_f16 v226, v228, v228, s53
    v_pk_fma_f16 v229, v231, v231, s53
    v_pk_mul_f16 v226, v226, v228 neg_lo:[1,0] neg_hi:[1,0]
    s_waitcnt lgkmcnt(10)
    v_or_b32 v247, v213, v212
    v_pk_mul_f16 v229, v229, v231 neg_lo:[1,0] neg_hi:[1,0]
    v_exp_f16 v227, v226
    v_mfma_f32_16x16x32_bf16 v[88:91], a[216:219], v[244:247], v[88:91]
    s_waitcnt lgkmcnt(9)
    ds_read_u16 v219, v219
    ds_read_u16_d16_hi v218, v218
    ds_read_u16 v221, v221
    ds_read_u16_d16_hi v220, v220
    v_mfma_f32_16x16x32_bf16 v[48:51], a[232:235], v[232:235], v[48:51]
    ds_read_u16 v223, v223
    v_exp_f16 v230, v229
    v_mfma_f32_16x16x32_bf16 v[56:59], a[232:235], v[236:239], v[56:59]
    s_waitcnt lgkmcnt(13)
    ds_read_u16_d16_hi v222, v222
    v_exp_f16_sdwa v227, v226 dst_sel:WORD_1 dst_unused:UNUSED_PRESERVE src0_sel:WORD_1
    v_mfma_f32_16x16x32_bf16 v[84:87], a[220:223], v[240:243], v[84:87]
    s_waitcnt lgkmcnt(13)
    ds_read_u16 v225, v225
    v_exp_f16_sdwa v230, v229 dst_sel:WORD_1 dst_unused:UNUSED_PRESERVE src0_sel:WORD_1
    v_mfma_f32_16x16x32_bf16 v[92:95], a[220:223], v[244:247], v[92:95]
    s_waitcnt lgkmcnt(13)
    ds_read_u16_d16_hi v224, v224
    v_pk_fma_f16 v227, v227, s86, s86
    v_pk_fma_f16 v230, v230, s86, s86
    v_mfma_f32_16x16x32_bf16 v[52:55], a[236:239], v[232:235], v[52:55]
    v_rcp_f16 v226, v227
    v_rcp_f16 v229, v230
    v_mfma_f32_16x16x32_bf16 v[60:63], a[236:239], v[236:239], v[60:63]
    v_rcp_f16_sdwa v226, v227 dst_sel:WORD_1 dst_unused:UNUSED_PRESERVE src0_sel:WORD_1
    v_rcp_f16_sdwa v229, v230 dst_sel:WORD_1 dst_unused:UNUSED_PRESERVE src0_sel:WORD_1
    v_mfma_f32_16x16x32_bf16 v[96:99], a[232:235], v[240:243], v[96:99]
    v_fma_mix_f32 v227, v226, v228, 0 op_sel_hi:[1,1,0]
    v_fma_mix_f32 v230, v229, v231, 0 op_sel_hi:[1,1,0]
    v_fma_mix_f32 v226, v226, v228, 0 op_sel:[1,1,0] op_sel_hi:[1,1,0]
    v_mfma_f32_16x16x32_bf16 v[104:107], a[232:235], v[244:247], v[104:107]
    s_waitcnt lgkmcnt(13)
    ds_read_b128 a[232:235], v24 offset:14336
    v_fma_mix_f32 v229, v229, v231, 0 op_sel:[1,1,0] op_sel_hi:[1,1,0]
    v_cvt_pkrtz_f16_f32 v248, v192, v193
    v_mfma_f32_16x16x32_bf16 v[64:67], a[240:243], v[232:235], v[64:67]
    v_pk_lshrrev_b16 v248, 3, v248 op_sel_hi:[0,1]
    v_cvt_pkrtz_f16_f32 v250, v194, v195
    v_cvt_pkrtz_f16_f32 v252, v196, v197
    v_mfma_f32_16x16x32_bf16 v[72:75], a[240:243], v[236:239], v[72:75]
    v_cvt_pkrtz_f16_f32 v0, v198, v199
    v_cvt_pkrtz_f16_f32 v209, v200, v201
    v_cvt_pkrtz_f16_f32 v211, v202, v203
    v_mfma_f32_16x16x32_bf16 v[100:103], a[236:239], v[240:243], v[100:103]
    v_mad_u32_u16 v249, v248, 2, s85
    v_mad_u32_u16 v248, v248, 2, s85 op_sel:[1,0,0,0]
    v_pk_lshrrev_b16 v250, 3, v250 op_sel_hi:[0,1]
    v_mfma_f32_16x16x32_bf16 v[108:111], a[236:239], v[244:247], v[108:111]
    s_waitcnt lgkmcnt(11)
    ds_read_b128 a[236:239], v24 offset:15360
    ds_read_u16 v249, v249
    ds_read_u16_d16_hi v248, v248
    v_mfma_f32_16x16x32_bf16 v[68:71], a[244:247], v[232:235], v[68:71]
    s_waitcnt lgkmcnt(10)
    v_or_b32 v232, v215, v214
    v_or_b32 v233, v217, v216
    v_or_b32 v234, v219, v218
    v_mfma_f32_16x16x32_bf16 v[76:79], a[244:247], v[236:239], v[76:79]
    s_waitcnt lgkmcnt(8)
    v_or_b32 v235, v221, v220
    v_cvt_pk_bf16_f32 v238, v227, v226
    v_cvt_pk_bf16_f32 v239, v230, v229
    v_mfma_f32_16x16x32_bf16 v[112:115], a[240:243], v[240:243], v[112:115]
    v_cvt_pkrtz_f16_f32 v215, v204, v205
    v_cvt_pkrtz_f16_f32 v218, v206, v207
    v_mad_u32_u16 v251, v250, 2, s85
    v_mfma_f32_16x16x32_bf16 v[120:123], a[240:243], v[244:247], v[120:123]
    s_waitcnt lgkmcnt(7)
    ds_read_b128 a[240:243], v24 offset:16384
    ds_read_u16 v251, v251
    s_waitcnt lgkmcnt(8)
    v_or_b32 v236, v223, v222
    v_mfma_f32_16x16x32_bf16 v[116:119], a[244:247], v[240:243], v[116:119]
    v_mad_u32_u16 v250, v250, 2, s85 op_sel:[1,0,0,0]
    v_pk_lshrrev_b16 v252, 3, v252 op_sel_hi:[0,1]
    v_mad_u32_u16 v253, v252, 2, s85
    v_mfma_f32_16x16x32_bf16 v[124:127], a[244:247], v[244:247], v[124:127]
    s_add_u32 m0, s56, 1024
    ds_read_b128 a[244:247], v24 offset:17408
    buffer_load_dwordx4 v2, s[20:23], 0 offen offset:0 lds
    ds_read_u16_d16_hi v250, v250
    ds_read_u16 v253, v253
    v_mfma_f32_16x16x32_f16 v[176:179], a[248:251], v[128:131], 0
    s_waitcnt lgkmcnt(9)
    v_or_b32 v237, v225, v224
    v_mad_u32_u16 v252, v252, 2, s85 op_sel:[1,0,0,0]
    v_pk_lshrrev_b16 v0, 3, v0 op_sel_hi:[0,1]
    v_mfma_f32_16x16x32_f16 v[184:187], a[248:251], v[132:135], 0
    ds_read_u16_d16_hi v252, v252
    v_mad_u32_u16 v208, v0, 2, s85
    v_mad_u32_u16 v0, v0, 2, s85 op_sel:[1,0,0,0]
    v_mfma_f32_16x16x32_f16 v[180:183], a[252:255], v[128:131], 0
    ds_read_u16 v208, v208
    ds_read_u16_d16_hi v0, v0
    v_pk_lshrrev_b16 v209, 3, v209 op_sel_hi:[0,1]
    v_mfma_f32_16x16x32_f16 v[188:191], a[252:255], v[132:135], 0
    v_mad_u32_u16 v210, v209, 2, s85
    v_mad_u32_u16 v209, v209, 2, s85 op_sel:[1,0,0,0]
    v_pk_lshrrev_b16 v211, 3, v211 op_sel_hi:[0,1]
    v_mfma_f32_16x16x32_f16 v[192:195], a[248:251], v[152:155], 0
    ds_read_u16 v210, v210
    ds_read_u16_d16_hi v209, v209
    v_mad_u32_u16 v212, v211, 2, s85
    v_mfma_f32_16x16x32_f16 v[200:203], a[248:251], v[156:159], 0
    s_waitcnt lgkmcnt(12)
    ds_read_u16 v212, v212
    ds_read_b128 a[248:251], v24 offset:6144
    v_mad_u32_u16 v211, v211, 2, s85 op_sel:[1,0,0,0]
    v_mfma_f32_16x16x32_f16 v[176:179], a[232:235], v[136:139], v[176:179]
    s_waitcnt lgkmcnt(13)
    ds_read_u16_d16_hi v211, v211
    v_pk_fma_f16 v213, v215, v215, s53
    v_pk_fma_f16 v216, v218, v218, s53
    v_mfma_f32_16x16x32_f16 v[184:187], a[232:235], v[140:143], v[184:187]
    v_pk_mul_f16 v213, v213, v215 neg_lo:[1,0] neg_hi:[1,0]
    v_pk_mul_f16 v216, v216, v218 neg_lo:[1,0] neg_hi:[1,0]
    v_exp_f16 v214, v213
    v_mfma_f32_16x16x32_f16 v[196:199], a[252:255], v[152:155], 0
    v_exp_f16 v217, v216
    v_exp_f16_sdwa v214, v213 dst_sel:WORD_1 dst_unused:UNUSED_PRESERVE src0_sel:WORD_1
    v_mfma_f32_16x16x32_f16 v[204:207], a[252:255], v[156:159], 0
    s_waitcnt lgkmcnt(13)
    ds_read_b128 a[252:255], v24 offset:7168
    v_exp_f16_sdwa v217, v216 dst_sel:WORD_1 dst_unused:UNUSED_PRESERVE src0_sel:WORD_1
    v_mfma_f32_16x16x32_f16 v[180:183], a[236:239], v[136:139], v[180:183]
    v_pk_fma_f16 v214, v214, s86, s86
    v_pk_fma_f16 v217, v217, s86, s86
    v_rcp_f16 v213, v214
    v_mfma_f32_16x16x32_f16 v[188:191], a[236:239], v[140:143], v[188:191]
    s_add_u32 m0, s56, 2048
    v_rcp_f16 v216, v217
    v_rcp_f16_sdwa v213, v214 dst_sel:WORD_1 dst_unused:UNUSED_PRESERVE src0_sel:WORD_1
    v_mfma_f32_16x16x32_f16 v[192:195], a[232:235], v[160:163], v[192:195]
    buffer_load_dwordx4 v3, s[20:23], 0 offen offset:0 lds
    v_mfma_f32_16x16x32_f16 v[200:203], a[232:235], v[164:167], v[200:203]
    s_waitcnt lgkmcnt(13)
    ds_read_b128 a[232:235], v24 offset:8192
    v_rcp_f16_sdwa v216, v217 dst_sel:WORD_1 dst_unused:UNUSED_PRESERVE src0_sel:WORD_1
    v_mfma_f32_16x16x32_f16 v[176:179], a[240:243], v[144:147], v[176:179]
    v_fma_mix_f32 v214, v213, v215, 0 op_sel_hi:[1,1,0]
    v_fma_mix_f32 v217, v216, v218, 0 op_sel_hi:[1,1,0]
    v_fma_mix_f32 v213, v213, v215, 0 op_sel:[1,1,0] op_sel_hi:[1,1,0]
    v_mfma_f32_16x16x32_f16 v[184:187], a[240:243], v[148:151], v[184:187]
    s_waitcnt lgkmcnt(11)
    v_fma_mix_f32 v216, v216, v218, 0 op_sel:[1,1,0] op_sel_hi:[1,1,0]
    v_or_b32 v240, v249, v248
    v_or_b32 v241, v251, v250
    v_mfma_f32_16x16x32_f16 v[196:199], a[236:239], v[160:163], v[196:199]
    s_waitcnt lgkmcnt(5)
    v_or_b32 v242, v253, v252
    v_or_b32 v243, v208, v0
    v_or_b32 v244, v210, v209
    v_mfma_f32_16x16x32_f16 v[204:207], a[236:239], v[164:167], v[204:207]
    ds_read_b128 a[236:239], v24 offset:9216
    v_cvt_pk_bf16_f32 v246, v214, v213
    v_cvt_pk_bf16_f32 v247, v217, v216
    v_mfma_f32_16x16x32_f16 v[180:183], a[244:247], v[144:147], v[180:183]
    v_cvt_pkrtz_f16_f32 v219, v176, v177
    v_pk_lshrrev_b16 v219, 3, v219 op_sel_hi:[0,1]
    v_mad_u32_u16 v220, v219, 2, s85
    v_mfma_f32_16x16x32_f16 v[188:191], a[244:247], v[148:151], v[188:191]
    s_waitcnt lgkmcnt(3)
    ds_read_u16 v220, v220
    v_or_b32 v245, v212, v211
    v_mad_u32_u16 v219, v219, 2, s85 op_sel:[1,0,0,0]
    v_mfma_f32_16x16x32_f16 v[192:195], a[240:243], v[168:171], v[192:195]
    ds_read_u16_d16_hi v219, v219
    v_cvt_pkrtz_f16_f32 v221, v178, v179
    v_pk_lshrrev_b16 v221, 3, v221 op_sel_hi:[0,1]
    v_mfma_f32_16x16x32_f16 v[200:203], a[240:243], v[172:175], v[200:203]
    ds_read_b128 a[240:243], v24 offset:10240
    v_mad_u32_u16 v222, v221, 2, s85
    v_mad_u32_u16 v221, v221, 2, s85 op_sel:[1,0,0,0]
    v_mfma_f32_16x16x32_f16 v[196:199], a[244:247], v[168:171], v[196:199]
    ds_read_u16 v222, v222
    ds_read_u16_d16_hi v221, v221
    v_cvt_pkrtz_f16_f32 v223, v180, v181
    v_mfma_f32_16x16x32_f16 v[204:207], a[244:247], v[172:175], v[204:207]
    ds_read_b128 a[244:247], v24 offset:11264
    v_pk_lshrrev_b16 v223, 3, v223 op_sel_hi:[0,1]
    v_mad_u32_u16 v224, v223, 2, s85
    v_mfma_f32_16x16x32_bf16 v[32:35], a[248:251], v[232:235], v[32:35]
    ds_read_u16 v224, v224
    v_mad_u32_u16 v223, v223, 2, s85 op_sel:[1,0,0,0]
    v_cvt_pkrtz_f16_f32 v225, v182, v183
    v_mfma_f32_16x16x32_bf16 v[40:43], a[248:251], v[236:239], v[40:43]
    s_waitcnt lgkmcnt(9)
    ds_read_u16_d16_hi v223, v223
    v_pk_lshrrev_b16 v225, 3, v225 op_sel_hi:[0,1]
    v_mad_u32_u16 v226, v225, 2, s85
    v_mfma_f32_16x16x32_bf16 v[36:39], a[252:255], v[232:235], v[36:39]
    ds_read_u16 v226, v226
    v_mad_u32_u16 v225, v225, 2, s85 op_sel:[1,0,0,0]
    v_cvt_pkrtz_f16_f32 v227, v184, v185
    v_mfma_f32_16x16x32_bf16 v[44:47], a[252:255], v[236:239], v[44:47]
    ds_read_u16_d16_hi v225, v225
    v_pk_lshrrev_b16 v227, 3, v227 op_sel_hi:[0,1]
    v_mad_u32_u16 v228, v227, 2, s85
    v_mfma_f32_16x16x32_bf16 v[80:83], a[248:251], v[240:243], v[80:83]
    ds_read_u16 v228, v228
    v_mad_u32_u16 v227, v227, 2, s85 op_sel:[1,0,0,0]
    v_cvt_pkrtz_f16_f32 v229, v186, v187
    v_mfma_f32_16x16x32_bf16 v[88:91], a[248:251], v[244:247], v[88:91]
    s_waitcnt lgkmcnt(12)
    ds_read_u16_d16_hi v227, v227
    ds_read_b128 a[248:251], v24 offset:24576
    v_pk_lshrrev_b16 v229, 3, v229 op_sel_hi:[0,1]
    v_mfma_f32_16x16x32_bf16 v[48:51], a[232:235], v[232:235], v[48:51]
    v_mad_u32_u16 v230, v229, 2, s85
    v_mad_u32_u16 v229, v229, 2, s85 op_sel:[1,0,0,0]
    v_cvt_pkrtz_f16_f32 v231, v188, v189
    v_mfma_f32_16x16x32_bf16 v[56:59], a[232:235], v[236:239], v[56:59]
    s_waitcnt lgkmcnt(12)
    ds_read_u16 v230, v230
    ds_read_u16_d16_hi v229, v229
    v_pk_lshrrev_b16 v231, 3, v231 op_sel_hi:[0,1]
    v_mfma_f32_16x16x32_bf16 v[84:87], a[252:255], v[240:243], v[84:87]
    v_mad_u32_u16 v248, v231, 2, s85
    v_mad_u32_u16 v231, v231, 2, s85 op_sel:[1,0,0,0]
    v_cvt_pkrtz_f16_f32 v249, v190, v191
    v_mfma_f32_16x16x32_bf16 v[92:95], a[252:255], v[244:247], v[92:95]
    s_waitcnt lgkmcnt(11)
    ds_read_u16 v248, v248
    ds_read_u16_d16_hi v231, v231
    ds_read_b128 a[252:255], v24 offset:25600
    v_mfma_f32_16x16x32_bf16 v[52:55], a[236:239], v[232:235], v[52:55]
    v_pk_lshrrev_b16 v249, 3, v249 op_sel_hi:[0,1]
    v_mad_u32_u16 v250, v249, 2, s85
    v_mad_u32_u16 v249, v249, 2, s85 op_sel:[1,0,0,0]
    v_mfma_f32_16x16x32_bf16 v[60:63], a[236:239], v[236:239], v[60:63]
    s_waitcnt lgkmcnt(12)
    ds_read_u16 v250, v250
    ds_read_u16_d16_hi v249, v249
    v_cvt_pkrtz_f16_f32 v251, v192, v193
    v_mfma_f32_16x16x32_bf16 v[96:99], a[232:235], v[240:243], v[96:99]
    v_pk_lshrrev_b16 v251, 3, v251 op_sel_hi:[0,1]
    v_cvt_pkrtz_f16_f32 v253, v194, v195
    v_cvt_pkrtz_f16_f32 v208, v196, v197
    v_mfma_f32_16x16x32_bf16 v[104:107], a[232:235], v[244:247], v[104:107]
    s_waitcnt lgkmcnt(13)
    ds_read_b128 a[232:235], v24 offset:26624
    v_cvt_pkrtz_f16_f32 v210, v198, v199
    v_cvt_pkrtz_f16_f32 v212, v200, v201
    v_mfma_f32_16x16x32_bf16 v[64:67], a[240:243], v[232:235], v[64:67]
    v_cvt_pkrtz_f16_f32 v214, v202, v203
    v_cvt_pkrtz_f16_f32 v216, v204, v205
    v_cvt_pkrtz_f16_f32 v218, v206, v207
    v_mfma_f32_16x16x32_bf16 v[72:75], a[240:243], v[236:239], v[72:75]
    v_mad_u32_u16 v252, v251, 2, s85
    v_mad_u32_u16 v251, v251, 2, s85 op_sel:[1,0,0,0]
    v_pk_lshrrev_b16 v253, 3, v253 op_sel_hi:[0,1]
    v_mfma_f32_16x16x32_bf16 v[100:103], a[236:239], v[240:243], v[100:103]
    s_waitcnt lgkmcnt(12)
    ds_read_u16 v252, v252
    ds_read_u16_d16_hi v251, v251
    v_mad_u32_u16 v0, v253, 2, s85
    v_mfma_f32_16x16x32_bf16 v[108:111], a[236:239], v[244:247], v[108:111]
    s_waitcnt lgkmcnt(12)
    ds_read_b128 a[236:239], v24 offset:27648
    ds_read_u16 v0, v0
    v_mad_u32_u16 v253, v253, 2, s85 op_sel:[1,0,0,0]
    v_mfma_f32_16x16x32_bf16 v[68:71], a[244:247], v[232:235], v[68:71]
    s_waitcnt lgkmcnt(13)
    ds_read_u16_d16_hi v253, v253
    v_or_b32 v232, v220, v219
    v_or_b32 v233, v222, v221
    v_mfma_f32_16x16x32_bf16 v[76:79], a[244:247], v[236:239], v[76:79]
    v_or_b32 v234, v224, v223
    v_or_b32 v235, v226, v225
    v_or_b32 v236, v228, v227
    v_mfma_f32_16x16x32_bf16 v[112:115], a[240:243], v[240:243], v[112:115]
    s_waitcnt lgkmcnt(9)
    v_or_b32 v237, v230, v229
    v_or_b32 v238, v248, v231
    v_pk_lshrrev_b16 v208, 3, v208 op_sel_hi:[0,1]
    v_mfma_f32_16x16x32_bf16 v[120:123], a[240:243], v[244:247], v[120:123]
    ds_read_b128 a[240:243], v24 offset:28672
    v_mad_u32_u16 v209, v208, 2, s85
    v_mad_u32_u16 v208, v208, 2, s85 op_sel:[1,0,0,0]
    v_mfma_f32_16x16x32_bf16 v[116:119], a[244:247], v[240:243], v[116:119]
    s_waitcnt lgkmcnt(7)
    ds_read_u16 v209, v209
    ds_read_u16_d16_hi v208, v208
    v_or_b32 v239, v250, v249
    v_mfma_f32_16x16x32_bf16 v[124:127], a[244:247], v[244:247], v[124:127]
    ds_read_b128 a[244:247], v24 offset:29696
    v_pk_lshrrev_b16 v210, 3, v210 op_sel_hi:[0,1]
    v_mad_u32_u16 v211, v210, 2, s85
    v_mfma_f32_16x16x32_f16 v[176:179], a[248:251], v[128:131], 0
    ds_read_u16 v211, v211
    v_mad_u32_u16 v210, v210, 2, s85 op_sel:[1,0,0,0]
    v_pk_lshrrev_b16 v212, 3, v212 op_sel_hi:[0,1]
    v_mfma_f32_16x16x32_f16 v[184:187], a[248:251], v[132:135], 0
    ds_read_u16_d16_hi v210, v210
    v_mad_u32_u16 v213, v212, 2, s85
    v_mad_u32_u16 v212, v212, 2, s85 op_sel:[1,0,0,0]
    v_mfma_f32_16x16x32_f16 v[180:183], a[252:255], v[128:131], 0
    ds_read_u16 v213, v213
    ds_read_u16_d16_hi v212, v212
    v_pk_lshrrev_b16 v214, 3, v214 op_sel_hi:[0,1]
    v_mfma_f32_16x16x32_f16 v[188:191], a[252:255], v[132:135], 0
    s_add_u32 m0, s56, 3072
    v_mad_u32_u16 v215, v214, 2, s85
    v_mad_u32_u16 v214, v214, 2, s85 op_sel:[1,0,0,0]
    v_pk_lshrrev_b16 v216, 3, v216 op_sel_hi:[0,1]
    v_mfma_f32_16x16x32_f16 v[192:195], a[248:251], v[152:155], 0
    s_waitcnt lgkmcnt(12)
    ds_read_u16 v215, v215
    ds_read_u16_d16_hi v214, v214
    buffer_load_dwordx4 v4, s[20:23], 0 offen offset:0 lds
    v_mfma_f32_16x16x32_f16 v[200:203], a[248:251], v[156:159], 0
    s_waitcnt lgkmcnt(13)
    ds_read_b128 a[248:251], v24 offset:18432
    v_mad_u32_u16 v217, v216, 2, s85
    v_mad_u32_u16 v216, v216, 2, s85 op_sel:[1,0,0,0]
    v_mfma_f32_16x16x32_f16 v[176:179], a[232:235], v[136:139], v[176:179]
    s_waitcnt lgkmcnt(12)
    ds_read_u16 v217, v217
    ds_read_u16_d16_hi v216, v216
    v_pk_lshrrev_b16 v218, 3, v218 op_sel_hi:[0,1]
    v_mfma_f32_16x16x32_f16 v[184:187], a[232:235], v[140:143], v[184:187]
    v_mad_u32_u16 v219, v218, 2, s85
    v_mad_u32_u16 v218, v218, 2, s85 op_sel:[1,0,0,0]
    v_or_b32 v240, v252, v251
    v_mfma_f32_16x16x32_f16 v[196:199], a[252:255], v[152:155], 0
    s_waitcnt lgkmcnt(12)
    ds_read_u16 v219, v219
    ds_read_u16_d16_hi v218, v218
    v_or_b32 v241, v0, v253
    v_mfma_f32_16x16x32_f16 v[204:207], a[252:255], v[156:159], 0
    s_waitcnt lgkmcnt(12)
    ds_read_b128 a[252:255], v24 offset:19456
    v_or_b32 v242, v209, v208
    v_mfma_f32_16x16x32_f16 v[180:183], a[236:239], v[136:139], v[180:183]
    v_mfma_f32_16x16x32_f16 v[188:191], a[236:239], v[140:143], v[188:191]
    v_mfma_f32_16x16x32_f16 v[192:195], a[232:235], v[160:163], v[192:195]
    s_waitcnt lgkmcnt(11)
    s_waitcnt lgkmcnt(10)
    v_or_b32 v243, v211, v210
    v_mfma_f32_16x16x32_f16 v[200:203], a[232:235], v[164:167], v[200:203]
    ds_read_b128 a[232:235], v24 offset:20480
    v_mfma_f32_16x16x32_f16 v[176:179], a[240:243], v[144:147], v[176:179]
    v_mfma_f32_16x16x32_f16 v[184:187], a[240:243], v[148:151], v[184:187]
    s_add_u32 m0, s56, 4096
    v_mfma_f32_16x16x32_f16 v[196:199], a[236:239], v[160:163], v[196:199]
    buffer_load_dwordx4 v5, s[20:23], 0 offen offset:0 lds
    v_mfma_f32_16x16x32_f16 v[204:207], a[236:239], v[164:167], v[204:207]
    s_waitcnt lgkmcnt(9)
    ds_read_b128 a[236:239], v24 offset:21504
    v_or_b32 v244, v213, v212
    v_mfma_f32_16x16x32_f16 v[180:183], a[244:247], v[144:147], v[180:183]
    v_cvt_pkrtz_f16_f32 v220, v176, v177
    v_pk_lshrrev_b16 v220, 3, v220 op_sel_hi:[0,1]
    v_mad_u32_u16 v221, v220, 2, s85
    v_mfma_f32_16x16x32_f16 v[188:191], a[244:247], v[148:151], v[188:191]
    s_waitcnt lgkmcnt(8)
    ds_read_u16 v221, v221
    v_or_b32 v245, v215, v214
    v_mad_u32_u16 v220, v220, 2, s85 op_sel:[1,0,0,0]
    v_mfma_f32_16x16x32_f16 v[192:195], a[240:243], v[168:171], v[192:195]
    ds_read_u16_d16_hi v220, v220
    v_cvt_pkrtz_f16_f32 v222, v178, v179
    v_pk_lshrrev_b16 v222, 3, v222 op_sel_hi:[0,1]
    v_mfma_f32_16x16x32_f16 v[200:203], a[240:243], v[172:175], v[200:203]
    ds_read_b128 a[240:243], v24 offset:22528
    v_mad_u32_u16 v223, v222, 2, s85
    v_mad_u32_u16 v222, v222, 2, s85 op_sel:[1,0,0,0]
    v_mfma_f32_16x16x32_f16 v[196:199], a[244:247], v[168:171], v[196:199]
    s_waitcnt lgkmcnt(8)
    ds_read_u16 v223, v223
    ds_read_u16_d16_hi v222, v222
    v_or_b32 v246, v217, v216
    v_mfma_f32_16x16x32_f16 v[204:207], a[244:247], v[172:175], v[204:207]
    ds_read_b128 a[244:247], v24 offset:23552
    v_cvt_pkrtz_f16_f32 v224, v180, v181
    v_pk_lshrrev_b16 v224, 3, v224 op_sel_hi:[0,1]
    v_mfma_f32_16x16x32_bf16 v[32:35], a[248:251], v[232:235], v[32:35]
    s_add_u32 m0, s56, 5120
    v_mad_u32_u16 v225, v224, 2, s85
    v_mad_u32_u16 v224, v224, 2, s85 op_sel:[1,0,0,0]
    v_cvt_pkrtz_f16_f32 v226, v182, v183
    v_mfma_f32_16x16x32_bf16 v[40:43], a[248:251], v[236:239], v[40:43]
    ds_read_u16 v225, v225
    ds_read_u16_d16_hi v224, v224
    buffer_load_dwordx4 v6, s[20:23], 0 offen offset:0 lds
    s_waitcnt lgkmcnt(10)
    v_mfma_f32_16x16x32_bf16 v[36:39], a[252:255], v[232:235], v[36:39]
    v_or_b32 v247, v219, v218
    v_pk_lshrrev_b16 v226, 3, v226 op_sel_hi:[0,1]
    v_mad_u32_u16 v227, v226, 2, s85
    v_mfma_f32_16x16x32_bf16 v[44:47], a[252:255], v[236:239], v[44:47]
    ds_read_u16 v227, v227
    v_mad_u32_u16 v226, v226, 2, s85 op_sel:[1,0,0,0]
    v_cvt_pkrtz_f16_f32 v228, v184, v185
    v_mfma_f32_16x16x32_bf16 v[80:83], a[248:251], v[240:243], v[80:83]
    ds_read_u16_d16_hi v226, v226
    v_pk_lshrrev_b16 v228, 3, v228 op_sel_hi:[0,1]
    v_mad_u32_u16 v229, v228, 2, s85
    v_mfma_f32_16x16x32_bf16 v[88:91], a[248:251], v[244:247], v[88:91]
    s_waitcnt lgkmcnt(11)
    ds_read_u16 v229, v229
    ds_read_b128 a[248:251], v24 offset:36864
    v_mad_u32_u16 v228, v228, 2, s85 op_sel:[1,0,0,0]
    v_mfma_f32_16x16x32_bf16 v[48:51], a[232:235], v[232:235], v[48:51]
    ds_read_u16_d16_hi v228, v228
    v_cvt_pkrtz_f16_f32 v230, v186, v187
    v_pk_lshrrev_b16 v230, 3, v230 op_sel_hi:[0,1]
    v_mfma_f32_16x16x32_bf16 v[56:59], a[232:235], v[236:239], v[56:59]
    v_mad_u32_u16 v231, v230, 2, s85
    v_mad_u32_u16 v230, v230, 2, s85 op_sel:[1,0,0,0]
    v_cvt_pkrtz_f16_f32 v248, v188, v189
    v_mfma_f32_16x16x32_bf16 v[84:87], a[252:255], v[240:243], v[84:87]
    s_waitcnt lgkmcnt(12)
    ds_read_u16 v231, v231
    ds_read_u16_d16_hi v230, v230
    v_pk_lshrrev_b16 v248, 3, v248 op_sel_hi:[0,1]
    v_mfma_f32_16x16x32_bf16 v[92:95], a[252:255], v[244:247], v[92:95]
    s_waitcnt lgkmcnt(13)
    ds_read_b128 a[252:255], v24 offset:37888
    v_mad_u32_u16 v249, v248, 2, s85
    v_mad_u32_u16 v248, v248, 2, s85 op_sel:[1,0,0,0]
    v_mfma_f32_16x16x32_bf16 v[52:55], a[236:239], v[232:235], v[52:55]
    s_waitcnt lgkmcnt(12)
    ds_read_u16 v249, v249
    ds_read_u16_d16_hi v248, v248
    v_cvt_pkrtz_f16_f32 v252, v190, v191
    v_mfma_f32_16x16x32_bf16 v[60:63], a[236:239], v[236:239], v[60:63]
    v_pk_fma_f16 v250, v252, v252, s53
    v_pk_mul_f16 v250, v250, v252 neg_lo:[1,0] neg_hi:[1,0]
    v_exp_f16 v251, v250
    v_mfma_f32_16x16x32_bf16 v[96:99], a[232:235], v[240:243], v[96:99]
    v_exp_f16_sdwa v251, v250 dst_sel:WORD_1 dst_unused:UNUSED_PRESERVE src0_sel:WORD_1
    v_cvt_pkrtz_f16_f32 v253, v192, v193
    v_mfma_f32_16x16x32_bf16 v[104:107], a[232:235], v[244:247], v[104:107]
    s_waitcnt lgkmcnt(13)
    ds_read_b128 a[232:235], v24 offset:38912
    v_pk_fma_f16 v251, v251, s86, s86
    v_rcp_f16 v250, v251
    v_mfma_f32_16x16x32_bf16 v[64:67], a[240:243], v[232:235], v[64:67]
    v_rcp_f16_sdwa v250, v251 dst_sel:WORD_1 dst_unused:UNUSED_PRESERVE src0_sel:WORD_1
    v_pk_lshrrev_b16 v253, 3, v253 op_sel_hi:[0,1]
    v_mfma_f32_16x16x32_bf16 v[72:75], a[240:243], v[236:239], v[72:75]
    v_fma_mix_f32 v251, v250, v252, 0 op_sel_hi:[1,1,0]
    v_fma_mix_f32 v250, v250, v252, 0 op_sel:[1,1,0] op_sel_hi:[1,1,0]
    v_cvt_pkrtz_f16_f32 v208, v194, v195
    v_mfma_f32_16x16x32_bf16 v[100:103], a[236:239], v[240:243], v[100:103]
    v_cvt_pkrtz_f16_f32 v210, v196, v197
    v_cvt_pkrtz_f16_f32 v212, v198, v199
    v_cvt_pkrtz_f16_f32 v214, v200, v201
    v_mfma_f32_16x16x32_bf16 v[108:111], a[236:239], v[244:247], v[108:111]
    s_waitcnt lgkmcnt(13)
    ds_read_b128 a[236:239], v24 offset:39936
    v_cvt_pkrtz_f16_f32 v216, v202, v203
    v_cvt_pkrtz_f16_f32 v218, v204, v205
    v_mfma_f32_16x16x32_bf16 v[68:71], a[244:247], v[232:235], v[68:71]
    s_waitcnt lgkmcnt(12)
    v_or_b32 v232, v221, v220
    v_or_b32 v233, v223, v222
    v_or_b32 v234, v225, v224
    v_mfma_f32_16x16x32_bf16 v[76:79], a[244:247], v[236:239], v[76:79]
    s_waitcnt lgkmcnt(7)
    v_or_b32 v235, v227, v226
    v_or_b32 v236, v229, v228
    v_cvt_pk_bf16_f32 v239, v251, v250
    v_mfma_f32_16x16x32_bf16 v[112:115], a[240:243], v[240:243], v[112:115]
    v_cvt_pkrtz_f16_f32 v220, v206, v207
    v_mad_u32_u16 v0, v253, 2, s85
    v_mad_u32_u16 v253, v253, 2, s85 op_sel:[1,0,0,0]
    v_mfma_f32_16x16x32_bf16 v[120:123], a[240:243], v[244:247], v[120:123]
    ds_read_b128 a[240:243], v24 offset:40960
    ds_read_u16 v0, v0
    ds_read_u16_d16_hi v253, v253
    v_mfma_f32_16x16x32_bf16 v[116:119], a[244:247], v[240:243], v[116:119]
    s_waitcnt lgkmcnt(8)
    v_or_b32 v237, v231, v230
    v_pk_lshrrev_b16 v208, 3, v208 op_sel_hi:[0,1]
    v_mad_u32_u16 v209, v208, 2, s85
    v_mfma_f32_16x16x32_bf16 v[124:127], a[244:247], v[244:247], v[124:127]
    ds_read_b128 a[244:247], v24 offset:41984
    ds_read_u16 v209, v209
    v_mad_u32_u16 v208, v208, 2, s85 op_sel:[1,0,0,0]
    v_mfma_f32_16x16x32_f16 v[176:179], a[248:251], v[128:131], 0
    ds_read_u16_d16_hi v208, v208
    v_pk_lshrrev_b16 v210, 3, v210 op_sel_hi:[0,1]
    v_mad_u32_u16 v211, v210, 2, s85
    v_mfma_f32_16x16x32_f16 v[184:187], a[248:251], v[132:135], 0
    s_waitcnt lgkmcnt(8)
    ds_read_u16 v211, v211
    v_or_b32 v238, v249, v248
    v_mad_u32_u16 v210, v210, 2, s85 op_sel:[1,0,0,0]
    v_mfma_f32_16x16x32_f16 v[180:183], a[252:255], v[128:131], 0
    ds_read_u16_d16_hi v210, v210
    v_pk_lshrrev_b16 v212, 3, v212 op_sel_hi:[0,1]
    v_mad_u32_u16 v213, v212, 2, s85
    v_mfma_f32_16x16x32_f16 v[188:191], a[252:255], v[132:135], 0
    s_add_u32 m0, s56, 6144
    ds_read_u16 v213, v213
    buffer_load_dword v7, s[20:23], 0 offen offset:0 lds
    v_mfma_f32_16x16x32_f16 v[192:195], a[248:251], v[152:155], 0
    v_mad_u32_u16 v212, v212, 2, s85 op_sel:[1,0,0,0]
    v_pk_lshrrev_b16 v214, 3, v214 op_sel_hi:[0,1]
    v_mad_u32_u16 v215, v214, 2, s85
    v_mfma_f32_16x16x32_f16 v[200:203], a[248:251], v[156:159], 0
    s_waitcnt lgkmcnt(10)
    ds_read_u16_d16_hi v212, v212
    ds_read_u16 v215, v215
    ds_read_b128 a[248:251], v24 offset:30720
    v_mfma_f32_16x16x32_f16 v[176:179], a[232:235], v[136:139], v[176:179]
    v_mad_u32_u16 v214, v214, 2, s85 op_sel:[1,0,0,0]
    v_pk_lshrrev_b16 v216, 3, v216 op_sel_hi:[0,1]
    v_mad_u32_u16 v217, v216, 2, s85
    v_mfma_f32_16x16x32_f16 v[184:187], a[232:235], v[140:143], v[184:187]
    s_waitcnt lgkmcnt(12)
    ds_read_u16_d16_hi v214, v214
    ds_read_u16 v217, v217
    v_mad_u32_u16 v216, v216, 2, s85 op_sel:[1,0,0,0]
    v_mfma_f32_16x16x32_f16 v[196:199], a[252:255], v[152:155], 0
    s_waitcnt lgkmcnt(13)
    ds_read_u16_d16_hi v216, v216
    v_pk_lshrrev_b16 v218, 3, v218 op_sel_hi:[0,1]
    v_mad_u32_u16 v219, v218, 2, s85
    v_mfma_f32_16x16x32_f16 v[204:207], a[252:255], v[156:159], 0
    s_waitcnt lgkmcnt(12)
    ds_read_u16 v219, v219
    ds_read_b128 a[252:255], v24 offset:31744
    v_mad_u32_u16 v218, v218, 2, s85 op_sel:[1,0,0,0]
    v_mfma_f32_16x16x32_f16 v[180:183], a[236:239], v[136:139], v[180:183]
    s_waitcnt lgkmcnt(13)
    ds_read_u16_d16_hi v218, v218
    v_pk_lshrrev_b16 v220, 3, v220 op_sel_hi:[0,1]
    v_mad_u32_u16 v221, v220, 2, s85
    v_mfma_f32_16x16x32_f16 v[188:191], a[236:239], v[140:143], v[188:191]
    s_waitcnt lgkmcnt(13)
    ds_read_u16 v221, v221
    v_mad_u32_u16 v220, v220, 2, s85 op_sel:[1,0,0,0]
    v_or_b32 v240, v0, v253
    v_mfma_f32_16x16x32_f16 v[192:195], a[232:235], v[160:163], v[192:195]
    s_waitcnt lgkmcnt(11)
    ds_read_u16_d16_hi v220, v220
    v_or_b32 v241, v209, v208
    v_or_b32 v242, v211, v210
    v_mfma_f32_16x16x32_f16 v[200:203], a[232:235], v[164:167], v[200:203]
    ds_read_b128 a[232:235], v24 offset:32768
    v_mfma_f32_16x16x32_f16 v[176:179], a[240:243], v[144:147], v[176:179]
    v_mfma_f32_16x16x32_f16 v[184:187], a[240:243], v[148:151], v[184:187]
    s_waitcnt lgkmcnt(11)
    v_or_b32 v243, v213, v212
    v_mfma_f32_16x16x32_f16 v[196:199], a[236:239], v[160:163], v[196:199]
    v_mfma_f32_16x16x32_f16 v[204:207], a[236:239], v[164:167], v[204:207]
    ds_read_b128 a[236:239], v24 offset:33792
    v_mfma_f32_16x16x32_f16 v[180:183], a[244:247], v[144:147], v[180:183]
    s_nop 0
    v_cvt_pkrtz_f16_f32 v222, v176, v177
    v_pk_lshrrev_b16 v222, 3, v222 op_sel_hi:[0,1]
    v_mfma_f32_16x16x32_f16 v[188:191], a[244:247], v[148:151], v[188:191]
    s_waitcnt lgkmcnt(9)
    v_or_b32 v244, v215, v214
    v_mad_u32_u16 v223, v222, 2, s85
    v_mad_u32_u16 v222, v222, 2, s85 op_sel:[1,0,0,0]
    v_mfma_f32_16x16x32_f16 v[192:195], a[240:243], v[168:171], v[192:195]
    ds_read_u16 v223, v223
    ds_read_u16_d16_hi v222, v222
    v_cvt_pkrtz_f16_f32 v224, v178, v179
    v_mfma_f32_16x16x32_f16 v[200:203], a[240:243], v[172:175], v[200:203]
    ds_read_b128 a[240:243], v24 offset:34816
    v_pk_lshrrev_b16 v224, 3, v224 op_sel_hi:[0,1]
    v_mad_u32_u16 v225, v224, 2, s85
    v_mfma_f32_16x16x32_f16 v[196:199], a[244:247], v[168:171], v[196:199]
    s_waitcnt lgkmcnt(10)
    ds_read_u16 v225, v225
    v_or_b32 v245, v217, v216
    v_mad_u32_u16 v224, v224, 2, s85 op_sel:[1,0,0,0]
    v_mfma_f32_16x16x32_f16 v[204:207], a[244:247], v[172:175], v[204:207]
    ds_read_b128 a[244:247], v24 offset:35840
    ds_read_u16_d16_hi v224, v224
    v_cvt_pkrtz_f16_f32 v226, v180, v181
    v_mfma_f32_16x16x32_bf16 v[32:35], a[248:251], v[232:235], v[32:35]
    v_pk_lshrrev_b16 v226, 3, v226 op_sel_hi:[0,1]
    v_mad_u32_u16 v227, v226, 2, s85
    v_mad_u32_u16 v226, v226, 2, s85 op_sel:[1,0,0,0]
    v_mfma_f32_16x16x32_bf16 v[40:43], a[248:251], v[236:239], v[40:43]
    s_waitcnt lgkmcnt(10)
    ds_read_u16 v227, v227
    ds_read_u16_d16_hi v226, v226
    v_or_b32 v246, v219, v218
    v_mfma_f32_16x16x32_bf16 v[36:39], a[252:255], v[232:235], v[36:39]
    v_cvt_pkrtz_f16_f32 v228, v182, v183
    v_pk_lshrrev_b16 v228, 3, v228 op_sel_hi:[0,1]
    v_mad_u32_u16 v229, v228, 2, s85
    v_mfma_f32_16x16x32_bf16 v[44:47], a[252:255], v[236:239], v[44:47]
    ds_read_u16 v229, v229
    v_mad_u32_u16 v228, v228, 2, s85 op_sel:[1,0,0,0]
    v_cvt_pkrtz_f16_f32 v230, v184, v185
    v_mfma_f32_16x16x32_bf16 v[80:83], a[248:251], v[240:243], v[80:83]
    s_waitcnt lgkmcnt(11)
    ds_read_u16_d16_hi v228, v228
    v_or_b32 v247, v221, v220
    v_pk_lshrrev_b16 v230, 3, v230 op_sel_hi:[0,1]
    v_mad_u32_u16 v231, v230, 2, s85
    v_mfma_f32_16x16x32_bf16 v[88:91], a[248:251], v[244:247], v[88:91]
    s_waitcnt lgkmcnt(11)
    ds_read_u16 v231, v231
    ds_read_b128 a[248:251], v24 offset:43008
    v_mad_u32_u16 v230, v230, 2, s85 op_sel:[1,0,0,0]
    v_mfma_f32_16x16x32_bf16 v[48:51], a[232:235], v[232:235], v[48:51]
    v_cvt_pkrtz_f16_f32 v248, v186, v187
    v_pk_lshrrev_b16 v248, 3, v248 op_sel_hi:[0,1]
    v_mad_u32_u16 v249, v248, 2, s85
    v_mfma_f32_16x16x32_bf16 v[56:59], a[232:235], v[236:239], v[56:59]
    ds_read_u16_d16_hi v230, v230
    v_mad_u32_u16 v248, v248, 2, s85 op_sel:[1,0,0,0]
    v_cvt_pkrtz_f16_f32 v250, v188, v189
    v_mfma_f32_16x16x32_bf16 v[84:87], a[252:255], v[240:243], v[84:87]
    s_waitcnt lgkmcnt(13)
    ds_read_u16 v249, v249
    v_pk_lshrrev_b16 v250, 3, v250 op_sel_hi:[0,1]
    v_mad_u32_u16 v251, v250, 2, s85
    v_mfma_f32_16x16x32_bf16 v[92:95], a[252:255], v[244:247], v[92:95]
    s_waitcnt lgkmcnt(13)
    ds_read_u16_d16_hi v248, v248
    v_mad_u32_u16 v250, v250, 2, s85 op_sel:[1,0,0,0]
    v_cvt_pkrtz_f16_f32 v252, v190, v191
    v_mfma_f32_16x16x32_bf16 v[52:55], a[236:239], v[232:235], v[52:55]
    s_waitcnt lgkmcnt(13)
    ds_read_u16 v251, v251
    v_pk_lshrrev_b16 v252, 3, v252 op_sel_hi:[0,1]
    v_mad_u32_u16 v253, v252, 2, s85
    v_mfma_f32_16x16x32_bf16 v[60:63], a[236:239], v[236:239], v[60:63]
    s_waitcnt lgkmcnt(13)
    ds_read_u16_d16_hi v250, v250
    v_mad_u32_u16 v252, v252, 2, s85 op_sel:[1,0,0,0]
    v_cvt_pkrtz_f16_f32 v0, v192, v193
    v_mfma_f32_16x16x32_bf16 v[96:99], a[232:235], v[240:243], v[96:99]
    v_pk_lshrrev_b16 v0, 3, v0 op_sel_hi:[0,1]
    v_cvt_pkrtz_f16_f32 v209, v194, v195
    v_cvt_pkrtz_f16_f32 v211, v196, v197
    v_mfma_f32_16x16x32_bf16 v[104:107], a[232:235], v[244:247], v[104:107]
    s_waitcnt lgkmcnt(13)
    ds_read_u16 v253, v253
    buffer_load_dword v254, v31, s[20:23], 0 offen
    v_cvt_pkrtz_f16_f32 v213, v198, v199
    v_mfma_f32_16x16x32_bf16 v[64:67], a[240:243], v[232:235], v[64:67]
    s_waitcnt lgkmcnt(13)
    ds_read_u16_d16_hi v252, v252
    v_cvt_pkrtz_f16_f32 v215, v200, v201
    v_cvt_pkrtz_f16_f32 v217, v202, v203
    v_mfma_f32_16x16x32_bf16 v[72:75], a[240:243], v[236:239], v[72:75]
    s_waitcnt lgkmcnt(13)
    ds_read_b128 a[252:255], v24 offset:44032
    v_cvt_pkrtz_f16_f32 v219, v204, v205
    v_cvt_pkrtz_f16_f32 v221, v206, v207
    v_mfma_f32_16x16x32_bf16 v[100:103], a[236:239], v[240:243], v[100:103]
    v_mad_u32_u16 v208, v0, 2, s85
    v_mad_u32_u16 v0, v0, 2, s85 op_sel:[1,0,0,0]
    v_pk_lshrrev_b16 v209, 3, v209 op_sel_hi:[0,1]
    v_mfma_f32_16x16x32_bf16 v[108:111], a[236:239], v[244:247], v[108:111]
    s_waitcnt lgkmcnt(13)
    ds_read_b128 a[232:235], v24 offset:45056
    v_mad_u32_u16 v210, v209, 2, s85
    v_mad_u32_u16 v209, v209, 2, s85 op_sel:[1,0,0,0]
    v_mfma_f32_16x16x32_bf16 v[68:71], a[244:247], v[232:235], v[68:71]
    s_waitcnt lgkmcnt(13)
    ds_read_b128 a[236:239], v24 offset:46080
    v_or_b32 v232, v223, v222
    v_or_b32 v233, v225, v224
    v_mfma_f32_16x16x32_bf16 v[76:79], a[244:247], v[236:239], v[76:79]
    s_waitcnt lgkmcnt(12)
    ds_read_u16 v208, v208
    v_or_b32 v234, v227, v226
    v_or_b32 v235, v229, v228
    v_mfma_f32_16x16x32_bf16 v[112:115], a[240:243], v[240:243], v[112:115]
    ds_read_u16_d16_hi v0, v0
    v_pk_lshrrev_b16 v211, 3, v211 op_sel_hi:[0,1]
    v_mad_u32_u16 v212, v211, 2, s85
    v_mfma_f32_16x16x32_bf16 v[120:123], a[240:243], v[244:247], v[120:123]
    s_waitcnt lgkmcnt(11)
    ds_read_b128 a[240:243], v24 offset:47104
    v_or_b32 v236, v231, v230
    v_mad_u32_u16 v211, v211, 2, s85 op_sel:[1,0,0,0]
    v_mfma_f32_16x16x32_bf16 v[116:119], a[244:247], v[240:243], v[116:119]
    v_pk_lshrrev_b16 v213, 3, v213 op_sel_hi:[0,1]
    v_mad_u32_u16 v214, v213, 2, s85
    v_mad_u32_u16 v213, v213, 2, s85 op_sel:[1,0,0,0]
    v_mfma_f32_16x16x32_bf16 v[124:127], a[244:247], v[244:247], v[124:127]
    ds_read_b128 a[244:247], v24 offset:48128
    v_pk_lshrrev_b16 v215, 3, v215 op_sel_hi:[0,1]
    v_mad_u32_u16 v216, v215, 2, s85
    v_mfma_f32_16x16x32_f16 v[176:179], a[0:3], v[128:131], 0
    s_waitcnt lgkmcnt(11)
    ds_read_u16 v210, v210
    v_or_b32 v237, v249, v248
    v_mad_u32_u16 v215, v215, 2, s85 op_sel:[1,0,0,0]
    v_mfma_f32_16x16x32_bf16 v[32:35], a[248:251], v[232:235], v[32:35]
    v_pk_lshrrev_b16 v217, 3, v217 op_sel_hi:[0,1]
    v_mad_u32_u16 v218, v217, 2, s85
    v_mad_u32_u16 v217, v217, 2, s85 op_sel:[1,0,0,0]
    v_mfma_f32_16x16x32_f16 v[180:183], a[4:7], v[128:131], 0
    s_waitcnt lgkmcnt(11)
    ds_read_u16_d16_hi v209, v209
    v_pk_lshrrev_b16 v219, 3, v219 op_sel_hi:[0,1]
    s_waitcnt lgkmcnt(11)
    v_or_b32 v238, v251, v250
    v_mad_u32_u16 v220, v219, 2, s85
    v_mad_u32_u16 v219, v219, 2, s85 op_sel:[1,0,0,0]
    v_pk_lshrrev_b16 v221, 3, v221 op_sel_hi:[0,1]
    v_mad_u32_u16 v222, v221, 2, s85
    v_mad_u32_u16 v221, v221, 2, s85 op_sel:[1,0,0,0]
    ds_read_u16 v212, v212
    ds_read_u16_d16_hi v211, v211
    s_waitcnt lgkmcnt(11)
    v_or_b32 v239, v253, v252
    s_waitcnt lgkmcnt(10)
    v_mfma_f32_16x16x32_bf16 v[36:39], a[252:255], v[232:235], v[36:39]
    ds_read_u16 v214, v214
    ds_read_u16_d16_hi v213, v213
    ds_read_u16 v216, v216
    v_mfma_f32_16x16x32_f16 v[176:179], a[8:11], v[136:139], v[176:179]
    s_waitcnt lgkmcnt(12)
    v_mfma_f32_16x16x32_bf16 v[48:51], a[232:235], v[232:235], v[48:51]
    ds_read_u16_d16_hi v215, v215
    v_mfma_f32_16x16x32_f16 v[180:183], a[12:15], v[136:139], v[180:183]
    s_waitcnt lgkmcnt(12)
    ds_read_u16 v218, v218
    v_mfma_f32_16x16x32_bf16 v[52:55], a[236:239], v[232:235], v[52:55]
    v_mfma_f32_16x16x32_f16 v[176:179], a[16:19], v[144:147], v[176:179]
    s_waitcnt lgkmcnt(11)
    ds_read_u16_d16_hi v217, v217
    v_or_b32 v240, v208, v0
    s_waitcnt lgkmcnt(11)
    v_mfma_f32_16x16x32_bf16 v[64:67], a[240:243], v[232:235], v[64:67]
    ds_read_u16 v220, v220
    v_mfma_f32_16x16x32_f16 v[180:183], a[20:23], v[144:147], v[180:183]
    s_waitcnt lgkmcnt(11)
    ds_read_u16_d16_hi v219, v219
    v_mfma_f32_16x16x32_bf16 v[68:71], a[244:247], v[232:235], v[68:71]
    v_cvt_pkrtz_f16_f32 v223, v176, v177
    v_pk_lshrrev_b16 v223, 3, v223 op_sel_hi:[0,1]
    v_mad_u32_u16 v224, v223, 2, s85
    v_mfma_f32_16x16x32_f16 v[184:187], a[0:3], v[132:135], 0
    ds_read_u16 v222, v222
    v_mad_u32_u16 v223, v223, 2, s85 op_sel:[1,0,0,0]
    v_cvt_pkrtz_f16_f32 v225, v178, v179
    v_mfma_f32_16x16x32_bf16 v[40:43], a[248:251], v[236:239], v[40:43]
    s_waitcnt lgkmcnt(11)
    ds_read_u16_d16_hi v221, v221
    v_or_b32 v241, v210, v209
    v_pk_lshrrev_b16 v225, 3, v225 op_sel_hi:[0,1]
    v_mfma_f32_16x16x32_f16 v[188:191], a[4:7], v[132:135], 0
    ds_read_u16 v224, v224
    v_mad_u32_u16 v226, v225, 2, s85
    v_mad_u32_u16 v225, v225, 2, s85 op_sel:[1,0,0,0]
    v_mfma_f32_16x16x32_bf16 v[44:47], a[252:255], v[236:239], v[44:47]
    s_waitcnt lgkmcnt(11)
    v_cvt_pkrtz_f16_f32 v227, v180, v181
    v_or_b32 v242, v212, v211
    v_pk_lshrrev_b16 v227, 3, v227 op_sel_hi:[0,1]
    v_mfma_f32_16x16x32_f16 v[184:187], a[8:11], v[140:143], v[184:187]
    ds_read_u16_d16_hi v223, v223
    v_mad_u32_u16 v228, v227, 2, s85
    v_mad_u32_u16 v227, v227, 2, s85 op_sel:[1,0,0,0]
    v_mfma_f32_16x16x32_bf16 v[56:59], a[232:235], v[236:239], v[56:59]
    ds_read_u16 v226, v226
    v_cvt_pkrtz_f16_f32 v229, v182, v183
    v_pk_lshrrev_b16 v229, 3, v229 op_sel_hi:[0,1]
    v_mfma_f32_16x16x32_f16 v[188:191], a[12:15], v[140:143], v[188:191]
    s_waitcnt lgkmcnt(11)
    ds_read_u16_d16_hi v225, v225
    v_or_b32 v243, v214, v213
    v_mad_u32_u16 v230, v229, 2, s85
    v_mfma_f32_16x16x32_bf16 v[60:63], a[236:239], v[236:239], v[60:63]
    v_mad_u32_u16 v229, v229, 2, s85 op_sel:[1,0,0,0]
    v_mfma_f32_16x16x32_f16 v[184:187], a[16:19], v[148:151], v[184:187]
    ds_read_u16 v228, v228
    v_mfma_f32_16x16x32_f16 v[188:191], a[20:23], v[148:151], v[188:191]
    s_waitcnt lgkmcnt(11)
    ds_read_u16_d16_hi v227, v227
    v_or_b32 v244, v216, v215
    v_mfma_f32_16x16x32_bf16 v[72:75], a[240:243], v[236:239], v[72:75]
    v_mfma_f32_16x16x32_bf16 v[76:79], a[244:247], v[236:239], v[76:79]
    ds_read_u16 v230, v230
    v_mfma_f32_16x16x32_f16 v[176:179], a[48:51], v[128:131], 0
    s_waitcnt lgkmcnt(12)
    v_cvt_pkrtz_f16_f32 v231, v184, v185
    v_pk_lshrrev_b16 v231, 3, v231 op_sel_hi:[0,1]
    s_waitcnt lgkmcnt(11)
    v_or_b32 v245, v218, v217
    v_mfma_f32_16x16x32_bf16 v[80:83], a[248:251], v[240:243], v[80:83]
    ds_read_u16_d16_hi v229, v229
    v_mad_u32_u16 v248, v231, 2, s85
    v_mad_u32_u16 v231, v231, 2, s85 op_sel:[1,0,0,0]
    v_mfma_f32_16x16x32_f16 v[180:183], a[52:55], v[128:131], 0
    ds_read_u16 v248, v248
    v_cvt_pkrtz_f16_f32 v249, v186, v187
    v_pk_lshrrev_b16 v249, 3, v249 op_sel_hi:[0,1]
    v_mfma_f32_16x16x32_bf16 v[84:87], a[252:255], v[240:243], v[84:87]
    s_waitcnt lgkmcnt(11)
    ds_read_u16_d16_hi v231, v231
    v_or_b32 v246, v220, v219
    v_mad_u32_u16 v250, v249, 2, s85
    v_mfma_f32_16x16x32_f16 v[176:179], a[56:59], v[136:139], v[176:179]
    v_mad_u32_u16 v249, v249, 2, s85 op_sel:[1,0,0,0]
    v_cvt_pkrtz_f16_f32 v251, v188, v189
    v_pk_lshrrev_b16 v251, 3, v251 op_sel_hi:[0,1]
    v_mfma_f32_16x16x32_bf16 v[96:99], a[232:235], v[240:243], v[96:99]
    ds_read_u16 v250, v250
    v_mad_u32_u16 v252, v251, 2, s85
    v_mad_u32_u16 v251, v251, 2, s85 op_sel:[1,0,0,0]
    v_mfma_f32_16x16x32_f16 v[180:183], a[60:63], v[136:139], v[180:183]
    s_waitcnt lgkmcnt(11)
    ds_read_u16_d16_hi v249, v249
    v_or_b32 v247, v222, v221
    v_cvt_pkrtz_f16_f32 v253, v190, v191
    v_mfma_f32_16x16x32_bf16 v[100:103], a[236:239], v[240:243], v[100:103]
    v_pk_lshrrev_b16 v253, 3, v253 op_sel_hi:[0,1]
    v_mad_u32_u16 v0, v253, 2, s85
    v_mad_u32_u16 v253, v253, 2, s85 op_sel:[1,0,0,0]
    v_mfma_f32_16x16x32_f16 v[176:179], a[64:67], v[144:147], v[176:179]
    ds_read_u16 v252, v252
    v_mfma_f32_16x16x32_bf16 v[112:115], a[240:243], v[240:243], v[112:115]
    s_waitcnt lgkmcnt(11)
    ds_read_u16_d16_hi v251, v251
    v_or_b32 v232, v224, v223
    v_mfma_f32_16x16x32_f16 v[180:183], a[68:71], v[144:147], v[180:183]
    v_mfma_f32_16x16x32_bf16 v[116:119], a[244:247], v[240:243], v[116:119]
    ds_read_u16 v0, v0
    v_mfma_f32_16x16x32_f16 v[184:187], a[48:51], v[132:135], 0
    s_waitcnt lgkmcnt(11)
    ds_read_u16_d16_hi v253, v253
    v_or_b32 v233, v226, v225
    v_cvt_pkrtz_f16_f32 v208, v176, v177
    v_mfma_f32_16x16x32_bf16 v[88:91], a[248:251], v[244:247], v[88:91]
    v_pk_lshrrev_b16 v208, 3, v208 op_sel_hi:[0,1]
    v_mad_u32_u16 v209, v208, 2, s85
    v_mad_u32_u16 v208, v208, 2, s85 op_sel:[1,0,0,0]
    v_mfma_f32_16x16x32_f16 v[188:191], a[52:55], v[132:135], 0
    ds_read_u16 v209, v209
    v_cvt_pkrtz_f16_f32 v210, v178, v179
    v_pk_lshrrev_b16 v210, 3, v210 op_sel_hi:[0,1]
    v_mfma_f32_16x16x32_bf16 v[92:95], a[252:255], v[244:247], v[92:95]
    s_waitcnt lgkmcnt(11)
    ds_read_u16_d16_hi v208, v208
    v_or_b32 v234, v228, v227
    v_mad_u32_u16 v211, v210, 2, s85
    v_mfma_f32_16x16x32_f16 v[184:187], a[56:59], v[140:143], v[184:187]
    ds_read_u16 v211, v211
    v_mad_u32_u16 v210, v210, 2, s85 op_sel:[1,0,0,0]
    v_cvt_pkrtz_f16_f32 v212, v180, v181
    v_mfma_f32_16x16x32_bf16 v[104:107], a[232:235], v[244:247], v[104:107]
    s_waitcnt lgkmcnt(12)
    v_pk_lshrrev_b16 v212, 3, v212 op_sel_hi:[0,1]
    v_mad_u32_u16 v213, v212, 2, s85
    s_waitcnt lgkmcnt(11)
    v_or_b32 v235, v230, v229
    v_mfma_f32_16x16x32_f16 v[188:191], a[60:63], v[140:143], v[188:191]
    ds_read_u16_d16_hi v210, v210
    v_mad_u32_u16 v212, v212, 2, s85 op_sel:[1,0,0,0]
    v_cvt_pkrtz_f16_f32 v214, v182, v183
    v_mfma_f32_16x16x32_bf16 v[108:111], a[236:239], v[244:247], v[108:111]
    ds_read_u16 v213, v213
    v_pk_lshrrev_b16 v214, 3, v214 op_sel_hi:[0,1]
    v_mad_u32_u16 v215, v214, 2, s85
    v_mfma_f32_16x16x32_f16 v[184:187], a[64:67], v[148:151], v[184:187]
    s_waitcnt lgkmcnt(11)
    ds_read_u16_d16_hi v212, v212
    v_or_b32 v236, v248, v231
    v_mad_u32_u16 v214, v214, 2, s85 op_sel:[1,0,0,0]
    v_mfma_f32_16x16x32_f16 v[188:191], a[68:71], v[148:151], v[188:191]
    v_mfma_f32_16x16x32_bf16 v[120:123], a[240:243], v[244:247], v[120:123]
    ds_read_u16 v215, v215
    v_mfma_f32_16x16x32_bf16 v[124:127], a[244:247], v[244:247], v[124:127]
    s_waitcnt lgkmcnt(11)
    v_cvt_pkrtz_f16_f32 v216, v184, v185
    v_or_b32 v237, v250, v249
    v_pk_lshrrev_b16 v216, 3, v216 op_sel_hi:[0,1]
    v_mfma_f32_16x16x32_f16 v[176:179], a[96:99], v[128:131], 0
    ds_read_u16_d16_hi v214, v214
    v_mad_u32_u16 v217, v216, 2, s85
    v_mad_u32_u16 v216, v216, 2, s85 op_sel:[1,0,0,0]
    v_mfma_f32_16x16x32_bf16 v[32:35], a[24:27], v[232:235], v[32:35]
    ds_read_u16 v217, v217
    v_cvt_pkrtz_f16_f32 v218, v186, v187
    v_pk_lshrrev_b16 v218, 3, v218 op_sel_hi:[0,1]
    v_mfma_f32_16x16x32_f16 v[180:183], a[100:103], v[128:131], 0
    s_waitcnt lgkmcnt(11)
    ds_read_u16_d16_hi v216, v216
    v_or_b32 v238, v252, v251
    v_mad_u32_u16 v219, v218, 2, s85
    v_mfma_f32_16x16x32_bf16 v[36:39], a[28:31], v[232:235], v[36:39]
    v_mad_u32_u16 v218, v218, 2, s85 op_sel:[1,0,0,0]
    v_cvt_pkrtz_f16_f32 v220, v188, v189
    v_pk_lshrrev_b16 v220, 3, v220 op_sel_hi:[0,1]
    v_mfma_f32_16x16x32_f16 v[176:179], a[104:107], v[136:139], v[176:179]
    ds_read_u16 v219, v219
    v_mad_u32_u16 v221, v220, 2, s85
    v_mad_u32_u16 v220, v220, 2, s85 op_sel:[1,0,0,0]
    v_mfma_f32_16x16x32_bf16 v[48:51], a[32:35], v[232:235], v[48:51]
    s_waitcnt lgkmcnt(11)
    ds_read_u16_d16_hi v218, v218
    v_or_b32 v239, v0, v253
    v_cvt_pkrtz_f16_f32 v222, v190, v191
    v_mfma_f32_16x16x32_f16 v[180:183], a[108:111], v[136:139], v[180:183]
    ds_read_u16 v221, v221
    v_pk_lshrrev_b16 v222, 3, v222 op_sel_hi:[0,1]
    v_mad_u32_u16 v223, v222, 2, s85
    v_mfma_f32_16x16x32_bf16 v[52:55], a[36:39], v[232:235], v[52:55]
    v_mad_u32_u16 v222, v222, 2, s85 op_sel:[1,0,0,0]
    v_mfma_f32_16x16x32_f16 v[176:179], a[112:115], v[144:147], v[176:179]
    ds_read_u16_d16_hi v220, v220
    v_mfma_f32_16x16x32_bf16 v[64:67], a[40:43], v[232:235], v[64:67]
    s_waitcnt lgkmcnt(13)
    ds_read_u16 v223, v223
    v_mfma_f32_16x16x32_f16 v[180:183], a[116:119], v[144:147], v[180:183]
    v_mfma_f32_16x16x32_bf16 v[68:71], a[44:47], v[232:235], v[68:71]
    s_waitcnt lgkmcnt(11)
    ds_read_u16_d16_hi v222, v222
    v_or_b32 v232, v209, v208
    v_or_b32 v233, v211, v210
    v_mfma_f32_16x16x32_f16 v[184:187], a[96:99], v[132:135], 0
    v_cvt_pkrtz_f16_f32 v224, v176, v177
    v_pk_lshrrev_b16 v224, 3, v224 op_sel_hi:[0,1]
    v_mad_u32_u16 v225, v224, 2, s85
    v_mfma_f32_16x16x32_bf16 v[40:43], a[24:27], v[236:239], v[40:43]
    s_waitcnt lgkmcnt(11)
    ds_read_u16 v225, v225
    v_mad_u32_u16 v224, v224, 2, s85 op_sel:[1,0,0,0]
    s_waitcnt lgkmcnt(11)
    v_or_b32 v234, v213, v212
    v_mfma_f32_16x16x32_f16 v[188:191], a[100:103], v[132:135], 0
    ds_read_u16_d16_hi v224, v224
    v_cvt_pkrtz_f16_f32 v226, v178, v179
    v_pk_lshrrev_b16 v226, 3, v226 op_sel_hi:[0,1]
    v_mfma_f32_16x16x32_bf16 v[44:47], a[28:31], v[236:239], v[44:47]
    v_mad_u32_u16 v227, v226, 2, s85
    v_mad_u32_u16 v226, v226, 2, s85 op_sel:[1,0,0,0]
    v_cvt_pkrtz_f16_f32 v228, v180, v181
    v_mfma_f32_16x16x32_f16 v[184:187], a[104:107], v[140:143], v[184:187]
    s_waitcnt lgkmcnt(10)
    ds_read_u16 v227, v227
    ds_read_u16_d16_hi v226, v226
    v_or_b32 v235, v215, v214
    v_mfma_f32_16x16x32_bf16 v[56:59], a[32:35], v[236:239], v[56:59]
    v_pk_lshrrev_b16 v228, 3, v228 op_sel_hi:[0,1]
    v_mad_u32_u16 v229, v228, 2, s85
    v_mad_u32_u16 v228, v228, 2, s85 op_sel:[1,0,0,0]
    v_mfma_f32_16x16x32_f16 v[188:191], a[108:111], v[140:143], v[188:191]
    ds_read_u16 v229, v229
    v_cvt_pkrtz_f16_f32 v230, v182, v183
    v_pk_lshrrev_b16 v230, 3, v230 op_sel_hi:[0,1]
    v_mfma_f32_16x16x32_bf16 v[60:63], a[36:39], v[236:239], v[60:63]
    ds_read_u16_d16_hi v228, v228
    v_mad_u32_u16 v231, v230, 2, s85
    v_mad_u32_u16 v230, v230, 2, s85 op_sel:[1,0,0,0]
    v_mfma_f32_16x16x32_f16 v[184:187], a[112:115], v[148:151], v[184:187]
    v_mfma_f32_16x16x32_f16 v[188:191], a[116:119], v[148:151], v[188:191]
    s_waitcnt lgkmcnt(13)
    ds_read_u16 v231, v231
    v_mfma_f32_16x16x32_bf16 v[72:75], a[40:43], v[236:239], v[72:75]
    s_waitcnt lgkmcnt(13)
    ds_read_u16_d16_hi v230, v230
    v_mfma_f32_16x16x32_bf16 v[76:79], a[44:47], v[236:239], v[76:79]
    s_waitcnt lgkmcnt(12)
    v_or_b32 v236, v217, v216
    v_or_b32 v237, v219, v218
    v_mfma_f32_16x16x32_f16 v[176:179], a[144:147], v[128:131], 0
    v_cvt_pkrtz_f16_f32 v248, v184, v185
    v_pk_lshrrev_b16 v248, 3, v248 op_sel_hi:[0,1]
    v_mad_u32_u16 v249, v248, 2, s85
    v_mfma_f32_16x16x32_bf16 v[32:35], a[72:75], v[232:235], v[32:35]
    s_waitcnt lgkmcnt(10)
    ds_read_u16 v249, v249
    v_or_b32 v238, v221, v220
    v_mad_u32_u16 v248, v248, 2, s85 op_sel:[1,0,0,0]
    v_mfma_f32_16x16x32_f16 v[180:183], a[148:151], v[128:131], 0
    ds_read_u16_d16_hi v248, v248
    v_cvt_pkrtz_f16_f32 v250, v186, v187
    v_pk_lshrrev_b16 v250, 3, v250 op_sel_hi:[0,1]
    v_mfma_f32_16x16x32_bf16 v[36:39], a[76:79], v[232:235], v[36:39]
    v_mad_u32_u16 v251, v250, 2, s85
    v_mad_u32_u16 v250, v250, 2, s85 op_sel:[1,0,0,0]
    v_cvt_pkrtz_f16_f32 v252, v188, v189
    v_mfma_f32_16x16x32_f16 v[176:179], a[152:155], v[136:139], v[176:179]
    s_waitcnt lgkmcnt(10)
    ds_read_u16 v251, v251
    ds_read_u16_d16_hi v250, v250
    v_or_b32 v239, v223, v222
    v_mfma_f32_16x16x32_bf16 v[48:51], a[80:83], v[232:235], v[48:51]
    v_pk_lshrrev_b16 v252, 3, v252 op_sel_hi:[0,1]
    v_mad_u32_u16 v253, v252, 2, s85
    v_mad_u32_u16 v252, v252, 2, s85 op_sel:[1,0,0,0]
    v_mfma_f32_16x16x32_f16 v[180:183], a[156:159], v[136:139], v[180:183]
    ds_read_u16 v253, v253
    v_cvt_pkrtz_f16_f32 v209, v190, v191
    v_pk_fma_f16 v0, v209, v209, s53
    v_mfma_f32_16x16x32_bf16 v[52:55], a[84:87], v[232:235], v[52:55]
    ds_read_u16_d16_hi v252, v252
    v_pk_mul_f16 v0, v0, v209 neg_lo:[1,0] neg_hi:[1,0]
    v_exp_f16 v208, v0
    v_mfma_f32_16x16x32_f16 v[176:179], a[160:163], v[144:147], v[176:179]
    v_exp_f16_sdwa v208, v0 dst_sel:WORD_1 dst_unused:UNUSED_PRESERVE src0_sel:WORD_1
    v_mfma_f32_16x16x32_bf16 v[64:67], a[88:91], v[232:235], v[64:67]
    v_pk_fma_f16 v208, v208, s86, s86
    v_rcp_f16 v0, v208
    v_mfma_f32_16x16x32_f16 v[180:183], a[164:167], v[144:147], v[180:183]
    v_rcp_f16_sdwa v0, v208 dst_sel:WORD_1 dst_unused:UNUSED_PRESERVE src0_sel:WORD_1
    v_mfma_f32_16x16x32_bf16 v[68:71], a[92:95], v[232:235], v[68:71]
    s_waitcnt lgkmcnt(12)
    v_fma_mix_f32 v208, v0, v209, 0 op_sel_hi:[1,1,0]
    v_fma_mix_f32 v0, v0, v209, 0 op_sel:[1,1,0] op_sel_hi:[1,1,0]
    v_or_b32 v232, v225, v224
    v_mfma_f32_16x16x32_f16 v[184:187], a[144:147], v[132:135], 0
    s_waitcnt lgkmcnt(8)
    v_or_b32 v233, v227, v226
    v_or_b32 v234, v229, v228
    v_cvt_pkrtz_f16_f32 v210, v176, v177
    v_mfma_f32_16x16x32_bf16 v[40:43], a[72:75], v[236:239], v[40:43]
    v_pk_lshrrev_b16 v210, 3, v210 op_sel_hi:[0,1]
    v_mad_u32_u16 v211, v210, 2, s85
    v_mad_u32_u16 v210, v210, 2, s85 op_sel:[1,0,0,0]
    v_mfma_f32_16x16x32_f16 v[188:191], a[148:151], v[132:135], 0
    ds_read_u16 v211, v211
    ds_read_u16_d16_hi v210, v210
    v_cvt_pkrtz_f16_f32 v212, v178, v179
    v_mfma_f32_16x16x32_bf16 v[44:47], a[76:79], v[236:239], v[44:47]
    s_waitcnt vmcnt(1) lgkmcnt(8)
    ds_read_b128 a[232:235], v8 offset:0
    v_or_b32 v235, v231, v230
    v_pk_lshrrev_b16 v212, 3, v212 op_sel_hi:[0,1]
    v_mfma_f32_16x16x32_f16 v[184:187], a[152:155], v[140:143], v[184:187]
    v_mad_u32_u16 v213, v212, 2, s85
    v_mad_u32_u16 v212, v212, 2, s85 op_sel:[1,0,0,0]
    v_cvt_pkrtz_f16_f32 v214, v180, v181
    v_mfma_f32_16x16x32_bf16 v[56:59], a[80:83], v[236:239], v[56:59]
    ds_read_u16 v213, v213
    ds_read_u16_d16_hi v212, v212
    v_pk_lshrrev_b16 v214, 3, v214 op_sel_hi:[0,1]
    v_mfma_f32_16x16x32_f16 v[188:191], a[156:159], v[140:143], v[188:191]
    v_mad_u32_u16 v215, v214, 2, s85
    v_mad_u32_u16 v214, v214, 2, s85 op_sel:[1,0,0,0]
    v_cvt_pkrtz_f16_f32 v216, v182, v183
    v_mfma_f32_16x16x32_bf16 v[60:63], a[84:87], v[236:239], v[60:63]
    ds_read_u16 v215, v215
    ds_read_u16_d16_hi v214, v214
    v_pk_lshrrev_b16 v216, 3, v216 op_sel_hi:[0,1]
    v_mfma_f32_16x16x32_f16 v[184:187], a[160:163], v[148:151], v[184:187]
    v_mad_u32_u16 v217, v216, 2, s85
    v_mad_u32_u16 v216, v216, 2, s85 op_sel:[1,0,0,0]
    v_mfma_f32_16x16x32_f16 v[188:191], a[164:167], v[148:151], v[188:191]
    s_waitcnt lgkmcnt(12)
    ds_read_u16 v217, v217
    ds_read_u16_d16_hi v216, v216
    v_mfma_f32_16x16x32_bf16 v[72:75], a[88:91], v[236:239], v[72:75]
    s_nop 0
    v_cvt_pkrtz_f16_f32 v218, v184, v185
    v_pk_lshrrev_b16 v218, 3, v218 op_sel_hi:[0,1]
    v_mfma_f32_16x16x32_bf16 v[76:79], a[92:95], v[236:239], v[76:79]
    s_waitcnt lgkmcnt(9)
    v_or_b32 v236, v249, v248
    v_or_b32 v237, v251, v250
    v_or_b32 v238, v253, v252
    v_mfma_f32_16x16x32_f16 v[192:195], a[0:3], v[152:155], 0
    v_cvt_pk_bf16_f32 v239, v208, v0
    v_mad_u32_u16 v219, v218, 2, s85
    v_mad_u32_u16 v218, v218, 2, s85 op_sel:[1,0,0,0]
    v_mfma_f32_16x16x32_bf16 v[32:35], a[120:123], v[232:235], v[32:35]
    ds_read_u16 v219, v219
    ds_read_u16_d16_hi v218, v218
    v_cvt_pkrtz_f16_f32 v220, v186, v187
    v_mfma_f32_16x16x32_f16 v[196:199], a[4:7], v[152:155], 0
    ds_read_b128 a[248:251], v12 offset:2560
    v_pk_lshrrev_b16 v220, 3, v220 op_sel_hi:[0,1]
    v_mad_u32_u16 v221, v220, 2, s85
    v_mfma_f32_16x16x32_bf16 v[36:39], a[124:127], v[232:235], v[36:39]
    ds_read_u16 v221, v221
    v_mad_u32_u16 v220, v220, 2, s85 op_sel:[1,0,0,0]
    v_cvt_pkrtz_f16_f32 v222, v188, v189
    v_mfma_f32_16x16x32_f16 v[192:195], a[8:11], v[160:163], v[192:195]
    ds_read_u16_d16_hi v220, v220
    v_pk_lshrrev_b16 v222, 3, v222 op_sel_hi:[0,1]
    v_mad_u32_u16 v223, v222, 2, s85
    v_mfma_f32_16x16x32_bf16 v[48:51], a[128:131], v[232:235], v[48:51]
    s_waitcnt lgkmcnt(12)
    ds_read_u16 v223, v223
    ds_read_b128 a[240:243], v15 offset:1280
    v_mad_u32_u16 v222, v222, 2, s85 op_sel:[1,0,0,0]
    v_mfma_f32_16x16x32_f16 v[196:199], a[12:15], v[160:163], v[196:199]
    s_waitcnt lgkmcnt(13)
    ds_read_u16_d16_hi v222, v222
    v_cvt_pkrtz_f16_f32 v224, v190, v191
    v_pk_lshrrev_b16 v224, 3, v224 op_sel_hi:[0,1]
    v_mfma_f32_16x16x32_bf16 v[52:55], a[132:135], v[232:235], v[52:55]
    v_mad_u32_u16 v225, v224, 2, s85
    v_mad_u32_u16 v224, v224, 2, s85 op_sel:[1,0,0,0]
    v_mfma_f32_16x16x32_f16 v[192:195], a[16:19], v[168:171], v[192:195]
    s_waitcnt lgkmcnt(13)
    ds_read_u16 v225, v225
    v_mfma_f32_16x16x32_bf16 v[64:67], a[136:139], v[232:235], v[64:67]
    s_waitcnt lgkmcnt(13)
    ds_read_u16_d16_hi v224, v224
    v_mfma_f32_16x16x32_f16 v[196:199], a[20:23], v[168:171], v[196:199]
    v_mfma_f32_16x16x32_bf16 v[68:71], a[140:143], v[232:235], v[68:71]
    s_waitcnt lgkmcnt(13)
    ds_read_b128 a[244:247], v8 offset:2560
    v_or_b32 v232, v211, v210
    v_or_b32 v233, v213, v212
    v_mfma_f32_16x16x32_f16 v[200:203], a[0:3], v[156:159], 0
    s_waitcnt lgkmcnt(11)
    v_or_b32 v234, v215, v214
    v_or_b32 v235, v217, v216
    v_cvt_pkrtz_f16_f32 v226, v192, v193
    v_mfma_f32_16x16x32_bf16 v[40:43], a[120:123], v[236:239], v[40:43]
    ds_read_b128 a[252:255], v15 offset:3840
    v_pk_lshrrev_b16 v226, 3, v226 op_sel_hi:[0,1]
    v_cvt_pkrtz_f16_f32 v228, v194, v195
    v_mfma_f32_16x16x32_f16 v[204:207], a[4:7], v[156:159], 0
    v_cvt_pkrtz_f16_f32 v230, v196, v197
    v_cvt_pkrtz_f16_f32 v248, v198, v199
    v_mad_u32_u16 v227, v226, 2, s85
    v_mfma_f32_16x16x32_bf16 v[44:47], a[124:127], v[236:239], v[44:47]
    ds_read_u16 v227, v227
    v_mad_u32_u16 v226, v226, 2, s85 op_sel:[1,0,0,0]
    v_pk_lshrrev_b16 v228, 3, v228 op_sel_hi:[0,1]
    v_mfma_f32_16x16x32_f16 v[200:203], a[8:11], v[164:167], v[200:203]
    ds_read_u16_d16_hi v226, v226
    v_mad_u32_u16 v229, v228, 2, s85
    v_mad_u32_u16 v228, v228, 2, s85 op_sel:[1,0,0,0]
    v_mfma_f32_16x16x32_bf16 v[56:59], a[128:131], v[236:239], v[56:59]
    s_waitcnt lgkmcnt(12)
    ds_read_u16 v229, v229
    ds_read_u16_d16_hi v228, v228
    v_pk_lshrrev_b16 v230, 3, v230 op_sel_hi:[0,1]
    v_mfma_f32_16x16x32_f16 v[204:207], a[12:15], v[164:167], v[204:207]
    s_waitcnt lgkmcnt(13)
    ds_read_b128 v[136:139], v11 offset:0
    v_mad_u32_u16 v231, v230, 2, s85
    v_mad_u32_u16 v230, v230, 2, s85 op_sel:[1,0,0,0]
    v_mfma_f32_16x16x32_bf16 v[60:63], a[132:135], v[236:239], v[60:63]
    v_pk_lshrrev_b16 v248, 3, v248 op_sel_hi:[0,1]
    v_mad_u32_u16 v249, v248, 2, s85
    v_mad_u32_u16 v248, v248, 2, s85 op_sel:[1,0,0,0]
    v_mfma_f32_16x16x32_f16 v[200:203], a[16:19], v[172:175], v[200:203]
    s_waitcnt lgkmcnt(12)
    ds_read_u16 v231, v231
    ds_read_u16_d16_hi v230, v230
    v_mfma_f32_16x16x32_f16 v[204:207], a[20:23], v[172:175], v[204:207]
    v_mfma_f32_16x16x32_bf16 v[72:75], a[136:139], v[236:239], v[72:75]
    s_waitcnt lgkmcnt(13)
    ds_read_u16 v249, v249
    v_mfma_f32_16x16x32_bf16 v[76:79], a[140:143], v[236:239], v[76:79]
    s_waitcnt lgkmcnt(12)
    v_or_b32 v236, v219, v218
    v_or_b32 v237, v221, v220
    v_or_b32 v238, v223, v222
    v_mfma_f32_16x16x32_f16 v[192:195], a[48:51], v[152:155], 0
    ds_read_b128 a[236:239], v12 offset:0
    v_cvt_pkrtz_f16_f32 v250, v200, v201
    v_cvt_pkrtz_f16_f32 v252, v202, v203
    v_mfma_f32_16x16x32_bf16 v[32:35], a[168:171], v[232:235], v[32:35]
    s_waitcnt lgkmcnt(11)
    ds_read_u16_d16_hi v248, v248
    v_or_b32 v239, v225, v224
    v_cvt_pkrtz_f16_f32 v0, v204, v205
    v_mfma_f32_16x16x32_f16 v[196:199], a[52:55], v[152:155], 0
    v_cvt_pkrtz_f16_f32 v209, v206, v207
    v_pk_lshrrev_b16 v250, 3, v250 op_sel_hi:[0,1]
    v_mad_u32_u16 v251, v250, 2, s85
    v_mfma_f32_16x16x32_bf16 v[36:39], a[172:175], v[232:235], v[36:39]
    ds_read_u16 v251, v251
    ds_read_b128 v[140:143], v15 offset:0
    v_mad_u32_u16 v250, v250, 2, s85 op_sel:[1,0,0,0]
    v_mfma_f32_16x16x32_f16 v[192:195], a[56:59], v[160:163], v[192:195]
    s_waitcnt lgkmcnt(13)
    ds_read_u16_d16_hi v250, v250
    v_pk_lshrrev_b16 v252, 3, v252 op_sel_hi:[0,1]
    v_mad_u32_u16 v253, v252, 2, s85
    v_mfma_f32_16x16x32_bf16 v[48:51], a[176:179], v[232:235], v[48:51]
    s_waitcnt lgkmcnt(13)
    ds_read_u16 v253, v253
    v_mad_u32_u16 v252, v252, 2, s85 op_sel:[1,0,0,0]
    v_pk_lshrrev_b16 v0, 3, v0 op_sel_hi:[0,1]
    v_mfma_f32_16x16x32_f16 v[196:199], a[60:63], v[160:163], v[196:199]
    v_mad_u32_u16 v208, v0, 2, s85
    v_mad_u32_u16 v0, v0, 2, s85 op_sel:[1,0,0,0]
    v_pk_lshrrev_b16 v209, 3, v209 op_sel_hi:[0,1]
    v_mfma_f32_16x16x32_bf16 v[52:55], a[180:183], v[232:235], v[52:55]
    s_waitcnt lgkmcnt(13)
    ds_read_u16_d16_hi v252, v252
    v_mad_u32_u16 v210, v209, 2, s85
    v_mad_u32_u16 v209, v209, 2, s85 op_sel:[1,0,0,0]
    v_mfma_f32_16x16x32_f16 v[192:195], a[64:67], v[168:171], v[192:195]
    s_waitcnt lgkmcnt(11)
    ds_read_u16 v208, v208
    v_or_b32 v240, v227, v226
    v_or_b32 v241, v229, v228
    v_mfma_f32_16x16x32_bf16 v[64:67], a[184:187], v[232:235], v[64:67]
    ds_read_u16_d16_hi v0, v0
    v_cvt_pk_bf16_f32 v32, v32, v33
    v_cvt_pk_bf16_f32 v33, v34, v35
    v_mfma_f32_16x16x32_f16 v[196:199], a[68:71], v[168:171], v[196:199]
    ds_read_u16 v210, v210
    v_cvt_pkrtz_f16_f32 v211, v192, v193
    v_pk_lshrrev_b16 v211, 3, v211 op_sel_hi:[0,1]
    v_mfma_f32_16x16x32_bf16 v[68:71], a[188:191], v[232:235], v[68:71]
    s_waitcnt lgkmcnt(11)
    v_cvt_pkrtz_f16_f32 v213, v194, v195
    v_or_b32 v242, v231, v230
    v_mad_u32_u16 v212, v211, 2, s85
    v_mfma_f32_16x16x32_f16 v[200:203], a[48:51], v[156:159], 0
    ds_read_u16_d16_hi v209, v209
    v_cvt_pkrtz_f16_f32 v215, v196, v197
    v_cvt_pkrtz_f16_f32 v217, v198, v199
    v_mfma_f32_16x16x32_bf16 v[40:43], a[168:171], v[236:239], v[40:43]
    ds_read_b128 v[148:151], v11 offset:2560
    v_mad_u32_u16 v211, v211, 2, s85 op_sel:[1,0,0,0]
    v_pk_lshrrev_b16 v213, 3, v213 op_sel_hi:[0,1]
    v_mfma_f32_16x16x32_f16 v[204:207], a[52:55], v[156:159], 0
    ds_read_b128 v[144:147], v12 offset:1280
    v_mad_u32_u16 v214, v213, 2, s85
    v_mad_u32_u16 v213, v213, 2, s85 op_sel:[1,0,0,0]
    v_mfma_f32_16x16x32_bf16 v[44:47], a[172:175], v[236:239], v[44:47]
    s_waitcnt lgkmcnt(11)
    ds_read_u16 v212, v212
    v_or_b32 v243, v249, v248
    v_pk_lshrrev_b16 v215, 3, v215 op_sel_hi:[0,1]
    v_mfma_f32_16x16x32_f16 v[200:203], a[56:59], v[164:167], v[200:203]
    ds_read_b128 v[180:183], v13 offset:0
    v_mad_u32_u16 v216, v215, 2, s85
    v_mad_u32_u16 v215, v215, 2, s85 op_sel:[1,0,0,0]
    v_mfma_f32_16x16x32_bf16 v[56:59], a[176:179], v[236:239], v[56:59]
    ds_read_u16_d16_hi v211, v211
    v_pk_lshrrev_b16 v217, 3, v217 op_sel_hi:[0,1]
    v_mad_u32_u16 v218, v217, 2, s85
    v_mfma_f32_16x16x32_f16 v[204:207], a[60:63], v[164:167], v[204:207]
    s_waitcnt lgkmcnt(11)
    v_mad_u32_u16 v217, v217, 2, s85 op_sel:[1,0,0,0]
    v_or_b32 v244, v251, v250
    v_cvt_pk_bf16_f32 v34, v36, v37
    v_mfma_f32_16x16x32_bf16 v[60:63], a[180:183], v[236:239], v[60:63]
    ds_read_u16 v214, v214
    v_cvt_pk_bf16_f32 v35, v38, v39
    v_cvt_pk_bf16_f32 v40, v40, v41
    v_mfma_f32_16x16x32_f16 v[200:203], a[64:67], v[172:175], v[200:203]
    ds_read_b128 v[188:191], v9 offset:2560
    v_cvt_pk_bf16_f32 v41, v42, v43
    v_cvt_pk_bf16_f32 v42, v44, v45
    v_mfma_f32_16x16x32_f16 v[204:207], a[68:71], v[172:175], v[204:207]
    s_waitcnt lgkmcnt(11)
    ds_read_u16_d16_hi v213, v213
    v_or_b32 v245, v253, v252
    v_cvt_pk_bf16_f32 v43, v46, v47
    v_mfma_f32_16x16x32_bf16 v[72:75], a[184:187], v[236:239], v[72:75]
    v_cvt_pkrtz_f16_f32 v219, v200, v201
    v_cvt_pkrtz_f16_f32 v221, v202, v203
    v_pk_lshrrev_b16 v219, 3, v219 op_sel_hi:[0,1]
    v_mfma_f32_16x16x32_bf16 v[76:79], a[188:191], v[236:239], v[76:79]
    ds_read_u16 v216, v216
    v_cvt_pkrtz_f16_f32 v223, v204, v205
    v_cvt_pkrtz_f16_f32 v225, v206, v207
    v_mfma_f32_16x16x32_f16 v[192:195], a[96:99], v[152:155], 0
    s_waitcnt lgkmcnt(11)
    ds_read_u16_d16_hi v215, v215
    v_or_b32 v246, v208, v0
    v_mad_u32_u16 v220, v219, 2, s85
    v_mfma_f32_16x16x32_bf16 v[80:83], a[24:27], v[240:243], v[80:83]
    ds_read_u16 v218, v218
    v_mad_u32_u16 v219, v219, 2, s85 op_sel:[1,0,0,0]
    v_pk_lshrrev_b16 v221, 3, v221 op_sel_hi:[0,1]
    v_mfma_f32_16x16x32_f16 v[196:199], a[100:103], v[152:155], 0
    s_waitcnt lgkmcnt(12)
    buffer_store_dwordx4 v[40:43], v26, s[24:27], s81 offen offset:0 sc0 sc1
    ds_read_u16_d16_hi v217, v217
    ds_read_u16 v220, v220
    v_mfma_f32_16x16x32_bf16 v[84:87], a[28:31], v[240:243], v[84:87]
    s_waitcnt lgkmcnt(13)
    v_or_b32 v247, v210, v209
    v_mad_u32_u16 v222, v221, 2, s85
    v_mad_u32_u16 v221, v221, 2, s85 op_sel:[1,0,0,0]
    v_mfma_f32_16x16x32_f16 v[192:195], a[104:107], v[160:163], v[192:195]
    s_waitcnt lgkmcnt(12)
    ds_read_u16_d16_hi v219, v219
    buffer_store_dwordx4 v[32:35], v26, s[24:27], s80 offen offset:0 sc0 sc1
    ds_read_u16 v222, v222
    v_mfma_f32_16x16x32_bf16 v[96:99], a[32:35], v[240:243], v[96:99]
    s_waitcnt lgkmcnt(13)
    ds_read_u16_d16_hi v221, v221
    v_pk_lshrrev_b16 v223, 3, v223 op_sel_hi:[0,1]
    v_mad_u32_u16 v224, v223, 2, s85
    v_mfma_f32_16x16x32_f16 v[196:199], a[108:111], v[160:163], v[196:199]
    v_mad_u32_u16 v223, v223, 2, s85 op_sel:[1,0,0,0]
    v_pk_lshrrev_b16 v225, 3, v225 op_sel_hi:[0,1]
    v_mad_u32_u16 v226, v225, 2, s85
    v_mfma_f32_16x16x32_bf16 v[100:103], a[36:39], v[240:243], v[100:103]
    s_waitcnt lgkmcnt(13)
    ds_read_u16 v224, v224
    v_mad_u32_u16 v225, v225, 2, s85 op_sel:[1,0,0,0]
    v_cvt_pk_bf16_f32 v48, v48, v49
    v_mfma_f32_16x16x32_f16 v[192:195], a[112:115], v[168:171], v[192:195]
    s_waitcnt lgkmcnt(13)
    ds_read_u16_d16_hi v223, v223
    v_cvt_pk_bf16_f32 v49, v50, v51
    v_cvt_pk_bf16_f32 v50, v52, v53
    v_mfma_f32_16x16x32_bf16 v[112:115], a[40:43], v[240:243], v[112:115]
    s_waitcnt lgkmcnt(13)
    ds_read_u16 v226, v226
    v_cvt_pk_bf16_f32 v51, v54, v55
    v_cvt_pk_bf16_f32 v56, v56, v57
    v_mfma_f32_16x16x32_f16 v[196:199], a[116:119], v[168:171], v[196:199]
    s_waitcnt lgkmcnt(13)
    ds_read_u16_d16_hi v225, v225
    v_cvt_pk_bf16_f32 v57, v58, v59
    v_cvt_pk_bf16_f32 v58, v60, v61
    v_mfma_f32_16x16x32_bf16 v[116:119], a[44:47], v[240:243], v[116:119]
    s_waitcnt lgkmcnt(13)
    ds_read_b128 v[232:235], v13 offset:2560
    v_cvt_pk_bf16_f32 v59, v62, v63
    v_cvt_pk_bf16_f32 v64, v64, v65
    v_mfma_f32_16x16x32_f16 v[200:203], a[96:99], v[156:159], 0
    s_waitcnt lgkmcnt(12)
    buffer_store_dwordx4 v[56:59], v26, s[24:27], s81 offen offset:64 sc0 sc1
    ds_read_b128 v[32:35], v10 offset:0
    buffer_store_dwordx4 v[48:51], v26, s[24:27], s80 offen offset:64 sc0 sc1
    ds_read_b128 v[176:179], v9 offset:0
    v_mfma_f32_16x16x32_bf16 v[88:91], a[24:27], v[244:247], v[88:91]
    v_cvt_pk_bf16_f32 v65, v66, v67
    v_cvt_pk_bf16_f32 v66, v68, v69
    v_cvt_pk_bf16_f32 v67, v70, v71
    v_mfma_f32_16x16x32_f16 v[204:207], a[100:103], v[156:159], 0
    v_cvt_pk_bf16_f32 v72, v72, v73
    v_cvt_pk_bf16_f32 v73, v74, v75
    v_cvt_pk_bf16_f32 v74, v76, v77
    v_mfma_f32_16x16x32_bf16 v[92:95], a[28:31], v[244:247], v[92:95]
    v_cvt_pk_bf16_f32 v75, v78, v79
    v_or_b32 v240, v212, v211
    v_or_b32 v241, v214, v213
    v_mfma_f32_16x16x32_f16 v[200:203], a[104:107], v[164:167], v[200:203]
    s_waitcnt lgkmcnt(11)
    ds_read_b128 v[184:187], v14 offset:1280
    v_or_b32 v242, v216, v215
    v_or_b32 v243, v218, v217
    v_mfma_f32_16x16x32_bf16 v[104:107], a[32:35], v[244:247], v[104:107]
    ds_read_b128 v[44:47], v10 offset:2560
    v_cvt_pkrtz_f16_f32 v227, v192, v193
    v_pk_lshrrev_b16 v227, 3, v227 op_sel_hi:[0,1]
    v_mfma_f32_16x16x32_f16 v[204:207], a[108:111], v[164:167], v[204:207]
    ds_read_b128 v[36:39], v14 offset:0
    v_cvt_pkrtz_f16_f32 v229, v194, v195
    v_cvt_pkrtz_f16_f32 v231, v196, v197
    v_mfma_f32_16x16x32_bf16 v[108:111], a[36:39], v[244:247], v[108:111]
    v_cvt_pkrtz_f16_f32 v249, v198, v199
    v_mad_u32_u16 v228, v227, 2, s85
    v_mad_u32_u16 v227, v227, 2, s85 op_sel:[1,0,0,0]
    v_mfma_f32_16x16x32_f16 v[200:203], a[112:115], v[172:175], v[200:203]
    s_waitcnt lgkmcnt(12)
    ds_read_u16 v228, v228
    ds_read_u16_d16_hi v227, v227
    v_pk_lshrrev_b16 v229, 3, v229 op_sel_hi:[0,1]
    v_mfma_f32_16x16x32_f16 v[204:207], a[116:119], v[172:175], v[204:207]
    buffer_store_dwordx4 v[72:75], v26, s[24:27], s81 offen offset:128 sc0 sc1
    v_mfma_f32_16x16x32_bf16 v[120:123], a[40:43], v[244:247], v[120:123]
    v_mad_u32_u16 v230, v229, 2, s85
    v_mad_u32_u16 v229, v229, 2, s85 op_sel:[1,0,0,0]
    v_cvt_pkrtz_f16_f32 v251, v200, v201
    v_mfma_f32_16x16x32_bf16 v[124:127], a[44:47], v[244:247], v[124:127]
    s_waitcnt lgkmcnt(12)
    ds_read_u16 v230, v230
    ds_read_u16_d16_hi v229, v229
    v_or_b32 v244, v220, v219
    v_mfma_f32_16x16x32_f16 v[192:195], a[144:147], v[152:155], 0
    s_waitcnt lgkmcnt(12)
    ds_read_b128 v[56:59], v20 offset:2560
    v_or_b32 v245, v222, v221
    v_or_b32 v246, v224, v223
    v_mfma_f32_16x16x32_bf16 v[80:83], a[72:75], v[240:243], v[80:83]
    s_waitcnt lgkmcnt(11)
    v_or_b32 v247, v226, v225
    v_cvt_pkrtz_f16_f32 v253, v202, v203
    v_cvt_pkrtz_f16_f32 v208, v204, v205
    v_mfma_f32_16x16x32_f16 v[196:199], a[148:151], v[152:155], 0
    ds_read_b128 v[60:63], v21 offset:2560
    v_cvt_pkrtz_f16_f32 v210, v206, v207
    v_pk_lshrrev_b16 v231, 3, v231 op_sel_hi:[0,1]
    v_mfma_f32_16x16x32_bf16 v[84:87], a[76:79], v[240:243], v[84:87]
    buffer_store_dwordx4 v[64:67], v26, s[24:27], s80 offen offset:128 sc0 sc1
    v_mfma_f32_16x16x32_f16 v[192:195], a[152:155], v[160:163], v[192:195]
    ds_read_b128 v[52:55], v21 offset:0
    v_mad_u32_u16 v248, v231, 2, s85
    v_mad_u32_u16 v231, v231, 2, s85 op_sel:[1,0,0,0]
    v_mfma_f32_16x16x32_bf16 v[96:99], a[80:83], v[240:243], v[96:99]
    s_waitcnt lgkmcnt(12)
    ds_read_u16 v248, v248
    ds_read_u16_d16_hi v231, v231
    v_pk_lshrrev_b16 v249, 3, v249 op_sel_hi:[0,1]
    v_mfma_f32_16x16x32_f16 v[196:199], a[156:159], v[160:163], v[196:199]
    s_waitcnt lgkmcnt(11)
    ds_read_b128 v[236:239], v14 offset:3840
    ds_read_b128 v[48:51], v20 offset:0
    ds_read_b128 v[40:43], v13 offset:1280
    v_mfma_f32_16x16x32_bf16 v[100:103], a[84:87], v[240:243], v[100:103]
    v_mad_u32_u16 v250, v249, 2, s85
    v_mad_u32_u16 v249, v249, 2, s85 op_sel:[1,0,0,0]
    v_pk_lshrrev_b16 v251, 3, v251 op_sel_hi:[0,1]
    v_mfma_f32_16x16x32_f16 v[192:195], a[160:163], v[168:171], v[192:195]
    s_waitcnt lgkmcnt(12)
    ds_read_u16 v250, v250
    ds_read_u16_d16_hi v249, v249
    v_mad_u32_u16 v252, v251, 2, s85
    v_mfma_f32_16x16x32_bf16 v[112:115], a[88:91], v[240:243], v[112:115]
    s_waitcnt lgkmcnt(13)
    ds_read_u16 v252, v252
    v_mad_u32_u16 v251, v251, 2, s85 op_sel:[1,0,0,0]
    v_pk_lshrrev_b16 v253, 3, v253 op_sel_hi:[0,1]
    v_mfma_f32_16x16x32_f16 v[196:199], a[164:167], v[168:171], v[196:199]
    v_mad_u32_u16 v0, v253, 2, s85
    v_mad_u32_u16 v253, v253, 2, s85 op_sel:[1,0,0,0]
    v_pk_lshrrev_b16 v208, 3, v208 op_sel_hi:[0,1]
    v_mfma_f32_16x16x32_bf16 v[116:119], a[92:95], v[240:243], v[116:119]
    s_waitcnt lgkmcnt(12)
    ds_read_u16_d16_hi v251, v251
    ds_read_u16 v0, v0
    v_mad_u32_u16 v209, v208, 2, s85
    v_mfma_f32_16x16x32_f16 v[200:203], a[144:147], v[156:159], 0
    s_waitcnt lgkmcnt(13)
    ds_read_u16_d16_hi v253, v253
    v_mad_u32_u16 v208, v208, 2, s85 op_sel:[1,0,0,0]
    v_pk_lshrrev_b16 v210, 3, v210 op_sel_hi:[0,1]
    v_mfma_f32_16x16x32_bf16 v[88:91], a[72:75], v[244:247], v[88:91]
    s_waitcnt lgkmcnt(13)
    ds_read_u16 v209, v209
    v_mad_u32_u16 v211, v210, 2, s85
    v_mad_u32_u16 v210, v210, 2, s85 op_sel:[1,0,0,0]
    v_mfma_f32_16x16x32_f16 v[204:207], a[148:151], v[156:159], 0
    s_waitcnt lgkmcnt(13)
    ds_read_u16_d16_hi v208, v208
    v_or_b32 v240, v228, v227
    v_or_b32 v241, v230, v229
    v_mfma_f32_16x16x32_bf16 v[92:95], a[76:79], v[244:247], v[92:95]
    s_waitcnt lgkmcnt(12)
    v_cvt_pkrtz_f16_f32 v212, v192, v193
    v_pk_lshrrev_b16 v212, 3, v212 op_sel_hi:[0,1]
    s_waitcnt lgkmcnt(11)
    v_or_b32 v242, v248, v231
    v_mfma_f32_16x16x32_f16 v[200:203], a[152:155], v[164:167], v[200:203]
    ds_read_u16 v211, v211
    ds_read_u16_d16_hi v210, v210
    v_cvt_pkrtz_f16_f32 v214, v194, v195
    v_mfma_f32_16x16x32_bf16 v[104:107], a[80:83], v[244:247], v[104:107]
    ds_read_b128 v[64:67], v14 offset:2560
    v_cvt_pkrtz_f16_f32 v216, v196, v197
    v_cvt_pkrtz_f16_f32 v218, v198, v199
    v_mfma_f32_16x16x32_f16 v[204:207], a[156:159], v[164:167], v[204:207]
    s_waitcnt lgkmcnt(13)
    ds_read_b128 v[68:71], v13 offset:3840
    v_mad_u32_u16 v213, v212, 2, s85
    v_mad_u32_u16 v212, v212, 2, s85 op_sel:[1,0,0,0]
    v_mfma_f32_16x16x32_bf16 v[108:111], a[84:87], v[244:247], v[108:111]
    v_pk_lshrrev_b16 v214, 3, v214 op_sel_hi:[0,1]
    v_mad_u32_u16 v215, v214, 2, s85
    v_mad_u32_u16 v214, v214, 2, s85 op_sel:[1,0,0,0]
    v_mfma_f32_16x16x32_f16 v[200:203], a[160:163], v[172:175], v[200:203]
    s_waitcnt lgkmcnt(11)
    ds_read_b128 v[72:75], v15 offset:2560
    v_pk_lshrrev_b16 v216, 3, v216 op_sel_hi:[0,1]
    s_waitcnt lgkmcnt(11)
    v_or_b32 v243, v250, v249
    v_mfma_f32_16x16x32_f16 v[204:207], a[164:167], v[172:175], v[204:207]
    ds_read_b128 v[76:79], v12 offset:3840
    v_mad_u32_u16 v217, v216, 2, s85
    v_mad_u32_u16 v216, v216, 2, s85 op_sel:[1,0,0,0]
    v_mfma_f32_16x16x32_bf16 v[120:123], a[88:91], v[244:247], v[120:123]
    ds_read_u16 v213, v213
    v_cvt_pkrtz_f16_f32 v220, v200, v201
    v_cvt_pkrtz_f16_f32 v222, v202, v203
    v_mfma_f32_16x16x32_bf16 v[124:127], a[92:95], v[244:247], v[124:127]
    s_waitcnt lgkmcnt(11)
    v_cvt_pkrtz_f16_f32 v224, v204, v205
    v_or_b32 v244, v252, v251
    v_cvt_pkrtz_f16_f32 v226, v206, v207
    v_mfma_f32_16x16x32_bf16 v[80:83], a[120:123], v[240:243], v[80:83]
    ds_read_u16_d16_hi v212, v212
    v_pk_lshrrev_b16 v218, 3, v218 op_sel_hi:[0,1]
    v_mad_u32_u16 v219, v218, 2, s85
    v_mfma_f32_16x16x32_bf16 v[84:87], a[124:127], v[240:243], v[84:87]
    s_add_u32 m0, s56, -128
    ds_read_u16 v215, v215
    v_mad_u32_u16 v218, v218, 2, s85 op_sel:[1,0,0,0]
    v_pk_lshrrev_b16 v220, 3, v220 op_sel_hi:[0,1]
    v_mfma_f32_16x16x32_bf16 v[96:99], a[128:131], v[240:243], v[96:99]
    s_waitcnt lgkmcnt(11)
    ds_read_u16_d16_hi v214, v214
    v_or_b32 v245, v0, v253
    v_mad_u32_u16 v221, v220, 2, s85
    v_mfma_f32_16x16x32_bf16 v[100:103], a[132:135], v[240:243], v[100:103]
    v_mad_u32_u16 v220, v220, 2, s85 op_sel:[1,0,0,0]
    v_pk_lshrrev_b16 v222, 3, v222 op_sel_hi:[0,1]
    v_mad_u32_u16 v223, v222, 2, s85
    v_mfma_f32_16x16x32_bf16 v[112:115], a[136:139], v[240:243], v[112:115]
    ds_read_u16 v217, v217
    v_mad_u32_u16 v222, v222, 2, s85 op_sel:[1,0,0,0]
    v_pk_lshrrev_b16 v224, 3, v224 op_sel_hi:[0,1]
    v_mfma_f32_16x16x32_bf16 v[116:119], a[140:143], v[240:243], v[116:119]
    s_waitcnt lgkmcnt(11)
    ds_read_u16_d16_hi v216, v216
    v_or_b32 v246, v209, v208
    v_mad_u32_u16 v225, v224, 2, s85
    v_mad_u32_u16 v224, v224, 2, s85 op_sel:[1,0,0,0]
    v_pk_lshrrev_b16 v226, 3, v226 op_sel_hi:[0,1]
    v_mad_u32_u16 v227, v226, 2, s85
    v_mad_u32_u16 v226, v226, 2, s85 op_sel:[1,0,0,0]
    ds_read_u16 v219, v219
    s_waitcnt lgkmcnt(11)
    v_or_b32 v247, v211, v210
    s_nop 1
    v_mfma_f32_16x16x32_bf16 v[88:91], a[120:123], v[244:247], v[88:91]
    ds_read_u16_d16_hi v218, v218
    ds_read_u16 v221, v221
    v_mfma_f32_16x16x32_bf16 v[92:95], a[124:127], v[244:247], v[92:95]
    ds_read_u16_d16_hi v220, v220
    v_mfma_f32_16x16x32_bf16 v[104:107], a[128:131], v[244:247], v[104:107]
    s_waitcnt lgkmcnt(13)
    ds_read_u16 v223, v223
    v_mfma_f32_16x16x32_bf16 v[108:111], a[132:135], v[244:247], v[108:111]
    s_waitcnt lgkmcnt(11)
    ds_read_u16_d16_hi v222, v222
    buffer_load_dwordx4 v1, s[20:23], 0 offen offset:128 lds
    s_add_u32 m0, s56, 896
    v_mfma_f32_16x16x32_bf16 v[120:123], a[136:139], v[244:247], v[120:123]
    ds_read_u16 v225, v225
    buffer_load_dwordx4 v2, s[20:23], 0 offen offset:128 lds
    s_add_u32 m0, s56, 1920
    v_mfma_f32_16x16x32_bf16 v[124:127], a[140:143], v[244:247], v[124:127]
    s_waitcnt lgkmcnt(8)
    ds_read_u16_d16_hi v224, v224
    buffer_load_dwordx4 v3, s[20:23], 0 offen offset:128 lds
    v_or_b32 v240, v213, v212
    s_add_u32 m0, s56, 2944
    ds_read_u16 v227, v227
    buffer_load_dwordx4 v4, s[20:23], 0 offen offset:128 lds
    s_add_u32 m0, s56, 3968
    v_or_b32 v241, v215, v214
    ds_read_u16_d16_hi v226, v226
    buffer_load_dwordx4 v5, s[20:23], 0 offen offset:128 lds
    ds_read_b128 v[192:195], v22 offset:0
    s_add_u32 m0, s56, 4992
    s_nop 0
    buffer_load_dwordx4 v6, s[20:23], 0 offen offset:128 lds
    s_add_u32 m0, s56, 6016
    s_waitcnt lgkmcnt(11)
    v_or_b32 v242, v217, v216
    ds_read_b128 v[196:199], v22 offset:256
    buffer_load_dword v7, s[20:23], 0 offen offset:128 lds
    ds_read_b128 v[204:207], v22 offset:272
    s_waitcnt lgkmcnt(11)
    v_or_b32 v243, v219, v218
    s_nop 1
    v_mfma_f32_16x16x32_bf16 v[80:83], a[168:171], v[240:243], v[80:83]
    v_mfma_f32_16x16x32_bf16 v[84:87], a[172:175], v[240:243], v[84:87]
    v_mfma_f32_16x16x32_bf16 v[96:99], a[176:179], v[240:243], v[96:99]
    s_waitcnt lgkmcnt(9)
    ds_read_b128 v[200:203], v22 offset:16
    v_or_b32 v244, v221, v220
    v_mfma_f32_16x16x32_bf16 v[100:103], a[180:183], v[240:243], v[100:103]
    v_mfma_f32_16x16x32_bf16 v[112:115], a[184:187], v[240:243], v[112:115]
    s_waitcnt lgkmcnt(9)
    v_mfma_f32_16x16x32_bf16 v[116:119], a[188:191], v[240:243], v[116:119]
    s_add_u32 s52, s52, 1
    s_cmp_eq_u32 s52, 4
    s_waitcnt lgkmcnt(8)
    v_or_b32 v245, v223, v222
    s_waitcnt lgkmcnt(6)
    v_or_b32 v246, v225, v224
    s_waitcnt lgkmcnt(4)
    v_or_b32 v247, v227, v226
    s_cbranch_scc0 L_conv
L_final:
    s_nop 0
    v_mfma_f32_16x16x32_bf16 v[88:91], a[168:171], v[244:247], v[88:91]
    v_cvt_pk_bf16_f32 v80, v80, v81
    v_cvt_pk_bf16_f32 v81, v82, v83
    v_cvt_pk_bf16_f32 v82, v84, v85
    v_mfma_f32_16x16x32_bf16 v[92:95], a[172:175], v[244:247], v[92:95]
    v_cvt_pk_bf16_f32 v83, v86, v87
    v_cvt_pk_bf16_f32 v96, v96, v97
    v_cvt_pk_bf16_f32 v97, v98, v99
    v_mfma_f32_16x16x32_bf16 v[104:107], a[176:179], v[244:247], v[104:107]
    buffer_store_dwordx4 v[80:83], v26, s[24:27], s82 offen offset:0 sc0 sc1
    v_mfma_f32_16x16x32_bf16 v[108:111], a[180:183], v[244:247], v[108:111]
    v_cvt_pk_bf16_f32 v98, v100, v101
    v_cvt_pk_bf16_f32 v99, v102, v103
    v_cvt_pk_bf16_f32 v112, v112, v113
    v_mfma_f32_16x16x32_bf16 v[120:123], a[184:187], v[244:247], v[120:123]
    buffer_store_dwordx4 v[96:99], v26, s[24:27], s82 offen offset:64 sc0 sc1
    v_mfma_f32_16x16x32_bf16 v[124:127], a[188:191], v[244:247], v[124:127]
    v_cvt_pk_bf16_f32 v113, v114, v115
    v_cvt_pk_bf16_f32 v114, v116, v117
    v_cvt_pk_bf16_f32 v115, v118, v119
    v_cvt_pk_bf16_f32 v88, v88, v89
    v_cvt_pk_bf16_f32 v89, v90, v91
    v_cvt_pk_bf16_f32 v90, v92, v93
    v_cvt_pk_bf16_f32 v91, v94, v95
    v_cvt_pk_bf16_f32 v104, v104, v105
    v_cvt_pk_bf16_f32 v105, v106, v107
    v_cvt_pk_bf16_f32 v106, v108, v109
    v_cvt_pk_bf16_f32 v107, v110, v111
    v_cvt_pk_bf16_f32 v120, v120, v121
    v_cvt_pk_bf16_f32 v121, v122, v123
    v_cvt_pk_bf16_f32 v122, v124, v125
    v_cvt_pk_bf16_f32 v123, v126, v127
    buffer_store_dwordx4 v[112:115], v26, s[24:27], s82 offen offset:128 sc0 sc1
    buffer_store_dwordx4 v[88:91], v26, s[24:27], s83 offen offset:0 sc0 sc1
    buffer_store_dwordx4 v[104:107], v26, s[24:27], s83 offen offset:64 sc0 sc1
    buffer_store_dwordx4 v[120:123], v26, s[24:27], s83 offen offset:128 sc0 sc1
L_end:
L_last:
    s_endpgm
.section .rodata,"a"
.p2align 6
.amdhsa_kernel standalone__modern_conv_block_convnext__vision_kernel
  .amdhsa_next_free_vgpr 512
  .amdhsa_next_free_sgpr 102
  .amdhsa_accum_offset 256
  .amdhsa_group_segment_fixed_size 0
  .amdhsa_kernarg_size 80
  .amdhsa_user_sgpr_count 2
  .amdhsa_user_sgpr_kernarg_segment_ptr 1
  .amdhsa_system_sgpr_workgroup_id_x 1
.end_amdhsa_kernel
```
